```python
import torch

def _softmax(x, axis=-1):
    return torch.softmax(x, dim=axis)
def _gelu(x):
    return torch.nn.functional.gelu(x, approximate="tanh")
def _silu(x):
    return torch.nn.functional.silu(x)
def _sigmoid(x):
    return torch.sigmoid(x)
def _layernorm(x, axis=-1, eps=1e-5):
    m = x.mean(dim=axis, keepdim=True)
    v = x.var(dim=axis, keepdim=True, unbiased=False)
    return (x - m) / torch.sqrt(v + eps)
def _scatter_add(tgt, idx, src, axis=0):
    return tgt.clone().index_add_(axis, idx, src)
def _segment_sum(src, seg, n):
    out = torch.zeros((n,) + src.shape[1:], dtype=src.dtype)
    return out.index_add_(0, seg, src)
def _pad(x, pw):
    flat = tuple(v for pair in reversed(pw) for v in pair)
    return torch.nn.functional.pad(x, flat)

kernel_name = 'gated_mix__sliding_local_dilated__moe_arch_mod__prompt'

def setup_inputs():

    _w = (lambda a: (lambda t: t.to(torch.bfloat16) if t.is_floating_point() else t)(torch.as_tensor(a)))
    def _A_setup():
        B, S, D = 1, 2048, 640
        return {
            "x": _w((lambda *s: torch.randn(*s, dtype=torch.bfloat16) * 0.05)(B, S, D)),
            "wqkv": _w((lambda *s: torch.randn(*s, dtype=torch.bfloat16) * 0.8)(D, 3 * D)),
            "wo": _w((lambda *s: torch.randn(*s, dtype=torch.bfloat16) * 0.05)(D, D)),
        }
    _A_in = _A_setup()

    def _B_setup():
        B, S, D, F, C = 1, 2048, 640, 1728, 2
        return {
            "x": _w((lambda *s: torch.randn(*s, dtype=torch.bfloat16) * 0.05)(B, S, D)),
            "w_r": _w((lambda *s: torch.randn(*s, dtype=torch.bfloat16) * 1.6)(D)),
            "w_gate": _w((lambda *s: torch.randn(*s, dtype=torch.bfloat16) * 0.4)(D, F)),
            "w_up": _w((lambda *s: torch.randn(*s, dtype=torch.bfloat16) * 0.4)(D, F)),
            "w_down": _w((lambda *s: torch.randn(*s, dtype=torch.bfloat16) * 0.4)(F, D)),
        }
    _B_in = _B_setup()

    return {
        "A_x": _A_in["x"],
        "A_wqkv": _A_in["wqkv"],
        "A_wo": _A_in["wo"],
        "B_x": _B_in["x"],
        "B_w_r": _B_in["w_r"],
        "B_w_gate": _B_in["w_gate"],
        "B_w_up": _B_in["w_up"],
        "B_w_down": _B_in["w_down"],
        "gate_w": _w((lambda *s: torch.randn(*s, dtype=torch.bfloat16) * 0.05)(640) * 16.0),
    }

def reference(A_x, A_wqkv, A_wo, B_x, B_w_r, B_w_gate, B_w_up, B_w_down, gate_w):
    def _A_ref(x, wqkv, wo):
        B, S, D = x.shape
        H = 32; Dh = D // H
        W, dil = 8, 2
        qkv = (lambda x, *d: x.permute(*d))((x @ wqkv).reshape(B, S, 3, H, Dh), 2, 0, 3, 1, 4)
        q, k, v = qkv[0], qkv[1], qkv[2]
        scale = Dh ** -0.5
        pos = torch.arange(S)
        off = torch.arange(W) * dil
        idx = pos[:, None] - off[None, :]
        mask = idx >= 0
        idx_c = torch.where(mask, idx, 0).reshape(-1)
        kg = k[:, :, idx_c, :].reshape(B, H, S, W, Dh)
        vg = v[:, :, idx_c, :].reshape(B, H, S, W, Dh)
        logits = torch.einsum("bhsd,bhswd->bhsw", q, kg) * scale
        logits = torch.where(mask[None, None, :, :], logits, -1e9)
        attn = _softmax(logits, axis=-1)
        o = torch.einsum("bhsw,bhswd->bhsd", attn, vg)
        return (lambda x, *d: x.permute(*d))(o, 0, 2, 1, 3).reshape(B, S, D) @ wo

    def _B_ref(x, w_r, w_gate, w_up, w_down):
        B, S, D = x.shape
        C = 2
        r = x @ w_r
        idx = torch.argsort(-r, axis=-1)[:, :C]
        idx_e = (lambda x, n, axis: torch.repeat_interleave(x, n, dim=axis))(idx.reshape(B, C, 1), D, axis=2)
        x_sel = (lambda x, i, axis: torch.take_along_dim(x, i, dim=axis))(x, idx_e, axis=1)
        g = _silu(x_sel @ w_gate)
        u = x_sel @ w_up
        y = (g * u) @ w_down
        r_sel = _sigmoid((lambda x, i, axis: torch.take_along_dim(x, i, dim=axis))(r, idx, axis=1))
        y = y * r_sel.reshape(B, C, 1)
        b_off = (torch.arange(B) * S).reshape(B, 1)
        flat_idx = (idx + b_off).reshape(B * C)
        zero = (x * 0.0).reshape(B * S, D)
        upd = _scatter_add(zero, flat_idx, y.reshape(B * C, D), axis=0)
        return x + upd.reshape(B, S, D)

    x = A_x
    g = _sigmoid((x * gate_w).sum(-1, keepdims=True))
    a = _A_ref(x, A_wqkv, A_wo)
    b = _B_ref(x, B_w_r, B_w_gate, B_w_up, B_w_down)
    return g * a + (1 - g) * b
```

```asm
; @launch grid=(256,1,1) block=(512,1,1) lds=163840
.amdgcn_target "amdgcn-amd-amdhsa--gfx950"
.text
K_CPL = 33
.p2align 12
.p2align 8
.globl gated_mix__sliding_local_dilated__moe_arch_mod__prompt_kernel
.type gated_mix__sliding_local_dilated__moe_arch_mod__prompt_kernel,@function
gated_mix__sliding_local_dilated__moe_arch_mod__prompt_kernel:
    s_cmp_ge_u32 s2, 256
    s_cbranch_scc1 K_EXIT
    s_load_dwordx2 s[12:13], s[0:1], 0
    s_load_dwordx2 s[16:17], s[0:1], 8
    s_load_dwordx4 s[4:7], s[0:1], 80
    s_load_dwordx2 s[8:9], s[0:1], 16
    s_load_dwordx2 s[10:11], s[0:1], 72
    v_readfirstlane_b32 s30, v0
    s_mov_b64 s[84:85], 0
    s_mov_b64 s[86:87], 0
    s_mov_b64 s[88:89], 0
    s_mov_b64 s[90:91], 0
    s_mov_b64 s[92:93], 0
    s_mov_b64 s[94:95], 0
    s_mov_b64 s[96:97], 0
    s_mov_b64 s[98:99], 0
    s_memrealtime s[84:85]
    s_mov_b32 s14, 0x280000
    s_mov_b32 s15, 0x20000
    s_lshr_b32 s30, s30, 6
    s_cmp_ge_u32 s2, 64
    s_cbranch_scc1 K_MAIN
    s_getpc_b64 s[38:39]
K_PC:
    s_lshr_b32 s3, s2, 3
    s_mul_i32 s3, s3, K_CPL
    v_add_u32 v2, s3, v0
    v_lshlrev_b32 v2, 7, v2
    v_min_u32 v2, K_CODE_END-K_PC-4, v2
    v_cmp_gt_u32 vcc, K_CPL, v0
    s_and_saveexec_b64 s[20:21], vcc
    s_cbranch_execz K_NOPF
    global_load_dword v6, v2, s[38:39]
K_NOPF:
    s_mov_b64 exec, -1
    s_branch K_OTHER
K_MAIN:
    s_cmp_ge_u32 s30, 4
    s_cbranch_scc1 K_OTHER
    s_bfe_u32 s3, s2, 0x20001
    s_mul_i32 s44, s3, 675840
    s_lshr_b32 s33, s2, 6
    s_mul_i32 s3, s33, 225280
    s_add_u32 s44, s44, s3
    s_mul_i32 s3, s30, 61440
    s_add_u32 s44, s44, s3
    s_sub_u32 s44, s44, 245760
    v_bfe_u32 v3, v0, 4, 2
    s_lshr_b32 s3, s2, 1
    s_and_b32 s3, s3, 28
    s_or_b32 s3, s3, 0x40000
    v_lshlrev_b32 v2, 1, v3
    v_sub_u32 v2, v0, v2
    s_bfe_u32 s49, 0x82931560, s3
    s_bfe_u32 s32, 0x64317520, s3
    v_and_b32 v2, 15, v2
    v_mul_u32_u24 v5, 3840, v3
    s_and_b32 s3, s2, 7
    s_lshl2_add_u32 s3, s33, s3
    s_add_u32 s49, s49, s3
    s_mov_b32 s33, 0x00a55a
    v_subrev_u32 v5, 160, v5
    s_mul_i32 s3, s49, 205
    s_lshr_b32 s3, s3, 11
    s_mul_i32 s3, s3, 10
    s_sub_u32 s49, s49, s3
    v_mul_u32_u24 v4, 52, v2
    v_lshrrev_b32 v4, 5, v4
    v_and_b32 v4, 24, v4
    v_bfe_u32 v4, s33, v4, 8
    v_add_u32 v4, v4, v2
    v_lshl_add_u32 v10, v4, 4, v5
    v_add_u32 v4, 1, v2
    v_lshrrev_b32 v4, 4, v4
    v_lshl_add_u32 v10, v4, 28, v10
    v_xor_b32 v2, 8, v2
    v_mul_u32_u24 v4, 52, v2
    v_lshrrev_b32 v4, 5, v4
    v_and_b32 v4, 24, v4
    v_bfe_u32 v4, s33, v4, 8
    v_add_u32 v4, v4, v2
    v_lshl_add_u32 v11, v4, 4, v5
    v_add_u32 v4, 1, v2
    v_lshrrev_b32 v4, 4, v4
    v_lshl_add_u32 v11, v4, 28, v11
    s_bitcmp1_b32 s2, 0
    s_cselect_b32 s3, 8, 0
    s_add_u32 s32, s32, s3
    s_mul_i32 s50, s32, 80
    s_mul_i32 s3, s30, 61440
    s_add_u32 s50, s50, s3
    s_lshl_b32 s46, s30, 12
    s_add_u32 s46, s46, 24576
    s_mul_i32 s45, s30, 6144
    s_mov_b32 s18, 0x258000
    s_mov_b32 s19, 0x20000
    v_xor_b32 v3, v3, v0
    v_and_b32 v3, 7, v3
    v_bfe_u32 v2, v0, 3, 3
    v_mul_u32_u24 v2, 1280, v2
    v_lshl_add_u32 v8, v3, 4, v2
    v_xor_b32 v9, 64, v8
    s_lshl_b32 s47, s49, 7
    s_mul_i32 s48, s49, 245760
    s_add_u32 s51, s44, s47
    s_add_u32 s48, s48, s50
    s_add_u32 s49, s49, 1
    s_cmp_eq_u32 s49, 10
    s_cselect_b32 s49, 0, s49
    s_waitcnt lgkmcnt(0)
    s_add_u32 m0, s46, 40960
    s_add_u32 s52, s48, 0
    buffer_load_dwordx4 v10, s[16:19], s52 offen lds
    s_add_u32 m0, s45, 40960
    s_max_i32 s52, s51, s47
    buffer_load_dwordx4 v8, s[12:15], s52 offen lds
    s_add_u32 m0, s46, 41984
    s_add_u32 s52, s48, 15360
    buffer_load_dwordx4 v10, s[16:19], s52 offen lds
    s_add_u32 m0, s45, 41984
    s_add_u32 s52, s51, 10240
    s_max_i32 s52, s52, s47
    buffer_load_dwordx4 v9, s[12:15], s52 offen lds
    s_add_u32 m0, s45, 43008
    s_add_u32 s52, s51, 20480
    buffer_load_dwordx4 v8, s[12:15], s52 offen lds
    s_add_u32 m0, s46, 43008
    s_add_u32 s52, s48, 30720
    buffer_load_dwordx4 v11, s[16:19], s52 offen lds
    s_add_u32 m0, s45, 44032
    s_add_u32 s52, s51, 30720
    buffer_load_dwordx4 v9, s[12:15], s52 offen lds
    s_add_u32 m0, s46, 44032
    s_add_u32 s52, s48, 46080
    buffer_load_dwordx4 v11, s[16:19], s52 offen lds
    s_add_u32 m0, s45, 45056
    s_add_u32 s52, s51, 40960
    buffer_load_dwordx4 v8, s[12:15], s52 offen lds
    s_add_u32 m0, s45, 46080
    s_add_u32 s52, s51, 51200
    buffer_load_dwordx4 v9, s[12:15], s52 offen lds
    s_lshl_b32 s47, s49, 7
    s_mul_i32 s48, s49, 245760
    s_add_u32 s51, s44, s47
    s_add_u32 s48, s48, s50
    s_add_u32 s49, s49, 1
    s_cmp_eq_u32 s49, 10
    s_cselect_b32 s49, 0, s49
    s_add_u32 m0, s46, 81920
    s_add_u32 s52, s48, 0
    buffer_load_dwordx4 v10, s[16:19], s52 offen lds
    s_add_u32 m0, s45, 81920
    s_max_i32 s52, s51, s47
    buffer_load_dwordx4 v8, s[12:15], s52 offen lds
    s_add_u32 m0, s46, 82944
    s_add_u32 s52, s48, 15360
    buffer_load_dwordx4 v10, s[16:19], s52 offen lds
    s_add_u32 m0, s45, 82944
    s_add_u32 s52, s51, 10240
    s_max_i32 s52, s52, s47
    buffer_load_dwordx4 v9, s[12:15], s52 offen lds
    s_add_u32 m0, s45, 83968
    s_add_u32 s52, s51, 20480
    buffer_load_dwordx4 v8, s[12:15], s52 offen lds
    s_mov_b32 s43, s30
    v_and_b32 v1, 63, v0
    v_mov_b32 v7, 0
    s_and_b32 s28, s2, 7
    s_lshr_b32 s29, s2, 3
    s_xor_b32 s30, s30, 4
    s_lshr_b32 s34, s29, 3
    s_lshl_b32 s34, s34, 2
    s_and_b32 s3, s29, 3
    s_add_u32 s34, s34, s3
    s_add_u32 s34, s34, 4
    s_bitcmp1_b32 s29, 2
    s_cselect_b32 s34, -1, s34
    s_cmp_lt_u32 s29, 8
    s_cselect_b32 s34, s29, s34
    s_lshl_b32 s40, s28, 1
    s_cmp_ge_u32 s34, 10
    s_addc_u32 s40, s40, 0
    s_sub_u32 s41, s34, 10
    s_cmp_ge_u32 s34, 10
    s_cselect_b32 s41, s41, s34
    s_mul_i32 s42, s28, 20
    s_add_u32 s42, s42, s34
    s_and_b32 s42, s42, 255
    s_lshl_b32 s42, s42, 8
    s_add_u32 s42, s42, 524288
    s_lshr_b32 s31, s28, 1
    s_mul_i32 s31, s31, 3
    s_lshr_b32 s3, s29, 3
    s_add_u32 s31, s31, s3
    s_sub_u32 s31, s31, 1
    s_and_b32 s32, s28, 1
    s_lshl_b32 s32, s32, 3
    s_and_b32 s3, s29, 7
    s_lshl_b32 s3, s3, 2
    s_lshr_b32 s3, 0x64317520, s3
    s_and_b32 s3, s3, 7
    s_add_u32 s32, s32, s3
    s_and_b32 s35, s29, 3
    s_and_b32 s3, s29, 4
    s_lshl_b32 s3, s3, 1
    s_add_u32 s35, s35, s3
    s_and_b32 s3, s28, 1
    s_lshl_b32 s3, s3, 2
    s_add_u32 s35, s35, s3
    s_branch K_LOADER
K_OTHER:
    v_and_b32 v1, 63, v0
    v_mov_b32 v7, 0
    s_and_b32 s28, s2, 7
    s_lshr_b32 s29, s2, 3
    s_xor_b32 s30, s30, 4
    s_lshr_b32 s34, s29, 3
    s_lshl_b32 s34, s34, 2
    s_and_b32 s3, s29, 3
    s_add_u32 s34, s34, s3
    s_add_u32 s34, s34, 4
    s_bitcmp1_b32 s29, 2
    s_cselect_b32 s34, -1, s34
    s_cmp_lt_u32 s29, 8
    s_cselect_b32 s34, s29, s34
    s_lshl_b32 s40, s28, 1
    s_cmp_ge_u32 s34, 10
    s_addc_u32 s40, s40, 0
    s_sub_u32 s41, s34, 10
    s_cmp_ge_u32 s34, 10
    s_cselect_b32 s41, s41, s34
    s_mul_i32 s42, s28, 20
    s_add_u32 s42, s42, s34
    s_and_b32 s42, s42, 255
    s_lshl_b32 s42, s42, 8
    s_add_u32 s42, s42, 524288
    v_mov_b32 v3, 158752
    ds_write2_b32 v3, v7, v7 offset0:0 offset1:1
    ds_write2_b32 v3, v7, v7 offset0:2 offset1:3
    ds_write2_b32 v3, v7, v7 offset0:4 offset1:5
    s_cmp_lt_u32 s29, 8
    s_cbranch_scc1 K_AUX
    s_branch K_CONS
K_LOADER:
    s_branch K_J830
K_CHM0:
K_STM0:
    s_branch K_STM4
K_STA0:
    s_branch K_STA4
K_J830:
    s_mov_b32 s24, s8
    s_mov_b32 s25, s9
    s_mov_b32 s26, 0xc8000
    s_mov_b32 s27, 0x20000
    v_and_b32 v12, 15, v1
    v_lshrrev_b32 v13, 4, v1
    v_bfe_u32 v14, v1, 2, 2
    v_and_b32 v15, 3, v1
    s_add_u32 s20, s6, 0x100000
    s_addc_u32 s21, s7, 0
    s_mov_b32 s22, 0x280000
    s_mov_b32 s23, 0x20000
    s_lshr_b32 s3, s30, 1
    s_mul_i32 s3, s3, 3
    s_mul_i32 s53, s31, 11
    s_add_u32 s53, s53, s3
    s_mul_i32 s3, s3, 4352
    s_and_b32 s33, s30, 1
    s_mul_i32 s56, s33, 40
    s_add_u32 s3, s3, s56
    s_add_u32 s3, s3, 81920
    v_mul_u32_u24 v17, 272, v12
    v_lshl_add_u32 v16, v13, 3, v17
    v_add_u32 v16, s3, v16
    v_add3_u32 v17, v17, 32, s3
    s_sub_u32 s56, 48, s56
    v_add_u32 v2, s56, v17
    v_cmp_eq_u32 vcc, 0, v13
    s_nop 1
    v_cndmask_b32 v27, v2, v17, vcc
    v_lshl_add_u32 v18, v13, 2, v14
    v_mul_u32_u24 v18, 272, v18
    v_lshl_add_u32 v18, v15, 3, v18
    v_add_u32 v18, s3, v18
    s_lshl_b32 s33, s33, 3
    s_lshl_b32 s3, s35, 10
    s_add_u32 s3, s3, s33
    v_lshl_add_u32 v19, v1, 4, s3
    s_lshl_b32 s3, s35, 8
    s_add_u32 s3, s3, s33
    s_add_u32 s3, s3, 16384
    v_lshl_add_u32 v20, v1, 4, s3
    s_mul_i32 s60, s53, 20480
    s_add_u32 s61, s60, 20480
    s_add_u32 s62, s60, 40960
    v_mov_b32 v21, 0xf149f2ca
    v_lshlrev_b32 v2, 2, v13
    v_sub_u32 v2, v12, v2
    s_cmp_eq_u32 s53, 0
    s_cselect_b32 s3, 0xf149f2ca, 0
    v_subrev_u32 v3, 0, v2
    v_and_b32 v4, 0x80000001, v3
    v_cmp_eq_u32 vcc, 0, v4
    s_nop 1
    v_cndmask_b32 v32, v21, 0, vcc
    v_cmp_eq_u32 vcc, 0x80000000, v4
    s_nop 1
    v_cndmask_b32 v28, v21, 0, vcc
    v_add_f32 v36, s3, v28
    v_subrev_u32 v3, 1, v2
    v_and_b32 v4, 0x80000001, v3
    v_cmp_eq_u32 vcc, 0, v4
    s_nop 1
    v_cndmask_b32 v33, v21, 0, vcc
    v_cmp_eq_u32 vcc, 0x80000000, v4
    s_nop 1
    v_cndmask_b32 v29, v21, 0, vcc
    v_add_f32 v37, s3, v29
    v_subrev_u32 v3, 2, v2
    v_and_b32 v4, 0x80000001, v3
    v_cmp_eq_u32 vcc, 0, v4
    s_nop 1
    v_cndmask_b32 v34, v21, 0, vcc
    v_cmp_eq_u32 vcc, 0x80000000, v4
    s_nop 1
    v_cndmask_b32 v30, v21, 0, vcc
    v_add_f32 v38, s3, v30
    v_subrev_u32 v3, 3, v2
    v_and_b32 v4, 0x80000001, v3
    v_cmp_eq_u32 vcc, 0, v4
    s_nop 1
    v_cndmask_b32 v35, v21, 0, vcc
    v_cmp_eq_u32 vcc, 0x80000000, v4
    s_nop 1
    v_cndmask_b32 v31, v21, 0, vcc
    v_add_f32 v39, s3, v31
    v_mov_b32 v3, 0x0c0c0c0c
    v_mov_b32 v4, 0xc0c0100
    v_cmp_eq_u32 vcc, 0, v28
    v_mov_b32 v5, 0x1000c0c
    s_nop 0
    v_cndmask_b32 v3, v3, v4, vcc
    v_cmp_eq_u32 vcc, 0, v29
    s_nop 1
    v_cndmask_b32 v40, v3, v5, vcc
    v_mov_b32 v3, 0x0c0c0c0c
    v_mov_b32 v4, 0xc0c0302
    v_cmp_eq_u32 vcc, 0, v30
    v_mov_b32 v5, 0x3020c0c
    s_nop 0
    v_cndmask_b32 v3, v3, v4, vcc
    v_cmp_eq_u32 vcc, 0, v31
    s_nop 1
    v_cndmask_b32 v41, v3, v5, vcc
    v_mov_b32 v3, 0x0c0c0c0c
    v_mov_b32 v4, 0xc0c0100
    v_cmp_eq_u32 vcc, 0, v32
    v_mov_b32 v5, 0x1000c0c
    s_nop 0
    v_cndmask_b32 v3, v3, v4, vcc
    v_cmp_eq_u32 vcc, 0, v33
    s_nop 1
    v_cndmask_b32 v42, v3, v5, vcc
    v_mov_b32 v3, 0x0c0c0c0c
    v_mov_b32 v4, 0xc0c0302
    v_cmp_eq_u32 vcc, 0, v34
    v_mov_b32 v5, 0x3020c0c
    s_nop 0
    v_cndmask_b32 v3, v3, v4, vcc
    v_cmp_eq_u32 vcc, 0, v35
    s_nop 1
    v_cndmask_b32 v43, v3, v5, vcc
    s_mul_i32 s3, s31, 11
    s_add_u32 s33, s3, 10
    s_lshr_b32 s3, s3, 3
    s_lshr_b32 s33, s33, 3
    s_min_u32 s33, s33, 15
    s_sub_u32 s33, s33, s3
    s_add_u32 s33, s33, 1
    s_mul_i32 s33, s33, 10
    s_bfm_b32 s36, s33, 0
    v_mul_u32_u24 v2, 205, v1
    v_lshrrev_b32 v2, 11, v2
    v_add_u32 v2, s3, v2
    v_mul_u32_u24 v2, 1496, v2
    v_lshrrev_b32 v2, 11, v2
    v_sub_u32 v2, s31, v2
    v_and_b32 v2, 1, v2
    v_lshlrev_b32 v2, 6, v2
    v_lshl_add_u32 v2, v1, 8, v2
    s_mul_i32 s3, s3, 2560
    s_lshl_b32 s33, s35, 2
    s_add_u32 s3, s3, s33
    s_add_u32 s3, s3, 524288
    v_add_u32 v23, s3, v2
    s_lshr_b32 s3, s30, 1
    s_mul_i32 s3, s3, 3
    s_and_b32 s33, s30, 1
    s_lshl_b32 s33, s33, 3
    v_lshl_add_u32 v2, v1, 4, s33
    s_lshl_b32 s33, s3, 10
    s_add_u32 s33, s33, 40960
    v_add_u32 v24, s33, v2
    s_lshl_b32 s33, s3, 8
    s_add_u32 s33, s33, 53248
    v_add_u32 v25, s33, v2
    s_lshl_b32 s33, s30, 10
    s_add_u32 s33, s33, 40960
    v_lshl_add_u32 v26, v1, 4, s33
    s_mul_i32 s60, s31, 225280
    s_mul_i32 s3, s30, 20480
    s_lshl_b32 s33, s35, 10
    s_add_u32 s3, s3, s33
    v_lshl_add_u32 v19, v1, 4, s3
    v_add_u32 v3, 163840, v19
    s_sub_u32 s3, s30, 4
    s_lshl_b32 s3, s3, 2
    v_add_u32 v4, s3, v13
    v_mul_u32_u24 v2, 20480, v4
    v_lshl_add_u32 v2, v12, 4, v2
    s_lshl_b32 s33, s35, 8
    s_add_u32 s33, s33, 16384
    s_branch K_Jbf8
K_CHM1:
K_STM1:
    s_branch K_STM5
K_STA1:
    s_branch K_STA5
K_Jbf8:
    v_add_u32 v2, s33, v2
    v_mov_b32 v5, 0x10000000
    v_cmp_gt_u32 vcc, 11, v4
    s_nop 1
    v_cndmask_b32 v2, v5, v2, vcc
    s_cmp_lt_u32 s30, 3
    s_cselect_b64 vcc, -1, 0
    s_nop 1
    v_cndmask_b32 v20, v2, v3, vcc
    s_mov_b64 s[54:55], 0xffff
    s_mov_b32 s56, 0x3fb8aa3b
    s_mov_b32 s57, s56
    s_mov_b32 s58, 0x3e64f92e
    s_mov_b32 s59, s58
    s_waitcnt vmcnt(5)
    s_barrier
    s_memrealtime s[86:87]
    s_add_u32 m0, s46, 83968
    s_add_u32 s52, s48, 30720
    buffer_load_dwordx4 v11, s[16:19], s52 offen lds
    s_add_u32 m0, s45, 84992
    s_add_u32 s52, s51, 30720
    buffer_load_dwordx4 v9, s[12:15], s52 offen lds
    s_add_u32 m0, s46, 84992
    s_add_u32 s52, s48, 46080
    buffer_load_dwordx4 v11, s[16:19], s52 offen lds
    s_add_u32 m0, s45, 86016
    s_add_u32 s52, s51, 40960
    buffer_load_dwordx4 v8, s[12:15], s52 offen lds
    s_add_u32 m0, s45, 87040
    s_add_u32 s52, s51, 51200
    buffer_load_dwordx4 v9, s[12:15], s52 offen lds
    s_lshl_b32 s47, s49, 7
    s_mul_i32 s48, s49, 245760
    s_add_u32 s51, s44, s47
    s_add_u32 s48, s48, s50
    s_add_u32 s49, s49, 1
    s_cmp_eq_u32 s49, 10
    s_cselect_b32 s49, 0, s49
    s_add_u32 m0, s46, 0
    s_add_u32 s52, s48, 0
    buffer_load_dwordx4 v10, s[16:19], s52 offen lds
    s_add_u32 m0, s45, 0
    s_max_i32 s52, s51, s47
    buffer_load_dwordx4 v8, s[12:15], s52 offen lds
    s_add_u32 m0, s46, 1024
    s_add_u32 s52, s48, 15360
    buffer_load_dwordx4 v10, s[16:19], s52 offen lds
    s_add_u32 m0, s45, 1024
    s_add_u32 s52, s51, 10240
    s_max_i32 s52, s52, s47
    buffer_load_dwordx4 v9, s[12:15], s52 offen lds
    s_add_u32 m0, s45, 2048
    s_add_u32 s52, s51, 20480
    buffer_load_dwordx4 v8, s[12:15], s52 offen lds
    s_waitcnt vmcnt(5)
    s_barrier
    s_add_u32 m0, s46, 2048
    s_add_u32 s52, s48, 30720
    buffer_load_dwordx4 v11, s[16:19], s52 offen lds
    s_add_u32 m0, s45, 3072
    s_add_u32 s52, s51, 30720
    buffer_load_dwordx4 v9, s[12:15], s52 offen lds
    s_add_u32 m0, s46, 3072
    s_add_u32 s52, s48, 46080
    buffer_load_dwordx4 v11, s[16:19], s52 offen lds
    s_add_u32 m0, s45, 4096
    s_add_u32 s52, s51, 40960
    buffer_load_dwordx4 v8, s[12:15], s52 offen lds
    s_add_u32 m0, s45, 5120
    s_add_u32 s52, s51, 51200
    buffer_load_dwordx4 v9, s[12:15], s52 offen lds
    s_lshl_b32 s47, s49, 7
    s_mul_i32 s48, s49, 245760
    s_add_u32 s51, s44, s47
    s_add_u32 s48, s48, s50
    s_add_u32 s49, s49, 1
    s_cmp_eq_u32 s49, 10
    s_cselect_b32 s49, 0, s49
    s_add_u32 m0, s46, 40960
    s_add_u32 s52, s48, 0
    buffer_load_dwordx4 v10, s[16:19], s52 offen lds
    s_add_u32 m0, s45, 40960
    s_max_i32 s52, s51, s47
    buffer_load_dwordx4 v8, s[12:15], s52 offen lds
    s_add_u32 m0, s46, 41984
    s_add_u32 s52, s48, 15360
    buffer_load_dwordx4 v10, s[16:19], s52 offen lds
    s_add_u32 m0, s45, 41984
    s_add_u32 s52, s51, 10240
    s_max_i32 s52, s52, s47
    buffer_load_dwordx4 v9, s[12:15], s52 offen lds
    s_add_u32 m0, s45, 43008
    s_add_u32 s52, s51, 20480
    buffer_load_dwordx4 v8, s[12:15], s52 offen lds
    s_waitcnt vmcnt(5)
    s_barrier
    s_add_u32 m0, s46, 43008
    s_add_u32 s52, s48, 30720
    buffer_load_dwordx4 v11, s[16:19], s52 offen lds
    s_add_u32 m0, s45, 44032
    s_add_u32 s52, s51, 30720
    buffer_load_dwordx4 v9, s[12:15], s52 offen lds
    s_add_u32 m0, s46, 44032
    s_add_u32 s52, s48, 46080
    buffer_load_dwordx4 v11, s[16:19], s52 offen lds
    s_add_u32 m0, s45, 45056
    s_add_u32 s52, s51, 40960
    buffer_load_dwordx4 v8, s[12:15], s52 offen lds
    s_add_u32 m0, s45, 46080
    s_add_u32 s52, s51, 51200
    buffer_load_dwordx4 v9, s[12:15], s52 offen lds
    s_lshl_b32 s47, s49, 7
    s_mul_i32 s48, s49, 245760
    s_add_u32 s51, s44, s47
    s_add_u32 s48, s48, s50
    s_add_u32 s49, s49, 1
    s_cmp_eq_u32 s49, 10
    s_cselect_b32 s49, 0, s49
    s_add_u32 m0, s46, 81920
    s_add_u32 s52, s48, 0
    buffer_load_dwordx4 v10, s[16:19], s52 offen lds
    s_add_u32 m0, s45, 81920
    s_max_i32 s52, s51, s47
    buffer_load_dwordx4 v8, s[12:15], s52 offen lds
    s_add_u32 m0, s46, 82944
    s_add_u32 s52, s48, 15360
    buffer_load_dwordx4 v10, s[16:19], s52 offen lds
    s_add_u32 m0, s45, 82944
    s_add_u32 s52, s51, 10240
    s_max_i32 s52, s52, s47
    buffer_load_dwordx4 v9, s[12:15], s52 offen lds
    s_add_u32 m0, s45, 83968
    s_add_u32 s52, s51, 20480
    buffer_load_dwordx4 v8, s[12:15], s52 offen lds
    s_waitcnt vmcnt(5)
    s_barrier
    s_add_u32 m0, s46, 83968
    s_add_u32 s52, s48, 30720
    buffer_load_dwordx4 v11, s[16:19], s52 offen lds
    s_add_u32 m0, s45, 84992
    s_add_u32 s52, s51, 30720
    buffer_load_dwordx4 v9, s[12:15], s52 offen lds
    s_add_u32 m0, s46, 84992
    s_add_u32 s52, s48, 46080
    buffer_load_dwordx4 v11, s[16:19], s52 offen lds
    s_add_u32 m0, s45, 86016
    s_add_u32 s52, s51, 40960
    buffer_load_dwordx4 v8, s[12:15], s52 offen lds
    s_add_u32 m0, s45, 87040
    s_branch K_PG0
.p2align 12
K_CHM2:
K_STM2:
    s_branch K_STM6
K_STA2:
    s_branch K_STA6
K_PG0:
    s_add_u32 s52, s51, 51200
    buffer_load_dwordx4 v9, s[12:15], s52 offen lds
    s_lshl_b32 s47, s49, 7
    s_mul_i32 s48, s49, 245760
    s_add_u32 s51, s44, s47
    s_add_u32 s48, s48, s50
    s_add_u32 s49, s49, 1
    s_cmp_eq_u32 s49, 10
    s_cselect_b32 s49, 0, s49
    s_add_u32 m0, s46, 0
    s_add_u32 s52, s48, 0
    buffer_load_dwordx4 v10, s[16:19], s52 offen lds
    s_add_u32 m0, s45, 0
    s_max_i32 s52, s51, s47
    buffer_load_dwordx4 v8, s[12:15], s52 offen lds
    s_add_u32 m0, s46, 1024
    s_add_u32 s52, s48, 15360
    buffer_load_dwordx4 v10, s[16:19], s52 offen lds
    s_add_u32 m0, s45, 1024
    s_add_u32 s52, s51, 10240
    s_max_i32 s52, s52, s47
    buffer_load_dwordx4 v9, s[12:15], s52 offen lds
    s_add_u32 m0, s45, 2048
    s_add_u32 s52, s51, 20480
    buffer_load_dwordx4 v8, s[12:15], s52 offen lds
    s_waitcnt vmcnt(5)
    s_barrier
    s_add_u32 m0, s46, 2048
    s_add_u32 s52, s48, 30720
    buffer_load_dwordx4 v11, s[16:19], s52 offen lds
    s_add_u32 m0, s45, 3072
    s_add_u32 s52, s51, 30720
    buffer_load_dwordx4 v9, s[12:15], s52 offen lds
    s_add_u32 m0, s46, 3072
    s_add_u32 s52, s48, 46080
    buffer_load_dwordx4 v11, s[16:19], s52 offen lds
    s_add_u32 m0, s45, 4096
    s_add_u32 s52, s51, 40960
    buffer_load_dwordx4 v8, s[12:15], s52 offen lds
    s_add_u32 m0, s45, 5120
    s_add_u32 s52, s51, 51200
    buffer_load_dwordx4 v9, s[12:15], s52 offen lds
    s_lshl_b32 s47, s49, 7
    s_mul_i32 s48, s49, 245760
    s_add_u32 s51, s44, s47
    s_add_u32 s48, s48, s50
    s_add_u32 s49, s49, 1
    s_cmp_eq_u32 s49, 10
    s_cselect_b32 s49, 0, s49
    s_add_u32 m0, s46, 40960
    s_add_u32 s52, s48, 0
    buffer_load_dwordx4 v10, s[16:19], s52 offen lds
    s_add_u32 m0, s45, 40960
    s_max_i32 s52, s51, s47
    buffer_load_dwordx4 v8, s[12:15], s52 offen lds
    s_add_u32 m0, s46, 41984
    s_add_u32 s52, s48, 15360
    buffer_load_dwordx4 v10, s[16:19], s52 offen lds
    s_add_u32 m0, s45, 41984
    s_add_u32 s52, s51, 10240
    s_max_i32 s52, s52, s47
    buffer_load_dwordx4 v9, s[12:15], s52 offen lds
    s_add_u32 m0, s45, 43008
    s_add_u32 s52, s51, 20480
    buffer_load_dwordx4 v8, s[12:15], s52 offen lds
    s_waitcnt vmcnt(5)
    s_barrier
    s_memrealtime s[88:89]
    s_add_u32 m0, s46, 43008
    s_add_u32 s52, s48, 30720
    buffer_load_dwordx4 v11, s[16:19], s52 offen lds
    s_add_u32 m0, s45, 44032
    s_add_u32 s52, s51, 30720
    buffer_load_dwordx4 v9, s[12:15], s52 offen lds
    s_add_u32 m0, s46, 44032
    s_add_u32 s52, s48, 46080
    buffer_load_dwordx4 v11, s[16:19], s52 offen lds
    s_add_u32 m0, s45, 45056
    s_add_u32 s52, s51, 40960
    buffer_load_dwordx4 v8, s[12:15], s52 offen lds
    s_add_u32 m0, s45, 46080
    s_add_u32 s52, s51, 51200
    buffer_load_dwordx4 v9, s[12:15], s52 offen lds
    s_lshl_b32 s47, s49, 7
    s_mul_i32 s48, s49, 245760
    s_add_u32 s51, s44, s47
    s_add_u32 s48, s48, s50
    s_add_u32 s49, s49, 1
    s_cmp_eq_u32 s49, 10
    s_cselect_b32 s49, 0, s49
    s_add_u32 m0, s46, 81920
    s_add_u32 s52, s48, 0
    buffer_load_dwordx4 v10, s[16:19], s52 offen lds
    s_add_u32 m0, s45, 81920
    s_max_i32 s52, s51, s47
    buffer_load_dwordx4 v8, s[12:15], s52 offen lds
    s_add_u32 m0, s46, 82944
    s_add_u32 s52, s48, 15360
    buffer_load_dwordx4 v10, s[16:19], s52 offen lds
    s_add_u32 m0, s45, 82944
    s_add_u32 s52, s51, 10240
    s_max_i32 s52, s52, s47
    buffer_load_dwordx4 v9, s[12:15], s52 offen lds
    s_add_u32 m0, s45, 83968
    s_add_u32 s52, s51, 20480
    buffer_load_dwordx4 v8, s[12:15], s52 offen lds
    s_waitcnt vmcnt(5)
    s_barrier
    s_add_u32 m0, s46, 83968
    s_add_u32 s52, s48, 30720
    buffer_load_dwordx4 v11, s[16:19], s52 offen lds
    s_add_u32 m0, s45, 84992
    s_add_u32 s52, s51, 30720
    buffer_load_dwordx4 v9, s[12:15], s52 offen lds
    s_add_u32 m0, s46, 84992
    s_add_u32 s52, s48, 46080
    buffer_load_dwordx4 v11, s[16:19], s52 offen lds
    s_add_u32 m0, s45, 86016
    s_add_u32 s52, s51, 40960
    buffer_load_dwordx4 v8, s[12:15], s52 offen lds
    s_add_u32 m0, s45, 87040
    s_add_u32 s52, s51, 51200
    buffer_load_dwordx4 v9, s[12:15], s52 offen lds
    s_lshl_b32 s47, s49, 7
    s_mul_i32 s48, s49, 245760
    s_add_u32 s51, s44, s47
    s_add_u32 s48, s48, s50
    s_add_u32 s49, s49, 1
    s_cmp_eq_u32 s49, 10
    s_cselect_b32 s49, 0, s49
    s_add_u32 m0, s46, 0
    s_add_u32 s52, s48, 0
    buffer_load_dwordx4 v10, s[16:19], s52 offen lds
    s_add_u32 m0, s45, 0
    s_max_i32 s52, s51, s47
    buffer_load_dwordx4 v8, s[12:15], s52 offen lds
    s_add_u32 m0, s46, 1024
    s_add_u32 s52, s48, 15360
    buffer_load_dwordx4 v10, s[16:19], s52 offen lds
    s_add_u32 m0, s45, 1024
    s_add_u32 s52, s51, 10240
    s_max_i32 s52, s52, s47
    buffer_load_dwordx4 v9, s[12:15], s52 offen lds
    s_branch K_J13c8
K_CHM3:
K_STM3:
    s_branch K_STM7
K_STA3:
    s_branch K_STA7
K_J13c8:
    s_add_u32 m0, s45, 2048
    s_add_u32 s52, s51, 20480
    buffer_load_dwordx4 v8, s[12:15], s52 offen lds
    s_waitcnt vmcnt(5)
    s_barrier
    s_add_u32 m0, s46, 2048
    s_add_u32 s52, s48, 30720
    buffer_load_dwordx4 v11, s[16:19], s52 offen lds
    s_add_u32 m0, s45, 3072
    s_add_u32 s52, s51, 30720
    buffer_load_dwordx4 v9, s[12:15], s52 offen lds
    s_add_u32 m0, s46, 3072
    s_add_u32 s52, s48, 46080
    buffer_load_dwordx4 v11, s[16:19], s52 offen lds
    s_add_u32 m0, s45, 4096
    s_add_u32 s52, s51, 40960
    buffer_load_dwordx4 v8, s[12:15], s52 offen lds
    s_add_u32 m0, s45, 5120
    s_add_u32 s52, s51, 51200
    buffer_load_dwordx4 v9, s[12:15], s52 offen lds
    s_lshl_b32 s47, s49, 7
    s_mul_i32 s48, s49, 245760
    s_add_u32 s51, s44, s47
    s_add_u32 s48, s48, s50
    s_add_u32 s49, s49, 1
    s_cmp_eq_u32 s49, 10
    s_cselect_b32 s49, 0, s49
    s_add_u32 m0, s46, 40960
    s_add_u32 s52, s48, 0
    buffer_load_dwordx4 v10, s[16:19], s52 offen lds
    s_add_u32 m0, s45, 40960
    s_max_i32 s52, s51, s47
    buffer_load_dwordx4 v8, s[12:15], s52 offen lds
    s_add_u32 m0, s46, 41984
    s_add_u32 s52, s48, 15360
    buffer_load_dwordx4 v10, s[16:19], s52 offen lds
    s_add_u32 m0, s45, 41984
    s_add_u32 s52, s51, 10240
    s_max_i32 s52, s52, s47
    buffer_load_dwordx4 v9, s[12:15], s52 offen lds
    s_add_u32 m0, s45, 43008
    s_add_u32 s52, s51, 20480
    buffer_load_dwordx4 v8, s[12:15], s52 offen lds
    s_waitcnt vmcnt(5)
    s_barrier
    s_add_u32 m0, s46, 43008
    s_add_u32 s52, s48, 30720
    buffer_load_dwordx4 v11, s[16:19], s52 offen lds
    s_add_u32 m0, s45, 44032
    s_add_u32 s52, s51, 30720
    buffer_load_dwordx4 v9, s[12:15], s52 offen lds
    s_add_u32 m0, s46, 44032
    s_add_u32 s52, s48, 46080
    buffer_load_dwordx4 v11, s[16:19], s52 offen lds
    s_add_u32 m0, s45, 45056
    s_add_u32 s52, s51, 40960
    buffer_load_dwordx4 v8, s[12:15], s52 offen lds
    s_add_u32 m0, s45, 46080
    s_add_u32 s52, s51, 51200
    buffer_load_dwordx4 v9, s[12:15], s52 offen lds
    s_waitcnt vmcnt(0)
    s_barrier
    s_cmp_eq_u32 s30, 4
    s_cbranch_scc1 K_NOSMP
    v_mov_b32 v2, 192
    global_load_dword v7, v2, s[4:5] sc1
K_NOSMP:
    s_cmp_eq_u32 s34, -1
    s_cbranch_scc1 K_NOLT
    v_lshrrev_b32 v2, 3, v1
    v_mul_u32_u24 v2, 1280, v2
    v_lshrrev_b32 v3, 4, v1
    v_lshlrev_b32 v3, 1, v3
    v_and_b32 v4, 7, v1
    v_xor_b32 v3, v3, v4
    v_lshl_add_u32 v2, v3, 4, v2
    s_lshl_b32 s33, s41, 7
    v_add_u32 v22, s33, v2
    s_lshl_b32 s47, s43, 2
    s_lshr_b32 s47, 0x7520, s47
    s_and_b32 s47, s47, 7
    s_mul_i32 s47, s47, 51200
    s_mul_i32 s48, s43, 5120
    s_add_u32 s3, s47, 0
    s_add_u32 m0, s48, 0
    s_nop 0
    buffer_load_dwordx4 v22, s[24:27], s3 offen lds
    s_add_u32 s3, s47, 10240
    s_add_u32 m0, s48, 1024
    s_nop 0
    buffer_load_dwordx4 v22, s[24:27], s3 offen lds
    s_add_u32 s3, s47, 20480
    s_add_u32 m0, s48, 2048
    s_nop 0
    buffer_load_dwordx4 v22, s[24:27], s3 offen lds
    s_add_u32 s3, s47, 30720
    s_add_u32 m0, s48, 3072
    s_nop 0
    buffer_load_dwordx4 v22, s[24:27], s3 offen lds
    s_add_u32 s3, s47, 40960
    s_add_u32 m0, s48, 4096
    s_nop 0
    buffer_load_dwordx4 v22, s[24:27], s3 offen lds
    s_add_u32 s3, s47, 409600
    s_add_u32 m0, s48, 20480
    s_nop 0
    buffer_load_dwordx4 v22, s[24:27], s3 offen lds
    s_add_u32 s3, s47, 419840
    s_add_u32 m0, s48, 21504
    s_nop 0
    buffer_load_dwordx4 v22, s[24:27], s3 offen lds
    s_add_u32 s3, s47, 430080
    s_add_u32 m0, s48, 22528
    s_nop 0
    buffer_load_dwordx4 v22, s[24:27], s3 offen lds
    s_add_u32 s3, s47, 440320
    s_add_u32 m0, s48, 23552
    s_nop 0
    buffer_load_dwordx4 v22, s[24:27], s3 offen lds
    s_add_u32 s3, s47, 450560
    s_add_u32 m0, s48, 24576
    s_nop 0
    buffer_load_dwordx4 v22, s[24:27], s3 offen lds
    s_waitcnt vmcnt(10)
    s_branch K_JOIN
K_NOLT:
    s_waitcnt vmcnt(0)
    s_branch K_JOIN
K_CONS:
    s_lshr_b32 s31, s28, 1
    s_mul_i32 s31, s31, 3
    s_lshr_b32 s3, s29, 3
    s_add_u32 s31, s31, s3
    s_sub_u32 s31, s31, 1
    s_and_b32 s32, s28, 1
    s_lshl_b32 s32, s32, 3
    s_and_b32 s3, s29, 7
    s_lshl_b32 s3, s3, 2
    s_lshr_b32 s3, 0x64317520, s3
    s_and_b32 s3, s3, 7
    s_add_u32 s32, s32, s3
    s_and_b32 s35, s29, 3
    s_and_b32 s3, s29, 4
    s_lshl_b32 s3, s3, 1
    s_add_u32 s35, s35, s3
    s_and_b32 s3, s28, 1
    s_lshl_b32 s3, s3, 2
    s_add_u32 s35, s35, s3
    v_and_b32 v12, 15, v1
    v_lshrrev_b32 v13, 4, v1
    v_bfe_u32 v14, v1, 2, 2
    v_and_b32 v15, 3, v1
    s_lshr_b32 s63, s30, 1
    s_and_b32 s64, s30, 1
    v_lshrrev_b32 v2, 1, v12
    v_xor_b32 v2, v2, v13
    v_lshlrev_b32 v2, 4, v2
    s_branch K_J178c
K_STM4:
    s_branch K_STM8
K_STA4:
    s_branch K_STA8
K_J178c:
    v_lshl_add_u32 v2, v12, 7, v2
    s_mul_i32 s3, s63, 12288
    v_add_u32 v44, s3, v2
    v_xor_b32 v45, 64, v44
    v_add_u32 v46, 81920, v44
    v_add_u32 v47, 81920, v45
    v_and_b32 v2, 1, v13
    v_lshl_or_b32 v2, v2, 2, v14
    v_lshl_add_u32 v3, v13, 3, v14
    v_lshlrev_b32 v3, 8, v3
    v_lshl_add_u32 v3, v15, 3, v3
    v_add_u32 v3, 24576, v3
    s_lshl_b32 s3, s64, 2
    v_add_u32 v2, s3, v2
    v_add_u32 v4, 0, v2
    v_and_b32 v4, 7, v4
    v_lshl_add_u32 v48, v4, 5, v3
    v_add_u32 v52, 81920, v48
    v_add_u32 v4, 1, v2
    v_and_b32 v4, 7, v4
    v_lshl_add_u32 v49, v4, 5, v3
    v_add_u32 v53, 81920, v49
    v_add_u32 v4, 2, v2
    v_and_b32 v4, 7, v4
    v_lshl_add_u32 v50, v4, 5, v3
    v_add_u32 v54, 81920, v50
    v_add_u32 v4, 3, v2
    v_and_b32 v4, 7, v4
    v_lshl_add_u32 v51, v4, 5, v3
    v_add_u32 v55, 81920, v51
    v_mul_u32_u24 v56, 272, v12
    v_lshl_add_u32 v56, v13, 3, v56
    s_mul_i32 s3, s63, 26112
    s_lshl_b32 s33, s64, 7
    s_add_u32 s3, s3, s33
    s_add_u32 s3, s3, 81920
    v_add_u32 v56, s3, v56
    s_waitcnt lgkmcnt(0)
    s_mov_b32 s24, s8
    s_mov_b32 s25, s9
    s_mov_b32 s26, 0xc8000
    s_mov_b32 s27, 0x20000
    s_mul_i32 s3, s30, 160
    v_add_u32 v57, s3, v1
    v_mul_u32_u24 v57, 1280, v57
    s_lshl_b32 s33, s41, 7
    s_and_b32 s33, s33, 0x7ff
    v_add_u32 v57, s33, v57
    s_add_u32 s20, s6, 0x100000
    s_addc_u32 s21, s7, 0
    s_mov_b32 s22, 0x280000
    s_mov_b32 s23, 0x20000
    s_lshr_b32 s3, s30, 1
    s_mul_i32 s3, s3, 3
    s_mul_i32 s53, s31, 11
    s_add_u32 s53, s53, s3
    s_mul_i32 s3, s3, 4352
    s_and_b32 s33, s30, 1
    s_mul_i32 s56, s33, 40
    s_add_u32 s3, s3, s56
    s_add_u32 s3, s3, 81920
    v_mul_u32_u24 v17, 272, v12
    v_lshl_add_u32 v16, v13, 3, v17
    v_add_u32 v16, s3, v16
    v_add3_u32 v17, v17, 32, s3
    s_sub_u32 s56, 48, s56
    v_add_u32 v2, s56, v17
    v_cmp_eq_u32 vcc, 0, v13
    s_nop 1
    v_cndmask_b32 v27, v2, v17, vcc
    v_lshl_add_u32 v18, v13, 2, v14
    v_mul_u32_u24 v18, 272, v18
    v_lshl_add_u32 v18, v15, 3, v18
    v_add_u32 v18, s3, v18
    s_lshl_b32 s33, s33, 3
    s_lshl_b32 s3, s35, 10
    s_add_u32 s3, s3, s33
    v_lshl_add_u32 v19, v1, 4, s3
    s_lshl_b32 s3, s35, 8
    s_add_u32 s3, s3, s33
    s_add_u32 s3, s3, 16384
    v_lshl_add_u32 v20, v1, 4, s3
    s_mul_i32 s60, s53, 20480
    s_add_u32 s61, s60, 20480
    s_add_u32 s62, s60, 40960
    v_mov_b32 v21, 0xf149f2ca
    v_lshlrev_b32 v2, 2, v13
    v_sub_u32 v2, v12, v2
    s_cmp_eq_u32 s53, 0
    s_cselect_b32 s3, 0xf149f2ca, 0
    v_subrev_u32 v3, 0, v2
    v_and_b32 v4, 0x80000001, v3
    v_cmp_eq_u32 vcc, 0, v4
    s_nop 1
    v_cndmask_b32 v32, v21, 0, vcc
    v_cmp_eq_u32 vcc, 0x80000000, v4
    s_nop 1
    v_cndmask_b32 v28, v21, 0, vcc
    v_add_f32 v36, s3, v28
    v_subrev_u32 v3, 1, v2
    v_and_b32 v4, 0x80000001, v3
    v_cmp_eq_u32 vcc, 0, v4
    s_nop 1
    v_cndmask_b32 v33, v21, 0, vcc
    v_cmp_eq_u32 vcc, 0x80000000, v4
    s_nop 1
    v_cndmask_b32 v29, v21, 0, vcc
    v_add_f32 v37, s3, v29
    v_subrev_u32 v3, 2, v2
    v_and_b32 v4, 0x80000001, v3
    v_cmp_eq_u32 vcc, 0, v4
    s_nop 1
    v_cndmask_b32 v34, v21, 0, vcc
    v_cmp_eq_u32 vcc, 0x80000000, v4
    s_nop 1
    v_cndmask_b32 v30, v21, 0, vcc
    v_add_f32 v38, s3, v30
    v_subrev_u32 v3, 3, v2
    v_and_b32 v4, 0x80000001, v3
    v_cmp_eq_u32 vcc, 0, v4
    s_nop 1
    v_cndmask_b32 v35, v21, 0, vcc
    v_cmp_eq_u32 vcc, 0x80000000, v4
    s_nop 1
    v_cndmask_b32 v31, v21, 0, vcc
    v_add_f32 v39, s3, v31
    v_mov_b32 v3, 0x0c0c0c0c
    v_mov_b32 v4, 0xc0c0100
    v_cmp_eq_u32 vcc, 0, v28
    v_mov_b32 v5, 0x1000c0c
    s_nop 0
    v_cndmask_b32 v3, v3, v4, vcc
    v_cmp_eq_u32 vcc, 0, v29
    s_nop 1
    v_cndmask_b32 v40, v3, v5, vcc
    v_mov_b32 v3, 0x0c0c0c0c
    v_mov_b32 v4, 0xc0c0302
    v_cmp_eq_u32 vcc, 0, v30
    v_mov_b32 v5, 0x3020c0c
    s_nop 0
    v_cndmask_b32 v3, v3, v4, vcc
    v_cmp_eq_u32 vcc, 0, v31
    s_nop 1
    v_cndmask_b32 v41, v3, v5, vcc
    v_mov_b32 v3, 0x0c0c0c0c
    v_mov_b32 v4, 0xc0c0100
    v_cmp_eq_u32 vcc, 0, v32
    v_mov_b32 v5, 0x1000c0c
    s_nop 0
    v_cndmask_b32 v3, v3, v4, vcc
    v_cmp_eq_u32 vcc, 0, v33
    s_nop 1
    v_cndmask_b32 v42, v3, v5, vcc
    v_mov_b32 v3, 0x0c0c0c0c
    v_mov_b32 v4, 0xc0c0302
    v_cmp_eq_u32 vcc, 0, v34
    v_mov_b32 v5, 0x3020c0c
    s_nop 0
    v_cndmask_b32 v3, v3, v4, vcc
    v_cmp_eq_u32 vcc, 0, v35
    s_nop 1
    v_cndmask_b32 v43, v3, v5, vcc
    s_mul_i32 s3, s31, 11
    s_add_u32 s33, s3, 10
    s_lshr_b32 s3, s3, 3
    s_lshr_b32 s33, s33, 3
    s_branch K_J1b50
K_STM5:
    s_branch K_STM9
K_STA5:
    s_branch K_STA9
K_J1b50:
    s_min_u32 s33, s33, 15
    s_sub_u32 s33, s33, s3
    s_add_u32 s33, s33, 1
    s_mul_i32 s33, s33, 10
    s_bfm_b32 s36, s33, 0
    v_mul_u32_u24 v2, 205, v1
    v_lshrrev_b32 v2, 11, v2
    v_add_u32 v2, s3, v2
    v_mul_u32_u24 v2, 1496, v2
    v_lshrrev_b32 v2, 11, v2
    v_sub_u32 v2, s31, v2
    v_and_b32 v2, 1, v2
    v_lshlrev_b32 v2, 6, v2
    v_lshl_add_u32 v2, v1, 8, v2
    s_mul_i32 s3, s3, 2560
    s_lshl_b32 s33, s35, 2
    s_add_u32 s3, s3, s33
    s_add_u32 s3, s3, 524288
    v_add_u32 v23, s3, v2
    s_lshr_b32 s3, s30, 1
    s_mul_i32 s3, s3, 3
    s_and_b32 s33, s30, 1
    s_lshl_b32 s33, s33, 3
    v_lshl_add_u32 v2, v1, 4, s33
    s_lshl_b32 s33, s3, 10
    s_add_u32 s33, s33, 40960
    v_add_u32 v24, s33, v2
    s_lshl_b32 s33, s3, 8
    s_add_u32 s33, s33, 53248
    v_add_u32 v25, s33, v2
    s_lshl_b32 s33, s30, 10
    s_add_u32 s33, s33, 40960
    v_lshl_add_u32 v26, v1, 4, s33
    s_mul_i32 s60, s31, 225280
    s_mul_i32 s3, s30, 20480
    s_lshl_b32 s33, s35, 10
    s_add_u32 s3, s3, s33
    v_lshl_add_u32 v19, v1, 4, s3
    v_add_u32 v3, 163840, v19
    s_sub_u32 s3, s30, 4
    s_lshl_b32 s3, s3, 2
    v_add_u32 v4, s3, v13
    v_mul_u32_u24 v2, 20480, v4
    v_lshl_add_u32 v2, v12, 4, v2
    s_lshl_b32 s33, s35, 8
    s_add_u32 s33, s33, 16384
    v_add_u32 v2, s33, v2
    v_mov_b32 v5, 0x10000000
    v_cmp_gt_u32 vcc, 11, v4
    s_nop 1
    v_cndmask_b32 v2, v5, v2, vcc
    s_cmp_lt_u32 s30, 3
    s_cselect_b64 vcc, -1, 0
    s_nop 1
    v_cndmask_b32 v20, v2, v3, vcc
    s_mov_b64 s[54:55], 0xffff
    s_mov_b32 s56, 0x3fb8aa3b
    s_mov_b32 s57, s56
    s_mov_b32 s58, 0x3e64f92e
    s_mov_b32 s59, s58
    v_and_b32 v156, -16, v19
    v_and_b32 v157, -16, v20
    s_mul_i32 s65, s31, 11
    s_add_u32 s65, s65, s30
    s_mul_i32 s65, s65, 20480
    s_cmp_eq_u32 s30, 0
    s_cbranch_scc1 K_CHM0
    s_cmp_eq_u32 s30, 1
    s_cbranch_scc1 K_CHM1
    s_cmp_eq_u32 s30, 2
    s_cbranch_scc1 K_CHM2
    s_branch K_CHM3
K_WRET_M:
    s_setprio 2
    s_barrier
    s_memrealtime s[86:87]
    ds_read_b64_tr_b16 v[208:209], v48 offset:40960
    ds_read_b64_tr_b16 v[210:211], v48 offset:41984
    ds_read_b128 v[160:163], v44 offset:40960
    ds_read_b64_tr_b16 v[212:213], v49 offset:40960
    ds_read_b64_tr_b16 v[214:215], v49 offset:41984
    ds_read_b128 v[164:167], v44 offset:43008
    ds_read_b64_tr_b16 v[216:217], v50 offset:40960
    ds_read_b64_tr_b16 v[218:219], v50 offset:41984
    ds_read_b128 v[168:171], v44 offset:45056
    ds_read_b64_tr_b16 v[220:221], v51 offset:40960
    ds_read_b64_tr_b16 v[222:223], v51 offset:41984
    ds_read_b128 v[172:175], v44 offset:47104
    ds_read_b128 v[176:179], v44 offset:49152
    ds_read_b128 v[180:183], v44 offset:51200
    s_waitcnt lgkmcnt(0)
    v_mfma_f32_16x16x32_bf16 v[60:63], v[208:211], v[160:163], 0
    ds_read_b64_tr_b16 v[224:225], v48 offset:49152
    v_mfma_f32_16x16x32_bf16 v[64:67], v[212:215], v[160:163], 0
    ds_read_b64_tr_b16 v[226:227], v48 offset:50176
    v_mfma_f32_16x16x32_bf16 v[68:71], v[216:219], v[160:163], 0
    ds_read_b128 v[184:187], v45 offset:40960
    v_mfma_f32_16x16x32_bf16 v[72:75], v[220:223], v[160:163], 0
    ds_read_b64_tr_b16 v[228:229], v49 offset:49152
    v_mfma_f32_16x16x32_bf16 v[88:91], v[220:223], v[164:167], 0
    ds_read_b64_tr_b16 v[230:231], v49 offset:50176
    v_mfma_f32_16x16x32_bf16 v[84:87], v[216:219], v[164:167], 0
    ds_read_b128 v[188:191], v45 offset:43008
    v_mfma_f32_16x16x32_bf16 v[80:83], v[212:215], v[164:167], 0
    ds_read_b64_tr_b16 v[232:233], v50 offset:49152
    v_mfma_f32_16x16x32_bf16 v[76:79], v[208:211], v[164:167], 0
    ds_read_b64_tr_b16 v[234:235], v50 offset:50176
    v_mfma_f32_16x16x32_bf16 v[92:95], v[208:211], v[168:171], 0
    ds_read_b128 v[192:195], v45 offset:45056
    v_mfma_f32_16x16x32_bf16 v[96:99], v[212:215], v[168:171], 0
    ds_read_b64_tr_b16 v[236:237], v51 offset:49152
    v_mfma_f32_16x16x32_bf16 v[100:103], v[216:219], v[168:171], 0
    ds_read_b64_tr_b16 v[238:239], v51 offset:50176
    v_mfma_f32_16x16x32_bf16 v[104:107], v[220:223], v[168:171], 0
    ds_read_b128 v[196:199], v45 offset:47104
    v_mfma_f32_16x16x32_bf16 v[120:123], v[220:223], v[172:175], 0
    ds_read_b128 v[200:203], v45 offset:49152
    v_mfma_f32_16x16x32_bf16 v[116:119], v[216:219], v[172:175], 0
    ds_read_b128 v[204:207], v45 offset:51200
    v_mfma_f32_16x16x32_bf16 v[112:115], v[212:215], v[172:175], 0
    v_mfma_f32_16x16x32_bf16 v[108:111], v[208:211], v[172:175], 0
    v_mfma_f32_16x16x32_bf16 v[124:127], v[208:211], v[176:179], 0
    v_mfma_f32_16x16x32_bf16 v[128:131], v[212:215], v[176:179], 0
    v_mfma_f32_16x16x32_bf16 v[132:135], v[216:219], v[176:179], 0
    v_mfma_f32_16x16x32_bf16 v[136:139], v[220:223], v[176:179], 0
    v_mfma_f32_16x16x32_bf16 v[152:155], v[220:223], v[180:183], 0
    v_mfma_f32_16x16x32_bf16 v[148:151], v[216:219], v[180:183], 0
    v_mfma_f32_16x16x32_bf16 v[144:147], v[212:215], v[180:183], 0
    v_mfma_f32_16x16x32_bf16 v[140:143], v[208:211], v[180:183], 0
    s_waitcnt lgkmcnt(0)
    s_barrier
    v_mfma_f32_16x16x32_bf16 v[60:63], v[224:227], v[184:187], v[60:63]
    ds_read_b64_tr_b16 v[208:209], v52 offset:0
    v_mfma_f32_16x16x32_bf16 v[64:67], v[228:231], v[184:187], v[64:67]
    ds_read_b64_tr_b16 v[210:211], v52 offset:1024
    v_mfma_f32_16x16x32_bf16 v[68:71], v[232:235], v[184:187], v[68:71]
    ds_read_b128 v[160:163], v46 offset:0
    v_mfma_f32_16x16x32_bf16 v[72:75], v[236:239], v[184:187], v[72:75]
    ds_read_b64_tr_b16 v[212:213], v53 offset:0
    v_mfma_f32_16x16x32_bf16 v[88:91], v[236:239], v[188:191], v[88:91]
    ds_read_b64_tr_b16 v[214:215], v53 offset:1024
    v_mfma_f32_16x16x32_bf16 v[84:87], v[232:235], v[188:191], v[84:87]
    ds_read_b128 v[164:167], v46 offset:2048
    v_mfma_f32_16x16x32_bf16 v[80:83], v[228:231], v[188:191], v[80:83]
    ds_read_b64_tr_b16 v[216:217], v54 offset:0
    v_mfma_f32_16x16x32_bf16 v[76:79], v[224:227], v[188:191], v[76:79]
    ds_read_b64_tr_b16 v[218:219], v54 offset:1024
    v_mfma_f32_16x16x32_bf16 v[92:95], v[224:227], v[192:195], v[92:95]
    s_branch K_J1f18
K_STM6:
    s_branch K_STM10
K_STA6:
    s_branch K_STA10
K_J1f18:
    ds_read_b128 v[168:171], v46 offset:4096
    v_mfma_f32_16x16x32_bf16 v[96:99], v[228:231], v[192:195], v[96:99]
    ds_read_b64_tr_b16 v[220:221], v55 offset:0
    v_mfma_f32_16x16x32_bf16 v[100:103], v[232:235], v[192:195], v[100:103]
    ds_read_b64_tr_b16 v[222:223], v55 offset:1024
    v_mfma_f32_16x16x32_bf16 v[104:107], v[236:239], v[192:195], v[104:107]
    ds_read_b128 v[172:175], v46 offset:6144
    v_mfma_f32_16x16x32_bf16 v[120:123], v[236:239], v[196:199], v[120:123]
    ds_read_b128 v[176:179], v46 offset:8192
    v_mfma_f32_16x16x32_bf16 v[116:119], v[232:235], v[196:199], v[116:119]
    ds_read_b128 v[180:183], v46 offset:10240
    v_mfma_f32_16x16x32_bf16 v[112:115], v[228:231], v[196:199], v[112:115]
    v_mfma_f32_16x16x32_bf16 v[108:111], v[224:227], v[196:199], v[108:111]
    v_mfma_f32_16x16x32_bf16 v[124:127], v[224:227], v[200:203], v[124:127]
    v_mfma_f32_16x16x32_bf16 v[128:131], v[228:231], v[200:203], v[128:131]
    v_mfma_f32_16x16x32_bf16 v[132:135], v[232:235], v[200:203], v[132:135]
    v_mfma_f32_16x16x32_bf16 v[136:139], v[236:239], v[200:203], v[136:139]
    v_mfma_f32_16x16x32_bf16 v[152:155], v[236:239], v[204:207], v[152:155]
    v_mfma_f32_16x16x32_bf16 v[148:151], v[232:235], v[204:207], v[148:151]
    v_mfma_f32_16x16x32_bf16 v[144:147], v[228:231], v[204:207], v[144:147]
    v_mfma_f32_16x16x32_bf16 v[140:143], v[224:227], v[204:207], v[140:143]
    s_waitcnt lgkmcnt(0)
    v_mfma_f32_16x16x32_bf16 v[60:63], v[208:211], v[160:163], v[60:63]
    ds_read_b64_tr_b16 v[224:225], v52 offset:8192
    v_mfma_f32_16x16x32_bf16 v[64:67], v[212:215], v[160:163], v[64:67]
    ds_read_b64_tr_b16 v[226:227], v52 offset:9216
    v_mfma_f32_16x16x32_bf16 v[68:71], v[216:219], v[160:163], v[68:71]
    s_branch K_PG1
.p2align 12
K_STM7:
    s_branch K_STM11
K_STA7:
    s_branch K_STA11
K_PG1:
    ds_read_b128 v[184:187], v47 offset:0
    v_mfma_f32_16x16x32_bf16 v[72:75], v[220:223], v[160:163], v[72:75]
    ds_read_b64_tr_b16 v[228:229], v53 offset:8192
    v_mfma_f32_16x16x32_bf16 v[88:91], v[220:223], v[164:167], v[88:91]
    ds_read_b64_tr_b16 v[230:231], v53 offset:9216
    v_mfma_f32_16x16x32_bf16 v[84:87], v[216:219], v[164:167], v[84:87]
    ds_read_b128 v[188:191], v47 offset:2048
    v_mfma_f32_16x16x32_bf16 v[80:83], v[212:215], v[164:167], v[80:83]
    ds_read_b64_tr_b16 v[232:233], v54 offset:8192
    v_mfma_f32_16x16x32_bf16 v[76:79], v[208:211], v[164:167], v[76:79]
    ds_read_b64_tr_b16 v[234:235], v54 offset:9216
    v_mfma_f32_16x16x32_bf16 v[92:95], v[208:211], v[168:171], v[92:95]
    ds_read_b128 v[192:195], v47 offset:4096
    v_mfma_f32_16x16x32_bf16 v[96:99], v[212:215], v[168:171], v[96:99]
    ds_read_b64_tr_b16 v[236:237], v55 offset:8192
    v_mfma_f32_16x16x32_bf16 v[100:103], v[216:219], v[168:171], v[100:103]
    ds_read_b64_tr_b16 v[238:239], v55 offset:9216
    v_mfma_f32_16x16x32_bf16 v[104:107], v[220:223], v[168:171], v[104:107]
    ds_read_b128 v[196:199], v47 offset:6144
    v_mfma_f32_16x16x32_bf16 v[120:123], v[220:223], v[172:175], v[120:123]
    ds_read_b128 v[200:203], v47 offset:8192
    v_mfma_f32_16x16x32_bf16 v[116:119], v[216:219], v[172:175], v[116:119]
    ds_read_b128 v[204:207], v47 offset:10240
    v_mfma_f32_16x16x32_bf16 v[112:115], v[212:215], v[172:175], v[112:115]
    v_mfma_f32_16x16x32_bf16 v[108:111], v[208:211], v[172:175], v[108:111]
    v_mfma_f32_16x16x32_bf16 v[124:127], v[208:211], v[176:179], v[124:127]
    v_mfma_f32_16x16x32_bf16 v[128:131], v[212:215], v[176:179], v[128:131]
    v_mfma_f32_16x16x32_bf16 v[132:135], v[216:219], v[176:179], v[132:135]
    v_mfma_f32_16x16x32_bf16 v[136:139], v[220:223], v[176:179], v[136:139]
    v_mfma_f32_16x16x32_bf16 v[152:155], v[220:223], v[180:183], v[152:155]
    v_mfma_f32_16x16x32_bf16 v[148:151], v[216:219], v[180:183], v[148:151]
    v_mfma_f32_16x16x32_bf16 v[144:147], v[212:215], v[180:183], v[144:147]
    v_mfma_f32_16x16x32_bf16 v[140:143], v[208:211], v[180:183], v[140:143]
    s_waitcnt lgkmcnt(0)
    s_barrier
    v_mfma_f32_16x16x32_bf16 v[60:63], v[224:227], v[184:187], v[60:63]
    ds_read_b64_tr_b16 v[208:209], v48 offset:0
    v_mfma_f32_16x16x32_bf16 v[64:67], v[228:231], v[184:187], v[64:67]
    ds_read_b64_tr_b16 v[210:211], v48 offset:1024
    v_mfma_f32_16x16x32_bf16 v[68:71], v[232:235], v[184:187], v[68:71]
    ds_read_b128 v[160:163], v44 offset:0
    v_mfma_f32_16x16x32_bf16 v[72:75], v[236:239], v[184:187], v[72:75]
    ds_read_b64_tr_b16 v[212:213], v49 offset:0
    v_mfma_f32_16x16x32_bf16 v[88:91], v[236:239], v[188:191], v[88:91]
    ds_read_b64_tr_b16 v[214:215], v49 offset:1024
    v_mfma_f32_16x16x32_bf16 v[84:87], v[232:235], v[188:191], v[84:87]
    ds_read_b128 v[164:167], v44 offset:2048
    v_mfma_f32_16x16x32_bf16 v[80:83], v[228:231], v[188:191], v[80:83]
    ds_read_b64_tr_b16 v[216:217], v50 offset:0
    v_mfma_f32_16x16x32_bf16 v[76:79], v[224:227], v[188:191], v[76:79]
    ds_read_b64_tr_b16 v[218:219], v50 offset:1024
    v_mfma_f32_16x16x32_bf16 v[92:95], v[224:227], v[192:195], v[92:95]
    ds_read_b128 v[168:171], v44 offset:4096
    v_mfma_f32_16x16x32_bf16 v[96:99], v[228:231], v[192:195], v[96:99]
    ds_read_b64_tr_b16 v[220:221], v51 offset:0
    v_mfma_f32_16x16x32_bf16 v[100:103], v[232:235], v[192:195], v[100:103]
    ds_read_b64_tr_b16 v[222:223], v51 offset:1024
    v_mfma_f32_16x16x32_bf16 v[104:107], v[236:239], v[192:195], v[104:107]
    ds_read_b128 v[172:175], v44 offset:6144
    v_mfma_f32_16x16x32_bf16 v[120:123], v[236:239], v[196:199], v[120:123]
    ds_read_b128 v[176:179], v44 offset:8192
    v_mfma_f32_16x16x32_bf16 v[116:119], v[232:235], v[196:199], v[116:119]
    ds_read_b128 v[180:183], v44 offset:10240
    v_mfma_f32_16x16x32_bf16 v[112:115], v[228:231], v[196:199], v[112:115]
    v_mfma_f32_16x16x32_bf16 v[108:111], v[224:227], v[196:199], v[108:111]
    v_mfma_f32_16x16x32_bf16 v[124:127], v[224:227], v[200:203], v[124:127]
    v_mfma_f32_16x16x32_bf16 v[128:131], v[228:231], v[200:203], v[128:131]
    v_mfma_f32_16x16x32_bf16 v[132:135], v[232:235], v[200:203], v[132:135]
    v_mfma_f32_16x16x32_bf16 v[136:139], v[236:239], v[200:203], v[136:139]
    v_mfma_f32_16x16x32_bf16 v[152:155], v[236:239], v[204:207], v[152:155]
    v_mfma_f32_16x16x32_bf16 v[148:151], v[232:235], v[204:207], v[148:151]
    v_mfma_f32_16x16x32_bf16 v[144:147], v[228:231], v[204:207], v[144:147]
    v_mfma_f32_16x16x32_bf16 v[140:143], v[224:227], v[204:207], v[140:143]
    s_waitcnt lgkmcnt(0)
    v_mfma_f32_16x16x32_bf16 v[60:63], v[208:211], v[160:163], v[60:63]
    ds_read_b64_tr_b16 v[224:225], v48 offset:8192
    v_mfma_f32_16x16x32_bf16 v[64:67], v[212:215], v[160:163], v[64:67]
    ds_read_b64_tr_b16 v[226:227], v48 offset:9216
    v_mfma_f32_16x16x32_bf16 v[68:71], v[216:219], v[160:163], v[68:71]
    ds_read_b128 v[184:187], v45 offset:0
    v_mfma_f32_16x16x32_bf16 v[72:75], v[220:223], v[160:163], v[72:75]
    ds_read_b64_tr_b16 v[228:229], v49 offset:8192
    v_mfma_f32_16x16x32_bf16 v[88:91], v[220:223], v[164:167], v[88:91]
    ds_read_b64_tr_b16 v[230:231], v49 offset:9216
    v_mfma_f32_16x16x32_bf16 v[84:87], v[216:219], v[164:167], v[84:87]
    ds_read_b128 v[188:191], v45 offset:2048
    v_mfma_f32_16x16x32_bf16 v[80:83], v[212:215], v[164:167], v[80:83]
    ds_read_b64_tr_b16 v[232:233], v50 offset:8192
    v_mfma_f32_16x16x32_bf16 v[76:79], v[208:211], v[164:167], v[76:79]
    ds_read_b64_tr_b16 v[234:235], v50 offset:9216
    v_mfma_f32_16x16x32_bf16 v[92:95], v[208:211], v[168:171], v[92:95]
    ds_read_b128 v[192:195], v45 offset:4096
    v_mfma_f32_16x16x32_bf16 v[96:99], v[212:215], v[168:171], v[96:99]
    ds_read_b64_tr_b16 v[236:237], v51 offset:8192
    v_mfma_f32_16x16x32_bf16 v[100:103], v[216:219], v[168:171], v[100:103]
    ds_read_b64_tr_b16 v[238:239], v51 offset:9216
    v_mfma_f32_16x16x32_bf16 v[104:107], v[220:223], v[168:171], v[104:107]
    ds_read_b128 v[196:199], v45 offset:6144
    v_mfma_f32_16x16x32_bf16 v[120:123], v[220:223], v[172:175], v[120:123]
    ds_read_b128 v[200:203], v45 offset:8192
    v_mfma_f32_16x16x32_bf16 v[116:119], v[216:219], v[172:175], v[116:119]
    ds_read_b128 v[204:207], v45 offset:10240
    v_mfma_f32_16x16x32_bf16 v[112:115], v[212:215], v[172:175], v[112:115]
    v_mfma_f32_16x16x32_bf16 v[108:111], v[208:211], v[172:175], v[108:111]
    v_mfma_f32_16x16x32_bf16 v[124:127], v[208:211], v[176:179], v[124:127]
    v_mfma_f32_16x16x32_bf16 v[128:131], v[212:215], v[176:179], v[128:131]
    v_mfma_f32_16x16x32_bf16 v[132:135], v[216:219], v[176:179], v[132:135]
    v_mfma_f32_16x16x32_bf16 v[136:139], v[220:223], v[176:179], v[136:139]
    v_mfma_f32_16x16x32_bf16 v[152:155], v[220:223], v[180:183], v[152:155]
    v_mfma_f32_16x16x32_bf16 v[148:151], v[216:219], v[180:183], v[148:151]
    v_mfma_f32_16x16x32_bf16 v[144:147], v[212:215], v[180:183], v[144:147]
    v_mfma_f32_16x16x32_bf16 v[140:143], v[208:211], v[180:183], v[140:143]
    s_waitcnt lgkmcnt(0)
    s_barrier
    v_mfma_f32_16x16x32_bf16 v[60:63], v[224:227], v[184:187], v[60:63]
    ds_read_b64_tr_b16 v[208:209], v48 offset:40960
    v_mfma_f32_16x16x32_bf16 v[64:67], v[228:231], v[184:187], v[64:67]
    ds_read_b64_tr_b16 v[210:211], v48 offset:41984
    v_mfma_f32_16x16x32_bf16 v[68:71], v[232:235], v[184:187], v[68:71]
    ds_read_b128 v[160:163], v44 offset:40960
    v_mfma_f32_16x16x32_bf16 v[72:75], v[236:239], v[184:187], v[72:75]
    ds_read_b64_tr_b16 v[212:213], v49 offset:40960
    v_mfma_f32_16x16x32_bf16 v[88:91], v[236:239], v[188:191], v[88:91]
    s_branch K_J23cc
K_STM8:
    s_branch K_STM12
K_STA8:
    s_branch K_STA12
K_J23cc:
    ds_read_b64_tr_b16 v[214:215], v49 offset:41984
    v_mfma_f32_16x16x32_bf16 v[84:87], v[232:235], v[188:191], v[84:87]
    ds_read_b128 v[164:167], v44 offset:43008
    v_mfma_f32_16x16x32_bf16 v[80:83], v[228:231], v[188:191], v[80:83]
    ds_read_b64_tr_b16 v[216:217], v50 offset:40960
    v_mfma_f32_16x16x32_bf16 v[76:79], v[224:227], v[188:191], v[76:79]
    ds_read_b64_tr_b16 v[218:219], v50 offset:41984
    v_mfma_f32_16x16x32_bf16 v[92:95], v[224:227], v[192:195], v[92:95]
    ds_read_b128 v[168:171], v44 offset:45056
    v_mfma_f32_16x16x32_bf16 v[96:99], v[228:231], v[192:195], v[96:99]
    ds_read_b64_tr_b16 v[220:221], v51 offset:40960
    v_mfma_f32_16x16x32_bf16 v[100:103], v[232:235], v[192:195], v[100:103]
    ds_read_b64_tr_b16 v[222:223], v51 offset:41984
    v_mfma_f32_16x16x32_bf16 v[104:107], v[236:239], v[192:195], v[104:107]
    ds_read_b128 v[172:175], v44 offset:47104
    v_mfma_f32_16x16x32_bf16 v[120:123], v[236:239], v[196:199], v[120:123]
    ds_read_b128 v[176:179], v44 offset:49152
    v_mfma_f32_16x16x32_bf16 v[116:119], v[232:235], v[196:199], v[116:119]
    ds_read_b128 v[180:183], v44 offset:51200
    v_mfma_f32_16x16x32_bf16 v[112:115], v[228:231], v[196:199], v[112:115]
    v_mfma_f32_16x16x32_bf16 v[108:111], v[224:227], v[196:199], v[108:111]
    v_mfma_f32_16x16x32_bf16 v[124:127], v[224:227], v[200:203], v[124:127]
    v_mfma_f32_16x16x32_bf16 v[128:131], v[228:231], v[200:203], v[128:131]
    v_mfma_f32_16x16x32_bf16 v[132:135], v[232:235], v[200:203], v[132:135]
    v_mfma_f32_16x16x32_bf16 v[136:139], v[236:239], v[200:203], v[136:139]
    v_mfma_f32_16x16x32_bf16 v[152:155], v[236:239], v[204:207], v[152:155]
    v_mfma_f32_16x16x32_bf16 v[148:151], v[232:235], v[204:207], v[148:151]
    v_mfma_f32_16x16x32_bf16 v[144:147], v[228:231], v[204:207], v[144:147]
    v_mfma_f32_16x16x32_bf16 v[140:143], v[224:227], v[204:207], v[140:143]
    s_waitcnt lgkmcnt(0)
    v_mfma_f32_16x16x32_bf16 v[60:63], v[208:211], v[160:163], v[60:63]
    ds_read_b64_tr_b16 v[224:225], v48 offset:49152
    v_mfma_f32_16x16x32_bf16 v[64:67], v[212:215], v[160:163], v[64:67]
    ds_read_b64_tr_b16 v[226:227], v48 offset:50176
    v_mfma_f32_16x16x32_bf16 v[68:71], v[216:219], v[160:163], v[68:71]
    ds_read_b128 v[184:187], v45 offset:40960
    v_mfma_f32_16x16x32_bf16 v[72:75], v[220:223], v[160:163], v[72:75]
    ds_read_b64_tr_b16 v[228:229], v49 offset:49152
    v_mfma_f32_16x16x32_bf16 v[88:91], v[220:223], v[164:167], v[88:91]
    ds_read_b64_tr_b16 v[230:231], v49 offset:50176
    v_mfma_f32_16x16x32_bf16 v[84:87], v[216:219], v[164:167], v[84:87]
    ds_read_b128 v[188:191], v45 offset:43008
    v_mfma_f32_16x16x32_bf16 v[80:83], v[212:215], v[164:167], v[80:83]
    ds_read_b64_tr_b16 v[232:233], v50 offset:49152
    v_mfma_f32_16x16x32_bf16 v[76:79], v[208:211], v[164:167], v[76:79]
    ds_read_b64_tr_b16 v[234:235], v50 offset:50176
    v_mfma_f32_16x16x32_bf16 v[92:95], v[208:211], v[168:171], v[92:95]
    ds_read_b128 v[192:195], v45 offset:45056
    v_mfma_f32_16x16x32_bf16 v[96:99], v[212:215], v[168:171], v[96:99]
    ds_read_b64_tr_b16 v[236:237], v51 offset:49152
    v_mfma_f32_16x16x32_bf16 v[100:103], v[216:219], v[168:171], v[100:103]
    ds_read_b64_tr_b16 v[238:239], v51 offset:50176
    v_mfma_f32_16x16x32_bf16 v[104:107], v[220:223], v[168:171], v[104:107]
    ds_read_b128 v[196:199], v45 offset:47104
    v_mfma_f32_16x16x32_bf16 v[120:123], v[220:223], v[172:175], v[120:123]
    ds_read_b128 v[200:203], v45 offset:49152
    v_mfma_f32_16x16x32_bf16 v[116:119], v[216:219], v[172:175], v[116:119]
    ds_read_b128 v[204:207], v45 offset:51200
    v_mfma_f32_16x16x32_bf16 v[112:115], v[212:215], v[172:175], v[112:115]
    v_mfma_f32_16x16x32_bf16 v[108:111], v[208:211], v[172:175], v[108:111]
    v_mfma_f32_16x16x32_bf16 v[124:127], v[208:211], v[176:179], v[124:127]
    v_mfma_f32_16x16x32_bf16 v[128:131], v[212:215], v[176:179], v[128:131]
    v_mfma_f32_16x16x32_bf16 v[132:135], v[216:219], v[176:179], v[132:135]
    v_mfma_f32_16x16x32_bf16 v[136:139], v[220:223], v[176:179], v[136:139]
    v_mfma_f32_16x16x32_bf16 v[152:155], v[220:223], v[180:183], v[152:155]
    v_mfma_f32_16x16x32_bf16 v[148:151], v[216:219], v[180:183], v[148:151]
    v_mfma_f32_16x16x32_bf16 v[144:147], v[212:215], v[180:183], v[144:147]
    v_mfma_f32_16x16x32_bf16 v[140:143], v[208:211], v[180:183], v[140:143]
    s_waitcnt lgkmcnt(0)
    s_barrier
    v_mfma_f32_16x16x32_bf16 v[60:63], v[224:227], v[184:187], v[60:63]
    ds_read_b64_tr_b16 v[208:209], v52 offset:0
    v_mfma_f32_16x16x32_bf16 v[64:67], v[228:231], v[184:187], v[64:67]
    ds_read_b64_tr_b16 v[210:211], v52 offset:1024
    v_mfma_f32_16x16x32_bf16 v[68:71], v[232:235], v[184:187], v[68:71]
    ds_read_b128 v[160:163], v46 offset:0
    v_mfma_f32_16x16x32_bf16 v[72:75], v[236:239], v[184:187], v[72:75]
    ds_read_b64_tr_b16 v[212:213], v53 offset:0
    v_mfma_f32_16x16x32_bf16 v[88:91], v[236:239], v[188:191], v[88:91]
    ds_read_b64_tr_b16 v[214:215], v53 offset:1024
    v_mfma_f32_16x16x32_bf16 v[84:87], v[232:235], v[188:191], v[84:87]
    ds_read_b128 v[164:167], v46 offset:2048
    v_mfma_f32_16x16x32_bf16 v[80:83], v[228:231], v[188:191], v[80:83]
    ds_read_b64_tr_b16 v[216:217], v54 offset:0
    v_mfma_f32_16x16x32_bf16 v[76:79], v[224:227], v[188:191], v[76:79]
    ds_read_b64_tr_b16 v[218:219], v54 offset:1024
    v_mfma_f32_16x16x32_bf16 v[92:95], v[224:227], v[192:195], v[92:95]
    ds_read_b128 v[168:171], v46 offset:4096
    v_mfma_f32_16x16x32_bf16 v[96:99], v[228:231], v[192:195], v[96:99]
    ds_read_b64_tr_b16 v[220:221], v55 offset:0
    v_mfma_f32_16x16x32_bf16 v[100:103], v[232:235], v[192:195], v[100:103]
    ds_read_b64_tr_b16 v[222:223], v55 offset:1024
    v_mfma_f32_16x16x32_bf16 v[104:107], v[236:239], v[192:195], v[104:107]
    ds_read_b128 v[172:175], v46 offset:6144
    v_mfma_f32_16x16x32_bf16 v[120:123], v[236:239], v[196:199], v[120:123]
    ds_read_b128 v[176:179], v46 offset:8192
    v_mfma_f32_16x16x32_bf16 v[116:119], v[232:235], v[196:199], v[116:119]
    ds_read_b128 v[180:183], v46 offset:10240
    v_mfma_f32_16x16x32_bf16 v[112:115], v[228:231], v[196:199], v[112:115]
    v_mfma_f32_16x16x32_bf16 v[108:111], v[224:227], v[196:199], v[108:111]
    v_mfma_f32_16x16x32_bf16 v[124:127], v[224:227], v[200:203], v[124:127]
    v_mfma_f32_16x16x32_bf16 v[128:131], v[228:231], v[200:203], v[128:131]
    v_mfma_f32_16x16x32_bf16 v[132:135], v[232:235], v[200:203], v[132:135]
    v_mfma_f32_16x16x32_bf16 v[136:139], v[236:239], v[200:203], v[136:139]
    v_mfma_f32_16x16x32_bf16 v[152:155], v[236:239], v[204:207], v[152:155]
    v_mfma_f32_16x16x32_bf16 v[148:151], v[232:235], v[204:207], v[148:151]
    v_mfma_f32_16x16x32_bf16 v[144:147], v[228:231], v[204:207], v[144:147]
    v_mfma_f32_16x16x32_bf16 v[140:143], v[224:227], v[204:207], v[140:143]
    s_waitcnt lgkmcnt(0)
    v_mfma_f32_16x16x32_bf16 v[60:63], v[208:211], v[160:163], v[60:63]
    ds_read_b64_tr_b16 v[224:225], v52 offset:8192
    v_mfma_f32_16x16x32_bf16 v[64:67], v[212:215], v[160:163], v[64:67]
    ds_read_b64_tr_b16 v[226:227], v52 offset:9216
    v_mfma_f32_16x16x32_bf16 v[68:71], v[216:219], v[160:163], v[68:71]
    ds_read_b128 v[184:187], v47 offset:0
    v_mfma_f32_16x16x32_bf16 v[72:75], v[220:223], v[160:163], v[72:75]
    ds_read_b64_tr_b16 v[228:229], v53 offset:8192
    v_mfma_f32_16x16x32_bf16 v[88:91], v[220:223], v[164:167], v[88:91]
    ds_read_b64_tr_b16 v[230:231], v53 offset:9216
    v_mfma_f32_16x16x32_bf16 v[84:87], v[216:219], v[164:167], v[84:87]
    ds_read_b128 v[188:191], v47 offset:2048
    s_branch K_J2790
K_STM9:
    s_branch K_STM13
K_STA9:
    s_branch K_STA13
K_J2790:
    v_mfma_f32_16x16x32_bf16 v[80:83], v[212:215], v[164:167], v[80:83]
    ds_read_b64_tr_b16 v[232:233], v54 offset:8192
    v_mfma_f32_16x16x32_bf16 v[76:79], v[208:211], v[164:167], v[76:79]
    ds_read_b64_tr_b16 v[234:235], v54 offset:9216
    v_mfma_f32_16x16x32_bf16 v[92:95], v[208:211], v[168:171], v[92:95]
    ds_read_b128 v[192:195], v47 offset:4096
    v_mfma_f32_16x16x32_bf16 v[96:99], v[212:215], v[168:171], v[96:99]
    ds_read_b64_tr_b16 v[236:237], v55 offset:8192
    v_mfma_f32_16x16x32_bf16 v[100:103], v[216:219], v[168:171], v[100:103]
    ds_read_b64_tr_b16 v[238:239], v55 offset:9216
    v_mfma_f32_16x16x32_bf16 v[104:107], v[220:223], v[168:171], v[104:107]
    ds_read_b128 v[196:199], v47 offset:6144
    v_mfma_f32_16x16x32_bf16 v[120:123], v[220:223], v[172:175], v[120:123]
    ds_read_b128 v[200:203], v47 offset:8192
    v_mfma_f32_16x16x32_bf16 v[116:119], v[216:219], v[172:175], v[116:119]
    ds_read_b128 v[204:207], v47 offset:10240
    v_mfma_f32_16x16x32_bf16 v[112:115], v[212:215], v[172:175], v[112:115]
    v_mfma_f32_16x16x32_bf16 v[108:111], v[208:211], v[172:175], v[108:111]
    v_mfma_f32_16x16x32_bf16 v[124:127], v[208:211], v[176:179], v[124:127]
    v_mfma_f32_16x16x32_bf16 v[128:131], v[212:215], v[176:179], v[128:131]
    v_mfma_f32_16x16x32_bf16 v[132:135], v[216:219], v[176:179], v[132:135]
    v_mfma_f32_16x16x32_bf16 v[136:139], v[220:223], v[176:179], v[136:139]
    v_mfma_f32_16x16x32_bf16 v[152:155], v[220:223], v[180:183], v[152:155]
    v_mfma_f32_16x16x32_bf16 v[148:151], v[216:219], v[180:183], v[148:151]
    v_mfma_f32_16x16x32_bf16 v[144:147], v[212:215], v[180:183], v[144:147]
    v_mfma_f32_16x16x32_bf16 v[140:143], v[208:211], v[180:183], v[140:143]
    s_waitcnt lgkmcnt(0)
    s_barrier
    v_mfma_f32_16x16x32_bf16 v[60:63], v[224:227], v[184:187], v[60:63]
    ds_read_b64_tr_b16 v[208:209], v48 offset:0
    v_mfma_f32_16x16x32_bf16 v[64:67], v[228:231], v[184:187], v[64:67]
    ds_read_b64_tr_b16 v[210:211], v48 offset:1024
    v_mfma_f32_16x16x32_bf16 v[68:71], v[232:235], v[184:187], v[68:71]
    ds_read_b128 v[160:163], v44 offset:0
    v_mfma_f32_16x16x32_bf16 v[72:75], v[236:239], v[184:187], v[72:75]
    ds_read_b64_tr_b16 v[212:213], v49 offset:0
    v_mfma_f32_16x16x32_bf16 v[88:91], v[236:239], v[188:191], v[88:91]
    ds_read_b64_tr_b16 v[214:215], v49 offset:1024
    v_mfma_f32_16x16x32_bf16 v[84:87], v[232:235], v[188:191], v[84:87]
    ds_read_b128 v[164:167], v44 offset:2048
    v_mfma_f32_16x16x32_bf16 v[80:83], v[228:231], v[188:191], v[80:83]
    ds_read_b64_tr_b16 v[216:217], v50 offset:0
    v_mfma_f32_16x16x32_bf16 v[76:79], v[224:227], v[188:191], v[76:79]
    ds_read_b64_tr_b16 v[218:219], v50 offset:1024
    v_mfma_f32_16x16x32_bf16 v[92:95], v[224:227], v[192:195], v[92:95]
    ds_read_b128 v[168:171], v44 offset:4096
    v_mfma_f32_16x16x32_bf16 v[96:99], v[228:231], v[192:195], v[96:99]
    ds_read_b64_tr_b16 v[220:221], v51 offset:0
    v_mfma_f32_16x16x32_bf16 v[100:103], v[232:235], v[192:195], v[100:103]
    ds_read_b64_tr_b16 v[222:223], v51 offset:1024
    v_mfma_f32_16x16x32_bf16 v[104:107], v[236:239], v[192:195], v[104:107]
    ds_read_b128 v[172:175], v44 offset:6144
    v_mfma_f32_16x16x32_bf16 v[120:123], v[236:239], v[196:199], v[120:123]
    ds_read_b128 v[176:179], v44 offset:8192
    v_mfma_f32_16x16x32_bf16 v[116:119], v[232:235], v[196:199], v[116:119]
    ds_read_b128 v[180:183], v44 offset:10240
    v_mfma_f32_16x16x32_bf16 v[112:115], v[228:231], v[196:199], v[112:115]
    v_mfma_f32_16x16x32_bf16 v[108:111], v[224:227], v[196:199], v[108:111]
    v_mfma_f32_16x16x32_bf16 v[124:127], v[224:227], v[200:203], v[124:127]
    v_mfma_f32_16x16x32_bf16 v[128:131], v[228:231], v[200:203], v[128:131]
    v_mfma_f32_16x16x32_bf16 v[132:135], v[232:235], v[200:203], v[132:135]
    v_mfma_f32_16x16x32_bf16 v[136:139], v[236:239], v[200:203], v[136:139]
    v_mfma_f32_16x16x32_bf16 v[152:155], v[236:239], v[204:207], v[152:155]
    v_mfma_f32_16x16x32_bf16 v[148:151], v[232:235], v[204:207], v[148:151]
    v_mfma_f32_16x16x32_bf16 v[144:147], v[228:231], v[204:207], v[144:147]
    v_mfma_f32_16x16x32_bf16 v[140:143], v[224:227], v[204:207], v[140:143]
    s_memrealtime s[88:89]
    s_waitcnt lgkmcnt(0)
    v_mfma_f32_16x16x32_bf16 v[60:63], v[208:211], v[160:163], v[60:63]
    ds_read_b64_tr_b16 v[224:225], v48 offset:8192
    v_mfma_f32_16x16x32_bf16 v[64:67], v[212:215], v[160:163], v[64:67]
    ds_read_b64_tr_b16 v[226:227], v48 offset:9216
    v_mfma_f32_16x16x32_bf16 v[68:71], v[216:219], v[160:163], v[68:71]
    ds_read_b128 v[184:187], v45 offset:0
    v_mfma_f32_16x16x32_bf16 v[72:75], v[220:223], v[160:163], v[72:75]
    ds_read_b64_tr_b16 v[228:229], v49 offset:8192
    v_mfma_f32_16x16x32_bf16 v[88:91], v[220:223], v[164:167], v[88:91]
    ds_read_b64_tr_b16 v[230:231], v49 offset:9216
    v_mfma_f32_16x16x32_bf16 v[84:87], v[216:219], v[164:167], v[84:87]
    ds_read_b128 v[188:191], v45 offset:2048
    v_mfma_f32_16x16x32_bf16 v[80:83], v[212:215], v[164:167], v[80:83]
    ds_read_b64_tr_b16 v[232:233], v50 offset:8192
    v_mfma_f32_16x16x32_bf16 v[76:79], v[208:211], v[164:167], v[76:79]
    ds_read_b64_tr_b16 v[234:235], v50 offset:9216
    v_mfma_f32_16x16x32_bf16 v[92:95], v[208:211], v[168:171], v[92:95]
    ds_read_b128 v[192:195], v45 offset:4096
    v_mfma_f32_16x16x32_bf16 v[96:99], v[212:215], v[168:171], v[96:99]
    ds_read_b64_tr_b16 v[236:237], v51 offset:8192
    v_mfma_f32_16x16x32_bf16 v[100:103], v[216:219], v[168:171], v[100:103]
    ds_read_b64_tr_b16 v[238:239], v51 offset:9216
    v_mfma_f32_16x16x32_bf16 v[104:107], v[220:223], v[168:171], v[104:107]
    ds_read_b128 v[196:199], v45 offset:6144
    v_mfma_f32_16x16x32_bf16 v[120:123], v[220:223], v[172:175], v[120:123]
    ds_read_b128 v[200:203], v45 offset:8192
    v_mfma_f32_16x16x32_bf16 v[116:119], v[216:219], v[172:175], v[116:119]
    ds_read_b128 v[204:207], v45 offset:10240
    v_mfma_f32_16x16x32_bf16 v[112:115], v[212:215], v[172:175], v[112:115]
    v_mfma_f32_16x16x32_bf16 v[108:111], v[208:211], v[172:175], v[108:111]
    v_mfma_f32_16x16x32_bf16 v[124:127], v[208:211], v[176:179], v[124:127]
    v_mfma_f32_16x16x32_bf16 v[128:131], v[212:215], v[176:179], v[128:131]
    v_mfma_f32_16x16x32_bf16 v[132:135], v[216:219], v[176:179], v[132:135]
    v_mfma_f32_16x16x32_bf16 v[136:139], v[220:223], v[176:179], v[136:139]
    v_mfma_f32_16x16x32_bf16 v[152:155], v[220:223], v[180:183], v[152:155]
    v_mfma_f32_16x16x32_bf16 v[148:151], v[216:219], v[180:183], v[148:151]
    v_mfma_f32_16x16x32_bf16 v[144:147], v[212:215], v[180:183], v[144:147]
    v_mfma_f32_16x16x32_bf16 v[140:143], v[208:211], v[180:183], v[140:143]
    s_waitcnt lgkmcnt(0)
    s_barrier
    v_mfma_f32_16x16x32_bf16 v[60:63], v[224:227], v[184:187], v[60:63]
    ds_read_b64_tr_b16 v[208:209], v48 offset:40960
    v_mfma_f32_16x16x32_bf16 v[64:67], v[228:231], v[184:187], v[64:67]
    ds_read_b64_tr_b16 v[210:211], v48 offset:41984
    v_mfma_f32_16x16x32_bf16 v[68:71], v[232:235], v[184:187], v[68:71]
    ds_read_b128 v[160:163], v44 offset:40960
    v_mfma_f32_16x16x32_bf16 v[72:75], v[236:239], v[184:187], v[72:75]
    ds_read_b64_tr_b16 v[212:213], v49 offset:40960
    v_mfma_f32_16x16x32_bf16 v[88:91], v[236:239], v[188:191], v[88:91]
    ds_read_b64_tr_b16 v[214:215], v49 offset:41984
    v_mfma_f32_16x16x32_bf16 v[84:87], v[232:235], v[188:191], v[84:87]
    ds_read_b128 v[164:167], v44 offset:43008
    v_mfma_f32_16x16x32_bf16 v[80:83], v[228:231], v[188:191], v[80:83]
    ds_read_b64_tr_b16 v[216:217], v50 offset:40960
    s_branch K_J2b58
K_STM10:
    s_branch K_STM14
K_STA10:
    s_branch K_STA14
K_J2b58:
    v_mfma_f32_16x16x32_bf16 v[76:79], v[224:227], v[188:191], v[76:79]
    ds_read_b64_tr_b16 v[218:219], v50 offset:41984
    v_mfma_f32_16x16x32_bf16 v[92:95], v[224:227], v[192:195], v[92:95]
    ds_read_b128 v[168:171], v44 offset:45056
    v_mfma_f32_16x16x32_bf16 v[96:99], v[228:231], v[192:195], v[96:99]
    ds_read_b64_tr_b16 v[220:221], v51 offset:40960
    v_mfma_f32_16x16x32_bf16 v[100:103], v[232:235], v[192:195], v[100:103]
    ds_read_b64_tr_b16 v[222:223], v51 offset:41984
    v_mfma_f32_16x16x32_bf16 v[104:107], v[236:239], v[192:195], v[104:107]
    ds_read_b128 v[172:175], v44 offset:47104
    v_mfma_f32_16x16x32_bf16 v[120:123], v[236:239], v[196:199], v[120:123]
    ds_read_b128 v[176:179], v44 offset:49152
    v_mfma_f32_16x16x32_bf16 v[116:119], v[232:235], v[196:199], v[116:119]
    ds_read_b128 v[180:183], v44 offset:51200
    v_mfma_f32_16x16x32_bf16 v[112:115], v[228:231], v[196:199], v[112:115]
    v_mfma_f32_16x16x32_bf16 v[108:111], v[224:227], v[196:199], v[108:111]
    v_mfma_f32_16x16x32_bf16 v[124:127], v[224:227], v[200:203], v[124:127]
    v_mfma_f32_16x16x32_bf16 v[128:131], v[228:231], v[200:203], v[128:131]
    v_mfma_f32_16x16x32_bf16 v[132:135], v[232:235], v[200:203], v[132:135]
    v_mfma_f32_16x16x32_bf16 v[136:139], v[236:239], v[200:203], v[136:139]
    v_mfma_f32_16x16x32_bf16 v[152:155], v[236:239], v[204:207], v[152:155]
    v_mfma_f32_16x16x32_bf16 v[148:151], v[232:235], v[204:207], v[148:151]
    v_mfma_f32_16x16x32_bf16 v[144:147], v[228:231], v[204:207], v[144:147]
    v_mfma_f32_16x16x32_bf16 v[140:143], v[224:227], v[204:207], v[140:143]
    s_waitcnt lgkmcnt(0)
    v_mfma_f32_16x16x32_bf16 v[60:63], v[208:211], v[160:163], v[60:63]
    ds_read_b64_tr_b16 v[224:225], v48 offset:49152
    v_mfma_f32_16x16x32_bf16 v[64:67], v[212:215], v[160:163], v[64:67]
    ds_read_b64_tr_b16 v[226:227], v48 offset:50176
    v_mfma_f32_16x16x32_bf16 v[68:71], v[216:219], v[160:163], v[68:71]
    ds_read_b128 v[184:187], v45 offset:40960
    v_mfma_f32_16x16x32_bf16 v[72:75], v[220:223], v[160:163], v[72:75]
    ds_read_b64_tr_b16 v[228:229], v49 offset:49152
    v_mfma_f32_16x16x32_bf16 v[88:91], v[220:223], v[164:167], v[88:91]
    ds_read_b64_tr_b16 v[230:231], v49 offset:50176
    v_mfma_f32_16x16x32_bf16 v[84:87], v[216:219], v[164:167], v[84:87]
    ds_read_b128 v[188:191], v45 offset:43008
    v_mfma_f32_16x16x32_bf16 v[80:83], v[212:215], v[164:167], v[80:83]
    ds_read_b64_tr_b16 v[232:233], v50 offset:49152
    v_mfma_f32_16x16x32_bf16 v[76:79], v[208:211], v[164:167], v[76:79]
    ds_read_b64_tr_b16 v[234:235], v50 offset:50176
    v_mfma_f32_16x16x32_bf16 v[92:95], v[208:211], v[168:171], v[92:95]
    ds_read_b128 v[192:195], v45 offset:45056
    v_mfma_f32_16x16x32_bf16 v[96:99], v[212:215], v[168:171], v[96:99]
    ds_read_b64_tr_b16 v[236:237], v51 offset:49152
    v_mfma_f32_16x16x32_bf16 v[100:103], v[216:219], v[168:171], v[100:103]
    ds_read_b64_tr_b16 v[238:239], v51 offset:50176
    v_mfma_f32_16x16x32_bf16 v[104:107], v[220:223], v[168:171], v[104:107]
    ds_read_b128 v[196:199], v45 offset:47104
    v_mfma_f32_16x16x32_bf16 v[120:123], v[220:223], v[172:175], v[120:123]
    ds_read_b128 v[200:203], v45 offset:49152
    v_mfma_f32_16x16x32_bf16 v[116:119], v[216:219], v[172:175], v[116:119]
    ds_read_b128 v[204:207], v45 offset:51200
    v_mfma_f32_16x16x32_bf16 v[112:115], v[212:215], v[172:175], v[112:115]
    v_mfma_f32_16x16x32_bf16 v[108:111], v[208:211], v[172:175], v[108:111]
    v_mfma_f32_16x16x32_bf16 v[124:127], v[208:211], v[176:179], v[124:127]
    v_mfma_f32_16x16x32_bf16 v[128:131], v[212:215], v[176:179], v[128:131]
    v_mfma_f32_16x16x32_bf16 v[132:135], v[216:219], v[176:179], v[132:135]
    v_mfma_f32_16x16x32_bf16 v[136:139], v[220:223], v[176:179], v[136:139]
    v_mfma_f32_16x16x32_bf16 v[152:155], v[220:223], v[180:183], v[152:155]
    v_mfma_f32_16x16x32_bf16 v[148:151], v[216:219], v[180:183], v[148:151]
    v_mfma_f32_16x16x32_bf16 v[144:147], v[212:215], v[180:183], v[144:147]
    v_mfma_f32_16x16x32_bf16 v[140:143], v[208:211], v[180:183], v[140:143]
    s_waitcnt lgkmcnt(0)
    s_barrier
    v_mfma_f32_16x16x32_bf16 v[60:63], v[224:227], v[184:187], v[60:63]
    ds_read_b64_tr_b16 v[208:209], v52 offset:0
    v_mfma_f32_16x16x32_bf16 v[64:67], v[228:231], v[184:187], v[64:67]
    ds_read_b64_tr_b16 v[210:211], v52 offset:1024
    v_mfma_f32_16x16x32_bf16 v[68:71], v[232:235], v[184:187], v[68:71]
    ds_read_b128 v[160:163], v46 offset:0
    v_mfma_f32_16x16x32_bf16 v[72:75], v[236:239], v[184:187], v[72:75]
    ds_read_b64_tr_b16 v[212:213], v53 offset:0
    v_mfma_f32_16x16x32_bf16 v[88:91], v[236:239], v[188:191], v[88:91]
    ds_read_b64_tr_b16 v[214:215], v53 offset:1024
    v_mfma_f32_16x16x32_bf16 v[84:87], v[232:235], v[188:191], v[84:87]
    ds_read_b128 v[164:167], v46 offset:2048
    v_mfma_f32_16x16x32_bf16 v[80:83], v[228:231], v[188:191], v[80:83]
    ds_read_b64_tr_b16 v[216:217], v54 offset:0
    v_mfma_f32_16x16x32_bf16 v[76:79], v[224:227], v[188:191], v[76:79]
    ds_read_b64_tr_b16 v[218:219], v54 offset:1024
    v_mfma_f32_16x16x32_bf16 v[92:95], v[224:227], v[192:195], v[92:95]
    ds_read_b128 v[168:171], v46 offset:4096
    v_mfma_f32_16x16x32_bf16 v[96:99], v[228:231], v[192:195], v[96:99]
    ds_read_b64_tr_b16 v[220:221], v55 offset:0
    v_mfma_f32_16x16x32_bf16 v[100:103], v[232:235], v[192:195], v[100:103]
    ds_read_b64_tr_b16 v[222:223], v55 offset:1024
    v_mfma_f32_16x16x32_bf16 v[104:107], v[236:239], v[192:195], v[104:107]
    ds_read_b128 v[172:175], v46 offset:6144
    v_mfma_f32_16x16x32_bf16 v[120:123], v[236:239], v[196:199], v[120:123]
    ds_read_b128 v[176:179], v46 offset:8192
    v_mfma_f32_16x16x32_bf16 v[116:119], v[232:235], v[196:199], v[116:119]
    ds_read_b128 v[180:183], v46 offset:10240
    v_mfma_f32_16x16x32_bf16 v[112:115], v[228:231], v[196:199], v[112:115]
    v_mfma_f32_16x16x32_bf16 v[108:111], v[224:227], v[196:199], v[108:111]
    v_mfma_f32_16x16x32_bf16 v[124:127], v[224:227], v[200:203], v[124:127]
    v_mfma_f32_16x16x32_bf16 v[128:131], v[228:231], v[200:203], v[128:131]
    v_mfma_f32_16x16x32_bf16 v[132:135], v[232:235], v[200:203], v[132:135]
    v_mfma_f32_16x16x32_bf16 v[136:139], v[236:239], v[200:203], v[136:139]
    v_mfma_f32_16x16x32_bf16 v[152:155], v[236:239], v[204:207], v[152:155]
    v_mfma_f32_16x16x32_bf16 v[148:151], v[232:235], v[204:207], v[148:151]
    v_mfma_f32_16x16x32_bf16 v[144:147], v[228:231], v[204:207], v[144:147]
    v_mfma_f32_16x16x32_bf16 v[140:143], v[224:227], v[204:207], v[140:143]
    s_waitcnt lgkmcnt(0)
    v_mfma_f32_16x16x32_bf16 v[60:63], v[208:211], v[160:163], v[60:63]
    ds_read_b64_tr_b16 v[224:225], v52 offset:8192
    v_mfma_f32_16x16x32_bf16 v[64:67], v[212:215], v[160:163], v[64:67]
    ds_read_b64_tr_b16 v[226:227], v52 offset:9216
    v_mfma_f32_16x16x32_bf16 v[68:71], v[216:219], v[160:163], v[68:71]
    ds_read_b128 v[184:187], v47 offset:0
    v_mfma_f32_16x16x32_bf16 v[72:75], v[220:223], v[160:163], v[72:75]
    ds_read_b64_tr_b16 v[228:229], v53 offset:8192
    v_mfma_f32_16x16x32_bf16 v[88:91], v[220:223], v[164:167], v[88:91]
    ds_read_b64_tr_b16 v[230:231], v53 offset:9216
    v_mfma_f32_16x16x32_bf16 v[84:87], v[216:219], v[164:167], v[84:87]
    ds_read_b128 v[188:191], v47 offset:2048
    v_mfma_f32_16x16x32_bf16 v[80:83], v[212:215], v[164:167], v[80:83]
    ds_read_b64_tr_b16 v[232:233], v54 offset:8192
    v_mfma_f32_16x16x32_bf16 v[76:79], v[208:211], v[164:167], v[76:79]
    ds_read_b64_tr_b16 v[234:235], v54 offset:9216
    v_mfma_f32_16x16x32_bf16 v[92:95], v[208:211], v[168:171], v[92:95]
    s_branch K_J2f1c
K_STM11:
    s_branch K_STM15
K_STA11:
    s_branch K_STA15
K_J2f1c:
    ds_read_b128 v[192:195], v47 offset:4096
    v_mfma_f32_16x16x32_bf16 v[96:99], v[212:215], v[168:171], v[96:99]
    ds_read_b64_tr_b16 v[236:237], v55 offset:8192
    v_mfma_f32_16x16x32_bf16 v[100:103], v[216:219], v[168:171], v[100:103]
    ds_read_b64_tr_b16 v[238:239], v55 offset:9216
    v_mfma_f32_16x16x32_bf16 v[104:107], v[220:223], v[168:171], v[104:107]
    ds_read_b128 v[196:199], v47 offset:6144
    v_mfma_f32_16x16x32_bf16 v[120:123], v[220:223], v[172:175], v[120:123]
    ds_read_b128 v[200:203], v47 offset:8192
    v_mfma_f32_16x16x32_bf16 v[116:119], v[216:219], v[172:175], v[116:119]
    ds_read_b128 v[204:207], v47 offset:10240
    v_mfma_f32_16x16x32_bf16 v[112:115], v[212:215], v[172:175], v[112:115]
    v_mfma_f32_16x16x32_bf16 v[108:111], v[208:211], v[172:175], v[108:111]
    v_mfma_f32_16x16x32_bf16 v[124:127], v[208:211], v[176:179], v[124:127]
    v_mfma_f32_16x16x32_bf16 v[128:131], v[212:215], v[176:179], v[128:131]
    v_mfma_f32_16x16x32_bf16 v[132:135], v[216:219], v[176:179], v[132:135]
    v_mfma_f32_16x16x32_bf16 v[136:139], v[220:223], v[176:179], v[136:139]
    v_mfma_f32_16x16x32_bf16 v[152:155], v[220:223], v[180:183], v[152:155]
    v_mfma_f32_16x16x32_bf16 v[148:151], v[216:219], v[180:183], v[148:151]
    v_mfma_f32_16x16x32_bf16 v[144:147], v[212:215], v[180:183], v[144:147]
    v_mfma_f32_16x16x32_bf16 v[140:143], v[208:211], v[180:183], v[140:143]
    s_waitcnt lgkmcnt(0)
    s_barrier
    v_mfma_f32_16x16x32_bf16 v[60:63], v[224:227], v[184:187], v[60:63]
    ds_read_b64_tr_b16 v[208:209], v48 offset:0
    v_mfma_f32_16x16x32_bf16 v[64:67], v[228:231], v[184:187], v[64:67]
    ds_read_b64_tr_b16 v[210:211], v48 offset:1024
    s_branch K_PG2
.p2align 12
K_STM12:
    s_branch K_STM16
K_STA12:
    s_branch K_STA16
K_PG2:
    v_mfma_f32_16x16x32_bf16 v[68:71], v[232:235], v[184:187], v[68:71]
    ds_read_b128 v[160:163], v44 offset:0
    v_mfma_f32_16x16x32_bf16 v[72:75], v[236:239], v[184:187], v[72:75]
    ds_read_b64_tr_b16 v[212:213], v49 offset:0
    v_mfma_f32_16x16x32_bf16 v[88:91], v[236:239], v[188:191], v[88:91]
    ds_read_b64_tr_b16 v[214:215], v49 offset:1024
    v_mfma_f32_16x16x32_bf16 v[84:87], v[232:235], v[188:191], v[84:87]
    ds_read_b128 v[164:167], v44 offset:2048
    v_mfma_f32_16x16x32_bf16 v[80:83], v[228:231], v[188:191], v[80:83]
    ds_read_b64_tr_b16 v[216:217], v50 offset:0
    v_mfma_f32_16x16x32_bf16 v[76:79], v[224:227], v[188:191], v[76:79]
    ds_read_b64_tr_b16 v[218:219], v50 offset:1024
    v_mfma_f32_16x16x32_bf16 v[92:95], v[224:227], v[192:195], v[92:95]
    ds_read_b128 v[168:171], v44 offset:4096
    v_mfma_f32_16x16x32_bf16 v[96:99], v[228:231], v[192:195], v[96:99]
    ds_read_b64_tr_b16 v[220:221], v51 offset:0
    v_mfma_f32_16x16x32_bf16 v[100:103], v[232:235], v[192:195], v[100:103]
    ds_read_b64_tr_b16 v[222:223], v51 offset:1024
    v_mfma_f32_16x16x32_bf16 v[104:107], v[236:239], v[192:195], v[104:107]
    ds_read_b128 v[172:175], v44 offset:6144
    v_mfma_f32_16x16x32_bf16 v[120:123], v[236:239], v[196:199], v[120:123]
    ds_read_b128 v[176:179], v44 offset:8192
    v_mfma_f32_16x16x32_bf16 v[116:119], v[232:235], v[196:199], v[116:119]
    ds_read_b128 v[180:183], v44 offset:10240
    v_mfma_f32_16x16x32_bf16 v[112:115], v[228:231], v[196:199], v[112:115]
    v_mfma_f32_16x16x32_bf16 v[108:111], v[224:227], v[196:199], v[108:111]
    v_mfma_f32_16x16x32_bf16 v[124:127], v[224:227], v[200:203], v[124:127]
    v_mfma_f32_16x16x32_bf16 v[128:131], v[228:231], v[200:203], v[128:131]
    v_mfma_f32_16x16x32_bf16 v[132:135], v[232:235], v[200:203], v[132:135]
    v_mfma_f32_16x16x32_bf16 v[136:139], v[236:239], v[200:203], v[136:139]
    v_mfma_f32_16x16x32_bf16 v[152:155], v[236:239], v[204:207], v[152:155]
    v_mfma_f32_16x16x32_bf16 v[148:151], v[232:235], v[204:207], v[148:151]
    v_mfma_f32_16x16x32_bf16 v[144:147], v[228:231], v[204:207], v[144:147]
    v_mfma_f32_16x16x32_bf16 v[140:143], v[224:227], v[204:207], v[140:143]
    s_waitcnt lgkmcnt(0)
    v_mfma_f32_16x16x32_bf16 v[60:63], v[208:211], v[160:163], v[60:63]
    ds_read_b64_tr_b16 v[224:225], v48 offset:8192
    v_mfma_f32_16x16x32_bf16 v[64:67], v[212:215], v[160:163], v[64:67]
    ds_read_b64_tr_b16 v[226:227], v48 offset:9216
    v_mfma_f32_16x16x32_bf16 v[68:71], v[216:219], v[160:163], v[68:71]
    ds_read_b128 v[184:187], v45 offset:0
    v_mfma_f32_16x16x32_bf16 v[72:75], v[220:223], v[160:163], v[72:75]
    ds_read_b64_tr_b16 v[228:229], v49 offset:8192
    v_mfma_f32_16x16x32_bf16 v[88:91], v[220:223], v[164:167], v[88:91]
    ds_read_b64_tr_b16 v[230:231], v49 offset:9216
    v_mfma_f32_16x16x32_bf16 v[84:87], v[216:219], v[164:167], v[84:87]
    ds_read_b128 v[188:191], v45 offset:2048
    v_mfma_f32_16x16x32_bf16 v[80:83], v[212:215], v[164:167], v[80:83]
    ds_read_b64_tr_b16 v[232:233], v50 offset:8192
    v_mfma_f32_16x16x32_bf16 v[76:79], v[208:211], v[164:167], v[76:79]
    ds_read_b64_tr_b16 v[234:235], v50 offset:9216
    v_mfma_f32_16x16x32_bf16 v[92:95], v[208:211], v[168:171], v[92:95]
    ds_read_b128 v[192:195], v45 offset:4096
    v_mfma_f32_16x16x32_bf16 v[96:99], v[212:215], v[168:171], v[96:99]
    ds_read_b64_tr_b16 v[236:237], v51 offset:8192
    v_mfma_f32_16x16x32_bf16 v[100:103], v[216:219], v[168:171], v[100:103]
    ds_read_b64_tr_b16 v[238:239], v51 offset:9216
    v_mfma_f32_16x16x32_bf16 v[104:107], v[220:223], v[168:171], v[104:107]
    ds_read_b128 v[196:199], v45 offset:6144
    v_mfma_f32_16x16x32_bf16 v[120:123], v[220:223], v[172:175], v[120:123]
    ds_read_b128 v[200:203], v45 offset:8192
    v_mfma_f32_16x16x32_bf16 v[116:119], v[216:219], v[172:175], v[116:119]
    ds_read_b128 v[204:207], v45 offset:10240
    v_mfma_f32_16x16x32_bf16 v[112:115], v[212:215], v[172:175], v[112:115]
    v_mfma_f32_16x16x32_bf16 v[108:111], v[208:211], v[172:175], v[108:111]
    v_mfma_f32_16x16x32_bf16 v[124:127], v[208:211], v[176:179], v[124:127]
    v_mfma_f32_16x16x32_bf16 v[128:131], v[212:215], v[176:179], v[128:131]
    v_mfma_f32_16x16x32_bf16 v[132:135], v[216:219], v[176:179], v[132:135]
    v_mfma_f32_16x16x32_bf16 v[136:139], v[220:223], v[176:179], v[136:139]
    v_mfma_f32_16x16x32_bf16 v[152:155], v[220:223], v[180:183], v[152:155]
    v_mfma_f32_16x16x32_bf16 v[148:151], v[216:219], v[180:183], v[148:151]
    v_mfma_f32_16x16x32_bf16 v[144:147], v[212:215], v[180:183], v[144:147]
    v_mfma_f32_16x16x32_bf16 v[140:143], v[208:211], v[180:183], v[140:143]
    s_waitcnt lgkmcnt(0)
    s_barrier
    v_mfma_f32_16x16x32_bf16 v[60:63], v[224:227], v[184:187], v[60:63]
    ds_read_b64_tr_b16 v[208:209], v48 offset:40960
    v_mfma_f32_16x16x32_bf16 v[64:67], v[228:231], v[184:187], v[64:67]
    ds_read_b64_tr_b16 v[210:211], v48 offset:41984
    v_mfma_f32_16x16x32_bf16 v[68:71], v[232:235], v[184:187], v[68:71]
    ds_read_b128 v[160:163], v44 offset:40960
    v_mfma_f32_16x16x32_bf16 v[72:75], v[236:239], v[184:187], v[72:75]
    ds_read_b64_tr_b16 v[212:213], v49 offset:40960
    v_mfma_f32_16x16x32_bf16 v[88:91], v[236:239], v[188:191], v[88:91]
    ds_read_b64_tr_b16 v[214:215], v49 offset:41984
    v_mfma_f32_16x16x32_bf16 v[84:87], v[232:235], v[188:191], v[84:87]
    ds_read_b128 v[164:167], v44 offset:43008
    v_mfma_f32_16x16x32_bf16 v[80:83], v[228:231], v[188:191], v[80:83]
    ds_read_b64_tr_b16 v[216:217], v50 offset:40960
    v_mfma_f32_16x16x32_bf16 v[76:79], v[224:227], v[188:191], v[76:79]
    ds_read_b64_tr_b16 v[218:219], v50 offset:41984
    v_mfma_f32_16x16x32_bf16 v[92:95], v[224:227], v[192:195], v[92:95]
    ds_read_b128 v[168:171], v44 offset:45056
    v_mfma_f32_16x16x32_bf16 v[96:99], v[228:231], v[192:195], v[96:99]
    ds_read_b64_tr_b16 v[220:221], v51 offset:40960
    v_mfma_f32_16x16x32_bf16 v[100:103], v[232:235], v[192:195], v[100:103]
    ds_read_b64_tr_b16 v[222:223], v51 offset:41984
    v_mfma_f32_16x16x32_bf16 v[104:107], v[236:239], v[192:195], v[104:107]
    ds_read_b128 v[172:175], v44 offset:47104
    v_mfma_f32_16x16x32_bf16 v[120:123], v[236:239], v[196:199], v[120:123]
    ds_read_b128 v[176:179], v44 offset:49152
    v_mfma_f32_16x16x32_bf16 v[116:119], v[232:235], v[196:199], v[116:119]
    ds_read_b128 v[180:183], v44 offset:51200
    v_mfma_f32_16x16x32_bf16 v[112:115], v[228:231], v[196:199], v[112:115]
    v_mfma_f32_16x16x32_bf16 v[108:111], v[224:227], v[196:199], v[108:111]
    v_mfma_f32_16x16x32_bf16 v[124:127], v[224:227], v[200:203], v[124:127]
    v_mfma_f32_16x16x32_bf16 v[128:131], v[228:231], v[200:203], v[128:131]
    v_mfma_f32_16x16x32_bf16 v[132:135], v[232:235], v[200:203], v[132:135]
    v_mfma_f32_16x16x32_bf16 v[136:139], v[236:239], v[200:203], v[136:139]
    v_mfma_f32_16x16x32_bf16 v[152:155], v[236:239], v[204:207], v[152:155]
    v_mfma_f32_16x16x32_bf16 v[148:151], v[232:235], v[204:207], v[148:151]
    v_mfma_f32_16x16x32_bf16 v[144:147], v[228:231], v[204:207], v[144:147]
    v_mfma_f32_16x16x32_bf16 v[140:143], v[224:227], v[204:207], v[140:143]
    s_waitcnt lgkmcnt(0)
    v_mfma_f32_16x16x32_bf16 v[60:63], v[208:211], v[160:163], v[60:63]
    ds_read_b64_tr_b16 v[224:225], v48 offset:49152
    v_mfma_f32_16x16x32_bf16 v[64:67], v[212:215], v[160:163], v[64:67]
    ds_read_b64_tr_b16 v[226:227], v48 offset:50176
    v_mfma_f32_16x16x32_bf16 v[68:71], v[216:219], v[160:163], v[68:71]
    ds_read_b128 v[184:187], v45 offset:40960
    v_mfma_f32_16x16x32_bf16 v[72:75], v[220:223], v[160:163], v[72:75]
    ds_read_b64_tr_b16 v[228:229], v49 offset:49152
    s_branch K_J33c8
K_STM13:
    s_branch K_STM17
K_STA13:
    s_branch K_STA17
K_J33c8:
    v_mfma_f32_16x16x32_bf16 v[76:79], v[208:211], v[164:167], v[76:79]
    ds_read_b64_tr_b16 v[230:231], v49 offset:50176
    v_mfma_f32_16x16x32_bf16 v[80:83], v[212:215], v[164:167], v[80:83]
    ds_read_b128 v[188:191], v45 offset:43008
    v_mfma_f32_16x16x32_bf16 v[84:87], v[216:219], v[164:167], v[84:87]
    ds_read_b64_tr_b16 v[232:233], v50 offset:49152
    v_mfma_f32_16x16x32_bf16 v[88:91], v[220:223], v[164:167], v[88:91]
    ds_read_b64_tr_b16 v[234:235], v50 offset:50176
    v_mfma_f32_16x16x32_bf16 v[92:95], v[208:211], v[168:171], v[92:95]
    ds_read_b128 v[192:195], v45 offset:45056
    v_mfma_f32_16x16x32_bf16 v[96:99], v[212:215], v[168:171], v[96:99]
    ds_read_b64_tr_b16 v[236:237], v51 offset:49152
    v_mfma_f32_16x16x32_bf16 v[100:103], v[216:219], v[168:171], v[100:103]
    ds_read_b64_tr_b16 v[238:239], v51 offset:50176
    v_mfma_f32_16x16x32_bf16 v[104:107], v[220:223], v[168:171], v[104:107]
    ds_read_b128 v[196:199], v45 offset:47104
    v_mfma_f32_16x16x32_bf16 v[108:111], v[208:211], v[172:175], v[108:111]
    ds_read_b128 v[200:203], v45 offset:49152
    v_mfma_f32_16x16x32_bf16 v[112:115], v[212:215], v[172:175], v[112:115]
    ds_read_b128 v[204:207], v45 offset:51200
    v_mfma_f32_16x16x32_bf16 v[116:119], v[216:219], v[172:175], v[116:119]
    v_mfma_f32_16x16x32_bf16 v[120:123], v[220:223], v[172:175], v[120:123]
    s_waitcnt lgkmcnt(0)
    v_mfma_f32_16x16x32_bf16 v[60:63], v[224:227], v[184:187], v[60:63]
    v_mfma_f32_16x16x32_bf16 v[64:67], v[228:231], v[184:187], v[64:67]
    v_mfma_f32_16x16x32_bf16 v[68:71], v[232:235], v[184:187], v[68:71]
    v_mfma_f32_16x16x32_bf16 v[72:75], v[236:239], v[184:187], v[72:75]
    v_mfma_f32_16x16x32_bf16 v[76:79], v[224:227], v[188:191], v[76:79]
    v_mfma_f32_16x16x32_bf16 v[80:83], v[228:231], v[188:191], v[80:83]
    v_mfma_f32_16x16x32_bf16 v[84:87], v[232:235], v[188:191], v[84:87]
    v_mfma_f32_16x16x32_bf16 v[88:91], v[236:239], v[188:191], v[88:91]
    v_mfma_f32_16x16x32_bf16 v[92:95], v[224:227], v[192:195], v[92:95]
    v_cvt_pk_bf16_f32 v240, v60, v61
    v_cvt_pk_bf16_f32 v241, v62, v63
    ds_write_b64 v56, v[240:241] offset:0
    v_mfma_f32_16x16x32_bf16 v[96:99], v[228:231], v[192:195], v[96:99]
    v_cvt_pk_bf16_f32 v242, v64, v65
    v_cvt_pk_bf16_f32 v243, v66, v67
    ds_write_b64 v56, v[242:243] offset:32
    v_mfma_f32_16x16x32_bf16 v[100:103], v[232:235], v[192:195], v[100:103]
    v_cvt_pk_bf16_f32 v244, v68, v69
    v_cvt_pk_bf16_f32 v245, v70, v71
    ds_write_b64 v56, v[244:245] offset:64
    v_mfma_f32_16x16x32_bf16 v[104:107], v[236:239], v[192:195], v[104:107]
    v_cvt_pk_bf16_f32 v246, v72, v73
    v_cvt_pk_bf16_f32 v247, v74, v75
    ds_write_b64 v56, v[246:247] offset:96
    v_mfma_f32_16x16x32_bf16 v[108:111], v[224:227], v[196:199], v[108:111]
    v_cvt_pk_bf16_f32 v240, v76, v77
    v_cvt_pk_bf16_f32 v241, v78, v79
    ds_write_b64 v56, v[240:241] offset:4352
    v_mfma_f32_16x16x32_bf16 v[112:115], v[228:231], v[196:199], v[112:115]
    v_cvt_pk_bf16_f32 v242, v80, v81
    v_cvt_pk_bf16_f32 v243, v82, v83
    ds_write_b64 v56, v[242:243] offset:4384
    v_mfma_f32_16x16x32_bf16 v[116:119], v[232:235], v[196:199], v[116:119]
    v_cvt_pk_bf16_f32 v244, v84, v85
    v_cvt_pk_bf16_f32 v245, v86, v87
    ds_write_b64 v56, v[244:245] offset:4416
    v_mfma_f32_16x16x32_bf16 v[120:123], v[236:239], v[196:199], v[120:123]
    v_cvt_pk_bf16_f32 v246, v88, v89
    v_cvt_pk_bf16_f32 v247, v90, v91
    ds_write_b64 v56, v[246:247] offset:4448
    v_mfma_f32_16x16x32_bf16 v[124:127], v[208:211], v[176:179], v[124:127]
    v_cvt_pk_bf16_f32 v240, v92, v93
    v_cvt_pk_bf16_f32 v241, v94, v95
    ds_write_b64 v56, v[240:241] offset:8704
    v_mfma_f32_16x16x32_bf16 v[128:131], v[212:215], v[176:179], v[128:131]
    v_cvt_pk_bf16_f32 v242, v96, v97
    v_cvt_pk_bf16_f32 v243, v98, v99
    ds_write_b64 v56, v[242:243] offset:8736
    v_mfma_f32_16x16x32_bf16 v[132:135], v[216:219], v[176:179], v[132:135]
    v_cvt_pk_bf16_f32 v244, v100, v101
    v_cvt_pk_bf16_f32 v245, v102, v103
    ds_write_b64 v56, v[244:245] offset:8768
    v_mfma_f32_16x16x32_bf16 v[136:139], v[220:223], v[176:179], v[136:139]
    v_cvt_pk_bf16_f32 v246, v104, v105
    v_cvt_pk_bf16_f32 v247, v106, v107
    ds_write_b64 v56, v[246:247] offset:8800
    v_mfma_f32_16x16x32_bf16 v[124:127], v[224:227], v[200:203], v[124:127]
    v_cvt_pk_bf16_f32 v240, v108, v109
    v_cvt_pk_bf16_f32 v241, v110, v111
    ds_write_b64 v56, v[240:241] offset:13056
    v_mfma_f32_16x16x32_bf16 v[128:131], v[228:231], v[200:203], v[128:131]
    v_cvt_pk_bf16_f32 v242, v112, v113
    v_cvt_pk_bf16_f32 v243, v114, v115
    ds_write_b64 v56, v[242:243] offset:13088
    v_mfma_f32_16x16x32_bf16 v[132:135], v[232:235], v[200:203], v[132:135]
    v_cvt_pk_bf16_f32 v244, v116, v117
    v_cvt_pk_bf16_f32 v245, v118, v119
    ds_write_b64 v56, v[244:245] offset:13120
    v_mfma_f32_16x16x32_bf16 v[136:139], v[236:239], v[200:203], v[136:139]
    v_cvt_pk_bf16_f32 v246, v120, v121
    v_cvt_pk_bf16_f32 v247, v122, v123
    ds_write_b64 v56, v[246:247] offset:13152
    v_mfma_f32_16x16x32_bf16 v[140:143], v[208:211], v[180:183], v[140:143]
    v_cvt_pk_bf16_f32 v240, v124, v125
    v_cvt_pk_bf16_f32 v241, v126, v127
    ds_write_b64 v56, v[240:241] offset:17408
    v_mfma_f32_16x16x32_bf16 v[144:147], v[212:215], v[180:183], v[144:147]
    v_cvt_pk_bf16_f32 v242, v128, v129
    v_cvt_pk_bf16_f32 v243, v130, v131
    ds_write_b64 v56, v[242:243] offset:17440
    v_mfma_f32_16x16x32_bf16 v[148:151], v[216:219], v[180:183], v[148:151]
    v_cvt_pk_bf16_f32 v244, v132, v133
    v_cvt_pk_bf16_f32 v245, v134, v135
    ds_write_b64 v56, v[244:245] offset:17472
    v_mfma_f32_16x16x32_bf16 v[152:155], v[220:223], v[180:183], v[152:155]
    v_cvt_pk_bf16_f32 v246, v136, v137
    v_cvt_pk_bf16_f32 v247, v138, v139
    ds_write_b64 v56, v[246:247] offset:17504
    v_mfma_f32_16x16x32_bf16 v[140:143], v[224:227], v[204:207], v[140:143]
    v_mfma_f32_16x16x32_bf16 v[144:147], v[228:231], v[204:207], v[144:147]
    v_mfma_f32_16x16x32_bf16 v[148:151], v[232:235], v[204:207], v[148:151]
    v_mfma_f32_16x16x32_bf16 v[152:155], v[236:239], v[204:207], v[152:155]
    s_nop 7
    v_cvt_pk_bf16_f32 v240, v140, v141
    v_cvt_pk_bf16_f32 v241, v142, v143
    ds_write_b64 v56, v[240:241] offset:21760
    v_cvt_pk_bf16_f32 v242, v144, v145
    s_branch K_J378c
K_STM14:
    s_branch K_STM18
K_STA14:
    s_branch K_STA18
K_J378c:
    v_cvt_pk_bf16_f32 v243, v146, v147
    ds_write_b64 v56, v[242:243] offset:21792
    v_cvt_pk_bf16_f32 v244, v148, v149
    v_cvt_pk_bf16_f32 v245, v150, v151
    ds_write_b64 v56, v[244:245] offset:21824
    v_cvt_pk_bf16_f32 v246, v152, v153
    v_cvt_pk_bf16_f32 v247, v154, v155
    ds_write_b64 v56, v[246:247] offset:21856
    s_waitcnt vmcnt(0) lgkmcnt(0)
    s_setprio 0
K_JOIN:
    s_barrier
    s_memrealtime s[90:91]
    ds_read_b64 v[56:57], v16 offset:0
    ds_read_b64 v[58:59], v17 offset:0
    ds_read_b64 v[44:45], v16 offset:4512
    ds_read_b64 v[46:47], v27 offset:4512
    ds_read_b64 v[60:61], v16 offset:4352
    ds_read_b64 v[62:63], v17 offset:4352
    ds_read_b64 v[48:49], v16 offset:8864
    ds_read_b64 v[50:51], v27 offset:8864
    ds_read_b64 v[64:65], v16 offset:8704
    ds_read_b64 v[66:67], v17 offset:8704
    ds_read_b64 v[52:53], v16 offset:13216
    ds_read_b64 v[54:55], v27 offset:13216
    ds_read_b64 v[68:69], v16 offset:13056
    ds_read_b64 v[70:71], v17 offset:13056
    s_waitcnt lgkmcnt(8)
    v_mfma_f32_16x16x32_bf16 v[88:91], v[56:59], v[44:47], v[36:39]
    v_mfma_f32_16x16x32_bf16 v[92:95], v[60:63], v[44:47], v[32:35]
    s_waitcnt lgkmcnt(4)
    v_mfma_f32_16x16x32_bf16 v[96:99], v[60:63], v[48:51], v[28:31]
    v_mfma_f32_16x16x32_bf16 v[100:103], v[64:67], v[48:51], v[32:35]
    s_waitcnt lgkmcnt(0)
    v_mfma_f32_16x16x32_bf16 v[104:107], v[64:67], v[52:55], v[28:31]
    v_mfma_f32_16x16x32_bf16 v[108:111], v[68:71], v[52:55], v[32:35]
    ds_read_b64_tr_b16 v[72:73], v18 offset:80
    ds_read_b64_tr_b16 v[80:81], v18 offset:112
    ds_read_b64_tr_b16 v[74:75], v18 offset:4432
    ds_read_b64_tr_b16 v[82:83], v18 offset:4464
    ds_read_b64_tr_b16 v[76:77], v18 offset:8784
    ds_read_b64_tr_b16 v[84:85], v18 offset:8816
    ds_read_b64_tr_b16 v[78:79], v18 offset:13136
    ds_read_b64_tr_b16 v[86:87], v18 offset:13168
    v_max3_f32 v148, v88, v89, v92
    v_max3_f32 v149, v90, v91, v94
    v_max_f32 v148, v148, v93
    v_max_f32 v149, v149, v95
    v_max3_f32 v150, v96, v97, v100
    v_max3_f32 v151, v98, v99, v102
    v_max_f32 v150, v150, v101
    v_max_f32 v151, v151, v103
    v_max3_f32 v152, v104, v105, v108
    v_max3_f32 v153, v106, v107, v110
    v_max_f32 v152, v152, v109
    v_max_f32 v153, v153, v111
    v_cvt_pk_bf16_f32 v149, v148, v149
    v_cvt_pk_bf16_f32 v151, v150, v151
    v_cvt_pk_bf16_f32 v153, v152, v153
    v_lshlrev_b32 v148, 16, v149
    v_and_b32 v149, 0xffff0000, v149
    v_lshlrev_b32 v150, 16, v151
    v_and_b32 v151, 0xffff0000, v151
    v_lshlrev_b32 v152, 16, v153
    v_and_b32 v153, 0xffff0000, v153
    v_pk_mul_f32 v[148:149], v[148:149], s[58:59]
    v_pk_mul_f32 v[150:151], v[150:151], s[58:59]
    v_pk_mul_f32 v[152:153], v[152:153], s[58:59]
    v_cvt_pk_bf16_f32 v149, v148, v149
    v_cvt_pk_bf16_f32 v151, v150, v151
    v_cvt_pk_bf16_f32 v153, v152, v153
    v_lshlrev_b32 v148, 16, v149
    v_and_b32 v149, 0xffff0000, v149
    v_lshlrev_b32 v150, 16, v151
    v_and_b32 v151, 0xffff0000, v151
    v_lshlrev_b32 v152, 16, v153
    v_and_b32 v153, 0xffff0000, v153
    v_max_f32 v154, v148, v149
    v_max_f32 v156, v150, v151
    v_max_f32 v158, v152, v153
    v_mov_b32 v168, v158
    v_permlane16_swap_b32 v154, v156
    s_nop 0
    v_permlane16_swap_b32 v158, v168
    v_max_f32 v154, v154, v156
    v_max_f32 v158, v158, v168
    v_mov_b32 v156, v154
    v_mov_b32 v168, v158
    s_nop 0
    v_permlane32_swap_b32 v154, v156
    v_permlane32_swap_b32 v158, v168
    v_max_f32 v154, v154, v156
    v_mov_b32 v156, v154
    v_max_f32 v158, v158, v168
    s_nop 0
    v_permlane16_swap_b32 v154, v156
    v_pk_add_f32 v[148:149], v[148:149], v[154:155] op_sel_hi:[1,0] neg_lo:[0,1] neg_hi:[0,1]
    v_pk_add_f32 v[150:151], v[150:151], v[156:157] op_sel_hi:[1,0] neg_lo:[0,1] neg_hi:[0,1]
    v_pk_add_f32 v[152:153], v[152:153], v[158:159] op_sel_hi:[1,0] neg_lo:[0,1] neg_hi:[0,1]
    v_pk_mul_f32 v[148:149], v[148:149], s[56:57]
    v_pk_mul_f32 v[150:151], v[150:151], s[56:57]
    v_pk_mul_f32 v[152:153], v[152:153], s[56:57]
    v_exp_f32 v148, v148
    v_exp_f32 v149, v149
    v_exp_f32 v150, v150
    v_exp_f32 v151, v151
    v_exp_f32 v152, v152
    v_exp_f32 v153, v153
    s_nop 0
    v_add_f32 v160, v148, v149
    v_add_f32 v162, v150, v151
    v_add_f32 v164, v152, v153
    v_mov_b32 v168, v164
    v_permlane16_swap_b32 v160, v162
    s_nop 0
    v_permlane16_swap_b32 v164, v168
    v_add_f32 v160, v160, v162
    v_add_f32 v164, v164, v168
    v_mov_b32 v162, v160
    v_mov_b32 v168, v164
    s_nop 0
    v_permlane32_swap_b32 v160, v162
    v_permlane32_swap_b32 v164, v168
    v_add_f32 v160, v160, v162
    v_mov_b32 v162, v160
    v_add_f32 v164, v164, v168
    s_nop 0
    v_permlane16_swap_b32 v160, v162
    v_rcp_f32 v160, v160
    v_rcp_f32 v162, v162
    v_rcp_f32 v164, v164
    s_waitcnt lgkmcnt(0)
    v_pk_mul_f32 v[148:149], v[148:149], v[160:161] op_sel_hi:[1,0]
    v_pk_mul_f32 v[150:151], v[150:151], v[162:163] op_sel_hi:[1,0]
    v_pk_mul_f32 v[152:153], v[152:153], v[164:165] op_sel_hi:[1,0]
    v_cvt_pk_bf16_f32 v148, v148, v149
    v_cvt_pk_bf16_f32 v150, v150, v151
    v_cvt_pk_bf16_f32 v152, v152, v153
    v_perm_b32 v112, v148, v148, v40
    v_perm_b32 v113, v148, v148, v41
    v_perm_b32 v114, v148, v148, v42
    v_perm_b32 v115, v148, v148, v43
    v_perm_b32 v116, v150, v150, v40
    v_perm_b32 v117, v150, v150, v41
    v_perm_b32 v118, v150, v150, v42
    v_perm_b32 v119, v150, v150, v43
    v_mfma_f32_16x16x32_bf16 v[124:127], v[72:75], v[112:115], 0
    v_mfma_f32_16x16x32_bf16 v[128:131], v[80:83], v[112:115], 0
    v_perm_b32 v120, v152, v152, v40
    v_perm_b32 v121, v152, v152, v41
    v_perm_b32 v122, v152, v152, v42
    v_perm_b32 v123, v152, v152, v43
    v_mfma_f32_16x16x32_bf16 v[132:135], v[74:77], v[116:119], 0
    v_mfma_f32_16x16x32_bf16 v[136:139], v[82:85], v[116:119], 0
    s_branch K_J3b54
K_STM15:
    s_branch K_STM19
K_STA15:
    s_branch K_STA19
K_J3b54:
    s_nop 0
    v_mfma_f32_16x16x32_bf16 v[140:143], v[76:79], v[120:123], 0
    v_mfma_f32_16x16x32_bf16 v[144:147], v[84:87], v[120:123], 0
    s_nop 1
    v_cvt_pk_bf16_f32 v172, v124, v125
    v_cvt_pk_bf16_f32 v173, v126, v127
    v_cvt_pk_bf16_f32 v174, v128, v129
    v_cvt_pk_bf16_f32 v175, v130, v131
    ds_write_b64 v24, v[172:173] offset:0
    v_cvt_pk_bf16_f32 v176, v132, v133
    v_cvt_pk_bf16_f32 v177, v134, v135
    v_cvt_pk_bf16_f32 v178, v136, v137
    v_cvt_pk_bf16_f32 v179, v138, v139
    ds_write_b64 v24, v[176:177] offset:1024
    v_cvt_pk_bf16_f32 v180, v140, v141
    v_cvt_pk_bf16_f32 v181, v142, v143
    v_cvt_pk_bf16_f32 v182, v144, v145
    v_cvt_pk_bf16_f32 v183, v146, v147
    ds_write_b64 v24, v[180:181] offset:2048
    s_mov_b64 exec, s[54:55]
    ds_write_b64 v25, v[174:175] offset:0
    ds_write_b64 v25, v[178:179] offset:256
    ds_write_b64 v25, v[182:183] offset:512
    s_mov_b64 exec, -1
    s_waitcnt lgkmcnt(0)
    s_barrier
    ds_read_b128 v[172:175], v26
    ds_read_b128 v[176:179], v26 offset:8192
    s_waitcnt lgkmcnt(1)
    buffer_store_dwordx4 v[172:175], v19, s[20:23], s60 offen sc1
    s_waitcnt lgkmcnt(0)
    buffer_store_dwordx4 v[176:179], v20, s[20:23], s60 offen sc1
K_ATT_DONE:
    s_memrealtime s[92:93]
    s_cmp_eq_u32 s34, -1
    s_cbranch_scc1 K_NOS6
    s_cmp_lt_u32 s30, 4
    s_cbranch_scc1 K_P2_EARLY
    s_cmp_lg_u32 s30, 6
    s_cbranch_scc1 K_NOS6
    v_mov_b32 v4, 192
    s_mov_b32 s3, 131072
K_ZPOLL2:
    v_readfirstlane_b32 s33, v7
    s_nop 3
    s_sub_u32 s3, s3, 1
    s_cselect_b32 s33, 1, s33
    s_cmp_lg_u32 s33, 0
    s_cbranch_scc1 K_ZOK2
    global_load_dword v7, v4, s[4:5] sc1
    s_waitcnt vmcnt(0)
    s_branch K_ZPOLL2
K_ZOK2:
    v_min_u32 v2, 23, v1
    v_lshl_add_u32 v2, v2, 2, s42
    global_load_dword v7, v2, s[6:7] offset:128 sc1
K_NOS6:
    s_cmp_lg_u32 s30, 5
    s_cbranch_scc1 K_NOFL
    v_mov_b32 v4, 192
    s_mov_b32 s3, 131072
K_ZPOLL0:
    v_readfirstlane_b32 s33, v7
    s_nop 3
    s_sub_u32 s3, s3, 1
    s_cselect_b32 s33, 1, s33
    s_cmp_lg_u32 s33, 0
    s_cbranch_scc1 K_ZOK0
    global_load_dword v7, v4, s[4:5] sc1
    s_waitcnt vmcnt(0)
    s_branch K_ZPOLL0
K_ZOK0:
    v_mov_b32 v3, 1
    s_mov_b32 exec_lo, s36
    s_mov_b32 exec_hi, 0
    s_setprio 3
    s_waitcnt vmcnt(0)
    s_barrier
    global_store_dword v23, v3, s[6:7] sc1
    s_setprio 0
    s_mov_b64 exec, -1
    s_branch K_FLAGGED
K_NOFL:
    s_waitcnt vmcnt(0)
    s_barrier
K_FLAGGED:
    s_cmp_eq_u32 s34, -1
    s_cbranch_scc1 K_END
    s_cmp_ge_u32 s30, 6
    s_cbranch_scc1 K_P2_HELP
    v_lshrrev_b32 v2, 3, v1
    v_mul_u32_u24 v2, 1280, v2
    v_lshrrev_b32 v3, 4, v1
    v_lshlrev_b32 v3, 1, v3
    v_and_b32 v4, 7, v1
    v_xor_b32 v3, v3, v4
    v_lshl_add_u32 v2, v3, 4, v2
    s_lshl_b32 s33, s41, 7
    v_add_u32 v22, s33, v2
    s_sub_u32 s53, s30, 4
    s_lshl_b32 s60, s53, 2
    s_lshr_b32 s60, 0x6431, s60
    s_and_b32 s60, s60, 7
    s_mul_i32 s60, s60, 51200
    s_mul_i32 s61, s53, 5120
    s_add_u32 s3, s60, 0
    s_add_u32 m0, s61, 40960
    s_waitcnt vmcnt(13)
    buffer_load_dwordx4 v22, s[24:27], s3 offen lds
    s_add_u32 s3, s60, 10240
    s_add_u32 m0, s61, 41984
    s_waitcnt vmcnt(13)
    buffer_load_dwordx4 v22, s[24:27], s3 offen lds
    s_add_u32 s3, s60, 20480
    s_add_u32 m0, s61, 43008
    s_waitcnt vmcnt(13)
    buffer_load_dwordx4 v22, s[24:27], s3 offen lds
    s_add_u32 s3, s60, 30720
    s_add_u32 m0, s61, 44032
    s_waitcnt vmcnt(13)
    buffer_load_dwordx4 v22, s[24:27], s3 offen lds
    s_add_u32 s3, s60, 40960
    s_add_u32 m0, s61, 45056
    s_waitcnt vmcnt(13)
    buffer_load_dwordx4 v22, s[24:27], s3 offen lds
    s_add_u32 s3, s60, 409600
    s_add_u32 m0, s61, 61440
    s_waitcnt vmcnt(13)
    buffer_load_dwordx4 v22, s[24:27], s3 offen lds
    s_add_u32 s3, s60, 419840
    s_add_u32 m0, s61, 62464
    s_waitcnt vmcnt(13)
    buffer_load_dwordx4 v22, s[24:27], s3 offen lds
    s_add_u32 s3, s60, 430080
    s_add_u32 m0, s61, 63488
    s_waitcnt vmcnt(13)
    buffer_load_dwordx4 v22, s[24:27], s3 offen lds
    s_add_u32 s3, s60, 440320
    s_add_u32 m0, s61, 64512
    s_waitcnt vmcnt(13)
    buffer_load_dwordx4 v22, s[24:27], s3 offen lds
    s_add_u32 s3, s60, 450560
    s_add_u32 m0, s61, 65536
    s_waitcnt vmcnt(13)
    buffer_load_dwordx4 v22, s[24:27], s3 offen lds
    s_add_u32 s53, s53, 2
    s_lshl_b32 s60, s53, 2
    s_lshr_b32 s60, 0x6431, s60
    s_and_b32 s60, s60, 7
    s_mul_i32 s60, s60, 51200
    s_mul_i32 s61, s53, 5120
    s_add_u32 s3, s60, 0
    s_add_u32 m0, s61, 40960
    s_waitcnt vmcnt(13)
    buffer_load_dwordx4 v22, s[24:27], s3 offen lds
    s_add_u32 s3, s60, 10240
    s_add_u32 m0, s61, 41984
    s_waitcnt vmcnt(13)
    buffer_load_dwordx4 v22, s[24:27], s3 offen lds
    s_add_u32 s3, s60, 20480
    s_add_u32 m0, s61, 43008
    s_waitcnt vmcnt(13)
    buffer_load_dwordx4 v22, s[24:27], s3 offen lds
    s_add_u32 s3, s60, 30720
    s_add_u32 m0, s61, 44032
    s_branch K_J3f18
K_STM16:
    s_branch K_STM20
K_STA16:
    s_branch K_STA20
K_J3f18:
    s_waitcnt vmcnt(13)
    buffer_load_dwordx4 v22, s[24:27], s3 offen lds
    s_add_u32 s3, s60, 40960
    s_add_u32 m0, s61, 45056
    s_waitcnt vmcnt(13)
    buffer_load_dwordx4 v22, s[24:27], s3 offen lds
    s_add_u32 s3, s60, 409600
    s_add_u32 m0, s61, 61440
    s_waitcnt vmcnt(13)
    buffer_load_dwordx4 v22, s[24:27], s3 offen lds
    s_add_u32 s3, s60, 419840
    s_add_u32 m0, s61, 62464
    s_waitcnt vmcnt(13)
    buffer_load_dwordx4 v22, s[24:27], s3 offen lds
    s_add_u32 s3, s60, 430080
    s_add_u32 m0, s61, 63488
    s_waitcnt vmcnt(13)
    buffer_load_dwordx4 v22, s[24:27], s3 offen lds
    s_add_u32 s3, s60, 440320
    s_add_u32 m0, s61, 64512
    s_waitcnt vmcnt(13)
    buffer_load_dwordx4 v22, s[24:27], s3 offen lds
    s_add_u32 s3, s60, 450560
    s_add_u32 m0, s61, 65536
    s_waitcnt vmcnt(13)
    buffer_load_dwordx4 v22, s[24:27], s3 offen lds
    v_mov_b32 v2, 158720
    v_mov_b32 v3, 2
    s_waitcnt vmcnt(0)
    s_mov_b64 exec, 1
    ds_add_u32 v2, v3 offset:44
    s_mov_b64 exec, -1
    s_branch K_P2_HELP
K_P2_EARLY:
    s_branch K_PG3
.p2align 12
K_STM17:
    s_branch K_STM21
K_CHA0:
K_STA17:
    s_branch K_STA21
K_PG3:
    s_lshl_b32 s54, s40, 7
    v_lshrrev_b32 v8, 3, v1
    v_lshrrev_b32 v9, 4, v1
    v_mov_b32 v15, 158720
    s_lshl_b32 s53, s40, 3
    s_add_u32 s53, s53, s30
    s_mul_i32 s3, s53, 20480
    s_lshl_b32 s33, s41, 7
    s_add_u32 s3, s3, s33
    v_and_b32 v2, 7, v1
    v_lshlrev_b32 v2, 4, v2
    v_mul_u32_u24 v4, 1280, v8
    v_add3_u32 v10, v2, v4, s3
    s_lshl_b32 s3, s53, 6
    v_lshl_add_u32 v11, v8, 2, s3
    s_mov_b32 s55, 10240
    s_add_u32 s20, s6, 0x100000
    s_addc_u32 s21, s7, 0
    s_mov_b32 s22, 0x280000
    s_mov_b32 s23, 0x20000
    s_add_u32 s16, s6, 0x1000
    s_addc_u32 s17, s7, 0
    s_mov_b32 s18, 0x2000
    s_mov_b32 s19, 0x20000
    s_mov_b32 s48, s10
    s_mov_b32 s49, s11
    s_mov_b32 s50, 0x280000
    s_mov_b32 s51, 0x20000
    v_mul_u32_u24 v3, 144, v8
    v_add_u32 v3, v2, v3
    s_mul_i32 s3, s30, 2304
    s_add_u32 s3, s3, 140288
    v_add_u32 v14, s3, v3
    v_bfe_u32 v50, v1, 2, 2
    v_and_b32 v51, 3, v1
    s_add_u32 s3, s53, s30
    s_mul_i32 s3, s3, 20480
    v_lshl_add_u32 v54, v1, 4, s3
    v_add_u32 v55, 20480, v54
    v_lshl_add_u32 v2, v9, 2, v50
    v_bfe_u32 v3, v2, 1, 2
    v_lshlrev_b32 v2, 7, v2
    v_lshl_add_u32 v2, v51, 3, v2
    v_xor_b32 v4, 0, v3
    v_lshl_add_u32 v56, v4, 5, v2
    v_add_u32 v60, 40960, v56
    v_xor_b32 v4, 1, v3
    v_lshl_add_u32 v57, v4, 5, v2
    v_add_u32 v61, 40960, v57
    v_xor_b32 v4, 2, v3
    v_lshl_add_u32 v58, v4, 5, v2
    v_add_u32 v62, 40960, v58
    v_xor_b32 v4, 3, v3
    v_lshl_add_u32 v59, v4, 5, v2
    v_add_u32 v63, 40960, v59
    v_lshrrev_b32 v3, 1, v50
    v_mul_u32_u24 v2, 40, v9
    v_add3_u32 v2, v2, 16, v50
    v_lshlrev_b32 v2, 7, v2
    v_lshl_add_u32 v2, v51, 3, v2
    v_xor_b32 v4, 0, v3
    v_lshl_add_u32 v64, v4, 5, v2
    v_xor_b32 v4, 1, v3
    v_lshl_add_u32 v65, v4, 5, v2
    v_xor_b32 v4, 2, v3
    v_lshl_add_u32 v66, v4, 5, v2
    v_xor_b32 v4, 3, v3
    v_lshl_add_u32 v67, v4, 5, v2
    v_and_b32 v2, 15, v1
    v_mul_u32_u24 v2, 144, v2
    v_lshl_add_u32 v2, v9, 3, v2
    s_mul_i32 s3, s30, 4608
    s_add_u32 s3, s3, 140288
    v_add_u32 v52, s3, v2
    s_mov_b32 s67, 0
    s_mov_b32 s68, 4096
    s_mov_b32 s69, 8192
    s_mov_b32 s70, 12288
    s_mov_b32 s71, 16384
    s_waitcnt vmcnt(0)
    s_barrier
    s_cmp_lt_u32 s29, 8
    s_cbranch_scc1 K_P2_AUXW
K_P2_GEMM:
    s_setprio 2
    s_lshl_b32 s3, s40, 3
    s_mul_i32 s33, s3, 187
    s_lshr_b32 s33, s33, 11
    s_add_u32 s33, s33, 1
    s_mul_i32 s33, s33, 11
    s_add_u32 s3, s53, s30
    s_cmp_ge_u32 s3, s33
    s_cselect_b32 s59, 16, 0
    s_add_u32 s3, s3, 1
    s_cmp_ge_u32 s3, s33
    s_cselect_b32 s61, 16, 0
    s_mov_b32 s58, 0
    ds_read_b64_tr_b16 v[148:149], v56 offset:0
    ds_read_b64_tr_b16 v[150:151], v58 offset:2560
    ds_read_b64_tr_b16 v[152:153], v57 offset:0
    ds_read_b64_tr_b16 v[154:155], v59 offset:2560
    ds_read_b64_tr_b16 v[156:157], v58 offset:0
    ds_read_b64_tr_b16 v[158:159], v56 offset:2560
    ds_read_b64_tr_b16 v[160:161], v59 offset:0
    ds_read_b64_tr_b16 v[162:163], v57 offset:2560
    ds_read_b64_tr_b16 v[164:165], v56 offset:20480
    ds_read_b64_tr_b16 v[166:167], v58 offset:23040
    ds_read_b64_tr_b16 v[168:169], v57 offset:20480
    ds_read_b64_tr_b16 v[170:171], v59 offset:23040
    ds_read_b64_tr_b16 v[172:173], v58 offset:20480
    ds_read_b64_tr_b16 v[174:175], v56 offset:23040
    ds_read_b64_tr_b16 v[176:177], v59 offset:20480
    ds_read_b64_tr_b16 v[178:179], v57 offset:23040
    ds_read_b64_tr_b16 v[180:181], v56 offset:5120
    ds_read_b64_tr_b16 v[182:183], v58 offset:7680
    ds_read_b64_tr_b16 v[184:185], v57 offset:5120
    ds_read_b64_tr_b16 v[186:187], v59 offset:7680
    ds_read_b64_tr_b16 v[188:189], v58 offset:5120
    ds_read_b64_tr_b16 v[190:191], v56 offset:7680
    ds_read_b64_tr_b16 v[192:193], v59 offset:5120
    ds_read_b64_tr_b16 v[194:195], v57 offset:7680
    s_andn2_b32 s33, 1, s58
    s_cbranch_scc1 K_SP0
K_SPR0:
    buffer_load_dwordx4 v[68:71], v54, s[20:23], s67 offen offset:0 sc1
    buffer_load_dwordx4 v[72:75], v55, s[20:23], s67 offen offset:0 sc1
    s_andn2_b32 s33, 16, s58
    s_cbranch_scc1 K_SP1
K_SPR1:
    buffer_load_dwordx4 v[76:79], v54, s[20:23], s68 offen offset:0 sc1
    buffer_load_dwordx4 v[80:83], v55, s[20:23], s68 offen offset:0 sc1
    s_andn2_b32 s33, 2, s58
    s_cbranch_scc1 K_SP2
K_SPR2:
    buffer_load_dwordx4 v[84:87], v54, s[20:23], s67 offen offset:1024 sc1
    buffer_load_dwordx4 v[88:91], v55, s[20:23], s67 offen offset:1024 sc1
    s_andn2_b32 s33, 32, s58
    s_cbranch_scc1 K_SP3
K_SPR3:
    buffer_load_dwordx4 v[92:95], v54, s[20:23], s68 offen offset:1024 sc1
    buffer_load_dwordx4 v[96:99], v55, s[20:23], s68 offen offset:1024 sc1
    s_andn2_b32 s33, 4, s58
    s_cbranch_scc1 K_SP4
K_SPR4:
    buffer_load_dwordx4 v[100:103], v54, s[20:23], s67 offen offset:2048 sc1
    buffer_load_dwordx4 v[104:107], v55, s[20:23], s67 offen offset:2048 sc1
    ds_read_b64_tr_b16 v[196:197], v56 offset:25600
    ds_read_b64_tr_b16 v[198:199], v58 offset:28160
    ds_read_b64_tr_b16 v[200:201], v57 offset:25600
    ds_read_b64_tr_b16 v[202:203], v59 offset:28160
    ds_read_b64_tr_b16 v[204:205], v58 offset:25600
    ds_read_b64_tr_b16 v[206:207], v56 offset:28160
    ds_read_b64_tr_b16 v[208:209], v59 offset:25600
    ds_read_b64_tr_b16 v[210:211], v57 offset:28160
    ds_read_b64_tr_b16 v[212:213], v56 offset:10240
    ds_read_b64_tr_b16 v[214:215], v58 offset:12800
    s_branch K_J43cc
K_STM18:
    s_branch K_STM22
K_CHA1:
K_STA18:
    s_branch K_STA22
K_J43cc:
    ds_read_b64_tr_b16 v[216:217], v57 offset:10240
    ds_read_b64_tr_b16 v[218:219], v59 offset:12800
    ds_read_b64_tr_b16 v[220:221], v58 offset:10240
    ds_read_b64_tr_b16 v[222:223], v56 offset:12800
    ds_read_b64_tr_b16 v[224:225], v59 offset:10240
    ds_read_b64_tr_b16 v[226:227], v57 offset:12800
    s_waitcnt vmcnt(8)
    s_waitcnt lgkmcnt(15)
    v_mfma_f32_16x16x32_bf16 v[116:119], v[148:151], v[68:71], 0
    v_mfma_f32_16x16x32_bf16 v[132:135], v[148:151], v[72:75], 0
    v_mfma_f32_16x16x32_bf16 v[120:123], v[152:155], v[68:71], 0
    v_mfma_f32_16x16x32_bf16 v[136:139], v[152:155], v[72:75], 0
    v_mfma_f32_16x16x32_bf16 v[124:127], v[156:159], v[68:71], 0
    v_mfma_f32_16x16x32_bf16 v[140:143], v[156:159], v[72:75], 0
    v_mfma_f32_16x16x32_bf16 v[128:131], v[160:163], v[68:71], 0
    v_mfma_f32_16x16x32_bf16 v[144:147], v[160:163], v[72:75], 0
    s_andn2_b32 s33, 64, s58
    s_cbranch_scc1 K_SP5
K_SPR5:
    buffer_load_dwordx4 v[108:111], v54, s[20:23], s68 offen offset:2048 sc1
    buffer_load_dwordx4 v[112:115], v55, s[20:23], s68 offen offset:2048 sc1
    s_waitcnt vmcnt(8)
    v_mfma_f32_16x16x32_bf16 v[116:119], v[164:167], v[76:79], v[116:119]
    ds_read_b64_tr_b16 v[148:149], v56 offset:30720
    v_mfma_f32_16x16x32_bf16 v[132:135], v[164:167], v[80:83], v[132:135]
    ds_read_b64_tr_b16 v[150:151], v58 offset:33280
    v_mfma_f32_16x16x32_bf16 v[120:123], v[168:171], v[76:79], v[120:123]
    ds_read_b64_tr_b16 v[152:153], v57 offset:30720
    v_mfma_f32_16x16x32_bf16 v[136:139], v[168:171], v[80:83], v[136:139]
    ds_read_b64_tr_b16 v[154:155], v59 offset:33280
    v_mfma_f32_16x16x32_bf16 v[124:127], v[172:175], v[76:79], v[124:127]
    ds_read_b64_tr_b16 v[156:157], v58 offset:30720
    v_mfma_f32_16x16x32_bf16 v[140:143], v[172:175], v[80:83], v[140:143]
    ds_read_b64_tr_b16 v[158:159], v56 offset:33280
    v_mfma_f32_16x16x32_bf16 v[128:131], v[176:179], v[76:79], v[128:131]
    ds_read_b64_tr_b16 v[160:161], v59 offset:30720
    v_mfma_f32_16x16x32_bf16 v[144:147], v[176:179], v[80:83], v[144:147]
    ds_read_b64_tr_b16 v[162:163], v57 offset:33280
    s_andn2_b32 s33, 8, s58
    s_cbranch_scc1 K_SP6
K_SPR6:
    buffer_load_dwordx4 v[68:71], v54, s[20:23], s67 offen offset:3072 sc1
    buffer_load_dwordx4 v[72:75], v55, s[20:23], s67 offen offset:3072 sc1
    s_waitcnt vmcnt(8)
    v_mfma_f32_16x16x32_bf16 v[116:119], v[180:183], v[84:87], v[116:119]
    ds_read_b64_tr_b16 v[164:165], v56 offset:15360
    v_mfma_f32_16x16x32_bf16 v[132:135], v[180:183], v[88:91], v[132:135]
    ds_read_b64_tr_b16 v[166:167], v58 offset:17920
    v_mfma_f32_16x16x32_bf16 v[120:123], v[184:187], v[84:87], v[120:123]
    ds_read_b64_tr_b16 v[168:169], v57 offset:15360
    v_mfma_f32_16x16x32_bf16 v[136:139], v[184:187], v[88:91], v[136:139]
    ds_read_b64_tr_b16 v[170:171], v59 offset:17920
    v_mfma_f32_16x16x32_bf16 v[124:127], v[188:191], v[84:87], v[124:127]
    ds_read_b64_tr_b16 v[172:173], v58 offset:15360
    v_mfma_f32_16x16x32_bf16 v[140:143], v[188:191], v[88:91], v[140:143]
    ds_read_b64_tr_b16 v[174:175], v56 offset:17920
    v_mfma_f32_16x16x32_bf16 v[128:131], v[192:195], v[84:87], v[128:131]
    ds_read_b64_tr_b16 v[176:177], v59 offset:15360
    v_mfma_f32_16x16x32_bf16 v[144:147], v[192:195], v[88:91], v[144:147]
    ds_read_b64_tr_b16 v[178:179], v57 offset:17920
    s_andn2_b32 s33, 128, s58
    s_cbranch_scc1 K_SP7
K_SPR7:
    buffer_load_dwordx4 v[76:79], v54, s[20:23], s68 offen offset:3072 sc1
    buffer_load_dwordx4 v[80:83], v55, s[20:23], s68 offen offset:3072 sc1
    s_waitcnt vmcnt(8)
    s_waitcnt lgkmcnt(15)
    v_mfma_f32_16x16x32_bf16 v[116:119], v[196:199], v[92:95], v[116:119]
    ds_read_b64_tr_b16 v[180:181], v56 offset:35840
    v_mfma_f32_16x16x32_bf16 v[132:135], v[196:199], v[96:99], v[132:135]
    ds_read_b64_tr_b16 v[182:183], v58 offset:38400
    v_mfma_f32_16x16x32_bf16 v[120:123], v[200:203], v[92:95], v[120:123]
    ds_read_b64_tr_b16 v[184:185], v57 offset:35840
    v_mfma_f32_16x16x32_bf16 v[136:139], v[200:203], v[96:99], v[136:139]
    ds_read_b64_tr_b16 v[186:187], v59 offset:38400
    v_mfma_f32_16x16x32_bf16 v[124:127], v[204:207], v[92:95], v[124:127]
    ds_read_b64_tr_b16 v[188:189], v58 offset:35840
    v_mfma_f32_16x16x32_bf16 v[140:143], v[204:207], v[96:99], v[140:143]
    ds_read_b64_tr_b16 v[190:191], v56 offset:38400
    v_mfma_f32_16x16x32_bf16 v[128:131], v[208:211], v[92:95], v[128:131]
    ds_read_b64_tr_b16 v[192:193], v59 offset:35840
    v_mfma_f32_16x16x32_bf16 v[144:147], v[208:211], v[96:99], v[144:147]
    ds_read_b64_tr_b16 v[194:195], v57 offset:38400
    s_andn2_b32 s33, 15, s58
    s_cbranch_scc1 K_SP8
K_SPR8:
    buffer_load_dwordx4 v[84:87], v54, s[20:23], s71 offen offset:0 sc1
    buffer_load_dwordx4 v[88:91], v55, s[20:23], s71 offen offset:0 sc1
    s_waitcnt vmcnt(8)
    v_mfma_f32_16x16x32_bf16 v[116:119], v[212:215], v[100:103], v[116:119]
    ds_read_b64_tr_b16 v[196:197], v64 offset:0
    v_mfma_f32_16x16x32_bf16 v[132:135], v[212:215], v[104:107], v[132:135]
    ds_read_b64_tr_b16 v[198:199], v66 offset:2560
    v_mfma_f32_16x16x32_bf16 v[120:123], v[216:219], v[100:103], v[120:123]
    ds_read_b64_tr_b16 v[200:201], v65 offset:0
    v_mfma_f32_16x16x32_bf16 v[136:139], v[216:219], v[104:107], v[136:139]
    ds_read_b64_tr_b16 v[202:203], v67 offset:2560
    v_mfma_f32_16x16x32_bf16 v[124:127], v[220:223], v[100:103], v[124:127]
    ds_read_b64_tr_b16 v[204:205], v66 offset:0
    v_mfma_f32_16x16x32_bf16 v[140:143], v[220:223], v[104:107], v[140:143]
    ds_read_b64_tr_b16 v[206:207], v64 offset:2560
    v_mfma_f32_16x16x32_bf16 v[128:131], v[224:227], v[100:103], v[128:131]
    ds_read_b64_tr_b16 v[208:209], v67 offset:0
    v_mfma_f32_16x16x32_bf16 v[144:147], v[224:227], v[104:107], v[144:147]
    ds_read_b64_tr_b16 v[210:211], v65 offset:2560
    s_andn2_b32 s33, 240, s58
    s_cbranch_scc1 K_SP9
K_SPR9:
    buffer_load_dwordx4 v[92:95], v54, s[20:23], s71 offen offset:1024 sc1
    buffer_load_dwordx4 v[96:99], v55, s[20:23], s71 offen offset:1024 sc1
    s_waitcnt vmcnt(8)
    s_waitcnt lgkmcnt(15)
    v_mfma_f32_16x16x32_bf16 v[116:119], v[148:151], v[108:111], v[116:119]
    ds_read_b64_tr_b16 v[212:213], v64 offset:20480
    v_mfma_f32_16x16x32_bf16 v[132:135], v[148:151], v[112:115], v[132:135]
    ds_read_b64_tr_b16 v[214:215], v66 offset:23040
    v_mfma_f32_16x16x32_bf16 v[120:123], v[152:155], v[108:111], v[120:123]
    ds_read_b64_tr_b16 v[216:217], v65 offset:20480
    v_mfma_f32_16x16x32_bf16 v[136:139], v[152:155], v[112:115], v[136:139]
    ds_read_b64_tr_b16 v[218:219], v67 offset:23040
    v_mfma_f32_16x16x32_bf16 v[124:127], v[156:159], v[108:111], v[124:127]
    ds_read_b64_tr_b16 v[220:221], v66 offset:20480
    v_mfma_f32_16x16x32_bf16 v[140:143], v[156:159], v[112:115], v[140:143]
    ds_read_b64_tr_b16 v[222:223], v64 offset:23040
    v_mfma_f32_16x16x32_bf16 v[128:131], v[160:163], v[108:111], v[128:131]
    ds_read_b64_tr_b16 v[224:225], v67 offset:20480
    v_mfma_f32_16x16x32_bf16 v[144:147], v[160:163], v[112:115], v[144:147]
    ds_read_b64_tr_b16 v[226:227], v65 offset:23040
    s_andn2_b32 s33, 256, s58
    s_cbranch_scc1 K_SP10
K_SPR10:
    buffer_load_dwordx4 v[100:103], v54, s[20:23], s69 offen offset:0 sc1
    buffer_load_dwordx4 v[104:107], v55, s[20:23], s69 offen offset:0 sc1
    s_mov_b32 s3, 1048576
K_P2_GS:
    s_branch K_J4790
K_STM19:
    s_branch K_STM23
K_CHA2:
K_STA19:
    s_branch K_STA23
K_J4790:
    ds_read_b32 v2, v15 offset:40
    s_sub_u32 s3, s3, 1
    s_waitcnt lgkmcnt(0)
    v_readfirstlane_b32 s33, v2
    s_nop 3
    s_cselect_b32 s33, 1, s33
    s_cmp_lt_u32 s33, 1
    s_cbranch_scc1 K_P2_GS
    buffer_load_dwordx4 v[16:19], v10, s[12:15], 0 offen
    buffer_load_dwordx4 v[20:23], v10, s[12:15], s55 offen
    buffer_load_dword v24, v11, s[16:19], 0 offen sc1
    buffer_load_dword v25, v11, s[16:19], 0 offen offset:32 sc1
    ds_read_b128 v[28:31], v15
    s_mov_b32 s3, 1048576
K_P2_GW:
    ds_read_b32 v2, v15 offset:44
    s_sub_u32 s3, s3, 1
    s_waitcnt lgkmcnt(0)
    v_readfirstlane_b32 s33, v2
    s_nop 3
    s_cselect_b32 s33, 4, s33
    s_cmp_lt_u32 s33, 4
    s_cbranch_scc1 K_P2_GW
    s_waitcnt vmcnt(12)
    v_mfma_f32_16x16x32_bf16 v[116:119], v[164:167], v[68:71], v[116:119]
    ds_read_b64_tr_b16 v[148:149], v60 offset:0
    v_mfma_f32_16x16x32_bf16 v[132:135], v[164:167], v[72:75], v[132:135]
    ds_read_b64_tr_b16 v[150:151], v62 offset:2560
    v_mfma_f32_16x16x32_bf16 v[120:123], v[168:171], v[68:71], v[120:123]
    ds_read_b64_tr_b16 v[152:153], v61 offset:0
    v_mfma_f32_16x16x32_bf16 v[136:139], v[168:171], v[72:75], v[136:139]
    ds_read_b64_tr_b16 v[154:155], v63 offset:2560
    v_mfma_f32_16x16x32_bf16 v[124:127], v[172:175], v[68:71], v[124:127]
    ds_read_b64_tr_b16 v[156:157], v62 offset:0
    v_mfma_f32_16x16x32_bf16 v[140:143], v[172:175], v[72:75], v[140:143]
    ds_read_b64_tr_b16 v[158:159], v60 offset:2560
    v_mfma_f32_16x16x32_bf16 v[128:131], v[176:179], v[68:71], v[128:131]
    ds_read_b64_tr_b16 v[160:161], v63 offset:0
    v_mfma_f32_16x16x32_bf16 v[144:147], v[176:179], v[72:75], v[144:147]
    ds_read_b64_tr_b16 v[162:163], v61 offset:2560
    s_andn2_b32 s33, 4096, s58
    s_cbranch_scc1 K_SP11
K_SPR11:
    buffer_load_dwordx4 v[108:111], v54, s[20:23], s70 offen offset:0 sc1
    buffer_load_dwordx4 v[112:115], v55, s[20:23], s70 offen offset:0 sc1
    s_waitcnt vmcnt(12)
    v_mfma_f32_16x16x32_bf16 v[116:119], v[180:183], v[76:79], v[116:119]
    ds_read_b64_tr_b16 v[164:165], v60 offset:20480
    v_mfma_f32_16x16x32_bf16 v[132:135], v[180:183], v[80:83], v[132:135]
    ds_read_b64_tr_b16 v[166:167], v62 offset:23040
    v_mfma_f32_16x16x32_bf16 v[120:123], v[184:187], v[76:79], v[120:123]
    ds_read_b64_tr_b16 v[168:169], v61 offset:20480
    v_mfma_f32_16x16x32_bf16 v[136:139], v[184:187], v[80:83], v[136:139]
    ds_read_b64_tr_b16 v[170:171], v63 offset:23040
    v_mfma_f32_16x16x32_bf16 v[124:127], v[188:191], v[76:79], v[124:127]
    ds_read_b64_tr_b16 v[172:173], v62 offset:20480
    v_mfma_f32_16x16x32_bf16 v[140:143], v[188:191], v[80:83], v[140:143]
    ds_read_b64_tr_b16 v[174:175], v60 offset:23040
    v_mfma_f32_16x16x32_bf16 v[128:131], v[192:195], v[76:79], v[128:131]
    ds_read_b64_tr_b16 v[176:177], v63 offset:20480
    v_mfma_f32_16x16x32_bf16 v[144:147], v[192:195], v[80:83], v[144:147]
    ds_read_b64_tr_b16 v[178:179], v61 offset:23040
    s_andn2_b32 s33, 512, s58
    s_cbranch_scc1 K_SP12
K_SPR12:
    buffer_load_dwordx4 v[68:71], v54, s[20:23], s69 offen offset:1024 sc1
    buffer_load_dwordx4 v[72:75], v55, s[20:23], s69 offen offset:1024 sc1
    s_waitcnt vmcnt(12)
    v_mfma_f32_16x16x32_bf16 v[116:119], v[196:199], v[84:87], v[116:119]
    ds_read_b64_tr_b16 v[180:181], v60 offset:5120
    v_mfma_f32_16x16x32_bf16 v[132:135], v[196:199], v[88:91], v[132:135]
    ds_read_b64_tr_b16 v[182:183], v62 offset:7680
    v_mfma_f32_16x16x32_bf16 v[120:123], v[200:203], v[84:87], v[120:123]
    ds_read_b64_tr_b16 v[184:185], v61 offset:5120
    v_mfma_f32_16x16x32_bf16 v[136:139], v[200:203], v[88:91], v[136:139]
    ds_read_b64_tr_b16 v[186:187], v63 offset:7680
    v_mfma_f32_16x16x32_bf16 v[124:127], v[204:207], v[84:87], v[124:127]
    ds_read_b64_tr_b16 v[188:189], v62 offset:5120
    v_mfma_f32_16x16x32_bf16 v[140:143], v[204:207], v[88:91], v[140:143]
    ds_read_b64_tr_b16 v[190:191], v60 offset:7680
    v_mfma_f32_16x16x32_bf16 v[128:131], v[208:211], v[84:87], v[128:131]
    ds_read_b64_tr_b16 v[192:193], v63 offset:5120
    v_mfma_f32_16x16x32_bf16 v[144:147], v[208:211], v[88:91], v[144:147]
    ds_read_b64_tr_b16 v[194:195], v61 offset:7680
    s_andn2_b32 s33, 8192, s58
    s_cbranch_scc1 K_SP13
K_SPR13:
    buffer_load_dwordx4 v[76:79], v54, s[20:23], s70 offen offset:1024 sc1
    buffer_load_dwordx4 v[80:83], v55, s[20:23], s70 offen offset:1024 sc1
    s_waitcnt vmcnt(12)
    v_mfma_f32_16x16x32_bf16 v[116:119], v[212:215], v[92:95], v[116:119]
    ds_read_b64_tr_b16 v[196:197], v60 offset:25600
    v_mfma_f32_16x16x32_bf16 v[132:135], v[212:215], v[96:99], v[132:135]
    ds_read_b64_tr_b16 v[198:199], v62 offset:28160
    v_mfma_f32_16x16x32_bf16 v[120:123], v[216:219], v[92:95], v[120:123]
    ds_read_b64_tr_b16 v[200:201], v61 offset:25600
    v_mfma_f32_16x16x32_bf16 v[136:139], v[216:219], v[96:99], v[136:139]
    ds_read_b64_tr_b16 v[202:203], v63 offset:28160
    v_mfma_f32_16x16x32_bf16 v[124:127], v[220:223], v[92:95], v[124:127]
    ds_read_b64_tr_b16 v[204:205], v62 offset:25600
    v_mfma_f32_16x16x32_bf16 v[140:143], v[220:223], v[96:99], v[140:143]
    ds_read_b64_tr_b16 v[206:207], v60 offset:28160
    v_mfma_f32_16x16x32_bf16 v[128:131], v[224:227], v[92:95], v[128:131]
    ds_read_b64_tr_b16 v[208:209], v63 offset:25600
    v_mfma_f32_16x16x32_bf16 v[144:147], v[224:227], v[96:99], v[144:147]
    ds_read_b64_tr_b16 v[210:211], v61 offset:28160
    s_andn2_b32 s33, 1024, s58
    s_cbranch_scc1 K_SP14
K_SPR14:
    buffer_load_dwordx4 v[84:87], v54, s[20:23], s69 offen offset:2048 sc1
    buffer_load_dwordx4 v[88:91], v55, s[20:23], s69 offen offset:2048 sc1
    s_waitcnt vmcnt(12)
    s_waitcnt lgkmcnt(15)
    v_mfma_f32_16x16x32_bf16 v[116:119], v[148:151], v[100:103], v[116:119]
    ds_read_b64_tr_b16 v[212:213], v60 offset:10240
    v_mfma_f32_16x16x32_bf16 v[132:135], v[148:151], v[104:107], v[132:135]
    ds_read_b64_tr_b16 v[214:215], v62 offset:12800
    v_mfma_f32_16x16x32_bf16 v[120:123], v[152:155], v[100:103], v[120:123]
    ds_read_b64_tr_b16 v[216:217], v61 offset:10240
    v_mfma_f32_16x16x32_bf16 v[136:139], v[152:155], v[104:107], v[136:139]
    ds_read_b64_tr_b16 v[218:219], v63 offset:12800
    v_mfma_f32_16x16x32_bf16 v[124:127], v[156:159], v[100:103], v[124:127]
    ds_read_b64_tr_b16 v[220:221], v62 offset:10240
    v_mfma_f32_16x16x32_bf16 v[140:143], v[156:159], v[104:107], v[140:143]
    ds_read_b64_tr_b16 v[222:223], v60 offset:12800
    v_mfma_f32_16x16x32_bf16 v[128:131], v[160:163], v[100:103], v[128:131]
    ds_read_b64_tr_b16 v[224:225], v63 offset:10240
    v_mfma_f32_16x16x32_bf16 v[144:147], v[160:163], v[104:107], v[144:147]
    ds_read_b64_tr_b16 v[226:227], v61 offset:12800
    s_andn2_b32 s33, 16384, s58
    s_cbranch_scc1 K_SP15
K_SPR15:
    buffer_load_dwordx4 v[92:95], v54, s[20:23], s70 offen offset:2048 sc1
    buffer_load_dwordx4 v[96:99], v55, s[20:23], s70 offen offset:2048 sc1
    s_waitcnt vmcnt(8)
    v_mfma_f32_16x16x32_bf16 v[116:119], v[164:167], v[108:111], v[116:119]
    ds_read_b64_tr_b16 v[148:149], v60 offset:30720
    v_sub_f32 v48, 1.0, v24
    v_mfma_f32_16x16x32_bf16 v[132:135], v[164:167], v[112:115], v[132:135]
    s_branch K_J4b58
K_STM20:
    s_branch K_STM24
K_CHA3:
K_STA20:
    s_branch K_STA24
K_J4b58:
    ds_read_b64_tr_b16 v[150:151], v62 offset:33280
    v_cvt_pk_bf16_f32 v48, v48, v48
    v_mfma_f32_16x16x32_bf16 v[120:123], v[168:171], v[108:111], v[120:123]
    ds_read_b64_tr_b16 v[152:153], v61 offset:30720
    v_lshlrev_b32 v48, 16, v48
    v_mfma_f32_16x16x32_bf16 v[136:139], v[168:171], v[112:115], v[136:139]
    ds_read_b64_tr_b16 v[154:155], v63 offset:33280
    v_sub_f32 v49, 1.0, v25
    v_mfma_f32_16x16x32_bf16 v[124:127], v[172:175], v[108:111], v[124:127]
    ds_read_b64_tr_b16 v[156:157], v62 offset:30720
    v_cvt_pk_bf16_f32 v49, v49, v49
    v_mfma_f32_16x16x32_bf16 v[140:143], v[172:175], v[112:115], v[140:143]
    ds_read_b64_tr_b16 v[158:159], v60 offset:33280
    v_lshlrev_b32 v49, 16, v49
    v_mfma_f32_16x16x32_bf16 v[128:131], v[176:179], v[108:111], v[128:131]
    ds_read_b64_tr_b16 v[160:161], v63 offset:30720
    v_lshlrev_b32 v32, 16, v16
    v_mfma_f32_16x16x32_bf16 v[144:147], v[176:179], v[112:115], v[144:147]
    ds_read_b64_tr_b16 v[162:163], v61 offset:33280
    v_and_b32 v33, 0xffff0000, v16
    s_andn2_b32 s33, 2048, s58
    s_cbranch_scc1 K_SP16
K_SPR16:
    buffer_load_dwordx4 v[100:103], v54, s[20:23], s69 offen offset:3072 sc1
    buffer_load_dwordx4 v[104:107], v55, s[20:23], s69 offen offset:3072 sc1
    s_waitcnt vmcnt(8)
    s_waitcnt lgkmcnt(15)
    v_mfma_f32_16x16x32_bf16 v[116:119], v[180:183], v[68:71], v[116:119]
    ds_read_b64_tr_b16 v[164:165], v60 offset:15360
    v_lshlrev_b32 v34, 16, v17
    v_mfma_f32_16x16x32_bf16 v[132:135], v[180:183], v[72:75], v[132:135]
    ds_read_b64_tr_b16 v[166:167], v62 offset:17920
    v_and_b32 v35, 0xffff0000, v17
    v_mfma_f32_16x16x32_bf16 v[120:123], v[184:187], v[68:71], v[120:123]
    ds_read_b64_tr_b16 v[168:169], v61 offset:15360
    v_lshlrev_b32 v36, 16, v18
    v_mfma_f32_16x16x32_bf16 v[136:139], v[184:187], v[72:75], v[136:139]
    ds_read_b64_tr_b16 v[170:171], v63 offset:17920
    v_and_b32 v37, 0xffff0000, v18
    v_mfma_f32_16x16x32_bf16 v[124:127], v[188:191], v[68:71], v[124:127]
    ds_read_b64_tr_b16 v[172:173], v62 offset:15360
    v_lshlrev_b32 v38, 16, v19
    v_mfma_f32_16x16x32_bf16 v[140:143], v[188:191], v[72:75], v[140:143]
    ds_read_b64_tr_b16 v[174:175], v60 offset:17920
    v_and_b32 v39, 0xffff0000, v19
    v_mfma_f32_16x16x32_bf16 v[128:131], v[192:195], v[68:71], v[128:131]
    ds_read_b64_tr_b16 v[176:177], v63 offset:15360
    v_lshlrev_b32 v40, 16, v20
    v_mfma_f32_16x16x32_bf16 v[144:147], v[192:195], v[72:75], v[144:147]
    ds_read_b64_tr_b16 v[178:179], v61 offset:17920
    v_and_b32 v41, 0xffff0000, v20
    s_andn2_b32 s33, 32768, s58
    s_cbranch_scc1 K_SP17
K_SPR17:
    buffer_load_dwordx4 v[108:111], v54, s[20:23], s70 offen offset:3072 sc1
    buffer_load_dwordx4 v[112:115], v55, s[20:23], s70 offen offset:3072 sc1
    s_waitcnt vmcnt(8)
    v_mfma_f32_16x16x32_bf16 v[116:119], v[196:199], v[76:79], v[116:119]
    ds_read_b64_tr_b16 v[180:181], v60 offset:35840
    v_lshlrev_b32 v42, 16, v21
    v_mfma_f32_16x16x32_bf16 v[132:135], v[196:199], v[80:83], v[132:135]
    ds_read_b64_tr_b16 v[182:183], v62 offset:38400
    v_and_b32 v43, 0xffff0000, v21
    v_mfma_f32_16x16x32_bf16 v[120:123], v[200:203], v[76:79], v[120:123]
    ds_read_b64_tr_b16 v[184:185], v61 offset:35840
    v_lshlrev_b32 v44, 16, v22
    v_mfma_f32_16x16x32_bf16 v[136:139], v[200:203], v[80:83], v[136:139]
    ds_read_b64_tr_b16 v[186:187], v63 offset:38400
    v_and_b32 v45, 0xffff0000, v22
    v_mfma_f32_16x16x32_bf16 v[124:127], v[204:207], v[76:79], v[124:127]
    ds_read_b64_tr_b16 v[188:189], v62 offset:35840
    v_lshlrev_b32 v46, 16, v23
    v_mfma_f32_16x16x32_bf16 v[140:143], v[204:207], v[80:83], v[140:143]
    ds_read_b64_tr_b16 v[190:191], v60 offset:38400
    v_and_b32 v47, 0xffff0000, v23
    v_mfma_f32_16x16x32_bf16 v[128:131], v[208:211], v[76:79], v[128:131]
    ds_read_b64_tr_b16 v[192:193], v63 offset:35840
    v_mul_f32 v32, v32, v48
    v_mfma_f32_16x16x32_bf16 v[144:147], v[208:211], v[80:83], v[144:147]
    ds_read_b64_tr_b16 v[194:195], v61 offset:38400
    v_mul_f32 v33, v33, v48
    s_andn2_b32 s33, 3840, s58
    s_cbranch_scc1 K_SP18
K_SPR18:
    buffer_load_dwordx4 v[68:71], v54, s[20:23], s71 offen offset:2048 sc1
    buffer_load_dwordx4 v[72:75], v55, s[20:23], s71 offen offset:2048 sc1
    s_waitcnt vmcnt(8)
    s_waitcnt lgkmcnt(15)
    v_mfma_f32_16x16x32_bf16 v[116:119], v[212:215], v[84:87], v[116:119]
    ds_read_b64_tr_b16 v[196:197], v64 offset:40960
    v_mul_f32 v34, v34, v48
    v_mfma_f32_16x16x32_bf16 v[132:135], v[212:215], v[88:91], v[132:135]
    ds_read_b64_tr_b16 v[198:199], v66 offset:43520
    v_mul_f32 v35, v35, v48
    v_mfma_f32_16x16x32_bf16 v[120:123], v[216:219], v[84:87], v[120:123]
    ds_read_b64_tr_b16 v[200:201], v65 offset:40960
    v_mul_f32 v36, v36, v48
    v_mfma_f32_16x16x32_bf16 v[136:139], v[216:219], v[88:91], v[136:139]
    ds_read_b64_tr_b16 v[202:203], v67 offset:43520
    v_mul_f32 v37, v37, v48
    v_mfma_f32_16x16x32_bf16 v[124:127], v[220:223], v[84:87], v[124:127]
    ds_read_b64_tr_b16 v[204:205], v66 offset:40960
    v_mul_f32 v38, v38, v48
    v_mfma_f32_16x16x32_bf16 v[140:143], v[220:223], v[88:91], v[140:143]
    ds_read_b64_tr_b16 v[206:207], v64 offset:43520
    v_mul_f32 v39, v39, v48
    v_mfma_f32_16x16x32_bf16 v[128:131], v[224:227], v[84:87], v[128:131]
    ds_read_b64_tr_b16 v[208:209], v67 offset:40960
    v_mul_f32 v40, v40, v49
    v_mfma_f32_16x16x32_bf16 v[144:147], v[224:227], v[88:91], v[144:147]
    ds_read_b64_tr_b16 v[210:211], v65 offset:43520
    v_mul_f32 v41, v41, v49
    s_andn2_b32 s33, 61440, s58
    s_cbranch_scc1 K_SP19
K_SPR19:
    s_memrealtime s[94:95]
    buffer_load_dwordx4 v[76:79], v54, s[20:23], s71 offen offset:3072 sc1
    buffer_load_dwordx4 v[80:83], v55, s[20:23], s71 offen offset:3072 sc1
    s_waitcnt vmcnt(8)
    v_mfma_f32_16x16x32_bf16 v[116:119], v[148:151], v[92:95], v[116:119]
    ds_read_b64_tr_b16 v[212:213], v64 offset:61440
    v_mul_f32 v42, v42, v49
    v_mfma_f32_16x16x32_bf16 v[132:135], v[148:151], v[96:99], v[132:135]
    ds_read_b64_tr_b16 v[214:215], v66 offset:64000
    v_mul_f32 v43, v43, v49
    v_mfma_f32_16x16x32_bf16 v[120:123], v[152:155], v[92:95], v[120:123]
    ds_read_b64_tr_b16 v[216:217], v65 offset:61440
    v_mul_f32 v44, v44, v49
    v_mfma_f32_16x16x32_bf16 v[136:139], v[152:155], v[96:99], v[136:139]
    ds_read_b64_tr_b16 v[218:219], v67 offset:64000
    v_mul_f32 v45, v45, v49
    v_mfma_f32_16x16x32_bf16 v[124:127], v[156:159], v[92:95], v[124:127]
    ds_read_b64_tr_b16 v[220:221], v66 offset:61440
    v_mul_f32 v46, v46, v49
    v_mfma_f32_16x16x32_bf16 v[140:143], v[156:159], v[96:99], v[140:143]
    ds_read_b64_tr_b16 v[222:223], v64 offset:64000
    v_mul_f32 v47, v47, v49
    v_mfma_f32_16x16x32_bf16 v[128:131], v[160:163], v[92:95], v[128:131]
    ds_read_b64_tr_b16 v[224:225], v67 offset:61440
    v_mfma_f32_16x16x32_bf16 v[144:147], v[160:163], v[96:99], v[144:147]
    ds_read_b64_tr_b16 v[226:227], v65 offset:64000
    s_waitcnt vmcnt(6)
    s_branch K_J4f1c
K_STM21:
    s_branch K_STM25
K_STA21:
    s_branch K_STA25
K_J4f1c:
    s_waitcnt lgkmcnt(15)
    v_mfma_f32_16x16x32_bf16 v[116:119], v[164:167], v[100:103], v[116:119]
    v_mfma_f32_16x16x32_bf16 v[132:135], v[164:167], v[104:107], v[132:135]
    v_mfma_f32_16x16x32_bf16 v[120:123], v[168:171], v[100:103], v[120:123]
    v_mfma_f32_16x16x32_bf16 v[136:139], v[168:171], v[104:107], v[136:139]
    v_mfma_f32_16x16x32_bf16 v[124:127], v[172:175], v[100:103], v[124:127]
    v_mfma_f32_16x16x32_bf16 v[140:143], v[172:175], v[104:107], v[140:143]
    v_mfma_f32_16x16x32_bf16 v[128:131], v[176:179], v[100:103], v[128:131]
    v_mfma_f32_16x16x32_bf16 v[144:147], v[176:179], v[104:107], v[144:147]
    s_waitcnt vmcnt(4)
    v_mfma_f32_16x16x32_bf16 v[116:119], v[180:183], v[108:111], v[116:119]
    v_mfma_f32_16x16x32_bf16 v[132:135], v[180:183], v[112:115], v[132:135]
    v_mfma_f32_16x16x32_bf16 v[120:123], v[184:187], v[108:111], v[120:123]
    v_mfma_f32_16x16x32_bf16 v[136:139], v[184:187], v[112:115], v[136:139]
    v_mfma_f32_16x16x32_bf16 v[124:127], v[188:191], v[108:111], v[124:127]
    v_mfma_f32_16x16x32_bf16 v[140:143], v[188:191], v[112:115], v[140:143]
    v_mfma_f32_16x16x32_bf16 v[128:131], v[192:195], v[108:111], v[128:131]
    v_mfma_f32_16x16x32_bf16 v[144:147], v[192:195], v[112:115], v[144:147]
    s_waitcnt vmcnt(2)
    s_waitcnt lgkmcnt(14)
    v_mfma_f32_16x16x32_bf16 v[116:119], v[196:199], v[68:71], v[116:119]
    v_mfma_f32_16x16x32_bf16 v[132:135], v[196:199], v[72:75], v[132:135]
    s_waitcnt lgkmcnt(12)
    v_mfma_f32_16x16x32_bf16 v[120:123], v[200:203], v[68:71], v[120:123]
    v_mfma_f32_16x16x32_bf16 v[136:139], v[200:203], v[72:75], v[136:139]
    s_waitcnt lgkmcnt(10)
    v_mfma_f32_16x16x32_bf16 v[124:127], v[204:207], v[68:71], v[124:127]
    v_mfma_f32_16x16x32_bf16 v[140:143], v[204:207], v[72:75], v[140:143]
    s_waitcnt lgkmcnt(8)
    v_mfma_f32_16x16x32_bf16 v[128:131], v[208:211], v[68:71], v[128:131]
    s_branch K_PG4
.p2align 12
K_STM22:
    s_branch K_STM26
K_STA22:
    s_branch K_STA26
K_PG4:
    v_mfma_f32_16x16x32_bf16 v[144:147], v[208:211], v[72:75], v[144:147]
    s_waitcnt vmcnt(0)
    s_waitcnt lgkmcnt(6)
    v_mfma_f32_16x16x32_bf16 v[116:119], v[212:215], v[76:79], v[116:119]
    v_mfma_f32_16x16x32_bf16 v[132:135], v[212:215], v[80:83], v[132:135]
    s_waitcnt lgkmcnt(4)
    v_mfma_f32_16x16x32_bf16 v[120:123], v[216:219], v[76:79], v[120:123]
    v_mfma_f32_16x16x32_bf16 v[136:139], v[216:219], v[80:83], v[136:139]
    s_waitcnt lgkmcnt(2)
    v_mfma_f32_16x16x32_bf16 v[124:127], v[220:223], v[76:79], v[124:127]
    v_mfma_f32_16x16x32_bf16 v[140:143], v[220:223], v[80:83], v[140:143]
    s_waitcnt lgkmcnt(0)
    v_mfma_f32_16x16x32_bf16 v[128:131], v[224:227], v[76:79], v[128:131]
    v_mfma_f32_16x16x32_bf16 v[144:147], v[224:227], v[80:83], v[144:147]
    s_nop 3
    v_cvt_pk_bf16_f32 v148, v116, v117
    v_cvt_pk_bf16_f32 v149, v118, v119
    ds_write_b64 v52, v[148:149] offset:0
    v_cvt_pk_bf16_f32 v164, v132, v133
    v_cvt_pk_bf16_f32 v165, v134, v135
    ds_write_b64 v52, v[164:165] offset:2304
    v_cvt_pk_bf16_f32 v152, v120, v121
    v_cvt_pk_bf16_f32 v153, v122, v123
    ds_write_b64 v52, v[152:153] offset:32
    v_cvt_pk_bf16_f32 v168, v136, v137
    v_cvt_pk_bf16_f32 v169, v138, v139
    ds_write_b64 v52, v[168:169] offset:2336
    v_cvt_pk_bf16_f32 v156, v124, v125
    v_cvt_pk_bf16_f32 v157, v126, v127
    ds_write_b64 v52, v[156:157] offset:64
    v_cvt_pk_bf16_f32 v172, v140, v141
    v_cvt_pk_bf16_f32 v173, v142, v143
    ds_write_b64 v52, v[172:173] offset:2368
    v_cvt_pk_bf16_f32 v160, v128, v129
    v_cvt_pk_bf16_f32 v161, v130, v131
    ds_write_b64 v52, v[160:161] offset:96
    v_cvt_pk_bf16_f32 v176, v144, v145
    v_cvt_pk_bf16_f32 v177, v146, v147
    ds_write_b64 v52, v[176:177] offset:2400
K_P2_E2:
    s_waitcnt lgkmcnt(0)
    v_readfirstlane_b32 s56, v28
    v_readfirstlane_b32 s57, v29
    s_lshl_b32 s72, s53, 4
    s_barrier
    s_memrealtime s[96:97]
    ds_read_b128 v[52:55], v14
    ds_read_b128 v[56:59], v14 offset:1152
    s_sub_u32 s3, s56, s72
    s_cmp_lt_u32 s3, 16
    s_cbranch_scc1 K_YROW0
K_NOY0:
    s_sub_u32 s3, s57, s72
    s_cmp_lt_u32 s3, 16
    s_cbranch_scc1 K_YROW1
K_NOY1:
    s_waitcnt lgkmcnt(1)
    v_lshlrev_b32 v72, 16, v52
    v_and_b32 v73, 0xffff0000, v52
    v_fma_f32 v72, v72, v24, v32
    v_fma_f32 v73, v73, v24, v33
    v_cvt_pk_bf16_f32 v52, v72, v73
    v_lshlrev_b32 v74, 16, v53
    v_and_b32 v75, 0xffff0000, v53
    v_fma_f32 v74, v74, v24, v34
    v_fma_f32 v75, v75, v24, v35
    v_cvt_pk_bf16_f32 v53, v74, v75
    v_lshlrev_b32 v72, 16, v54
    v_and_b32 v73, 0xffff0000, v54
    v_fma_f32 v72, v72, v24, v36
    v_fma_f32 v73, v73, v24, v37
    v_cvt_pk_bf16_f32 v54, v72, v73
    v_lshlrev_b32 v74, 16, v55
    v_and_b32 v75, 0xffff0000, v55
    v_fma_f32 v74, v74, v24, v38
    v_fma_f32 v75, v75, v24, v39
    v_cvt_pk_bf16_f32 v55, v74, v75
    buffer_store_dwordx4 v[52:55], v10, s[48:51], 0 offen sc1
    s_waitcnt lgkmcnt(0)
    v_lshlrev_b32 v72, 16, v56
    v_and_b32 v73, 0xffff0000, v56
    v_fma_f32 v72, v72, v25, v40
    v_fma_f32 v73, v73, v25, v41
    v_cvt_pk_bf16_f32 v56, v72, v73
    v_lshlrev_b32 v74, 16, v57
    v_and_b32 v75, 0xffff0000, v57
    v_fma_f32 v74, v74, v25, v42
    v_fma_f32 v75, v75, v25, v43
    v_cvt_pk_bf16_f32 v57, v74, v75
    v_lshlrev_b32 v72, 16, v58
    v_and_b32 v73, 0xffff0000, v58
    v_fma_f32 v72, v72, v25, v44
    v_fma_f32 v73, v73, v25, v45
    v_cvt_pk_bf16_f32 v58, v72, v73
    v_lshlrev_b32 v74, 16, v59
    v_and_b32 v75, 0xffff0000, v59
    v_fma_f32 v74, v74, v25, v46
    v_fma_f32 v75, v75, v25, v47
    v_cvt_pk_bf16_f32 v59, v74, v75
    buffer_store_dwordx4 v[56:59], v10, s[48:51], s55 offen sc1
K_END:
    s_memrealtime s[98:99]
    s_mov_b64 exec, -1
    v_cmp_eq_u32 vcc, 256, v0
    s_and_saveexec_b64 s[82:83], vcc
    s_cbranch_execz K_STX
    s_waitcnt lgkmcnt(0)
    s_lshl_b32 s82, s2, 6
    s_add_u32 s82, s82, 0x400000
    v_mov_b32 v1, s82
    v_mov_b32 v2, s84
    v_mov_b32 v3, s85
    global_store_dwordx2 v1, v[2:3], s[6:7] offset:0
    v_mov_b32 v2, s86
    v_mov_b32 v3, s87
    global_store_dwordx2 v1, v[2:3], s[6:7] offset:8
    v_mov_b32 v2, s88
    v_mov_b32 v3, s89
    global_store_dwordx2 v1, v[2:3], s[6:7] offset:16
    v_mov_b32 v2, s90
    v_mov_b32 v3, s91
    global_store_dwordx2 v1, v[2:3], s[6:7] offset:24
    v_mov_b32 v2, s92
    v_mov_b32 v3, s93
    global_store_dwordx2 v1, v[2:3], s[6:7] offset:32
    v_mov_b32 v2, s94
    v_mov_b32 v3, s95
    global_store_dwordx2 v1, v[2:3], s[6:7] offset:40
    v_mov_b32 v2, s96
    v_mov_b32 v3, s97
    global_store_dwordx2 v1, v[2:3], s[6:7] offset:48
    v_mov_b32 v2, s98
    v_mov_b32 v3, s99
    global_store_dwordx2 v1, v[2:3], s[6:7] offset:56
K_STX:
K_EXIT:
    s_endpgm
K_YROW0:
    v_and_b32 v2, 7, v1
    v_lshlrev_b32 v2, 5, v2
    v_add_u32 v2, 158976, v2
    ds_read_b128 v[60:63], v2
    ds_read_b128 v[64:67], v2 offset:16
    s_and_b32 s33, s3, 7
    v_cmp_eq_u32 vcc, s33, v8
    s_cmp_ge_u32 s3, 8
    s_cbranch_scc1 K_YR1_0
    s_waitcnt lgkmcnt(0)
    v_lshlrev_b32 v68, 16, v16
    v_add_f32 v68, v68, v60
    v_cvt_pk_bf16_f32 v68, v68, v68
    v_lshlrev_b32 v68, 16, v68
    v_mul_f32 v68, v68, v48
    v_cndmask_b32 v32, v32, v68, vcc
    v_and_b32 v69, 0xffff0000, v16
    v_add_f32 v69, v69, v61
    v_cvt_pk_bf16_f32 v69, v69, v69
    v_lshlrev_b32 v69, 16, v69
    v_mul_f32 v69, v69, v48
    v_cndmask_b32 v33, v33, v69, vcc
    s_branch K_J53c8
K_STM23:
    s_branch K_STM27
K_STA23:
    s_branch K_STA27
K_J53c8:
    v_lshlrev_b32 v70, 16, v17
    v_add_f32 v70, v70, v62
    v_cvt_pk_bf16_f32 v70, v70, v70
    v_lshlrev_b32 v70, 16, v70
    v_mul_f32 v70, v70, v48
    v_cndmask_b32 v34, v34, v70, vcc
    v_and_b32 v71, 0xffff0000, v17
    v_add_f32 v71, v71, v63
    v_cvt_pk_bf16_f32 v71, v71, v71
    v_lshlrev_b32 v71, 16, v71
    v_mul_f32 v71, v71, v48
    v_cndmask_b32 v35, v35, v71, vcc
    v_lshlrev_b32 v68, 16, v18
    v_add_f32 v68, v68, v64
    v_cvt_pk_bf16_f32 v68, v68, v68
    v_lshlrev_b32 v68, 16, v68
    v_mul_f32 v68, v68, v48
    v_cndmask_b32 v36, v36, v68, vcc
    v_and_b32 v69, 0xffff0000, v18
    v_add_f32 v69, v69, v65
    v_cvt_pk_bf16_f32 v69, v69, v69
    v_lshlrev_b32 v69, 16, v69
    v_mul_f32 v69, v69, v48
    v_cndmask_b32 v37, v37, v69, vcc
    v_lshlrev_b32 v70, 16, v19
    v_add_f32 v70, v70, v66
    v_cvt_pk_bf16_f32 v70, v70, v70
    v_lshlrev_b32 v70, 16, v70
    v_mul_f32 v70, v70, v48
    v_cndmask_b32 v38, v38, v70, vcc
    v_and_b32 v71, 0xffff0000, v19
    v_add_f32 v71, v71, v67
    v_cvt_pk_bf16_f32 v71, v71, v71
    v_lshlrev_b32 v71, 16, v71
    v_mul_f32 v71, v71, v48
    v_cndmask_b32 v39, v39, v71, vcc
    s_branch K_NOY0
K_YR1_0:
    s_waitcnt lgkmcnt(0)
    v_lshlrev_b32 v68, 16, v20
    v_add_f32 v68, v68, v60
    v_cvt_pk_bf16_f32 v68, v68, v68
    v_lshlrev_b32 v68, 16, v68
    v_mul_f32 v68, v68, v49
    v_cndmask_b32 v40, v40, v68, vcc
    v_and_b32 v69, 0xffff0000, v20
    v_add_f32 v69, v69, v61
    v_cvt_pk_bf16_f32 v69, v69, v69
    v_lshlrev_b32 v69, 16, v69
    v_mul_f32 v69, v69, v49
    v_cndmask_b32 v41, v41, v69, vcc
    v_lshlrev_b32 v70, 16, v21
    v_add_f32 v70, v70, v62
    v_cvt_pk_bf16_f32 v70, v70, v70
    v_lshlrev_b32 v70, 16, v70
    v_mul_f32 v70, v70, v49
    v_cndmask_b32 v42, v42, v70, vcc
    v_and_b32 v71, 0xffff0000, v21
    v_add_f32 v71, v71, v63
    v_cvt_pk_bf16_f32 v71, v71, v71
    v_lshlrev_b32 v71, 16, v71
    v_mul_f32 v71, v71, v49
    v_cndmask_b32 v43, v43, v71, vcc
    v_lshlrev_b32 v68, 16, v22
    v_add_f32 v68, v68, v64
    v_cvt_pk_bf16_f32 v68, v68, v68
    v_lshlrev_b32 v68, 16, v68
    v_mul_f32 v68, v68, v49
    v_cndmask_b32 v44, v44, v68, vcc
    v_and_b32 v69, 0xffff0000, v22
    v_add_f32 v69, v69, v65
    v_cvt_pk_bf16_f32 v69, v69, v69
    v_lshlrev_b32 v69, 16, v69
    v_mul_f32 v69, v69, v49
    v_cndmask_b32 v45, v45, v69, vcc
    v_lshlrev_b32 v70, 16, v23
    v_add_f32 v70, v70, v66
    v_cvt_pk_bf16_f32 v70, v70, v70
    v_lshlrev_b32 v70, 16, v70
    v_mul_f32 v70, v70, v49
    v_cndmask_b32 v46, v46, v70, vcc
    v_and_b32 v71, 0xffff0000, v23
    v_add_f32 v71, v71, v67
    v_cvt_pk_bf16_f32 v71, v71, v71
    v_lshlrev_b32 v71, 16, v71
    v_mul_f32 v71, v71, v49
    v_cndmask_b32 v47, v47, v71, vcc
    s_branch K_NOY0
K_YROW1:
    v_and_b32 v2, 7, v1
    v_lshlrev_b32 v2, 5, v2
    v_add_u32 v2, 159232, v2
    ds_read_b128 v[60:63], v2
    ds_read_b128 v[64:67], v2 offset:16
    s_and_b32 s33, s3, 7
    v_cmp_eq_u32 vcc, s33, v8
    s_cmp_ge_u32 s3, 8
    s_cbranch_scc1 K_YR1_1
    s_waitcnt lgkmcnt(0)
    v_lshlrev_b32 v68, 16, v16
    v_add_f32 v68, v68, v60
    v_cvt_pk_bf16_f32 v68, v68, v68
    v_lshlrev_b32 v68, 16, v68
    v_mul_f32 v68, v68, v48
    v_cndmask_b32 v32, v32, v68, vcc
    v_and_b32 v69, 0xffff0000, v16
    v_add_f32 v69, v69, v61
    v_cvt_pk_bf16_f32 v69, v69, v69
    v_lshlrev_b32 v69, 16, v69
    v_mul_f32 v69, v69, v48
    v_cndmask_b32 v33, v33, v69, vcc
    v_lshlrev_b32 v70, 16, v17
    v_add_f32 v70, v70, v62
    v_cvt_pk_bf16_f32 v70, v70, v70
    v_lshlrev_b32 v70, 16, v70
    v_mul_f32 v70, v70, v48
    v_cndmask_b32 v34, v34, v70, vcc
    v_and_b32 v71, 0xffff0000, v17
    v_add_f32 v71, v71, v63
    v_cvt_pk_bf16_f32 v71, v71, v71
    v_lshlrev_b32 v71, 16, v71
    v_mul_f32 v71, v71, v48
    v_cndmask_b32 v35, v35, v71, vcc
    v_lshlrev_b32 v68, 16, v18
    v_add_f32 v68, v68, v64
    v_cvt_pk_bf16_f32 v68, v68, v68
    v_lshlrev_b32 v68, 16, v68
    v_mul_f32 v68, v68, v48
    v_cndmask_b32 v36, v36, v68, vcc
    v_and_b32 v69, 0xffff0000, v18
    v_add_f32 v69, v69, v65
    v_cvt_pk_bf16_f32 v69, v69, v69
    v_lshlrev_b32 v69, 16, v69
    v_mul_f32 v69, v69, v48
    v_cndmask_b32 v37, v37, v69, vcc
    v_lshlrev_b32 v70, 16, v19
    v_add_f32 v70, v70, v66
    v_cvt_pk_bf16_f32 v70, v70, v70
    v_lshlrev_b32 v70, 16, v70
    v_mul_f32 v70, v70, v48
    v_cndmask_b32 v38, v38, v70, vcc
    v_and_b32 v71, 0xffff0000, v19
    v_add_f32 v71, v71, v67
    v_cvt_pk_bf16_f32 v71, v71, v71
    v_lshlrev_b32 v71, 16, v71
    v_mul_f32 v71, v71, v48
    v_cndmask_b32 v39, v39, v71, vcc
    s_branch K_NOY1
K_YR1_1:
    s_waitcnt lgkmcnt(0)
    v_lshlrev_b32 v68, 16, v20
    v_add_f32 v68, v68, v60
    v_cvt_pk_bf16_f32 v68, v68, v68
    v_lshlrev_b32 v68, 16, v68
    v_mul_f32 v68, v68, v49
    v_cndmask_b32 v40, v40, v68, vcc
    v_and_b32 v69, 0xffff0000, v20
    v_add_f32 v69, v69, v61
    v_cvt_pk_bf16_f32 v69, v69, v69
    v_lshlrev_b32 v69, 16, v69
    v_mul_f32 v69, v69, v49
    v_cndmask_b32 v41, v41, v69, vcc
    v_lshlrev_b32 v70, 16, v21
    v_add_f32 v70, v70, v62
    v_cvt_pk_bf16_f32 v70, v70, v70
    v_lshlrev_b32 v70, 16, v70
    v_mul_f32 v70, v70, v49
    v_cndmask_b32 v42, v42, v70, vcc
    v_and_b32 v71, 0xffff0000, v21
    v_add_f32 v71, v71, v63
    v_cvt_pk_bf16_f32 v71, v71, v71
    v_lshlrev_b32 v71, 16, v71
    v_mul_f32 v71, v71, v49
    v_cndmask_b32 v43, v43, v71, vcc
    v_lshlrev_b32 v68, 16, v22
    v_add_f32 v68, v68, v64
    v_cvt_pk_bf16_f32 v68, v68, v68
    v_lshlrev_b32 v68, 16, v68
    v_mul_f32 v68, v68, v49
    v_cndmask_b32 v44, v44, v68, vcc
    v_and_b32 v69, 0xffff0000, v22
    v_add_f32 v69, v69, v65
    v_cvt_pk_bf16_f32 v69, v69, v69
    v_lshlrev_b32 v69, 16, v69
    v_mul_f32 v69, v69, v49
    v_cndmask_b32 v45, v45, v69, vcc
    v_lshlrev_b32 v70, 16, v23
    v_add_f32 v70, v70, v66
    v_cvt_pk_bf16_f32 v70, v70, v70
    v_lshlrev_b32 v70, 16, v70
    v_mul_f32 v70, v70, v49
    v_cndmask_b32 v46, v46, v70, vcc
    v_and_b32 v71, 0xffff0000, v23
    v_add_f32 v71, v71, v67
    s_branch K_J578c
K_STM24:
    s_branch K_STM28
K_STA24:
    s_branch K_STA28
K_J578c:
    v_cvt_pk_bf16_f32 v71, v71, v71
    v_lshlrev_b32 v71, 16, v71
    v_mul_f32 v71, v71, v49
    v_cndmask_b32 v47, v47, v71, vcc
    s_branch K_NOY1
K_SP0:
    ds_read_b32 v2, v15 offset:32
    s_waitcnt lgkmcnt(0)
    v_readfirstlane_b32 s33, v2
    s_nop 3
    s_lshr_b32 s58, s33, s59
    s_lshr_b32 s33, s33, s61
    s_and_b32 s58, s58, s33
    s_andn2_b32 s33, 1, s58
    s_cbranch_scc1 K_SP0
    s_branch K_SPR0
K_SP1:
    ds_read_b32 v2, v15 offset:32
    s_waitcnt lgkmcnt(0)
    v_readfirstlane_b32 s33, v2
    s_nop 3
    s_lshr_b32 s58, s33, s59
    s_lshr_b32 s33, s33, s61
    s_and_b32 s58, s58, s33
    s_andn2_b32 s33, 16, s58
    s_cbranch_scc1 K_SP1
    s_branch K_SPR1
K_SP2:
    ds_read_b32 v2, v15 offset:32
    s_waitcnt lgkmcnt(0)
    v_readfirstlane_b32 s33, v2
    s_nop 3
    s_lshr_b32 s58, s33, s59
    s_lshr_b32 s33, s33, s61
    s_and_b32 s58, s58, s33
    s_andn2_b32 s33, 2, s58
    s_cbranch_scc1 K_SP2
    s_branch K_SPR2
K_SP3:
    ds_read_b32 v2, v15 offset:32
    s_waitcnt lgkmcnt(0)
    v_readfirstlane_b32 s33, v2
    s_nop 3
    s_lshr_b32 s58, s33, s59
    s_lshr_b32 s33, s33, s61
    s_and_b32 s58, s58, s33
    s_andn2_b32 s33, 32, s58
    s_cbranch_scc1 K_SP3
    s_branch K_SPR3
K_SP4:
    ds_read_b32 v2, v15 offset:32
    s_waitcnt lgkmcnt(0)
    v_readfirstlane_b32 s33, v2
    s_nop 3
    s_lshr_b32 s58, s33, s59
    s_lshr_b32 s33, s33, s61
    s_and_b32 s58, s58, s33
    s_andn2_b32 s33, 4, s58
    s_cbranch_scc1 K_SP4
    s_branch K_SPR4
K_SP5:
    ds_read_b32 v2, v15 offset:32
    s_waitcnt lgkmcnt(0)
    v_readfirstlane_b32 s33, v2
    s_nop 3
    s_lshr_b32 s58, s33, s59
    s_lshr_b32 s33, s33, s61
    s_and_b32 s58, s58, s33
    s_andn2_b32 s33, 64, s58
    s_cbranch_scc1 K_SP5
    s_branch K_SPR5
K_SP6:
    ds_read_b32 v2, v15 offset:32
    s_waitcnt lgkmcnt(0)
    v_readfirstlane_b32 s33, v2
    s_nop 3
    s_lshr_b32 s58, s33, s59
    s_lshr_b32 s33, s33, s61
    s_and_b32 s58, s58, s33
    s_andn2_b32 s33, 8, s58
    s_cbranch_scc1 K_SP6
    s_branch K_SPR6
K_SP7:
    ds_read_b32 v2, v15 offset:32
    s_waitcnt lgkmcnt(0)
    v_readfirstlane_b32 s33, v2
    s_nop 3
    s_lshr_b32 s58, s33, s59
    s_lshr_b32 s33, s33, s61
    s_and_b32 s58, s58, s33
    s_andn2_b32 s33, 128, s58
    s_cbranch_scc1 K_SP7
    s_branch K_SPR7
K_SP8:
    ds_read_b32 v2, v15 offset:32
    s_waitcnt lgkmcnt(0)
    v_readfirstlane_b32 s33, v2
    s_nop 3
    s_lshr_b32 s58, s33, s59
    s_lshr_b32 s33, s33, s61
    s_and_b32 s58, s58, s33
    s_andn2_b32 s33, 15, s58
    s_cbranch_scc1 K_SP8
    s_branch K_SPR8
K_SP9:
    ds_read_b32 v2, v15 offset:32
    s_waitcnt lgkmcnt(0)
    v_readfirstlane_b32 s33, v2
    s_nop 3
    s_lshr_b32 s58, s33, s59
    s_lshr_b32 s33, s33, s61
    s_and_b32 s58, s58, s33
    s_andn2_b32 s33, 240, s58
    s_cbranch_scc1 K_SP9
    s_branch K_SPR9
K_SP10:
    ds_read_b32 v2, v15 offset:32
    s_waitcnt lgkmcnt(0)
    v_readfirstlane_b32 s33, v2
    s_nop 3
    s_lshr_b32 s58, s33, s59
    s_lshr_b32 s33, s33, s61
    s_and_b32 s58, s58, s33
    s_andn2_b32 s33, 256, s58
    s_cbranch_scc1 K_SP10
    s_branch K_SPR10
K_STM25:
    s_branch K_STM29
K_STA25:
    s_branch K_STA29
K_SP11:
    ds_read_b32 v2, v15 offset:32
    s_waitcnt lgkmcnt(0)
    v_readfirstlane_b32 s33, v2
    s_nop 3
    s_lshr_b32 s58, s33, s59
    s_lshr_b32 s33, s33, s61
    s_and_b32 s58, s58, s33
    s_andn2_b32 s33, 4096, s58
    s_cbranch_scc1 K_SP11
    s_branch K_SPR11
K_SP12:
    ds_read_b32 v2, v15 offset:32
    s_waitcnt lgkmcnt(0)
    v_readfirstlane_b32 s33, v2
    s_nop 3
    s_lshr_b32 s58, s33, s59
    s_lshr_b32 s33, s33, s61
    s_and_b32 s58, s58, s33
    s_andn2_b32 s33, 512, s58
    s_cbranch_scc1 K_SP12
    s_branch K_SPR12
K_SP13:
    ds_read_b32 v2, v15 offset:32
    s_waitcnt lgkmcnt(0)
    v_readfirstlane_b32 s33, v2
    s_nop 3
    s_lshr_b32 s58, s33, s59
    s_lshr_b32 s33, s33, s61
    s_and_b32 s58, s58, s33
    s_andn2_b32 s33, 8192, s58
    s_cbranch_scc1 K_SP13
    s_branch K_SPR13
K_SP14:
    ds_read_b32 v2, v15 offset:32
    s_waitcnt lgkmcnt(0)
    v_readfirstlane_b32 s33, v2
    s_nop 3
    s_lshr_b32 s58, s33, s59
    s_lshr_b32 s33, s33, s61
    s_and_b32 s58, s58, s33
    s_andn2_b32 s33, 1024, s58
    s_cbranch_scc1 K_SP14
    s_branch K_SPR14
K_SP15:
    ds_read_b32 v2, v15 offset:32
    s_waitcnt lgkmcnt(0)
    v_readfirstlane_b32 s33, v2
    s_nop 3
    s_lshr_b32 s58, s33, s59
    s_lshr_b32 s33, s33, s61
    s_and_b32 s58, s58, s33
    s_andn2_b32 s33, 16384, s58
    s_cbranch_scc1 K_SP15
    s_branch K_SPR15
K_SP16:
    ds_read_b32 v2, v15 offset:32
    s_waitcnt lgkmcnt(0)
    v_readfirstlane_b32 s33, v2
    s_nop 3
    s_lshr_b32 s58, s33, s59
    s_lshr_b32 s33, s33, s61
    s_and_b32 s58, s58, s33
    s_andn2_b32 s33, 2048, s58
    s_cbranch_scc1 K_SP16
    s_branch K_SPR16
K_SP17:
    ds_read_b32 v2, v15 offset:32
    s_waitcnt lgkmcnt(0)
    v_readfirstlane_b32 s33, v2
    s_nop 3
    s_lshr_b32 s58, s33, s59
    s_lshr_b32 s33, s33, s61
    s_and_b32 s58, s58, s33
    s_andn2_b32 s33, 32768, s58
    s_cbranch_scc1 K_SP17
    s_branch K_SPR17
K_SP18:
    ds_read_b32 v2, v15 offset:32
    s_waitcnt lgkmcnt(0)
    v_readfirstlane_b32 s33, v2
    s_nop 3
    s_lshr_b32 s58, s33, s59
    s_lshr_b32 s33, s33, s61
    s_and_b32 s58, s58, s33
    s_andn2_b32 s33, 3840, s58
    s_cbranch_scc1 K_SP18
    s_branch K_SPR18
K_SP19:
    ds_read_b32 v2, v15 offset:32
    s_waitcnt lgkmcnt(0)
    v_readfirstlane_b32 s33, v2
    s_nop 3
    s_lshr_b32 s58, s33, s59
    s_lshr_b32 s33, s33, s61
    s_and_b32 s58, s58, s33
    s_andn2_b32 s33, 61440, s58
    s_cbranch_scc1 K_SP19
    s_branch K_SPR19
K_P2:
    s_cmp_ge_u32 s30, 4
    s_cbranch_scc1 K_P2_HELP
    s_lshl_b32 s54, s40, 7
    v_lshrrev_b32 v8, 3, v1
    v_lshrrev_b32 v9, 4, v1
    v_mov_b32 v15, 158720
    s_lshl_b32 s53, s40, 3
    s_add_u32 s53, s53, s30
    s_mul_i32 s3, s53, 20480
    s_lshl_b32 s33, s41, 7
    s_add_u32 s3, s3, s33
    v_and_b32 v2, 7, v1
    v_lshlrev_b32 v2, 4, v2
    v_mul_u32_u24 v4, 1280, v8
    v_add3_u32 v10, v2, v4, s3
    s_lshl_b32 s3, s53, 6
    v_lshl_add_u32 v11, v8, 2, s3
    s_mov_b32 s55, 10240
    s_add_u32 s20, s6, 0x100000
    s_addc_u32 s21, s7, 0
    s_mov_b32 s22, 0x280000
    s_mov_b32 s23, 0x20000
    s_add_u32 s16, s6, 0x1000
    s_addc_u32 s17, s7, 0
    s_mov_b32 s18, 0x2000
    s_mov_b32 s19, 0x20000
    s_mov_b32 s48, s10
    s_mov_b32 s49, s11
    s_mov_b32 s50, 0x280000
    s_mov_b32 s51, 0x20000
    v_mul_u32_u24 v3, 144, v8
    v_add_u32 v3, v2, v3
    s_mul_i32 s3, s30, 2304
    s_add_u32 s3, s3, 140288
    v_add_u32 v14, s3, v3
    v_bfe_u32 v50, v1, 2, 2
    v_and_b32 v51, 3, v1
    s_add_u32 s3, s53, s30
    s_mul_i32 s3, s3, 20480
    v_lshl_add_u32 v54, v1, 4, s3
    v_add_u32 v55, 20480, v54
    v_lshl_add_u32 v2, v9, 2, v50
    v_bfe_u32 v3, v2, 1, 2
    v_lshlrev_b32 v2, 7, v2
    v_lshl_add_u32 v2, v51, 3, v2
    v_xor_b32 v4, 0, v3
    v_lshl_add_u32 v56, v4, 5, v2
    v_add_u32 v60, 40960, v56
    v_xor_b32 v4, 1, v3
    v_lshl_add_u32 v57, v4, 5, v2
    v_add_u32 v61, 40960, v57
    v_xor_b32 v4, 2, v3
    v_lshl_add_u32 v58, v4, 5, v2
    v_add_u32 v62, 40960, v58
    v_xor_b32 v4, 3, v3
    v_lshl_add_u32 v59, v4, 5, v2
    v_add_u32 v63, 40960, v59
    v_lshrrev_b32 v3, 1, v50
    v_mul_u32_u24 v2, 40, v9
    v_add3_u32 v2, v2, 16, v50
    v_lshlrev_b32 v2, 7, v2
    v_lshl_add_u32 v2, v51, 3, v2
    v_xor_b32 v4, 0, v3
    v_lshl_add_u32 v64, v4, 5, v2
    v_xor_b32 v4, 1, v3
    v_lshl_add_u32 v65, v4, 5, v2
    v_xor_b32 v4, 2, v3
    v_lshl_add_u32 v66, v4, 5, v2
    v_xor_b32 v4, 3, v3
    v_lshl_add_u32 v67, v4, 5, v2
    v_and_b32 v2, 15, v1
    v_mul_u32_u24 v2, 144, v2
    v_lshl_add_u32 v2, v9, 3, v2
    s_mul_i32 s3, s30, 4608
    s_add_u32 s3, s3, 140288
    v_add_u32 v52, s3, v2
    s_mov_b32 s67, 0
    s_mov_b32 s68, 4096
    s_mov_b32 s69, 8192
    s_mov_b32 s70, 12288
    s_mov_b32 s71, 16384
K_P2_AUXW:
    v_lshrrev_b32 v2, 3, v1
    v_mul_u32_u24 v2, 1280, v2
    s_branch K_J5d60
K_STM26:
    s_branch K_WRET_M
K_STA26:
    s_branch K_WRET_A
K_J5d60:
    v_lshrrev_b32 v3, 4, v1
    v_lshlrev_b32 v3, 1, v3
    v_and_b32 v4, 7, v1
    v_xor_b32 v3, v3, v4
    v_lshl_add_u32 v2, v3, 4, v2
    s_lshl_b32 s33, s41, 7
    v_add_u32 v53, s33, v2
    s_lshl_b32 s60, s30, 2
    s_lshr_b32 s60, 0x7520, s60
    s_and_b32 s60, s60, 7
    s_mul_i32 s60, s60, 51200
    s_mul_i32 s61, s30, 5120
    s_add_u32 s52, s60, 0
    s_add_u32 m0, s61, 0
    s_waitcnt vmcnt(5)
    buffer_load_dwordx4 v53, s[24:27], s52 offen lds
    s_add_u32 s52, s60, 10240
    s_add_u32 m0, s61, 1024
    s_waitcnt vmcnt(5)
    buffer_load_dwordx4 v53, s[24:27], s52 offen lds
    s_add_u32 s52, s60, 20480
    s_add_u32 m0, s61, 2048
    s_waitcnt vmcnt(5)
    buffer_load_dwordx4 v53, s[24:27], s52 offen lds
    s_add_u32 s52, s60, 30720
    s_add_u32 m0, s61, 3072
    s_waitcnt vmcnt(5)
    buffer_load_dwordx4 v53, s[24:27], s52 offen lds
    s_add_u32 s52, s60, 40960
    s_add_u32 m0, s61, 4096
    s_waitcnt vmcnt(5)
    buffer_load_dwordx4 v53, s[24:27], s52 offen lds
    s_add_u32 s52, s60, 409600
    s_add_u32 m0, s61, 20480
    s_waitcnt vmcnt(5)
    buffer_load_dwordx4 v53, s[24:27], s52 offen lds
    s_add_u32 s52, s60, 419840
    s_add_u32 m0, s61, 21504
    s_waitcnt vmcnt(5)
    buffer_load_dwordx4 v53, s[24:27], s52 offen lds
    s_add_u32 s52, s60, 430080
    s_add_u32 m0, s61, 22528
    s_waitcnt vmcnt(5)
    buffer_load_dwordx4 v53, s[24:27], s52 offen lds
    s_add_u32 s52, s60, 440320
    s_add_u32 m0, s61, 23552
    s_waitcnt vmcnt(5)
    buffer_load_dwordx4 v53, s[24:27], s52 offen lds
    s_add_u32 s52, s60, 450560
    s_add_u32 m0, s61, 24576
    s_waitcnt vmcnt(5)
    buffer_load_dwordx4 v53, s[24:27], s52 offen lds
    s_lshl_b32 s60, s30, 2
    s_lshr_b32 s60, 0x6431, s60
    s_and_b32 s60, s60, 7
    s_mul_i32 s60, s60, 51200
    s_mul_i32 s61, s30, 5120
    s_add_u32 s52, s60, 0
    s_add_u32 m0, s61, 40960
    s_waitcnt vmcnt(5)
    buffer_load_dwordx4 v53, s[24:27], s52 offen lds
    s_add_u32 s52, s60, 10240
    s_add_u32 m0, s61, 41984
    s_waitcnt vmcnt(5)
    buffer_load_dwordx4 v53, s[24:27], s52 offen lds
    s_add_u32 s52, s60, 20480
    s_add_u32 m0, s61, 43008
    s_waitcnt vmcnt(5)
    buffer_load_dwordx4 v53, s[24:27], s52 offen lds
    s_add_u32 s52, s60, 30720
    s_add_u32 m0, s61, 44032
    s_waitcnt vmcnt(5)
    buffer_load_dwordx4 v53, s[24:27], s52 offen lds
    s_add_u32 s52, s60, 40960
    s_add_u32 m0, s61, 45056
    s_waitcnt vmcnt(5)
    buffer_load_dwordx4 v53, s[24:27], s52 offen lds
    s_add_u32 s52, s60, 409600
    s_add_u32 m0, s61, 61440
    s_waitcnt vmcnt(5)
    buffer_load_dwordx4 v53, s[24:27], s52 offen lds
    s_add_u32 s52, s60, 419840
    s_add_u32 m0, s61, 62464
    s_waitcnt vmcnt(5)
    buffer_load_dwordx4 v53, s[24:27], s52 offen lds
    s_add_u32 s52, s60, 430080
    s_add_u32 m0, s61, 63488
    s_waitcnt vmcnt(5)
    buffer_load_dwordx4 v53, s[24:27], s52 offen lds
    s_add_u32 s52, s60, 440320
    s_add_u32 m0, s61, 64512
    s_waitcnt vmcnt(5)
    buffer_load_dwordx4 v53, s[24:27], s52 offen lds
    s_add_u32 s52, s60, 450560
    s_add_u32 m0, s61, 65536
    s_waitcnt vmcnt(5)
    buffer_load_dwordx4 v53, s[24:27], s52 offen lds
    s_cmp_eq_u32 s30, 0
    s_cbranch_scc1 K_CHA0
    s_cmp_eq_u32 s30, 1
    s_branch K_PG5
.p2align 12
K_STM27:
    s_branch K_WRET_M
K_STA27:
    s_branch K_WRET_A
K_PG5:
    s_cbranch_scc1 K_CHA1
    s_cmp_eq_u32 s30, 2
    s_cbranch_scc1 K_CHA2
    s_branch K_CHA3
K_WRET_A:
    v_mov_b32 v3, 1
    s_waitcnt vmcnt(0)
    s_mov_b64 exec, 1
    ds_add_u32 v15, v3 offset:44
    s_mov_b64 exec, -1
    s_mov_b32 s3, 1048576
K_P2_GWA:
    ds_read_b32 v2, v15 offset:44
    s_sub_u32 s3, s3, 1
    s_waitcnt lgkmcnt(0)
    v_readfirstlane_b32 s33, v2
    s_nop 3
    s_cselect_b32 s33, 4, s33
    s_cmp_lt_u32 s33, 4
    s_cbranch_scc1 K_P2_GWA
    s_branch K_P2_GEMM
K_P2_HELP:
    s_setprio 3
    s_lshl_b32 s53, s40, 3
    s_mul_i32 s60, s53, 187
    s_lshr_b32 s60, s60, 11
    s_add_u32 s3, s53, 7
    s_mul_i32 s61, s3, 187
    s_lshr_b32 s61, s61, 11
    s_sub_u32 s61, s61, s60
    s_lshl_b32 s61, s61, 4
    s_or_b32 s61, s61, 15
    v_and_b32 v12, s61, v1
    v_lshl_add_u32 v12, v12, 2, s42
    s_cmp_lg_u32 s30, 7
    s_cbranch_scc1 K_P2_N7
    v_mov_b32 v4, 192
    s_mov_b32 s3, 131072
K_ZPOLL1:
    v_readfirstlane_b32 s33, v7
    s_nop 3
    s_sub_u32 s3, s3, 1
    s_cselect_b32 s33, 1, s33
    s_cmp_lg_u32 s33, 0
    s_cbranch_scc1 K_ZOK1
    global_load_dword v7, v4, s[4:5] sc1
    s_waitcnt vmcnt(0)
    s_branch K_ZPOLL1
K_ZOK1:
    global_load_dword v7, v12, s[6:7] sc1
K_P2_N7:
    s_lshl_b32 s54, s40, 7
    v_lshrrev_b32 v8, 3, v1
    v_lshrrev_b32 v9, 4, v1
    v_mov_b32 v15, 158720
    s_lshl_b32 s53, s40, 3
    s_add_u32 s53, s53, s30
    s_mul_i32 s3, s53, 20480
    s_lshl_b32 s33, s41, 7
    s_add_u32 s3, s3, s33
    v_and_b32 v2, 7, v1
    v_lshlrev_b32 v2, 4, v2
    v_mul_u32_u24 v4, 1280, v8
    v_add3_u32 v10, v2, v4, s3
    s_lshl_b32 s3, s53, 6
    v_lshl_add_u32 v11, v8, 2, s3
    s_mov_b32 s55, 10240
    s_add_u32 s20, s6, 0x100000
    s_addc_u32 s21, s7, 0
    s_mov_b32 s22, 0x280000
    s_mov_b32 s23, 0x20000
    s_add_u32 s16, s6, 0x1000
    s_addc_u32 s17, s7, 0
    s_mov_b32 s18, 0x2000
    s_mov_b32 s19, 0x20000
    s_mov_b32 s48, s10
    s_mov_b32 s49, s11
    s_mov_b32 s50, 0x280000
    s_mov_b32 s51, 0x20000
    v_mul_u32_u24 v3, 144, v8
    v_add_u32 v3, v2, v3
    s_mul_i32 s3, s30, 2304
    s_add_u32 s3, s3, 140288
    v_add_u32 v14, s3, v3
    s_add_u32 s44, s6, 0x10000
    s_addc_u32 s45, s7, 0
    s_mov_b32 s46, 0x43800
    s_mov_b32 s47, 0x20000
    v_mov_b32 v112, 1
    s_cmp_eq_u32 s30, 7
    s_cbranch_scc1 K_P2_FLAGS
    buffer_load_dwordx4 v[16:19], v10, s[12:15], 0 offen
    buffer_load_dwordx4 v[20:23], v10, s[12:15], s55 offen
    s_cmp_lg_u32 s30, 6
    s_cbranch_scc1 K_P2_HW
    s_mov_b32 s3, 131072
K_P2_DPOLL:
    v_cmp_eq_u32 vcc, 0, v7
    s_cbranch_vccz K_P2_DOK
    s_cmp_eq_u32 s3, 131072
    s_cbranch_scc1 K_P2_DNS
    s_sleep 12
K_P2_DNS:
    v_min_u32 v13, 23, v1
    v_lshl_add_u32 v13, v13, 2, s42
    global_load_dword v7, v13, s[6:7] offset:128 sc1
    s_sub_u32 s3, s3, 1
    s_waitcnt vmcnt(0)
    s_cmp_lg_u32 s3, 0
    s_cbranch_scc1 K_P2_DPOLL
K_P2_DOK:
    v_cmp_gt_u32 vcc, 16, v1
    s_nop 1
    v_cndmask_b32 v2, 0, v7, vcc
    s_nop 1
    v_max_u32_dpp v3, v2, v2 quad_perm:[1,0,3,2] row_mask:0xf bank_mask:0xf
    s_nop 1
    v_max_u32_dpp v3, v3, v3 quad_perm:[2,3,0,1] row_mask:0xf bank_mask:0xf
    s_nop 1
    v_max_u32_dpp v3, v3, v3 row_half_mirror row_mask:0xf bank_mask:0xf
    s_nop 1
    v_max_u32_dpp v3, v3, v3 row_mirror row_mask:0xf bank_mask:0xf
    s_nop 1
    v_readlane_b32 s60, v3, 0
    v_readlane_b32 s64, v3, 16
    v_readlane_b32 s65, v3, 32
    v_readlane_b32 s66, v3, 48
    s_nop 3
    s_max_u32 s60, s60, s64
    s_max_u32 s65, s65, s66
    s_max_u32 s60, s60, s65
    v_cmp_ne_u32 vcc, s60, v2
    s_nop 1
    v_cndmask_b32 v2, 0, v2, vcc
    s_nop 1
    v_max_u32_dpp v3, v2, v2 quad_perm:[1,0,3,2] row_mask:0xf bank_mask:0xf
    s_nop 1
    v_max_u32_dpp v3, v3, v3 quad_perm:[2,3,0,1] row_mask:0xf bank_mask:0xf
    s_nop 1
    v_max_u32_dpp v3, v3, v3 row_half_mirror row_mask:0xf bank_mask:0xf
    s_nop 1
    v_max_u32_dpp v3, v3, v3 row_mirror row_mask:0xf bank_mask:0xf
    s_nop 1
    v_readlane_b32 s61, v3, 0
    v_readlane_b32 s64, v3, 16
    v_readlane_b32 s65, v3, 32
    v_readlane_b32 s66, v3, 48
    s_nop 3
    s_max_u32 s61, s61, s64
    s_max_u32 s65, s65, s66
    s_max_u32 s61, s61, s65
    s_and_b32 s3, s60, 0x7ff
    s_sub_u32 s3, 2047, s3
    v_mov_b32 v52, s3
    v_mov_b32 v4, s60
    v_and_b32 v4, 0xffff0000, v4
    v_ashrrev_i32 v5, 31, v4
    v_not_b32 v5, v5
    v_or_b32 v5, 0x80000000, v5
    v_xor_b32 v4, v4, v5
    v_and_b32 v4, 0xffff0000, v4
    v_mul_f32 v5, 0xbfb8aa3b, v4
    v_exp_f32 v5, v5
    s_nop 0
    v_add_f32 v5, 1.0, v5
    v_rcp_f32 v4, v5
    s_nop 0
    v_cvt_pk_bf16_f32 v54, v4, v4
    v_lshlrev_b32 v54, 16, v54
    s_and_b32 s3, s61, 0x7ff
    s_sub_u32 s3, 2047, s3
    v_mov_b32 v53, s3
    v_mov_b32 v4, s61
    v_and_b32 v4, 0xffff0000, v4
    v_ashrrev_i32 v5, 31, v4
    v_not_b32 v5, v5
    v_or_b32 v5, 0x80000000, v5
    v_xor_b32 v4, v4, v5
    v_and_b32 v4, 0xffff0000, v4
    v_mul_f32 v5, 0xbfb8aa3b, v4
    v_exp_f32 v5, v5
    s_nop 0
    v_add_f32 v5, 1.0, v5
    v_rcp_f32 v4, v5
    s_branch K_J63c8
K_STM28:
    s_branch K_WRET_M
K_STA28:
    s_branch K_WRET_A
K_J63c8:
    s_nop 0
    v_cvt_pk_bf16_f32 v55, v4, v4
    v_lshlrev_b32 v55, 16, v55
    ds_write_b128 v15, v[52:55]
    ds_write_b32 v15, v112 offset:40
K_P2_HW:
    s_mov_b32 s3, 1048576
K_P2_GS2:
    ds_read_b32 v2, v15 offset:40
    s_sleep 1
    s_sub_u32 s3, s3, 1
    s_waitcnt lgkmcnt(0)
    v_readfirstlane_b32 s33, v2
    s_nop 3
    s_cselect_b32 s33, 1, s33
    s_cmp_lt_u32 s33, 1
    s_cbranch_scc1 K_P2_GS2
    buffer_load_dword v24, v11, s[16:19], 0 offen sc1
    buffer_load_dword v25, v11, s[16:19], 0 offen offset:32 sc1
    ds_read_b128 v[28:31], v15
    s_cmp_eq_u32 s30, 6
    s_cbranch_scc1 K_P2_E
    s_waitcnt lgkmcnt(0)
    s_cmp_eq_u32 s30, 4
    s_cselect_b64 vcc, -1, 0
    s_nop 1
    v_cndmask_b32 v2, v29, v28, vcc
    v_cndmask_b32 v5, v31, v30, vcc
    s_nop 0
    v_readfirstlane_b32 s60, v2
    s_nop 3
    s_sub_u32 s3, s60, s54
    s_cmp_lt_u32 s3, 128
    s_cbranch_scc0 K_P2_E
    v_min_u32 v3, 53, v1
    v_lshlrev_b32 v3, 5, v3
    v_add_u32 v3, 565248, v3
    s_mov_b32 s3, 1048576
K_P2_GY:
    ds_read_b32 v2, v15 offset:32
    s_sleep 1
    s_sub_u32 s3, s3, 1
    s_waitcnt lgkmcnt(0)
    v_readfirstlane_b32 s33, v2
    s_nop 3
    s_cselect_b32 s33, 16777216, s33
    s_cmp_lt_u32 s33, 16777216
    s_cbranch_scc1 K_P2_GY
    s_mov_b32 s3, 131072
K_P2_YPOLL:
    global_load_dwordx4 v[52:55], v3, s[6:7] sc1
    s_sub_u32 s3, s3, 1
    s_waitcnt vmcnt(0)
    v_and_b32 v2, v52, v53
    v_and_b32 v2, v2, v54
    v_and_b32 v2, v2, v55
    v_cmp_ne_u32 vcc, 1, v2
    s_cbranch_vccz K_P2_YGO
    s_sleep 8
    s_cmp_lg_u32 s3, 0
    s_cbranch_scc1 K_P2_YPOLL
K_P2_YGO:
    v_and_b32 v2, 15, v1
    v_lshlrev_b32 v2, 4, v2
    v_mul_u32_u24 v4, 5120, v9
    s_sub_u32 s61, s30, 4
    s_mul_i32 s33, s61, 2560
    s_lshl_b32 s3, s41, 8
    s_add_u32 s3, s3, s33
    v_add3_u32 v3, v2, v4, s3
    s_mov_b32 s52, 0
    buffer_load_dwordx4 v[56:59], v3, s[44:47], s52 offen sc1
    s_mov_b32 s52, 20480
    buffer_load_dwordx4 v[60:63], v3, s[44:47], s52 offen sc1
    s_mov_b32 s52, 40960
    buffer_load_dwordx4 v[64:67], v3, s[44:47], s52 offen sc1
    s_mov_b32 s52, 61440
    buffer_load_dwordx4 v[68:71], v3, s[44:47], s52 offen sc1
    s_mov_b32 s52, 81920
    buffer_load_dwordx4 v[72:75], v3, s[44:47], s52 offen sc1
    s_mov_b32 s52, 102400
    buffer_load_dwordx4 v[76:79], v3, s[44:47], s52 offen sc1
    s_mov_b32 s52, 122880
    buffer_load_dwordx4 v[80:83], v3, s[44:47], s52 offen sc1
    s_mov_b32 s52, 143360
    buffer_load_dwordx4 v[84:87], v3, s[44:47], s52 offen sc1
    s_mov_b32 s52, 163840
    buffer_load_dwordx4 v[88:91], v3, s[44:47], s52 offen sc1
    s_mov_b32 s52, 184320
    buffer_load_dwordx4 v[92:95], v3, s[44:47], s52 offen sc1
    s_mov_b32 s52, 204800
    buffer_load_dwordx4 v[96:99], v3, s[44:47], s52 offen sc1
    s_mov_b32 s52, 225280
    buffer_load_dwordx4 v[100:103], v3, s[44:47], s52 offen sc1
    s_mov_b32 s52, 245760
    buffer_load_dwordx4 v[104:107], v3, s[44:47], s52 offen sc1
    s_mov_b32 s52, 266240
    buffer_load_dwordx4 v[108:111], v3, s[44:47], s52 offen sc1
    s_waitcnt vmcnt(12)
    v_add_f32 v52, v56, v60
    v_add_f32 v53, v57, v61
    v_add_f32 v54, v58, v62
    v_add_f32 v55, v59, v63
    s_waitcnt vmcnt(11)
    v_add_f32 v52, v52, v64
    v_add_f32 v53, v53, v65
    v_add_f32 v54, v54, v66
    v_add_f32 v55, v55, v67
    s_waitcnt vmcnt(10)
    v_add_f32 v52, v52, v68
    v_add_f32 v53, v53, v69
    v_add_f32 v54, v54, v70
    v_add_f32 v55, v55, v71
    s_waitcnt vmcnt(9)
    v_add_f32 v52, v52, v72
    v_add_f32 v53, v53, v73
    v_add_f32 v54, v54, v74
    v_add_f32 v55, v55, v75
    s_waitcnt vmcnt(8)
    v_add_f32 v52, v52, v76
    v_add_f32 v53, v53, v77
    v_add_f32 v54, v54, v78
    v_add_f32 v55, v55, v79
    s_waitcnt vmcnt(7)
    v_add_f32 v52, v52, v80
    v_add_f32 v53, v53, v81
    v_add_f32 v54, v54, v82
    v_add_f32 v55, v55, v83
    s_waitcnt vmcnt(6)
    v_add_f32 v52, v52, v84
    v_add_f32 v53, v53, v85
    v_add_f32 v54, v54, v86
    v_add_f32 v55, v55, v87
    s_waitcnt vmcnt(5)
    v_add_f32 v52, v52, v88
    v_add_f32 v53, v53, v89
    v_add_f32 v54, v54, v90
    v_add_f32 v55, v55, v91
    s_waitcnt vmcnt(4)
    v_add_f32 v52, v52, v92
    v_add_f32 v53, v53, v93
    v_add_f32 v54, v54, v94
    v_add_f32 v55, v55, v95
    s_waitcnt vmcnt(3)
    v_add_f32 v52, v52, v96
    v_add_f32 v53, v53, v97
    v_add_f32 v54, v54, v98
    v_add_f32 v55, v55, v99
    s_waitcnt vmcnt(2)
    v_add_f32 v52, v52, v100
    v_add_f32 v53, v53, v101
    v_add_f32 v54, v54, v102
    v_add_f32 v55, v55, v103
    s_waitcnt vmcnt(1)
    v_add_f32 v52, v52, v104
    v_add_f32 v53, v53, v105
    v_add_f32 v54, v54, v106
    v_add_f32 v55, v55, v107
    s_waitcnt vmcnt(0)
    v_add_f32 v52, v52, v108
    v_add_f32 v53, v53, v109
    v_add_f32 v54, v54, v110
    v_add_f32 v55, v55, v111
    v_mov_b32 v56, v52
    v_mov_b32 v57, v53
    v_mov_b32 v58, v54
    v_mov_b32 v59, v55
    s_nop 0
    v_permlane16_swap_b32 v52, v56
    v_permlane16_swap_b32 v53, v57
    v_permlane16_swap_b32 v54, v58
    v_permlane16_swap_b32 v55, v59
    v_add_f32 v52, v52, v56
    v_add_f32 v53, v53, v57
    v_add_f32 v54, v54, v58
    v_add_f32 v55, v55, v59
    v_mov_b32 v56, v52
    v_mov_b32 v57, v53
    v_mov_b32 v58, v54
    v_mov_b32 v59, v55
    s_nop 0
    v_permlane32_swap_b32 v52, v56
    v_permlane32_swap_b32 v53, v57
    v_permlane32_swap_b32 v54, v58
    v_permlane32_swap_b32 v55, v59
    v_add_f32 v52, v52, v56
    v_add_f32 v53, v53, v57
    v_add_f32 v54, v54, v58
    v_add_f32 v55, v55, v59
    v_cvt_pk_bf16_f32 v52, v52, v52
    v_lshlrev_b32 v52, 16, v52
    v_mul_f32 v52, v5, v52
    v_cvt_pk_bf16_f32 v52, v52, v52
    v_lshlrev_b32 v52, 16, v52
    v_cvt_pk_bf16_f32 v53, v53, v53
    s_branch K_J6790
K_STM29:
    s_branch K_WRET_M
K_STA29:
    s_branch K_WRET_A
K_J6790:
    v_lshlrev_b32 v53, 16, v53
    v_mul_f32 v53, v5, v53
    v_cvt_pk_bf16_f32 v53, v53, v53
    v_lshlrev_b32 v53, 16, v53
    v_cvt_pk_bf16_f32 v54, v54, v54
    v_lshlrev_b32 v54, 16, v54
    v_mul_f32 v54, v5, v54
    v_cvt_pk_bf16_f32 v54, v54, v54
    v_lshlrev_b32 v54, 16, v54
    v_cvt_pk_bf16_f32 v55, v55, v55
    v_lshlrev_b32 v55, 16, v55
    v_mul_f32 v55, v5, v55
    v_cvt_pk_bf16_f32 v55, v55, v55
    v_lshlrev_b32 v55, 16, v55
    s_lshl_b32 s3, s61, 8
    s_add_u32 s3, s3, 158976
    v_add_u32 v2, s3, v2
    ds_write_b128 v2, v[52:55]
    s_branch K_P2_E
K_P2_FLAGS:
    s_mov_b32 exec_hi, 0
    s_waitcnt vmcnt(0)
    s_mov_b32 s3, 131072
K_P2_FCHK:
    v_cmp_eq_u32 vcc, 1, v7
    s_nop 1
    v_mov_b32 v2, vcc_lo
    ds_write_b32 v15, v2 offset:32
    s_cmp_eq_u32 vcc_lo, -1
    s_cbranch_scc1 K_P2_FGO
    s_cmp_lg_u32 vcc_lo, 0
    s_cbranch_scc1 K_P2_FS
    s_sleep 16
K_P2_FS:
    s_sleep 6
    global_load_dword v7, v12, s[6:7] sc1
    s_sub_u32 s3, s3, 1
    s_waitcnt vmcnt(0)
    s_cbranch_scc0 K_P2_FCHK
    v_mov_b32 v2, -1
    ds_write_b32 v15, v2 offset:32
K_P2_FGO:
    s_mov_b64 exec, -1
    buffer_load_dwordx4 v[16:19], v10, s[12:15], 0 offen
    buffer_load_dwordx4 v[20:23], v10, s[12:15], s55 offen
    s_mov_b32 s3, 1048576
K_P2_GS3:
    ds_read_b32 v2, v15 offset:40
    s_sleep 1
    s_sub_u32 s3, s3, 1
    s_waitcnt lgkmcnt(0)
    v_readfirstlane_b32 s33, v2
    s_nop 3
    s_cselect_b32 s33, 1, s33
    s_cmp_lt_u32 s33, 1
    s_cbranch_scc1 K_P2_GS3
    buffer_load_dword v24, v11, s[16:19], 0 offen sc1
    buffer_load_dword v25, v11, s[16:19], 0 offen offset:32 sc1
    ds_read_b128 v[28:31], v15
K_P2_E:
    s_setprio 0
    s_waitcnt vmcnt(0)
    v_sub_f32 v48, 1.0, v24
    v_cvt_pk_bf16_f32 v48, v48, v48
    v_lshlrev_b32 v48, 16, v48
    v_sub_f32 v49, 1.0, v25
    v_cvt_pk_bf16_f32 v49, v49, v49
    v_lshlrev_b32 v49, 16, v49
    v_lshlrev_b32 v32, 16, v16
    v_and_b32 v33, 0xffff0000, v16
    v_lshlrev_b32 v34, 16, v17
    v_and_b32 v35, 0xffff0000, v17
    v_lshlrev_b32 v36, 16, v18
    v_and_b32 v37, 0xffff0000, v18
    v_lshlrev_b32 v38, 16, v19
    v_and_b32 v39, 0xffff0000, v19
    v_lshlrev_b32 v40, 16, v20
    v_and_b32 v41, 0xffff0000, v20
    v_lshlrev_b32 v42, 16, v21
    v_and_b32 v43, 0xffff0000, v21
    v_lshlrev_b32 v44, 16, v22
    v_and_b32 v45, 0xffff0000, v22
    v_lshlrev_b32 v46, 16, v23
    v_and_b32 v47, 0xffff0000, v23
    v_mul_f32 v32, v32, v48
    v_mul_f32 v33, v33, v48
    v_mul_f32 v34, v34, v48
    v_mul_f32 v35, v35, v48
    v_mul_f32 v36, v36, v48
    v_mul_f32 v37, v37, v48
    v_mul_f32 v38, v38, v48
    v_mul_f32 v39, v39, v48
    v_mul_f32 v40, v40, v49
    v_mul_f32 v41, v41, v49
    v_mul_f32 v42, v42, v49
    v_mul_f32 v43, v43, v49
    v_mul_f32 v44, v44, v49
    v_mul_f32 v45, v45, v49
    v_mul_f32 v46, v46, v49
    v_mul_f32 v47, v47, v49
    s_branch K_P2_E2
K_CHEND:
K_AUX:
    s_load_dwordx8 s[44:51], s[0:1], 32
    s_load_dwordx2 s[52:53], s[0:1], 64
    s_mov_b32 s36, 4
    s_mul_i32 s43, s28, 7
    s_add_u32 s43, s43, s29
    s_sub_u32 s43, s43, 1
    s_cmp_lt_u32 s43, 54
    s_cselect_b32 s43, s43, 63
    s_cmp_eq_u32 s29, 0
    s_cselect_b32 s43, 63, s43
    s_lshl_b32 s3, s28, 8
    s_lshl_b32 s68, s30, 5
    s_add_u32 s3, s3, s68
    v_lshrrev_b32 v8, 3, v1
    v_add_u32 v8, s3, v8
    v_and_b32 v10, 7, v1
    v_lshlrev_b32 v10, 4, v10
    v_mul_u32_u24 v9, 1280, v8
    v_add_u32 v9, v9, v10
    s_waitcnt lgkmcnt(0)
    s_mov_b32 s16, s44
    s_mov_b32 s17, s45
    s_mov_b32 s18, 0x500
    s_mov_b32 s19, 0x20000
    s_mov_b32 s20, s52
    s_mov_b32 s21, s53
    s_mov_b32 s22, 0x500
    s_mov_b32 s23, 0x20000
    s_mov_b32 s24, s8
    s_mov_b32 s25, s9
    s_mov_b32 s26, 0xc8000
    s_mov_b32 s27, 0x20000
    s_cmp_lg_u32 s2, 63
    s_cbranch_scc1 K_AUX_NOZ
    s_add_u32 s56, s6, 0x80000
    s_addc_u32 s57, s7, 0
    s_mov_b32 s58, 0xa800
    s_mov_b32 s59, 0x20000
    v_lshlrev_b32 v2, 4, v0
    v_mov_b32 v12, 0
    v_mov_b32 v13, 0
    v_mov_b32 v14, 0
    v_mov_b32 v15, 0
    s_mov_b32 s3, 0
    buffer_store_dwordx4 v[12:15], v2, s[56:59], s3 offen sc1
    s_mov_b32 s3, 8192
    buffer_store_dwordx4 v[12:15], v2, s[56:59], s3 offen sc1
    s_mov_b32 s3, 16384
    buffer_store_dwordx4 v[12:15], v2, s[56:59], s3 offen sc1
    s_mov_b32 s3, 24576
    buffer_store_dwordx4 v[12:15], v2, s[56:59], s3 offen sc1
    s_mov_b32 s3, 32768
    buffer_store_dwordx4 v[12:15], v2, s[56:59], s3 offen sc1
    s_mov_b32 s3, 40960
    buffer_store_dwordx4 v[12:15], v2, s[56:59], s3 offen sc1
    v_mov_b32 v2, 192
    v_mov_b32 v3, 1
    s_waitcnt vmcnt(0)
    s_barrier
    s_cmp_lg_u32 s30, 0
    s_cbranch_scc1 K_AUX_NOZ
    s_mov_b64 exec, 1
    global_store_dword v2, v3, s[4:5] sc1
    s_mov_b64 exec, -1
K_AUX_NOZ:
    s_cmp_lg_u32 s29, 0
    s_cbranch_scc1 K_AUX_FFN0
    v_lshlrev_b32 v2, 4, v1
    s_cmp_ge_u32 s30, 2
    s_cbranch_scc1 K_AUX_R1
    s_cmp_eq_u32 s30, 1
    s_cbranch_scc1 K_AUX_R0
    s_mov_b32 m0, 126016
    s_nop 0
    buffer_load_dwordx4 v2, s[16:19], 0 offen lds
    buffer_load_dwordx4 v2, s[16:19], 0 offen offset:1024 lds
    s_branch K_AUX_R1
K_AUX_R0:
    s_mov_b32 m0, 128064
    s_nop 0
    buffer_load_dwordx4 v2, s[20:23], 0 offen lds
    buffer_load_dwordx4 v2, s[20:23], 0 offen offset:1024 lds
K_AUX_R1:
    s_mov_b32 s68, 10240
    s_mov_b32 s69, 20480
    s_mov_b32 s70, 30720
    v_add_u32 v10, 126016, v10
    buffer_load_dwordx4 v[12:15], v9, s[12:15], 0 offen offset:0
    buffer_load_dwordx4 v[16:19], v9, s[12:15], s68 offen offset:0
    buffer_load_dwordx4 v[20:23], v9, s[12:15], s69 offen offset:0
    buffer_load_dwordx4 v[24:27], v9, s[12:15], s70 offen offset:0
    buffer_load_dwordx4 v[28:31], v9, s[12:15], 0 offen offset:128
    buffer_load_dwordx4 v[32:35], v9, s[12:15], s68 offen offset:128
    buffer_load_dwordx4 v[36:39], v9, s[12:15], s69 offen offset:128
    buffer_load_dwordx4 v[40:43], v9, s[12:15], s70 offen offset:128
    s_waitcnt vmcnt(8)
    s_barrier
    buffer_load_dwordx4 v[44:47], v9, s[12:15], 0 offen offset:256
    buffer_load_dwordx4 v[48:51], v9, s[12:15], s68 offen offset:256
    buffer_load_dwordx4 v[52:55], v9, s[12:15], s69 offen offset:256
    buffer_load_dwordx4 v[56:59], v9, s[12:15], s70 offen offset:256
    buffer_load_dwordx4 v[60:63], v9, s[12:15], 0 offen offset:384
    buffer_load_dwordx4 v[64:67], v9, s[12:15], s68 offen offset:384
    buffer_load_dwordx4 v[68:71], v9, s[12:15], s69 offen offset:384
    buffer_load_dwordx4 v[72:75], v9, s[12:15], s70 offen offset:384
    buffer_load_dwordx4 v[76:79], v9, s[12:15], 0 offen offset:512
    buffer_load_dwordx4 v[80:83], v9, s[12:15], s68 offen offset:512
    buffer_load_dwordx4 v[84:87], v9, s[12:15], s69 offen offset:512
    buffer_load_dwordx4 v[88:91], v9, s[12:15], s70 offen offset:512
    buffer_load_dwordx4 v[92:95], v9, s[12:15], 0 offen offset:640
    buffer_load_dwordx4 v[96:99], v9, s[12:15], s68 offen offset:640
    buffer_load_dwordx4 v[100:103], v9, s[12:15], s69 offen offset:640
    buffer_load_dwordx4 v[104:107], v9, s[12:15], s70 offen offset:640
    buffer_load_dwordx4 v[108:111], v9, s[12:15], 0 offen offset:768
    buffer_load_dwordx4 v[112:115], v9, s[12:15], s68 offen offset:768
    buffer_load_dwordx4 v[116:119], v9, s[12:15], s69 offen offset:768
    buffer_load_dwordx4 v[120:123], v9, s[12:15], s70 offen offset:768
    buffer_load_dwordx4 v[124:127], v9, s[12:15], 0 offen offset:896
    buffer_load_dwordx4 v[128:131], v9, s[12:15], s68 offen offset:896
    buffer_load_dwordx4 v[132:135], v9, s[12:15], s69 offen offset:896
    buffer_load_dwordx4 v[136:139], v9, s[12:15], s70 offen offset:896
    buffer_load_dwordx4 v[140:143], v9, s[12:15], 0 offen offset:1024
    buffer_load_dwordx4 v[144:147], v9, s[12:15], s68 offen offset:1024
    buffer_load_dwordx4 v[148:151], v9, s[12:15], s69 offen offset:1024
    buffer_load_dwordx4 v[152:155], v9, s[12:15], s70 offen offset:1024
    buffer_load_dwordx4 v[156:159], v9, s[12:15], 0 offen offset:1152
    buffer_load_dwordx4 v[160:163], v9, s[12:15], s68 offen offset:1152
    buffer_load_dwordx4 v[164:167], v9, s[12:15], s69 offen offset:1152
    buffer_load_dwordx4 v[168:171], v9, s[12:15], s70 offen offset:1152
    v_mov_b32 v2, 192
    global_load_dword v7, v2, s[4:5] sc1
    v_mov_b32 v188, 0
    v_mov_b32 v192, 0
    v_mov_b32 v189, 0
    v_mov_b32 v193, 0
    v_mov_b32 v190, 0
    v_mov_b32 v194, 0
    v_mov_b32 v191, 0
    v_mov_b32 v195, 0
    ds_read_b128 v[172:175], v10 offset:0
    ds_read_b128 v[176:179], v10 offset:128
    s_waitcnt vmcnt(37) lgkmcnt(1)
    v_dot2c_f32_bf16 v188, v12, v172
    v_dot2c_f32_bf16 v189, v16, v172
    v_dot2c_f32_bf16 v190, v20, v172
    v_dot2c_f32_bf16 v191, v24, v172
    v_dot2c_f32_bf16 v188, v13, v173
    v_dot2c_f32_bf16 v189, v17, v173
    v_dot2c_f32_bf16 v190, v21, v173
    v_dot2c_f32_bf16 v191, v25, v173
    v_dot2c_f32_bf16 v188, v14, v174
    v_dot2c_f32_bf16 v189, v18, v174
    v_dot2c_f32_bf16 v190, v22, v174
    v_dot2c_f32_bf16 v191, v26, v174
    v_dot2c_f32_bf16 v188, v15, v175
    v_dot2c_f32_bf16 v189, v19, v175
    v_dot2c_f32_bf16 v190, v23, v175
    v_dot2c_f32_bf16 v191, v27, v175
    ds_read_b128 v[172:175], v10 offset:256
    s_waitcnt vmcnt(33) lgkmcnt(1)
    v_dot2c_f32_bf16 v188, v28, v176
    v_dot2c_f32_bf16 v189, v32, v176
    v_dot2c_f32_bf16 v190, v36, v176
    v_dot2c_f32_bf16 v191, v40, v176
    v_dot2c_f32_bf16 v188, v29, v177
    v_dot2c_f32_bf16 v189, v33, v177
    v_dot2c_f32_bf16 v190, v37, v177
    v_dot2c_f32_bf16 v191, v41, v177
    v_dot2c_f32_bf16 v188, v30, v178
    v_dot2c_f32_bf16 v189, v34, v178
    v_dot2c_f32_bf16 v190, v38, v178
    v_dot2c_f32_bf16 v191, v42, v178
    v_dot2c_f32_bf16 v188, v31, v179
    v_dot2c_f32_bf16 v189, v35, v179
    v_dot2c_f32_bf16 v190, v39, v179
    v_dot2c_f32_bf16 v191, v43, v179
    ds_read_b128 v[176:179], v10 offset:384
    s_waitcnt vmcnt(29) lgkmcnt(1)
    v_dot2c_f32_bf16 v188, v44, v172
    v_dot2c_f32_bf16 v189, v48, v172
    v_dot2c_f32_bf16 v190, v52, v172
    v_dot2c_f32_bf16 v191, v56, v172
    v_dot2c_f32_bf16 v188, v45, v173
    v_dot2c_f32_bf16 v189, v49, v173
    v_dot2c_f32_bf16 v190, v53, v173
    v_dot2c_f32_bf16 v191, v57, v173
    v_dot2c_f32_bf16 v188, v46, v174
    v_dot2c_f32_bf16 v189, v50, v174
    v_dot2c_f32_bf16 v190, v54, v174
    v_dot2c_f32_bf16 v191, v58, v174
    v_dot2c_f32_bf16 v188, v47, v175
    v_dot2c_f32_bf16 v189, v51, v175
    v_dot2c_f32_bf16 v190, v55, v175
    v_dot2c_f32_bf16 v191, v59, v175
    ds_read_b128 v[172:175], v10 offset:512
    s_waitcnt vmcnt(25) lgkmcnt(1)
    v_dot2c_f32_bf16 v188, v60, v176
    v_dot2c_f32_bf16 v189, v64, v176
    v_dot2c_f32_bf16 v190, v68, v176
    v_dot2c_f32_bf16 v191, v72, v176
    v_dot2c_f32_bf16 v188, v61, v177
    v_dot2c_f32_bf16 v189, v65, v177
    v_dot2c_f32_bf16 v190, v69, v177
    v_dot2c_f32_bf16 v191, v73, v177
    v_dot2c_f32_bf16 v188, v62, v178
    v_dot2c_f32_bf16 v189, v66, v178
    v_dot2c_f32_bf16 v190, v70, v178
    v_dot2c_f32_bf16 v191, v74, v178
    v_dot2c_f32_bf16 v188, v63, v179
    v_dot2c_f32_bf16 v189, v67, v179
    v_dot2c_f32_bf16 v190, v71, v179
    v_dot2c_f32_bf16 v191, v75, v179
    ds_read_b128 v[176:179], v10 offset:640
    s_waitcnt vmcnt(21) lgkmcnt(1)
    v_dot2c_f32_bf16 v188, v76, v172
    v_dot2c_f32_bf16 v189, v80, v172
    v_dot2c_f32_bf16 v190, v84, v172
    v_dot2c_f32_bf16 v191, v88, v172
    v_dot2c_f32_bf16 v188, v77, v173
    v_dot2c_f32_bf16 v189, v81, v173
    v_dot2c_f32_bf16 v190, v85, v173
    v_dot2c_f32_bf16 v191, v89, v173
    v_dot2c_f32_bf16 v188, v78, v174
    v_dot2c_f32_bf16 v189, v82, v174
    v_dot2c_f32_bf16 v190, v86, v174
    v_dot2c_f32_bf16 v191, v90, v174
    v_dot2c_f32_bf16 v188, v79, v175
    v_dot2c_f32_bf16 v189, v83, v175
    v_dot2c_f32_bf16 v190, v87, v175
    v_dot2c_f32_bf16 v191, v91, v175
    ds_read_b128 v[172:175], v10 offset:768
    s_waitcnt vmcnt(17) lgkmcnt(1)
    v_dot2c_f32_bf16 v188, v92, v176
    v_dot2c_f32_bf16 v189, v96, v176
    v_dot2c_f32_bf16 v190, v100, v176
    v_dot2c_f32_bf16 v191, v104, v176
    v_dot2c_f32_bf16 v188, v93, v177
    v_dot2c_f32_bf16 v189, v97, v177
    v_dot2c_f32_bf16 v190, v101, v177
    v_dot2c_f32_bf16 v191, v105, v177
    v_dot2c_f32_bf16 v188, v94, v178
    v_dot2c_f32_bf16 v189, v98, v178
    v_dot2c_f32_bf16 v190, v102, v178
    v_dot2c_f32_bf16 v191, v106, v178
    v_dot2c_f32_bf16 v188, v95, v179
    v_dot2c_f32_bf16 v189, v99, v179
    v_dot2c_f32_bf16 v190, v103, v179
    v_dot2c_f32_bf16 v191, v107, v179
    ds_read_b128 v[176:179], v10 offset:896
    s_waitcnt vmcnt(13) lgkmcnt(1)
    v_dot2c_f32_bf16 v188, v108, v172
    v_dot2c_f32_bf16 v189, v112, v172
    v_dot2c_f32_bf16 v190, v116, v172
    v_dot2c_f32_bf16 v191, v120, v172
    v_dot2c_f32_bf16 v188, v109, v173
    v_dot2c_f32_bf16 v189, v113, v173
    v_dot2c_f32_bf16 v190, v117, v173
    v_dot2c_f32_bf16 v191, v121, v173
    v_dot2c_f32_bf16 v188, v110, v174
    v_dot2c_f32_bf16 v189, v114, v174
    v_dot2c_f32_bf16 v190, v118, v174
    v_dot2c_f32_bf16 v191, v122, v174
    v_dot2c_f32_bf16 v188, v111, v175
    v_dot2c_f32_bf16 v189, v115, v175
    v_dot2c_f32_bf16 v190, v119, v175
    v_dot2c_f32_bf16 v191, v123, v175
    ds_read_b128 v[172:175], v10 offset:1024
    s_waitcnt vmcnt(9) lgkmcnt(1)
    v_dot2c_f32_bf16 v188, v124, v176
    v_dot2c_f32_bf16 v189, v128, v176
    v_dot2c_f32_bf16 v190, v132, v176
    v_dot2c_f32_bf16 v191, v136, v176
    v_dot2c_f32_bf16 v188, v125, v177
    v_dot2c_f32_bf16 v189, v129, v177
    v_dot2c_f32_bf16 v190, v133, v177
    v_dot2c_f32_bf16 v191, v137, v177
    v_dot2c_f32_bf16 v188, v126, v178
    v_dot2c_f32_bf16 v189, v130, v178
    v_dot2c_f32_bf16 v190, v134, v178
    v_dot2c_f32_bf16 v191, v138, v178
    v_dot2c_f32_bf16 v188, v127, v179
    v_dot2c_f32_bf16 v189, v131, v179
    v_dot2c_f32_bf16 v190, v135, v179
    v_dot2c_f32_bf16 v191, v139, v179
    ds_read_b128 v[176:179], v10 offset:1152
    s_waitcnt vmcnt(5) lgkmcnt(1)
    v_dot2c_f32_bf16 v188, v140, v172
    v_dot2c_f32_bf16 v189, v144, v172
    v_dot2c_f32_bf16 v190, v148, v172
    v_dot2c_f32_bf16 v191, v152, v172
    v_dot2c_f32_bf16 v188, v141, v173
    v_dot2c_f32_bf16 v189, v145, v173
    v_dot2c_f32_bf16 v190, v149, v173
    v_dot2c_f32_bf16 v191, v153, v173
    v_dot2c_f32_bf16 v188, v142, v174
    v_dot2c_f32_bf16 v189, v146, v174
    v_dot2c_f32_bf16 v190, v150, v174
    v_dot2c_f32_bf16 v191, v154, v174
    v_dot2c_f32_bf16 v188, v143, v175
    v_dot2c_f32_bf16 v189, v147, v175
    v_dot2c_f32_bf16 v190, v151, v175
    v_dot2c_f32_bf16 v191, v155, v175
    s_waitcnt vmcnt(0) lgkmcnt(0)
    v_dot2c_f32_bf16 v188, v156, v176
    v_dot2c_f32_bf16 v189, v160, v176
    v_dot2c_f32_bf16 v190, v164, v176
    v_dot2c_f32_bf16 v191, v168, v176
    v_dot2c_f32_bf16 v188, v157, v177
    v_dot2c_f32_bf16 v189, v161, v177
    v_dot2c_f32_bf16 v190, v165, v177
    v_dot2c_f32_bf16 v191, v169, v177
    v_dot2c_f32_bf16 v188, v158, v178
    v_dot2c_f32_bf16 v189, v162, v178
    v_dot2c_f32_bf16 v190, v166, v178
    v_dot2c_f32_bf16 v191, v170, v178
    v_dot2c_f32_bf16 v188, v159, v179
    v_dot2c_f32_bf16 v189, v163, v179
    v_dot2c_f32_bf16 v190, v167, v179
    v_dot2c_f32_bf16 v191, v171, v179
    s_nop 2
    v_add_f32_dpp v188, v188, v188 quad_perm:[1,0,3,2] row_mask:0xf bank_mask:0xf
    v_add_f32_dpp v189, v189, v189 quad_perm:[1,0,3,2] row_mask:0xf bank_mask:0xf
    v_add_f32_dpp v190, v190, v190 quad_perm:[1,0,3,2] row_mask:0xf bank_mask:0xf
    v_add_f32_dpp v191, v191, v191 quad_perm:[1,0,3,2] row_mask:0xf bank_mask:0xf
    s_branch K_PG6
.p2align 12
K_PG6:
    v_add_f32_dpp v188, v188, v188 quad_perm:[2,3,0,1] row_mask:0xf bank_mask:0xf
    v_add_f32_dpp v189, v189, v189 quad_perm:[2,3,0,1] row_mask:0xf bank_mask:0xf
    v_add_f32_dpp v190, v190, v190 quad_perm:[2,3,0,1] row_mask:0xf bank_mask:0xf
    v_add_f32_dpp v191, v191, v191 quad_perm:[2,3,0,1] row_mask:0xf bank_mask:0xf
    v_add_f32_dpp v188, v188, v188 row_half_mirror row_mask:0xf bank_mask:0xf
    v_add_f32_dpp v189, v189, v189 row_half_mirror row_mask:0xf bank_mask:0xf
    v_add_f32_dpp v190, v190, v190 row_half_mirror row_mask:0xf bank_mask:0xf
    v_add_f32_dpp v191, v191, v191 row_half_mirror row_mask:0xf bank_mask:0xf
    v_and_b32 v180, 255, v8
    v_lshlrev_b32 v180, 2, v180
    v_add_u32 v180, 122880, v180
    v_cvt_pk_bf16_f32 v2, v188, v188
    v_lshlrev_b32 v2, 16, v2
    v_ashrrev_i32 v3, 31, v2
    v_or_b32 v3, 0x80000000, v3
    v_xor_b32 v2, v2, v3
    v_and_b32 v2, 0xffff0000, v2
    v_sub_u32 v3, 0x87ff, v8
    v_or_b32 v188, v2, v3
    ds_write_b32 v180, v188 offset:0
    v_cvt_pk_bf16_f32 v2, v189, v189
    v_lshlrev_b32 v2, 16, v2
    v_ashrrev_i32 v3, 31, v2
    v_or_b32 v3, 0x80000000, v3
    v_xor_b32 v2, v2, v3
    v_and_b32 v2, 0xffff0000, v2
    v_sub_u32 v3, 0x87f7, v8
    v_or_b32 v189, v2, v3
    ds_write_b32 v180, v189 offset:32
    v_cvt_pk_bf16_f32 v2, v190, v190
    v_lshlrev_b32 v2, 16, v2
    v_ashrrev_i32 v3, 31, v2
    v_or_b32 v3, 0x80000000, v3
    v_xor_b32 v2, v2, v3
    v_and_b32 v2, 0xffff0000, v2
    v_sub_u32 v3, 0x87ef, v8
    v_or_b32 v190, v2, v3
    ds_write_b32 v180, v190 offset:64
    v_cvt_pk_bf16_f32 v2, v191, v191
    v_lshlrev_b32 v2, 16, v2
    v_ashrrev_i32 v3, 31, v2
    v_or_b32 v3, 0x80000000, v3
    v_xor_b32 v2, v2, v3
    v_and_b32 v2, 0xffff0000, v2
    v_sub_u32 v3, 0x87e7, v8
    v_or_b32 v191, v2, v3
    ds_write_b32 v180, v191 offset:96
    s_waitcnt lgkmcnt(0)
    s_barrier
    s_cmp_lg_u32 s30, 0
    s_cbranch_scc1 K_AUX_G0
    s_setprio 3
    v_lshlrev_b32 v3, 4, v1
    v_add_u32 v3, 122880, v3
    ds_read_b128 v[196:199], v3
    s_waitcnt lgkmcnt(0)
    v_max_u32 v2, v196, v197
    v_min_u32 v3, v196, v197
    v_max_u32 v4, v198, v199
    v_min_u32 v5, v198, v199
    v_max_u32 v3, v3, v5
    v_min_u32 v5, v2, v4
    v_max_u32 v2, v2, v4
    v_max_u32 v4, v3, v5
    s_nop 1
    v_max_u32_dpp v3, v2, v2 quad_perm:[1,0,3,2] row_mask:0xf bank_mask:0xf
    s_nop 1
    v_max_u32_dpp v3, v3, v3 quad_perm:[2,3,0,1] row_mask:0xf bank_mask:0xf
    s_nop 1
    v_max_u32_dpp v3, v3, v3 row_half_mirror row_mask:0xf bank_mask:0xf
    s_nop 1
    v_max_u32_dpp v3, v3, v3 row_mirror row_mask:0xf bank_mask:0xf
    s_nop 1
    v_readlane_b32 s70, v3, 0
    v_readlane_b32 s72, v3, 16
    v_readlane_b32 s73, v3, 32
    v_readlane_b32 s74, v3, 48
    s_nop 3
    s_max_u32 s70, s70, s72
    s_max_u32 s73, s73, s74
    s_max_u32 s70, s70, s73
    v_cmp_ne_u32 vcc, s70, v2
    s_nop 1
    v_cndmask_b32 v2, v4, v2, vcc
    s_nop 1
    v_max_u32_dpp v3, v2, v2 quad_perm:[1,0,3,2] row_mask:0xf bank_mask:0xf
    s_nop 1
    v_max_u32_dpp v3, v3, v3 quad_perm:[2,3,0,1] row_mask:0xf bank_mask:0xf
    s_nop 1
    v_max_u32_dpp v3, v3, v3 row_half_mirror row_mask:0xf bank_mask:0xf
    s_nop 1
    v_max_u32_dpp v3, v3, v3 row_mirror row_mask:0xf bank_mask:0xf
    s_nop 1
    v_readlane_b32 s71, v3, 0
    v_readlane_b32 s72, v3, 16
    v_readlane_b32 s73, v3, 32
    v_readlane_b32 s74, v3, 48
    s_nop 3
    s_max_u32 s71, s71, s72
    s_max_u32 s73, s73, s74
    s_max_u32 s71, s71, s73
    v_mov_b32 v196, s70
    v_mov_b32 v197, s71
    v_mov_b32 v4, 192
    s_mov_b32 s3, 131072
K_ZPOLL3:
    v_readfirstlane_b32 s33, v7
    s_nop 3
    s_sub_u32 s3, s3, 1
    s_cselect_b32 s33, 1, s33
    s_cmp_lg_u32 s33, 0
    s_cbranch_scc1 K_ZOK3
    global_load_dword v7, v4, s[4:5] sc1
    s_waitcnt vmcnt(0)
    s_branch K_ZPOLL3
K_ZOK3:
    s_add_u32 s60, s6, 0x80000
    s_addc_u32 s61, s7, 0
    s_mov_b32 s62, 0xa000
    s_mov_b32 s63, 0x20000
    s_lshl_b32 s3, s28, 3
    v_lshl_add_u32 v3, v1, 8, s3
    s_mov_b32 s3, 0
    buffer_store_dwordx2 v[196:197], v3, s[60:63], s3 offen offset:128 sc1
    s_mov_b32 s3, 16384
    buffer_store_dwordx2 v[196:197], v3, s[60:63], s3 offen offset:128 sc1
    s_mov_b32 s3, 32768
    buffer_store_dwordx2 v[196:197], v3, s[60:63], s3 offen offset:128 sc1
    s_setprio 0
K_AUX_G0:
    ds_read_b128 v[172:175], v10 offset:2048
    ds_read_b128 v[176:179], v10 offset:2176
    s_waitcnt lgkmcnt(1)
    v_dot2c_f32_bf16 v192, v12, v172
    v_dot2c_f32_bf16 v193, v16, v172
    v_dot2c_f32_bf16 v194, v20, v172
    v_dot2c_f32_bf16 v195, v24, v172
    v_dot2c_f32_bf16 v192, v13, v173
    v_dot2c_f32_bf16 v193, v17, v173
    v_dot2c_f32_bf16 v194, v21, v173
    v_dot2c_f32_bf16 v195, v25, v173
    v_dot2c_f32_bf16 v192, v14, v174
    v_dot2c_f32_bf16 v193, v18, v174
    v_dot2c_f32_bf16 v194, v22, v174
    v_dot2c_f32_bf16 v195, v26, v174
    v_dot2c_f32_bf16 v192, v15, v175
    v_dot2c_f32_bf16 v193, v19, v175
    v_dot2c_f32_bf16 v194, v23, v175
    v_dot2c_f32_bf16 v195, v27, v175
    ds_read_b128 v[172:175], v10 offset:2304
    s_waitcnt lgkmcnt(1)
    v_dot2c_f32_bf16 v192, v28, v176
    v_dot2c_f32_bf16 v193, v32, v176
    v_dot2c_f32_bf16 v194, v36, v176
    v_dot2c_f32_bf16 v195, v40, v176
    v_dot2c_f32_bf16 v192, v29, v177
    v_dot2c_f32_bf16 v193, v33, v177
    v_dot2c_f32_bf16 v194, v37, v177
    v_dot2c_f32_bf16 v195, v41, v177
    v_dot2c_f32_bf16 v192, v30, v178
    v_dot2c_f32_bf16 v193, v34, v178
    v_dot2c_f32_bf16 v194, v38, v178
    v_dot2c_f32_bf16 v195, v42, v178
    v_dot2c_f32_bf16 v192, v31, v179
    v_dot2c_f32_bf16 v193, v35, v179
    v_dot2c_f32_bf16 v194, v39, v179
    v_dot2c_f32_bf16 v195, v43, v179
    ds_read_b128 v[176:179], v10 offset:2432
    s_waitcnt lgkmcnt(1)
    v_dot2c_f32_bf16 v192, v44, v172
    v_dot2c_f32_bf16 v193, v48, v172
    v_dot2c_f32_bf16 v194, v52, v172
    v_dot2c_f32_bf16 v195, v56, v172
    v_dot2c_f32_bf16 v192, v45, v173
    v_dot2c_f32_bf16 v193, v49, v173
    v_dot2c_f32_bf16 v194, v53, v173
    v_dot2c_f32_bf16 v195, v57, v173
    v_dot2c_f32_bf16 v192, v46, v174
    v_dot2c_f32_bf16 v193, v50, v174
    v_dot2c_f32_bf16 v194, v54, v174
    v_dot2c_f32_bf16 v195, v58, v174
    v_dot2c_f32_bf16 v192, v47, v175
    v_dot2c_f32_bf16 v193, v51, v175
    v_dot2c_f32_bf16 v194, v55, v175
    v_dot2c_f32_bf16 v195, v59, v175
    ds_read_b128 v[172:175], v10 offset:2560
    s_waitcnt lgkmcnt(1)
    v_dot2c_f32_bf16 v192, v60, v176
    v_dot2c_f32_bf16 v193, v64, v176
    v_dot2c_f32_bf16 v194, v68, v176
    v_dot2c_f32_bf16 v195, v72, v176
    v_dot2c_f32_bf16 v192, v61, v177
    v_dot2c_f32_bf16 v193, v65, v177
    v_dot2c_f32_bf16 v194, v69, v177
    v_dot2c_f32_bf16 v195, v73, v177
    v_dot2c_f32_bf16 v192, v62, v178
    v_dot2c_f32_bf16 v193, v66, v178
    v_dot2c_f32_bf16 v194, v70, v178
    v_dot2c_f32_bf16 v195, v74, v178
    v_dot2c_f32_bf16 v192, v63, v179
    v_dot2c_f32_bf16 v193, v67, v179
    v_dot2c_f32_bf16 v194, v71, v179
    v_dot2c_f32_bf16 v195, v75, v179
    ds_read_b128 v[176:179], v10 offset:2688
    s_waitcnt lgkmcnt(1)
    v_dot2c_f32_bf16 v192, v76, v172
    v_dot2c_f32_bf16 v193, v80, v172
    v_dot2c_f32_bf16 v194, v84, v172
    v_dot2c_f32_bf16 v195, v88, v172
    v_dot2c_f32_bf16 v192, v77, v173
    v_dot2c_f32_bf16 v193, v81, v173
    v_dot2c_f32_bf16 v194, v85, v173
    v_dot2c_f32_bf16 v195, v89, v173
    v_dot2c_f32_bf16 v192, v78, v174
    v_dot2c_f32_bf16 v193, v82, v174
    v_dot2c_f32_bf16 v194, v86, v174
    v_dot2c_f32_bf16 v195, v90, v174
    v_dot2c_f32_bf16 v192, v79, v175
    v_dot2c_f32_bf16 v193, v83, v175
    v_dot2c_f32_bf16 v194, v87, v175
    v_dot2c_f32_bf16 v195, v91, v175
    ds_read_b128 v[172:175], v10 offset:2816
    s_waitcnt lgkmcnt(1)
    v_dot2c_f32_bf16 v192, v92, v176
    v_dot2c_f32_bf16 v193, v96, v176
    v_dot2c_f32_bf16 v194, v100, v176
    v_dot2c_f32_bf16 v195, v104, v176
    v_dot2c_f32_bf16 v192, v93, v177
    v_dot2c_f32_bf16 v193, v97, v177
    v_dot2c_f32_bf16 v194, v101, v177
    v_dot2c_f32_bf16 v195, v105, v177
    v_dot2c_f32_bf16 v192, v94, v178
    v_dot2c_f32_bf16 v193, v98, v178
    v_dot2c_f32_bf16 v194, v102, v178
    v_dot2c_f32_bf16 v195, v106, v178
    v_dot2c_f32_bf16 v192, v95, v179
    v_dot2c_f32_bf16 v193, v99, v179
    v_dot2c_f32_bf16 v194, v103, v179
    v_dot2c_f32_bf16 v195, v107, v179
    ds_read_b128 v[176:179], v10 offset:2944
    s_waitcnt lgkmcnt(1)
    v_dot2c_f32_bf16 v192, v108, v172
    v_dot2c_f32_bf16 v193, v112, v172
    v_dot2c_f32_bf16 v194, v116, v172
    v_dot2c_f32_bf16 v195, v120, v172
    v_dot2c_f32_bf16 v192, v109, v173
    v_dot2c_f32_bf16 v193, v113, v173
    v_dot2c_f32_bf16 v194, v117, v173
    v_dot2c_f32_bf16 v195, v121, v173
    v_dot2c_f32_bf16 v192, v110, v174
    v_dot2c_f32_bf16 v193, v114, v174
    v_dot2c_f32_bf16 v194, v118, v174
    v_dot2c_f32_bf16 v195, v122, v174
    v_dot2c_f32_bf16 v192, v111, v175
    v_dot2c_f32_bf16 v193, v115, v175
    v_dot2c_f32_bf16 v194, v119, v175
    v_dot2c_f32_bf16 v195, v123, v175
    ds_read_b128 v[172:175], v10 offset:3072
    s_waitcnt lgkmcnt(1)
    v_dot2c_f32_bf16 v192, v124, v176
    v_dot2c_f32_bf16 v193, v128, v176
    v_dot2c_f32_bf16 v194, v132, v176
    v_dot2c_f32_bf16 v195, v136, v176
    v_dot2c_f32_bf16 v192, v125, v177
    v_dot2c_f32_bf16 v193, v129, v177
    v_dot2c_f32_bf16 v194, v133, v177
    v_dot2c_f32_bf16 v195, v137, v177
    v_dot2c_f32_bf16 v192, v126, v178
    v_dot2c_f32_bf16 v193, v130, v178
    v_dot2c_f32_bf16 v194, v134, v178
    v_dot2c_f32_bf16 v195, v138, v178
    v_dot2c_f32_bf16 v192, v127, v179
    v_dot2c_f32_bf16 v193, v131, v179
    v_dot2c_f32_bf16 v194, v135, v179
    v_dot2c_f32_bf16 v195, v139, v179
    ds_read_b128 v[176:179], v10 offset:3200
    s_waitcnt lgkmcnt(1)
    v_dot2c_f32_bf16 v192, v140, v172
    v_dot2c_f32_bf16 v193, v144, v172
    v_dot2c_f32_bf16 v194, v148, v172
    v_dot2c_f32_bf16 v195, v152, v172
    v_dot2c_f32_bf16 v192, v141, v173
    v_dot2c_f32_bf16 v193, v145, v173
    v_dot2c_f32_bf16 v194, v149, v173
    v_dot2c_f32_bf16 v195, v153, v173
    v_dot2c_f32_bf16 v192, v142, v174
    v_dot2c_f32_bf16 v193, v146, v174
    v_dot2c_f32_bf16 v194, v150, v174
    v_dot2c_f32_bf16 v195, v154, v174
    v_dot2c_f32_bf16 v192, v143, v175
    v_dot2c_f32_bf16 v193, v147, v175
    v_dot2c_f32_bf16 v194, v151, v175
    v_dot2c_f32_bf16 v195, v155, v175
    s_waitcnt lgkmcnt(0)
    v_dot2c_f32_bf16 v192, v156, v176
    v_dot2c_f32_bf16 v193, v160, v176
    v_dot2c_f32_bf16 v194, v164, v176
    v_dot2c_f32_bf16 v195, v168, v176
    v_dot2c_f32_bf16 v192, v157, v177
    v_dot2c_f32_bf16 v193, v161, v177
    v_dot2c_f32_bf16 v194, v165, v177
    v_dot2c_f32_bf16 v195, v169, v177
    v_dot2c_f32_bf16 v192, v158, v178
    v_dot2c_f32_bf16 v193, v162, v178
    v_dot2c_f32_bf16 v194, v166, v178
    v_dot2c_f32_bf16 v195, v170, v178
    v_dot2c_f32_bf16 v192, v159, v179
    v_dot2c_f32_bf16 v193, v163, v179
    v_dot2c_f32_bf16 v194, v167, v179
    v_dot2c_f32_bf16 v195, v171, v179
    s_nop 2
    v_add_f32_dpp v192, v192, v192 quad_perm:[1,0,3,2] row_mask:0xf bank_mask:0xf
    v_add_f32_dpp v193, v193, v193 quad_perm:[1,0,3,2] row_mask:0xf bank_mask:0xf
    v_add_f32_dpp v194, v194, v194 quad_perm:[1,0,3,2] row_mask:0xf bank_mask:0xf
    v_add_f32_dpp v195, v195, v195 quad_perm:[1,0,3,2] row_mask:0xf bank_mask:0xf
    v_add_f32_dpp v192, v192, v192 quad_perm:[2,3,0,1] row_mask:0xf bank_mask:0xf
    v_add_f32_dpp v193, v193, v193 quad_perm:[2,3,0,1] row_mask:0xf bank_mask:0xf
    v_add_f32_dpp v194, v194, v194 quad_perm:[2,3,0,1] row_mask:0xf bank_mask:0xf
    v_add_f32_dpp v195, v195, v195 quad_perm:[2,3,0,1] row_mask:0xf bank_mask:0xf
    v_add_f32_dpp v192, v192, v192 row_half_mirror row_mask:0xf bank_mask:0xf
    v_add_f32_dpp v193, v193, v193 row_half_mirror row_mask:0xf bank_mask:0xf
    v_add_f32_dpp v194, v194, v194 row_half_mirror row_mask:0xf bank_mask:0xf
    v_add_f32_dpp v195, v195, v195 row_half_mirror row_mask:0xf bank_mask:0xf
    ds_write_b32 v180, v192 offset:1088
    ds_write_b32 v180, v193 offset:1120
    ds_write_b32 v180, v194 offset:1152
    ds_write_b32 v180, v195 offset:1184
    s_waitcnt lgkmcnt(0)
    s_barrier
    s_cmp_lg_u32 s30, 5
    s_cbranch_scc1 K_AUX_FFN0
    s_add_u32 s56, s6, 0x1000
    s_addc_u32 s57, s7, 0
    s_mov_b32 s58, 0x2000
    s_mov_b32 s59, 0x20000
    v_lshlrev_b32 v3, 4, v1
    v_add_u32 v4, 123968, v3
    ds_read_b128 v[196:199], v4
    s_waitcnt lgkmcnt(0)
    v_cvt_pk_bf16_f32 v196, v196, v196
    v_lshlrev_b32 v196, 16, v196
    v_mul_f32 v5, 0xbfb8aa3b, v196
    v_exp_f32 v5, v5
    s_nop 0
    v_add_f32 v5, 1.0, v5
    v_rcp_f32 v196, v5
    s_nop 0
    v_cvt_pk_bf16_f32 v196, v196, v196
    v_lshlrev_b32 v196, 16, v196
    v_cvt_pk_bf16_f32 v197, v197, v197
    v_lshlrev_b32 v197, 16, v197
    v_mul_f32 v5, 0xbfb8aa3b, v197
    v_exp_f32 v5, v5
    s_nop 0
    v_add_f32 v5, 1.0, v5
    v_rcp_f32 v197, v5
    s_nop 0
    v_cvt_pk_bf16_f32 v197, v197, v197
    v_lshlrev_b32 v197, 16, v197
    v_cvt_pk_bf16_f32 v198, v198, v198
    v_lshlrev_b32 v198, 16, v198
    v_mul_f32 v5, 0xbfb8aa3b, v198
    v_exp_f32 v5, v5
    s_nop 0
    v_add_f32 v5, 1.0, v5
    v_rcp_f32 v198, v5
    s_nop 0
    v_cvt_pk_bf16_f32 v198, v198, v198
    v_lshlrev_b32 v198, 16, v198
    v_cvt_pk_bf16_f32 v199, v199, v199
    v_lshlrev_b32 v199, 16, v199
    v_mul_f32 v5, 0xbfb8aa3b, v199
    v_exp_f32 v5, v5
    s_nop 0
    v_add_f32 v5, 1.0, v5
    v_rcp_f32 v199, v5
    s_nop 0
    v_cvt_pk_bf16_f32 v199, v199, v199
    v_lshlrev_b32 v199, 16, v199
    s_lshl_b32 s3, s28, 10
    buffer_store_dwordx4 v[196:199], v3, s[56:59], s3 offen sc1
    v_mov_b32 v4, 192
    s_mov_b32 s3, 131072
K_ZPOLL4:
    v_readfirstlane_b32 s33, v7
    s_nop 3
    s_sub_u32 s3, s3, 1
    s_cselect_b32 s33, 1, s33
    s_cmp_lg_u32 s33, 0
    s_cbranch_scc1 K_ZOK4
    global_load_dword v7, v4, s[4:5] sc1
    s_waitcnt vmcnt(0)
    s_branch K_ZPOLL4
K_ZOK4:
    s_add_u32 s60, s6, 0x80000
    s_addc_u32 s61, s7, 0
    s_mov_b32 s62, 0xa000
    s_mov_b32 s63, 0x20000
    s_lshl_b32 s3, s28, 2
    v_lshl_add_u32 v2, v1, 8, s3
    v_mov_b32 v3, 1
    s_waitcnt vmcnt(0)
    s_mov_b32 s3, 0
    buffer_store_dword v3, v2, s[60:63], s3 offen offset:192 sc1
    s_mov_b32 s3, 16384
    buffer_store_dword v3, v2, s[60:63], s3 offen offset:192 sc1
    s_mov_b32 s3, 32768
    buffer_store_dword v3, v2, s[60:63], s3 offen offset:192 sc1
K_AUX_FFN0:
    s_cmp_lg_u32 s43, 63
    s_cbranch_scc1 K_AUX_FFN1
    s_cmp_eq_u32 s29, 0
    s_cbranch_scc1 K_AUX_NB
    s_barrier
K_AUX_NB:
    s_cmp_lg_u32 s30, 6
    s_cbranch_scc1 K_P2
    v_mov_b32 v4, 192
    s_mov_b32 s3, 131072
K_ZPOLL6:
    v_readfirstlane_b32 s33, v7
    s_nop 3
    s_sub_u32 s3, s3, 1
    s_cselect_b32 s33, 1, s33
    s_cmp_lg_u32 s33, 0
    s_cbranch_scc1 K_ZOK6
    global_load_dword v7, v4, s[4:5] sc1
    s_waitcnt vmcnt(0)
    s_branch K_ZPOLL6
K_ZOK6:
    v_mov_b32 v7, 0
    s_branch K_P2
K_AUX_FFN1:
    s_mov_b32 s56, s46
    s_mov_b32 s57, s47
    s_mov_b32 s58, 0x21c000
    s_mov_b32 s59, 0x20000
    s_mov_b32 s60, s48
    s_mov_b32 s61, s49
    s_mov_b32 s62, 0x21c000
    s_mov_b32 s63, 0x20000
    v_lshrrev_b32 v2, 2, v1
    v_mul_u32_u24 v200, 3456, v2
    v_and_b32 v2, 3, v1
    v_lshl_add_u32 v200, v2, 4, v200
    s_mul_i32 s3, s30, 276480
    s_lshl_b32 s68, s43, 6
    s_add_u32 s3, s3, s68
    v_add_u32 v200, s3, v200
    s_mul_i32 s69, s30, 5120
    s_mov_b32 s68, 0
    s_add_u32 m0, s69, 0
    s_nop 0
    buffer_load_dwordx4 v200, s[56:59], s68 offen  lds
    s_add_u32 m0, s69, 40960
    s_nop 0
    buffer_load_dwordx4 v200, s[60:63], s68 offen  lds
    s_mov_b32 s68, 55296
    s_add_u32 m0, s69, 1024
    s_nop 0
    buffer_load_dwordx4 v200, s[56:59], s68 offen  lds
    s_add_u32 m0, s69, 41984
    s_nop 0
    buffer_load_dwordx4 v200, s[60:63], s68 offen  lds
    s_mov_b32 s68, 110592
    s_add_u32 m0, s69, 2048
    s_nop 0
    buffer_load_dwordx4 v200, s[56:59], s68 offen  lds
    s_add_u32 m0, s69, 43008
    s_nop 0
    buffer_load_dwordx4 v200, s[60:63], s68 offen  lds
    s_mov_b32 s68, 165888
    s_add_u32 m0, s69, 3072
    s_nop 0
    buffer_load_dwordx4 v200, s[56:59], s68 offen  lds
    s_add_u32 m0, s69, 44032
    s_nop 0
    buffer_load_dwordx4 v200, s[60:63], s68 offen  lds
    s_mov_b32 s68, 221184
    s_add_u32 m0, s69, 4096
    s_nop 0
    buffer_load_dwordx4 v200, s[56:59], s68 offen  lds
    s_add_u32 m0, s69, 45056
    s_nop 0
    buffer_load_dwordx4 v200, s[60:63], s68 offen  lds
    s_add_u32 s60, s6, 0x10000
    s_addc_u32 s61, s7, 0
    s_mov_b32 s62, 0x43800
    s_mov_b32 s63, 0x20000
    s_cmp_ge_u32 s30, 4
    s_cbranch_scc1 K_FFN_C
    s_mul_i32 s3, s43, 5120
    s_mul_i32 s68, s30, 1280
    s_add_u32 s3, s3, s68
    v_lshlrev_b32 v2, 4, v1
    buffer_store_dwordx4 v[12:15], v2, s[60:63], s3 offen sc1
    s_mov_b64 exec, 0xffff
    buffer_store_dwordx4 v[12:15], v2, s[60:63], s3 offen offset:1024 sc1
    s_mov_b64 exec, -1
    s_sub_u32 s3, s29, 1
    s_mul_i32 s3, s3, 92
    s_mul_i32 s68, s30, 23
    s_add_u32 s3, s3, s68
    v_lshrrev_b32 v2, 1, v1
    v_add_u32 v2, s3, v2
    v_mul_u32_u24 v2, 1280, v2
    v_and_b32 v3, 1, v1
    v_lshl_add_u32 v2, v3, 7, v2
    s_mov_b32 exec_hi, 0x3fff
    buffer_load_dword v6, v2, s[24:27], 0 offen offset:1024
    s_mov_b32 exec_lo, 0x55555555
    s_mov_b32 exec_hi, 0x1555
    buffer_load_dword v6, v2, s[24:27], 0 offen
    s_mov_b64 exec, -1
    s_waitcnt vmcnt(4)
    s_barrier
    s_branch K_P2_EARLY
K_FFN_C:
    s_mov_b32 s64, s50
    s_mov_b32 s65, s51
    s_mov_b32 s66, 0x21c000
    s_mov_b32 s67, 0x20000
    s_sub_u32 s69, s30, 4
    s_mul_i32 s3, s43, 40960
    s_mul_i32 s69, s69, 10240
    s_add_u32 s3, s3, s69
    v_lshl_add_u32 v201, v1, 4, s3
    v_lshrrev_b32 v202, 4, v1
    v_bfe_u32 v2, v1, 2, 2
    v_lshl_add_u32 v2, v202, 3, v2
    v_and_b32 v3, 3, v1
    v_lshlrev_b32 v3, 3, v3
    v_lshl_add_u32 v203, v2, 6, v3
    s_bfe_u32 s3, s30, 0x10001
    s_mul_i32 s3, s3, 40960
    s_and_b32 s68, s30, 1
    s_lshl_b32 s68, s68, 5
    s_add_u32 s3, s3, s68
    s_add_u32 s3, s3, 0
    v_add_u32 v203, s3, v203
    v_mul_u32_u24 v204, 1280, v2
    s_and_b32 s3, s30, 3
    s_mul_i32 s3, s3, 320
    s_add_u32 s3, s3, 81920
    v_add3_u32 v204, v204, v3, s3
    v_mov_b32 v205, 123904
    v_mov_b32 v206, 158720
    s_mov_b32 s68, 0
    s_add_u32 m0, s69, 81920
    s_nop 0
    buffer_load_dwordx4 v201, s[64:67], s68 offen  lds
    s_mov_b32 s68, 1024
    s_add_u32 m0, s69, 82944
    s_nop 0
    buffer_load_dwordx4 v201, s[64:67], s68 offen  lds
    s_mov_b32 s68, 2048
    s_add_u32 m0, s69, 83968
    s_nop 0
    buffer_load_dwordx4 v201, s[64:67], s68 offen  lds
    s_mov_b32 s68, 3072
    s_add_u32 m0, s69, 84992
    s_nop 0
    buffer_load_dwordx4 v201, s[64:67], s68 offen  lds
    s_mov_b32 s68, 4096
    s_add_u32 m0, s69, 86016
    s_nop 0
    buffer_load_dwordx4 v201, s[64:67], s68 offen  lds
    s_mov_b32 s68, 5120
    s_add_u32 m0, s69, 87040
    s_nop 0
    buffer_load_dwordx4 v201, s[64:67], s68 offen  lds
    s_mov_b32 s68, 6144
    s_add_u32 m0, s69, 88064
    s_nop 0
    buffer_load_dwordx4 v201, s[64:67], s68 offen  lds
    s_mov_b32 s68, 7168
    s_add_u32 m0, s69, 89088
    s_nop 0
    buffer_load_dwordx4 v201, s[64:67], s68 offen  lds
    s_mov_b32 s68, 8192
    s_add_u32 m0, s69, 90112
    s_nop 0
    buffer_load_dwordx4 v201, s[64:67], s68 offen  lds
    s_mov_b32 s68, 9216
    s_add_u32 m0, s69, 91136
    s_nop 0
    buffer_load_dwordx4 v201, s[64:67], s68 offen  lds
    s_waitcnt vmcnt(10)
    s_barrier
    ds_read_b64_tr_b16 v[12:13], v203 offset:0
    ds_read_b64_tr_b16 v[14:15], v203 offset:256
    ds_read_b64_tr_b16 v[16:17], v203 offset:2048
    ds_read_b64_tr_b16 v[18:19], v203 offset:2304
    ds_read_b64_tr_b16 v[20:21], v203 offset:4096
    ds_read_b64_tr_b16 v[22:23], v203 offset:4352
    ds_read_b64_tr_b16 v[24:25], v203 offset:6144
    ds_read_b64_tr_b16 v[26:27], v203 offset:6400
    ds_read_b64_tr_b16 v[28:29], v203 offset:8192
    ds_read_b64_tr_b16 v[30:31], v203 offset:8448
    ds_read_b64_tr_b16 v[32:33], v203 offset:10240
    ds_read_b64_tr_b16 v[34:35], v203 offset:10496
    ds_read_b64_tr_b16 v[36:37], v203 offset:12288
    ds_read_b64_tr_b16 v[38:39], v203 offset:12544
    ds_read_b64_tr_b16 v[40:41], v203 offset:14336
    ds_read_b64_tr_b16 v[42:43], v203 offset:14592
    ds_read_b64_tr_b16 v[44:45], v203 offset:16384
    ds_read_b64_tr_b16 v[46:47], v203 offset:16640
    ds_read_b64_tr_b16 v[48:49], v203 offset:18432
    ds_read_b64_tr_b16 v[50:51], v203 offset:18688
    ds_read_b64_tr_b16 v[52:53], v203 offset:20480
    ds_read_b64_tr_b16 v[54:55], v203 offset:20736
    ds_read_b64_tr_b16 v[56:57], v203 offset:22528
    ds_read_b64_tr_b16 v[58:59], v203 offset:22784
    ds_read_b64_tr_b16 v[60:61], v203 offset:24576
    ds_read_b64_tr_b16 v[62:63], v203 offset:24832
    ds_read_b64_tr_b16 v[64:65], v203 offset:26624
    ds_read_b64_tr_b16 v[66:67], v203 offset:26880
    ds_read_b64_tr_b16 v[68:69], v203 offset:28672
    ds_read_b64_tr_b16 v[70:71], v203 offset:28928
    ds_read_b64_tr_b16 v[72:73], v203 offset:30720
    ds_read_b64_tr_b16 v[74:75], v203 offset:30976
    ds_read_b64_tr_b16 v[76:77], v203 offset:32768
    ds_read_b64_tr_b16 v[78:79], v203 offset:33024
    ds_read_b64_tr_b16 v[80:81], v203 offset:34816
    ds_read_b64_tr_b16 v[82:83], v203 offset:35072
    ds_read_b64_tr_b16 v[84:85], v203 offset:36864
    ds_read_b64_tr_b16 v[86:87], v203 offset:37120
    ds_read_b64_tr_b16 v[88:89], v203 offset:38912
    ds_read_b64_tr_b16 v[90:91], v203 offset:39168
    s_setprio 3
    s_waitcnt lgkmcnt(0)
    s_barrier
    s_cmp_lg_u32 s30, 7
    s_cbranch_scc1 K_AUX_POLLED
    v_mov_b32 v4, 192
    s_mov_b32 s3, 131072
K_ZPOLL5:
    v_readfirstlane_b32 s33, v7
    s_nop 3
    s_sub_u32 s3, s3, 1
    s_cselect_b32 s33, 1, s33
    s_cmp_lg_u32 s33, 0
    s_cbranch_scc1 K_ZOK5
    global_load_dword v7, v4, s[4:5] sc1
    s_waitcnt vmcnt(0)
    s_branch K_ZPOLL5
K_ZOK5:
    v_and_b32 v3, 15, v1
    v_lshl_add_u32 v3, v3, 2, s42
    s_mov_b32 s3, 131072
K_AUX_POLL:
    global_load_dword v2, v3, s[6:7] offset:128 sc1
    s_waitcnt vmcnt(0)
    v_cmp_eq_u32 vcc, 0, v2
    s_cbranch_vccz K_AUX_GOT
    s_sleep 6
    s_sub_u32 s3, s3, 1
    s_cmp_lg_u32 s3, 0
    s_cbranch_scc1 K_AUX_POLL
K_AUX_GOT:
    s_nop 1
    v_max_u32_dpp v3, v2, v2 quad_perm:[1,0,3,2] row_mask:0xf bank_mask:0xf
    s_nop 1
    v_max_u32_dpp v3, v3, v3 quad_perm:[2,3,0,1] row_mask:0xf bank_mask:0xf
    s_nop 1
    v_max_u32_dpp v3, v3, v3 row_half_mirror row_mask:0xf bank_mask:0xf
    s_nop 1
    v_max_u32_dpp v3, v3, v3 row_mirror row_mask:0xf bank_mask:0xf
    s_nop 1
    v_readlane_b32 s70, v3, 0
    v_readlane_b32 s72, v3, 16
    v_readlane_b32 s73, v3, 32
    v_readlane_b32 s74, v3, 48
    s_nop 3
    s_max_u32 s70, s70, s72
    s_max_u32 s73, s73, s74
    s_max_u32 s70, s70, s73
    v_cmp_ne_u32 vcc, s70, v2
    s_nop 1
    v_cndmask_b32 v2, 0, v2, vcc
    s_nop 1
    v_max_u32_dpp v3, v2, v2 quad_perm:[1,0,3,2] row_mask:0xf bank_mask:0xf
    s_nop 1
    v_max_u32_dpp v3, v3, v3 quad_perm:[2,3,0,1] row_mask:0xf bank_mask:0xf
    s_nop 1
    v_max_u32_dpp v3, v3, v3 row_half_mirror row_mask:0xf bank_mask:0xf
    s_nop 1
    v_max_u32_dpp v3, v3, v3 row_mirror row_mask:0xf bank_mask:0xf
    s_nop 1
    v_readlane_b32 s71, v3, 0
    v_readlane_b32 s72, v3, 16
    v_readlane_b32 s73, v3, 32
    v_readlane_b32 s74, v3, 48
    s_nop 3
    s_max_u32 s71, s71, s72
    s_max_u32 s73, s73, s74
    s_max_u32 s71, s71, s73
    v_mov_b32 v196, s70
    v_mov_b32 v197, s71
    v_mov_b32 v3, 1
    ds_write_b64 v205, v[196:197]
    ds_write_b32 v206, v3 offset:48
K_AUX_POLLED:
    s_mov_b32 s3, 1048576
K_FGK:
    ds_read_b32 v2, v206 offset:48
    s_sleep 1
    s_sub_u32 s3, s3, 1
    s_waitcnt lgkmcnt(0)
    v_readfirstlane_b32 s33, v2
    s_nop 3
    s_cselect_b32 s33, 1, s33
    s_cmp_lt_u32 s33, 1
    s_cbranch_scc1 K_FGK
    ds_read_b64 v[196:197], v205
    v_and_b32 v2, 1, v1
    v_cmp_eq_u32 vcc, 1, v2
    s_waitcnt lgkmcnt(0)
    v_cndmask_b32 v4, v196, v197, vcc
    v_and_b32 v3, 0x7ff, v4
    v_sub_u32 v3, 2047, v3
    v_mul_u32_u24 v9, 1280, v3
    v_lshl_add_u32 v9, v202, 4, v9
    s_mov_b32 exec_lo, 0x00030003
    s_mov_b32 exec_hi, 0x00030003
    buffer_load_dwordx4 v[92:95], v9, s[12:15], 0 offen offset:0
    buffer_load_dwordx4 v[96:99], v9, s[12:15], 0 offen offset:64
    buffer_load_dwordx4 v[100:103], v9, s[12:15], 0 offen offset:128
    buffer_load_dwordx4 v[104:107], v9, s[12:15], 0 offen offset:192
    buffer_load_dwordx4 v[108:111], v9, s[12:15], 0 offen offset:256
    buffer_load_dwordx4 v[112:115], v9, s[12:15], 0 offen offset:320
    buffer_load_dwordx4 v[116:119], v9, s[12:15], 0 offen offset:384
    buffer_load_dwordx4 v[120:123], v9, s[12:15], 0 offen offset:448
    buffer_load_dwordx4 v[124:127], v9, s[12:15], 0 offen offset:512
    buffer_load_dwordx4 v[128:131], v9, s[12:15], 0 offen offset:576
    buffer_load_dwordx4 v[132:135], v9, s[12:15], 0 offen offset:640
    buffer_load_dwordx4 v[136:139], v9, s[12:15], 0 offen offset:704
    buffer_load_dwordx4 v[140:143], v9, s[12:15], 0 offen offset:768
    buffer_load_dwordx4 v[144:147], v9, s[12:15], 0 offen offset:832
    buffer_load_dwordx4 v[148:151], v9, s[12:15], 0 offen offset:896
    s_branch K_PG7
.p2align 12
K_PG7:
    buffer_load_dwordx4 v[152:155], v9, s[12:15], 0 offen offset:960
    buffer_load_dwordx4 v[156:159], v9, s[12:15], 0 offen offset:1024
    buffer_load_dwordx4 v[160:163], v9, s[12:15], 0 offen offset:1088
    buffer_load_dwordx4 v[164:167], v9, s[12:15], 0 offen offset:1152
    buffer_load_dwordx4 v[168:171], v9, s[12:15], 0 offen offset:1216
    s_mov_b64 exec, -1
    v_and_b32 v2, 1, v1
    v_lshlrev_b32 v216, 6, v2
    v_lshl_add_u32 v216, v202, 4, v216
    s_and_b32 s3, s30, 3
    s_lshl_b32 s3, s3, 7
    v_add3_u32 v217, v216, s3, v205
    v_add_u32 v216, 64, v217
    v_add_u32 v217, 1088, v217
    v_lshrrev_b32 v2, 5, v1
    v_bfe_u32 v3, v1, 4, 1
    v_lshl_add_u32 v3, v3, 1, v2
    v_lshlrev_b32 v3, 6, v3
    v_and_b32 v4, 15, v1
    v_lshl_add_u32 v3, v4, 2, v3
    v_add_u32 v218, 123968, v3
    v_lshlrev_b32 v4, 1, v1
    s_add_u32 s3, s3, 124992
    v_add_u32 v219, s3, v4
    v_and_b32 v2, 1, v1
    v_mul_u32_u24 v2, 2560, v2
    v_lshl_add_u32 v220, v202, 4, v2
    s_mul_i32 s3, s43, 5120
    s_and_b32 s68, s30, 3
    s_mul_i32 s68, s68, 640
    s_add_u32 s68, s68, s3
    v_mov_b32 v3, 1
    s_waitcnt vmcnt(16)
    v_mfma_f32_16x16x32_bf16 v[208:211], v[12:15], v[92:95], 0
    v_mfma_f32_16x16x32_bf16 v[212:215], v[16:19], v[96:99], 0
    v_mfma_f32_16x16x32_bf16 v[208:211], v[20:23], v[100:103], v[208:211]
    v_mfma_f32_16x16x32_bf16 v[212:215], v[24:27], v[104:107], v[212:215]
    s_waitcnt vmcnt(12)
    v_mfma_f32_16x16x32_bf16 v[208:211], v[28:31], v[108:111], v[208:211]
    v_mfma_f32_16x16x32_bf16 v[212:215], v[32:35], v[112:115], v[212:215]
    v_mfma_f32_16x16x32_bf16 v[208:211], v[36:39], v[116:119], v[208:211]
    v_mfma_f32_16x16x32_bf16 v[212:215], v[40:43], v[120:123], v[212:215]
    s_waitcnt vmcnt(8)
    v_mfma_f32_16x16x32_bf16 v[208:211], v[44:47], v[124:127], v[208:211]
    v_mfma_f32_16x16x32_bf16 v[212:215], v[48:51], v[128:131], v[212:215]
    v_mfma_f32_16x16x32_bf16 v[208:211], v[52:55], v[132:135], v[208:211]
    v_mfma_f32_16x16x32_bf16 v[212:215], v[56:59], v[136:139], v[212:215]
    s_waitcnt vmcnt(4)
    v_mfma_f32_16x16x32_bf16 v[208:211], v[60:63], v[140:143], v[208:211]
    v_mfma_f32_16x16x32_bf16 v[212:215], v[64:67], v[144:147], v[212:215]
    v_mfma_f32_16x16x32_bf16 v[208:211], v[68:71], v[148:151], v[208:211]
    v_mfma_f32_16x16x32_bf16 v[212:215], v[72:75], v[152:155], v[212:215]
    s_waitcnt vmcnt(0)
    v_mfma_f32_16x16x32_bf16 v[208:211], v[76:79], v[156:159], v[208:211]
    v_mfma_f32_16x16x32_bf16 v[212:215], v[80:83], v[160:163], v[212:215]
    v_mfma_f32_16x16x32_bf16 v[208:211], v[84:87], v[164:167], v[208:211]
    v_mfma_f32_16x16x32_bf16 v[212:215], v[88:91], v[168:171], v[212:215]
    s_nop 7
    v_add_f32 v208, v208, v212
    v_add_f32 v209, v209, v213
    v_add_f32 v210, v210, v214
    v_add_f32 v211, v211, v215
    s_mov_b32 exec_lo, 0x00030003
    s_mov_b32 exec_hi, 0x00030003
    ds_write_b128 v216, v[208:211]
    s_mov_b64 exec, 1
    ds_add_u32 v206, v3 offset:52
    s_mov_b64 exec, -1
    s_cmp_lg_u32 s30, 6
    s_cbranch_scc1 K_NOS6B
    v_min_u32 v4, 23, v1
    v_lshl_add_u32 v4, v4, 2, s42
    global_load_dword v7, v4, s[6:7] offset:128 sc1
K_NOS6B:
    s_mov_b32 s3, 1048576
K_FGP:
    ds_read_b32 v2, v206 offset:52
    s_sleep 1
    s_sub_u32 s3, s3, 1
    s_waitcnt lgkmcnt(0)
    v_readfirstlane_b32 s33, v2
    s_nop 3
    s_cselect_b32 s33, 4, s33
    s_cmp_lt_u32 s33, 4
    s_cbranch_scc1 K_FGP
    ds_read_b32 v224, v218
    ds_read_b32 v226, v218 offset:256
    ds_read_b64_tr_b16 v[12:13], v204 offset:0
    ds_read_b64_tr_b16 v[14:15], v204 offset:5120
    ds_read_b64_tr_b16 v[16:17], v204 offset:32
    ds_read_b64_tr_b16 v[18:19], v204 offset:5152
    ds_read_b64_tr_b16 v[20:21], v204 offset:64
    ds_read_b64_tr_b16 v[22:23], v204 offset:5184
    ds_read_b64_tr_b16 v[24:25], v204 offset:96
    ds_read_b64_tr_b16 v[26:27], v204 offset:5216
    ds_read_b64_tr_b16 v[28:29], v204 offset:128
    ds_read_b64_tr_b16 v[30:31], v204 offset:5248
    ds_read_b64_tr_b16 v[32:33], v204 offset:160
    ds_read_b64_tr_b16 v[34:35], v204 offset:5280
    ds_read_b64_tr_b16 v[36:37], v204 offset:192
    ds_read_b64_tr_b16 v[38:39], v204 offset:5312
    s_waitcnt lgkmcnt(14)
    v_cvt_pk_bf16_f32 v224, v224, v224
    v_lshlrev_b32 v224, 16, v224
    v_cvt_pk_bf16_f32 v226, v226, v226
    v_lshlrev_b32 v226, 16, v226
    v_mul_f32 v225, 0xbfb8aa3b, v224
    v_exp_f32 v225, v225
    s_nop 0
    v_add_f32 v225, 1.0, v225
    v_rcp_f32 v225, v225
    s_nop 0
    v_mul_f32 v224, v224, v225
    v_cvt_pk_bf16_f32 v224, v224, v224
    v_lshlrev_b32 v224, 16, v224
    v_mul_f32 v224, v224, v226
    v_cvt_pk_bf16_f32 v224, v224, v224
    ds_write_b16 v219, v224
    s_waitcnt lgkmcnt(0)
    ds_read_b128 v[224:227], v217
    ds_read_b64_tr_b16 v[40:41], v204 offset:224
    ds_read_b64_tr_b16 v[42:43], v204 offset:5344
    ds_read_b64_tr_b16 v[44:45], v204 offset:256
    ds_read_b64_tr_b16 v[46:47], v204 offset:5376
    ds_read_b64_tr_b16 v[48:49], v204 offset:288
    ds_read_b64_tr_b16 v[50:51], v204 offset:5408
    s_waitcnt lgkmcnt(6)
    v_mfma_f32_16x16x32_bf16 v[92:95], v[12:15], v[224:227], 0
    v_mfma_f32_16x16x32_bf16 v[96:99], v[16:19], v[224:227], 0
    v_mfma_f32_16x16x32_bf16 v[100:103], v[20:23], v[224:227], 0
    v_mfma_f32_16x16x32_bf16 v[104:107], v[24:27], v[224:227], 0
    v_mfma_f32_16x16x32_bf16 v[108:111], v[28:31], v[224:227], 0
    v_mfma_f32_16x16x32_bf16 v[112:115], v[32:35], v[224:227], 0
    v_mfma_f32_16x16x32_bf16 v[116:119], v[36:39], v[224:227], 0
    s_waitcnt lgkmcnt(4)
    v_mfma_f32_16x16x32_bf16 v[120:123], v[40:43], v[224:227], 0
    s_waitcnt lgkmcnt(2)
    v_mfma_f32_16x16x32_bf16 v[124:127], v[44:47], v[224:227], 0
    s_waitcnt lgkmcnt(0)
    v_mfma_f32_16x16x32_bf16 v[128:131], v[48:51], v[224:227], 0
    s_mov_b32 exec_lo, 0x00030003
    s_mov_b32 exec_hi, 0x00030003
    buffer_store_dwordx4 v[92:95], v220, s[60:63], s68 offen offset:0 sc1
    buffer_store_dwordx4 v[96:99], v220, s[60:63], s68 offen offset:64 sc1
    buffer_store_dwordx4 v[100:103], v220, s[60:63], s68 offen offset:128 sc1
    buffer_store_dwordx4 v[104:107], v220, s[60:63], s68 offen offset:192 sc1
    buffer_store_dwordx4 v[108:111], v220, s[60:63], s68 offen offset:256 sc1
    buffer_store_dwordx4 v[112:115], v220, s[60:63], s68 offen offset:320 sc1
    buffer_store_dwordx4 v[116:119], v220, s[60:63], s68 offen offset:384 sc1
    buffer_store_dwordx4 v[120:123], v220, s[60:63], s68 offen offset:448 sc1
    buffer_store_dwordx4 v[124:127], v220, s[60:63], s68 offen offset:512 sc1
    buffer_store_dwordx4 v[128:131], v220, s[60:63], s68 offen offset:576 sc1
    s_mov_b64 exec, -1
    s_lshl_b32 s3, s43, 3
    s_add_u32 s3, s3, s30
    s_lshl_b32 s3, s3, 2
    s_add_u32 s3, s3, 565232
    v_mov_b32 v2, s3
    v_mov_b32 v3, 1
    s_waitcnt vmcnt(0)
    s_mov_b64 exec, 1
    global_store_dword v2, v3, s[6:7] sc1
    s_mov_b64 exec, -1
    s_branch K_P2
K_CODE_END:
.section .rodata,"a"
.p2align 6
.amdhsa_kernel gated_mix__sliding_local_dilated__moe_arch_mod__prompt_kernel
  .amdhsa_next_free_vgpr 248
  .amdhsa_next_free_sgpr 100
  .amdhsa_accum_offset 248
  .amdhsa_group_segment_fixed_size 0
  .amdhsa_kernarg_size 96
  .amdhsa_user_sgpr_count 2
  .amdhsa_user_sgpr_kernarg_segment_ptr 1
  .amdhsa_system_sgpr_workgroup_id_x 1
.end_amdhsa_kernel
```

```asm
; @launch grid=(256,1,1) block=(512,1,1) lds=163840
.amdgcn_target "amdgcn-amd-amdhsa--gfx950"
.text
K_CPL = 32
.p2align 12
.p2align 8
.globl gated_mix__sliding_local_dilated__moe_arch_mod__prompt_kernel
.type gated_mix__sliding_local_dilated__moe_arch_mod__prompt_kernel,@function
gated_mix__sliding_local_dilated__moe_arch_mod__prompt_kernel:
    s_cmp_ge_u32 s2, 256
    s_cbranch_scc1 K_EXIT
    s_load_dwordx2 s[12:13], s[0:1], 0
    s_load_dwordx2 s[16:17], s[0:1], 8
    s_load_dwordx4 s[4:7], s[0:1], 80
    s_load_dwordx2 s[8:9], s[0:1], 16
    s_load_dwordx2 s[10:11], s[0:1], 72
    v_readfirstlane_b32 s30, v0
    s_mov_b32 s14, 0x280000
    s_mov_b32 s15, 0x20000
    s_lshr_b32 s30, s30, 6
    s_cmp_ge_u32 s2, 64
    s_cbranch_scc1 K_MAIN
    s_getpc_b64 s[38:39]
K_PC:
    s_lshr_b32 s3, s2, 3
    s_mul_i32 s3, s3, K_CPL
    v_add_u32 v2, s3, v0
    v_lshlrev_b32 v2, 7, v2
    v_min_u32 v2, K_CODE_END-K_PC-4, v2
    v_cmp_gt_u32 vcc, K_CPL, v0
    s_and_saveexec_b64 s[20:21], vcc
    s_cbranch_execz K_NOPF
    global_load_dword v6, v2, s[38:39]
K_NOPF:
    s_mov_b64 exec, -1
    s_branch K_OTHER
K_MAIN:
    s_cmp_ge_u32 s30, 4
    s_cbranch_scc1 K_OTHER
    s_bfe_u32 s3, s2, 0x20001
    s_mul_i32 s44, s3, 675840
    s_lshr_b32 s33, s2, 6
    s_mul_i32 s3, s33, 225280
    s_add_u32 s44, s44, s3
    s_mul_i32 s3, s30, 61440
    s_add_u32 s44, s44, s3
    s_sub_u32 s44, s44, 245760
    v_bfe_u32 v3, v0, 4, 2
    s_lshr_b32 s3, s2, 1
    s_and_b32 s3, s3, 28
    s_or_b32 s3, s3, 0x40000
    v_lshlrev_b32 v2, 1, v3
    v_sub_u32 v2, v0, v2
    s_bfe_u32 s49, 0x82931560, s3
    s_bfe_u32 s32, 0x64317520, s3
    v_and_b32 v2, 15, v2
    v_mul_u32_u24 v5, 3840, v3
    s_and_b32 s3, s2, 7
    s_lshl2_add_u32 s3, s33, s3
    s_add_u32 s49, s49, s3
    s_mov_b32 s33, 0x00a55a
    v_subrev_u32 v5, 160, v5
    s_mul_i32 s3, s49, 205
    s_lshr_b32 s3, s3, 11
    s_mul_i32 s3, s3, 10
    s_sub_u32 s49, s49, s3
    v_mul_u32_u24 v4, 52, v2
    v_lshrrev_b32 v4, 5, v4
    v_and_b32 v4, 24, v4
    v_bfe_u32 v4, s33, v4, 8
    v_add_u32 v4, v4, v2
    v_lshl_add_u32 v10, v4, 4, v5
    v_add_u32 v4, 1, v2
    v_lshrrev_b32 v4, 4, v4
    v_lshl_add_u32 v10, v4, 28, v10
    v_xor_b32 v2, 8, v2
    v_mul_u32_u24 v4, 52, v2
    v_lshrrev_b32 v4, 5, v4
    v_and_b32 v4, 24, v4
    v_bfe_u32 v4, s33, v4, 8
    v_add_u32 v4, v4, v2
    v_lshl_add_u32 v11, v4, 4, v5
    v_add_u32 v4, 1, v2
    v_lshrrev_b32 v4, 4, v4
    v_lshl_add_u32 v11, v4, 28, v11
    s_bitcmp1_b32 s2, 0
    s_cselect_b32 s3, 8, 0
    s_add_u32 s32, s32, s3
    s_mul_i32 s50, s32, 80
    s_mul_i32 s3, s30, 61440
    s_add_u32 s50, s50, s3
    s_lshl_b32 s46, s30, 12
    s_add_u32 s46, s46, 24576
    s_mul_i32 s45, s30, 6144
    s_mov_b32 s18, 0x258000
    s_mov_b32 s19, 0x20000
    v_xor_b32 v3, v3, v0
    v_and_b32 v3, 7, v3
    v_bfe_u32 v2, v0, 3, 3
    v_mul_u32_u24 v2, 1280, v2
    v_lshl_add_u32 v8, v3, 4, v2
    v_xor_b32 v9, 64, v8
    s_lshl_b32 s47, s49, 7
    s_mul_i32 s48, s49, 245760
    s_add_u32 s51, s44, s47
    s_add_u32 s48, s48, s50
    s_add_u32 s49, s49, 1
    s_cmp_eq_u32 s49, 10
    s_cselect_b32 s49, 0, s49
    s_waitcnt lgkmcnt(0)
    s_add_u32 m0, s46, 40960
    s_add_u32 s52, s48, 0
    buffer_load_dwordx4 v10, s[16:19], s52 offen lds
    s_add_u32 m0, s45, 40960
    s_max_i32 s52, s51, s47
    buffer_load_dwordx4 v8, s[12:15], s52 offen lds
    s_add_u32 m0, s46, 41984
    s_add_u32 s52, s48, 15360
    buffer_load_dwordx4 v10, s[16:19], s52 offen lds
    s_add_u32 m0, s45, 41984
    s_add_u32 s52, s51, 10240
    s_max_i32 s52, s52, s47
    buffer_load_dwordx4 v9, s[12:15], s52 offen lds
    s_add_u32 m0, s45, 43008
    s_add_u32 s52, s51, 20480
    buffer_load_dwordx4 v8, s[12:15], s52 offen lds
    s_add_u32 m0, s46, 43008
    s_add_u32 s52, s48, 30720
    buffer_load_dwordx4 v11, s[16:19], s52 offen lds
    s_add_u32 m0, s45, 44032
    s_add_u32 s52, s51, 30720
    buffer_load_dwordx4 v9, s[12:15], s52 offen lds
    s_add_u32 m0, s46, 44032
    s_add_u32 s52, s48, 46080
    buffer_load_dwordx4 v11, s[16:19], s52 offen lds
    s_add_u32 m0, s45, 45056
    s_add_u32 s52, s51, 40960
    buffer_load_dwordx4 v8, s[12:15], s52 offen lds
    s_add_u32 m0, s45, 46080
    s_add_u32 s52, s51, 51200
    buffer_load_dwordx4 v9, s[12:15], s52 offen lds
    s_lshl_b32 s47, s49, 7
    s_mul_i32 s48, s49, 245760
    s_add_u32 s51, s44, s47
    s_add_u32 s48, s48, s50
    s_add_u32 s49, s49, 1
    s_cmp_eq_u32 s49, 10
    s_cselect_b32 s49, 0, s49
    s_add_u32 m0, s46, 81920
    s_add_u32 s52, s48, 0
    buffer_load_dwordx4 v10, s[16:19], s52 offen lds
    s_add_u32 m0, s45, 81920
    s_max_i32 s52, s51, s47
    buffer_load_dwordx4 v8, s[12:15], s52 offen lds
    s_add_u32 m0, s46, 82944
    s_add_u32 s52, s48, 15360
    buffer_load_dwordx4 v10, s[16:19], s52 offen lds
    s_add_u32 m0, s45, 82944
    s_add_u32 s52, s51, 10240
    s_max_i32 s52, s52, s47
    buffer_load_dwordx4 v9, s[12:15], s52 offen lds
    s_add_u32 m0, s45, 83968
    s_add_u32 s52, s51, 20480
    buffer_load_dwordx4 v8, s[12:15], s52 offen lds
    s_mov_b32 s43, s30
    v_and_b32 v1, 63, v0
    v_mov_b32 v7, 0
    s_and_b32 s28, s2, 7
    s_lshr_b32 s29, s2, 3
    s_xor_b32 s30, s30, 4
    s_lshr_b32 s34, s29, 3
    s_lshl_b32 s34, s34, 2
    s_and_b32 s3, s29, 3
    s_add_u32 s34, s34, s3
    s_add_u32 s34, s34, 4
    s_bitcmp1_b32 s29, 2
    s_cselect_b32 s34, -1, s34
    s_cmp_lt_u32 s29, 8
    s_cselect_b32 s34, s29, s34
    s_lshl_b32 s40, s28, 1
    s_cmp_ge_u32 s34, 10
    s_addc_u32 s40, s40, 0
    s_sub_u32 s41, s34, 10
    s_cmp_ge_u32 s34, 10
    s_cselect_b32 s41, s41, s34
    s_mul_i32 s42, s28, 20
    s_add_u32 s42, s42, s34
    s_and_b32 s42, s42, 255
    s_lshl_b32 s42, s42, 8
    s_add_u32 s42, s42, 524288
    s_lshr_b32 s31, s28, 1
    s_mul_i32 s31, s31, 3
    s_lshr_b32 s3, s29, 3
    s_add_u32 s31, s31, s3
    s_sub_u32 s31, s31, 1
    s_and_b32 s32, s28, 1
    s_lshl_b32 s32, s32, 3
    s_and_b32 s3, s29, 7
    s_lshl_b32 s3, s3, 2
    s_lshr_b32 s3, 0x64317520, s3
    s_and_b32 s3, s3, 7
    s_add_u32 s32, s32, s3
    s_and_b32 s35, s29, 3
    s_and_b32 s3, s29, 4
    s_lshl_b32 s3, s3, 1
    s_add_u32 s35, s35, s3
    s_and_b32 s3, s28, 1
    s_lshl_b32 s3, s3, 2
    s_add_u32 s35, s35, s3
    s_branch K_LOADER
K_OTHER:
    v_and_b32 v1, 63, v0
    v_mov_b32 v7, 0
    s_and_b32 s28, s2, 7
    s_lshr_b32 s29, s2, 3
    s_xor_b32 s30, s30, 4
    s_lshr_b32 s34, s29, 3
    s_lshl_b32 s34, s34, 2
    s_and_b32 s3, s29, 3
    s_add_u32 s34, s34, s3
    s_add_u32 s34, s34, 4
    s_bitcmp1_b32 s29, 2
    s_cselect_b32 s34, -1, s34
    s_cmp_lt_u32 s29, 8
    s_cselect_b32 s34, s29, s34
    s_lshl_b32 s40, s28, 1
    s_cmp_ge_u32 s34, 10
    s_addc_u32 s40, s40, 0
    s_sub_u32 s41, s34, 10
    s_cmp_ge_u32 s34, 10
    s_cselect_b32 s41, s41, s34
    s_mul_i32 s42, s28, 20
    s_add_u32 s42, s42, s34
    s_and_b32 s42, s42, 255
    s_lshl_b32 s42, s42, 8
    s_add_u32 s42, s42, 524288
    v_mov_b32 v3, 158752
    ds_write2_b32 v3, v7, v7 offset0:0 offset1:1
    ds_write2_b32 v3, v7, v7 offset0:2 offset1:3
    ds_write2_b32 v3, v7, v7 offset0:4 offset1:5
    s_cmp_lt_u32 s29, 8
    s_cbranch_scc1 K_AUX
    s_branch K_CONS
K_LOADER:
    s_branch K_J808
K_CHM0:
K_STM0:
    s_branch K_STM4
K_STA0:
    s_branch K_STA4
K_J808:
    s_mov_b32 s24, s8
    s_mov_b32 s25, s9
    s_mov_b32 s26, 0xc8000
    s_mov_b32 s27, 0x20000
    v_and_b32 v12, 15, v1
    v_lshrrev_b32 v13, 4, v1
    v_bfe_u32 v14, v1, 2, 2
    v_and_b32 v15, 3, v1
    s_add_u32 s20, s6, 0x100000
    s_addc_u32 s21, s7, 0
    s_mov_b32 s22, 0x280000
    s_mov_b32 s23, 0x20000
    s_lshr_b32 s3, s30, 1
    s_mul_i32 s3, s3, 3
    s_mul_i32 s53, s31, 11
    s_add_u32 s53, s53, s3
    s_mul_i32 s3, s3, 4352
    s_and_b32 s33, s30, 1
    s_mul_i32 s56, s33, 40
    s_add_u32 s3, s3, s56
    s_add_u32 s3, s3, 81920
    v_mul_u32_u24 v17, 272, v12
    v_lshl_add_u32 v16, v13, 3, v17
    v_add_u32 v16, s3, v16
    v_add3_u32 v17, v17, 32, s3
    s_sub_u32 s56, 48, s56
    v_add_u32 v2, s56, v17
    v_cmp_eq_u32 vcc, 0, v13
    s_nop 1
    v_cndmask_b32 v27, v2, v17, vcc
    v_lshl_add_u32 v18, v13, 2, v14
    v_mul_u32_u24 v18, 272, v18
    v_lshl_add_u32 v18, v15, 3, v18
    v_add_u32 v18, s3, v18
    s_lshl_b32 s33, s33, 3
    s_lshl_b32 s3, s35, 10
    s_add_u32 s3, s3, s33
    v_lshl_add_u32 v19, v1, 4, s3
    s_lshl_b32 s3, s35, 8
    s_add_u32 s3, s3, s33
    s_add_u32 s3, s3, 16384
    v_lshl_add_u32 v20, v1, 4, s3
    s_mul_i32 s60, s53, 20480
    s_add_u32 s61, s60, 20480
    s_add_u32 s62, s60, 40960
    v_mov_b32 v21, 0xf149f2ca
    v_lshlrev_b32 v2, 2, v13
    v_sub_u32 v2, v12, v2
    s_cmp_eq_u32 s53, 0
    s_cselect_b32 s3, 0xf149f2ca, 0
    v_subrev_u32 v3, 0, v2
    v_and_b32 v4, 0x80000001, v3
    v_cmp_eq_u32 vcc, 0, v4
    s_nop 1
    v_cndmask_b32 v32, v21, 0, vcc
    v_cmp_eq_u32 vcc, 0x80000000, v4
    s_nop 1
    v_cndmask_b32 v28, v21, 0, vcc
    v_add_f32 v36, s3, v28
    v_subrev_u32 v3, 1, v2
    v_and_b32 v4, 0x80000001, v3
    v_cmp_eq_u32 vcc, 0, v4
    s_nop 1
    v_cndmask_b32 v33, v21, 0, vcc
    v_cmp_eq_u32 vcc, 0x80000000, v4
    s_nop 1
    v_cndmask_b32 v29, v21, 0, vcc
    v_add_f32 v37, s3, v29
    v_subrev_u32 v3, 2, v2
    v_and_b32 v4, 0x80000001, v3
    v_cmp_eq_u32 vcc, 0, v4
    s_nop 1
    v_cndmask_b32 v34, v21, 0, vcc
    v_cmp_eq_u32 vcc, 0x80000000, v4
    s_nop 1
    v_cndmask_b32 v30, v21, 0, vcc
    v_add_f32 v38, s3, v30
    v_subrev_u32 v3, 3, v2
    v_and_b32 v4, 0x80000001, v3
    v_cmp_eq_u32 vcc, 0, v4
    s_nop 1
    v_cndmask_b32 v35, v21, 0, vcc
    v_cmp_eq_u32 vcc, 0x80000000, v4
    s_nop 1
    v_cndmask_b32 v31, v21, 0, vcc
    v_add_f32 v39, s3, v31
    v_mov_b32 v3, 0x0c0c0c0c
    v_mov_b32 v4, 0xc0c0100
    v_cmp_eq_u32 vcc, 0, v28
    v_mov_b32 v5, 0x1000c0c
    s_nop 0
    v_cndmask_b32 v3, v3, v4, vcc
    v_cmp_eq_u32 vcc, 0, v29
    s_nop 1
    v_cndmask_b32 v40, v3, v5, vcc
    v_mov_b32 v3, 0x0c0c0c0c
    v_mov_b32 v4, 0xc0c0302
    v_cmp_eq_u32 vcc, 0, v30
    v_mov_b32 v5, 0x3020c0c
    s_nop 0
    v_cndmask_b32 v3, v3, v4, vcc
    v_cmp_eq_u32 vcc, 0, v31
    s_nop 1
    v_cndmask_b32 v41, v3, v5, vcc
    v_mov_b32 v3, 0x0c0c0c0c
    v_mov_b32 v4, 0xc0c0100
    v_cmp_eq_u32 vcc, 0, v32
    v_mov_b32 v5, 0x1000c0c
    s_nop 0
    v_cndmask_b32 v3, v3, v4, vcc
    v_cmp_eq_u32 vcc, 0, v33
    s_nop 1
    v_cndmask_b32 v42, v3, v5, vcc
    v_mov_b32 v3, 0x0c0c0c0c
    v_mov_b32 v4, 0xc0c0302
    v_cmp_eq_u32 vcc, 0, v34
    v_mov_b32 v5, 0x3020c0c
    s_nop 0
    v_cndmask_b32 v3, v3, v4, vcc
    v_cmp_eq_u32 vcc, 0, v35
    s_nop 1
    v_cndmask_b32 v43, v3, v5, vcc
    s_mul_i32 s3, s31, 11
    s_add_u32 s33, s3, 10
    s_lshr_b32 s3, s3, 3
    s_lshr_b32 s33, s33, 3
    s_min_u32 s33, s33, 15
    s_sub_u32 s33, s33, s3
    s_add_u32 s33, s33, 1
    s_mul_i32 s33, s33, 10
    s_bfm_b32 s36, s33, 0
    v_mul_u32_u24 v2, 205, v1
    v_lshrrev_b32 v2, 11, v2
    v_add_u32 v2, s3, v2
    v_mul_u32_u24 v2, 1496, v2
    v_lshrrev_b32 v2, 11, v2
    v_sub_u32 v2, s31, v2
    v_and_b32 v2, 1, v2
    v_lshlrev_b32 v2, 6, v2
    v_lshl_add_u32 v2, v1, 8, v2
    s_mul_i32 s3, s3, 2560
    s_lshl_b32 s33, s35, 2
    s_add_u32 s3, s3, s33
    s_add_u32 s3, s3, 524288
    v_add_u32 v23, s3, v2
    s_lshr_b32 s3, s30, 1
    s_mul_i32 s3, s3, 3
    s_and_b32 s33, s30, 1
    s_lshl_b32 s33, s33, 3
    v_lshl_add_u32 v2, v1, 4, s33
    s_lshl_b32 s33, s3, 10
    s_add_u32 s33, s33, 40960
    v_add_u32 v24, s33, v2
    s_lshl_b32 s33, s3, 8
    s_add_u32 s33, s33, 53248
    v_add_u32 v25, s33, v2
    s_lshl_b32 s33, s30, 10
    s_add_u32 s33, s33, 40960
    v_lshl_add_u32 v26, v1, 4, s33
    s_mul_i32 s60, s31, 225280
    s_mul_i32 s3, s30, 20480
    s_lshl_b32 s33, s35, 10
    s_add_u32 s3, s3, s33
    v_lshl_add_u32 v19, v1, 4, s3
    v_add_u32 v3, 163840, v19
    s_sub_u32 s3, s30, 4
    s_lshl_b32 s3, s3, 2
    v_add_u32 v4, s3, v13
    v_mul_u32_u24 v2, 20480, v4
    v_lshl_add_u32 v2, v12, 4, v2
    s_lshl_b32 s33, s35, 8
    s_add_u32 s33, s33, 16384
    s_branch K_Jbd0
K_CHM1:
K_STM1:
    s_branch K_STM5
K_STA1:
    s_branch K_STA5
K_Jbd0:
    v_add_u32 v2, s33, v2
    v_mov_b32 v5, 0x10000000
    v_cmp_gt_u32 vcc, 11, v4
    s_nop 1
    v_cndmask_b32 v2, v5, v2, vcc
    s_cmp_lt_u32 s30, 3
    s_cselect_b64 vcc, -1, 0
    s_nop 1
    v_cndmask_b32 v20, v2, v3, vcc
    s_mov_b64 s[54:55], 0xffff
    s_mov_b32 s56, 0x3fb8aa3b
    s_mov_b32 s57, s56
    s_mov_b32 s58, 0x3e64f92e
    s_mov_b32 s59, s58
    s_waitcnt vmcnt(5)
    s_barrier
    s_add_u32 m0, s46, 83968
    s_add_u32 s52, s48, 30720
    buffer_load_dwordx4 v11, s[16:19], s52 offen lds
    s_add_u32 m0, s45, 84992
    s_add_u32 s52, s51, 30720
    buffer_load_dwordx4 v9, s[12:15], s52 offen lds
    s_add_u32 m0, s46, 84992
    s_add_u32 s52, s48, 46080
    buffer_load_dwordx4 v11, s[16:19], s52 offen lds
    s_add_u32 m0, s45, 86016
    s_add_u32 s52, s51, 40960
    buffer_load_dwordx4 v8, s[12:15], s52 offen lds
    s_add_u32 m0, s45, 87040
    s_add_u32 s52, s51, 51200
    buffer_load_dwordx4 v9, s[12:15], s52 offen lds
    s_lshl_b32 s47, s49, 7
    s_mul_i32 s48, s49, 245760
    s_add_u32 s51, s44, s47
    s_add_u32 s48, s48, s50
    s_add_u32 s49, s49, 1
    s_cmp_eq_u32 s49, 10
    s_cselect_b32 s49, 0, s49
    s_add_u32 m0, s46, 0
    s_add_u32 s52, s48, 0
    buffer_load_dwordx4 v10, s[16:19], s52 offen lds
    s_add_u32 m0, s45, 0
    s_max_i32 s52, s51, s47
    buffer_load_dwordx4 v8, s[12:15], s52 offen lds
    s_add_u32 m0, s46, 1024
    s_add_u32 s52, s48, 15360
    buffer_load_dwordx4 v10, s[16:19], s52 offen lds
    s_add_u32 m0, s45, 1024
    s_add_u32 s52, s51, 10240
    s_max_i32 s52, s52, s47
    buffer_load_dwordx4 v9, s[12:15], s52 offen lds
    s_add_u32 m0, s45, 2048
    s_add_u32 s52, s51, 20480
    buffer_load_dwordx4 v8, s[12:15], s52 offen lds
    s_waitcnt vmcnt(5)
    s_barrier
    s_add_u32 m0, s46, 2048
    s_add_u32 s52, s48, 30720
    buffer_load_dwordx4 v11, s[16:19], s52 offen lds
    s_add_u32 m0, s45, 3072
    s_add_u32 s52, s51, 30720
    buffer_load_dwordx4 v9, s[12:15], s52 offen lds
    s_add_u32 m0, s46, 3072
    s_add_u32 s52, s48, 46080
    buffer_load_dwordx4 v11, s[16:19], s52 offen lds
    s_add_u32 m0, s45, 4096
    s_add_u32 s52, s51, 40960
    buffer_load_dwordx4 v8, s[12:15], s52 offen lds
    s_add_u32 m0, s45, 5120
    s_add_u32 s52, s51, 51200
    buffer_load_dwordx4 v9, s[12:15], s52 offen lds
    s_lshl_b32 s47, s49, 7
    s_mul_i32 s48, s49, 245760
    s_add_u32 s51, s44, s47
    s_add_u32 s48, s48, s50
    s_add_u32 s49, s49, 1
    s_cmp_eq_u32 s49, 10
    s_cselect_b32 s49, 0, s49
    s_add_u32 m0, s46, 40960
    s_add_u32 s52, s48, 0
    buffer_load_dwordx4 v10, s[16:19], s52 offen lds
    s_add_u32 m0, s45, 40960
    s_max_i32 s52, s51, s47
    buffer_load_dwordx4 v8, s[12:15], s52 offen lds
    s_add_u32 m0, s46, 41984
    s_add_u32 s52, s48, 15360
    buffer_load_dwordx4 v10, s[16:19], s52 offen lds
    s_add_u32 m0, s45, 41984
    s_add_u32 s52, s51, 10240
    s_max_i32 s52, s52, s47
    buffer_load_dwordx4 v9, s[12:15], s52 offen lds
    s_add_u32 m0, s45, 43008
    s_add_u32 s52, s51, 20480
    buffer_load_dwordx4 v8, s[12:15], s52 offen lds
    s_waitcnt vmcnt(5)
    s_barrier
    s_add_u32 m0, s46, 43008
    s_add_u32 s52, s48, 30720
    buffer_load_dwordx4 v11, s[16:19], s52 offen lds
    s_add_u32 m0, s45, 44032
    s_add_u32 s52, s51, 30720
    buffer_load_dwordx4 v9, s[12:15], s52 offen lds
    s_add_u32 m0, s46, 44032
    s_add_u32 s52, s48, 46080
    buffer_load_dwordx4 v11, s[16:19], s52 offen lds
    s_add_u32 m0, s45, 45056
    s_add_u32 s52, s51, 40960
    buffer_load_dwordx4 v8, s[12:15], s52 offen lds
    s_add_u32 m0, s45, 46080
    s_add_u32 s52, s51, 51200
    buffer_load_dwordx4 v9, s[12:15], s52 offen lds
    s_lshl_b32 s47, s49, 7
    s_mul_i32 s48, s49, 245760
    s_add_u32 s51, s44, s47
    s_add_u32 s48, s48, s50
    s_add_u32 s49, s49, 1
    s_cmp_eq_u32 s49, 10
    s_cselect_b32 s49, 0, s49
    s_add_u32 m0, s46, 81920
    s_add_u32 s52, s48, 0
    buffer_load_dwordx4 v10, s[16:19], s52 offen lds
    s_add_u32 m0, s45, 81920
    s_max_i32 s52, s51, s47
    buffer_load_dwordx4 v8, s[12:15], s52 offen lds
    s_add_u32 m0, s46, 82944
    s_add_u32 s52, s48, 15360
    buffer_load_dwordx4 v10, s[16:19], s52 offen lds
    s_add_u32 m0, s45, 82944
    s_add_u32 s52, s51, 10240
    s_max_i32 s52, s52, s47
    buffer_load_dwordx4 v9, s[12:15], s52 offen lds
    s_add_u32 m0, s45, 83968
    s_add_u32 s52, s51, 20480
    buffer_load_dwordx4 v8, s[12:15], s52 offen lds
    s_waitcnt vmcnt(5)
    s_barrier
    s_add_u32 m0, s46, 83968
    s_add_u32 s52, s48, 30720
    buffer_load_dwordx4 v11, s[16:19], s52 offen lds
    s_add_u32 m0, s45, 84992
    s_add_u32 s52, s51, 30720
    buffer_load_dwordx4 v9, s[12:15], s52 offen lds
    s_add_u32 m0, s46, 84992
    s_branch K_Jf98
K_CHM2:
K_STM2:
    s_branch K_STM6
K_STA2:
    s_branch K_STA6
K_Jf98:
    s_add_u32 s52, s48, 46080
    buffer_load_dwordx4 v11, s[16:19], s52 offen lds
    s_add_u32 m0, s45, 86016
    s_add_u32 s52, s51, 40960
    buffer_load_dwordx4 v8, s[12:15], s52 offen lds
    s_add_u32 m0, s45, 87040
    s_add_u32 s52, s51, 51200
    buffer_load_dwordx4 v9, s[12:15], s52 offen lds
    s_lshl_b32 s47, s49, 7
    s_mul_i32 s48, s49, 245760
    s_add_u32 s51, s44, s47
    s_add_u32 s48, s48, s50
    s_add_u32 s49, s49, 1
    s_branch K_PG0
.p2align 12
K_CHM3:
K_STM3:
    s_branch K_STM7
K_STA3:
    s_branch K_STA7
K_PG0:
    s_cmp_eq_u32 s49, 10
    s_cselect_b32 s49, 0, s49
    s_add_u32 m0, s46, 0
    s_add_u32 s52, s48, 0
    buffer_load_dwordx4 v10, s[16:19], s52 offen lds
    s_add_u32 m0, s45, 0
    s_max_i32 s52, s51, s47
    buffer_load_dwordx4 v8, s[12:15], s52 offen lds
    s_add_u32 m0, s46, 1024
    s_add_u32 s52, s48, 15360
    buffer_load_dwordx4 v10, s[16:19], s52 offen lds
    s_add_u32 m0, s45, 1024
    s_add_u32 s52, s51, 10240
    s_max_i32 s52, s52, s47
    buffer_load_dwordx4 v9, s[12:15], s52 offen lds
    s_add_u32 m0, s45, 2048
    s_add_u32 s52, s51, 20480
    buffer_load_dwordx4 v8, s[12:15], s52 offen lds
    s_waitcnt vmcnt(5)
    s_barrier
    s_add_u32 m0, s46, 2048
    s_add_u32 s52, s48, 30720
    buffer_load_dwordx4 v11, s[16:19], s52 offen lds
    s_add_u32 m0, s45, 3072
    s_add_u32 s52, s51, 30720
    buffer_load_dwordx4 v9, s[12:15], s52 offen lds
    s_add_u32 m0, s46, 3072
    s_add_u32 s52, s48, 46080
    buffer_load_dwordx4 v11, s[16:19], s52 offen lds
    s_add_u32 m0, s45, 4096
    s_add_u32 s52, s51, 40960
    buffer_load_dwordx4 v8, s[12:15], s52 offen lds
    s_add_u32 m0, s45, 5120
    s_add_u32 s52, s51, 51200
    buffer_load_dwordx4 v9, s[12:15], s52 offen lds
    s_lshl_b32 s47, s49, 7
    s_mul_i32 s48, s49, 245760
    s_add_u32 s51, s44, s47
    s_add_u32 s48, s48, s50
    s_add_u32 s49, s49, 1
    s_cmp_eq_u32 s49, 10
    s_cselect_b32 s49, 0, s49
    s_add_u32 m0, s46, 40960
    s_add_u32 s52, s48, 0
    buffer_load_dwordx4 v10, s[16:19], s52 offen lds
    s_add_u32 m0, s45, 40960
    s_max_i32 s52, s51, s47
    buffer_load_dwordx4 v8, s[12:15], s52 offen lds
    s_add_u32 m0, s46, 41984
    s_add_u32 s52, s48, 15360
    buffer_load_dwordx4 v10, s[16:19], s52 offen lds
    s_add_u32 m0, s45, 41984
    s_add_u32 s52, s51, 10240
    s_max_i32 s52, s52, s47
    buffer_load_dwordx4 v9, s[12:15], s52 offen lds
    s_add_u32 m0, s45, 43008
    s_add_u32 s52, s51, 20480
    buffer_load_dwordx4 v8, s[12:15], s52 offen lds
    s_waitcnt vmcnt(5)
    s_barrier
    s_add_u32 m0, s46, 43008
    s_add_u32 s52, s48, 30720
    buffer_load_dwordx4 v11, s[16:19], s52 offen lds
    s_add_u32 m0, s45, 44032
    s_add_u32 s52, s51, 30720
    buffer_load_dwordx4 v9, s[12:15], s52 offen lds
    s_add_u32 m0, s46, 44032
    s_add_u32 s52, s48, 46080
    buffer_load_dwordx4 v11, s[16:19], s52 offen lds
    s_add_u32 m0, s45, 45056
    s_add_u32 s52, s51, 40960
    buffer_load_dwordx4 v8, s[12:15], s52 offen lds
    s_add_u32 m0, s45, 46080
    s_add_u32 s52, s51, 51200
    buffer_load_dwordx4 v9, s[12:15], s52 offen lds
    s_lshl_b32 s47, s49, 7
    s_mul_i32 s48, s49, 245760
    s_add_u32 s51, s44, s47
    s_add_u32 s48, s48, s50
    s_add_u32 s49, s49, 1
    s_cmp_eq_u32 s49, 10
    s_cselect_b32 s49, 0, s49
    s_add_u32 m0, s46, 81920
    s_add_u32 s52, s48, 0
    buffer_load_dwordx4 v10, s[16:19], s52 offen lds
    s_add_u32 m0, s45, 81920
    s_max_i32 s52, s51, s47
    buffer_load_dwordx4 v8, s[12:15], s52 offen lds
    s_add_u32 m0, s46, 82944
    s_add_u32 s52, s48, 15360
    buffer_load_dwordx4 v10, s[16:19], s52 offen lds
    s_add_u32 m0, s45, 82944
    s_add_u32 s52, s51, 10240
    s_max_i32 s52, s52, s47
    buffer_load_dwordx4 v9, s[12:15], s52 offen lds
    s_add_u32 m0, s45, 83968
    s_add_u32 s52, s51, 20480
    buffer_load_dwordx4 v8, s[12:15], s52 offen lds
    s_waitcnt vmcnt(5)
    s_barrier
    s_add_u32 m0, s46, 83968
    s_add_u32 s52, s48, 30720
    buffer_load_dwordx4 v11, s[16:19], s52 offen lds
    s_add_u32 m0, s45, 84992
    s_add_u32 s52, s51, 30720
    buffer_load_dwordx4 v9, s[12:15], s52 offen lds
    s_add_u32 m0, s46, 84992
    s_add_u32 s52, s48, 46080
    buffer_load_dwordx4 v11, s[16:19], s52 offen lds
    s_add_u32 m0, s45, 86016
    s_add_u32 s52, s51, 40960
    buffer_load_dwordx4 v8, s[12:15], s52 offen lds
    s_add_u32 m0, s45, 87040
    s_add_u32 s52, s51, 51200
    buffer_load_dwordx4 v9, s[12:15], s52 offen lds
    s_lshl_b32 s47, s49, 7
    s_mul_i32 s48, s49, 245760
    s_add_u32 s51, s44, s47
    s_add_u32 s48, s48, s50
    s_add_u32 s49, s49, 1
    s_cmp_eq_u32 s49, 10
    s_cselect_b32 s49, 0, s49
    s_add_u32 m0, s46, 0
    s_add_u32 s52, s48, 0
    buffer_load_dwordx4 v10, s[16:19], s52 offen lds
    s_add_u32 m0, s45, 0
    s_max_i32 s52, s51, s47
    buffer_load_dwordx4 v8, s[12:15], s52 offen lds
    s_add_u32 m0, s46, 1024
    s_add_u32 s52, s48, 15360
    buffer_load_dwordx4 v10, s[16:19], s52 offen lds
    s_add_u32 m0, s45, 1024
    s_add_u32 s52, s51, 10240
    s_max_i32 s52, s52, s47
    buffer_load_dwordx4 v9, s[12:15], s52 offen lds
    s_add_u32 m0, s45, 2048
    s_add_u32 s52, s51, 20480
    buffer_load_dwordx4 v8, s[12:15], s52 offen lds
    s_waitcnt vmcnt(5)
    s_barrier
    s_add_u32 m0, s46, 2048
    s_add_u32 s52, s48, 30720
    s_branch K_J13c8
K_STM4:
    s_branch K_STM8
K_STA4:
    s_branch K_STA8
K_J13c8:
    buffer_load_dwordx4 v11, s[16:19], s52 offen lds
    s_add_u32 m0, s45, 3072
    s_add_u32 s52, s51, 30720
    buffer_load_dwordx4 v9, s[12:15], s52 offen lds
    s_add_u32 m0, s46, 3072
    s_add_u32 s52, s48, 46080
    buffer_load_dwordx4 v11, s[16:19], s52 offen lds
    s_add_u32 m0, s45, 4096
    s_add_u32 s52, s51, 40960
    buffer_load_dwordx4 v8, s[12:15], s52 offen lds
    s_add_u32 m0, s45, 5120
    s_add_u32 s52, s51, 51200
    buffer_load_dwordx4 v9, s[12:15], s52 offen lds
    s_lshl_b32 s47, s49, 7
    s_mul_i32 s48, s49, 245760
    s_add_u32 s51, s44, s47
    s_add_u32 s48, s48, s50
    s_add_u32 s49, s49, 1
    s_cmp_eq_u32 s49, 10
    s_cselect_b32 s49, 0, s49
    s_add_u32 m0, s46, 40960
    s_add_u32 s52, s48, 0
    buffer_load_dwordx4 v10, s[16:19], s52 offen lds
    s_add_u32 m0, s45, 40960
    s_max_i32 s52, s51, s47
    buffer_load_dwordx4 v8, s[12:15], s52 offen lds
    s_add_u32 m0, s46, 41984
    s_add_u32 s52, s48, 15360
    buffer_load_dwordx4 v10, s[16:19], s52 offen lds
    s_add_u32 m0, s45, 41984
    s_add_u32 s52, s51, 10240
    s_max_i32 s52, s52, s47
    buffer_load_dwordx4 v9, s[12:15], s52 offen lds
    s_add_u32 m0, s45, 43008
    s_add_u32 s52, s51, 20480
    buffer_load_dwordx4 v8, s[12:15], s52 offen lds
    s_waitcnt vmcnt(5)
    s_barrier
    s_add_u32 m0, s46, 43008
    s_add_u32 s52, s48, 30720
    buffer_load_dwordx4 v11, s[16:19], s52 offen lds
    s_add_u32 m0, s45, 44032
    s_add_u32 s52, s51, 30720
    buffer_load_dwordx4 v9, s[12:15], s52 offen lds
    s_add_u32 m0, s46, 44032
    s_add_u32 s52, s48, 46080
    buffer_load_dwordx4 v11, s[16:19], s52 offen lds
    s_add_u32 m0, s45, 45056
    s_add_u32 s52, s51, 40960
    buffer_load_dwordx4 v8, s[12:15], s52 offen lds
    s_add_u32 m0, s45, 46080
    s_add_u32 s52, s51, 51200
    buffer_load_dwordx4 v9, s[12:15], s52 offen lds
    s_waitcnt vmcnt(0)
    s_barrier
    s_cmp_eq_u32 s30, 4
    s_cbranch_scc1 K_NOSMP
    v_mov_b32 v2, 192
    global_load_dword v7, v2, s[4:5] sc1
K_NOSMP:
    s_cmp_eq_u32 s34, -1
    s_cbranch_scc1 K_NOLT
    v_lshrrev_b32 v2, 3, v1
    v_mul_u32_u24 v2, 1280, v2
    v_lshrrev_b32 v3, 4, v1
    v_lshlrev_b32 v3, 1, v3
    v_and_b32 v4, 7, v1
    v_xor_b32 v3, v3, v4
    v_lshl_add_u32 v2, v3, 4, v2
    s_lshl_b32 s33, s41, 7
    v_add_u32 v22, s33, v2
    s_lshl_b32 s47, s43, 2
    s_lshr_b32 s47, 0x7520, s47
    s_and_b32 s47, s47, 7
    s_mul_i32 s47, s47, 51200
    s_mul_i32 s48, s43, 5120
    s_add_u32 s3, s47, 0
    s_add_u32 m0, s48, 0
    s_nop 0
    buffer_load_dwordx4 v22, s[24:27], s3 offen lds
    s_add_u32 s3, s47, 10240
    s_add_u32 m0, s48, 1024
    s_nop 0
    buffer_load_dwordx4 v22, s[24:27], s3 offen lds
    s_add_u32 s3, s47, 20480
    s_add_u32 m0, s48, 2048
    s_nop 0
    buffer_load_dwordx4 v22, s[24:27], s3 offen lds
    s_add_u32 s3, s47, 30720
    s_add_u32 m0, s48, 3072
    s_nop 0
    buffer_load_dwordx4 v22, s[24:27], s3 offen lds
    s_add_u32 s3, s47, 40960
    s_add_u32 m0, s48, 4096
    s_nop 0
    buffer_load_dwordx4 v22, s[24:27], s3 offen lds
    s_add_u32 s3, s47, 409600
    s_add_u32 m0, s48, 20480
    s_nop 0
    buffer_load_dwordx4 v22, s[24:27], s3 offen lds
    s_add_u32 s3, s47, 419840
    s_add_u32 m0, s48, 21504
    s_nop 0
    buffer_load_dwordx4 v22, s[24:27], s3 offen lds
    s_add_u32 s3, s47, 430080
    s_add_u32 m0, s48, 22528
    s_nop 0
    buffer_load_dwordx4 v22, s[24:27], s3 offen lds
    s_add_u32 s3, s47, 440320
    s_add_u32 m0, s48, 23552
    s_nop 0
    buffer_load_dwordx4 v22, s[24:27], s3 offen lds
    s_add_u32 s3, s47, 450560
    s_add_u32 m0, s48, 24576
    s_nop 0
    buffer_load_dwordx4 v22, s[24:27], s3 offen lds
    s_waitcnt vmcnt(10)
    s_branch K_JOIN
K_NOLT:
    s_waitcnt vmcnt(0)
    s_branch K_JOIN
K_CONS:
    s_lshr_b32 s31, s28, 1
    s_mul_i32 s31, s31, 3
    s_lshr_b32 s3, s29, 3
    s_add_u32 s31, s31, s3
    s_sub_u32 s31, s31, 1
    s_and_b32 s32, s28, 1
    s_lshl_b32 s32, s32, 3
    s_and_b32 s3, s29, 7
    s_lshl_b32 s3, s3, 2
    s_lshr_b32 s3, 0x64317520, s3
    s_and_b32 s3, s3, 7
    s_add_u32 s32, s32, s3
    s_and_b32 s35, s29, 3
    s_and_b32 s3, s29, 4
    s_lshl_b32 s3, s3, 1
    s_add_u32 s35, s35, s3
    s_and_b32 s3, s28, 1
    s_lshl_b32 s3, s3, 2
    s_add_u32 s35, s35, s3
    v_and_b32 v12, 15, v1
    v_lshrrev_b32 v13, 4, v1
    v_bfe_u32 v14, v1, 2, 2
    v_and_b32 v15, 3, v1
    s_lshr_b32 s63, s30, 1
    s_and_b32 s64, s30, 1
    v_lshrrev_b32 v2, 1, v12
    v_xor_b32 v2, v2, v13
    v_lshlrev_b32 v2, 4, v2
    v_lshl_add_u32 v2, v12, 7, v2
    s_mul_i32 s3, s63, 12288
    v_add_u32 v44, s3, v2
    v_xor_b32 v45, 64, v44
    v_add_u32 v46, 81920, v44
    v_add_u32 v47, 81920, v45
    v_and_b32 v2, 1, v13
    v_lshl_or_b32 v2, v2, 2, v14
    s_branch K_J1790
K_STM5:
    s_branch K_STM9
K_STA5:
    s_branch K_STA9
K_J1790:
    v_lshl_add_u32 v3, v13, 3, v14
    v_lshlrev_b32 v3, 8, v3
    v_lshl_add_u32 v3, v15, 3, v3
    v_add_u32 v3, 24576, v3
    s_lshl_b32 s3, s64, 2
    v_add_u32 v2, s3, v2
    v_add_u32 v4, 0, v2
    v_and_b32 v4, 7, v4
    v_lshl_add_u32 v48, v4, 5, v3
    v_add_u32 v52, 81920, v48
    v_add_u32 v4, 1, v2
    v_and_b32 v4, 7, v4
    v_lshl_add_u32 v49, v4, 5, v3
    v_add_u32 v53, 81920, v49
    v_add_u32 v4, 2, v2
    v_and_b32 v4, 7, v4
    v_lshl_add_u32 v50, v4, 5, v3
    v_add_u32 v54, 81920, v50
    v_add_u32 v4, 3, v2
    v_and_b32 v4, 7, v4
    v_lshl_add_u32 v51, v4, 5, v3
    v_add_u32 v55, 81920, v51
    v_mul_u32_u24 v56, 272, v12
    v_lshl_add_u32 v56, v13, 3, v56
    s_mul_i32 s3, s63, 26112
    s_lshl_b32 s33, s64, 7
    s_add_u32 s3, s3, s33
    s_add_u32 s3, s3, 81920
    v_add_u32 v56, s3, v56
    s_waitcnt lgkmcnt(0)
    s_mov_b32 s24, s8
    s_mov_b32 s25, s9
    s_mov_b32 s26, 0xc8000
    s_mov_b32 s27, 0x20000
    s_mul_i32 s3, s30, 160
    v_add_u32 v57, s3, v1
    v_mul_u32_u24 v57, 1280, v57
    s_lshl_b32 s33, s41, 7
    s_and_b32 s33, s33, 0x7ff
    v_add_u32 v57, s33, v57
    s_add_u32 s20, s6, 0x100000
    s_addc_u32 s21, s7, 0
    s_mov_b32 s22, 0x280000
    s_mov_b32 s23, 0x20000
    s_lshr_b32 s3, s30, 1
    s_mul_i32 s3, s3, 3
    s_mul_i32 s53, s31, 11
    s_add_u32 s53, s53, s3
    s_mul_i32 s3, s3, 4352
    s_and_b32 s33, s30, 1
    s_mul_i32 s56, s33, 40
    s_add_u32 s3, s3, s56
    s_add_u32 s3, s3, 81920
    v_mul_u32_u24 v17, 272, v12
    v_lshl_add_u32 v16, v13, 3, v17
    v_add_u32 v16, s3, v16
    v_add3_u32 v17, v17, 32, s3
    s_sub_u32 s56, 48, s56
    v_add_u32 v2, s56, v17
    v_cmp_eq_u32 vcc, 0, v13
    s_nop 1
    v_cndmask_b32 v27, v2, v17, vcc
    v_lshl_add_u32 v18, v13, 2, v14
    v_mul_u32_u24 v18, 272, v18
    v_lshl_add_u32 v18, v15, 3, v18
    v_add_u32 v18, s3, v18
    s_lshl_b32 s33, s33, 3
    s_lshl_b32 s3, s35, 10
    s_add_u32 s3, s3, s33
    v_lshl_add_u32 v19, v1, 4, s3
    s_lshl_b32 s3, s35, 8
    s_add_u32 s3, s3, s33
    s_add_u32 s3, s3, 16384
    v_lshl_add_u32 v20, v1, 4, s3
    s_mul_i32 s60, s53, 20480
    s_add_u32 s61, s60, 20480
    s_add_u32 s62, s60, 40960
    v_mov_b32 v21, 0xf149f2ca
    v_lshlrev_b32 v2, 2, v13
    v_sub_u32 v2, v12, v2
    s_cmp_eq_u32 s53, 0
    s_cselect_b32 s3, 0xf149f2ca, 0
    v_subrev_u32 v3, 0, v2
    v_and_b32 v4, 0x80000001, v3
    v_cmp_eq_u32 vcc, 0, v4
    s_nop 1
    v_cndmask_b32 v32, v21, 0, vcc
    v_cmp_eq_u32 vcc, 0x80000000, v4
    s_nop 1
    v_cndmask_b32 v28, v21, 0, vcc
    v_add_f32 v36, s3, v28
    v_subrev_u32 v3, 1, v2
    v_and_b32 v4, 0x80000001, v3
    v_cmp_eq_u32 vcc, 0, v4
    s_nop 1
    v_cndmask_b32 v33, v21, 0, vcc
    v_cmp_eq_u32 vcc, 0x80000000, v4
    s_nop 1
    v_cndmask_b32 v29, v21, 0, vcc
    v_add_f32 v37, s3, v29
    v_subrev_u32 v3, 2, v2
    v_and_b32 v4, 0x80000001, v3
    v_cmp_eq_u32 vcc, 0, v4
    s_nop 1
    v_cndmask_b32 v34, v21, 0, vcc
    v_cmp_eq_u32 vcc, 0x80000000, v4
    s_nop 1
    v_cndmask_b32 v30, v21, 0, vcc
    v_add_f32 v38, s3, v30
    v_subrev_u32 v3, 3, v2
    v_and_b32 v4, 0x80000001, v3
    v_cmp_eq_u32 vcc, 0, v4
    s_nop 1
    v_cndmask_b32 v35, v21, 0, vcc
    v_cmp_eq_u32 vcc, 0x80000000, v4
    s_nop 1
    v_cndmask_b32 v31, v21, 0, vcc
    v_add_f32 v39, s3, v31
    v_mov_b32 v3, 0x0c0c0c0c
    v_mov_b32 v4, 0xc0c0100
    v_cmp_eq_u32 vcc, 0, v28
    v_mov_b32 v5, 0x1000c0c
    s_nop 0
    v_cndmask_b32 v3, v3, v4, vcc
    v_cmp_eq_u32 vcc, 0, v29
    s_nop 1
    v_cndmask_b32 v40, v3, v5, vcc
    v_mov_b32 v3, 0x0c0c0c0c
    v_mov_b32 v4, 0xc0c0302
    v_cmp_eq_u32 vcc, 0, v30
    v_mov_b32 v5, 0x3020c0c
    s_nop 0
    v_cndmask_b32 v3, v3, v4, vcc
    v_cmp_eq_u32 vcc, 0, v31
    s_nop 1
    v_cndmask_b32 v41, v3, v5, vcc
    v_mov_b32 v3, 0x0c0c0c0c
    v_mov_b32 v4, 0xc0c0100
    v_cmp_eq_u32 vcc, 0, v32
    v_mov_b32 v5, 0x1000c0c
    s_nop 0
    v_cndmask_b32 v3, v3, v4, vcc
    v_cmp_eq_u32 vcc, 0, v33
    s_nop 1
    v_cndmask_b32 v42, v3, v5, vcc
    v_mov_b32 v3, 0x0c0c0c0c
    v_mov_b32 v4, 0xc0c0302
    v_cmp_eq_u32 vcc, 0, v34
    v_mov_b32 v5, 0x3020c0c
    s_nop 0
    v_cndmask_b32 v3, v3, v4, vcc
    v_cmp_eq_u32 vcc, 0, v35
    s_nop 1
    v_cndmask_b32 v43, v3, v5, vcc
    s_mul_i32 s3, s31, 11
    s_add_u32 s33, s3, 10
    s_lshr_b32 s3, s3, 3
    s_lshr_b32 s33, s33, 3
    s_min_u32 s33, s33, 15
    s_sub_u32 s33, s33, s3
    s_add_u32 s33, s33, 1
    s_mul_i32 s33, s33, 10
    s_bfm_b32 s36, s33, 0
    v_mul_u32_u24 v2, 205, v1
    v_lshrrev_b32 v2, 11, v2
    v_add_u32 v2, s3, v2
    v_mul_u32_u24 v2, 1496, v2
    v_lshrrev_b32 v2, 11, v2
    v_sub_u32 v2, s31, v2
    s_branch K_J1b54
K_STM6:
    s_branch K_STM10
K_STA6:
    s_branch K_STA10
K_J1b54:
    v_and_b32 v2, 1, v2
    v_lshlrev_b32 v2, 6, v2
    v_lshl_add_u32 v2, v1, 8, v2
    s_mul_i32 s3, s3, 2560
    s_lshl_b32 s33, s35, 2
    s_add_u32 s3, s3, s33
    s_add_u32 s3, s3, 524288
    v_add_u32 v23, s3, v2
    s_lshr_b32 s3, s30, 1
    s_mul_i32 s3, s3, 3
    s_and_b32 s33, s30, 1
    s_lshl_b32 s33, s33, 3
    v_lshl_add_u32 v2, v1, 4, s33
    s_lshl_b32 s33, s3, 10
    s_add_u32 s33, s33, 40960
    v_add_u32 v24, s33, v2
    s_lshl_b32 s33, s3, 8
    s_add_u32 s33, s33, 53248
    v_add_u32 v25, s33, v2
    s_lshl_b32 s33, s30, 10
    s_add_u32 s33, s33, 40960
    v_lshl_add_u32 v26, v1, 4, s33
    s_mul_i32 s60, s31, 225280
    s_mul_i32 s3, s30, 20480
    s_lshl_b32 s33, s35, 10
    s_add_u32 s3, s3, s33
    v_lshl_add_u32 v19, v1, 4, s3
    v_add_u32 v3, 163840, v19
    s_sub_u32 s3, s30, 4
    s_lshl_b32 s3, s3, 2
    v_add_u32 v4, s3, v13
    v_mul_u32_u24 v2, 20480, v4
    v_lshl_add_u32 v2, v12, 4, v2
    s_lshl_b32 s33, s35, 8
    s_add_u32 s33, s33, 16384
    v_add_u32 v2, s33, v2
    v_mov_b32 v5, 0x10000000
    v_cmp_gt_u32 vcc, 11, v4
    s_nop 1
    v_cndmask_b32 v2, v5, v2, vcc
    s_cmp_lt_u32 s30, 3
    s_cselect_b64 vcc, -1, 0
    s_nop 1
    v_cndmask_b32 v20, v2, v3, vcc
    s_mov_b64 s[54:55], 0xffff
    s_mov_b32 s56, 0x3fb8aa3b
    s_mov_b32 s57, s56
    s_mov_b32 s58, 0x3e64f92e
    s_mov_b32 s59, s58
    v_and_b32 v156, -16, v19
    v_and_b32 v157, -16, v20
    s_mul_i32 s65, s31, 11
    s_add_u32 s65, s65, s30
    s_mul_i32 s65, s65, 20480
    s_cmp_eq_u32 s30, 0
    s_cbranch_scc1 K_CHM0
    s_cmp_eq_u32 s30, 1
    s_cbranch_scc1 K_CHM1
    s_cmp_eq_u32 s30, 2
    s_cbranch_scc1 K_CHM2
    s_branch K_CHM3
K_WRET_M:
    s_setprio 2
    s_barrier
    ds_read_b64_tr_b16 v[208:209], v48 offset:40960
    ds_read_b64_tr_b16 v[210:211], v48 offset:41984
    ds_read_b128 v[160:163], v44 offset:40960
    ds_read_b64_tr_b16 v[212:213], v49 offset:40960
    ds_read_b64_tr_b16 v[214:215], v49 offset:41984
    ds_read_b128 v[164:167], v44 offset:43008
    ds_read_b64_tr_b16 v[216:217], v50 offset:40960
    ds_read_b64_tr_b16 v[218:219], v50 offset:41984
    ds_read_b128 v[168:171], v44 offset:45056
    ds_read_b64_tr_b16 v[220:221], v51 offset:40960
    ds_read_b64_tr_b16 v[222:223], v51 offset:41984
    ds_read_b128 v[172:175], v44 offset:47104
    ds_read_b128 v[176:179], v44 offset:49152
    ds_read_b128 v[180:183], v44 offset:51200
    s_waitcnt lgkmcnt(0)
    v_mfma_f32_16x16x32_bf16 v[60:63], v[208:211], v[160:163], 0
    ds_read_b64_tr_b16 v[224:225], v48 offset:49152
    v_mfma_f32_16x16x32_bf16 v[64:67], v[212:215], v[160:163], 0
    ds_read_b64_tr_b16 v[226:227], v48 offset:50176
    v_mfma_f32_16x16x32_bf16 v[68:71], v[216:219], v[160:163], 0
    ds_read_b128 v[184:187], v45 offset:40960
    v_mfma_f32_16x16x32_bf16 v[72:75], v[220:223], v[160:163], 0
    ds_read_b64_tr_b16 v[228:229], v49 offset:49152
    v_mfma_f32_16x16x32_bf16 v[88:91], v[220:223], v[164:167], 0
    ds_read_b64_tr_b16 v[230:231], v49 offset:50176
    v_mfma_f32_16x16x32_bf16 v[84:87], v[216:219], v[164:167], 0
    ds_read_b128 v[188:191], v45 offset:43008
    v_mfma_f32_16x16x32_bf16 v[80:83], v[212:215], v[164:167], 0
    ds_read_b64_tr_b16 v[232:233], v50 offset:49152
    v_mfma_f32_16x16x32_bf16 v[76:79], v[208:211], v[164:167], 0
    ds_read_b64_tr_b16 v[234:235], v50 offset:50176
    v_mfma_f32_16x16x32_bf16 v[92:95], v[208:211], v[168:171], 0
    ds_read_b128 v[192:195], v45 offset:45056
    v_mfma_f32_16x16x32_bf16 v[96:99], v[212:215], v[168:171], 0
    ds_read_b64_tr_b16 v[236:237], v51 offset:49152
    v_mfma_f32_16x16x32_bf16 v[100:103], v[216:219], v[168:171], 0
    ds_read_b64_tr_b16 v[238:239], v51 offset:50176
    v_mfma_f32_16x16x32_bf16 v[104:107], v[220:223], v[168:171], 0
    ds_read_b128 v[196:199], v45 offset:47104
    v_mfma_f32_16x16x32_bf16 v[120:123], v[220:223], v[172:175], 0
    ds_read_b128 v[200:203], v45 offset:49152
    v_mfma_f32_16x16x32_bf16 v[116:119], v[216:219], v[172:175], 0
    ds_read_b128 v[204:207], v45 offset:51200
    v_mfma_f32_16x16x32_bf16 v[112:115], v[212:215], v[172:175], 0
    v_mfma_f32_16x16x32_bf16 v[108:111], v[208:211], v[172:175], 0
    v_mfma_f32_16x16x32_bf16 v[124:127], v[208:211], v[176:179], 0
    v_mfma_f32_16x16x32_bf16 v[128:131], v[212:215], v[176:179], 0
    v_mfma_f32_16x16x32_bf16 v[132:135], v[216:219], v[176:179], 0
    v_mfma_f32_16x16x32_bf16 v[136:139], v[220:223], v[176:179], 0
    v_mfma_f32_16x16x32_bf16 v[152:155], v[220:223], v[180:183], 0
    v_mfma_f32_16x16x32_bf16 v[148:151], v[216:219], v[180:183], 0
    v_mfma_f32_16x16x32_bf16 v[144:147], v[212:215], v[180:183], 0
    v_mfma_f32_16x16x32_bf16 v[140:143], v[208:211], v[180:183], 0
    s_waitcnt lgkmcnt(0)
    s_barrier
    v_mfma_f32_16x16x32_bf16 v[60:63], v[224:227], v[184:187], v[60:63]
    ds_read_b64_tr_b16 v[208:209], v52 offset:0
    v_mfma_f32_16x16x32_bf16 v[64:67], v[228:231], v[184:187], v[64:67]
    ds_read_b64_tr_b16 v[210:211], v52 offset:1024
    v_mfma_f32_16x16x32_bf16 v[68:71], v[232:235], v[184:187], v[68:71]
    ds_read_b128 v[160:163], v46 offset:0
    v_mfma_f32_16x16x32_bf16 v[72:75], v[236:239], v[184:187], v[72:75]
    ds_read_b64_tr_b16 v[212:213], v53 offset:0
    v_mfma_f32_16x16x32_bf16 v[88:91], v[236:239], v[188:191], v[88:91]
    ds_read_b64_tr_b16 v[214:215], v53 offset:1024
    v_mfma_f32_16x16x32_bf16 v[84:87], v[232:235], v[188:191], v[84:87]
    ds_read_b128 v[164:167], v46 offset:2048
    v_mfma_f32_16x16x32_bf16 v[80:83], v[228:231], v[188:191], v[80:83]
    ds_read_b64_tr_b16 v[216:217], v54 offset:0
    v_mfma_f32_16x16x32_bf16 v[76:79], v[224:227], v[188:191], v[76:79]
    ds_read_b64_tr_b16 v[218:219], v54 offset:1024
    v_mfma_f32_16x16x32_bf16 v[92:95], v[224:227], v[192:195], v[92:95]
    ds_read_b128 v[168:171], v46 offset:4096
    v_mfma_f32_16x16x32_bf16 v[96:99], v[228:231], v[192:195], v[96:99]
    ds_read_b64_tr_b16 v[220:221], v55 offset:0
    v_mfma_f32_16x16x32_bf16 v[100:103], v[232:235], v[192:195], v[100:103]
    ds_read_b64_tr_b16 v[222:223], v55 offset:1024
    v_mfma_f32_16x16x32_bf16 v[104:107], v[236:239], v[192:195], v[104:107]
    ds_read_b128 v[172:175], v46 offset:6144
    s_branch K_J1f18
K_STM7:
    s_branch K_STM11
K_STA7:
    s_branch K_STA11
K_J1f18:
    v_mfma_f32_16x16x32_bf16 v[120:123], v[236:239], v[196:199], v[120:123]
    ds_read_b128 v[176:179], v46 offset:8192
    v_mfma_f32_16x16x32_bf16 v[116:119], v[232:235], v[196:199], v[116:119]
    ds_read_b128 v[180:183], v46 offset:10240
    v_mfma_f32_16x16x32_bf16 v[112:115], v[228:231], v[196:199], v[112:115]
    v_mfma_f32_16x16x32_bf16 v[108:111], v[224:227], v[196:199], v[108:111]
    v_mfma_f32_16x16x32_bf16 v[124:127], v[224:227], v[200:203], v[124:127]
    v_mfma_f32_16x16x32_bf16 v[128:131], v[228:231], v[200:203], v[128:131]
    v_mfma_f32_16x16x32_bf16 v[132:135], v[232:235], v[200:203], v[132:135]
    v_mfma_f32_16x16x32_bf16 v[136:139], v[236:239], v[200:203], v[136:139]
    v_mfma_f32_16x16x32_bf16 v[152:155], v[236:239], v[204:207], v[152:155]
    v_mfma_f32_16x16x32_bf16 v[148:151], v[232:235], v[204:207], v[148:151]
    v_mfma_f32_16x16x32_bf16 v[144:147], v[228:231], v[204:207], v[144:147]
    v_mfma_f32_16x16x32_bf16 v[140:143], v[224:227], v[204:207], v[140:143]
    s_waitcnt lgkmcnt(0)
    v_mfma_f32_16x16x32_bf16 v[60:63], v[208:211], v[160:163], v[60:63]
    ds_read_b64_tr_b16 v[224:225], v52 offset:8192
    v_mfma_f32_16x16x32_bf16 v[64:67], v[212:215], v[160:163], v[64:67]
    ds_read_b64_tr_b16 v[226:227], v52 offset:9216
    v_mfma_f32_16x16x32_bf16 v[68:71], v[216:219], v[160:163], v[68:71]
    ds_read_b128 v[184:187], v47 offset:0
    v_mfma_f32_16x16x32_bf16 v[72:75], v[220:223], v[160:163], v[72:75]
    ds_read_b64_tr_b16 v[228:229], v53 offset:8192
    v_mfma_f32_16x16x32_bf16 v[88:91], v[220:223], v[164:167], v[88:91]
    ds_read_b64_tr_b16 v[230:231], v53 offset:9216
    v_mfma_f32_16x16x32_bf16 v[84:87], v[216:219], v[164:167], v[84:87]
    ds_read_b128 v[188:191], v47 offset:2048
    s_branch K_PG1
.p2align 12
K_STM8:
    s_branch K_STM12
K_STA8:
    s_branch K_STA12
K_PG1:
    v_mfma_f32_16x16x32_bf16 v[80:83], v[212:215], v[164:167], v[80:83]
    ds_read_b64_tr_b16 v[232:233], v54 offset:8192
    v_mfma_f32_16x16x32_bf16 v[76:79], v[208:211], v[164:167], v[76:79]
    ds_read_b64_tr_b16 v[234:235], v54 offset:9216
    v_mfma_f32_16x16x32_bf16 v[92:95], v[208:211], v[168:171], v[92:95]
    ds_read_b128 v[192:195], v47 offset:4096
    v_mfma_f32_16x16x32_bf16 v[96:99], v[212:215], v[168:171], v[96:99]
    ds_read_b64_tr_b16 v[236:237], v55 offset:8192
    v_mfma_f32_16x16x32_bf16 v[100:103], v[216:219], v[168:171], v[100:103]
    ds_read_b64_tr_b16 v[238:239], v55 offset:9216
    v_mfma_f32_16x16x32_bf16 v[104:107], v[220:223], v[168:171], v[104:107]
    ds_read_b128 v[196:199], v47 offset:6144
    v_mfma_f32_16x16x32_bf16 v[120:123], v[220:223], v[172:175], v[120:123]
    ds_read_b128 v[200:203], v47 offset:8192
    v_mfma_f32_16x16x32_bf16 v[116:119], v[216:219], v[172:175], v[116:119]
    ds_read_b128 v[204:207], v47 offset:10240
    v_mfma_f32_16x16x32_bf16 v[112:115], v[212:215], v[172:175], v[112:115]
    v_mfma_f32_16x16x32_bf16 v[108:111], v[208:211], v[172:175], v[108:111]
    v_mfma_f32_16x16x32_bf16 v[124:127], v[208:211], v[176:179], v[124:127]
    v_mfma_f32_16x16x32_bf16 v[128:131], v[212:215], v[176:179], v[128:131]
    v_mfma_f32_16x16x32_bf16 v[132:135], v[216:219], v[176:179], v[132:135]
    v_mfma_f32_16x16x32_bf16 v[136:139], v[220:223], v[176:179], v[136:139]
    v_mfma_f32_16x16x32_bf16 v[152:155], v[220:223], v[180:183], v[152:155]
    v_mfma_f32_16x16x32_bf16 v[148:151], v[216:219], v[180:183], v[148:151]
    v_mfma_f32_16x16x32_bf16 v[144:147], v[212:215], v[180:183], v[144:147]
    v_mfma_f32_16x16x32_bf16 v[140:143], v[208:211], v[180:183], v[140:143]
    s_waitcnt lgkmcnt(0)
    s_barrier
    v_mfma_f32_16x16x32_bf16 v[60:63], v[224:227], v[184:187], v[60:63]
    ds_read_b64_tr_b16 v[208:209], v48 offset:0
    v_mfma_f32_16x16x32_bf16 v[64:67], v[228:231], v[184:187], v[64:67]
    ds_read_b64_tr_b16 v[210:211], v48 offset:1024
    v_mfma_f32_16x16x32_bf16 v[68:71], v[232:235], v[184:187], v[68:71]
    ds_read_b128 v[160:163], v44 offset:0
    v_mfma_f32_16x16x32_bf16 v[72:75], v[236:239], v[184:187], v[72:75]
    ds_read_b64_tr_b16 v[212:213], v49 offset:0
    v_mfma_f32_16x16x32_bf16 v[88:91], v[236:239], v[188:191], v[88:91]
    ds_read_b64_tr_b16 v[214:215], v49 offset:1024
    v_mfma_f32_16x16x32_bf16 v[84:87], v[232:235], v[188:191], v[84:87]
    ds_read_b128 v[164:167], v44 offset:2048
    v_mfma_f32_16x16x32_bf16 v[80:83], v[228:231], v[188:191], v[80:83]
    ds_read_b64_tr_b16 v[216:217], v50 offset:0
    v_mfma_f32_16x16x32_bf16 v[76:79], v[224:227], v[188:191], v[76:79]
    ds_read_b64_tr_b16 v[218:219], v50 offset:1024
    v_mfma_f32_16x16x32_bf16 v[92:95], v[224:227], v[192:195], v[92:95]
    ds_read_b128 v[168:171], v44 offset:4096
    v_mfma_f32_16x16x32_bf16 v[96:99], v[228:231], v[192:195], v[96:99]
    ds_read_b64_tr_b16 v[220:221], v51 offset:0
    v_mfma_f32_16x16x32_bf16 v[100:103], v[232:235], v[192:195], v[100:103]
    ds_read_b64_tr_b16 v[222:223], v51 offset:1024
    v_mfma_f32_16x16x32_bf16 v[104:107], v[236:239], v[192:195], v[104:107]
    ds_read_b128 v[172:175], v44 offset:6144
    v_mfma_f32_16x16x32_bf16 v[120:123], v[236:239], v[196:199], v[120:123]
    ds_read_b128 v[176:179], v44 offset:8192
    v_mfma_f32_16x16x32_bf16 v[116:119], v[232:235], v[196:199], v[116:119]
    ds_read_b128 v[180:183], v44 offset:10240
    v_mfma_f32_16x16x32_bf16 v[112:115], v[228:231], v[196:199], v[112:115]
    v_mfma_f32_16x16x32_bf16 v[108:111], v[224:227], v[196:199], v[108:111]
    v_mfma_f32_16x16x32_bf16 v[124:127], v[224:227], v[200:203], v[124:127]
    v_mfma_f32_16x16x32_bf16 v[128:131], v[228:231], v[200:203], v[128:131]
    v_mfma_f32_16x16x32_bf16 v[132:135], v[232:235], v[200:203], v[132:135]
    v_mfma_f32_16x16x32_bf16 v[136:139], v[236:239], v[200:203], v[136:139]
    v_mfma_f32_16x16x32_bf16 v[152:155], v[236:239], v[204:207], v[152:155]
    v_mfma_f32_16x16x32_bf16 v[148:151], v[232:235], v[204:207], v[148:151]
    v_mfma_f32_16x16x32_bf16 v[144:147], v[228:231], v[204:207], v[144:147]
    v_mfma_f32_16x16x32_bf16 v[140:143], v[224:227], v[204:207], v[140:143]
    s_waitcnt lgkmcnt(0)
    v_mfma_f32_16x16x32_bf16 v[60:63], v[208:211], v[160:163], v[60:63]
    ds_read_b64_tr_b16 v[224:225], v48 offset:8192
    v_mfma_f32_16x16x32_bf16 v[64:67], v[212:215], v[160:163], v[64:67]
    ds_read_b64_tr_b16 v[226:227], v48 offset:9216
    v_mfma_f32_16x16x32_bf16 v[68:71], v[216:219], v[160:163], v[68:71]
    ds_read_b128 v[184:187], v45 offset:0
    v_mfma_f32_16x16x32_bf16 v[72:75], v[220:223], v[160:163], v[72:75]
    ds_read_b64_tr_b16 v[228:229], v49 offset:8192
    v_mfma_f32_16x16x32_bf16 v[88:91], v[220:223], v[164:167], v[88:91]
    ds_read_b64_tr_b16 v[230:231], v49 offset:9216
    v_mfma_f32_16x16x32_bf16 v[84:87], v[216:219], v[164:167], v[84:87]
    ds_read_b128 v[188:191], v45 offset:2048
    v_mfma_f32_16x16x32_bf16 v[80:83], v[212:215], v[164:167], v[80:83]
    ds_read_b64_tr_b16 v[232:233], v50 offset:8192
    v_mfma_f32_16x16x32_bf16 v[76:79], v[208:211], v[164:167], v[76:79]
    ds_read_b64_tr_b16 v[234:235], v50 offset:9216
    v_mfma_f32_16x16x32_bf16 v[92:95], v[208:211], v[168:171], v[92:95]
    ds_read_b128 v[192:195], v45 offset:4096
    v_mfma_f32_16x16x32_bf16 v[96:99], v[212:215], v[168:171], v[96:99]
    ds_read_b64_tr_b16 v[236:237], v51 offset:8192
    v_mfma_f32_16x16x32_bf16 v[100:103], v[216:219], v[168:171], v[100:103]
    ds_read_b64_tr_b16 v[238:239], v51 offset:9216
    v_mfma_f32_16x16x32_bf16 v[104:107], v[220:223], v[168:171], v[104:107]
    ds_read_b128 v[196:199], v45 offset:6144
    v_mfma_f32_16x16x32_bf16 v[120:123], v[220:223], v[172:175], v[120:123]
    ds_read_b128 v[200:203], v45 offset:8192
    v_mfma_f32_16x16x32_bf16 v[116:119], v[216:219], v[172:175], v[116:119]
    ds_read_b128 v[204:207], v45 offset:10240
    v_mfma_f32_16x16x32_bf16 v[112:115], v[212:215], v[172:175], v[112:115]
    v_mfma_f32_16x16x32_bf16 v[108:111], v[208:211], v[172:175], v[108:111]
    v_mfma_f32_16x16x32_bf16 v[124:127], v[208:211], v[176:179], v[124:127]
    v_mfma_f32_16x16x32_bf16 v[128:131], v[212:215], v[176:179], v[128:131]
    v_mfma_f32_16x16x32_bf16 v[132:135], v[216:219], v[176:179], v[132:135]
    v_mfma_f32_16x16x32_bf16 v[136:139], v[220:223], v[176:179], v[136:139]
    v_mfma_f32_16x16x32_bf16 v[152:155], v[220:223], v[180:183], v[152:155]
    v_mfma_f32_16x16x32_bf16 v[148:151], v[216:219], v[180:183], v[148:151]
    v_mfma_f32_16x16x32_bf16 v[144:147], v[212:215], v[180:183], v[144:147]
    v_mfma_f32_16x16x32_bf16 v[140:143], v[208:211], v[180:183], v[140:143]
    s_waitcnt lgkmcnt(0)
    s_barrier
    v_mfma_f32_16x16x32_bf16 v[60:63], v[224:227], v[184:187], v[60:63]
    ds_read_b64_tr_b16 v[208:209], v48 offset:40960
    v_mfma_f32_16x16x32_bf16 v[64:67], v[228:231], v[184:187], v[64:67]
    ds_read_b64_tr_b16 v[210:211], v48 offset:41984
    v_mfma_f32_16x16x32_bf16 v[68:71], v[232:235], v[184:187], v[68:71]
    ds_read_b128 v[160:163], v44 offset:40960
    v_mfma_f32_16x16x32_bf16 v[72:75], v[236:239], v[184:187], v[72:75]
    ds_read_b64_tr_b16 v[212:213], v49 offset:40960
    v_mfma_f32_16x16x32_bf16 v[88:91], v[236:239], v[188:191], v[88:91]
    ds_read_b64_tr_b16 v[214:215], v49 offset:41984
    v_mfma_f32_16x16x32_bf16 v[84:87], v[232:235], v[188:191], v[84:87]
    ds_read_b128 v[164:167], v44 offset:43008
    v_mfma_f32_16x16x32_bf16 v[80:83], v[228:231], v[188:191], v[80:83]
    ds_read_b64_tr_b16 v[216:217], v50 offset:40960
    v_mfma_f32_16x16x32_bf16 v[76:79], v[224:227], v[188:191], v[76:79]
    ds_read_b64_tr_b16 v[218:219], v50 offset:41984
    s_branch K_J23cc
K_STM9:
    s_branch K_STM13
K_STA9:
    s_branch K_STA13
K_J23cc:
    v_mfma_f32_16x16x32_bf16 v[92:95], v[224:227], v[192:195], v[92:95]
    ds_read_b128 v[168:171], v44 offset:45056
    v_mfma_f32_16x16x32_bf16 v[96:99], v[228:231], v[192:195], v[96:99]
    ds_read_b64_tr_b16 v[220:221], v51 offset:40960
    v_mfma_f32_16x16x32_bf16 v[100:103], v[232:235], v[192:195], v[100:103]
    ds_read_b64_tr_b16 v[222:223], v51 offset:41984
    v_mfma_f32_16x16x32_bf16 v[104:107], v[236:239], v[192:195], v[104:107]
    ds_read_b128 v[172:175], v44 offset:47104
    v_mfma_f32_16x16x32_bf16 v[120:123], v[236:239], v[196:199], v[120:123]
    ds_read_b128 v[176:179], v44 offset:49152
    v_mfma_f32_16x16x32_bf16 v[116:119], v[232:235], v[196:199], v[116:119]
    ds_read_b128 v[180:183], v44 offset:51200
    v_mfma_f32_16x16x32_bf16 v[112:115], v[228:231], v[196:199], v[112:115]
    v_mfma_f32_16x16x32_bf16 v[108:111], v[224:227], v[196:199], v[108:111]
    v_mfma_f32_16x16x32_bf16 v[124:127], v[224:227], v[200:203], v[124:127]
    v_mfma_f32_16x16x32_bf16 v[128:131], v[228:231], v[200:203], v[128:131]
    v_mfma_f32_16x16x32_bf16 v[132:135], v[232:235], v[200:203], v[132:135]
    v_mfma_f32_16x16x32_bf16 v[136:139], v[236:239], v[200:203], v[136:139]
    v_mfma_f32_16x16x32_bf16 v[152:155], v[236:239], v[204:207], v[152:155]
    v_mfma_f32_16x16x32_bf16 v[148:151], v[232:235], v[204:207], v[148:151]
    v_mfma_f32_16x16x32_bf16 v[144:147], v[228:231], v[204:207], v[144:147]
    v_mfma_f32_16x16x32_bf16 v[140:143], v[224:227], v[204:207], v[140:143]
    s_waitcnt lgkmcnt(0)
    v_mfma_f32_16x16x32_bf16 v[60:63], v[208:211], v[160:163], v[60:63]
    ds_read_b64_tr_b16 v[224:225], v48 offset:49152
    v_mfma_f32_16x16x32_bf16 v[64:67], v[212:215], v[160:163], v[64:67]
    ds_read_b64_tr_b16 v[226:227], v48 offset:50176
    v_mfma_f32_16x16x32_bf16 v[68:71], v[216:219], v[160:163], v[68:71]
    ds_read_b128 v[184:187], v45 offset:40960
    v_mfma_f32_16x16x32_bf16 v[72:75], v[220:223], v[160:163], v[72:75]
    ds_read_b64_tr_b16 v[228:229], v49 offset:49152
    v_mfma_f32_16x16x32_bf16 v[88:91], v[220:223], v[164:167], v[88:91]
    ds_read_b64_tr_b16 v[230:231], v49 offset:50176
    v_mfma_f32_16x16x32_bf16 v[84:87], v[216:219], v[164:167], v[84:87]
    ds_read_b128 v[188:191], v45 offset:43008
    v_mfma_f32_16x16x32_bf16 v[80:83], v[212:215], v[164:167], v[80:83]
    ds_read_b64_tr_b16 v[232:233], v50 offset:49152
    v_mfma_f32_16x16x32_bf16 v[76:79], v[208:211], v[164:167], v[76:79]
    ds_read_b64_tr_b16 v[234:235], v50 offset:50176
    v_mfma_f32_16x16x32_bf16 v[92:95], v[208:211], v[168:171], v[92:95]
    ds_read_b128 v[192:195], v45 offset:45056
    v_mfma_f32_16x16x32_bf16 v[96:99], v[212:215], v[168:171], v[96:99]
    ds_read_b64_tr_b16 v[236:237], v51 offset:49152
    v_mfma_f32_16x16x32_bf16 v[100:103], v[216:219], v[168:171], v[100:103]
    ds_read_b64_tr_b16 v[238:239], v51 offset:50176
    v_mfma_f32_16x16x32_bf16 v[104:107], v[220:223], v[168:171], v[104:107]
    ds_read_b128 v[196:199], v45 offset:47104
    v_mfma_f32_16x16x32_bf16 v[120:123], v[220:223], v[172:175], v[120:123]
    ds_read_b128 v[200:203], v45 offset:49152
    v_mfma_f32_16x16x32_bf16 v[116:119], v[216:219], v[172:175], v[116:119]
    ds_read_b128 v[204:207], v45 offset:51200
    v_mfma_f32_16x16x32_bf16 v[112:115], v[212:215], v[172:175], v[112:115]
    v_mfma_f32_16x16x32_bf16 v[108:111], v[208:211], v[172:175], v[108:111]
    v_mfma_f32_16x16x32_bf16 v[124:127], v[208:211], v[176:179], v[124:127]
    v_mfma_f32_16x16x32_bf16 v[128:131], v[212:215], v[176:179], v[128:131]
    v_mfma_f32_16x16x32_bf16 v[132:135], v[216:219], v[176:179], v[132:135]
    v_mfma_f32_16x16x32_bf16 v[136:139], v[220:223], v[176:179], v[136:139]
    v_mfma_f32_16x16x32_bf16 v[152:155], v[220:223], v[180:183], v[152:155]
    v_mfma_f32_16x16x32_bf16 v[148:151], v[216:219], v[180:183], v[148:151]
    v_mfma_f32_16x16x32_bf16 v[144:147], v[212:215], v[180:183], v[144:147]
    v_mfma_f32_16x16x32_bf16 v[140:143], v[208:211], v[180:183], v[140:143]
    s_waitcnt lgkmcnt(0)
    s_barrier
    v_mfma_f32_16x16x32_bf16 v[60:63], v[224:227], v[184:187], v[60:63]
    ds_read_b64_tr_b16 v[208:209], v52 offset:0
    v_mfma_f32_16x16x32_bf16 v[64:67], v[228:231], v[184:187], v[64:67]
    ds_read_b64_tr_b16 v[210:211], v52 offset:1024
    v_mfma_f32_16x16x32_bf16 v[68:71], v[232:235], v[184:187], v[68:71]
    ds_read_b128 v[160:163], v46 offset:0
    v_mfma_f32_16x16x32_bf16 v[72:75], v[236:239], v[184:187], v[72:75]
    ds_read_b64_tr_b16 v[212:213], v53 offset:0
    v_mfma_f32_16x16x32_bf16 v[88:91], v[236:239], v[188:191], v[88:91]
    ds_read_b64_tr_b16 v[214:215], v53 offset:1024
    v_mfma_f32_16x16x32_bf16 v[84:87], v[232:235], v[188:191], v[84:87]
    ds_read_b128 v[164:167], v46 offset:2048
    v_mfma_f32_16x16x32_bf16 v[80:83], v[228:231], v[188:191], v[80:83]
    ds_read_b64_tr_b16 v[216:217], v54 offset:0
    v_mfma_f32_16x16x32_bf16 v[76:79], v[224:227], v[188:191], v[76:79]
    ds_read_b64_tr_b16 v[218:219], v54 offset:1024
    v_mfma_f32_16x16x32_bf16 v[92:95], v[224:227], v[192:195], v[92:95]
    ds_read_b128 v[168:171], v46 offset:4096
    v_mfma_f32_16x16x32_bf16 v[96:99], v[228:231], v[192:195], v[96:99]
    ds_read_b64_tr_b16 v[220:221], v55 offset:0
    v_mfma_f32_16x16x32_bf16 v[100:103], v[232:235], v[192:195], v[100:103]
    ds_read_b64_tr_b16 v[222:223], v55 offset:1024
    v_mfma_f32_16x16x32_bf16 v[104:107], v[236:239], v[192:195], v[104:107]
    ds_read_b128 v[172:175], v46 offset:6144
    v_mfma_f32_16x16x32_bf16 v[120:123], v[236:239], v[196:199], v[120:123]
    ds_read_b128 v[176:179], v46 offset:8192
    v_mfma_f32_16x16x32_bf16 v[116:119], v[232:235], v[196:199], v[116:119]
    ds_read_b128 v[180:183], v46 offset:10240
    v_mfma_f32_16x16x32_bf16 v[112:115], v[228:231], v[196:199], v[112:115]
    v_mfma_f32_16x16x32_bf16 v[108:111], v[224:227], v[196:199], v[108:111]
    v_mfma_f32_16x16x32_bf16 v[124:127], v[224:227], v[200:203], v[124:127]
    v_mfma_f32_16x16x32_bf16 v[128:131], v[228:231], v[200:203], v[128:131]
    v_mfma_f32_16x16x32_bf16 v[132:135], v[232:235], v[200:203], v[132:135]
    v_mfma_f32_16x16x32_bf16 v[136:139], v[236:239], v[200:203], v[136:139]
    v_mfma_f32_16x16x32_bf16 v[152:155], v[236:239], v[204:207], v[152:155]
    v_mfma_f32_16x16x32_bf16 v[148:151], v[232:235], v[204:207], v[148:151]
    v_mfma_f32_16x16x32_bf16 v[144:147], v[228:231], v[204:207], v[144:147]
    v_mfma_f32_16x16x32_bf16 v[140:143], v[224:227], v[204:207], v[140:143]
    s_waitcnt lgkmcnt(0)
    v_mfma_f32_16x16x32_bf16 v[60:63], v[208:211], v[160:163], v[60:63]
    ds_read_b64_tr_b16 v[224:225], v52 offset:8192
    v_mfma_f32_16x16x32_bf16 v[64:67], v[212:215], v[160:163], v[64:67]
    ds_read_b64_tr_b16 v[226:227], v52 offset:9216
    v_mfma_f32_16x16x32_bf16 v[68:71], v[216:219], v[160:163], v[68:71]
    ds_read_b128 v[184:187], v47 offset:0
    v_mfma_f32_16x16x32_bf16 v[72:75], v[220:223], v[160:163], v[72:75]
    ds_read_b64_tr_b16 v[228:229], v53 offset:8192
    v_mfma_f32_16x16x32_bf16 v[88:91], v[220:223], v[164:167], v[88:91]
    ds_read_b64_tr_b16 v[230:231], v53 offset:9216
    v_mfma_f32_16x16x32_bf16 v[84:87], v[216:219], v[164:167], v[84:87]
    ds_read_b128 v[188:191], v47 offset:2048
    v_mfma_f32_16x16x32_bf16 v[80:83], v[212:215], v[164:167], v[80:83]
    ds_read_b64_tr_b16 v[232:233], v54 offset:8192
    v_mfma_f32_16x16x32_bf16 v[76:79], v[208:211], v[164:167], v[76:79]
    ds_read_b64_tr_b16 v[234:235], v54 offset:9216
    v_mfma_f32_16x16x32_bf16 v[92:95], v[208:211], v[168:171], v[92:95]
    ds_read_b128 v[192:195], v47 offset:4096
    v_mfma_f32_16x16x32_bf16 v[96:99], v[212:215], v[168:171], v[96:99]
    s_branch K_J2790
K_STM10:
    s_branch K_STM14
K_STA10:
    s_branch K_STA14
K_J2790:
    ds_read_b64_tr_b16 v[236:237], v55 offset:8192
    v_mfma_f32_16x16x32_bf16 v[100:103], v[216:219], v[168:171], v[100:103]
    ds_read_b64_tr_b16 v[238:239], v55 offset:9216
    v_mfma_f32_16x16x32_bf16 v[104:107], v[220:223], v[168:171], v[104:107]
    ds_read_b128 v[196:199], v47 offset:6144
    v_mfma_f32_16x16x32_bf16 v[120:123], v[220:223], v[172:175], v[120:123]
    ds_read_b128 v[200:203], v47 offset:8192
    v_mfma_f32_16x16x32_bf16 v[116:119], v[216:219], v[172:175], v[116:119]
    ds_read_b128 v[204:207], v47 offset:10240
    v_mfma_f32_16x16x32_bf16 v[112:115], v[212:215], v[172:175], v[112:115]
    v_mfma_f32_16x16x32_bf16 v[108:111], v[208:211], v[172:175], v[108:111]
    v_mfma_f32_16x16x32_bf16 v[124:127], v[208:211], v[176:179], v[124:127]
    v_mfma_f32_16x16x32_bf16 v[128:131], v[212:215], v[176:179], v[128:131]
    v_mfma_f32_16x16x32_bf16 v[132:135], v[216:219], v[176:179], v[132:135]
    v_mfma_f32_16x16x32_bf16 v[136:139], v[220:223], v[176:179], v[136:139]
    v_mfma_f32_16x16x32_bf16 v[152:155], v[220:223], v[180:183], v[152:155]
    v_mfma_f32_16x16x32_bf16 v[148:151], v[216:219], v[180:183], v[148:151]
    v_mfma_f32_16x16x32_bf16 v[144:147], v[212:215], v[180:183], v[144:147]
    v_mfma_f32_16x16x32_bf16 v[140:143], v[208:211], v[180:183], v[140:143]
    s_waitcnt lgkmcnt(0)
    s_barrier
    v_mfma_f32_16x16x32_bf16 v[60:63], v[224:227], v[184:187], v[60:63]
    ds_read_b64_tr_b16 v[208:209], v48 offset:0
    v_mfma_f32_16x16x32_bf16 v[64:67], v[228:231], v[184:187], v[64:67]
    ds_read_b64_tr_b16 v[210:211], v48 offset:1024
    v_mfma_f32_16x16x32_bf16 v[68:71], v[232:235], v[184:187], v[68:71]
    ds_read_b128 v[160:163], v44 offset:0
    v_mfma_f32_16x16x32_bf16 v[72:75], v[236:239], v[184:187], v[72:75]
    ds_read_b64_tr_b16 v[212:213], v49 offset:0
    v_mfma_f32_16x16x32_bf16 v[88:91], v[236:239], v[188:191], v[88:91]
    ds_read_b64_tr_b16 v[214:215], v49 offset:1024
    v_mfma_f32_16x16x32_bf16 v[84:87], v[232:235], v[188:191], v[84:87]
    ds_read_b128 v[164:167], v44 offset:2048
    v_mfma_f32_16x16x32_bf16 v[80:83], v[228:231], v[188:191], v[80:83]
    ds_read_b64_tr_b16 v[216:217], v50 offset:0
    v_mfma_f32_16x16x32_bf16 v[76:79], v[224:227], v[188:191], v[76:79]
    ds_read_b64_tr_b16 v[218:219], v50 offset:1024
    v_mfma_f32_16x16x32_bf16 v[92:95], v[224:227], v[192:195], v[92:95]
    ds_read_b128 v[168:171], v44 offset:4096
    v_mfma_f32_16x16x32_bf16 v[96:99], v[228:231], v[192:195], v[96:99]
    ds_read_b64_tr_b16 v[220:221], v51 offset:0
    v_mfma_f32_16x16x32_bf16 v[100:103], v[232:235], v[192:195], v[100:103]
    ds_read_b64_tr_b16 v[222:223], v51 offset:1024
    v_mfma_f32_16x16x32_bf16 v[104:107], v[236:239], v[192:195], v[104:107]
    ds_read_b128 v[172:175], v44 offset:6144
    v_mfma_f32_16x16x32_bf16 v[120:123], v[236:239], v[196:199], v[120:123]
    ds_read_b128 v[176:179], v44 offset:8192
    v_mfma_f32_16x16x32_bf16 v[116:119], v[232:235], v[196:199], v[116:119]
    ds_read_b128 v[180:183], v44 offset:10240
    v_mfma_f32_16x16x32_bf16 v[112:115], v[228:231], v[196:199], v[112:115]
    v_mfma_f32_16x16x32_bf16 v[108:111], v[224:227], v[196:199], v[108:111]
    v_mfma_f32_16x16x32_bf16 v[124:127], v[224:227], v[200:203], v[124:127]
    v_mfma_f32_16x16x32_bf16 v[128:131], v[228:231], v[200:203], v[128:131]
    v_mfma_f32_16x16x32_bf16 v[132:135], v[232:235], v[200:203], v[132:135]
    v_mfma_f32_16x16x32_bf16 v[136:139], v[236:239], v[200:203], v[136:139]
    v_mfma_f32_16x16x32_bf16 v[152:155], v[236:239], v[204:207], v[152:155]
    v_mfma_f32_16x16x32_bf16 v[148:151], v[232:235], v[204:207], v[148:151]
    v_mfma_f32_16x16x32_bf16 v[144:147], v[228:231], v[204:207], v[144:147]
    v_mfma_f32_16x16x32_bf16 v[140:143], v[224:227], v[204:207], v[140:143]
    s_waitcnt lgkmcnt(0)
    v_mfma_f32_16x16x32_bf16 v[60:63], v[208:211], v[160:163], v[60:63]
    ds_read_b64_tr_b16 v[224:225], v48 offset:8192
    v_mfma_f32_16x16x32_bf16 v[64:67], v[212:215], v[160:163], v[64:67]
    ds_read_b64_tr_b16 v[226:227], v48 offset:9216
    v_mfma_f32_16x16x32_bf16 v[68:71], v[216:219], v[160:163], v[68:71]
    ds_read_b128 v[184:187], v45 offset:0
    v_mfma_f32_16x16x32_bf16 v[72:75], v[220:223], v[160:163], v[72:75]
    ds_read_b64_tr_b16 v[228:229], v49 offset:8192
    v_mfma_f32_16x16x32_bf16 v[88:91], v[220:223], v[164:167], v[88:91]
    ds_read_b64_tr_b16 v[230:231], v49 offset:9216
    v_mfma_f32_16x16x32_bf16 v[84:87], v[216:219], v[164:167], v[84:87]
    ds_read_b128 v[188:191], v45 offset:2048
    v_mfma_f32_16x16x32_bf16 v[80:83], v[212:215], v[164:167], v[80:83]
    ds_read_b64_tr_b16 v[232:233], v50 offset:8192
    v_mfma_f32_16x16x32_bf16 v[76:79], v[208:211], v[164:167], v[76:79]
    ds_read_b64_tr_b16 v[234:235], v50 offset:9216
    v_mfma_f32_16x16x32_bf16 v[92:95], v[208:211], v[168:171], v[92:95]
    ds_read_b128 v[192:195], v45 offset:4096
    v_mfma_f32_16x16x32_bf16 v[96:99], v[212:215], v[168:171], v[96:99]
    ds_read_b64_tr_b16 v[236:237], v51 offset:8192
    v_mfma_f32_16x16x32_bf16 v[100:103], v[216:219], v[168:171], v[100:103]
    ds_read_b64_tr_b16 v[238:239], v51 offset:9216
    v_mfma_f32_16x16x32_bf16 v[104:107], v[220:223], v[168:171], v[104:107]
    ds_read_b128 v[196:199], v45 offset:6144
    v_mfma_f32_16x16x32_bf16 v[120:123], v[220:223], v[172:175], v[120:123]
    ds_read_b128 v[200:203], v45 offset:8192
    v_mfma_f32_16x16x32_bf16 v[116:119], v[216:219], v[172:175], v[116:119]
    ds_read_b128 v[204:207], v45 offset:10240
    v_mfma_f32_16x16x32_bf16 v[112:115], v[212:215], v[172:175], v[112:115]
    v_mfma_f32_16x16x32_bf16 v[108:111], v[208:211], v[172:175], v[108:111]
    v_mfma_f32_16x16x32_bf16 v[124:127], v[208:211], v[176:179], v[124:127]
    v_mfma_f32_16x16x32_bf16 v[128:131], v[212:215], v[176:179], v[128:131]
    v_mfma_f32_16x16x32_bf16 v[132:135], v[216:219], v[176:179], v[132:135]
    v_mfma_f32_16x16x32_bf16 v[136:139], v[220:223], v[176:179], v[136:139]
    v_mfma_f32_16x16x32_bf16 v[152:155], v[220:223], v[180:183], v[152:155]
    v_mfma_f32_16x16x32_bf16 v[148:151], v[216:219], v[180:183], v[148:151]
    v_mfma_f32_16x16x32_bf16 v[144:147], v[212:215], v[180:183], v[144:147]
    v_mfma_f32_16x16x32_bf16 v[140:143], v[208:211], v[180:183], v[140:143]
    s_waitcnt lgkmcnt(0)
    s_barrier
    v_mfma_f32_16x16x32_bf16 v[60:63], v[224:227], v[184:187], v[60:63]
    ds_read_b64_tr_b16 v[208:209], v48 offset:40960
    v_mfma_f32_16x16x32_bf16 v[64:67], v[228:231], v[184:187], v[64:67]
    ds_read_b64_tr_b16 v[210:211], v48 offset:41984
    v_mfma_f32_16x16x32_bf16 v[68:71], v[232:235], v[184:187], v[68:71]
    ds_read_b128 v[160:163], v44 offset:40960
    v_mfma_f32_16x16x32_bf16 v[72:75], v[236:239], v[184:187], v[72:75]
    ds_read_b64_tr_b16 v[212:213], v49 offset:40960
    v_mfma_f32_16x16x32_bf16 v[88:91], v[236:239], v[188:191], v[88:91]
    ds_read_b64_tr_b16 v[214:215], v49 offset:41984
    v_mfma_f32_16x16x32_bf16 v[84:87], v[232:235], v[188:191], v[84:87]
    ds_read_b128 v[164:167], v44 offset:43008
    v_mfma_f32_16x16x32_bf16 v[80:83], v[228:231], v[188:191], v[80:83]
    ds_read_b64_tr_b16 v[216:217], v50 offset:40960
    v_mfma_f32_16x16x32_bf16 v[76:79], v[224:227], v[188:191], v[76:79]
    ds_read_b64_tr_b16 v[218:219], v50 offset:41984
    v_mfma_f32_16x16x32_bf16 v[92:95], v[224:227], v[192:195], v[92:95]
    ds_read_b128 v[168:171], v44 offset:45056
    v_mfma_f32_16x16x32_bf16 v[96:99], v[228:231], v[192:195], v[96:99]
    ds_read_b64_tr_b16 v[220:221], v51 offset:40960
    v_mfma_f32_16x16x32_bf16 v[100:103], v[232:235], v[192:195], v[100:103]
    ds_read_b64_tr_b16 v[222:223], v51 offset:41984
    s_branch K_J2b58
K_STM11:
    s_branch K_STM15
K_STA11:
    s_branch K_STA15
K_J2b58:
    v_mfma_f32_16x16x32_bf16 v[104:107], v[236:239], v[192:195], v[104:107]
    ds_read_b128 v[172:175], v44 offset:47104
    v_mfma_f32_16x16x32_bf16 v[120:123], v[236:239], v[196:199], v[120:123]
    ds_read_b128 v[176:179], v44 offset:49152
    v_mfma_f32_16x16x32_bf16 v[116:119], v[232:235], v[196:199], v[116:119]
    ds_read_b128 v[180:183], v44 offset:51200
    v_mfma_f32_16x16x32_bf16 v[112:115], v[228:231], v[196:199], v[112:115]
    v_mfma_f32_16x16x32_bf16 v[108:111], v[224:227], v[196:199], v[108:111]
    v_mfma_f32_16x16x32_bf16 v[124:127], v[224:227], v[200:203], v[124:127]
    v_mfma_f32_16x16x32_bf16 v[128:131], v[228:231], v[200:203], v[128:131]
    v_mfma_f32_16x16x32_bf16 v[132:135], v[232:235], v[200:203], v[132:135]
    v_mfma_f32_16x16x32_bf16 v[136:139], v[236:239], v[200:203], v[136:139]
    v_mfma_f32_16x16x32_bf16 v[152:155], v[236:239], v[204:207], v[152:155]
    v_mfma_f32_16x16x32_bf16 v[148:151], v[232:235], v[204:207], v[148:151]
    v_mfma_f32_16x16x32_bf16 v[144:147], v[228:231], v[204:207], v[144:147]
    v_mfma_f32_16x16x32_bf16 v[140:143], v[224:227], v[204:207], v[140:143]
    s_waitcnt lgkmcnt(0)
    v_mfma_f32_16x16x32_bf16 v[60:63], v[208:211], v[160:163], v[60:63]
    ds_read_b64_tr_b16 v[224:225], v48 offset:49152
    v_mfma_f32_16x16x32_bf16 v[64:67], v[212:215], v[160:163], v[64:67]
    ds_read_b64_tr_b16 v[226:227], v48 offset:50176
    v_mfma_f32_16x16x32_bf16 v[68:71], v[216:219], v[160:163], v[68:71]
    ds_read_b128 v[184:187], v45 offset:40960
    v_mfma_f32_16x16x32_bf16 v[72:75], v[220:223], v[160:163], v[72:75]
    ds_read_b64_tr_b16 v[228:229], v49 offset:49152
    v_mfma_f32_16x16x32_bf16 v[88:91], v[220:223], v[164:167], v[88:91]
    ds_read_b64_tr_b16 v[230:231], v49 offset:50176
    v_mfma_f32_16x16x32_bf16 v[84:87], v[216:219], v[164:167], v[84:87]
    ds_read_b128 v[188:191], v45 offset:43008
    v_mfma_f32_16x16x32_bf16 v[80:83], v[212:215], v[164:167], v[80:83]
    ds_read_b64_tr_b16 v[232:233], v50 offset:49152
    v_mfma_f32_16x16x32_bf16 v[76:79], v[208:211], v[164:167], v[76:79]
    ds_read_b64_tr_b16 v[234:235], v50 offset:50176
    v_mfma_f32_16x16x32_bf16 v[92:95], v[208:211], v[168:171], v[92:95]
    ds_read_b128 v[192:195], v45 offset:45056
    v_mfma_f32_16x16x32_bf16 v[96:99], v[212:215], v[168:171], v[96:99]
    ds_read_b64_tr_b16 v[236:237], v51 offset:49152
    v_mfma_f32_16x16x32_bf16 v[100:103], v[216:219], v[168:171], v[100:103]
    ds_read_b64_tr_b16 v[238:239], v51 offset:50176
    v_mfma_f32_16x16x32_bf16 v[104:107], v[220:223], v[168:171], v[104:107]
    ds_read_b128 v[196:199], v45 offset:47104
    v_mfma_f32_16x16x32_bf16 v[120:123], v[220:223], v[172:175], v[120:123]
    ds_read_b128 v[200:203], v45 offset:49152
    v_mfma_f32_16x16x32_bf16 v[116:119], v[216:219], v[172:175], v[116:119]
    ds_read_b128 v[204:207], v45 offset:51200
    v_mfma_f32_16x16x32_bf16 v[112:115], v[212:215], v[172:175], v[112:115]
    v_mfma_f32_16x16x32_bf16 v[108:111], v[208:211], v[172:175], v[108:111]
    v_mfma_f32_16x16x32_bf16 v[124:127], v[208:211], v[176:179], v[124:127]
    v_mfma_f32_16x16x32_bf16 v[128:131], v[212:215], v[176:179], v[128:131]
    v_mfma_f32_16x16x32_bf16 v[132:135], v[216:219], v[176:179], v[132:135]
    v_mfma_f32_16x16x32_bf16 v[136:139], v[220:223], v[176:179], v[136:139]
    v_mfma_f32_16x16x32_bf16 v[152:155], v[220:223], v[180:183], v[152:155]
    v_mfma_f32_16x16x32_bf16 v[148:151], v[216:219], v[180:183], v[148:151]
    v_mfma_f32_16x16x32_bf16 v[144:147], v[212:215], v[180:183], v[144:147]
    v_mfma_f32_16x16x32_bf16 v[140:143], v[208:211], v[180:183], v[140:143]
    s_waitcnt lgkmcnt(0)
    s_barrier
    v_mfma_f32_16x16x32_bf16 v[60:63], v[224:227], v[184:187], v[60:63]
    ds_read_b64_tr_b16 v[208:209], v52 offset:0
    v_mfma_f32_16x16x32_bf16 v[64:67], v[228:231], v[184:187], v[64:67]
    ds_read_b64_tr_b16 v[210:211], v52 offset:1024
    v_mfma_f32_16x16x32_bf16 v[68:71], v[232:235], v[184:187], v[68:71]
    ds_read_b128 v[160:163], v46 offset:0
    v_mfma_f32_16x16x32_bf16 v[72:75], v[236:239], v[184:187], v[72:75]
    ds_read_b64_tr_b16 v[212:213], v53 offset:0
    v_mfma_f32_16x16x32_bf16 v[88:91], v[236:239], v[188:191], v[88:91]
    ds_read_b64_tr_b16 v[214:215], v53 offset:1024
    v_mfma_f32_16x16x32_bf16 v[84:87], v[232:235], v[188:191], v[84:87]
    ds_read_b128 v[164:167], v46 offset:2048
    v_mfma_f32_16x16x32_bf16 v[80:83], v[228:231], v[188:191], v[80:83]
    ds_read_b64_tr_b16 v[216:217], v54 offset:0
    v_mfma_f32_16x16x32_bf16 v[76:79], v[224:227], v[188:191], v[76:79]
    ds_read_b64_tr_b16 v[218:219], v54 offset:1024
    v_mfma_f32_16x16x32_bf16 v[92:95], v[224:227], v[192:195], v[92:95]
    ds_read_b128 v[168:171], v46 offset:4096
    v_mfma_f32_16x16x32_bf16 v[96:99], v[228:231], v[192:195], v[96:99]
    ds_read_b64_tr_b16 v[220:221], v55 offset:0
    v_mfma_f32_16x16x32_bf16 v[100:103], v[232:235], v[192:195], v[100:103]
    ds_read_b64_tr_b16 v[222:223], v55 offset:1024
    v_mfma_f32_16x16x32_bf16 v[104:107], v[236:239], v[192:195], v[104:107]
    ds_read_b128 v[172:175], v46 offset:6144
    v_mfma_f32_16x16x32_bf16 v[120:123], v[236:239], v[196:199], v[120:123]
    ds_read_b128 v[176:179], v46 offset:8192
    v_mfma_f32_16x16x32_bf16 v[116:119], v[232:235], v[196:199], v[116:119]
    ds_read_b128 v[180:183], v46 offset:10240
    v_mfma_f32_16x16x32_bf16 v[112:115], v[228:231], v[196:199], v[112:115]
    v_mfma_f32_16x16x32_bf16 v[108:111], v[224:227], v[196:199], v[108:111]
    v_mfma_f32_16x16x32_bf16 v[124:127], v[224:227], v[200:203], v[124:127]
    v_mfma_f32_16x16x32_bf16 v[128:131], v[228:231], v[200:203], v[128:131]
    v_mfma_f32_16x16x32_bf16 v[132:135], v[232:235], v[200:203], v[132:135]
    v_mfma_f32_16x16x32_bf16 v[136:139], v[236:239], v[200:203], v[136:139]
    v_mfma_f32_16x16x32_bf16 v[152:155], v[236:239], v[204:207], v[152:155]
    v_mfma_f32_16x16x32_bf16 v[148:151], v[232:235], v[204:207], v[148:151]
    v_mfma_f32_16x16x32_bf16 v[144:147], v[228:231], v[204:207], v[144:147]
    v_mfma_f32_16x16x32_bf16 v[140:143], v[224:227], v[204:207], v[140:143]
    s_waitcnt lgkmcnt(0)
    v_mfma_f32_16x16x32_bf16 v[60:63], v[208:211], v[160:163], v[60:63]
    ds_read_b64_tr_b16 v[224:225], v52 offset:8192
    v_mfma_f32_16x16x32_bf16 v[64:67], v[212:215], v[160:163], v[64:67]
    ds_read_b64_tr_b16 v[226:227], v52 offset:9216
    v_mfma_f32_16x16x32_bf16 v[68:71], v[216:219], v[160:163], v[68:71]
    ds_read_b128 v[184:187], v47 offset:0
    v_mfma_f32_16x16x32_bf16 v[72:75], v[220:223], v[160:163], v[72:75]
    ds_read_b64_tr_b16 v[228:229], v53 offset:8192
    v_mfma_f32_16x16x32_bf16 v[88:91], v[220:223], v[164:167], v[88:91]
    ds_read_b64_tr_b16 v[230:231], v53 offset:9216
    v_mfma_f32_16x16x32_bf16 v[84:87], v[216:219], v[164:167], v[84:87]
    ds_read_b128 v[188:191], v47 offset:2048
    v_mfma_f32_16x16x32_bf16 v[80:83], v[212:215], v[164:167], v[80:83]
    ds_read_b64_tr_b16 v[232:233], v54 offset:8192
    v_mfma_f32_16x16x32_bf16 v[76:79], v[208:211], v[164:167], v[76:79]
    ds_read_b64_tr_b16 v[234:235], v54 offset:9216
    v_mfma_f32_16x16x32_bf16 v[92:95], v[208:211], v[168:171], v[92:95]
    ds_read_b128 v[192:195], v47 offset:4096
    v_mfma_f32_16x16x32_bf16 v[96:99], v[212:215], v[168:171], v[96:99]
    ds_read_b64_tr_b16 v[236:237], v55 offset:8192
    v_mfma_f32_16x16x32_bf16 v[100:103], v[216:219], v[168:171], v[100:103]
    ds_read_b64_tr_b16 v[238:239], v55 offset:9216
    v_mfma_f32_16x16x32_bf16 v[104:107], v[220:223], v[168:171], v[104:107]
    ds_read_b128 v[196:199], v47 offset:6144
    v_mfma_f32_16x16x32_bf16 v[120:123], v[220:223], v[172:175], v[120:123]
    s_branch K_J2f1c
K_STM12:
    s_branch K_STM16
K_STA12:
    s_branch K_STA16
K_J2f1c:
    ds_read_b128 v[200:203], v47 offset:8192
    v_mfma_f32_16x16x32_bf16 v[116:119], v[216:219], v[172:175], v[116:119]
    ds_read_b128 v[204:207], v47 offset:10240
    v_mfma_f32_16x16x32_bf16 v[112:115], v[212:215], v[172:175], v[112:115]
    v_mfma_f32_16x16x32_bf16 v[108:111], v[208:211], v[172:175], v[108:111]
    v_mfma_f32_16x16x32_bf16 v[124:127], v[208:211], v[176:179], v[124:127]
    v_mfma_f32_16x16x32_bf16 v[128:131], v[212:215], v[176:179], v[128:131]
    v_mfma_f32_16x16x32_bf16 v[132:135], v[216:219], v[176:179], v[132:135]
    v_mfma_f32_16x16x32_bf16 v[136:139], v[220:223], v[176:179], v[136:139]
    v_mfma_f32_16x16x32_bf16 v[152:155], v[220:223], v[180:183], v[152:155]
    v_mfma_f32_16x16x32_bf16 v[148:151], v[216:219], v[180:183], v[148:151]
    v_mfma_f32_16x16x32_bf16 v[144:147], v[212:215], v[180:183], v[144:147]
    v_mfma_f32_16x16x32_bf16 v[140:143], v[208:211], v[180:183], v[140:143]
    s_waitcnt lgkmcnt(0)
    s_barrier
    v_mfma_f32_16x16x32_bf16 v[60:63], v[224:227], v[184:187], v[60:63]
    ds_read_b64_tr_b16 v[208:209], v48 offset:0
    v_mfma_f32_16x16x32_bf16 v[64:67], v[228:231], v[184:187], v[64:67]
    ds_read_b64_tr_b16 v[210:211], v48 offset:1024
    v_mfma_f32_16x16x32_bf16 v[68:71], v[232:235], v[184:187], v[68:71]
    ds_read_b128 v[160:163], v44 offset:0
    v_mfma_f32_16x16x32_bf16 v[72:75], v[236:239], v[184:187], v[72:75]
    ds_read_b64_tr_b16 v[212:213], v49 offset:0
    v_mfma_f32_16x16x32_bf16 v[88:91], v[236:239], v[188:191], v[88:91]
    ds_read_b64_tr_b16 v[214:215], v49 offset:1024
    v_mfma_f32_16x16x32_bf16 v[84:87], v[232:235], v[188:191], v[84:87]
    ds_read_b128 v[164:167], v44 offset:2048
    s_branch K_PG2
.p2align 12
K_STM13:
    s_branch K_STM17
K_STA13:
    s_branch K_STA17
K_PG2:
    v_mfma_f32_16x16x32_bf16 v[80:83], v[228:231], v[188:191], v[80:83]
    ds_read_b64_tr_b16 v[216:217], v50 offset:0
    v_mfma_f32_16x16x32_bf16 v[76:79], v[224:227], v[188:191], v[76:79]
    ds_read_b64_tr_b16 v[218:219], v50 offset:1024
    v_mfma_f32_16x16x32_bf16 v[92:95], v[224:227], v[192:195], v[92:95]
    ds_read_b128 v[168:171], v44 offset:4096
    v_mfma_f32_16x16x32_bf16 v[96:99], v[228:231], v[192:195], v[96:99]
    ds_read_b64_tr_b16 v[220:221], v51 offset:0
    v_mfma_f32_16x16x32_bf16 v[100:103], v[232:235], v[192:195], v[100:103]
    ds_read_b64_tr_b16 v[222:223], v51 offset:1024
    v_mfma_f32_16x16x32_bf16 v[104:107], v[236:239], v[192:195], v[104:107]
    ds_read_b128 v[172:175], v44 offset:6144
    v_mfma_f32_16x16x32_bf16 v[120:123], v[236:239], v[196:199], v[120:123]
    ds_read_b128 v[176:179], v44 offset:8192
    v_mfma_f32_16x16x32_bf16 v[116:119], v[232:235], v[196:199], v[116:119]
    ds_read_b128 v[180:183], v44 offset:10240
    v_mfma_f32_16x16x32_bf16 v[112:115], v[228:231], v[196:199], v[112:115]
    v_mfma_f32_16x16x32_bf16 v[108:111], v[224:227], v[196:199], v[108:111]
    v_mfma_f32_16x16x32_bf16 v[124:127], v[224:227], v[200:203], v[124:127]
    v_mfma_f32_16x16x32_bf16 v[128:131], v[228:231], v[200:203], v[128:131]
    v_mfma_f32_16x16x32_bf16 v[132:135], v[232:235], v[200:203], v[132:135]
    v_mfma_f32_16x16x32_bf16 v[136:139], v[236:239], v[200:203], v[136:139]
    v_mfma_f32_16x16x32_bf16 v[152:155], v[236:239], v[204:207], v[152:155]
    v_mfma_f32_16x16x32_bf16 v[148:151], v[232:235], v[204:207], v[148:151]
    v_mfma_f32_16x16x32_bf16 v[144:147], v[228:231], v[204:207], v[144:147]
    v_mfma_f32_16x16x32_bf16 v[140:143], v[224:227], v[204:207], v[140:143]
    s_waitcnt lgkmcnt(0)
    v_mfma_f32_16x16x32_bf16 v[60:63], v[208:211], v[160:163], v[60:63]
    ds_read_b64_tr_b16 v[224:225], v48 offset:8192
    v_mfma_f32_16x16x32_bf16 v[64:67], v[212:215], v[160:163], v[64:67]
    ds_read_b64_tr_b16 v[226:227], v48 offset:9216
    v_mfma_f32_16x16x32_bf16 v[68:71], v[216:219], v[160:163], v[68:71]
    ds_read_b128 v[184:187], v45 offset:0
    v_mfma_f32_16x16x32_bf16 v[72:75], v[220:223], v[160:163], v[72:75]
    ds_read_b64_tr_b16 v[228:229], v49 offset:8192
    v_mfma_f32_16x16x32_bf16 v[88:91], v[220:223], v[164:167], v[88:91]
    ds_read_b64_tr_b16 v[230:231], v49 offset:9216
    v_mfma_f32_16x16x32_bf16 v[84:87], v[216:219], v[164:167], v[84:87]
    ds_read_b128 v[188:191], v45 offset:2048
    v_mfma_f32_16x16x32_bf16 v[80:83], v[212:215], v[164:167], v[80:83]
    ds_read_b64_tr_b16 v[232:233], v50 offset:8192
    v_mfma_f32_16x16x32_bf16 v[76:79], v[208:211], v[164:167], v[76:79]
    ds_read_b64_tr_b16 v[234:235], v50 offset:9216
    v_mfma_f32_16x16x32_bf16 v[92:95], v[208:211], v[168:171], v[92:95]
    ds_read_b128 v[192:195], v45 offset:4096
    v_mfma_f32_16x16x32_bf16 v[96:99], v[212:215], v[168:171], v[96:99]
    ds_read_b64_tr_b16 v[236:237], v51 offset:8192
    v_mfma_f32_16x16x32_bf16 v[100:103], v[216:219], v[168:171], v[100:103]
    ds_read_b64_tr_b16 v[238:239], v51 offset:9216
    v_mfma_f32_16x16x32_bf16 v[104:107], v[220:223], v[168:171], v[104:107]
    ds_read_b128 v[196:199], v45 offset:6144
    v_mfma_f32_16x16x32_bf16 v[120:123], v[220:223], v[172:175], v[120:123]
    ds_read_b128 v[200:203], v45 offset:8192
    v_mfma_f32_16x16x32_bf16 v[116:119], v[216:219], v[172:175], v[116:119]
    ds_read_b128 v[204:207], v45 offset:10240
    v_mfma_f32_16x16x32_bf16 v[112:115], v[212:215], v[172:175], v[112:115]
    v_mfma_f32_16x16x32_bf16 v[108:111], v[208:211], v[172:175], v[108:111]
    v_mfma_f32_16x16x32_bf16 v[124:127], v[208:211], v[176:179], v[124:127]
    v_mfma_f32_16x16x32_bf16 v[128:131], v[212:215], v[176:179], v[128:131]
    v_mfma_f32_16x16x32_bf16 v[132:135], v[216:219], v[176:179], v[132:135]
    v_mfma_f32_16x16x32_bf16 v[136:139], v[220:223], v[176:179], v[136:139]
    v_mfma_f32_16x16x32_bf16 v[152:155], v[220:223], v[180:183], v[152:155]
    v_mfma_f32_16x16x32_bf16 v[148:151], v[216:219], v[180:183], v[148:151]
    v_mfma_f32_16x16x32_bf16 v[144:147], v[212:215], v[180:183], v[144:147]
    v_mfma_f32_16x16x32_bf16 v[140:143], v[208:211], v[180:183], v[140:143]
    s_waitcnt lgkmcnt(0)
    s_barrier
    v_mfma_f32_16x16x32_bf16 v[60:63], v[224:227], v[184:187], v[60:63]
    ds_read_b64_tr_b16 v[208:209], v48 offset:40960
    v_mfma_f32_16x16x32_bf16 v[64:67], v[228:231], v[184:187], v[64:67]
    ds_read_b64_tr_b16 v[210:211], v48 offset:41984
    v_mfma_f32_16x16x32_bf16 v[68:71], v[232:235], v[184:187], v[68:71]
    ds_read_b128 v[160:163], v44 offset:40960
    v_mfma_f32_16x16x32_bf16 v[72:75], v[236:239], v[184:187], v[72:75]
    ds_read_b64_tr_b16 v[212:213], v49 offset:40960
    v_mfma_f32_16x16x32_bf16 v[88:91], v[236:239], v[188:191], v[88:91]
    ds_read_b64_tr_b16 v[214:215], v49 offset:41984
    v_mfma_f32_16x16x32_bf16 v[84:87], v[232:235], v[188:191], v[84:87]
    ds_read_b128 v[164:167], v44 offset:43008
    v_mfma_f32_16x16x32_bf16 v[80:83], v[228:231], v[188:191], v[80:83]
    ds_read_b64_tr_b16 v[216:217], v50 offset:40960
    v_mfma_f32_16x16x32_bf16 v[76:79], v[224:227], v[188:191], v[76:79]
    ds_read_b64_tr_b16 v[218:219], v50 offset:41984
    v_mfma_f32_16x16x32_bf16 v[92:95], v[224:227], v[192:195], v[92:95]
    ds_read_b128 v[168:171], v44 offset:45056
    v_mfma_f32_16x16x32_bf16 v[96:99], v[228:231], v[192:195], v[96:99]
    ds_read_b64_tr_b16 v[220:221], v51 offset:40960
    v_mfma_f32_16x16x32_bf16 v[100:103], v[232:235], v[192:195], v[100:103]
    ds_read_b64_tr_b16 v[222:223], v51 offset:41984
    v_mfma_f32_16x16x32_bf16 v[104:107], v[236:239], v[192:195], v[104:107]
    ds_read_b128 v[172:175], v44 offset:47104
    v_mfma_f32_16x16x32_bf16 v[120:123], v[236:239], v[196:199], v[120:123]
    ds_read_b128 v[176:179], v44 offset:49152
    v_mfma_f32_16x16x32_bf16 v[116:119], v[232:235], v[196:199], v[116:119]
    ds_read_b128 v[180:183], v44 offset:51200
    v_mfma_f32_16x16x32_bf16 v[112:115], v[228:231], v[196:199], v[112:115]
    v_mfma_f32_16x16x32_bf16 v[108:111], v[224:227], v[196:199], v[108:111]
    v_mfma_f32_16x16x32_bf16 v[124:127], v[224:227], v[200:203], v[124:127]
    v_mfma_f32_16x16x32_bf16 v[128:131], v[228:231], v[200:203], v[128:131]
    v_mfma_f32_16x16x32_bf16 v[132:135], v[232:235], v[200:203], v[132:135]
    v_mfma_f32_16x16x32_bf16 v[136:139], v[236:239], v[200:203], v[136:139]
    v_mfma_f32_16x16x32_bf16 v[152:155], v[236:239], v[204:207], v[152:155]
    v_mfma_f32_16x16x32_bf16 v[148:151], v[232:235], v[204:207], v[148:151]
    v_mfma_f32_16x16x32_bf16 v[144:147], v[228:231], v[204:207], v[144:147]
    v_mfma_f32_16x16x32_bf16 v[140:143], v[224:227], v[204:207], v[140:143]
    s_waitcnt lgkmcnt(0)
    v_mfma_f32_16x16x32_bf16 v[60:63], v[208:211], v[160:163], v[60:63]
    ds_read_b64_tr_b16 v[224:225], v48 offset:49152
    v_mfma_f32_16x16x32_bf16 v[64:67], v[212:215], v[160:163], v[64:67]
    ds_read_b64_tr_b16 v[226:227], v48 offset:50176
    v_mfma_f32_16x16x32_bf16 v[68:71], v[216:219], v[160:163], v[68:71]
    ds_read_b128 v[184:187], v45 offset:40960
    v_mfma_f32_16x16x32_bf16 v[72:75], v[220:223], v[160:163], v[72:75]
    ds_read_b64_tr_b16 v[228:229], v49 offset:49152
    v_mfma_f32_16x16x32_bf16 v[76:79], v[208:211], v[164:167], v[76:79]
    ds_read_b64_tr_b16 v[230:231], v49 offset:50176
    v_mfma_f32_16x16x32_bf16 v[80:83], v[212:215], v[164:167], v[80:83]
    ds_read_b128 v[188:191], v45 offset:43008
    v_mfma_f32_16x16x32_bf16 v[84:87], v[216:219], v[164:167], v[84:87]
    ds_read_b64_tr_b16 v[232:233], v50 offset:49152
    v_mfma_f32_16x16x32_bf16 v[88:91], v[220:223], v[164:167], v[88:91]
    ds_read_b64_tr_b16 v[234:235], v50 offset:50176
    s_branch K_J33c8
K_STM14:
    s_branch K_STM18
K_STA14:
    s_branch K_STA18
K_J33c8:
    v_mfma_f32_16x16x32_bf16 v[92:95], v[208:211], v[168:171], v[92:95]
    ds_read_b128 v[192:195], v45 offset:45056
    v_mfma_f32_16x16x32_bf16 v[96:99], v[212:215], v[168:171], v[96:99]
    ds_read_b64_tr_b16 v[236:237], v51 offset:49152
    v_mfma_f32_16x16x32_bf16 v[100:103], v[216:219], v[168:171], v[100:103]
    ds_read_b64_tr_b16 v[238:239], v51 offset:50176
    v_mfma_f32_16x16x32_bf16 v[104:107], v[220:223], v[168:171], v[104:107]
    ds_read_b128 v[196:199], v45 offset:47104
    v_mfma_f32_16x16x32_bf16 v[108:111], v[208:211], v[172:175], v[108:111]
    ds_read_b128 v[200:203], v45 offset:49152
    v_mfma_f32_16x16x32_bf16 v[112:115], v[212:215], v[172:175], v[112:115]
    ds_read_b128 v[204:207], v45 offset:51200
    v_mfma_f32_16x16x32_bf16 v[116:119], v[216:219], v[172:175], v[116:119]
    v_mfma_f32_16x16x32_bf16 v[120:123], v[220:223], v[172:175], v[120:123]
    s_waitcnt lgkmcnt(0)
    v_mfma_f32_16x16x32_bf16 v[60:63], v[224:227], v[184:187], v[60:63]
    v_mfma_f32_16x16x32_bf16 v[64:67], v[228:231], v[184:187], v[64:67]
    v_mfma_f32_16x16x32_bf16 v[68:71], v[232:235], v[184:187], v[68:71]
    v_mfma_f32_16x16x32_bf16 v[72:75], v[236:239], v[184:187], v[72:75]
    v_mfma_f32_16x16x32_bf16 v[76:79], v[224:227], v[188:191], v[76:79]
    v_mfma_f32_16x16x32_bf16 v[80:83], v[228:231], v[188:191], v[80:83]
    v_mfma_f32_16x16x32_bf16 v[84:87], v[232:235], v[188:191], v[84:87]
    v_mfma_f32_16x16x32_bf16 v[88:91], v[236:239], v[188:191], v[88:91]
    v_mfma_f32_16x16x32_bf16 v[92:95], v[224:227], v[192:195], v[92:95]
    v_cvt_pk_bf16_f32 v240, v60, v61
    v_cvt_pk_bf16_f32 v241, v62, v63
    ds_write_b64 v56, v[240:241] offset:0
    v_mfma_f32_16x16x32_bf16 v[96:99], v[228:231], v[192:195], v[96:99]
    v_cvt_pk_bf16_f32 v242, v64, v65
    v_cvt_pk_bf16_f32 v243, v66, v67
    ds_write_b64 v56, v[242:243] offset:32
    v_mfma_f32_16x16x32_bf16 v[100:103], v[232:235], v[192:195], v[100:103]
    v_cvt_pk_bf16_f32 v244, v68, v69
    v_cvt_pk_bf16_f32 v245, v70, v71
    ds_write_b64 v56, v[244:245] offset:64
    v_mfma_f32_16x16x32_bf16 v[104:107], v[236:239], v[192:195], v[104:107]
    v_cvt_pk_bf16_f32 v246, v72, v73
    v_cvt_pk_bf16_f32 v247, v74, v75
    ds_write_b64 v56, v[246:247] offset:96
    v_mfma_f32_16x16x32_bf16 v[108:111], v[224:227], v[196:199], v[108:111]
    v_cvt_pk_bf16_f32 v240, v76, v77
    v_cvt_pk_bf16_f32 v241, v78, v79
    ds_write_b64 v56, v[240:241] offset:4352
    v_mfma_f32_16x16x32_bf16 v[112:115], v[228:231], v[196:199], v[112:115]
    v_cvt_pk_bf16_f32 v242, v80, v81
    v_cvt_pk_bf16_f32 v243, v82, v83
    ds_write_b64 v56, v[242:243] offset:4384
    v_mfma_f32_16x16x32_bf16 v[116:119], v[232:235], v[196:199], v[116:119]
    v_cvt_pk_bf16_f32 v244, v84, v85
    v_cvt_pk_bf16_f32 v245, v86, v87
    ds_write_b64 v56, v[244:245] offset:4416
    v_mfma_f32_16x16x32_bf16 v[120:123], v[236:239], v[196:199], v[120:123]
    v_cvt_pk_bf16_f32 v246, v88, v89
    v_cvt_pk_bf16_f32 v247, v90, v91
    ds_write_b64 v56, v[246:247] offset:4448
    v_mfma_f32_16x16x32_bf16 v[124:127], v[208:211], v[176:179], v[124:127]
    v_cvt_pk_bf16_f32 v240, v92, v93
    v_cvt_pk_bf16_f32 v241, v94, v95
    ds_write_b64 v56, v[240:241] offset:8704
    v_mfma_f32_16x16x32_bf16 v[128:131], v[212:215], v[176:179], v[128:131]
    v_cvt_pk_bf16_f32 v242, v96, v97
    v_cvt_pk_bf16_f32 v243, v98, v99
    ds_write_b64 v56, v[242:243] offset:8736
    v_mfma_f32_16x16x32_bf16 v[132:135], v[216:219], v[176:179], v[132:135]
    v_cvt_pk_bf16_f32 v244, v100, v101
    v_cvt_pk_bf16_f32 v245, v102, v103
    ds_write_b64 v56, v[244:245] offset:8768
    v_mfma_f32_16x16x32_bf16 v[136:139], v[220:223], v[176:179], v[136:139]
    v_cvt_pk_bf16_f32 v246, v104, v105
    v_cvt_pk_bf16_f32 v247, v106, v107
    ds_write_b64 v56, v[246:247] offset:8800
    v_mfma_f32_16x16x32_bf16 v[124:127], v[224:227], v[200:203], v[124:127]
    v_cvt_pk_bf16_f32 v240, v108, v109
    v_cvt_pk_bf16_f32 v241, v110, v111
    ds_write_b64 v56, v[240:241] offset:13056
    v_mfma_f32_16x16x32_bf16 v[128:131], v[228:231], v[200:203], v[128:131]
    v_cvt_pk_bf16_f32 v242, v112, v113
    v_cvt_pk_bf16_f32 v243, v114, v115
    ds_write_b64 v56, v[242:243] offset:13088
    v_mfma_f32_16x16x32_bf16 v[132:135], v[232:235], v[200:203], v[132:135]
    v_cvt_pk_bf16_f32 v244, v116, v117
    v_cvt_pk_bf16_f32 v245, v118, v119
    ds_write_b64 v56, v[244:245] offset:13120
    v_mfma_f32_16x16x32_bf16 v[136:139], v[236:239], v[200:203], v[136:139]
    v_cvt_pk_bf16_f32 v246, v120, v121
    v_cvt_pk_bf16_f32 v247, v122, v123
    ds_write_b64 v56, v[246:247] offset:13152
    v_mfma_f32_16x16x32_bf16 v[140:143], v[208:211], v[180:183], v[140:143]
    v_cvt_pk_bf16_f32 v240, v124, v125
    v_cvt_pk_bf16_f32 v241, v126, v127
    ds_write_b64 v56, v[240:241] offset:17408
    v_mfma_f32_16x16x32_bf16 v[144:147], v[212:215], v[180:183], v[144:147]
    v_cvt_pk_bf16_f32 v242, v128, v129
    v_cvt_pk_bf16_f32 v243, v130, v131
    ds_write_b64 v56, v[242:243] offset:17440
    v_mfma_f32_16x16x32_bf16 v[148:151], v[216:219], v[180:183], v[148:151]
    v_cvt_pk_bf16_f32 v244, v132, v133
    v_cvt_pk_bf16_f32 v245, v134, v135
    ds_write_b64 v56, v[244:245] offset:17472
    v_mfma_f32_16x16x32_bf16 v[152:155], v[220:223], v[180:183], v[152:155]
    v_cvt_pk_bf16_f32 v246, v136, v137
    v_cvt_pk_bf16_f32 v247, v138, v139
    ds_write_b64 v56, v[246:247] offset:17504
    v_mfma_f32_16x16x32_bf16 v[140:143], v[224:227], v[204:207], v[140:143]
    v_mfma_f32_16x16x32_bf16 v[144:147], v[228:231], v[204:207], v[144:147]
    v_mfma_f32_16x16x32_bf16 v[148:151], v[232:235], v[204:207], v[148:151]
    v_mfma_f32_16x16x32_bf16 v[152:155], v[236:239], v[204:207], v[152:155]
    s_nop 7
    v_cvt_pk_bf16_f32 v240, v140, v141
    v_cvt_pk_bf16_f32 v241, v142, v143
    ds_write_b64 v56, v[240:241] offset:21760
    v_cvt_pk_bf16_f32 v242, v144, v145
    v_cvt_pk_bf16_f32 v243, v146, v147
    ds_write_b64 v56, v[242:243] offset:21792
    v_cvt_pk_bf16_f32 v244, v148, v149
    v_cvt_pk_bf16_f32 v245, v150, v151
    ds_write_b64 v56, v[244:245] offset:21824
    v_cvt_pk_bf16_f32 v246, v152, v153
    v_cvt_pk_bf16_f32 v247, v154, v155
    ds_write_b64 v56, v[246:247] offset:21856
    s_branch K_J378c
K_STM15:
    s_branch K_STM19
K_STA15:
    s_branch K_STA19
K_J378c:
    s_waitcnt vmcnt(0) lgkmcnt(0)
    s_setprio 0
K_JOIN:
    s_barrier
    ds_read_b64 v[56:57], v16 offset:0
    ds_read_b64 v[58:59], v17 offset:0
    ds_read_b64 v[44:45], v16 offset:4512
    ds_read_b64 v[46:47], v27 offset:4512
    ds_read_b64 v[60:61], v16 offset:4352
    ds_read_b64 v[62:63], v17 offset:4352
    ds_read_b64 v[48:49], v16 offset:8864
    ds_read_b64 v[50:51], v27 offset:8864
    ds_read_b64 v[64:65], v16 offset:8704
    ds_read_b64 v[66:67], v17 offset:8704
    ds_read_b64 v[52:53], v16 offset:13216
    ds_read_b64 v[54:55], v27 offset:13216
    ds_read_b64 v[68:69], v16 offset:13056
    ds_read_b64 v[70:71], v17 offset:13056
    s_waitcnt lgkmcnt(8)
    v_mfma_f32_16x16x32_bf16 v[88:91], v[56:59], v[44:47], v[36:39]
    v_mfma_f32_16x16x32_bf16 v[92:95], v[60:63], v[44:47], v[32:35]
    s_waitcnt lgkmcnt(4)
    v_mfma_f32_16x16x32_bf16 v[96:99], v[60:63], v[48:51], v[28:31]
    v_mfma_f32_16x16x32_bf16 v[100:103], v[64:67], v[48:51], v[32:35]
    s_waitcnt lgkmcnt(0)
    v_mfma_f32_16x16x32_bf16 v[104:107], v[64:67], v[52:55], v[28:31]
    v_mfma_f32_16x16x32_bf16 v[108:111], v[68:71], v[52:55], v[32:35]
    ds_read_b64_tr_b16 v[72:73], v18 offset:80
    ds_read_b64_tr_b16 v[80:81], v18 offset:112
    ds_read_b64_tr_b16 v[74:75], v18 offset:4432
    ds_read_b64_tr_b16 v[82:83], v18 offset:4464
    ds_read_b64_tr_b16 v[76:77], v18 offset:8784
    ds_read_b64_tr_b16 v[84:85], v18 offset:8816
    ds_read_b64_tr_b16 v[78:79], v18 offset:13136
    ds_read_b64_tr_b16 v[86:87], v18 offset:13168
    v_max3_f32 v148, v88, v89, v92
    v_max3_f32 v149, v90, v91, v94
    v_max_f32 v148, v148, v93
    v_max_f32 v149, v149, v95
    v_max3_f32 v150, v96, v97, v100
    v_max3_f32 v151, v98, v99, v102
    v_max_f32 v150, v150, v101
    v_max_f32 v151, v151, v103
    v_max3_f32 v152, v104, v105, v108
    v_max3_f32 v153, v106, v107, v110
    v_max_f32 v152, v152, v109
    v_max_f32 v153, v153, v111
    v_cvt_pk_bf16_f32 v149, v148, v149
    v_cvt_pk_bf16_f32 v151, v150, v151
    v_cvt_pk_bf16_f32 v153, v152, v153
    v_lshlrev_b32 v148, 16, v149
    v_and_b32 v149, 0xffff0000, v149
    v_lshlrev_b32 v150, 16, v151
    v_and_b32 v151, 0xffff0000, v151
    v_lshlrev_b32 v152, 16, v153
    v_and_b32 v153, 0xffff0000, v153
    v_pk_mul_f32 v[148:149], v[148:149], s[58:59]
    v_pk_mul_f32 v[150:151], v[150:151], s[58:59]
    v_pk_mul_f32 v[152:153], v[152:153], s[58:59]
    v_cvt_pk_bf16_f32 v149, v148, v149
    v_cvt_pk_bf16_f32 v151, v150, v151
    v_cvt_pk_bf16_f32 v153, v152, v153
    v_lshlrev_b32 v148, 16, v149
    v_and_b32 v149, 0xffff0000, v149
    v_lshlrev_b32 v150, 16, v151
    v_and_b32 v151, 0xffff0000, v151
    v_lshlrev_b32 v152, 16, v153
    v_and_b32 v153, 0xffff0000, v153
    v_max_f32 v154, v148, v149
    v_max_f32 v156, v150, v151
    v_max_f32 v158, v152, v153
    v_mov_b32 v168, v158
    v_permlane16_swap_b32 v154, v156
    s_nop 0
    v_permlane16_swap_b32 v158, v168
    v_max_f32 v154, v154, v156
    v_max_f32 v158, v158, v168
    v_mov_b32 v156, v154
    v_mov_b32 v168, v158
    s_nop 0
    v_permlane32_swap_b32 v154, v156
    v_permlane32_swap_b32 v158, v168
    v_max_f32 v154, v154, v156
    v_mov_b32 v156, v154
    v_max_f32 v158, v158, v168
    s_nop 0
    v_permlane16_swap_b32 v154, v156
    v_pk_add_f32 v[148:149], v[148:149], v[154:155] op_sel_hi:[1,0] neg_lo:[0,1] neg_hi:[0,1]
    v_pk_add_f32 v[150:151], v[150:151], v[156:157] op_sel_hi:[1,0] neg_lo:[0,1] neg_hi:[0,1]
    v_pk_add_f32 v[152:153], v[152:153], v[158:159] op_sel_hi:[1,0] neg_lo:[0,1] neg_hi:[0,1]
    v_pk_mul_f32 v[148:149], v[148:149], s[56:57]
    v_pk_mul_f32 v[150:151], v[150:151], s[56:57]
    v_pk_mul_f32 v[152:153], v[152:153], s[56:57]
    v_exp_f32 v148, v148
    v_exp_f32 v149, v149
    v_exp_f32 v150, v150
    v_exp_f32 v151, v151
    v_exp_f32 v152, v152
    v_exp_f32 v153, v153
    s_nop 0
    v_add_f32 v160, v148, v149
    v_add_f32 v162, v150, v151
    v_add_f32 v164, v152, v153
    v_mov_b32 v168, v164
    v_permlane16_swap_b32 v160, v162
    s_nop 0
    v_permlane16_swap_b32 v164, v168
    v_add_f32 v160, v160, v162
    v_add_f32 v164, v164, v168
    v_mov_b32 v162, v160
    v_mov_b32 v168, v164
    s_nop 0
    v_permlane32_swap_b32 v160, v162
    v_permlane32_swap_b32 v164, v168
    v_add_f32 v160, v160, v162
    v_mov_b32 v162, v160
    v_add_f32 v164, v164, v168
    s_nop 0
    v_permlane16_swap_b32 v160, v162
    v_rcp_f32 v160, v160
    v_rcp_f32 v162, v162
    v_rcp_f32 v164, v164
    s_waitcnt lgkmcnt(0)
    v_pk_mul_f32 v[148:149], v[148:149], v[160:161] op_sel_hi:[1,0]
    v_pk_mul_f32 v[150:151], v[150:151], v[162:163] op_sel_hi:[1,0]
    v_pk_mul_f32 v[152:153], v[152:153], v[164:165] op_sel_hi:[1,0]
    v_cvt_pk_bf16_f32 v148, v148, v149
    v_cvt_pk_bf16_f32 v150, v150, v151
    v_cvt_pk_bf16_f32 v152, v152, v153
    v_perm_b32 v112, v148, v148, v40
    v_perm_b32 v113, v148, v148, v41
    v_perm_b32 v114, v148, v148, v42
    v_perm_b32 v115, v148, v148, v43
    v_perm_b32 v116, v150, v150, v40
    v_perm_b32 v117, v150, v150, v41
    v_perm_b32 v118, v150, v150, v42
    v_perm_b32 v119, v150, v150, v43
    v_mfma_f32_16x16x32_bf16 v[124:127], v[72:75], v[112:115], 0
    v_mfma_f32_16x16x32_bf16 v[128:131], v[80:83], v[112:115], 0
    v_perm_b32 v120, v152, v152, v40
    v_perm_b32 v121, v152, v152, v41
    v_perm_b32 v122, v152, v152, v42
    v_perm_b32 v123, v152, v152, v43
    v_mfma_f32_16x16x32_bf16 v[132:135], v[74:77], v[116:119], 0
    v_mfma_f32_16x16x32_bf16 v[136:139], v[82:85], v[116:119], 0
    s_nop 0
    v_mfma_f32_16x16x32_bf16 v[140:143], v[76:79], v[120:123], 0
    v_mfma_f32_16x16x32_bf16 v[144:147], v[84:87], v[120:123], 0
    s_nop 1
    v_cvt_pk_bf16_f32 v172, v124, v125
    v_cvt_pk_bf16_f32 v173, v126, v127
    v_cvt_pk_bf16_f32 v174, v128, v129
    v_cvt_pk_bf16_f32 v175, v130, v131
    ds_write_b64 v24, v[172:173] offset:0
    v_cvt_pk_bf16_f32 v176, v132, v133
    s_branch K_J3b54
K_STM16:
    s_branch K_STM20
K_STA16:
    s_branch K_STA20
K_J3b54:
    v_cvt_pk_bf16_f32 v177, v134, v135
    v_cvt_pk_bf16_f32 v178, v136, v137
    v_cvt_pk_bf16_f32 v179, v138, v139
    ds_write_b64 v24, v[176:177] offset:1024
    v_cvt_pk_bf16_f32 v180, v140, v141
    v_cvt_pk_bf16_f32 v181, v142, v143
    v_cvt_pk_bf16_f32 v182, v144, v145
    v_cvt_pk_bf16_f32 v183, v146, v147
    ds_write_b64 v24, v[180:181] offset:2048
    s_mov_b64 exec, s[54:55]
    ds_write_b64 v25, v[174:175] offset:0
    ds_write_b64 v25, v[178:179] offset:256
    ds_write_b64 v25, v[182:183] offset:512
    s_mov_b64 exec, -1
    s_waitcnt lgkmcnt(0)
    s_barrier
    ds_read_b128 v[172:175], v26
    ds_read_b128 v[176:179], v26 offset:8192
    s_waitcnt lgkmcnt(1)
    buffer_store_dwordx4 v[172:175], v19, s[20:23], s60 offen sc1
    s_waitcnt lgkmcnt(0)
    buffer_store_dwordx4 v[176:179], v20, s[20:23], s60 offen sc1
K_ATT_DONE:
    s_cmp_eq_u32 s34, -1
    s_cbranch_scc1 K_NOS6
    s_cmp_lt_u32 s30, 4
    s_cbranch_scc1 K_P2_EARLY
    s_cmp_lg_u32 s30, 6
    s_cbranch_scc1 K_NOS6
    v_mov_b32 v4, 192
    s_mov_b32 s3, 131072
K_ZPOLL2:
    v_readfirstlane_b32 s33, v7
    s_nop 3
    s_sub_u32 s3, s3, 1
    s_cselect_b32 s33, 1, s33
    s_cmp_lg_u32 s33, 0
    s_cbranch_scc1 K_ZOK2
    global_load_dword v7, v4, s[4:5] sc1
    s_waitcnt vmcnt(0)
    s_branch K_ZPOLL2
K_ZOK2:
    v_min_u32 v2, 23, v1
    v_lshl_add_u32 v2, v2, 2, s42
    global_load_dword v7, v2, s[6:7] offset:128 sc1
K_NOS6:
    s_cmp_lg_u32 s30, 5
    s_cbranch_scc1 K_NOFL
    v_mov_b32 v4, 192
    s_mov_b32 s3, 131072
K_ZPOLL0:
    v_readfirstlane_b32 s33, v7
    s_nop 3
    s_sub_u32 s3, s3, 1
    s_cselect_b32 s33, 1, s33
    s_cmp_lg_u32 s33, 0
    s_cbranch_scc1 K_ZOK0
    global_load_dword v7, v4, s[4:5] sc1
    s_waitcnt vmcnt(0)
    s_branch K_ZPOLL0
K_ZOK0:
    v_mov_b32 v3, 1
    s_mov_b32 exec_lo, s36
    s_mov_b32 exec_hi, 0
    s_setprio 3
    s_waitcnt vmcnt(0)
    s_barrier
    global_store_dword v23, v3, s[6:7] sc1
    s_setprio 0
    s_mov_b64 exec, -1
    s_branch K_FLAGGED
K_NOFL:
    s_waitcnt vmcnt(0)
    s_barrier
K_FLAGGED:
    s_cmp_eq_u32 s34, -1
    s_cbranch_scc1 K_END
    s_cmp_ge_u32 s30, 6
    s_cbranch_scc1 K_P2_HELP
    v_lshrrev_b32 v2, 3, v1
    v_mul_u32_u24 v2, 1280, v2
    v_lshrrev_b32 v3, 4, v1
    v_lshlrev_b32 v3, 1, v3
    v_and_b32 v4, 7, v1
    v_xor_b32 v3, v3, v4
    v_lshl_add_u32 v2, v3, 4, v2
    s_lshl_b32 s33, s41, 7
    v_add_u32 v22, s33, v2
    s_sub_u32 s53, s30, 4
    s_lshl_b32 s60, s53, 2
    s_lshr_b32 s60, 0x6431, s60
    s_and_b32 s60, s60, 7
    s_mul_i32 s60, s60, 51200
    s_mul_i32 s61, s53, 5120
    s_add_u32 s3, s60, 0
    s_add_u32 m0, s61, 40960
    s_waitcnt vmcnt(13)
    buffer_load_dwordx4 v22, s[24:27], s3 offen lds
    s_add_u32 s3, s60, 10240
    s_add_u32 m0, s61, 41984
    s_waitcnt vmcnt(13)
    buffer_load_dwordx4 v22, s[24:27], s3 offen lds
    s_add_u32 s3, s60, 20480
    s_add_u32 m0, s61, 43008
    s_waitcnt vmcnt(13)
    buffer_load_dwordx4 v22, s[24:27], s3 offen lds
    s_add_u32 s3, s60, 30720
    s_add_u32 m0, s61, 44032
    s_waitcnt vmcnt(13)
    buffer_load_dwordx4 v22, s[24:27], s3 offen lds
    s_add_u32 s3, s60, 40960
    s_add_u32 m0, s61, 45056
    s_waitcnt vmcnt(13)
    buffer_load_dwordx4 v22, s[24:27], s3 offen lds
    s_add_u32 s3, s60, 409600
    s_add_u32 m0, s61, 61440
    s_waitcnt vmcnt(13)
    buffer_load_dwordx4 v22, s[24:27], s3 offen lds
    s_add_u32 s3, s60, 419840
    s_add_u32 m0, s61, 62464
    s_waitcnt vmcnt(13)
    buffer_load_dwordx4 v22, s[24:27], s3 offen lds
    s_add_u32 s3, s60, 430080
    s_add_u32 m0, s61, 63488
    s_waitcnt vmcnt(13)
    buffer_load_dwordx4 v22, s[24:27], s3 offen lds
    s_add_u32 s3, s60, 440320
    s_add_u32 m0, s61, 64512
    s_waitcnt vmcnt(13)
    buffer_load_dwordx4 v22, s[24:27], s3 offen lds
    s_add_u32 s3, s60, 450560
    s_add_u32 m0, s61, 65536
    s_waitcnt vmcnt(13)
    buffer_load_dwordx4 v22, s[24:27], s3 offen lds
    s_add_u32 s53, s53, 2
    s_lshl_b32 s60, s53, 2
    s_lshr_b32 s60, 0x6431, s60
    s_and_b32 s60, s60, 7
    s_mul_i32 s60, s60, 51200
    s_mul_i32 s61, s53, 5120
    s_add_u32 s3, s60, 0
    s_add_u32 m0, s61, 40960
    s_waitcnt vmcnt(13)
    buffer_load_dwordx4 v22, s[24:27], s3 offen lds
    s_add_u32 s3, s60, 10240
    s_add_u32 m0, s61, 41984
    s_waitcnt vmcnt(13)
    buffer_load_dwordx4 v22, s[24:27], s3 offen lds
    s_add_u32 s3, s60, 20480
    s_add_u32 m0, s61, 43008
    s_waitcnt vmcnt(13)
    buffer_load_dwordx4 v22, s[24:27], s3 offen lds
    s_add_u32 s3, s60, 30720
    s_add_u32 m0, s61, 44032
    s_waitcnt vmcnt(13)
    buffer_load_dwordx4 v22, s[24:27], s3 offen lds
    s_add_u32 s3, s60, 40960
    s_add_u32 m0, s61, 45056
    s_waitcnt vmcnt(13)
    buffer_load_dwordx4 v22, s[24:27], s3 offen lds
    s_add_u32 s3, s60, 409600
    s_add_u32 m0, s61, 61440
    s_waitcnt vmcnt(13)
    buffer_load_dwordx4 v22, s[24:27], s3 offen lds
    s_add_u32 s3, s60, 419840
    s_add_u32 m0, s61, 62464
    s_branch K_J3f1c
K_STM17:
    s_branch K_STM21
K_STA17:
    s_branch K_STA21
K_J3f1c:
    s_waitcnt vmcnt(13)
    buffer_load_dwordx4 v22, s[24:27], s3 offen lds
    s_add_u32 s3, s60, 430080
    s_add_u32 m0, s61, 63488
    s_waitcnt vmcnt(13)
    buffer_load_dwordx4 v22, s[24:27], s3 offen lds
    s_add_u32 s3, s60, 440320
    s_add_u32 m0, s61, 64512
    s_waitcnt vmcnt(13)
    buffer_load_dwordx4 v22, s[24:27], s3 offen lds
    s_add_u32 s3, s60, 450560
    s_add_u32 m0, s61, 65536
    s_waitcnt vmcnt(13)
    buffer_load_dwordx4 v22, s[24:27], s3 offen lds
    v_mov_b32 v2, 158720
    v_mov_b32 v3, 2
    s_waitcnt vmcnt(0)
    s_mov_b64 exec, 1
    ds_add_u32 v2, v3 offset:44
    s_mov_b64 exec, -1
    s_branch K_P2_HELP
K_P2_EARLY:
    s_lshl_b32 s54, s40, 7
    v_lshrrev_b32 v8, 3, v1
    v_lshrrev_b32 v9, 4, v1
    v_mov_b32 v15, 158720
    s_lshl_b32 s53, s40, 3
    s_add_u32 s53, s53, s30
    s_mul_i32 s3, s53, 20480
    s_lshl_b32 s33, s41, 7
    s_add_u32 s3, s3, s33
    v_and_b32 v2, 7, v1
    v_lshlrev_b32 v2, 4, v2
    v_mul_u32_u24 v4, 1280, v8
    v_add3_u32 v10, v2, v4, s3
    s_lshl_b32 s3, s53, 6
    v_lshl_add_u32 v11, v8, 2, s3
    s_branch K_PG3
.p2align 12
K_STM18:
    s_branch K_STM22
K_CHA0:
K_STA18:
    s_branch K_STA22
K_PG3:
    s_mov_b32 s55, 10240
    s_add_u32 s20, s6, 0x100000
    s_addc_u32 s21, s7, 0
    s_mov_b32 s22, 0x280000
    s_mov_b32 s23, 0x20000
    s_add_u32 s16, s6, 0x1000
    s_addc_u32 s17, s7, 0
    s_mov_b32 s18, 0x2000
    s_mov_b32 s19, 0x20000
    s_mov_b32 s48, s10
    s_mov_b32 s49, s11
    s_mov_b32 s50, 0x280000
    s_mov_b32 s51, 0x20000
    v_mul_u32_u24 v3, 144, v8
    v_add_u32 v3, v2, v3
    s_mul_i32 s3, s30, 2304
    s_add_u32 s3, s3, 140288
    v_add_u32 v14, s3, v3
    v_bfe_u32 v50, v1, 2, 2
    v_and_b32 v51, 3, v1
    s_add_u32 s3, s53, s30
    s_mul_i32 s3, s3, 20480
    v_lshl_add_u32 v54, v1, 4, s3
    v_add_u32 v55, 20480, v54
    v_lshl_add_u32 v2, v9, 2, v50
    v_bfe_u32 v3, v2, 1, 2
    v_lshlrev_b32 v2, 7, v2
    v_lshl_add_u32 v2, v51, 3, v2
    v_xor_b32 v4, 0, v3
    v_lshl_add_u32 v56, v4, 5, v2
    v_add_u32 v60, 40960, v56
    v_xor_b32 v4, 1, v3
    v_lshl_add_u32 v57, v4, 5, v2
    v_add_u32 v61, 40960, v57
    v_xor_b32 v4, 2, v3
    v_lshl_add_u32 v58, v4, 5, v2
    v_add_u32 v62, 40960, v58
    v_xor_b32 v4, 3, v3
    v_lshl_add_u32 v59, v4, 5, v2
    v_add_u32 v63, 40960, v59
    v_lshrrev_b32 v3, 1, v50
    v_mul_u32_u24 v2, 40, v9
    v_add3_u32 v2, v2, 16, v50
    v_lshlrev_b32 v2, 7, v2
    v_lshl_add_u32 v2, v51, 3, v2
    v_xor_b32 v4, 0, v3
    v_lshl_add_u32 v64, v4, 5, v2
    v_xor_b32 v4, 1, v3
    v_lshl_add_u32 v65, v4, 5, v2
    v_xor_b32 v4, 2, v3
    v_lshl_add_u32 v66, v4, 5, v2
    v_xor_b32 v4, 3, v3
    v_lshl_add_u32 v67, v4, 5, v2
    v_and_b32 v2, 15, v1
    v_mul_u32_u24 v2, 144, v2
    v_lshl_add_u32 v2, v9, 3, v2
    s_mul_i32 s3, s30, 4608
    s_add_u32 s3, s3, 140288
    v_add_u32 v52, s3, v2
    s_mov_b32 s67, 0
    s_mov_b32 s68, 4096
    s_mov_b32 s69, 8192
    s_mov_b32 s70, 12288
    s_mov_b32 s71, 16384
    s_waitcnt vmcnt(0)
    s_barrier
    s_cmp_lt_u32 s29, 8
    s_cbranch_scc1 K_P2_AUXW
K_P2_GEMM:
    s_setprio 2
    s_lshl_b32 s3, s40, 3
    s_mul_i32 s33, s3, 187
    s_lshr_b32 s33, s33, 11
    s_add_u32 s33, s33, 1
    s_mul_i32 s33, s33, 11
    s_add_u32 s3, s53, s30
    s_cmp_ge_u32 s3, s33
    s_cselect_b32 s59, 16, 0
    s_add_u32 s3, s3, 1
    s_cmp_ge_u32 s3, s33
    s_cselect_b32 s61, 16, 0
    s_mov_b32 s58, 0
    ds_read_b64_tr_b16 v[148:149], v56 offset:0
    ds_read_b64_tr_b16 v[150:151], v58 offset:2560
    ds_read_b64_tr_b16 v[152:153], v57 offset:0
    ds_read_b64_tr_b16 v[154:155], v59 offset:2560
    ds_read_b64_tr_b16 v[156:157], v58 offset:0
    ds_read_b64_tr_b16 v[158:159], v56 offset:2560
    ds_read_b64_tr_b16 v[160:161], v59 offset:0
    ds_read_b64_tr_b16 v[162:163], v57 offset:2560
    ds_read_b64_tr_b16 v[164:165], v56 offset:20480
    ds_read_b64_tr_b16 v[166:167], v58 offset:23040
    ds_read_b64_tr_b16 v[168:169], v57 offset:20480
    ds_read_b64_tr_b16 v[170:171], v59 offset:23040
    ds_read_b64_tr_b16 v[172:173], v58 offset:20480
    ds_read_b64_tr_b16 v[174:175], v56 offset:23040
    ds_read_b64_tr_b16 v[176:177], v59 offset:20480
    ds_read_b64_tr_b16 v[178:179], v57 offset:23040
    ds_read_b64_tr_b16 v[180:181], v56 offset:5120
    ds_read_b64_tr_b16 v[182:183], v58 offset:7680
    ds_read_b64_tr_b16 v[184:185], v57 offset:5120
    ds_read_b64_tr_b16 v[186:187], v59 offset:7680
    ds_read_b64_tr_b16 v[188:189], v58 offset:5120
    ds_read_b64_tr_b16 v[190:191], v56 offset:7680
    ds_read_b64_tr_b16 v[192:193], v59 offset:5120
    ds_read_b64_tr_b16 v[194:195], v57 offset:7680
    s_andn2_b32 s33, 1, s58
    s_cbranch_scc1 K_SP0
K_SPR0:
    buffer_load_dwordx4 v[68:71], v54, s[20:23], s67 offen offset:0 sc1
    buffer_load_dwordx4 v[72:75], v55, s[20:23], s67 offen offset:0 sc1
    s_andn2_b32 s33, 16, s58
    s_cbranch_scc1 K_SP1
K_SPR1:
    buffer_load_dwordx4 v[76:79], v54, s[20:23], s68 offen offset:0 sc1
    buffer_load_dwordx4 v[80:83], v55, s[20:23], s68 offen offset:0 sc1
    s_andn2_b32 s33, 2, s58
    s_cbranch_scc1 K_SP2
K_SPR2:
    buffer_load_dwordx4 v[84:87], v54, s[20:23], s67 offen offset:1024 sc1
    buffer_load_dwordx4 v[88:91], v55, s[20:23], s67 offen offset:1024 sc1
    s_andn2_b32 s33, 32, s58
    s_cbranch_scc1 K_SP3
K_SPR3:
    buffer_load_dwordx4 v[92:95], v54, s[20:23], s68 offen offset:1024 sc1
    buffer_load_dwordx4 v[96:99], v55, s[20:23], s68 offen offset:1024 sc1
    s_andn2_b32 s33, 4, s58
    s_cbranch_scc1 K_SP4
K_SPR4:
    buffer_load_dwordx4 v[100:103], v54, s[20:23], s67 offen offset:2048 sc1
    buffer_load_dwordx4 v[104:107], v55, s[20:23], s67 offen offset:2048 sc1
    ds_read_b64_tr_b16 v[196:197], v56 offset:25600
    ds_read_b64_tr_b16 v[198:199], v58 offset:28160
    ds_read_b64_tr_b16 v[200:201], v57 offset:25600
    ds_read_b64_tr_b16 v[202:203], v59 offset:28160
    ds_read_b64_tr_b16 v[204:205], v58 offset:25600
    ds_read_b64_tr_b16 v[206:207], v56 offset:28160
    ds_read_b64_tr_b16 v[208:209], v59 offset:25600
    ds_read_b64_tr_b16 v[210:211], v57 offset:28160
    ds_read_b64_tr_b16 v[212:213], v56 offset:10240
    ds_read_b64_tr_b16 v[214:215], v58 offset:12800
    ds_read_b64_tr_b16 v[216:217], v57 offset:10240
    ds_read_b64_tr_b16 v[218:219], v59 offset:12800
    ds_read_b64_tr_b16 v[220:221], v58 offset:10240
    ds_read_b64_tr_b16 v[222:223], v56 offset:12800
    ds_read_b64_tr_b16 v[224:225], v59 offset:10240
    ds_read_b64_tr_b16 v[226:227], v57 offset:12800
    s_waitcnt vmcnt(8)
    s_waitcnt lgkmcnt(15)
    v_mfma_f32_16x16x32_bf16 v[116:119], v[148:151], v[68:71], 0
    v_mfma_f32_16x16x32_bf16 v[132:135], v[148:151], v[72:75], 0
    v_mfma_f32_16x16x32_bf16 v[120:123], v[152:155], v[68:71], 0
    s_branch K_J43cc
K_STM19:
    s_branch K_STM23
K_CHA1:
K_STA19:
    s_branch K_STA23
K_J43cc:
    v_mfma_f32_16x16x32_bf16 v[136:139], v[152:155], v[72:75], 0
    v_mfma_f32_16x16x32_bf16 v[124:127], v[156:159], v[68:71], 0
    v_mfma_f32_16x16x32_bf16 v[140:143], v[156:159], v[72:75], 0
    v_mfma_f32_16x16x32_bf16 v[128:131], v[160:163], v[68:71], 0
    v_mfma_f32_16x16x32_bf16 v[144:147], v[160:163], v[72:75], 0
    s_andn2_b32 s33, 64, s58
    s_cbranch_scc1 K_SP5
K_SPR5:
    buffer_load_dwordx4 v[108:111], v54, s[20:23], s68 offen offset:2048 sc1
    buffer_load_dwordx4 v[112:115], v55, s[20:23], s68 offen offset:2048 sc1
    s_waitcnt vmcnt(8)
    v_mfma_f32_16x16x32_bf16 v[116:119], v[164:167], v[76:79], v[116:119]
    ds_read_b64_tr_b16 v[148:149], v56 offset:30720
    v_mfma_f32_16x16x32_bf16 v[132:135], v[164:167], v[80:83], v[132:135]
    ds_read_b64_tr_b16 v[150:151], v58 offset:33280
    v_mfma_f32_16x16x32_bf16 v[120:123], v[168:171], v[76:79], v[120:123]
    ds_read_b64_tr_b16 v[152:153], v57 offset:30720
    v_mfma_f32_16x16x32_bf16 v[136:139], v[168:171], v[80:83], v[136:139]
    ds_read_b64_tr_b16 v[154:155], v59 offset:33280
    v_mfma_f32_16x16x32_bf16 v[124:127], v[172:175], v[76:79], v[124:127]
    ds_read_b64_tr_b16 v[156:157], v58 offset:30720
    v_mfma_f32_16x16x32_bf16 v[140:143], v[172:175], v[80:83], v[140:143]
    ds_read_b64_tr_b16 v[158:159], v56 offset:33280
    v_mfma_f32_16x16x32_bf16 v[128:131], v[176:179], v[76:79], v[128:131]
    ds_read_b64_tr_b16 v[160:161], v59 offset:30720
    v_mfma_f32_16x16x32_bf16 v[144:147], v[176:179], v[80:83], v[144:147]
    ds_read_b64_tr_b16 v[162:163], v57 offset:33280
    s_andn2_b32 s33, 8, s58
    s_cbranch_scc1 K_SP6
K_SPR6:
    buffer_load_dwordx4 v[68:71], v54, s[20:23], s67 offen offset:3072 sc1
    buffer_load_dwordx4 v[72:75], v55, s[20:23], s67 offen offset:3072 sc1
    s_waitcnt vmcnt(8)
    v_mfma_f32_16x16x32_bf16 v[116:119], v[180:183], v[84:87], v[116:119]
    ds_read_b64_tr_b16 v[164:165], v56 offset:15360
    v_mfma_f32_16x16x32_bf16 v[132:135], v[180:183], v[88:91], v[132:135]
    ds_read_b64_tr_b16 v[166:167], v58 offset:17920
    v_mfma_f32_16x16x32_bf16 v[120:123], v[184:187], v[84:87], v[120:123]
    ds_read_b64_tr_b16 v[168:169], v57 offset:15360
    v_mfma_f32_16x16x32_bf16 v[136:139], v[184:187], v[88:91], v[136:139]
    ds_read_b64_tr_b16 v[170:171], v59 offset:17920
    v_mfma_f32_16x16x32_bf16 v[124:127], v[188:191], v[84:87], v[124:127]
    ds_read_b64_tr_b16 v[172:173], v58 offset:15360
    v_mfma_f32_16x16x32_bf16 v[140:143], v[188:191], v[88:91], v[140:143]
    ds_read_b64_tr_b16 v[174:175], v56 offset:17920
    v_mfma_f32_16x16x32_bf16 v[128:131], v[192:195], v[84:87], v[128:131]
    ds_read_b64_tr_b16 v[176:177], v59 offset:15360
    v_mfma_f32_16x16x32_bf16 v[144:147], v[192:195], v[88:91], v[144:147]
    ds_read_b64_tr_b16 v[178:179], v57 offset:17920
    s_andn2_b32 s33, 128, s58
    s_cbranch_scc1 K_SP7
K_SPR7:
    buffer_load_dwordx4 v[76:79], v54, s[20:23], s68 offen offset:3072 sc1
    buffer_load_dwordx4 v[80:83], v55, s[20:23], s68 offen offset:3072 sc1
    s_waitcnt vmcnt(8)
    s_waitcnt lgkmcnt(15)
    v_mfma_f32_16x16x32_bf16 v[116:119], v[196:199], v[92:95], v[116:119]
    ds_read_b64_tr_b16 v[180:181], v56 offset:35840
    v_mfma_f32_16x16x32_bf16 v[132:135], v[196:199], v[96:99], v[132:135]
    ds_read_b64_tr_b16 v[182:183], v58 offset:38400
    v_mfma_f32_16x16x32_bf16 v[120:123], v[200:203], v[92:95], v[120:123]
    ds_read_b64_tr_b16 v[184:185], v57 offset:35840
    v_mfma_f32_16x16x32_bf16 v[136:139], v[200:203], v[96:99], v[136:139]
    ds_read_b64_tr_b16 v[186:187], v59 offset:38400
    v_mfma_f32_16x16x32_bf16 v[124:127], v[204:207], v[92:95], v[124:127]
    ds_read_b64_tr_b16 v[188:189], v58 offset:35840
    v_mfma_f32_16x16x32_bf16 v[140:143], v[204:207], v[96:99], v[140:143]
    ds_read_b64_tr_b16 v[190:191], v56 offset:38400
    v_mfma_f32_16x16x32_bf16 v[128:131], v[208:211], v[92:95], v[128:131]
    ds_read_b64_tr_b16 v[192:193], v59 offset:35840
    v_mfma_f32_16x16x32_bf16 v[144:147], v[208:211], v[96:99], v[144:147]
    ds_read_b64_tr_b16 v[194:195], v57 offset:38400
    s_andn2_b32 s33, 15, s58
    s_cbranch_scc1 K_SP8
K_SPR8:
    buffer_load_dwordx4 v[84:87], v54, s[20:23], s71 offen offset:0 sc1
    buffer_load_dwordx4 v[88:91], v55, s[20:23], s71 offen offset:0 sc1
    s_waitcnt vmcnt(8)
    v_mfma_f32_16x16x32_bf16 v[116:119], v[212:215], v[100:103], v[116:119]
    ds_read_b64_tr_b16 v[196:197], v64 offset:0
    v_mfma_f32_16x16x32_bf16 v[132:135], v[212:215], v[104:107], v[132:135]
    ds_read_b64_tr_b16 v[198:199], v66 offset:2560
    v_mfma_f32_16x16x32_bf16 v[120:123], v[216:219], v[100:103], v[120:123]
    ds_read_b64_tr_b16 v[200:201], v65 offset:0
    v_mfma_f32_16x16x32_bf16 v[136:139], v[216:219], v[104:107], v[136:139]
    ds_read_b64_tr_b16 v[202:203], v67 offset:2560
    v_mfma_f32_16x16x32_bf16 v[124:127], v[220:223], v[100:103], v[124:127]
    ds_read_b64_tr_b16 v[204:205], v66 offset:0
    v_mfma_f32_16x16x32_bf16 v[140:143], v[220:223], v[104:107], v[140:143]
    ds_read_b64_tr_b16 v[206:207], v64 offset:2560
    v_mfma_f32_16x16x32_bf16 v[128:131], v[224:227], v[100:103], v[128:131]
    ds_read_b64_tr_b16 v[208:209], v67 offset:0
    v_mfma_f32_16x16x32_bf16 v[144:147], v[224:227], v[104:107], v[144:147]
    ds_read_b64_tr_b16 v[210:211], v65 offset:2560
    s_andn2_b32 s33, 240, s58
    s_cbranch_scc1 K_SP9
K_SPR9:
    buffer_load_dwordx4 v[92:95], v54, s[20:23], s71 offen offset:1024 sc1
    buffer_load_dwordx4 v[96:99], v55, s[20:23], s71 offen offset:1024 sc1
    s_waitcnt vmcnt(8)
    s_waitcnt lgkmcnt(15)
    v_mfma_f32_16x16x32_bf16 v[116:119], v[148:151], v[108:111], v[116:119]
    ds_read_b64_tr_b16 v[212:213], v64 offset:20480
    v_mfma_f32_16x16x32_bf16 v[132:135], v[148:151], v[112:115], v[132:135]
    ds_read_b64_tr_b16 v[214:215], v66 offset:23040
    v_mfma_f32_16x16x32_bf16 v[120:123], v[152:155], v[108:111], v[120:123]
    ds_read_b64_tr_b16 v[216:217], v65 offset:20480
    v_mfma_f32_16x16x32_bf16 v[136:139], v[152:155], v[112:115], v[136:139]
    ds_read_b64_tr_b16 v[218:219], v67 offset:23040
    v_mfma_f32_16x16x32_bf16 v[124:127], v[156:159], v[108:111], v[124:127]
    ds_read_b64_tr_b16 v[220:221], v66 offset:20480
    v_mfma_f32_16x16x32_bf16 v[140:143], v[156:159], v[112:115], v[140:143]
    ds_read_b64_tr_b16 v[222:223], v64 offset:23040
    v_mfma_f32_16x16x32_bf16 v[128:131], v[160:163], v[108:111], v[128:131]
    ds_read_b64_tr_b16 v[224:225], v67 offset:20480
    v_mfma_f32_16x16x32_bf16 v[144:147], v[160:163], v[112:115], v[144:147]
    ds_read_b64_tr_b16 v[226:227], v65 offset:23040
    s_andn2_b32 s33, 256, s58
    s_cbranch_scc1 K_SP10
K_SPR10:
    buffer_load_dwordx4 v[100:103], v54, s[20:23], s69 offen offset:0 sc1
    buffer_load_dwordx4 v[104:107], v55, s[20:23], s69 offen offset:0 sc1
    s_mov_b32 s3, 1048576
K_P2_GS:
    ds_read_b32 v2, v15 offset:40
    s_sub_u32 s3, s3, 1
    s_waitcnt lgkmcnt(0)
    v_readfirstlane_b32 s33, v2
    s_nop 3
    s_cselect_b32 s33, 1, s33
    s_cmp_lt_u32 s33, 1
    s_cbranch_scc1 K_P2_GS
    buffer_load_dwordx4 v[16:19], v10, s[12:15], 0 offen
    buffer_load_dwordx4 v[20:23], v10, s[12:15], s55 offen
    buffer_load_dword v24, v11, s[16:19], 0 offen sc1
    buffer_load_dword v25, v11, s[16:19], 0 offen offset:32 sc1
    ds_read_b128 v[28:31], v15
    s_mov_b32 s3, 1048576
K_P2_GW:
    s_branch K_J4794
K_STM20:
    s_branch K_STM24
K_CHA2:
K_STA20:
    s_branch K_STA24
K_J4794:
    ds_read_b32 v2, v15 offset:44
    s_sub_u32 s3, s3, 1
    s_waitcnt lgkmcnt(0)
    v_readfirstlane_b32 s33, v2
    s_nop 3
    s_cselect_b32 s33, 4, s33
    s_cmp_lt_u32 s33, 4
    s_cbranch_scc1 K_P2_GW
    s_waitcnt vmcnt(12)
    v_mfma_f32_16x16x32_bf16 v[116:119], v[164:167], v[68:71], v[116:119]
    ds_read_b64_tr_b16 v[148:149], v60 offset:0
    v_mfma_f32_16x16x32_bf16 v[132:135], v[164:167], v[72:75], v[132:135]
    ds_read_b64_tr_b16 v[150:151], v62 offset:2560
    v_mfma_f32_16x16x32_bf16 v[120:123], v[168:171], v[68:71], v[120:123]
    ds_read_b64_tr_b16 v[152:153], v61 offset:0
    v_mfma_f32_16x16x32_bf16 v[136:139], v[168:171], v[72:75], v[136:139]
    ds_read_b64_tr_b16 v[154:155], v63 offset:2560
    v_mfma_f32_16x16x32_bf16 v[124:127], v[172:175], v[68:71], v[124:127]
    ds_read_b64_tr_b16 v[156:157], v62 offset:0
    v_mfma_f32_16x16x32_bf16 v[140:143], v[172:175], v[72:75], v[140:143]
    ds_read_b64_tr_b16 v[158:159], v60 offset:2560
    v_mfma_f32_16x16x32_bf16 v[128:131], v[176:179], v[68:71], v[128:131]
    ds_read_b64_tr_b16 v[160:161], v63 offset:0
    v_mfma_f32_16x16x32_bf16 v[144:147], v[176:179], v[72:75], v[144:147]
    ds_read_b64_tr_b16 v[162:163], v61 offset:2560
    s_andn2_b32 s33, 4096, s58
    s_cbranch_scc1 K_SP11
K_SPR11:
    buffer_load_dwordx4 v[108:111], v54, s[20:23], s70 offen offset:0 sc1
    buffer_load_dwordx4 v[112:115], v55, s[20:23], s70 offen offset:0 sc1
    s_waitcnt vmcnt(12)
    v_mfma_f32_16x16x32_bf16 v[116:119], v[180:183], v[76:79], v[116:119]
    ds_read_b64_tr_b16 v[164:165], v60 offset:20480
    v_mfma_f32_16x16x32_bf16 v[132:135], v[180:183], v[80:83], v[132:135]
    ds_read_b64_tr_b16 v[166:167], v62 offset:23040
    v_mfma_f32_16x16x32_bf16 v[120:123], v[184:187], v[76:79], v[120:123]
    ds_read_b64_tr_b16 v[168:169], v61 offset:20480
    v_mfma_f32_16x16x32_bf16 v[136:139], v[184:187], v[80:83], v[136:139]
    ds_read_b64_tr_b16 v[170:171], v63 offset:23040
    v_mfma_f32_16x16x32_bf16 v[124:127], v[188:191], v[76:79], v[124:127]
    ds_read_b64_tr_b16 v[172:173], v62 offset:20480
    v_mfma_f32_16x16x32_bf16 v[140:143], v[188:191], v[80:83], v[140:143]
    ds_read_b64_tr_b16 v[174:175], v60 offset:23040
    v_mfma_f32_16x16x32_bf16 v[128:131], v[192:195], v[76:79], v[128:131]
    ds_read_b64_tr_b16 v[176:177], v63 offset:20480
    v_mfma_f32_16x16x32_bf16 v[144:147], v[192:195], v[80:83], v[144:147]
    ds_read_b64_tr_b16 v[178:179], v61 offset:23040
    s_andn2_b32 s33, 512, s58
    s_cbranch_scc1 K_SP12
K_SPR12:
    buffer_load_dwordx4 v[68:71], v54, s[20:23], s69 offen offset:1024 sc1
    buffer_load_dwordx4 v[72:75], v55, s[20:23], s69 offen offset:1024 sc1
    s_waitcnt vmcnt(12)
    v_mfma_f32_16x16x32_bf16 v[116:119], v[196:199], v[84:87], v[116:119]
    ds_read_b64_tr_b16 v[180:181], v60 offset:5120
    v_mfma_f32_16x16x32_bf16 v[132:135], v[196:199], v[88:91], v[132:135]
    ds_read_b64_tr_b16 v[182:183], v62 offset:7680
    v_mfma_f32_16x16x32_bf16 v[120:123], v[200:203], v[84:87], v[120:123]
    ds_read_b64_tr_b16 v[184:185], v61 offset:5120
    v_mfma_f32_16x16x32_bf16 v[136:139], v[200:203], v[88:91], v[136:139]
    ds_read_b64_tr_b16 v[186:187], v63 offset:7680
    v_mfma_f32_16x16x32_bf16 v[124:127], v[204:207], v[84:87], v[124:127]
    ds_read_b64_tr_b16 v[188:189], v62 offset:5120
    v_mfma_f32_16x16x32_bf16 v[140:143], v[204:207], v[88:91], v[140:143]
    ds_read_b64_tr_b16 v[190:191], v60 offset:7680
    v_mfma_f32_16x16x32_bf16 v[128:131], v[208:211], v[84:87], v[128:131]
    ds_read_b64_tr_b16 v[192:193], v63 offset:5120
    v_mfma_f32_16x16x32_bf16 v[144:147], v[208:211], v[88:91], v[144:147]
    ds_read_b64_tr_b16 v[194:195], v61 offset:7680
    s_andn2_b32 s33, 8192, s58
    s_cbranch_scc1 K_SP13
K_SPR13:
    buffer_load_dwordx4 v[76:79], v54, s[20:23], s70 offen offset:1024 sc1
    buffer_load_dwordx4 v[80:83], v55, s[20:23], s70 offen offset:1024 sc1
    s_waitcnt vmcnt(12)
    v_mfma_f32_16x16x32_bf16 v[116:119], v[212:215], v[92:95], v[116:119]
    ds_read_b64_tr_b16 v[196:197], v60 offset:25600
    v_mfma_f32_16x16x32_bf16 v[132:135], v[212:215], v[96:99], v[132:135]
    ds_read_b64_tr_b16 v[198:199], v62 offset:28160
    v_mfma_f32_16x16x32_bf16 v[120:123], v[216:219], v[92:95], v[120:123]
    ds_read_b64_tr_b16 v[200:201], v61 offset:25600
    v_mfma_f32_16x16x32_bf16 v[136:139], v[216:219], v[96:99], v[136:139]
    ds_read_b64_tr_b16 v[202:203], v63 offset:28160
    v_mfma_f32_16x16x32_bf16 v[124:127], v[220:223], v[92:95], v[124:127]
    ds_read_b64_tr_b16 v[204:205], v62 offset:25600
    v_mfma_f32_16x16x32_bf16 v[140:143], v[220:223], v[96:99], v[140:143]
    ds_read_b64_tr_b16 v[206:207], v60 offset:28160
    v_mfma_f32_16x16x32_bf16 v[128:131], v[224:227], v[92:95], v[128:131]
    ds_read_b64_tr_b16 v[208:209], v63 offset:25600
    v_mfma_f32_16x16x32_bf16 v[144:147], v[224:227], v[96:99], v[144:147]
    ds_read_b64_tr_b16 v[210:211], v61 offset:28160
    s_andn2_b32 s33, 1024, s58
    s_cbranch_scc1 K_SP14
K_SPR14:
    buffer_load_dwordx4 v[84:87], v54, s[20:23], s69 offen offset:2048 sc1
    buffer_load_dwordx4 v[88:91], v55, s[20:23], s69 offen offset:2048 sc1
    s_waitcnt vmcnt(12)
    s_waitcnt lgkmcnt(15)
    v_mfma_f32_16x16x32_bf16 v[116:119], v[148:151], v[100:103], v[116:119]
    ds_read_b64_tr_b16 v[212:213], v60 offset:10240
    v_mfma_f32_16x16x32_bf16 v[132:135], v[148:151], v[104:107], v[132:135]
    ds_read_b64_tr_b16 v[214:215], v62 offset:12800
    v_mfma_f32_16x16x32_bf16 v[120:123], v[152:155], v[100:103], v[120:123]
    ds_read_b64_tr_b16 v[216:217], v61 offset:10240
    v_mfma_f32_16x16x32_bf16 v[136:139], v[152:155], v[104:107], v[136:139]
    ds_read_b64_tr_b16 v[218:219], v63 offset:12800
    v_mfma_f32_16x16x32_bf16 v[124:127], v[156:159], v[100:103], v[124:127]
    ds_read_b64_tr_b16 v[220:221], v62 offset:10240
    v_mfma_f32_16x16x32_bf16 v[140:143], v[156:159], v[104:107], v[140:143]
    ds_read_b64_tr_b16 v[222:223], v60 offset:12800
    v_mfma_f32_16x16x32_bf16 v[128:131], v[160:163], v[100:103], v[128:131]
    ds_read_b64_tr_b16 v[224:225], v63 offset:10240
    v_mfma_f32_16x16x32_bf16 v[144:147], v[160:163], v[104:107], v[144:147]
    ds_read_b64_tr_b16 v[226:227], v61 offset:12800
    s_andn2_b32 s33, 16384, s58
    s_cbranch_scc1 K_SP15
K_SPR15:
    buffer_load_dwordx4 v[92:95], v54, s[20:23], s70 offen offset:2048 sc1
    buffer_load_dwordx4 v[96:99], v55, s[20:23], s70 offen offset:2048 sc1
    s_waitcnt vmcnt(8)
    v_mfma_f32_16x16x32_bf16 v[116:119], v[164:167], v[108:111], v[116:119]
    ds_read_b64_tr_b16 v[148:149], v60 offset:30720
    v_sub_f32 v48, 1.0, v24
    v_mfma_f32_16x16x32_bf16 v[132:135], v[164:167], v[112:115], v[132:135]
    ds_read_b64_tr_b16 v[150:151], v62 offset:33280
    v_cvt_pk_bf16_f32 v48, v48, v48
    v_mfma_f32_16x16x32_bf16 v[120:123], v[168:171], v[108:111], v[120:123]
    ds_read_b64_tr_b16 v[152:153], v61 offset:30720
    v_lshlrev_b32 v48, 16, v48
    v_mfma_f32_16x16x32_bf16 v[136:139], v[168:171], v[112:115], v[136:139]
    ds_read_b64_tr_b16 v[154:155], v63 offset:33280
    v_sub_f32 v49, 1.0, v25
    v_mfma_f32_16x16x32_bf16 v[124:127], v[172:175], v[108:111], v[124:127]
    ds_read_b64_tr_b16 v[156:157], v62 offset:30720
    v_cvt_pk_bf16_f32 v49, v49, v49
    s_branch K_J4b58
K_STM21:
    s_branch K_STM25
K_CHA3:
K_STA21:
    s_branch K_STA25
K_J4b58:
    v_mfma_f32_16x16x32_bf16 v[140:143], v[172:175], v[112:115], v[140:143]
    ds_read_b64_tr_b16 v[158:159], v60 offset:33280
    v_lshlrev_b32 v49, 16, v49
    v_mfma_f32_16x16x32_bf16 v[128:131], v[176:179], v[108:111], v[128:131]
    ds_read_b64_tr_b16 v[160:161], v63 offset:30720
    v_lshlrev_b32 v32, 16, v16
    v_mfma_f32_16x16x32_bf16 v[144:147], v[176:179], v[112:115], v[144:147]
    ds_read_b64_tr_b16 v[162:163], v61 offset:33280
    v_and_b32 v33, 0xffff0000, v16
    s_andn2_b32 s33, 2048, s58
    s_cbranch_scc1 K_SP16
K_SPR16:
    buffer_load_dwordx4 v[100:103], v54, s[20:23], s69 offen offset:3072 sc1
    buffer_load_dwordx4 v[104:107], v55, s[20:23], s69 offen offset:3072 sc1
    s_waitcnt vmcnt(8)
    s_waitcnt lgkmcnt(15)
    v_mfma_f32_16x16x32_bf16 v[116:119], v[180:183], v[68:71], v[116:119]
    ds_read_b64_tr_b16 v[164:165], v60 offset:15360
    v_lshlrev_b32 v34, 16, v17
    v_mfma_f32_16x16x32_bf16 v[132:135], v[180:183], v[72:75], v[132:135]
    ds_read_b64_tr_b16 v[166:167], v62 offset:17920
    v_and_b32 v35, 0xffff0000, v17
    v_mfma_f32_16x16x32_bf16 v[120:123], v[184:187], v[68:71], v[120:123]
    ds_read_b64_tr_b16 v[168:169], v61 offset:15360
    v_lshlrev_b32 v36, 16, v18
    v_mfma_f32_16x16x32_bf16 v[136:139], v[184:187], v[72:75], v[136:139]
    ds_read_b64_tr_b16 v[170:171], v63 offset:17920
    v_and_b32 v37, 0xffff0000, v18
    v_mfma_f32_16x16x32_bf16 v[124:127], v[188:191], v[68:71], v[124:127]
    ds_read_b64_tr_b16 v[172:173], v62 offset:15360
    v_lshlrev_b32 v38, 16, v19
    v_mfma_f32_16x16x32_bf16 v[140:143], v[188:191], v[72:75], v[140:143]
    ds_read_b64_tr_b16 v[174:175], v60 offset:17920
    v_and_b32 v39, 0xffff0000, v19
    v_mfma_f32_16x16x32_bf16 v[128:131], v[192:195], v[68:71], v[128:131]
    ds_read_b64_tr_b16 v[176:177], v63 offset:15360
    v_lshlrev_b32 v40, 16, v20
    v_mfma_f32_16x16x32_bf16 v[144:147], v[192:195], v[72:75], v[144:147]
    ds_read_b64_tr_b16 v[178:179], v61 offset:17920
    v_and_b32 v41, 0xffff0000, v20
    s_andn2_b32 s33, 32768, s58
    s_cbranch_scc1 K_SP17
K_SPR17:
    buffer_load_dwordx4 v[108:111], v54, s[20:23], s70 offen offset:3072 sc1
    buffer_load_dwordx4 v[112:115], v55, s[20:23], s70 offen offset:3072 sc1
    s_waitcnt vmcnt(8)
    v_mfma_f32_16x16x32_bf16 v[116:119], v[196:199], v[76:79], v[116:119]
    ds_read_b64_tr_b16 v[180:181], v60 offset:35840
    v_lshlrev_b32 v42, 16, v21
    v_mfma_f32_16x16x32_bf16 v[132:135], v[196:199], v[80:83], v[132:135]
    ds_read_b64_tr_b16 v[182:183], v62 offset:38400
    v_and_b32 v43, 0xffff0000, v21
    v_mfma_f32_16x16x32_bf16 v[120:123], v[200:203], v[76:79], v[120:123]
    ds_read_b64_tr_b16 v[184:185], v61 offset:35840
    v_lshlrev_b32 v44, 16, v22
    v_mfma_f32_16x16x32_bf16 v[136:139], v[200:203], v[80:83], v[136:139]
    ds_read_b64_tr_b16 v[186:187], v63 offset:38400
    v_and_b32 v45, 0xffff0000, v22
    v_mfma_f32_16x16x32_bf16 v[124:127], v[204:207], v[76:79], v[124:127]
    ds_read_b64_tr_b16 v[188:189], v62 offset:35840
    v_lshlrev_b32 v46, 16, v23
    v_mfma_f32_16x16x32_bf16 v[140:143], v[204:207], v[80:83], v[140:143]
    ds_read_b64_tr_b16 v[190:191], v60 offset:38400
    v_and_b32 v47, 0xffff0000, v23
    v_mfma_f32_16x16x32_bf16 v[128:131], v[208:211], v[76:79], v[128:131]
    ds_read_b64_tr_b16 v[192:193], v63 offset:35840
    v_mul_f32 v32, v32, v48
    v_mfma_f32_16x16x32_bf16 v[144:147], v[208:211], v[80:83], v[144:147]
    ds_read_b64_tr_b16 v[194:195], v61 offset:38400
    v_mul_f32 v33, v33, v48
    s_andn2_b32 s33, 3840, s58
    s_cbranch_scc1 K_SP18
K_SPR18:
    buffer_load_dwordx4 v[68:71], v54, s[20:23], s71 offen offset:2048 sc1
    buffer_load_dwordx4 v[72:75], v55, s[20:23], s71 offen offset:2048 sc1
    s_waitcnt vmcnt(8)
    s_waitcnt lgkmcnt(15)
    v_mfma_f32_16x16x32_bf16 v[116:119], v[212:215], v[84:87], v[116:119]
    ds_read_b64_tr_b16 v[196:197], v64 offset:40960
    v_mul_f32 v34, v34, v48
    v_mfma_f32_16x16x32_bf16 v[132:135], v[212:215], v[88:91], v[132:135]
    ds_read_b64_tr_b16 v[198:199], v66 offset:43520
    v_mul_f32 v35, v35, v48
    v_mfma_f32_16x16x32_bf16 v[120:123], v[216:219], v[84:87], v[120:123]
    ds_read_b64_tr_b16 v[200:201], v65 offset:40960
    v_mul_f32 v36, v36, v48
    v_mfma_f32_16x16x32_bf16 v[136:139], v[216:219], v[88:91], v[136:139]
    ds_read_b64_tr_b16 v[202:203], v67 offset:43520
    v_mul_f32 v37, v37, v48
    v_mfma_f32_16x16x32_bf16 v[124:127], v[220:223], v[84:87], v[124:127]
    ds_read_b64_tr_b16 v[204:205], v66 offset:40960
    v_mul_f32 v38, v38, v48
    v_mfma_f32_16x16x32_bf16 v[140:143], v[220:223], v[88:91], v[140:143]
    ds_read_b64_tr_b16 v[206:207], v64 offset:43520
    v_mul_f32 v39, v39, v48
    v_mfma_f32_16x16x32_bf16 v[128:131], v[224:227], v[84:87], v[128:131]
    ds_read_b64_tr_b16 v[208:209], v67 offset:40960
    v_mul_f32 v40, v40, v49
    v_mfma_f32_16x16x32_bf16 v[144:147], v[224:227], v[88:91], v[144:147]
    ds_read_b64_tr_b16 v[210:211], v65 offset:43520
    v_mul_f32 v41, v41, v49
    s_andn2_b32 s33, 61440, s58
    s_cbranch_scc1 K_SP19
K_SPR19:
    buffer_load_dwordx4 v[76:79], v54, s[20:23], s71 offen offset:3072 sc1
    buffer_load_dwordx4 v[80:83], v55, s[20:23], s71 offen offset:3072 sc1
    s_waitcnt vmcnt(8)
    v_mfma_f32_16x16x32_bf16 v[116:119], v[148:151], v[92:95], v[116:119]
    ds_read_b64_tr_b16 v[212:213], v64 offset:61440
    v_mul_f32 v42, v42, v49
    v_mfma_f32_16x16x32_bf16 v[132:135], v[148:151], v[96:99], v[132:135]
    ds_read_b64_tr_b16 v[214:215], v66 offset:64000
    v_mul_f32 v43, v43, v49
    v_mfma_f32_16x16x32_bf16 v[120:123], v[152:155], v[92:95], v[120:123]
    ds_read_b64_tr_b16 v[216:217], v65 offset:61440
    v_mul_f32 v44, v44, v49
    v_mfma_f32_16x16x32_bf16 v[136:139], v[152:155], v[96:99], v[136:139]
    ds_read_b64_tr_b16 v[218:219], v67 offset:64000
    v_mul_f32 v45, v45, v49
    v_mfma_f32_16x16x32_bf16 v[124:127], v[156:159], v[92:95], v[124:127]
    ds_read_b64_tr_b16 v[220:221], v66 offset:61440
    v_mul_f32 v46, v46, v49
    v_mfma_f32_16x16x32_bf16 v[140:143], v[156:159], v[96:99], v[140:143]
    ds_read_b64_tr_b16 v[222:223], v64 offset:64000
    v_mul_f32 v47, v47, v49
    v_mfma_f32_16x16x32_bf16 v[128:131], v[160:163], v[92:95], v[128:131]
    ds_read_b64_tr_b16 v[224:225], v67 offset:61440
    v_mfma_f32_16x16x32_bf16 v[144:147], v[160:163], v[96:99], v[144:147]
    ds_read_b64_tr_b16 v[226:227], v65 offset:64000
    s_waitcnt vmcnt(6)
    s_waitcnt lgkmcnt(15)
    v_mfma_f32_16x16x32_bf16 v[116:119], v[164:167], v[100:103], v[116:119]
    v_mfma_f32_16x16x32_bf16 v[132:135], v[164:167], v[104:107], v[132:135]
    v_mfma_f32_16x16x32_bf16 v[120:123], v[168:171], v[100:103], v[120:123]
    v_mfma_f32_16x16x32_bf16 v[136:139], v[168:171], v[104:107], v[136:139]
    v_mfma_f32_16x16x32_bf16 v[124:127], v[172:175], v[100:103], v[124:127]
    v_mfma_f32_16x16x32_bf16 v[140:143], v[172:175], v[104:107], v[140:143]
    v_mfma_f32_16x16x32_bf16 v[128:131], v[176:179], v[100:103], v[128:131]
    v_mfma_f32_16x16x32_bf16 v[144:147], v[176:179], v[104:107], v[144:147]
    s_waitcnt vmcnt(4)
    v_mfma_f32_16x16x32_bf16 v[116:119], v[180:183], v[108:111], v[116:119]
    v_mfma_f32_16x16x32_bf16 v[132:135], v[180:183], v[112:115], v[132:135]
    s_branch K_J4f1c
K_STM22:
    s_branch K_STM26
K_STA22:
    s_branch K_STA26
K_J4f1c:
    v_mfma_f32_16x16x32_bf16 v[120:123], v[184:187], v[108:111], v[120:123]
    v_mfma_f32_16x16x32_bf16 v[136:139], v[184:187], v[112:115], v[136:139]
    v_mfma_f32_16x16x32_bf16 v[124:127], v[188:191], v[108:111], v[124:127]
    v_mfma_f32_16x16x32_bf16 v[140:143], v[188:191], v[112:115], v[140:143]
    v_mfma_f32_16x16x32_bf16 v[128:131], v[192:195], v[108:111], v[128:131]
    v_mfma_f32_16x16x32_bf16 v[144:147], v[192:195], v[112:115], v[144:147]
    s_waitcnt vmcnt(2)
    s_waitcnt lgkmcnt(14)
    v_mfma_f32_16x16x32_bf16 v[116:119], v[196:199], v[68:71], v[116:119]
    v_mfma_f32_16x16x32_bf16 v[132:135], v[196:199], v[72:75], v[132:135]
    s_waitcnt lgkmcnt(12)
    v_mfma_f32_16x16x32_bf16 v[120:123], v[200:203], v[68:71], v[120:123]
    v_mfma_f32_16x16x32_bf16 v[136:139], v[200:203], v[72:75], v[136:139]
    s_waitcnt lgkmcnt(10)
    v_mfma_f32_16x16x32_bf16 v[124:127], v[204:207], v[68:71], v[124:127]
    v_mfma_f32_16x16x32_bf16 v[140:143], v[204:207], v[72:75], v[140:143]
    s_waitcnt lgkmcnt(8)
    v_mfma_f32_16x16x32_bf16 v[128:131], v[208:211], v[68:71], v[128:131]
    v_mfma_f32_16x16x32_bf16 v[144:147], v[208:211], v[72:75], v[144:147]
    s_waitcnt vmcnt(0)
    s_waitcnt lgkmcnt(6)
    v_mfma_f32_16x16x32_bf16 v[116:119], v[212:215], v[76:79], v[116:119]
    v_mfma_f32_16x16x32_bf16 v[132:135], v[212:215], v[80:83], v[132:135]
    s_waitcnt lgkmcnt(4)
    v_mfma_f32_16x16x32_bf16 v[120:123], v[216:219], v[76:79], v[120:123]
    v_mfma_f32_16x16x32_bf16 v[136:139], v[216:219], v[80:83], v[136:139]
    s_waitcnt lgkmcnt(2)
    v_mfma_f32_16x16x32_bf16 v[124:127], v[220:223], v[76:79], v[124:127]
    v_mfma_f32_16x16x32_bf16 v[140:143], v[220:223], v[80:83], v[140:143]
    s_waitcnt lgkmcnt(0)
    v_mfma_f32_16x16x32_bf16 v[128:131], v[224:227], v[76:79], v[128:131]
    s_branch K_PG4
.p2align 12
K_STM23:
    s_branch K_STM27
K_STA23:
    s_branch K_STA27
K_PG4:
    v_mfma_f32_16x16x32_bf16 v[144:147], v[224:227], v[80:83], v[144:147]
    s_nop 3
    v_cvt_pk_bf16_f32 v148, v116, v117
    v_cvt_pk_bf16_f32 v149, v118, v119
    ds_write_b64 v52, v[148:149] offset:0
    v_cvt_pk_bf16_f32 v164, v132, v133
    v_cvt_pk_bf16_f32 v165, v134, v135
    ds_write_b64 v52, v[164:165] offset:2304
    v_cvt_pk_bf16_f32 v152, v120, v121
    v_cvt_pk_bf16_f32 v153, v122, v123
    ds_write_b64 v52, v[152:153] offset:32
    v_cvt_pk_bf16_f32 v168, v136, v137
    v_cvt_pk_bf16_f32 v169, v138, v139
    ds_write_b64 v52, v[168:169] offset:2336
    v_cvt_pk_bf16_f32 v156, v124, v125
    v_cvt_pk_bf16_f32 v157, v126, v127
    ds_write_b64 v52, v[156:157] offset:64
    v_cvt_pk_bf16_f32 v172, v140, v141
    v_cvt_pk_bf16_f32 v173, v142, v143
    ds_write_b64 v52, v[172:173] offset:2368
    v_cvt_pk_bf16_f32 v160, v128, v129
    v_cvt_pk_bf16_f32 v161, v130, v131
    ds_write_b64 v52, v[160:161] offset:96
    v_cvt_pk_bf16_f32 v176, v144, v145
    v_cvt_pk_bf16_f32 v177, v146, v147
    ds_write_b64 v52, v[176:177] offset:2400
K_P2_E2:
    s_waitcnt lgkmcnt(0)
    v_readfirstlane_b32 s56, v28
    v_readfirstlane_b32 s57, v29
    s_lshl_b32 s72, s53, 4
    s_barrier
    ds_read_b128 v[52:55], v14
    ds_read_b128 v[56:59], v14 offset:1152
    s_sub_u32 s3, s56, s72
    s_cmp_lt_u32 s3, 16
    s_cbranch_scc1 K_YROW0
K_NOY0:
    s_sub_u32 s3, s57, s72
    s_cmp_lt_u32 s3, 16
    s_cbranch_scc1 K_YROW1
K_NOY1:
    s_waitcnt lgkmcnt(1)
    v_lshlrev_b32 v72, 16, v52
    v_and_b32 v73, 0xffff0000, v52
    v_fma_f32 v72, v72, v24, v32
    v_fma_f32 v73, v73, v24, v33
    v_cvt_pk_bf16_f32 v52, v72, v73
    v_lshlrev_b32 v74, 16, v53
    v_and_b32 v75, 0xffff0000, v53
    v_fma_f32 v74, v74, v24, v34
    v_fma_f32 v75, v75, v24, v35
    v_cvt_pk_bf16_f32 v53, v74, v75
    v_lshlrev_b32 v72, 16, v54
    v_and_b32 v73, 0xffff0000, v54
    v_fma_f32 v72, v72, v24, v36
    v_fma_f32 v73, v73, v24, v37
    v_cvt_pk_bf16_f32 v54, v72, v73
    v_lshlrev_b32 v74, 16, v55
    v_and_b32 v75, 0xffff0000, v55
    v_fma_f32 v74, v74, v24, v38
    v_fma_f32 v75, v75, v24, v39
    v_cvt_pk_bf16_f32 v55, v74, v75
    buffer_store_dwordx4 v[52:55], v10, s[48:51], 0 offen sc1
    s_waitcnt lgkmcnt(0)
    v_lshlrev_b32 v72, 16, v56
    v_and_b32 v73, 0xffff0000, v56
    v_fma_f32 v72, v72, v25, v40
    v_fma_f32 v73, v73, v25, v41
    v_cvt_pk_bf16_f32 v56, v72, v73
    v_lshlrev_b32 v74, 16, v57
    v_and_b32 v75, 0xffff0000, v57
    v_fma_f32 v74, v74, v25, v42
    v_fma_f32 v75, v75, v25, v43
    v_cvt_pk_bf16_f32 v57, v74, v75
    v_lshlrev_b32 v72, 16, v58
    v_and_b32 v73, 0xffff0000, v58
    v_fma_f32 v72, v72, v25, v44
    v_fma_f32 v73, v73, v25, v45
    v_cvt_pk_bf16_f32 v58, v72, v73
    v_lshlrev_b32 v74, 16, v59
    v_and_b32 v75, 0xffff0000, v59
    v_fma_f32 v74, v74, v25, v46
    v_fma_f32 v75, v75, v25, v47
    v_cvt_pk_bf16_f32 v59, v74, v75
    buffer_store_dwordx4 v[56:59], v10, s[48:51], s55 offen sc1
K_END:
K_EXIT:
    s_endpgm
K_YROW0:
    v_and_b32 v2, 7, v1
    v_lshlrev_b32 v2, 5, v2
    v_add_u32 v2, 158976, v2
    ds_read_b128 v[60:63], v2
    ds_read_b128 v[64:67], v2 offset:16
    s_and_b32 s33, s3, 7
    v_cmp_eq_u32 vcc, s33, v8
    s_cmp_ge_u32 s3, 8
    s_cbranch_scc1 K_YR1_0
    s_waitcnt lgkmcnt(0)
    v_lshlrev_b32 v68, 16, v16
    v_add_f32 v68, v68, v60
    v_cvt_pk_bf16_f32 v68, v68, v68
    v_lshlrev_b32 v68, 16, v68
    v_mul_f32 v68, v68, v48
    v_cndmask_b32 v32, v32, v68, vcc
    v_and_b32 v69, 0xffff0000, v16
    v_add_f32 v69, v69, v61
    v_cvt_pk_bf16_f32 v69, v69, v69
    v_lshlrev_b32 v69, 16, v69
    v_mul_f32 v69, v69, v48
    v_cndmask_b32 v33, v33, v69, vcc
    v_lshlrev_b32 v70, 16, v17
    v_add_f32 v70, v70, v62
    v_cvt_pk_bf16_f32 v70, v70, v70
    v_lshlrev_b32 v70, 16, v70
    v_mul_f32 v70, v70, v48
    v_cndmask_b32 v34, v34, v70, vcc
    v_and_b32 v71, 0xffff0000, v17
    v_add_f32 v71, v71, v63
    v_cvt_pk_bf16_f32 v71, v71, v71
    v_lshlrev_b32 v71, 16, v71
    v_mul_f32 v71, v71, v48
    v_cndmask_b32 v35, v35, v71, vcc
    v_lshlrev_b32 v68, 16, v18
    v_add_f32 v68, v68, v64
    v_cvt_pk_bf16_f32 v68, v68, v68
    v_lshlrev_b32 v68, 16, v68
    v_mul_f32 v68, v68, v48
    v_cndmask_b32 v36, v36, v68, vcc
    v_and_b32 v69, 0xffff0000, v18
    v_add_f32 v69, v69, v65
    v_cvt_pk_bf16_f32 v69, v69, v69
    v_lshlrev_b32 v69, 16, v69
    v_mul_f32 v69, v69, v48
    v_cndmask_b32 v37, v37, v69, vcc
    v_lshlrev_b32 v70, 16, v19
    v_add_f32 v70, v70, v66
    v_cvt_pk_bf16_f32 v70, v70, v70
    v_lshlrev_b32 v70, 16, v70
    v_mul_f32 v70, v70, v48
    v_cndmask_b32 v38, v38, v70, vcc
    v_and_b32 v71, 0xffff0000, v19
    v_add_f32 v71, v71, v67
    v_cvt_pk_bf16_f32 v71, v71, v71
    v_lshlrev_b32 v71, 16, v71
    v_mul_f32 v71, v71, v48
    v_cndmask_b32 v39, v39, v71, vcc
    s_branch K_NOY0
K_YR1_0:
    s_waitcnt lgkmcnt(0)
    v_lshlrev_b32 v68, 16, v20
    v_add_f32 v68, v68, v60
    v_cvt_pk_bf16_f32 v68, v68, v68
    v_lshlrev_b32 v68, 16, v68
    v_mul_f32 v68, v68, v49
    v_cndmask_b32 v40, v40, v68, vcc
    v_and_b32 v69, 0xffff0000, v20
    v_add_f32 v69, v69, v61
    v_cvt_pk_bf16_f32 v69, v69, v69
    v_lshlrev_b32 v69, 16, v69
    v_mul_f32 v69, v69, v49
    v_cndmask_b32 v41, v41, v69, vcc
    v_lshlrev_b32 v70, 16, v21
    v_add_f32 v70, v70, v62
    v_cvt_pk_bf16_f32 v70, v70, v70
    v_lshlrev_b32 v70, 16, v70
    s_branch K_J53c8
K_STM24:
    s_branch K_STM28
K_STA24:
    s_branch K_STA28
K_J53c8:
    v_mul_f32 v70, v70, v49
    v_cndmask_b32 v42, v42, v70, vcc
    v_and_b32 v71, 0xffff0000, v21
    v_add_f32 v71, v71, v63
    v_cvt_pk_bf16_f32 v71, v71, v71
    v_lshlrev_b32 v71, 16, v71
    v_mul_f32 v71, v71, v49
    v_cndmask_b32 v43, v43, v71, vcc
    v_lshlrev_b32 v68, 16, v22
    v_add_f32 v68, v68, v64
    v_cvt_pk_bf16_f32 v68, v68, v68
    v_lshlrev_b32 v68, 16, v68
    v_mul_f32 v68, v68, v49
    v_cndmask_b32 v44, v44, v68, vcc
    v_and_b32 v69, 0xffff0000, v22
    v_add_f32 v69, v69, v65
    v_cvt_pk_bf16_f32 v69, v69, v69
    v_lshlrev_b32 v69, 16, v69
    v_mul_f32 v69, v69, v49
    v_cndmask_b32 v45, v45, v69, vcc
    v_lshlrev_b32 v70, 16, v23
    v_add_f32 v70, v70, v66
    v_cvt_pk_bf16_f32 v70, v70, v70
    v_lshlrev_b32 v70, 16, v70
    v_mul_f32 v70, v70, v49
    v_cndmask_b32 v46, v46, v70, vcc
    v_and_b32 v71, 0xffff0000, v23
    v_add_f32 v71, v71, v67
    v_cvt_pk_bf16_f32 v71, v71, v71
    v_lshlrev_b32 v71, 16, v71
    v_mul_f32 v71, v71, v49
    v_cndmask_b32 v47, v47, v71, vcc
    s_branch K_NOY0
K_YROW1:
    v_and_b32 v2, 7, v1
    v_lshlrev_b32 v2, 5, v2
    v_add_u32 v2, 159232, v2
    ds_read_b128 v[60:63], v2
    ds_read_b128 v[64:67], v2 offset:16
    s_and_b32 s33, s3, 7
    v_cmp_eq_u32 vcc, s33, v8
    s_cmp_ge_u32 s3, 8
    s_cbranch_scc1 K_YR1_1
    s_waitcnt lgkmcnt(0)
    v_lshlrev_b32 v68, 16, v16
    v_add_f32 v68, v68, v60
    v_cvt_pk_bf16_f32 v68, v68, v68
    v_lshlrev_b32 v68, 16, v68
    v_mul_f32 v68, v68, v48
    v_cndmask_b32 v32, v32, v68, vcc
    v_and_b32 v69, 0xffff0000, v16
    v_add_f32 v69, v69, v61
    v_cvt_pk_bf16_f32 v69, v69, v69
    v_lshlrev_b32 v69, 16, v69
    v_mul_f32 v69, v69, v48
    v_cndmask_b32 v33, v33, v69, vcc
    v_lshlrev_b32 v70, 16, v17
    v_add_f32 v70, v70, v62
    v_cvt_pk_bf16_f32 v70, v70, v70
    v_lshlrev_b32 v70, 16, v70
    v_mul_f32 v70, v70, v48
    v_cndmask_b32 v34, v34, v70, vcc
    v_and_b32 v71, 0xffff0000, v17
    v_add_f32 v71, v71, v63
    v_cvt_pk_bf16_f32 v71, v71, v71
    v_lshlrev_b32 v71, 16, v71
    v_mul_f32 v71, v71, v48
    v_cndmask_b32 v35, v35, v71, vcc
    v_lshlrev_b32 v68, 16, v18
    v_add_f32 v68, v68, v64
    v_cvt_pk_bf16_f32 v68, v68, v68
    v_lshlrev_b32 v68, 16, v68
    v_mul_f32 v68, v68, v48
    v_cndmask_b32 v36, v36, v68, vcc
    v_and_b32 v69, 0xffff0000, v18
    v_add_f32 v69, v69, v65
    v_cvt_pk_bf16_f32 v69, v69, v69
    v_lshlrev_b32 v69, 16, v69
    v_mul_f32 v69, v69, v48
    v_cndmask_b32 v37, v37, v69, vcc
    v_lshlrev_b32 v70, 16, v19
    v_add_f32 v70, v70, v66
    v_cvt_pk_bf16_f32 v70, v70, v70
    v_lshlrev_b32 v70, 16, v70
    v_mul_f32 v70, v70, v48
    v_cndmask_b32 v38, v38, v70, vcc
    v_and_b32 v71, 0xffff0000, v19
    v_add_f32 v71, v71, v67
    v_cvt_pk_bf16_f32 v71, v71, v71
    v_lshlrev_b32 v71, 16, v71
    v_mul_f32 v71, v71, v48
    v_cndmask_b32 v39, v39, v71, vcc
    s_branch K_NOY1
K_YR1_1:
    s_waitcnt lgkmcnt(0)
    v_lshlrev_b32 v68, 16, v20
    v_add_f32 v68, v68, v60
    v_cvt_pk_bf16_f32 v68, v68, v68
    v_lshlrev_b32 v68, 16, v68
    v_mul_f32 v68, v68, v49
    v_cndmask_b32 v40, v40, v68, vcc
    v_and_b32 v69, 0xffff0000, v20
    v_add_f32 v69, v69, v61
    v_cvt_pk_bf16_f32 v69, v69, v69
    v_lshlrev_b32 v69, 16, v69
    v_mul_f32 v69, v69, v49
    v_cndmask_b32 v41, v41, v69, vcc
    v_lshlrev_b32 v70, 16, v21
    v_add_f32 v70, v70, v62
    v_cvt_pk_bf16_f32 v70, v70, v70
    v_lshlrev_b32 v70, 16, v70
    v_mul_f32 v70, v70, v49
    v_cndmask_b32 v42, v42, v70, vcc
    v_and_b32 v71, 0xffff0000, v21
    v_add_f32 v71, v71, v63
    v_cvt_pk_bf16_f32 v71, v71, v71
    v_lshlrev_b32 v71, 16, v71
    v_mul_f32 v71, v71, v49
    v_cndmask_b32 v43, v43, v71, vcc
    v_lshlrev_b32 v68, 16, v22
    v_add_f32 v68, v68, v64
    v_cvt_pk_bf16_f32 v68, v68, v68
    v_lshlrev_b32 v68, 16, v68
    v_mul_f32 v68, v68, v49
    v_cndmask_b32 v44, v44, v68, vcc
    v_and_b32 v69, 0xffff0000, v22
    v_add_f32 v69, v69, v65
    v_cvt_pk_bf16_f32 v69, v69, v69
    v_lshlrev_b32 v69, 16, v69
    v_mul_f32 v69, v69, v49
    v_cndmask_b32 v45, v45, v69, vcc
    v_lshlrev_b32 v70, 16, v23
    v_add_f32 v70, v70, v66
    v_cvt_pk_bf16_f32 v70, v70, v70
    v_lshlrev_b32 v70, 16, v70
    v_mul_f32 v70, v70, v49
    v_cndmask_b32 v46, v46, v70, vcc
    v_and_b32 v71, 0xffff0000, v23
    v_add_f32 v71, v71, v67
    v_cvt_pk_bf16_f32 v71, v71, v71
    v_lshlrev_b32 v71, 16, v71
    v_mul_f32 v71, v71, v49
    v_cndmask_b32 v47, v47, v71, vcc
    s_branch K_NOY1
K_STM25:
    s_branch K_STM29
K_STA25:
    s_branch K_STA29
K_SP0:
    ds_read_b32 v2, v15 offset:32
    s_waitcnt lgkmcnt(0)
    v_readfirstlane_b32 s33, v2
    s_nop 3
    s_lshr_b32 s58, s33, s59
    s_lshr_b32 s33, s33, s61
    s_and_b32 s58, s58, s33
    s_andn2_b32 s33, 1, s58
    s_cbranch_scc1 K_SP0
    s_branch K_SPR0
K_SP1:
    ds_read_b32 v2, v15 offset:32
    s_waitcnt lgkmcnt(0)
    v_readfirstlane_b32 s33, v2
    s_nop 3
    s_lshr_b32 s58, s33, s59
    s_lshr_b32 s33, s33, s61
    s_and_b32 s58, s58, s33
    s_andn2_b32 s33, 16, s58
    s_cbranch_scc1 K_SP1
    s_branch K_SPR1
K_SP2:
    ds_read_b32 v2, v15 offset:32
    s_waitcnt lgkmcnt(0)
    v_readfirstlane_b32 s33, v2
    s_nop 3
    s_lshr_b32 s58, s33, s59
    s_lshr_b32 s33, s33, s61
    s_and_b32 s58, s58, s33
    s_andn2_b32 s33, 2, s58
    s_cbranch_scc1 K_SP2
    s_branch K_SPR2
K_SP3:
    ds_read_b32 v2, v15 offset:32
    s_waitcnt lgkmcnt(0)
    v_readfirstlane_b32 s33, v2
    s_nop 3
    s_lshr_b32 s58, s33, s59
    s_lshr_b32 s33, s33, s61
    s_and_b32 s58, s58, s33
    s_andn2_b32 s33, 32, s58
    s_cbranch_scc1 K_SP3
    s_branch K_SPR3
K_SP4:
    ds_read_b32 v2, v15 offset:32
    s_waitcnt lgkmcnt(0)
    v_readfirstlane_b32 s33, v2
    s_nop 3
    s_lshr_b32 s58, s33, s59
    s_lshr_b32 s33, s33, s61
    s_and_b32 s58, s58, s33
    s_andn2_b32 s33, 4, s58
    s_cbranch_scc1 K_SP4
    s_branch K_SPR4
K_SP5:
    ds_read_b32 v2, v15 offset:32
    s_waitcnt lgkmcnt(0)
    v_readfirstlane_b32 s33, v2
    s_nop 3
    s_lshr_b32 s58, s33, s59
    s_lshr_b32 s33, s33, s61
    s_and_b32 s58, s58, s33
    s_andn2_b32 s33, 64, s58
    s_cbranch_scc1 K_SP5
    s_branch K_SPR5
K_SP6:
    ds_read_b32 v2, v15 offset:32
    s_waitcnt lgkmcnt(0)
    v_readfirstlane_b32 s33, v2
    s_nop 3
    s_lshr_b32 s58, s33, s59
    s_lshr_b32 s33, s33, s61
    s_and_b32 s58, s58, s33
    s_andn2_b32 s33, 8, s58
    s_cbranch_scc1 K_SP6
    s_branch K_SPR6
K_SP7:
    ds_read_b32 v2, v15 offset:32
    s_waitcnt lgkmcnt(0)
    v_readfirstlane_b32 s33, v2
    s_nop 3
    s_lshr_b32 s58, s33, s59
    s_lshr_b32 s33, s33, s61
    s_and_b32 s58, s58, s33
    s_andn2_b32 s33, 128, s58
    s_cbranch_scc1 K_SP7
    s_branch K_SPR7
K_SP8:
    ds_read_b32 v2, v15 offset:32
    s_waitcnt lgkmcnt(0)
    v_readfirstlane_b32 s33, v2
    s_nop 3
    s_lshr_b32 s58, s33, s59
    s_lshr_b32 s33, s33, s61
    s_and_b32 s58, s58, s33
    s_andn2_b32 s33, 15, s58
    s_cbranch_scc1 K_SP8
    s_branch K_SPR8
K_SP9:
    ds_read_b32 v2, v15 offset:32
    s_waitcnt lgkmcnt(0)
    v_readfirstlane_b32 s33, v2
    s_nop 3
    s_lshr_b32 s58, s33, s59
    s_lshr_b32 s33, s33, s61
    s_and_b32 s58, s58, s33
    s_andn2_b32 s33, 240, s58
    s_cbranch_scc1 K_SP9
    s_branch K_SPR9
K_SP10:
    ds_read_b32 v2, v15 offset:32
    s_waitcnt lgkmcnt(0)
    v_readfirstlane_b32 s33, v2
    s_nop 3
    s_lshr_b32 s58, s33, s59
    s_lshr_b32 s33, s33, s61
    s_and_b32 s58, s58, s33
    s_andn2_b32 s33, 256, s58
    s_cbranch_scc1 K_SP10
    s_branch K_SPR10
K_SP11:
    ds_read_b32 v2, v15 offset:32
    s_waitcnt lgkmcnt(0)
    v_readfirstlane_b32 s33, v2
    s_nop 3
    s_lshr_b32 s58, s33, s59
    s_lshr_b32 s33, s33, s61
    s_and_b32 s58, s58, s33
    s_andn2_b32 s33, 4096, s58
    s_cbranch_scc1 K_SP11
    s_branch K_SPR11
K_STM26:
    s_branch K_STM30
K_STA26:
    s_branch K_STA30
K_SP12:
    ds_read_b32 v2, v15 offset:32
    s_waitcnt lgkmcnt(0)
    v_readfirstlane_b32 s33, v2
    s_nop 3
    s_lshr_b32 s58, s33, s59
    s_lshr_b32 s33, s33, s61
    s_and_b32 s58, s58, s33
    s_andn2_b32 s33, 512, s58
    s_cbranch_scc1 K_SP12
    s_branch K_SPR12
K_SP13:
    ds_read_b32 v2, v15 offset:32
    s_waitcnt lgkmcnt(0)
    v_readfirstlane_b32 s33, v2
    s_nop 3
    s_lshr_b32 s58, s33, s59
    s_lshr_b32 s33, s33, s61
    s_and_b32 s58, s58, s33
    s_andn2_b32 s33, 8192, s58
    s_cbranch_scc1 K_SP13
    s_branch K_SPR13
K_SP14:
    ds_read_b32 v2, v15 offset:32
    s_waitcnt lgkmcnt(0)
    v_readfirstlane_b32 s33, v2
    s_nop 3
    s_lshr_b32 s58, s33, s59
    s_lshr_b32 s33, s33, s61
    s_and_b32 s58, s58, s33
    s_andn2_b32 s33, 1024, s58
    s_cbranch_scc1 K_SP14
    s_branch K_SPR14
K_SP15:
    ds_read_b32 v2, v15 offset:32
    s_waitcnt lgkmcnt(0)
    v_readfirstlane_b32 s33, v2
    s_nop 3
    s_lshr_b32 s58, s33, s59
    s_lshr_b32 s33, s33, s61
    s_and_b32 s58, s58, s33
    s_andn2_b32 s33, 16384, s58
    s_cbranch_scc1 K_SP15
    s_branch K_SPR15
K_SP16:
    ds_read_b32 v2, v15 offset:32
    s_waitcnt lgkmcnt(0)
    v_readfirstlane_b32 s33, v2
    s_nop 3
    s_lshr_b32 s58, s33, s59
    s_lshr_b32 s33, s33, s61
    s_and_b32 s58, s58, s33
    s_andn2_b32 s33, 2048, s58
    s_cbranch_scc1 K_SP16
    s_branch K_SPR16
K_SP17:
    ds_read_b32 v2, v15 offset:32
    s_waitcnt lgkmcnt(0)
    v_readfirstlane_b32 s33, v2
    s_nop 3
    s_lshr_b32 s58, s33, s59
    s_lshr_b32 s33, s33, s61
    s_and_b32 s58, s58, s33
    s_andn2_b32 s33, 32768, s58
    s_cbranch_scc1 K_SP17
    s_branch K_SPR17
K_SP18:
    ds_read_b32 v2, v15 offset:32
    s_waitcnt lgkmcnt(0)
    v_readfirstlane_b32 s33, v2
    s_nop 3
    s_lshr_b32 s58, s33, s59
    s_lshr_b32 s33, s33, s61
    s_and_b32 s58, s58, s33
    s_andn2_b32 s33, 3840, s58
    s_cbranch_scc1 K_SP18
    s_branch K_SPR18
K_SP19:
    ds_read_b32 v2, v15 offset:32
    s_waitcnt lgkmcnt(0)
    v_readfirstlane_b32 s33, v2
    s_nop 3
    s_lshr_b32 s58, s33, s59
    s_lshr_b32 s33, s33, s61
    s_and_b32 s58, s58, s33
    s_andn2_b32 s33, 61440, s58
    s_cbranch_scc1 K_SP19
    s_branch K_SPR19
K_P2:
    s_cmp_ge_u32 s30, 4
    s_cbranch_scc1 K_P2_HELP
    s_lshl_b32 s54, s40, 7
    v_lshrrev_b32 v8, 3, v1
    v_lshrrev_b32 v9, 4, v1
    v_mov_b32 v15, 158720
    s_lshl_b32 s53, s40, 3
    s_add_u32 s53, s53, s30
    s_mul_i32 s3, s53, 20480
    s_lshl_b32 s33, s41, 7
    s_add_u32 s3, s3, s33
    v_and_b32 v2, 7, v1
    v_lshlrev_b32 v2, 4, v2
    v_mul_u32_u24 v4, 1280, v8
    v_add3_u32 v10, v2, v4, s3
    s_lshl_b32 s3, s53, 6
    v_lshl_add_u32 v11, v8, 2, s3
    s_mov_b32 s55, 10240
    s_add_u32 s20, s6, 0x100000
    s_addc_u32 s21, s7, 0
    s_mov_b32 s22, 0x280000
    s_mov_b32 s23, 0x20000
    s_add_u32 s16, s6, 0x1000
    s_addc_u32 s17, s7, 0
    s_mov_b32 s18, 0x2000
    s_mov_b32 s19, 0x20000
    s_mov_b32 s48, s10
    s_mov_b32 s49, s11
    s_mov_b32 s50, 0x280000
    s_mov_b32 s51, 0x20000
    v_mul_u32_u24 v3, 144, v8
    v_add_u32 v3, v2, v3
    s_mul_i32 s3, s30, 2304
    s_add_u32 s3, s3, 140288
    v_add_u32 v14, s3, v3
    v_bfe_u32 v50, v1, 2, 2
    v_and_b32 v51, 3, v1
    s_add_u32 s3, s53, s30
    s_mul_i32 s3, s3, 20480
    v_lshl_add_u32 v54, v1, 4, s3
    v_add_u32 v55, 20480, v54
    v_lshl_add_u32 v2, v9, 2, v50
    v_bfe_u32 v3, v2, 1, 2
    v_lshlrev_b32 v2, 7, v2
    v_lshl_add_u32 v2, v51, 3, v2
    v_xor_b32 v4, 0, v3
    v_lshl_add_u32 v56, v4, 5, v2
    v_add_u32 v60, 40960, v56
    v_xor_b32 v4, 1, v3
    v_lshl_add_u32 v57, v4, 5, v2
    v_add_u32 v61, 40960, v57
    v_xor_b32 v4, 2, v3
    v_lshl_add_u32 v58, v4, 5, v2
    v_add_u32 v62, 40960, v58
    v_xor_b32 v4, 3, v3
    v_lshl_add_u32 v59, v4, 5, v2
    v_add_u32 v63, 40960, v59
    v_lshrrev_b32 v3, 1, v50
    v_mul_u32_u24 v2, 40, v9
    v_add3_u32 v2, v2, 16, v50
    v_lshlrev_b32 v2, 7, v2
    v_lshl_add_u32 v2, v51, 3, v2
    v_xor_b32 v4, 0, v3
    v_lshl_add_u32 v64, v4, 5, v2
    v_xor_b32 v4, 1, v3
    v_lshl_add_u32 v65, v4, 5, v2
    v_xor_b32 v4, 2, v3
    v_lshl_add_u32 v66, v4, 5, v2
    v_xor_b32 v4, 3, v3
    v_lshl_add_u32 v67, v4, 5, v2
    v_and_b32 v2, 15, v1
    v_mul_u32_u24 v2, 144, v2
    v_lshl_add_u32 v2, v9, 3, v2
    s_mul_i32 s3, s30, 4608
    s_add_u32 s3, s3, 140288
    v_add_u32 v52, s3, v2
    s_mov_b32 s67, 0
    s_mov_b32 s68, 4096
    s_mov_b32 s69, 8192
    s_mov_b32 s70, 12288
    s_mov_b32 s71, 16384
K_P2_AUXW:
    v_lshrrev_b32 v2, 3, v1
    v_mul_u32_u24 v2, 1280, v2
    v_lshrrev_b32 v3, 4, v1
    v_lshlrev_b32 v3, 1, v3
    v_and_b32 v4, 7, v1
    v_xor_b32 v3, v3, v4
    v_lshl_add_u32 v2, v3, 4, v2
    s_lshl_b32 s33, s41, 7
    v_add_u32 v53, s33, v2
    s_lshl_b32 s60, s30, 2
    s_lshr_b32 s60, 0x7520, s60
    s_and_b32 s60, s60, 7
    s_branch K_J5c80
K_STM27:
    s_branch K_STM31
K_STA27:
    s_branch K_STA31
K_J5c80:
    s_mul_i32 s60, s60, 51200
    s_mul_i32 s61, s30, 5120
    s_add_u32 s52, s60, 0
    s_add_u32 m0, s61, 0
    s_waitcnt vmcnt(5)
    buffer_load_dwordx4 v53, s[24:27], s52 offen lds
    s_add_u32 s52, s60, 10240
    s_add_u32 m0, s61, 1024
    s_waitcnt vmcnt(5)
    buffer_load_dwordx4 v53, s[24:27], s52 offen lds
    s_add_u32 s52, s60, 20480
    s_add_u32 m0, s61, 2048
    s_waitcnt vmcnt(5)
    buffer_load_dwordx4 v53, s[24:27], s52 offen lds
    s_add_u32 s52, s60, 30720
    s_add_u32 m0, s61, 3072
    s_waitcnt vmcnt(5)
    buffer_load_dwordx4 v53, s[24:27], s52 offen lds
    s_add_u32 s52, s60, 40960
    s_add_u32 m0, s61, 4096
    s_waitcnt vmcnt(5)
    buffer_load_dwordx4 v53, s[24:27], s52 offen lds
    s_add_u32 s52, s60, 409600
    s_add_u32 m0, s61, 20480
    s_waitcnt vmcnt(5)
    buffer_load_dwordx4 v53, s[24:27], s52 offen lds
    s_add_u32 s52, s60, 419840
    s_add_u32 m0, s61, 21504
    s_waitcnt vmcnt(5)
    buffer_load_dwordx4 v53, s[24:27], s52 offen lds
    s_add_u32 s52, s60, 430080
    s_add_u32 m0, s61, 22528
    s_waitcnt vmcnt(5)
    buffer_load_dwordx4 v53, s[24:27], s52 offen lds
    s_add_u32 s52, s60, 440320
    s_add_u32 m0, s61, 23552
    s_waitcnt vmcnt(5)
    buffer_load_dwordx4 v53, s[24:27], s52 offen lds
    s_add_u32 s52, s60, 450560
    s_add_u32 m0, s61, 24576
    s_waitcnt vmcnt(5)
    buffer_load_dwordx4 v53, s[24:27], s52 offen lds
    s_lshl_b32 s60, s30, 2
    s_lshr_b32 s60, 0x6431, s60
    s_and_b32 s60, s60, 7
    s_mul_i32 s60, s60, 51200
    s_mul_i32 s61, s30, 5120
    s_add_u32 s52, s60, 0
    s_add_u32 m0, s61, 40960
    s_waitcnt vmcnt(5)
    buffer_load_dwordx4 v53, s[24:27], s52 offen lds
    s_add_u32 s52, s60, 10240
    s_add_u32 m0, s61, 41984
    s_waitcnt vmcnt(5)
    buffer_load_dwordx4 v53, s[24:27], s52 offen lds
    s_add_u32 s52, s60, 20480
    s_add_u32 m0, s61, 43008
    s_waitcnt vmcnt(5)
    buffer_load_dwordx4 v53, s[24:27], s52 offen lds
    s_add_u32 s52, s60, 30720
    s_add_u32 m0, s61, 44032
    s_waitcnt vmcnt(5)
    buffer_load_dwordx4 v53, s[24:27], s52 offen lds
    s_add_u32 s52, s60, 40960
    s_add_u32 m0, s61, 45056
    s_waitcnt vmcnt(5)
    buffer_load_dwordx4 v53, s[24:27], s52 offen lds
    s_add_u32 s52, s60, 409600
    s_add_u32 m0, s61, 61440
    s_waitcnt vmcnt(5)
    buffer_load_dwordx4 v53, s[24:27], s52 offen lds
    s_add_u32 s52, s60, 419840
    s_add_u32 m0, s61, 62464
    s_waitcnt vmcnt(5)
    buffer_load_dwordx4 v53, s[24:27], s52 offen lds
    s_add_u32 s52, s60, 430080
    s_add_u32 m0, s61, 63488
    s_waitcnt vmcnt(5)
    buffer_load_dwordx4 v53, s[24:27], s52 offen lds
    s_add_u32 s52, s60, 440320
    s_add_u32 m0, s61, 64512
    s_waitcnt vmcnt(5)
    buffer_load_dwordx4 v53, s[24:27], s52 offen lds
    s_add_u32 s52, s60, 450560
    s_add_u32 m0, s61, 65536
    s_waitcnt vmcnt(5)
    buffer_load_dwordx4 v53, s[24:27], s52 offen lds
    s_cmp_eq_u32 s30, 0
    s_cbranch_scc1 K_CHA0
    s_cmp_eq_u32 s30, 1
    s_cbranch_scc1 K_CHA1
    s_cmp_eq_u32 s30, 2
    s_cbranch_scc1 K_CHA2
    s_branch K_CHA3
K_WRET_A:
    v_mov_b32 v3, 1
    s_waitcnt vmcnt(0)
    s_mov_b64 exec, 1
    ds_add_u32 v15, v3 offset:44
    s_mov_b64 exec, -1
    s_mov_b32 s3, 1048576
K_P2_GWA:
    ds_read_b32 v2, v15 offset:44
    s_sub_u32 s3, s3, 1
    s_waitcnt lgkmcnt(0)
    v_readfirstlane_b32 s33, v2
    s_nop 3
    s_cselect_b32 s33, 4, s33
    s_cmp_lt_u32 s33, 4
    s_cbranch_scc1 K_P2_GWA
    s_branch K_P2_GEMM
K_STM28:
    s_branch K_WRET_M
K_STA28:
    s_branch K_WRET_A
K_P2_HELP:
    s_setprio 3
    s_lshl_b32 s53, s40, 3
    s_mul_i32 s60, s53, 187
    s_lshr_b32 s60, s60, 11
    s_add_u32 s3, s53, 7
    s_mul_i32 s61, s3, 187
    s_lshr_b32 s61, s61, 11
    s_sub_u32 s61, s61, s60
    s_lshl_b32 s61, s61, 4
    s_or_b32 s61, s61, 15
    v_and_b32 v12, s61, v1
    v_lshl_add_u32 v12, v12, 2, s42
    s_cmp_lg_u32 s30, 7
    s_cbranch_scc1 K_P2_N7
    v_mov_b32 v4, 192
    s_mov_b32 s3, 131072
K_ZPOLL1:
    v_readfirstlane_b32 s33, v7
    s_nop 3
    s_sub_u32 s3, s3, 1
    s_cselect_b32 s33, 1, s33
    s_cmp_lg_u32 s33, 0
    s_cbranch_scc1 K_ZOK1
    global_load_dword v7, v4, s[4:5] sc1
    s_waitcnt vmcnt(0)
    s_branch K_ZPOLL1
K_ZOK1:
    global_load_dword v7, v12, s[6:7] sc1
K_P2_N7:
    s_lshl_b32 s54, s40, 7
    v_lshrrev_b32 v8, 3, v1
    v_lshrrev_b32 v9, 4, v1
    v_mov_b32 v15, 158720
    s_lshl_b32 s53, s40, 3
    s_add_u32 s53, s53, s30
    s_mul_i32 s3, s53, 20480
    s_lshl_b32 s33, s41, 7
    s_add_u32 s3, s3, s33
    s_branch K_PG5
.p2align 12
K_STM29:
    s_branch K_WRET_M
K_STA29:
    s_branch K_WRET_A
K_PG5:
    v_and_b32 v2, 7, v1
    v_lshlrev_b32 v2, 4, v2
    v_mul_u32_u24 v4, 1280, v8
    v_add3_u32 v10, v2, v4, s3
    s_lshl_b32 s3, s53, 6
    v_lshl_add_u32 v11, v8, 2, s3
    s_mov_b32 s55, 10240
    s_add_u32 s20, s6, 0x100000
    s_addc_u32 s21, s7, 0
    s_mov_b32 s22, 0x280000
    s_mov_b32 s23, 0x20000
    s_add_u32 s16, s6, 0x1000
    s_addc_u32 s17, s7, 0
    s_mov_b32 s18, 0x2000
    s_mov_b32 s19, 0x20000
    s_mov_b32 s48, s10
    s_mov_b32 s49, s11
    s_mov_b32 s50, 0x280000
    s_mov_b32 s51, 0x20000
    v_mul_u32_u24 v3, 144, v8
    v_add_u32 v3, v2, v3
    s_mul_i32 s3, s30, 2304
    s_add_u32 s3, s3, 140288
    v_add_u32 v14, s3, v3
    s_add_u32 s44, s6, 0x10000
    s_addc_u32 s45, s7, 0
    s_mov_b32 s46, 0x43800
    s_mov_b32 s47, 0x20000
    v_mov_b32 v112, 1
    s_cmp_eq_u32 s30, 7
    s_cbranch_scc1 K_P2_FLAGS
    buffer_load_dwordx4 v[16:19], v10, s[12:15], 0 offen
    buffer_load_dwordx4 v[20:23], v10, s[12:15], s55 offen
    s_cmp_lg_u32 s30, 6
    s_cbranch_scc1 K_P2_HW
    s_mov_b32 s3, 131072
K_P2_DPOLL:
    v_cmp_eq_u32 vcc, 0, v7
    s_cbranch_vccz K_P2_DOK
    s_cmp_eq_u32 s3, 131072
    s_cbranch_scc1 K_P2_DNS
    s_sleep 12
K_P2_DNS:
    v_min_u32 v13, 23, v1
    v_lshl_add_u32 v13, v13, 2, s42
    global_load_dword v7, v13, s[6:7] offset:128 sc1
    s_sub_u32 s3, s3, 1
    s_waitcnt vmcnt(0)
    s_cmp_lg_u32 s3, 0
    s_cbranch_scc1 K_P2_DPOLL
K_P2_DOK:
    v_cmp_gt_u32 vcc, 16, v1
    s_nop 1
    v_cndmask_b32 v2, 0, v7, vcc
    s_nop 1
    v_max_u32_dpp v3, v2, v2 quad_perm:[1,0,3,2] row_mask:0xf bank_mask:0xf
    s_nop 1
    v_max_u32_dpp v3, v3, v3 quad_perm:[2,3,0,1] row_mask:0xf bank_mask:0xf
    s_nop 1
    v_max_u32_dpp v3, v3, v3 row_half_mirror row_mask:0xf bank_mask:0xf
    s_nop 1
    v_max_u32_dpp v3, v3, v3 row_mirror row_mask:0xf bank_mask:0xf
    s_nop 1
    v_readlane_b32 s60, v3, 0
    v_readlane_b32 s64, v3, 16
    v_readlane_b32 s65, v3, 32
    v_readlane_b32 s66, v3, 48
    s_nop 3
    s_max_u32 s60, s60, s64
    s_max_u32 s65, s65, s66
    s_max_u32 s60, s60, s65
    v_cmp_ne_u32 vcc, s60, v2
    s_nop 1
    v_cndmask_b32 v2, 0, v2, vcc
    s_nop 1
    v_max_u32_dpp v3, v2, v2 quad_perm:[1,0,3,2] row_mask:0xf bank_mask:0xf
    s_nop 1
    v_max_u32_dpp v3, v3, v3 quad_perm:[2,3,0,1] row_mask:0xf bank_mask:0xf
    s_nop 1
    v_max_u32_dpp v3, v3, v3 row_half_mirror row_mask:0xf bank_mask:0xf
    s_nop 1
    v_max_u32_dpp v3, v3, v3 row_mirror row_mask:0xf bank_mask:0xf
    s_nop 1
    v_readlane_b32 s61, v3, 0
    v_readlane_b32 s64, v3, 16
    v_readlane_b32 s65, v3, 32
    v_readlane_b32 s66, v3, 48
    s_nop 3
    s_max_u32 s61, s61, s64
    s_max_u32 s65, s65, s66
    s_max_u32 s61, s61, s65
    s_and_b32 s3, s60, 0x7ff
    s_sub_u32 s3, 2047, s3
    v_mov_b32 v52, s3
    v_mov_b32 v4, s60
    v_and_b32 v4, 0xffff0000, v4
    v_ashrrev_i32 v5, 31, v4
    v_not_b32 v5, v5
    v_or_b32 v5, 0x80000000, v5
    v_xor_b32 v4, v4, v5
    v_and_b32 v4, 0xffff0000, v4
    v_mul_f32 v5, 0xbfb8aa3b, v4
    v_exp_f32 v5, v5
    s_nop 0
    v_add_f32 v5, 1.0, v5
    v_rcp_f32 v4, v5
    s_nop 0
    v_cvt_pk_bf16_f32 v54, v4, v4
    v_lshlrev_b32 v54, 16, v54
    s_and_b32 s3, s61, 0x7ff
    s_sub_u32 s3, 2047, s3
    v_mov_b32 v53, s3
    v_mov_b32 v4, s61
    v_and_b32 v4, 0xffff0000, v4
    v_ashrrev_i32 v5, 31, v4
    v_not_b32 v5, v5
    v_or_b32 v5, 0x80000000, v5
    v_xor_b32 v4, v4, v5
    v_and_b32 v4, 0xffff0000, v4
    v_mul_f32 v5, 0xbfb8aa3b, v4
    v_exp_f32 v5, v5
    s_nop 0
    v_add_f32 v5, 1.0, v5
    v_rcp_f32 v4, v5
    s_nop 0
    v_cvt_pk_bf16_f32 v55, v4, v4
    v_lshlrev_b32 v55, 16, v55
    ds_write_b128 v15, v[52:55]
    ds_write_b32 v15, v112 offset:40
K_P2_HW:
    s_mov_b32 s3, 1048576
K_P2_GS2:
    ds_read_b32 v2, v15 offset:40
    s_sleep 1
    s_sub_u32 s3, s3, 1
    s_waitcnt lgkmcnt(0)
    v_readfirstlane_b32 s33, v2
    s_nop 3
    s_cselect_b32 s33, 1, s33
    s_cmp_lt_u32 s33, 1
    s_cbranch_scc1 K_P2_GS2
    buffer_load_dword v24, v11, s[16:19], 0 offen sc1
    buffer_load_dword v25, v11, s[16:19], 0 offen offset:32 sc1
    ds_read_b128 v[28:31], v15
    s_cmp_eq_u32 s30, 6
    s_cbranch_scc1 K_P2_E
    s_waitcnt lgkmcnt(0)
    s_cmp_eq_u32 s30, 4
    s_cselect_b64 vcc, -1, 0
    s_nop 1
    v_cndmask_b32 v2, v29, v28, vcc
    v_cndmask_b32 v5, v31, v30, vcc
    s_nop 0
    v_readfirstlane_b32 s60, v2
    s_nop 3
    s_sub_u32 s3, s60, s54
    s_cmp_lt_u32 s3, 128
    s_cbranch_scc0 K_P2_E
    v_min_u32 v3, 53, v1
    v_lshlrev_b32 v3, 5, v3
    v_add_u32 v3, 565248, v3
    s_mov_b32 s3, 1048576
K_P2_GY:
    ds_read_b32 v2, v15 offset:32
    s_sleep 1
    s_sub_u32 s3, s3, 1
    s_waitcnt lgkmcnt(0)
    v_readfirstlane_b32 s33, v2
    s_nop 3
    s_cselect_b32 s33, 16777216, s33
    s_cmp_lt_u32 s33, 16777216
    s_cbranch_scc1 K_P2_GY
    s_mov_b32 s3, 131072
K_P2_YPOLL:
    global_load_dwordx4 v[52:55], v3, s[6:7] sc1
    s_sub_u32 s3, s3, 1
    s_waitcnt vmcnt(0)
    v_and_b32 v2, v52, v53
    s_branch K_J63c8
K_STM30:
    s_branch K_WRET_M
K_STA30:
    s_branch K_WRET_A
K_J63c8:
    v_and_b32 v2, v2, v54
    v_and_b32 v2, v2, v55
    v_cmp_ne_u32 vcc, 1, v2
    s_cbranch_vccz K_P2_YGO
    s_sleep 8
    s_cmp_lg_u32 s3, 0
    s_cbranch_scc1 K_P2_YPOLL
K_P2_YGO:
    v_and_b32 v2, 15, v1
    v_lshlrev_b32 v2, 4, v2
    v_mul_u32_u24 v4, 5120, v9
    s_sub_u32 s61, s30, 4
    s_mul_i32 s33, s61, 2560
    s_lshl_b32 s3, s41, 8
    s_add_u32 s3, s3, s33
    v_add3_u32 v3, v2, v4, s3
    s_mov_b32 s52, 0
    buffer_load_dwordx4 v[56:59], v3, s[44:47], s52 offen sc1
    s_mov_b32 s52, 20480
    buffer_load_dwordx4 v[60:63], v3, s[44:47], s52 offen sc1
    s_mov_b32 s52, 40960
    buffer_load_dwordx4 v[64:67], v3, s[44:47], s52 offen sc1
    s_mov_b32 s52, 61440
    buffer_load_dwordx4 v[68:71], v3, s[44:47], s52 offen sc1
    s_mov_b32 s52, 81920
    buffer_load_dwordx4 v[72:75], v3, s[44:47], s52 offen sc1
    s_mov_b32 s52, 102400
    buffer_load_dwordx4 v[76:79], v3, s[44:47], s52 offen sc1
    s_mov_b32 s52, 122880
    buffer_load_dwordx4 v[80:83], v3, s[44:47], s52 offen sc1
    s_mov_b32 s52, 143360
    buffer_load_dwordx4 v[84:87], v3, s[44:47], s52 offen sc1
    s_mov_b32 s52, 163840
    buffer_load_dwordx4 v[88:91], v3, s[44:47], s52 offen sc1
    s_mov_b32 s52, 184320
    buffer_load_dwordx4 v[92:95], v3, s[44:47], s52 offen sc1
    s_mov_b32 s52, 204800
    buffer_load_dwordx4 v[96:99], v3, s[44:47], s52 offen sc1
    s_mov_b32 s52, 225280
    buffer_load_dwordx4 v[100:103], v3, s[44:47], s52 offen sc1
    s_mov_b32 s52, 245760
    buffer_load_dwordx4 v[104:107], v3, s[44:47], s52 offen sc1
    s_mov_b32 s52, 266240
    buffer_load_dwordx4 v[108:111], v3, s[44:47], s52 offen sc1
    s_waitcnt vmcnt(12)
    v_add_f32 v52, v56, v60
    v_add_f32 v53, v57, v61
    v_add_f32 v54, v58, v62
    v_add_f32 v55, v59, v63
    s_waitcnt vmcnt(11)
    v_add_f32 v52, v52, v64
    v_add_f32 v53, v53, v65
    v_add_f32 v54, v54, v66
    v_add_f32 v55, v55, v67
    s_waitcnt vmcnt(10)
    v_add_f32 v52, v52, v68
    v_add_f32 v53, v53, v69
    v_add_f32 v54, v54, v70
    v_add_f32 v55, v55, v71
    s_waitcnt vmcnt(9)
    v_add_f32 v52, v52, v72
    v_add_f32 v53, v53, v73
    v_add_f32 v54, v54, v74
    v_add_f32 v55, v55, v75
    s_waitcnt vmcnt(8)
    v_add_f32 v52, v52, v76
    v_add_f32 v53, v53, v77
    v_add_f32 v54, v54, v78
    v_add_f32 v55, v55, v79
    s_waitcnt vmcnt(7)
    v_add_f32 v52, v52, v80
    v_add_f32 v53, v53, v81
    v_add_f32 v54, v54, v82
    v_add_f32 v55, v55, v83
    s_waitcnt vmcnt(6)
    v_add_f32 v52, v52, v84
    v_add_f32 v53, v53, v85
    v_add_f32 v54, v54, v86
    v_add_f32 v55, v55, v87
    s_waitcnt vmcnt(5)
    v_add_f32 v52, v52, v88
    v_add_f32 v53, v53, v89
    v_add_f32 v54, v54, v90
    v_add_f32 v55, v55, v91
    s_waitcnt vmcnt(4)
    v_add_f32 v52, v52, v92
    v_add_f32 v53, v53, v93
    v_add_f32 v54, v54, v94
    v_add_f32 v55, v55, v95
    s_waitcnt vmcnt(3)
    v_add_f32 v52, v52, v96
    v_add_f32 v53, v53, v97
    v_add_f32 v54, v54, v98
    v_add_f32 v55, v55, v99
    s_waitcnt vmcnt(2)
    v_add_f32 v52, v52, v100
    v_add_f32 v53, v53, v101
    v_add_f32 v54, v54, v102
    v_add_f32 v55, v55, v103
    s_waitcnt vmcnt(1)
    v_add_f32 v52, v52, v104
    v_add_f32 v53, v53, v105
    v_add_f32 v54, v54, v106
    v_add_f32 v55, v55, v107
    s_waitcnt vmcnt(0)
    v_add_f32 v52, v52, v108
    v_add_f32 v53, v53, v109
    v_add_f32 v54, v54, v110
    v_add_f32 v55, v55, v111
    v_mov_b32 v56, v52
    v_mov_b32 v57, v53
    v_mov_b32 v58, v54
    v_mov_b32 v59, v55
    s_nop 0
    v_permlane16_swap_b32 v52, v56
    v_permlane16_swap_b32 v53, v57
    v_permlane16_swap_b32 v54, v58
    v_permlane16_swap_b32 v55, v59
    v_add_f32 v52, v52, v56
    v_add_f32 v53, v53, v57
    v_add_f32 v54, v54, v58
    v_add_f32 v55, v55, v59
    v_mov_b32 v56, v52
    v_mov_b32 v57, v53
    v_mov_b32 v58, v54
    v_mov_b32 v59, v55
    s_nop 0
    v_permlane32_swap_b32 v52, v56
    v_permlane32_swap_b32 v53, v57
    v_permlane32_swap_b32 v54, v58
    v_permlane32_swap_b32 v55, v59
    v_add_f32 v52, v52, v56
    v_add_f32 v53, v53, v57
    v_add_f32 v54, v54, v58
    v_add_f32 v55, v55, v59
    v_cvt_pk_bf16_f32 v52, v52, v52
    v_lshlrev_b32 v52, 16, v52
    v_mul_f32 v52, v5, v52
    v_cvt_pk_bf16_f32 v52, v52, v52
    v_lshlrev_b32 v52, 16, v52
    v_cvt_pk_bf16_f32 v53, v53, v53
    v_lshlrev_b32 v53, 16, v53
    v_mul_f32 v53, v5, v53
    v_cvt_pk_bf16_f32 v53, v53, v53
    v_lshlrev_b32 v53, 16, v53
    v_cvt_pk_bf16_f32 v54, v54, v54
    v_lshlrev_b32 v54, 16, v54
    v_mul_f32 v54, v5, v54
    v_cvt_pk_bf16_f32 v54, v54, v54
    v_lshlrev_b32 v54, 16, v54
    v_cvt_pk_bf16_f32 v55, v55, v55
    v_lshlrev_b32 v55, 16, v55
    v_mul_f32 v55, v5, v55
    v_cvt_pk_bf16_f32 v55, v55, v55
    v_lshlrev_b32 v55, 16, v55
    s_lshl_b32 s3, s61, 8
    s_add_u32 s3, s3, 158976
    v_add_u32 v2, s3, v2
    ds_write_b128 v2, v[52:55]
    s_branch K_P2_E
K_STM31:
    s_branch K_WRET_M
K_STA31:
    s_branch K_WRET_A
K_P2_FLAGS:
    s_mov_b32 exec_hi, 0
    s_waitcnt vmcnt(0)
    s_mov_b32 s3, 131072
K_P2_FCHK:
    v_cmp_eq_u32 vcc, 1, v7
    s_nop 1
    v_mov_b32 v2, vcc_lo
    ds_write_b32 v15, v2 offset:32
    s_cmp_eq_u32 vcc_lo, -1
    s_cbranch_scc1 K_P2_FGO
    s_cmp_lg_u32 vcc_lo, 0
    s_cbranch_scc1 K_P2_FS
    s_sleep 16
K_P2_FS:
    s_sleep 6
    global_load_dword v7, v12, s[6:7] sc1
    s_sub_u32 s3, s3, 1
    s_waitcnt vmcnt(0)
    s_cbranch_scc0 K_P2_FCHK
    v_mov_b32 v2, -1
    ds_write_b32 v15, v2 offset:32
K_P2_FGO:
    s_mov_b64 exec, -1
    buffer_load_dwordx4 v[16:19], v10, s[12:15], 0 offen
    buffer_load_dwordx4 v[20:23], v10, s[12:15], s55 offen
    s_mov_b32 s3, 1048576
K_P2_GS3:
    ds_read_b32 v2, v15 offset:40
    s_sleep 1
    s_sub_u32 s3, s3, 1
    s_waitcnt lgkmcnt(0)
    v_readfirstlane_b32 s33, v2
    s_nop 3
    s_cselect_b32 s33, 1, s33
    s_cmp_lt_u32 s33, 1
    s_cbranch_scc1 K_P2_GS3
    buffer_load_dword v24, v11, s[16:19], 0 offen sc1
    buffer_load_dword v25, v11, s[16:19], 0 offen offset:32 sc1
    ds_read_b128 v[28:31], v15
K_P2_E:
    s_setprio 0
    s_waitcnt vmcnt(0)
    v_sub_f32 v48, 1.0, v24
    v_cvt_pk_bf16_f32 v48, v48, v48
    v_lshlrev_b32 v48, 16, v48
    v_sub_f32 v49, 1.0, v25
    v_cvt_pk_bf16_f32 v49, v49, v49
    v_lshlrev_b32 v49, 16, v49
    v_lshlrev_b32 v32, 16, v16
    v_and_b32 v33, 0xffff0000, v16
    v_lshlrev_b32 v34, 16, v17
    v_and_b32 v35, 0xffff0000, v17
    v_lshlrev_b32 v36, 16, v18
    v_and_b32 v37, 0xffff0000, v18
    v_lshlrev_b32 v38, 16, v19
    v_and_b32 v39, 0xffff0000, v19
    v_lshlrev_b32 v40, 16, v20
    v_and_b32 v41, 0xffff0000, v20
    v_lshlrev_b32 v42, 16, v21
    v_and_b32 v43, 0xffff0000, v21
    v_lshlrev_b32 v44, 16, v22
    v_and_b32 v45, 0xffff0000, v22
    v_lshlrev_b32 v46, 16, v23
    v_and_b32 v47, 0xffff0000, v23
    v_mul_f32 v32, v32, v48
    v_mul_f32 v33, v33, v48
    v_mul_f32 v34, v34, v48
    v_mul_f32 v35, v35, v48
    v_mul_f32 v36, v36, v48
    v_mul_f32 v37, v37, v48
    v_mul_f32 v38, v38, v48
    v_mul_f32 v39, v39, v48
    v_mul_f32 v40, v40, v49
    v_mul_f32 v41, v41, v49
    v_mul_f32 v42, v42, v49
    v_mul_f32 v43, v43, v49
    v_mul_f32 v44, v44, v49
    v_mul_f32 v45, v45, v49
    v_mul_f32 v46, v46, v49
    v_mul_f32 v47, v47, v49
    s_branch K_P2_E2
K_CHEND:
K_AUX:
    s_load_dwordx8 s[44:51], s[0:1], 32
    s_load_dwordx2 s[52:53], s[0:1], 64
    s_mov_b32 s36, 4
    s_mul_i32 s43, s28, 7
    s_add_u32 s43, s43, s29
    s_sub_u32 s43, s43, 1
    s_cmp_lt_u32 s43, 54
    s_cselect_b32 s43, s43, 63
    s_cmp_eq_u32 s29, 0
    s_cselect_b32 s43, 63, s43
    s_lshl_b32 s3, s28, 8
    s_lshl_b32 s68, s30, 5
    s_add_u32 s3, s3, s68
    v_lshrrev_b32 v8, 3, v1
    v_add_u32 v8, s3, v8
    v_and_b32 v10, 7, v1
    v_lshlrev_b32 v10, 4, v10
    v_mul_u32_u24 v9, 1280, v8
    v_add_u32 v9, v9, v10
    s_waitcnt lgkmcnt(0)
    s_mov_b32 s16, s44
    s_mov_b32 s17, s45
    s_mov_b32 s18, 0x500
    s_mov_b32 s19, 0x20000
    s_mov_b32 s20, s52
    s_mov_b32 s21, s53
    s_mov_b32 s22, 0x500
    s_mov_b32 s23, 0x20000
    s_mov_b32 s24, s8
    s_mov_b32 s25, s9
    s_mov_b32 s26, 0xc8000
    s_mov_b32 s27, 0x20000
    s_cmp_lg_u32 s2, 63
    s_cbranch_scc1 K_AUX_NOZ
    s_add_u32 s56, s6, 0x80000
    s_addc_u32 s57, s7, 0
    s_mov_b32 s58, 0xa800
    s_mov_b32 s59, 0x20000
    v_lshlrev_b32 v2, 4, v0
    v_mov_b32 v12, 0
    v_mov_b32 v13, 0
    v_mov_b32 v14, 0
    v_mov_b32 v15, 0
    s_mov_b32 s3, 0
    buffer_store_dwordx4 v[12:15], v2, s[56:59], s3 offen sc1
    s_mov_b32 s3, 8192
    buffer_store_dwordx4 v[12:15], v2, s[56:59], s3 offen sc1
    s_mov_b32 s3, 16384
    buffer_store_dwordx4 v[12:15], v2, s[56:59], s3 offen sc1
    s_mov_b32 s3, 24576
    buffer_store_dwordx4 v[12:15], v2, s[56:59], s3 offen sc1
    s_mov_b32 s3, 32768
    buffer_store_dwordx4 v[12:15], v2, s[56:59], s3 offen sc1
    s_mov_b32 s3, 40960
    buffer_store_dwordx4 v[12:15], v2, s[56:59], s3 offen sc1
    v_mov_b32 v2, 192
    v_mov_b32 v3, 1
    s_waitcnt vmcnt(0)
    s_barrier
    s_cmp_lg_u32 s30, 0
    s_cbranch_scc1 K_AUX_NOZ
    s_mov_b64 exec, 1
    global_store_dword v2, v3, s[4:5] sc1
    s_mov_b64 exec, -1
K_AUX_NOZ:
    s_cmp_lg_u32 s29, 0
    s_cbranch_scc1 K_AUX_FFN0
    v_lshlrev_b32 v2, 4, v1
    s_cmp_ge_u32 s30, 2
    s_cbranch_scc1 K_AUX_R1
    s_cmp_eq_u32 s30, 1
    s_cbranch_scc1 K_AUX_R0
    s_mov_b32 m0, 126016
    s_nop 0
    buffer_load_dwordx4 v2, s[16:19], 0 offen lds
    buffer_load_dwordx4 v2, s[16:19], 0 offen offset:1024 lds
    s_branch K_AUX_R1
K_AUX_R0:
    s_mov_b32 m0, 128064
    s_nop 0
    buffer_load_dwordx4 v2, s[20:23], 0 offen lds
    buffer_load_dwordx4 v2, s[20:23], 0 offen offset:1024 lds
K_AUX_R1:
    s_mov_b32 s68, 10240
    s_mov_b32 s69, 20480
    s_mov_b32 s70, 30720
    v_add_u32 v10, 126016, v10
    buffer_load_dwordx4 v[12:15], v9, s[12:15], 0 offen offset:0
    buffer_load_dwordx4 v[16:19], v9, s[12:15], s68 offen offset:0
    buffer_load_dwordx4 v[20:23], v9, s[12:15], s69 offen offset:0
    buffer_load_dwordx4 v[24:27], v9, s[12:15], s70 offen offset:0
    buffer_load_dwordx4 v[28:31], v9, s[12:15], 0 offen offset:128
    buffer_load_dwordx4 v[32:35], v9, s[12:15], s68 offen offset:128
    buffer_load_dwordx4 v[36:39], v9, s[12:15], s69 offen offset:128
    buffer_load_dwordx4 v[40:43], v9, s[12:15], s70 offen offset:128
    s_waitcnt vmcnt(8)
    s_barrier
    buffer_load_dwordx4 v[44:47], v9, s[12:15], 0 offen offset:256
    buffer_load_dwordx4 v[48:51], v9, s[12:15], s68 offen offset:256
    buffer_load_dwordx4 v[52:55], v9, s[12:15], s69 offen offset:256
    buffer_load_dwordx4 v[56:59], v9, s[12:15], s70 offen offset:256
    buffer_load_dwordx4 v[60:63], v9, s[12:15], 0 offen offset:384
    buffer_load_dwordx4 v[64:67], v9, s[12:15], s68 offen offset:384
    buffer_load_dwordx4 v[68:71], v9, s[12:15], s69 offen offset:384
    buffer_load_dwordx4 v[72:75], v9, s[12:15], s70 offen offset:384
    buffer_load_dwordx4 v[76:79], v9, s[12:15], 0 offen offset:512
    buffer_load_dwordx4 v[80:83], v9, s[12:15], s68 offen offset:512
    buffer_load_dwordx4 v[84:87], v9, s[12:15], s69 offen offset:512
    buffer_load_dwordx4 v[88:91], v9, s[12:15], s70 offen offset:512
    buffer_load_dwordx4 v[92:95], v9, s[12:15], 0 offen offset:640
    buffer_load_dwordx4 v[96:99], v9, s[12:15], s68 offen offset:640
    buffer_load_dwordx4 v[100:103], v9, s[12:15], s69 offen offset:640
    buffer_load_dwordx4 v[104:107], v9, s[12:15], s70 offen offset:640
    buffer_load_dwordx4 v[108:111], v9, s[12:15], 0 offen offset:768
    buffer_load_dwordx4 v[112:115], v9, s[12:15], s68 offen offset:768
    buffer_load_dwordx4 v[116:119], v9, s[12:15], s69 offen offset:768
    buffer_load_dwordx4 v[120:123], v9, s[12:15], s70 offen offset:768
    buffer_load_dwordx4 v[124:127], v9, s[12:15], 0 offen offset:896
    buffer_load_dwordx4 v[128:131], v9, s[12:15], s68 offen offset:896
    buffer_load_dwordx4 v[132:135], v9, s[12:15], s69 offen offset:896
    buffer_load_dwordx4 v[136:139], v9, s[12:15], s70 offen offset:896
    buffer_load_dwordx4 v[140:143], v9, s[12:15], 0 offen offset:1024
    buffer_load_dwordx4 v[144:147], v9, s[12:15], s68 offen offset:1024
    buffer_load_dwordx4 v[148:151], v9, s[12:15], s69 offen offset:1024
    buffer_load_dwordx4 v[152:155], v9, s[12:15], s70 offen offset:1024
    buffer_load_dwordx4 v[156:159], v9, s[12:15], 0 offen offset:1152
    buffer_load_dwordx4 v[160:163], v9, s[12:15], s68 offen offset:1152
    buffer_load_dwordx4 v[164:167], v9, s[12:15], s69 offen offset:1152
    buffer_load_dwordx4 v[168:171], v9, s[12:15], s70 offen offset:1152
    v_mov_b32 v2, 192
    global_load_dword v7, v2, s[4:5] sc1
    v_mov_b32 v188, 0
    v_mov_b32 v192, 0
    v_mov_b32 v189, 0
    v_mov_b32 v193, 0
    v_mov_b32 v190, 0
    v_mov_b32 v194, 0
    v_mov_b32 v191, 0
    v_mov_b32 v195, 0
    ds_read_b128 v[172:175], v10 offset:0
    ds_read_b128 v[176:179], v10 offset:128
    s_waitcnt vmcnt(37) lgkmcnt(1)
    v_dot2c_f32_bf16 v188, v12, v172
    v_dot2c_f32_bf16 v189, v16, v172
    v_dot2c_f32_bf16 v190, v20, v172
    v_dot2c_f32_bf16 v191, v24, v172
    v_dot2c_f32_bf16 v188, v13, v173
    v_dot2c_f32_bf16 v189, v17, v173
    v_dot2c_f32_bf16 v190, v21, v173
    v_dot2c_f32_bf16 v191, v25, v173
    v_dot2c_f32_bf16 v188, v14, v174
    v_dot2c_f32_bf16 v189, v18, v174
    v_dot2c_f32_bf16 v190, v22, v174
    v_dot2c_f32_bf16 v191, v26, v174
    v_dot2c_f32_bf16 v188, v15, v175
    v_dot2c_f32_bf16 v189, v19, v175
    v_dot2c_f32_bf16 v190, v23, v175
    v_dot2c_f32_bf16 v191, v27, v175
    ds_read_b128 v[172:175], v10 offset:256
    s_waitcnt vmcnt(33) lgkmcnt(1)
    v_dot2c_f32_bf16 v188, v28, v176
    v_dot2c_f32_bf16 v189, v32, v176
    v_dot2c_f32_bf16 v190, v36, v176
    v_dot2c_f32_bf16 v191, v40, v176
    v_dot2c_f32_bf16 v188, v29, v177
    v_dot2c_f32_bf16 v189, v33, v177
    v_dot2c_f32_bf16 v190, v37, v177
    v_dot2c_f32_bf16 v191, v41, v177
    v_dot2c_f32_bf16 v188, v30, v178
    v_dot2c_f32_bf16 v189, v34, v178
    v_dot2c_f32_bf16 v190, v38, v178
    v_dot2c_f32_bf16 v191, v42, v178
    v_dot2c_f32_bf16 v188, v31, v179
    v_dot2c_f32_bf16 v189, v35, v179
    v_dot2c_f32_bf16 v190, v39, v179
    v_dot2c_f32_bf16 v191, v43, v179
    ds_read_b128 v[176:179], v10 offset:384
    s_waitcnt vmcnt(29) lgkmcnt(1)
    v_dot2c_f32_bf16 v188, v44, v172
    v_dot2c_f32_bf16 v189, v48, v172
    v_dot2c_f32_bf16 v190, v52, v172
    v_dot2c_f32_bf16 v191, v56, v172
    v_dot2c_f32_bf16 v188, v45, v173
    v_dot2c_f32_bf16 v189, v49, v173
    v_dot2c_f32_bf16 v190, v53, v173
    v_dot2c_f32_bf16 v191, v57, v173
    v_dot2c_f32_bf16 v188, v46, v174
    v_dot2c_f32_bf16 v189, v50, v174
    v_dot2c_f32_bf16 v190, v54, v174
    v_dot2c_f32_bf16 v191, v58, v174
    v_dot2c_f32_bf16 v188, v47, v175
    v_dot2c_f32_bf16 v189, v51, v175
    v_dot2c_f32_bf16 v190, v55, v175
    v_dot2c_f32_bf16 v191, v59, v175
    ds_read_b128 v[172:175], v10 offset:512
    s_waitcnt vmcnt(25) lgkmcnt(1)
    v_dot2c_f32_bf16 v188, v60, v176
    v_dot2c_f32_bf16 v189, v64, v176
    v_dot2c_f32_bf16 v190, v68, v176
    v_dot2c_f32_bf16 v191, v72, v176
    v_dot2c_f32_bf16 v188, v61, v177
    v_dot2c_f32_bf16 v189, v65, v177
    v_dot2c_f32_bf16 v190, v69, v177
    v_dot2c_f32_bf16 v191, v73, v177
    v_dot2c_f32_bf16 v188, v62, v178
    v_dot2c_f32_bf16 v189, v66, v178
    v_dot2c_f32_bf16 v190, v70, v178
    v_dot2c_f32_bf16 v191, v74, v178
    v_dot2c_f32_bf16 v188, v63, v179
    v_dot2c_f32_bf16 v189, v67, v179
    v_dot2c_f32_bf16 v190, v71, v179
    v_dot2c_f32_bf16 v191, v75, v179
    ds_read_b128 v[176:179], v10 offset:640
    s_waitcnt vmcnt(21) lgkmcnt(1)
    v_dot2c_f32_bf16 v188, v76, v172
    v_dot2c_f32_bf16 v189, v80, v172
    v_dot2c_f32_bf16 v190, v84, v172
    v_dot2c_f32_bf16 v191, v88, v172
    v_dot2c_f32_bf16 v188, v77, v173
    v_dot2c_f32_bf16 v189, v81, v173
    v_dot2c_f32_bf16 v190, v85, v173
    v_dot2c_f32_bf16 v191, v89, v173
    v_dot2c_f32_bf16 v188, v78, v174
    v_dot2c_f32_bf16 v189, v82, v174
    v_dot2c_f32_bf16 v190, v86, v174
    v_dot2c_f32_bf16 v191, v90, v174
    v_dot2c_f32_bf16 v188, v79, v175
    v_dot2c_f32_bf16 v189, v83, v175
    v_dot2c_f32_bf16 v190, v87, v175
    v_dot2c_f32_bf16 v191, v91, v175
    ds_read_b128 v[172:175], v10 offset:768
    s_waitcnt vmcnt(17) lgkmcnt(1)
    v_dot2c_f32_bf16 v188, v92, v176
    v_dot2c_f32_bf16 v189, v96, v176
    v_dot2c_f32_bf16 v190, v100, v176
    v_dot2c_f32_bf16 v191, v104, v176
    v_dot2c_f32_bf16 v188, v93, v177
    v_dot2c_f32_bf16 v189, v97, v177
    v_dot2c_f32_bf16 v190, v101, v177
    v_dot2c_f32_bf16 v191, v105, v177
    v_dot2c_f32_bf16 v188, v94, v178
    v_dot2c_f32_bf16 v189, v98, v178
    v_dot2c_f32_bf16 v190, v102, v178
    v_dot2c_f32_bf16 v191, v106, v178
    v_dot2c_f32_bf16 v188, v95, v179
    v_dot2c_f32_bf16 v189, v99, v179
    v_dot2c_f32_bf16 v190, v103, v179
    v_dot2c_f32_bf16 v191, v107, v179
    ds_read_b128 v[176:179], v10 offset:896
    s_waitcnt vmcnt(13) lgkmcnt(1)
    v_dot2c_f32_bf16 v188, v108, v172
    v_dot2c_f32_bf16 v189, v112, v172
    v_dot2c_f32_bf16 v190, v116, v172
    v_dot2c_f32_bf16 v191, v120, v172
    v_dot2c_f32_bf16 v188, v109, v173
    v_dot2c_f32_bf16 v189, v113, v173
    v_dot2c_f32_bf16 v190, v117, v173
    v_dot2c_f32_bf16 v191, v121, v173
    v_dot2c_f32_bf16 v188, v110, v174
    v_dot2c_f32_bf16 v189, v114, v174
    v_dot2c_f32_bf16 v190, v118, v174
    v_dot2c_f32_bf16 v191, v122, v174
    v_dot2c_f32_bf16 v188, v111, v175
    v_dot2c_f32_bf16 v189, v115, v175
    v_dot2c_f32_bf16 v190, v119, v175
    v_dot2c_f32_bf16 v191, v123, v175
    ds_read_b128 v[172:175], v10 offset:1024
    s_waitcnt vmcnt(9) lgkmcnt(1)
    v_dot2c_f32_bf16 v188, v124, v176
    v_dot2c_f32_bf16 v189, v128, v176
    v_dot2c_f32_bf16 v190, v132, v176
    v_dot2c_f32_bf16 v191, v136, v176
    v_dot2c_f32_bf16 v188, v125, v177
    v_dot2c_f32_bf16 v189, v129, v177
    v_dot2c_f32_bf16 v190, v133, v177
    v_dot2c_f32_bf16 v191, v137, v177
    v_dot2c_f32_bf16 v188, v126, v178
    v_dot2c_f32_bf16 v189, v130, v178
    v_dot2c_f32_bf16 v190, v134, v178
    v_dot2c_f32_bf16 v191, v138, v178
    v_dot2c_f32_bf16 v188, v127, v179
    v_dot2c_f32_bf16 v189, v131, v179
    v_dot2c_f32_bf16 v190, v135, v179
    v_dot2c_f32_bf16 v191, v139, v179
    ds_read_b128 v[176:179], v10 offset:1152
    s_waitcnt vmcnt(5) lgkmcnt(1)
    v_dot2c_f32_bf16 v188, v140, v172
    v_dot2c_f32_bf16 v189, v144, v172
    v_dot2c_f32_bf16 v190, v148, v172
    v_dot2c_f32_bf16 v191, v152, v172
    v_dot2c_f32_bf16 v188, v141, v173
    v_dot2c_f32_bf16 v189, v145, v173
    v_dot2c_f32_bf16 v190, v149, v173
    v_dot2c_f32_bf16 v191, v153, v173
    v_dot2c_f32_bf16 v188, v142, v174
    v_dot2c_f32_bf16 v189, v146, v174
    v_dot2c_f32_bf16 v190, v150, v174
    v_dot2c_f32_bf16 v191, v154, v174
    v_dot2c_f32_bf16 v188, v143, v175
    v_dot2c_f32_bf16 v189, v147, v175
    v_dot2c_f32_bf16 v190, v151, v175
    v_dot2c_f32_bf16 v191, v155, v175
    s_waitcnt vmcnt(0) lgkmcnt(0)
    v_dot2c_f32_bf16 v188, v156, v176
    v_dot2c_f32_bf16 v189, v160, v176
    v_dot2c_f32_bf16 v190, v164, v176
    v_dot2c_f32_bf16 v191, v168, v176
    v_dot2c_f32_bf16 v188, v157, v177
    v_dot2c_f32_bf16 v189, v161, v177
    v_dot2c_f32_bf16 v190, v165, v177
    v_dot2c_f32_bf16 v191, v169, v177
    v_dot2c_f32_bf16 v188, v158, v178
    v_dot2c_f32_bf16 v189, v162, v178
    v_dot2c_f32_bf16 v190, v166, v178
    v_dot2c_f32_bf16 v191, v170, v178
    v_dot2c_f32_bf16 v188, v159, v179
    v_dot2c_f32_bf16 v189, v163, v179
    v_dot2c_f32_bf16 v190, v167, v179
    v_dot2c_f32_bf16 v191, v171, v179
    s_nop 2
    v_add_f32_dpp v188, v188, v188 quad_perm:[1,0,3,2] row_mask:0xf bank_mask:0xf
    v_add_f32_dpp v189, v189, v189 quad_perm:[1,0,3,2] row_mask:0xf bank_mask:0xf
    v_add_f32_dpp v190, v190, v190 quad_perm:[1,0,3,2] row_mask:0xf bank_mask:0xf
    v_add_f32_dpp v191, v191, v191 quad_perm:[1,0,3,2] row_mask:0xf bank_mask:0xf
    v_add_f32_dpp v188, v188, v188 quad_perm:[2,3,0,1] row_mask:0xf bank_mask:0xf
    v_add_f32_dpp v189, v189, v189 quad_perm:[2,3,0,1] row_mask:0xf bank_mask:0xf
    v_add_f32_dpp v190, v190, v190 quad_perm:[2,3,0,1] row_mask:0xf bank_mask:0xf
    v_add_f32_dpp v191, v191, v191 quad_perm:[2,3,0,1] row_mask:0xf bank_mask:0xf
    v_add_f32_dpp v188, v188, v188 row_half_mirror row_mask:0xf bank_mask:0xf
    v_add_f32_dpp v189, v189, v189 row_half_mirror row_mask:0xf bank_mask:0xf
    v_add_f32_dpp v190, v190, v190 row_half_mirror row_mask:0xf bank_mask:0xf
    v_add_f32_dpp v191, v191, v191 row_half_mirror row_mask:0xf bank_mask:0xf
    v_and_b32 v180, 255, v8
    v_lshlrev_b32 v180, 2, v180
    v_add_u32 v180, 122880, v180
    v_cvt_pk_bf16_f32 v2, v188, v188
    v_lshlrev_b32 v2, 16, v2
    v_ashrrev_i32 v3, 31, v2
    v_or_b32 v3, 0x80000000, v3
    v_xor_b32 v2, v2, v3
    v_and_b32 v2, 0xffff0000, v2
    v_sub_u32 v3, 0x87ff, v8
    v_or_b32 v188, v2, v3
    ds_write_b32 v180, v188 offset:0
    v_cvt_pk_bf16_f32 v2, v189, v189
    v_lshlrev_b32 v2, 16, v2
    v_ashrrev_i32 v3, 31, v2
    v_or_b32 v3, 0x80000000, v3
    v_xor_b32 v2, v2, v3
    v_and_b32 v2, 0xffff0000, v2
    v_sub_u32 v3, 0x87f7, v8
    v_or_b32 v189, v2, v3
    ds_write_b32 v180, v189 offset:32
    v_cvt_pk_bf16_f32 v2, v190, v190
    v_lshlrev_b32 v2, 16, v2
    v_ashrrev_i32 v3, 31, v2
    v_or_b32 v3, 0x80000000, v3
    v_xor_b32 v2, v2, v3
    v_and_b32 v2, 0xffff0000, v2
    v_sub_u32 v3, 0x87ef, v8
    v_or_b32 v190, v2, v3
    ds_write_b32 v180, v190 offset:64
    v_cvt_pk_bf16_f32 v2, v191, v191
    v_lshlrev_b32 v2, 16, v2
    v_ashrrev_i32 v3, 31, v2
    s_branch K_PG6
.p2align 12
K_PG6:
    v_or_b32 v3, 0x80000000, v3
    v_xor_b32 v2, v2, v3
    v_and_b32 v2, 0xffff0000, v2
    v_sub_u32 v3, 0x87e7, v8
    v_or_b32 v191, v2, v3
    ds_write_b32 v180, v191 offset:96
    s_waitcnt lgkmcnt(0)
    s_barrier
    s_cmp_lg_u32 s30, 0
    s_cbranch_scc1 K_AUX_G0
    s_setprio 3
    v_lshlrev_b32 v3, 4, v1
    v_add_u32 v3, 122880, v3
    ds_read_b128 v[196:199], v3
    s_waitcnt lgkmcnt(0)
    v_max_u32 v2, v196, v197
    v_min_u32 v3, v196, v197
    v_max_u32 v4, v198, v199
    v_min_u32 v5, v198, v199
    v_max_u32 v3, v3, v5
    v_min_u32 v5, v2, v4
    v_max_u32 v2, v2, v4
    v_max_u32 v4, v3, v5
    s_nop 1
    v_max_u32_dpp v3, v2, v2 quad_perm:[1,0,3,2] row_mask:0xf bank_mask:0xf
    s_nop 1
    v_max_u32_dpp v3, v3, v3 quad_perm:[2,3,0,1] row_mask:0xf bank_mask:0xf
    s_nop 1
    v_max_u32_dpp v3, v3, v3 row_half_mirror row_mask:0xf bank_mask:0xf
    s_nop 1
    v_max_u32_dpp v3, v3, v3 row_mirror row_mask:0xf bank_mask:0xf
    s_nop 1
    v_readlane_b32 s70, v3, 0
    v_readlane_b32 s72, v3, 16
    v_readlane_b32 s73, v3, 32
    v_readlane_b32 s74, v3, 48
    s_nop 3
    s_max_u32 s70, s70, s72
    s_max_u32 s73, s73, s74
    s_max_u32 s70, s70, s73
    v_cmp_ne_u32 vcc, s70, v2
    s_nop 1
    v_cndmask_b32 v2, v4, v2, vcc
    s_nop 1
    v_max_u32_dpp v3, v2, v2 quad_perm:[1,0,3,2] row_mask:0xf bank_mask:0xf
    s_nop 1
    v_max_u32_dpp v3, v3, v3 quad_perm:[2,3,0,1] row_mask:0xf bank_mask:0xf
    s_nop 1
    v_max_u32_dpp v3, v3, v3 row_half_mirror row_mask:0xf bank_mask:0xf
    s_nop 1
    v_max_u32_dpp v3, v3, v3 row_mirror row_mask:0xf bank_mask:0xf
    s_nop 1
    v_readlane_b32 s71, v3, 0
    v_readlane_b32 s72, v3, 16
    v_readlane_b32 s73, v3, 32
    v_readlane_b32 s74, v3, 48
    s_nop 3
    s_max_u32 s71, s71, s72
    s_max_u32 s73, s73, s74
    s_max_u32 s71, s71, s73
    v_mov_b32 v196, s70
    v_mov_b32 v197, s71
    v_mov_b32 v4, 192
    s_mov_b32 s3, 131072
K_ZPOLL3:
    v_readfirstlane_b32 s33, v7
    s_nop 3
    s_sub_u32 s3, s3, 1
    s_cselect_b32 s33, 1, s33
    s_cmp_lg_u32 s33, 0
    s_cbranch_scc1 K_ZOK3
    global_load_dword v7, v4, s[4:5] sc1
    s_waitcnt vmcnt(0)
    s_branch K_ZPOLL3
K_ZOK3:
    s_add_u32 s60, s6, 0x80000
    s_addc_u32 s61, s7, 0
    s_mov_b32 s62, 0xa000
    s_mov_b32 s63, 0x20000
    s_lshl_b32 s3, s28, 3
    v_lshl_add_u32 v3, v1, 8, s3
    s_mov_b32 s3, 0
    buffer_store_dwordx2 v[196:197], v3, s[60:63], s3 offen offset:128 sc1
    s_mov_b32 s3, 16384
    buffer_store_dwordx2 v[196:197], v3, s[60:63], s3 offen offset:128 sc1
    s_mov_b32 s3, 32768
    buffer_store_dwordx2 v[196:197], v3, s[60:63], s3 offen offset:128 sc1
    s_setprio 0
K_AUX_G0:
    ds_read_b128 v[172:175], v10 offset:2048
    ds_read_b128 v[176:179], v10 offset:2176
    s_waitcnt lgkmcnt(1)
    v_dot2c_f32_bf16 v192, v12, v172
    v_dot2c_f32_bf16 v193, v16, v172
    v_dot2c_f32_bf16 v194, v20, v172
    v_dot2c_f32_bf16 v195, v24, v172
    v_dot2c_f32_bf16 v192, v13, v173
    v_dot2c_f32_bf16 v193, v17, v173
    v_dot2c_f32_bf16 v194, v21, v173
    v_dot2c_f32_bf16 v195, v25, v173
    v_dot2c_f32_bf16 v192, v14, v174
    v_dot2c_f32_bf16 v193, v18, v174
    v_dot2c_f32_bf16 v194, v22, v174
    v_dot2c_f32_bf16 v195, v26, v174
    v_dot2c_f32_bf16 v192, v15, v175
    v_dot2c_f32_bf16 v193, v19, v175
    v_dot2c_f32_bf16 v194, v23, v175
    v_dot2c_f32_bf16 v195, v27, v175
    ds_read_b128 v[172:175], v10 offset:2304
    s_waitcnt lgkmcnt(1)
    v_dot2c_f32_bf16 v192, v28, v176
    v_dot2c_f32_bf16 v193, v32, v176
    v_dot2c_f32_bf16 v194, v36, v176
    v_dot2c_f32_bf16 v195, v40, v176
    v_dot2c_f32_bf16 v192, v29, v177
    v_dot2c_f32_bf16 v193, v33, v177
    v_dot2c_f32_bf16 v194, v37, v177
    v_dot2c_f32_bf16 v195, v41, v177
    v_dot2c_f32_bf16 v192, v30, v178
    v_dot2c_f32_bf16 v193, v34, v178
    v_dot2c_f32_bf16 v194, v38, v178
    v_dot2c_f32_bf16 v195, v42, v178
    v_dot2c_f32_bf16 v192, v31, v179
    v_dot2c_f32_bf16 v193, v35, v179
    v_dot2c_f32_bf16 v194, v39, v179
    v_dot2c_f32_bf16 v195, v43, v179
    ds_read_b128 v[176:179], v10 offset:2432
    s_waitcnt lgkmcnt(1)
    v_dot2c_f32_bf16 v192, v44, v172
    v_dot2c_f32_bf16 v193, v48, v172
    v_dot2c_f32_bf16 v194, v52, v172
    v_dot2c_f32_bf16 v195, v56, v172
    v_dot2c_f32_bf16 v192, v45, v173
    v_dot2c_f32_bf16 v193, v49, v173
    v_dot2c_f32_bf16 v194, v53, v173
    v_dot2c_f32_bf16 v195, v57, v173
    v_dot2c_f32_bf16 v192, v46, v174
    v_dot2c_f32_bf16 v193, v50, v174
    v_dot2c_f32_bf16 v194, v54, v174
    v_dot2c_f32_bf16 v195, v58, v174
    v_dot2c_f32_bf16 v192, v47, v175
    v_dot2c_f32_bf16 v193, v51, v175
    v_dot2c_f32_bf16 v194, v55, v175
    v_dot2c_f32_bf16 v195, v59, v175
    ds_read_b128 v[172:175], v10 offset:2560
    s_waitcnt lgkmcnt(1)
    v_dot2c_f32_bf16 v192, v60, v176
    v_dot2c_f32_bf16 v193, v64, v176
    v_dot2c_f32_bf16 v194, v68, v176
    v_dot2c_f32_bf16 v195, v72, v176
    v_dot2c_f32_bf16 v192, v61, v177
    v_dot2c_f32_bf16 v193, v65, v177
    v_dot2c_f32_bf16 v194, v69, v177
    v_dot2c_f32_bf16 v195, v73, v177
    v_dot2c_f32_bf16 v192, v62, v178
    v_dot2c_f32_bf16 v193, v66, v178
    v_dot2c_f32_bf16 v194, v70, v178
    v_dot2c_f32_bf16 v195, v74, v178
    v_dot2c_f32_bf16 v192, v63, v179
    v_dot2c_f32_bf16 v193, v67, v179
    v_dot2c_f32_bf16 v194, v71, v179
    v_dot2c_f32_bf16 v195, v75, v179
    ds_read_b128 v[176:179], v10 offset:2688
    s_waitcnt lgkmcnt(1)
    v_dot2c_f32_bf16 v192, v76, v172
    v_dot2c_f32_bf16 v193, v80, v172
    v_dot2c_f32_bf16 v194, v84, v172
    v_dot2c_f32_bf16 v195, v88, v172
    v_dot2c_f32_bf16 v192, v77, v173
    v_dot2c_f32_bf16 v193, v81, v173
    v_dot2c_f32_bf16 v194, v85, v173
    v_dot2c_f32_bf16 v195, v89, v173
    v_dot2c_f32_bf16 v192, v78, v174
    v_dot2c_f32_bf16 v193, v82, v174
    v_dot2c_f32_bf16 v194, v86, v174
    v_dot2c_f32_bf16 v195, v90, v174
    v_dot2c_f32_bf16 v192, v79, v175
    v_dot2c_f32_bf16 v193, v83, v175
    v_dot2c_f32_bf16 v194, v87, v175
    v_dot2c_f32_bf16 v195, v91, v175
    ds_read_b128 v[172:175], v10 offset:2816
    s_waitcnt lgkmcnt(1)
    v_dot2c_f32_bf16 v192, v92, v176
    v_dot2c_f32_bf16 v193, v96, v176
    v_dot2c_f32_bf16 v194, v100, v176
    v_dot2c_f32_bf16 v195, v104, v176
    v_dot2c_f32_bf16 v192, v93, v177
    v_dot2c_f32_bf16 v193, v97, v177
    v_dot2c_f32_bf16 v194, v101, v177
    v_dot2c_f32_bf16 v195, v105, v177
    v_dot2c_f32_bf16 v192, v94, v178
    v_dot2c_f32_bf16 v193, v98, v178
    v_dot2c_f32_bf16 v194, v102, v178
    v_dot2c_f32_bf16 v195, v106, v178
    v_dot2c_f32_bf16 v192, v95, v179
    v_dot2c_f32_bf16 v193, v99, v179
    v_dot2c_f32_bf16 v194, v103, v179
    v_dot2c_f32_bf16 v195, v107, v179
    ds_read_b128 v[176:179], v10 offset:2944
    s_waitcnt lgkmcnt(1)
    v_dot2c_f32_bf16 v192, v108, v172
    v_dot2c_f32_bf16 v193, v112, v172
    v_dot2c_f32_bf16 v194, v116, v172
    v_dot2c_f32_bf16 v195, v120, v172
    v_dot2c_f32_bf16 v192, v109, v173
    v_dot2c_f32_bf16 v193, v113, v173
    v_dot2c_f32_bf16 v194, v117, v173
    v_dot2c_f32_bf16 v195, v121, v173
    v_dot2c_f32_bf16 v192, v110, v174
    v_dot2c_f32_bf16 v193, v114, v174
    v_dot2c_f32_bf16 v194, v118, v174
    v_dot2c_f32_bf16 v195, v122, v174
    v_dot2c_f32_bf16 v192, v111, v175
    v_dot2c_f32_bf16 v193, v115, v175
    v_dot2c_f32_bf16 v194, v119, v175
    v_dot2c_f32_bf16 v195, v123, v175
    ds_read_b128 v[172:175], v10 offset:3072
    s_waitcnt lgkmcnt(1)
    v_dot2c_f32_bf16 v192, v124, v176
    v_dot2c_f32_bf16 v193, v128, v176
    v_dot2c_f32_bf16 v194, v132, v176
    v_dot2c_f32_bf16 v195, v136, v176
    v_dot2c_f32_bf16 v192, v125, v177
    v_dot2c_f32_bf16 v193, v129, v177
    v_dot2c_f32_bf16 v194, v133, v177
    v_dot2c_f32_bf16 v195, v137, v177
    v_dot2c_f32_bf16 v192, v126, v178
    v_dot2c_f32_bf16 v193, v130, v178
    v_dot2c_f32_bf16 v194, v134, v178
    v_dot2c_f32_bf16 v195, v138, v178
    v_dot2c_f32_bf16 v192, v127, v179
    v_dot2c_f32_bf16 v193, v131, v179
    v_dot2c_f32_bf16 v194, v135, v179
    v_dot2c_f32_bf16 v195, v139, v179
    ds_read_b128 v[176:179], v10 offset:3200
    s_waitcnt lgkmcnt(1)
    v_dot2c_f32_bf16 v192, v140, v172
    v_dot2c_f32_bf16 v193, v144, v172
    v_dot2c_f32_bf16 v194, v148, v172
    v_dot2c_f32_bf16 v195, v152, v172
    v_dot2c_f32_bf16 v192, v141, v173
    v_dot2c_f32_bf16 v193, v145, v173
    v_dot2c_f32_bf16 v194, v149, v173
    v_dot2c_f32_bf16 v195, v153, v173
    v_dot2c_f32_bf16 v192, v142, v174
    v_dot2c_f32_bf16 v193, v146, v174
    v_dot2c_f32_bf16 v194, v150, v174
    v_dot2c_f32_bf16 v195, v154, v174
    v_dot2c_f32_bf16 v192, v143, v175
    v_dot2c_f32_bf16 v193, v147, v175
    v_dot2c_f32_bf16 v194, v151, v175
    v_dot2c_f32_bf16 v195, v155, v175
    s_waitcnt lgkmcnt(0)
    v_dot2c_f32_bf16 v192, v156, v176
    v_dot2c_f32_bf16 v193, v160, v176
    v_dot2c_f32_bf16 v194, v164, v176
    v_dot2c_f32_bf16 v195, v168, v176
    v_dot2c_f32_bf16 v192, v157, v177
    v_dot2c_f32_bf16 v193, v161, v177
    v_dot2c_f32_bf16 v194, v165, v177
    v_dot2c_f32_bf16 v195, v169, v177
    v_dot2c_f32_bf16 v192, v158, v178
    v_dot2c_f32_bf16 v193, v162, v178
    v_dot2c_f32_bf16 v194, v166, v178
    v_dot2c_f32_bf16 v195, v170, v178
    v_dot2c_f32_bf16 v192, v159, v179
    v_dot2c_f32_bf16 v193, v163, v179
    v_dot2c_f32_bf16 v194, v167, v179
    v_dot2c_f32_bf16 v195, v171, v179
    s_nop 2
    v_add_f32_dpp v192, v192, v192 quad_perm:[1,0,3,2] row_mask:0xf bank_mask:0xf
    v_add_f32_dpp v193, v193, v193 quad_perm:[1,0,3,2] row_mask:0xf bank_mask:0xf
    v_add_f32_dpp v194, v194, v194 quad_perm:[1,0,3,2] row_mask:0xf bank_mask:0xf
    v_add_f32_dpp v195, v195, v195 quad_perm:[1,0,3,2] row_mask:0xf bank_mask:0xf
    v_add_f32_dpp v192, v192, v192 quad_perm:[2,3,0,1] row_mask:0xf bank_mask:0xf
    v_add_f32_dpp v193, v193, v193 quad_perm:[2,3,0,1] row_mask:0xf bank_mask:0xf
    v_add_f32_dpp v194, v194, v194 quad_perm:[2,3,0,1] row_mask:0xf bank_mask:0xf
    v_add_f32_dpp v195, v195, v195 quad_perm:[2,3,0,1] row_mask:0xf bank_mask:0xf
    v_add_f32_dpp v192, v192, v192 row_half_mirror row_mask:0xf bank_mask:0xf
    v_add_f32_dpp v193, v193, v193 row_half_mirror row_mask:0xf bank_mask:0xf
    v_add_f32_dpp v194, v194, v194 row_half_mirror row_mask:0xf bank_mask:0xf
    v_add_f32_dpp v195, v195, v195 row_half_mirror row_mask:0xf bank_mask:0xf
    ds_write_b32 v180, v192 offset:1088
    ds_write_b32 v180, v193 offset:1120
    ds_write_b32 v180, v194 offset:1152
    ds_write_b32 v180, v195 offset:1184
    s_waitcnt lgkmcnt(0)
    s_barrier
    s_cmp_lg_u32 s30, 5
    s_cbranch_scc1 K_AUX_FFN0
    s_add_u32 s56, s6, 0x1000
    s_addc_u32 s57, s7, 0
    s_mov_b32 s58, 0x2000
    s_mov_b32 s59, 0x20000
    v_lshlrev_b32 v3, 4, v1
    v_add_u32 v4, 123968, v3
    ds_read_b128 v[196:199], v4
    s_waitcnt lgkmcnt(0)
    v_cvt_pk_bf16_f32 v196, v196, v196
    v_lshlrev_b32 v196, 16, v196
    v_mul_f32 v5, 0xbfb8aa3b, v196
    v_exp_f32 v5, v5
    s_nop 0
    v_add_f32 v5, 1.0, v5
    v_rcp_f32 v196, v5
    s_nop 0
    v_cvt_pk_bf16_f32 v196, v196, v196
    v_lshlrev_b32 v196, 16, v196
    v_cvt_pk_bf16_f32 v197, v197, v197
    v_lshlrev_b32 v197, 16, v197
    v_mul_f32 v5, 0xbfb8aa3b, v197
    v_exp_f32 v5, v5
    s_nop 0
    v_add_f32 v5, 1.0, v5
    v_rcp_f32 v197, v5
    s_nop 0
    v_cvt_pk_bf16_f32 v197, v197, v197
    v_lshlrev_b32 v197, 16, v197
    v_cvt_pk_bf16_f32 v198, v198, v198
    v_lshlrev_b32 v198, 16, v198
    v_mul_f32 v5, 0xbfb8aa3b, v198
    v_exp_f32 v5, v5
    s_nop 0
    v_add_f32 v5, 1.0, v5
    v_rcp_f32 v198, v5
    s_nop 0
    v_cvt_pk_bf16_f32 v198, v198, v198
    v_lshlrev_b32 v198, 16, v198
    v_cvt_pk_bf16_f32 v199, v199, v199
    v_lshlrev_b32 v199, 16, v199
    v_mul_f32 v5, 0xbfb8aa3b, v199
    v_exp_f32 v5, v5
    s_nop 0
    v_add_f32 v5, 1.0, v5
    v_rcp_f32 v199, v5
    s_nop 0
    v_cvt_pk_bf16_f32 v199, v199, v199
    v_lshlrev_b32 v199, 16, v199
    s_lshl_b32 s3, s28, 10
    buffer_store_dwordx4 v[196:199], v3, s[56:59], s3 offen sc1
    v_mov_b32 v4, 192
    s_mov_b32 s3, 131072
K_ZPOLL4:
    v_readfirstlane_b32 s33, v7
    s_nop 3
    s_sub_u32 s3, s3, 1
    s_cselect_b32 s33, 1, s33
    s_cmp_lg_u32 s33, 0
    s_cbranch_scc1 K_ZOK4
    global_load_dword v7, v4, s[4:5] sc1
    s_waitcnt vmcnt(0)
    s_branch K_ZPOLL4
K_ZOK4:
    s_add_u32 s60, s6, 0x80000
    s_addc_u32 s61, s7, 0
    s_mov_b32 s62, 0xa000
    s_mov_b32 s63, 0x20000
    s_lshl_b32 s3, s28, 2
    v_lshl_add_u32 v2, v1, 8, s3
    v_mov_b32 v3, 1
    s_waitcnt vmcnt(0)
    s_mov_b32 s3, 0
    buffer_store_dword v3, v2, s[60:63], s3 offen offset:192 sc1
    s_mov_b32 s3, 16384
    buffer_store_dword v3, v2, s[60:63], s3 offen offset:192 sc1
    s_mov_b32 s3, 32768
    buffer_store_dword v3, v2, s[60:63], s3 offen offset:192 sc1
K_AUX_FFN0:
    s_cmp_lg_u32 s43, 63
    s_cbranch_scc1 K_AUX_FFN1
    s_cmp_eq_u32 s29, 0
    s_cbranch_scc1 K_AUX_NB
    s_barrier
K_AUX_NB:
    s_cmp_lg_u32 s30, 6
    s_cbranch_scc1 K_P2
    v_mov_b32 v4, 192
    s_mov_b32 s3, 131072
K_ZPOLL6:
    v_readfirstlane_b32 s33, v7
    s_nop 3
    s_sub_u32 s3, s3, 1
    s_cselect_b32 s33, 1, s33
    s_cmp_lg_u32 s33, 0
    s_cbranch_scc1 K_ZOK6
    global_load_dword v7, v4, s[4:5] sc1
    s_waitcnt vmcnt(0)
    s_branch K_ZPOLL6
K_ZOK6:
    v_mov_b32 v7, 0
    s_branch K_P2
K_AUX_FFN1:
    s_mov_b32 s56, s46
    s_mov_b32 s57, s47
    s_mov_b32 s58, 0x21c000
    s_mov_b32 s59, 0x20000
    s_mov_b32 s60, s48
    s_mov_b32 s61, s49
    s_mov_b32 s62, 0x21c000
    s_mov_b32 s63, 0x20000
    v_lshrrev_b32 v2, 2, v1
    v_mul_u32_u24 v200, 3456, v2
    v_and_b32 v2, 3, v1
    v_lshl_add_u32 v200, v2, 4, v200
    s_mul_i32 s3, s30, 276480
    s_lshl_b32 s68, s43, 6
    s_add_u32 s3, s3, s68
    v_add_u32 v200, s3, v200
    s_mul_i32 s69, s30, 5120
    s_mov_b32 s68, 0
    s_add_u32 m0, s69, 0
    s_nop 0
    buffer_load_dwordx4 v200, s[56:59], s68 offen  lds
    s_add_u32 m0, s69, 40960
    s_nop 0
    buffer_load_dwordx4 v200, s[60:63], s68 offen  lds
    s_mov_b32 s68, 55296
    s_add_u32 m0, s69, 1024
    s_nop 0
    buffer_load_dwordx4 v200, s[56:59], s68 offen  lds
    s_add_u32 m0, s69, 41984
    s_nop 0
    buffer_load_dwordx4 v200, s[60:63], s68 offen  lds
    s_mov_b32 s68, 110592
    s_add_u32 m0, s69, 2048
    s_nop 0
    buffer_load_dwordx4 v200, s[56:59], s68 offen  lds
    s_add_u32 m0, s69, 43008
    s_nop 0
    buffer_load_dwordx4 v200, s[60:63], s68 offen  lds
    s_mov_b32 s68, 165888
    s_add_u32 m0, s69, 3072
    s_nop 0
    buffer_load_dwordx4 v200, s[56:59], s68 offen  lds
    s_add_u32 m0, s69, 44032
    s_nop 0
    buffer_load_dwordx4 v200, s[60:63], s68 offen  lds
    s_mov_b32 s68, 221184
    s_add_u32 m0, s69, 4096
    s_nop 0
    buffer_load_dwordx4 v200, s[56:59], s68 offen  lds
    s_add_u32 m0, s69, 45056
    s_nop 0
    buffer_load_dwordx4 v200, s[60:63], s68 offen  lds
    s_add_u32 s60, s6, 0x10000
    s_addc_u32 s61, s7, 0
    s_mov_b32 s62, 0x43800
    s_mov_b32 s63, 0x20000
    s_cmp_ge_u32 s30, 4
    s_cbranch_scc1 K_FFN_C
    s_mul_i32 s3, s43, 5120
    s_mul_i32 s68, s30, 1280
    s_add_u32 s3, s3, s68
    v_lshlrev_b32 v2, 4, v1
    buffer_store_dwordx4 v[12:15], v2, s[60:63], s3 offen sc1
    s_mov_b64 exec, 0xffff
    buffer_store_dwordx4 v[12:15], v2, s[60:63], s3 offen offset:1024 sc1
    s_mov_b64 exec, -1
    s_sub_u32 s3, s29, 1
    s_mul_i32 s3, s3, 92
    s_mul_i32 s68, s30, 23
    s_add_u32 s3, s3, s68
    v_lshrrev_b32 v2, 1, v1
    v_add_u32 v2, s3, v2
    v_mul_u32_u24 v2, 1280, v2
    v_and_b32 v3, 1, v1
    v_lshl_add_u32 v2, v3, 7, v2
    s_mov_b32 exec_hi, 0x3fff
    buffer_load_dword v6, v2, s[24:27], 0 offen offset:1024
    s_mov_b32 exec_lo, 0x55555555
    s_mov_b32 exec_hi, 0x1555
    buffer_load_dword v6, v2, s[24:27], 0 offen
    s_mov_b64 exec, -1
    s_waitcnt vmcnt(4)
    s_barrier
    s_branch K_P2_EARLY
K_FFN_C:
    s_mov_b32 s64, s50
    s_mov_b32 s65, s51
    s_mov_b32 s66, 0x21c000
    s_mov_b32 s67, 0x20000
    s_sub_u32 s69, s30, 4
    s_mul_i32 s3, s43, 40960
    s_mul_i32 s69, s69, 10240
    s_add_u32 s3, s3, s69
    v_lshl_add_u32 v201, v1, 4, s3
    v_lshrrev_b32 v202, 4, v1
    v_bfe_u32 v2, v1, 2, 2
    v_lshl_add_u32 v2, v202, 3, v2
    v_and_b32 v3, 3, v1
    v_lshlrev_b32 v3, 3, v3
    v_lshl_add_u32 v203, v2, 6, v3
    s_bfe_u32 s3, s30, 0x10001
    s_mul_i32 s3, s3, 40960
    s_and_b32 s68, s30, 1
    s_lshl_b32 s68, s68, 5
    s_add_u32 s3, s3, s68
    s_add_u32 s3, s3, 0
    v_add_u32 v203, s3, v203
    v_mul_u32_u24 v204, 1280, v2
    s_and_b32 s3, s30, 3
    s_mul_i32 s3, s3, 320
    s_add_u32 s3, s3, 81920
    v_add3_u32 v204, v204, v3, s3
    v_mov_b32 v205, 123904
    v_mov_b32 v206, 158720
    s_mov_b32 s68, 0
    s_add_u32 m0, s69, 81920
    s_nop 0
    buffer_load_dwordx4 v201, s[64:67], s68 offen  lds
    s_mov_b32 s68, 1024
    s_add_u32 m0, s69, 82944
    s_nop 0
    buffer_load_dwordx4 v201, s[64:67], s68 offen  lds
    s_mov_b32 s68, 2048
    s_add_u32 m0, s69, 83968
    s_nop 0
    buffer_load_dwordx4 v201, s[64:67], s68 offen  lds
    s_mov_b32 s68, 3072
    s_add_u32 m0, s69, 84992
    s_nop 0
    buffer_load_dwordx4 v201, s[64:67], s68 offen  lds
    s_mov_b32 s68, 4096
    s_add_u32 m0, s69, 86016
    s_nop 0
    buffer_load_dwordx4 v201, s[64:67], s68 offen  lds
    s_mov_b32 s68, 5120
    s_add_u32 m0, s69, 87040
    s_nop 0
    buffer_load_dwordx4 v201, s[64:67], s68 offen  lds
    s_mov_b32 s68, 6144
    s_add_u32 m0, s69, 88064
    s_nop 0
    buffer_load_dwordx4 v201, s[64:67], s68 offen  lds
    s_mov_b32 s68, 7168
    s_add_u32 m0, s69, 89088
    s_nop 0
    buffer_load_dwordx4 v201, s[64:67], s68 offen  lds
    s_mov_b32 s68, 8192
    s_add_u32 m0, s69, 90112
    s_nop 0
    buffer_load_dwordx4 v201, s[64:67], s68 offen  lds
    s_mov_b32 s68, 9216
    s_add_u32 m0, s69, 91136
    s_nop 0
    buffer_load_dwordx4 v201, s[64:67], s68 offen  lds
    s_waitcnt vmcnt(10)
    s_barrier
    ds_read_b64_tr_b16 v[12:13], v203 offset:0
    ds_read_b64_tr_b16 v[14:15], v203 offset:256
    ds_read_b64_tr_b16 v[16:17], v203 offset:2048
    ds_read_b64_tr_b16 v[18:19], v203 offset:2304
    ds_read_b64_tr_b16 v[20:21], v203 offset:4096
    ds_read_b64_tr_b16 v[22:23], v203 offset:4352
    ds_read_b64_tr_b16 v[24:25], v203 offset:6144
    ds_read_b64_tr_b16 v[26:27], v203 offset:6400
    ds_read_b64_tr_b16 v[28:29], v203 offset:8192
    ds_read_b64_tr_b16 v[30:31], v203 offset:8448
    ds_read_b64_tr_b16 v[32:33], v203 offset:10240
    ds_read_b64_tr_b16 v[34:35], v203 offset:10496
    ds_read_b64_tr_b16 v[36:37], v203 offset:12288
    ds_read_b64_tr_b16 v[38:39], v203 offset:12544
    ds_read_b64_tr_b16 v[40:41], v203 offset:14336
    ds_read_b64_tr_b16 v[42:43], v203 offset:14592
    ds_read_b64_tr_b16 v[44:45], v203 offset:16384
    ds_read_b64_tr_b16 v[46:47], v203 offset:16640
    ds_read_b64_tr_b16 v[48:49], v203 offset:18432
    ds_read_b64_tr_b16 v[50:51], v203 offset:18688
    ds_read_b64_tr_b16 v[52:53], v203 offset:20480
    ds_read_b64_tr_b16 v[54:55], v203 offset:20736
    ds_read_b64_tr_b16 v[56:57], v203 offset:22528
    ds_read_b64_tr_b16 v[58:59], v203 offset:22784
    ds_read_b64_tr_b16 v[60:61], v203 offset:24576
    ds_read_b64_tr_b16 v[62:63], v203 offset:24832
    ds_read_b64_tr_b16 v[64:65], v203 offset:26624
    ds_read_b64_tr_b16 v[66:67], v203 offset:26880
    ds_read_b64_tr_b16 v[68:69], v203 offset:28672
    ds_read_b64_tr_b16 v[70:71], v203 offset:28928
    ds_read_b64_tr_b16 v[72:73], v203 offset:30720
    ds_read_b64_tr_b16 v[74:75], v203 offset:30976
    ds_read_b64_tr_b16 v[76:77], v203 offset:32768
    ds_read_b64_tr_b16 v[78:79], v203 offset:33024
    ds_read_b64_tr_b16 v[80:81], v203 offset:34816
    ds_read_b64_tr_b16 v[82:83], v203 offset:35072
    ds_read_b64_tr_b16 v[84:85], v203 offset:36864
    ds_read_b64_tr_b16 v[86:87], v203 offset:37120
    ds_read_b64_tr_b16 v[88:89], v203 offset:38912
    ds_read_b64_tr_b16 v[90:91], v203 offset:39168
    s_setprio 3
    s_waitcnt lgkmcnt(0)
    s_barrier
    s_cmp_lg_u32 s30, 7
    s_cbranch_scc1 K_AUX_POLLED
    v_mov_b32 v4, 192
    s_mov_b32 s3, 131072
K_ZPOLL5:
    v_readfirstlane_b32 s33, v7
    s_nop 3
    s_sub_u32 s3, s3, 1
    s_cselect_b32 s33, 1, s33
    s_cmp_lg_u32 s33, 0
    s_cbranch_scc1 K_ZOK5
    global_load_dword v7, v4, s[4:5] sc1
    s_waitcnt vmcnt(0)
    s_branch K_ZPOLL5
K_ZOK5:
    v_and_b32 v3, 15, v1
    v_lshl_add_u32 v3, v3, 2, s42
    s_mov_b32 s3, 131072
K_AUX_POLL:
    global_load_dword v2, v3, s[6:7] offset:128 sc1
    s_waitcnt vmcnt(0)
    v_cmp_eq_u32 vcc, 0, v2
    s_cbranch_vccz K_AUX_GOT
    s_sleep 6
    s_sub_u32 s3, s3, 1
    s_cmp_lg_u32 s3, 0
    s_cbranch_scc1 K_AUX_POLL
K_AUX_GOT:
    s_nop 1
    v_max_u32_dpp v3, v2, v2 quad_perm:[1,0,3,2] row_mask:0xf bank_mask:0xf
    s_nop 1
    v_max_u32_dpp v3, v3, v3 quad_perm:[2,3,0,1] row_mask:0xf bank_mask:0xf
    s_nop 1
    v_max_u32_dpp v3, v3, v3 row_half_mirror row_mask:0xf bank_mask:0xf
    s_nop 1
    v_max_u32_dpp v3, v3, v3 row_mirror row_mask:0xf bank_mask:0xf
    s_nop 1
    v_readlane_b32 s70, v3, 0
    v_readlane_b32 s72, v3, 16
    v_readlane_b32 s73, v3, 32
    v_readlane_b32 s74, v3, 48
    s_nop 3
    s_max_u32 s70, s70, s72
    s_max_u32 s73, s73, s74
    s_max_u32 s70, s70, s73
    v_cmp_ne_u32 vcc, s70, v2
    s_nop 1
    v_cndmask_b32 v2, 0, v2, vcc
    s_nop 1
    v_max_u32_dpp v3, v2, v2 quad_perm:[1,0,3,2] row_mask:0xf bank_mask:0xf
    s_nop 1
    v_max_u32_dpp v3, v3, v3 quad_perm:[2,3,0,1] row_mask:0xf bank_mask:0xf
    s_nop 1
    v_max_u32_dpp v3, v3, v3 row_half_mirror row_mask:0xf bank_mask:0xf
    s_nop 1
    v_max_u32_dpp v3, v3, v3 row_mirror row_mask:0xf bank_mask:0xf
    s_nop 1
    v_readlane_b32 s71, v3, 0
    v_readlane_b32 s72, v3, 16
    v_readlane_b32 s73, v3, 32
    v_readlane_b32 s74, v3, 48
    s_nop 3
    s_max_u32 s71, s71, s72
    s_max_u32 s73, s73, s74
    s_max_u32 s71, s71, s73
    v_mov_b32 v196, s70
    v_mov_b32 v197, s71
    v_mov_b32 v3, 1
    ds_write_b64 v205, v[196:197]
    ds_write_b32 v206, v3 offset:48
K_AUX_POLLED:
    s_mov_b32 s3, 1048576
K_FGK:
    ds_read_b32 v2, v206 offset:48
    s_sleep 1
    s_sub_u32 s3, s3, 1
    s_waitcnt lgkmcnt(0)
    v_readfirstlane_b32 s33, v2
    s_nop 3
    s_cselect_b32 s33, 1, s33
    s_cmp_lt_u32 s33, 1
    s_cbranch_scc1 K_FGK
    ds_read_b64 v[196:197], v205
    v_and_b32 v2, 1, v1
    v_cmp_eq_u32 vcc, 1, v2
    s_waitcnt lgkmcnt(0)
    v_cndmask_b32 v4, v196, v197, vcc
    v_and_b32 v3, 0x7ff, v4
    v_sub_u32 v3, 2047, v3
    v_mul_u32_u24 v9, 1280, v3
    v_lshl_add_u32 v9, v202, 4, v9
    s_mov_b32 exec_lo, 0x00030003
    s_mov_b32 exec_hi, 0x00030003
    buffer_load_dwordx4 v[92:95], v9, s[12:15], 0 offen offset:0
    buffer_load_dwordx4 v[96:99], v9, s[12:15], 0 offen offset:64
    buffer_load_dwordx4 v[100:103], v9, s[12:15], 0 offen offset:128
    buffer_load_dwordx4 v[104:107], v9, s[12:15], 0 offen offset:192
    buffer_load_dwordx4 v[108:111], v9, s[12:15], 0 offen offset:256
    buffer_load_dwordx4 v[112:115], v9, s[12:15], 0 offen offset:320
    buffer_load_dwordx4 v[116:119], v9, s[12:15], 0 offen offset:384
    buffer_load_dwordx4 v[120:123], v9, s[12:15], 0 offen offset:448
    buffer_load_dwordx4 v[124:127], v9, s[12:15], 0 offen offset:512
    buffer_load_dwordx4 v[128:131], v9, s[12:15], 0 offen offset:576
    buffer_load_dwordx4 v[132:135], v9, s[12:15], 0 offen offset:640
    buffer_load_dwordx4 v[136:139], v9, s[12:15], 0 offen offset:704
    buffer_load_dwordx4 v[140:143], v9, s[12:15], 0 offen offset:768
    buffer_load_dwordx4 v[144:147], v9, s[12:15], 0 offen offset:832
    buffer_load_dwordx4 v[148:151], v9, s[12:15], 0 offen offset:896
    buffer_load_dwordx4 v[152:155], v9, s[12:15], 0 offen offset:960
    buffer_load_dwordx4 v[156:159], v9, s[12:15], 0 offen offset:1024
    buffer_load_dwordx4 v[160:163], v9, s[12:15], 0 offen offset:1088
    buffer_load_dwordx4 v[164:167], v9, s[12:15], 0 offen offset:1152
    buffer_load_dwordx4 v[168:171], v9, s[12:15], 0 offen offset:1216
    s_mov_b64 exec, -1
    v_and_b32 v2, 1, v1
    v_lshlrev_b32 v216, 6, v2
    v_lshl_add_u32 v216, v202, 4, v216
    s_and_b32 s3, s30, 3
    s_lshl_b32 s3, s3, 7
    v_add3_u32 v217, v216, s3, v205
    v_add_u32 v216, 64, v217
    v_add_u32 v217, 1088, v217
    v_lshrrev_b32 v2, 5, v1
    v_bfe_u32 v3, v1, 4, 1
    v_lshl_add_u32 v3, v3, 1, v2
    v_lshlrev_b32 v3, 6, v3
    v_and_b32 v4, 15, v1
    v_lshl_add_u32 v3, v4, 2, v3
    v_add_u32 v218, 123968, v3
    v_lshlrev_b32 v4, 1, v1
    s_add_u32 s3, s3, 124992
    v_add_u32 v219, s3, v4
    v_and_b32 v2, 1, v1
    v_mul_u32_u24 v2, 2560, v2
    v_lshl_add_u32 v220, v202, 4, v2
    s_mul_i32 s3, s43, 5120
    s_and_b32 s68, s30, 3
    s_mul_i32 s68, s68, 640
    s_add_u32 s68, s68, s3
    v_mov_b32 v3, 1
    s_waitcnt vmcnt(16)
    v_mfma_f32_16x16x32_bf16 v[208:211], v[12:15], v[92:95], 0
    v_mfma_f32_16x16x32_bf16 v[212:215], v[16:19], v[96:99], 0
    v_mfma_f32_16x16x32_bf16 v[208:211], v[20:23], v[100:103], v[208:211]
    v_mfma_f32_16x16x32_bf16 v[212:215], v[24:27], v[104:107], v[212:215]
    s_waitcnt vmcnt(12)
    v_mfma_f32_16x16x32_bf16 v[208:211], v[28:31], v[108:111], v[208:211]
    v_mfma_f32_16x16x32_bf16 v[212:215], v[32:35], v[112:115], v[212:215]
    v_mfma_f32_16x16x32_bf16 v[208:211], v[36:39], v[116:119], v[208:211]
    v_mfma_f32_16x16x32_bf16 v[212:215], v[40:43], v[120:123], v[212:215]
    s_waitcnt vmcnt(8)
    s_branch K_PG7
.p2align 12
K_PG7:
    v_mfma_f32_16x16x32_bf16 v[208:211], v[44:47], v[124:127], v[208:211]
    v_mfma_f32_16x16x32_bf16 v[212:215], v[48:51], v[128:131], v[212:215]
    v_mfma_f32_16x16x32_bf16 v[208:211], v[52:55], v[132:135], v[208:211]
    v_mfma_f32_16x16x32_bf16 v[212:215], v[56:59], v[136:139], v[212:215]
    s_waitcnt vmcnt(4)
    v_mfma_f32_16x16x32_bf16 v[208:211], v[60:63], v[140:143], v[208:211]
    v_mfma_f32_16x16x32_bf16 v[212:215], v[64:67], v[144:147], v[212:215]
    v_mfma_f32_16x16x32_bf16 v[208:211], v[68:71], v[148:151], v[208:211]
    v_mfma_f32_16x16x32_bf16 v[212:215], v[72:75], v[152:155], v[212:215]
    s_waitcnt vmcnt(0)
    v_mfma_f32_16x16x32_bf16 v[208:211], v[76:79], v[156:159], v[208:211]
    v_mfma_f32_16x16x32_bf16 v[212:215], v[80:83], v[160:163], v[212:215]
    v_mfma_f32_16x16x32_bf16 v[208:211], v[84:87], v[164:167], v[208:211]
    v_mfma_f32_16x16x32_bf16 v[212:215], v[88:91], v[168:171], v[212:215]
    s_nop 7
    v_add_f32 v208, v208, v212
    v_add_f32 v209, v209, v213
    v_add_f32 v210, v210, v214
    v_add_f32 v211, v211, v215
    s_mov_b32 exec_lo, 0x00030003
    s_mov_b32 exec_hi, 0x00030003
    ds_write_b128 v216, v[208:211]
    s_mov_b64 exec, 1
    ds_add_u32 v206, v3 offset:52
    s_mov_b64 exec, -1
    s_cmp_lg_u32 s30, 6
    s_cbranch_scc1 K_NOS6B
    v_min_u32 v4, 23, v1
    v_lshl_add_u32 v4, v4, 2, s42
    global_load_dword v7, v4, s[6:7] offset:128 sc1
K_NOS6B:
    s_mov_b32 s3, 1048576
K_FGP:
    ds_read_b32 v2, v206 offset:52
    s_sleep 1
    s_sub_u32 s3, s3, 1
    s_waitcnt lgkmcnt(0)
    v_readfirstlane_b32 s33, v2
    s_nop 3
    s_cselect_b32 s33, 4, s33
    s_cmp_lt_u32 s33, 4
    s_cbranch_scc1 K_FGP
    ds_read_b32 v224, v218
    ds_read_b32 v226, v218 offset:256
    ds_read_b64_tr_b16 v[12:13], v204 offset:0
    ds_read_b64_tr_b16 v[14:15], v204 offset:5120
    ds_read_b64_tr_b16 v[16:17], v204 offset:32
    ds_read_b64_tr_b16 v[18:19], v204 offset:5152
    ds_read_b64_tr_b16 v[20:21], v204 offset:64
    ds_read_b64_tr_b16 v[22:23], v204 offset:5184
    ds_read_b64_tr_b16 v[24:25], v204 offset:96
    ds_read_b64_tr_b16 v[26:27], v204 offset:5216
    ds_read_b64_tr_b16 v[28:29], v204 offset:128
    ds_read_b64_tr_b16 v[30:31], v204 offset:5248
    ds_read_b64_tr_b16 v[32:33], v204 offset:160
    ds_read_b64_tr_b16 v[34:35], v204 offset:5280
    ds_read_b64_tr_b16 v[36:37], v204 offset:192
    ds_read_b64_tr_b16 v[38:39], v204 offset:5312
    s_waitcnt lgkmcnt(14)
    v_cvt_pk_bf16_f32 v224, v224, v224
    v_lshlrev_b32 v224, 16, v224
    v_cvt_pk_bf16_f32 v226, v226, v226
    v_lshlrev_b32 v226, 16, v226
    v_mul_f32 v225, 0xbfb8aa3b, v224
    v_exp_f32 v225, v225
    s_nop 0
    v_add_f32 v225, 1.0, v225
    v_rcp_f32 v225, v225
    s_nop 0
    v_mul_f32 v224, v224, v225
    v_cvt_pk_bf16_f32 v224, v224, v224
    v_lshlrev_b32 v224, 16, v224
    v_mul_f32 v224, v224, v226
    v_cvt_pk_bf16_f32 v224, v224, v224
    ds_write_b16 v219, v224
    s_waitcnt lgkmcnt(0)
    ds_read_b128 v[224:227], v217
    ds_read_b64_tr_b16 v[40:41], v204 offset:224
    ds_read_b64_tr_b16 v[42:43], v204 offset:5344
    ds_read_b64_tr_b16 v[44:45], v204 offset:256
    ds_read_b64_tr_b16 v[46:47], v204 offset:5376
    ds_read_b64_tr_b16 v[48:49], v204 offset:288
    ds_read_b64_tr_b16 v[50:51], v204 offset:5408
    s_waitcnt lgkmcnt(6)
    v_mfma_f32_16x16x32_bf16 v[92:95], v[12:15], v[224:227], 0
    v_mfma_f32_16x16x32_bf16 v[96:99], v[16:19], v[224:227], 0
    v_mfma_f32_16x16x32_bf16 v[100:103], v[20:23], v[224:227], 0
    v_mfma_f32_16x16x32_bf16 v[104:107], v[24:27], v[224:227], 0
    v_mfma_f32_16x16x32_bf16 v[108:111], v[28:31], v[224:227], 0
    v_mfma_f32_16x16x32_bf16 v[112:115], v[32:35], v[224:227], 0
    v_mfma_f32_16x16x32_bf16 v[116:119], v[36:39], v[224:227], 0
    s_waitcnt lgkmcnt(4)
    v_mfma_f32_16x16x32_bf16 v[120:123], v[40:43], v[224:227], 0
    s_waitcnt lgkmcnt(2)
    v_mfma_f32_16x16x32_bf16 v[124:127], v[44:47], v[224:227], 0
    s_waitcnt lgkmcnt(0)
    v_mfma_f32_16x16x32_bf16 v[128:131], v[48:51], v[224:227], 0
    s_mov_b32 exec_lo, 0x00030003
    s_mov_b32 exec_hi, 0x00030003
    buffer_store_dwordx4 v[92:95], v220, s[60:63], s68 offen offset:0 sc1
    buffer_store_dwordx4 v[96:99], v220, s[60:63], s68 offen offset:64 sc1
    buffer_store_dwordx4 v[100:103], v220, s[60:63], s68 offen offset:128 sc1
    buffer_store_dwordx4 v[104:107], v220, s[60:63], s68 offen offset:192 sc1
    buffer_store_dwordx4 v[108:111], v220, s[60:63], s68 offen offset:256 sc1
    buffer_store_dwordx4 v[112:115], v220, s[60:63], s68 offen offset:320 sc1
    buffer_store_dwordx4 v[116:119], v220, s[60:63], s68 offen offset:384 sc1
    buffer_store_dwordx4 v[120:123], v220, s[60:63], s68 offen offset:448 sc1
    buffer_store_dwordx4 v[124:127], v220, s[60:63], s68 offen offset:512 sc1
    buffer_store_dwordx4 v[128:131], v220, s[60:63], s68 offen offset:576 sc1
    s_mov_b64 exec, -1
    s_lshl_b32 s3, s43, 3
    s_add_u32 s3, s3, s30
    s_lshl_b32 s3, s3, 2
    s_add_u32 s3, s3, 565232
    v_mov_b32 v2, s3
    v_mov_b32 v3, 1
    s_waitcnt vmcnt(0)
    s_mov_b64 exec, 1
    global_store_dword v2, v3, s[6:7] sc1
    s_mov_b64 exec, -1
    s_branch K_P2
K_CODE_END:
.section .rodata,"a"
.p2align 6
.amdhsa_kernel gated_mix__sliding_local_dilated__moe_arch_mod__prompt_kernel
  .amdhsa_next_free_vgpr 248
  .amdhsa_next_free_sgpr 75
  .amdhsa_accum_offset 248
  .amdhsa_group_segment_fixed_size 0
  .amdhsa_kernarg_size 96
  .amdhsa_user_sgpr_count 2
  .amdhsa_user_sgpr_kernarg_segment_ptr 1
  .amdhsa_system_sgpr_workgroup_id_x 1
.end_amdhsa_kernel
```

```asm
; @launch grid=(256,1,1) block=(512,1,1) lds=163840
.amdgcn_target "amdgcn-amd-amdhsa--gfx950"
.text
K_CPL = 30
.p2align 12
.p2align 8
.globl gated_mix__sliding_local_dilated__moe_arch_mod__prompt_kernel
.type gated_mix__sliding_local_dilated__moe_arch_mod__prompt_kernel,@function
gated_mix__sliding_local_dilated__moe_arch_mod__prompt_kernel:
    s_cmp_ge_u32 s2, 256
    s_cbranch_scc1 K_EXIT
    s_load_dwordx2 s[12:13], s[0:1], 0
    s_load_dwordx2 s[16:17], s[0:1], 8
    s_load_dwordx4 s[4:7], s[0:1], 80
    s_load_dwordx2 s[8:9], s[0:1], 16
    s_load_dwordx2 s[10:11], s[0:1], 72
    v_readfirstlane_b32 s30, v0
    s_mov_b32 s14, 0x280000
    s_mov_b32 s15, 0x20000
    s_lshr_b32 s30, s30, 6
    s_cmp_ge_u32 s2, 64
    s_cbranch_scc1 K_MAIN
    s_load_dwordx8 s[44:51], s[0:1], 32
    s_load_dwordx2 s[52:53], s[0:1], 64
    s_getpc_b64 s[38:39]
K_PC:
    s_lshr_b32 s3, s2, 3
    s_mul_i32 s3, s3, K_CPL
    v_add_u32 v2, s3, v0
    v_lshlrev_b32 v2, 7, v2
    v_min_u32 v2, K_CODE_END-K_PC-4, v2
    v_cmp_gt_u32 vcc, K_CPL, v0
    s_and_saveexec_b64 s[20:21], vcc
    s_cbranch_execz K_NOPF
    global_load_dword v6, v2, s[38:39]
K_NOPF:
    s_mov_b64 exec, -1
    s_cmp_lg_u32 s30, 4
    s_cbranch_scc1 K_AUX
    s_min_u32 s3, s2, 8
    s_mul_i32 s3, s3, 10240
    s_add_u32 s33, s3, 10240
    s_cmp_lt_u32 s2, 8
    s_cbranch_scc1 K_ZS
    s_cmp_lg_u32 s2, 63
    s_cbranch_scc1 K_AUX
    s_mov_b32 s33, 0
K_ZS:
    v_lshlrev_b32 v2, 4, v0
    v_mov_b32 v8, 0
    v_mov_b32 v9, 0
    v_mov_b32 v10, 0
    v_mov_b32 v11, 0
    s_waitcnt lgkmcnt(0)
    s_add_u32 s20, s6, 0x7f000
    s_addc_u32 s21, s7, 0
    s_mov_b32 s22, 0x15400
    s_mov_b32 s23, 0x20000
K_ZL:
    buffer_store_dwordx4 v[8:11], v2, s[20:23], s3 offen sc1
    s_add_u32 s3, s3, 1024
    s_cmp_lt_u32 s3, s33
    s_cbranch_scc1 K_ZL
    s_branch K_AUX
K_MAIN:
    s_cmp_ge_u32 s30, 4
    s_cbranch_scc1 K_CONS
    s_bfe_u32 s3, s2, 0x20001
    s_mul_i32 s44, s3, 675840
    s_lshr_b32 s33, s2, 6
    s_mul_i32 s3, s33, 225280
    s_add_u32 s44, s44, s3
    s_mul_i32 s3, s30, 61440
    s_add_u32 s44, s44, s3
    s_sub_u32 s44, s44, 245760
    v_bfe_u32 v3, v0, 4, 2
    s_lshr_b32 s3, s2, 1
    s_and_b32 s3, s3, 28
    s_or_b32 s3, s3, 0x40000
    v_lshlrev_b32 v2, 1, v3
    v_sub_u32 v2, v0, v2
    s_bfe_u32 s49, 0x82931560, s3
    s_bfe_u32 s32, 0x64317520, s3
    v_and_b32 v2, 15, v2
    v_mul_u32_u24 v5, 3840, v3
    s_and_b32 s3, s2, 7
    s_lshl2_add_u32 s3, s33, s3
    s_add_u32 s49, s49, s3
    s_mov_b32 s33, 0x00a55a
    v_subrev_u32 v5, 160, v5
    s_mul_i32 s3, s49, 205
    s_lshr_b32 s3, s3, 11
    s_mul_i32 s3, s3, 10
    s_sub_u32 s49, s49, s3
    v_mul_u32_u24 v4, 52, v2
    v_lshrrev_b32 v4, 5, v4
    v_and_b32 v4, 24, v4
    v_bfe_u32 v4, s33, v4, 8
    v_add_u32 v4, v4, v2
    v_lshl_add_u32 v10, v4, 4, v5
    v_add_u32 v4, 1, v2
    v_lshrrev_b32 v4, 4, v4
    v_lshl_add_u32 v10, v4, 28, v10
    v_xor_b32 v2, 8, v2
    v_mul_u32_u24 v4, 52, v2
    v_lshrrev_b32 v4, 5, v4
    v_and_b32 v4, 24, v4
    v_bfe_u32 v4, s33, v4, 8
    v_add_u32 v4, v4, v2
    v_lshl_add_u32 v11, v4, 4, v5
    v_add_u32 v4, 1, v2
    v_lshrrev_b32 v4, 4, v4
    v_lshl_add_u32 v11, v4, 28, v11
    s_bitcmp1_b32 s2, 0
    s_cselect_b32 s3, 8, 0
    s_add_u32 s32, s32, s3
    s_mul_i32 s50, s32, 80
    s_mul_i32 s3, s30, 61440
    s_add_u32 s50, s50, s3
    s_lshl_b32 s46, s30, 12
    s_add_u32 s46, s46, 24576
    s_mul_i32 s45, s30, 6144
    s_mov_b32 s18, 0x258000
    s_mov_b32 s19, 0x20000
    v_xor_b32 v3, v3, v0
    v_and_b32 v3, 7, v3
    v_bfe_u32 v2, v0, 3, 3
    v_mul_u32_u24 v2, 1280, v2
    v_lshl_add_u32 v8, v3, 4, v2
    v_xor_b32 v9, 64, v8
    s_lshl_b32 s47, s49, 7
    s_mul_i32 s48, s49, 245760
    s_add_u32 s51, s44, s47
    s_add_u32 s48, s48, s50
    s_add_u32 s49, s49, 1
    s_cmp_eq_u32 s49, 10
    s_cselect_b32 s49, 0, s49
    s_waitcnt lgkmcnt(0)
    s_add_u32 m0, s46, 40960
    s_add_u32 s52, s48, 0
    buffer_load_dwordx4 v10, s[16:19], s52 offen lds
    s_add_u32 m0, s45, 40960
    s_max_i32 s52, s51, s47
    buffer_load_dwordx4 v8, s[12:15], s52 offen lds
    s_add_u32 m0, s46, 41984
    s_add_u32 s52, s48, 15360
    buffer_load_dwordx4 v10, s[16:19], s52 offen lds
    s_add_u32 m0, s45, 41984
    s_add_u32 s52, s51, 10240
    s_max_i32 s52, s52, s47
    buffer_load_dwordx4 v9, s[12:15], s52 offen lds
    s_add_u32 m0, s45, 43008
    s_add_u32 s52, s51, 20480
    buffer_load_dwordx4 v8, s[12:15], s52 offen lds
    s_add_u32 m0, s46, 43008
    s_add_u32 s52, s48, 30720
    buffer_load_dwordx4 v11, s[16:19], s52 offen lds
    s_add_u32 m0, s45, 44032
    s_add_u32 s52, s51, 30720
    buffer_load_dwordx4 v9, s[12:15], s52 offen lds
    s_add_u32 m0, s46, 44032
    s_add_u32 s52, s48, 46080
    buffer_load_dwordx4 v11, s[16:19], s52 offen lds
    s_add_u32 m0, s45, 45056
    s_add_u32 s52, s51, 40960
    buffer_load_dwordx4 v8, s[12:15], s52 offen lds
    s_add_u32 m0, s45, 46080
    s_add_u32 s52, s51, 51200
    buffer_load_dwordx4 v9, s[12:15], s52 offen lds
    s_lshl_b32 s47, s49, 7
    s_mul_i32 s48, s49, 245760
    s_add_u32 s51, s44, s47
    s_add_u32 s48, s48, s50
    s_add_u32 s49, s49, 1
    s_cmp_eq_u32 s49, 10
    s_cselect_b32 s49, 0, s49
    s_add_u32 m0, s46, 81920
    s_add_u32 s52, s48, 0
    buffer_load_dwordx4 v10, s[16:19], s52 offen lds
    s_add_u32 m0, s45, 81920
    s_max_i32 s52, s51, s47
    buffer_load_dwordx4 v8, s[12:15], s52 offen lds
    s_add_u32 m0, s46, 82944
    s_add_u32 s52, s48, 15360
    buffer_load_dwordx4 v10, s[16:19], s52 offen lds
    s_add_u32 m0, s45, 82944
    s_add_u32 s52, s51, 10240
    s_max_i32 s52, s52, s47
    buffer_load_dwordx4 v9, s[12:15], s52 offen lds
    s_add_u32 m0, s45, 83968
    s_add_u32 s52, s51, 20480
    buffer_load_dwordx4 v8, s[12:15], s52 offen lds
    s_mov_b32 s43, s30
    v_and_b32 v1, 63, v0
    v_mov_b32 v7, 0
    s_and_b32 s28, s2, 7
    s_lshr_b32 s29, s2, 3
    s_xor_b32 s30, s30, 4
    s_lshr_b32 s34, s29, 3
    s_lshl_b32 s34, s34, 2
    s_and_b32 s3, s29, 3
    s_add_u32 s34, s34, s3
    s_add_u32 s34, s34, 4
    s_bitcmp1_b32 s29, 2
    s_cselect_b32 s34, -1, s34
    s_cmp_lt_u32 s29, 8
    s_cselect_b32 s34, s29, s34
    s_lshl_b32 s40, s28, 1
    s_cmp_ge_u32 s34, 10
    s_addc_u32 s40, s40, 0
    s_sub_u32 s41, s34, 10
    s_cmp_ge_u32 s34, 10
    s_cselect_b32 s41, s41, s34
    s_mul_i32 s42, s28, 20
    s_add_u32 s42, s42, s34
    s_and_b32 s42, s42, 255
    s_lshl_b32 s42, s42, 9
    s_add_u32 s42, s42, 524288
    s_lshr_b32 s31, s28, 1
    s_mul_i32 s31, s31, 3
    s_lshr_b32 s3, s29, 3
    s_add_u32 s31, s31, s3
    s_sub_u32 s31, s31, 1
    s_and_b32 s32, s28, 1
    s_lshl_b32 s32, s32, 3
    s_and_b32 s3, s29, 7
    s_lshl_b32 s3, s3, 2
    s_lshr_b32 s3, 0x64317520, s3
    s_and_b32 s3, s3, 7
    s_add_u32 s32, s32, s3
    s_and_b32 s35, s29, 3
    s_and_b32 s3, s29, 4
    s_lshl_b32 s3, s3, 1
    s_add_u32 s35, s35, s3
    s_and_b32 s3, s28, 1
    s_lshl_b32 s3, s3, 2
    s_add_u32 s35, s35, s3
K_LOADER:
    s_branch K_J7f8
K_CHM0:
K_STM0:
    s_branch K_STM4
K_STA0:
    s_branch K_STA4
K_J7f8:
    s_mov_b32 s24, s8
    s_mov_b32 s25, s9
    s_mov_b32 s26, 0xc8000
    s_mov_b32 s27, 0x20000
    v_and_b32 v12, 15, v1
    v_lshrrev_b32 v13, 4, v1
    v_bfe_u32 v14, v1, 2, 2
    v_and_b32 v15, 3, v1
    s_add_u32 s20, s6, 0x100000
    s_addc_u32 s21, s7, 0
    s_mov_b32 s22, 0x280000
    s_mov_b32 s23, 0x20000
    s_lshr_b32 s3, s30, 1
    s_mul_i32 s3, s3, 3
    s_mul_i32 s53, s31, 11
    s_add_u32 s53, s53, s3
    s_mul_i32 s3, s3, 4352
    s_and_b32 s33, s30, 1
    s_mul_i32 s56, s33, 40
    s_add_u32 s3, s3, s56
    s_add_u32 s3, s3, 81920
    v_mul_u32_u24 v17, 272, v12
    v_lshl_add_u32 v16, v13, 3, v17
    v_add_u32 v16, s3, v16
    v_add3_u32 v17, v17, 32, s3
    s_sub_u32 s56, 48, s56
    v_add_u32 v2, s56, v17
    v_cmp_eq_u32 vcc, 0, v13
    s_nop 1
    v_cndmask_b32 v26, v2, v17, vcc
    v_lshl_add_u32 v18, v13, 2, v14
    v_mul_u32_u24 v18, 272, v18
    v_lshl_add_u32 v18, v15, 3, v18
    v_add_u32 v18, s3, v18
    v_mov_b32 v21, 0xf149f2ca
    v_lshlrev_b32 v2, 2, v13
    v_sub_u32 v2, v12, v2
    s_cmp_eq_u32 s53, 0
    s_cselect_b32 s3, 0xf149f2ca, 0
    v_subrev_u32 v3, 0, v2
    v_and_b32 v4, 0x80000001, v3
    v_cmp_eq_u32 vcc, 0, v4
    s_nop 1
    v_cndmask_b32 v32, v21, 0, vcc
    v_cmp_eq_u32 vcc, 0x80000000, v4
    s_nop 1
    v_cndmask_b32 v28, v21, 0, vcc
    v_add_f32 v36, s3, v28
    v_subrev_u32 v3, 1, v2
    v_and_b32 v4, 0x80000001, v3
    v_cmp_eq_u32 vcc, 0, v4
    s_nop 1
    v_cndmask_b32 v33, v21, 0, vcc
    v_cmp_eq_u32 vcc, 0x80000000, v4
    s_nop 1
    v_cndmask_b32 v29, v21, 0, vcc
    v_add_f32 v37, s3, v29
    v_subrev_u32 v3, 2, v2
    v_and_b32 v4, 0x80000001, v3
    v_cmp_eq_u32 vcc, 0, v4
    s_nop 1
    v_cndmask_b32 v34, v21, 0, vcc
    v_cmp_eq_u32 vcc, 0x80000000, v4
    s_nop 1
    v_cndmask_b32 v30, v21, 0, vcc
    v_add_f32 v38, s3, v30
    v_subrev_u32 v3, 3, v2
    v_and_b32 v4, 0x80000001, v3
    v_cmp_eq_u32 vcc, 0, v4
    s_nop 1
    v_cndmask_b32 v35, v21, 0, vcc
    v_cmp_eq_u32 vcc, 0x80000000, v4
    s_nop 1
    v_cndmask_b32 v31, v21, 0, vcc
    v_add_f32 v39, s3, v31
    v_mov_b32 v3, 0x0c0c0c0c
    v_mov_b32 v4, 0xc0c0100
    v_cmp_eq_u32 vcc, 0, v28
    v_mov_b32 v5, 0x1000c0c
    s_nop 0
    v_cndmask_b32 v3, v3, v4, vcc
    v_cmp_eq_u32 vcc, 0, v29
    s_nop 1
    v_cndmask_b32 v40, v3, v5, vcc
    v_mov_b32 v3, 0x0c0c0c0c
    v_mov_b32 v4, 0xc0c0302
    v_cmp_eq_u32 vcc, 0, v30
    v_mov_b32 v5, 0x3020c0c
    s_nop 0
    v_cndmask_b32 v3, v3, v4, vcc
    v_cmp_eq_u32 vcc, 0, v31
    s_nop 1
    v_cndmask_b32 v41, v3, v5, vcc
    v_mov_b32 v3, 0x0c0c0c0c
    v_mov_b32 v4, 0xc0c0100
    v_cmp_eq_u32 vcc, 0, v32
    v_mov_b32 v5, 0x1000c0c
    s_nop 0
    v_cndmask_b32 v3, v3, v4, vcc
    v_cmp_eq_u32 vcc, 0, v33
    s_nop 1
    v_cndmask_b32 v42, v3, v5, vcc
    v_mov_b32 v3, 0x0c0c0c0c
    v_mov_b32 v4, 0xc0c0302
    v_cmp_eq_u32 vcc, 0, v34
    v_mov_b32 v5, 0x3020c0c
    s_nop 0
    v_cndmask_b32 v3, v3, v4, vcc
    v_cmp_eq_u32 vcc, 0, v35
    s_nop 1
    v_cndmask_b32 v43, v3, v5, vcc
    s_lshr_b32 s3, s30, 1
    s_mul_i32 s3, s3, 3
    s_and_b32 s33, s30, 1
    s_lshl_b32 s33, s33, 3
    v_lshl_add_u32 v2, v1, 4, s33
    s_lshl_b32 s33, s3, 10
    s_add_u32 s33, s33, 140288
    v_add_u32 v23, s33, v2
    s_lshl_b32 s33, s3, 8
    s_add_u32 s33, s33, 152576
    v_add_u32 v24, s33, v2
    s_lshl_b32 s33, s30, 10
    s_add_u32 s33, s33, 140288
    v_lshl_add_u32 v25, v1, 4, s33
    s_mul_i32 s60, s31, 11
    s_add_u32 s3, s60, s30
    s_lshr_b32 s33, s3, 2
    s_mul_i32 s33, s33, 76
    s_add_u32 s3, s3, s33
    s_lshr_b32 s61, s35, 2
    s_add_u32 s33, s61, s35
    s_lshl2_add_u32 s3, s33, s3
    s_lshl_b32 s3, s3, 10
    v_lshl_add_u32 v19, v1, 4, s3
    v_add_u32 v3, 163840, v19
    s_sub_u32 s3, s30, 4
    s_lshl_b32 s3, s3, 2
    v_add_u32 v4, s3, v13
    v_add_u32 v5, s60, v4
    v_lshrrev_b32 v2, 2, v5
    v_mul_u32_u24 v2, 76, v2
    v_add_lshl_u32 v2, v2, v5, 10
    v_lshl_add_u32 v2, v12, 4, v2
    s_mul_i32 s33, s61, 19456
    s_lshl_b32 s3, s35, 8
    s_add_u32 s33, s33, s3
    s_add_u32 s33, s33, 16384
    v_add_u32 v2, s33, v2
    v_mov_b32 v5, 0x10000000
    v_cmp_gt_u32 vcc, 11, v4
    s_nop 1
    v_cndmask_b32 v2, v5, v2, vcc
    s_cmp_lt_u32 s30, 3
    s_cselect_b64 vcc, -1, 0
    s_nop 1
    v_cndmask_b32 v20, v2, v3, vcc
    s_mov_b64 s[54:55], 0xffff
    s_mov_b32 s56, 0x3fb8aa3b
    s_mov_b32 s57, s56
    s_mov_b32 s58, 0x3e64f92e
    s_mov_b32 s59, s58
    s_mul_i32 s3, s31, 11
    s_add_u32 s33, s3, 10
    s_lshr_b32 s3, s3, 3
    s_lshr_b32 s33, s33, 3
    s_min_u32 s33, s33, 15
    s_sub_u32 s33, s33, s3
    s_add_u32 s33, s33, 1
    s_mul_i32 s33, s33, 10
    s_bfm_b32 s37, s33, 0
    v_mul_u32_u24 v2, 205, v1
    v_lshrrev_b32 v2, 11, v2
    v_add_u32 v2, s3, v2
    v_mul_u32_u24 v2, 1496, v2
    s_branch K_Jbbc
K_CHM1:
K_STM1:
    s_branch K_STM5
K_STA1:
    s_branch K_STA5
K_Jbbc:
    v_lshrrev_b32 v2, 11, v2
    v_sub_u32 v2, s31, v2
    v_and_b32 v2, 1, v2
    v_lshlrev_b32 v2, 2, v2
    v_lshl_add_u32 v2, v1, 9, v2
    s_mul_i32 s3, s3, 5120
    s_add_u32 s3, s3, 524288
    v_add_u32 v27, s3, v2
    s_lshr_b32 s36, s35, 2
    s_add_u32 s36, s36, s35
    s_lshl_b32 s36, 1, s36
    s_cmp_eq_u32 s30, 5
    s_cselect_b32 s36, s36, 0
    s_waitcnt vmcnt(5)
    s_barrier
    s_add_u32 m0, s46, 83968
    s_add_u32 s52, s48, 30720
    buffer_load_dwordx4 v11, s[16:19], s52 offen lds
    s_add_u32 m0, s45, 84992
    s_add_u32 s52, s51, 30720
    buffer_load_dwordx4 v9, s[12:15], s52 offen lds
    s_add_u32 m0, s46, 84992
    s_add_u32 s52, s48, 46080
    buffer_load_dwordx4 v11, s[16:19], s52 offen lds
    s_add_u32 m0, s45, 86016
    s_add_u32 s52, s51, 40960
    buffer_load_dwordx4 v8, s[12:15], s52 offen lds
    s_add_u32 m0, s45, 87040
    s_add_u32 s52, s51, 51200
    buffer_load_dwordx4 v9, s[12:15], s52 offen lds
    s_lshl_b32 s47, s49, 7
    s_mul_i32 s48, s49, 245760
    s_add_u32 s51, s44, s47
    s_add_u32 s48, s48, s50
    s_add_u32 s49, s49, 1
    s_cmp_eq_u32 s49, 10
    s_cselect_b32 s49, 0, s49
    s_add_u32 m0, s46, 0
    s_add_u32 s52, s48, 0
    buffer_load_dwordx4 v10, s[16:19], s52 offen lds
    s_add_u32 m0, s45, 0
    s_max_i32 s52, s51, s47
    buffer_load_dwordx4 v8, s[12:15], s52 offen lds
    s_add_u32 m0, s46, 1024
    s_add_u32 s52, s48, 15360
    buffer_load_dwordx4 v10, s[16:19], s52 offen lds
    s_add_u32 m0, s45, 1024
    s_add_u32 s52, s51, 10240
    s_max_i32 s52, s52, s47
    buffer_load_dwordx4 v9, s[12:15], s52 offen lds
    s_add_u32 m0, s45, 2048
    s_add_u32 s52, s51, 20480
    buffer_load_dwordx4 v8, s[12:15], s52 offen lds
    s_waitcnt vmcnt(5)
    s_barrier
    s_add_u32 m0, s46, 2048
    s_add_u32 s52, s48, 30720
    buffer_load_dwordx4 v11, s[16:19], s52 offen lds
    s_add_u32 m0, s45, 3072
    s_add_u32 s52, s51, 30720
    buffer_load_dwordx4 v9, s[12:15], s52 offen lds
    s_add_u32 m0, s46, 3072
    s_add_u32 s52, s48, 46080
    buffer_load_dwordx4 v11, s[16:19], s52 offen lds
    s_add_u32 m0, s45, 4096
    s_add_u32 s52, s51, 40960
    buffer_load_dwordx4 v8, s[12:15], s52 offen lds
    s_add_u32 m0, s45, 5120
    s_add_u32 s52, s51, 51200
    buffer_load_dwordx4 v9, s[12:15], s52 offen lds
    s_lshl_b32 s47, s49, 7
    s_mul_i32 s48, s49, 245760
    s_add_u32 s51, s44, s47
    s_add_u32 s48, s48, s50
    s_add_u32 s49, s49, 1
    s_cmp_eq_u32 s49, 10
    s_cselect_b32 s49, 0, s49
    s_add_u32 m0, s46, 40960
    s_add_u32 s52, s48, 0
    buffer_load_dwordx4 v10, s[16:19], s52 offen lds
    s_add_u32 m0, s45, 40960
    s_max_i32 s52, s51, s47
    buffer_load_dwordx4 v8, s[12:15], s52 offen lds
    s_add_u32 m0, s46, 41984
    s_add_u32 s52, s48, 15360
    buffer_load_dwordx4 v10, s[16:19], s52 offen lds
    s_add_u32 m0, s45, 41984
    s_add_u32 s52, s51, 10240
    s_max_i32 s52, s52, s47
    buffer_load_dwordx4 v9, s[12:15], s52 offen lds
    s_add_u32 m0, s45, 43008
    s_add_u32 s52, s51, 20480
    buffer_load_dwordx4 v8, s[12:15], s52 offen lds
    s_waitcnt vmcnt(5)
    s_barrier
    s_add_u32 m0, s46, 43008
    s_add_u32 s52, s48, 30720
    buffer_load_dwordx4 v11, s[16:19], s52 offen lds
    s_add_u32 m0, s45, 44032
    s_add_u32 s52, s51, 30720
    buffer_load_dwordx4 v9, s[12:15], s52 offen lds
    s_add_u32 m0, s46, 44032
    s_add_u32 s52, s48, 46080
    buffer_load_dwordx4 v11, s[16:19], s52 offen lds
    s_add_u32 m0, s45, 45056
    s_add_u32 s52, s51, 40960
    buffer_load_dwordx4 v8, s[12:15], s52 offen lds
    s_add_u32 m0, s45, 46080
    s_add_u32 s52, s51, 51200
    buffer_load_dwordx4 v9, s[12:15], s52 offen lds
    s_lshl_b32 s47, s49, 7
    s_mul_i32 s48, s49, 245760
    s_add_u32 s51, s44, s47
    s_add_u32 s48, s48, s50
    s_add_u32 s49, s49, 1
    s_cmp_eq_u32 s49, 10
    s_cselect_b32 s49, 0, s49
    s_add_u32 m0, s46, 81920
    s_add_u32 s52, s48, 0
    buffer_load_dwordx4 v10, s[16:19], s52 offen lds
    s_add_u32 m0, s45, 81920
    s_max_i32 s52, s51, s47
    buffer_load_dwordx4 v8, s[12:15], s52 offen lds
    s_add_u32 m0, s46, 82944
    s_add_u32 s52, s48, 15360
    buffer_load_dwordx4 v10, s[16:19], s52 offen lds
    s_add_u32 m0, s45, 82944
    s_add_u32 s52, s51, 10240
    s_max_i32 s52, s52, s47
    buffer_load_dwordx4 v9, s[12:15], s52 offen lds
    s_add_u32 m0, s45, 83968
    s_add_u32 s52, s51, 20480
    buffer_load_dwordx4 v8, s[12:15], s52 offen lds
    s_waitcnt vmcnt(5)
    s_barrier
    s_add_u32 m0, s46, 83968
    s_add_u32 s52, s48, 30720
    buffer_load_dwordx4 v11, s[16:19], s52 offen lds
    s_add_u32 m0, s45, 84992
    s_add_u32 s52, s51, 30720
    buffer_load_dwordx4 v9, s[12:15], s52 offen lds
    s_add_u32 m0, s46, 84992
    s_add_u32 s52, s48, 46080
    s_branch K_Jf84
K_CHM2:
K_STM2:
    s_branch K_STM6
K_STA2:
    s_branch K_STA6
K_Jf84:
    buffer_load_dwordx4 v11, s[16:19], s52 offen lds
    s_add_u32 m0, s45, 86016
    s_add_u32 s52, s51, 40960
    buffer_load_dwordx4 v8, s[12:15], s52 offen lds
    s_add_u32 m0, s45, 87040
    s_add_u32 s52, s51, 51200
    buffer_load_dwordx4 v9, s[12:15], s52 offen lds
    s_lshl_b32 s47, s49, 7
    s_mul_i32 s48, s49, 245760
    s_add_u32 s51, s44, s47
    s_add_u32 s48, s48, s50
    s_add_u32 s49, s49, 1
    s_cmp_eq_u32 s49, 10
    s_cselect_b32 s49, 0, s49
    s_add_u32 m0, s46, 0
    s_add_u32 s52, s48, 0
    buffer_load_dwordx4 v10, s[16:19], s52 offen lds
    s_add_u32 m0, s45, 0
    s_branch K_PG0
.p2align 12
K_CHM3:
K_STM3:
    s_branch K_STM7
K_STA3:
    s_branch K_STA7
K_PG0:
    s_max_i32 s52, s51, s47
    buffer_load_dwordx4 v8, s[12:15], s52 offen lds
    s_add_u32 m0, s46, 1024
    s_add_u32 s52, s48, 15360
    buffer_load_dwordx4 v10, s[16:19], s52 offen lds
    s_add_u32 m0, s45, 1024
    s_add_u32 s52, s51, 10240
    s_max_i32 s52, s52, s47
    buffer_load_dwordx4 v9, s[12:15], s52 offen lds
    s_add_u32 m0, s45, 2048
    s_add_u32 s52, s51, 20480
    buffer_load_dwordx4 v8, s[12:15], s52 offen lds
    s_waitcnt vmcnt(5)
    s_barrier
    s_add_u32 m0, s46, 2048
    s_add_u32 s52, s48, 30720
    buffer_load_dwordx4 v11, s[16:19], s52 offen lds
    s_add_u32 m0, s45, 3072
    s_add_u32 s52, s51, 30720
    buffer_load_dwordx4 v9, s[12:15], s52 offen lds
    s_add_u32 m0, s46, 3072
    s_add_u32 s52, s48, 46080
    buffer_load_dwordx4 v11, s[16:19], s52 offen lds
    s_add_u32 m0, s45, 4096
    s_add_u32 s52, s51, 40960
    buffer_load_dwordx4 v8, s[12:15], s52 offen lds
    s_add_u32 m0, s45, 5120
    s_add_u32 s52, s51, 51200
    buffer_load_dwordx4 v9, s[12:15], s52 offen lds
    s_lshl_b32 s47, s49, 7
    s_mul_i32 s48, s49, 245760
    s_add_u32 s51, s44, s47
    s_add_u32 s48, s48, s50
    s_add_u32 s49, s49, 1
    s_cmp_eq_u32 s49, 10
    s_cselect_b32 s49, 0, s49
    s_add_u32 m0, s46, 40960
    s_add_u32 s52, s48, 0
    buffer_load_dwordx4 v10, s[16:19], s52 offen lds
    s_add_u32 m0, s45, 40960
    s_max_i32 s52, s51, s47
    buffer_load_dwordx4 v8, s[12:15], s52 offen lds
    s_add_u32 m0, s46, 41984
    s_add_u32 s52, s48, 15360
    buffer_load_dwordx4 v10, s[16:19], s52 offen lds
    s_add_u32 m0, s45, 41984
    s_add_u32 s52, s51, 10240
    s_max_i32 s52, s52, s47
    buffer_load_dwordx4 v9, s[12:15], s52 offen lds
    s_add_u32 m0, s45, 43008
    s_add_u32 s52, s51, 20480
    buffer_load_dwordx4 v8, s[12:15], s52 offen lds
    v_mov_b32 v44, -1
    v_mov_b32 v45, -1
    v_mov_b32 v46, -1
    v_mov_b32 v47, -1
    v_subrev_u32 v2, 81920, v19
    s_cmp_eq_u32 s30, 7
    s_cselect_b32 s3, 0, 81920
    buffer_store_dwordx4 v[44:47], v2, s[20:23], 0 offen sc1
    buffer_store_dwordx4 v[44:47], v19, s[20:23], 0 offen sc1
    buffer_store_dwordx4 v[44:47], v19, s[20:23], s3 offen sc1
    buffer_store_dwordx4 v[44:47], v20, s[20:23], 0 offen sc1
    s_waitcnt vmcnt(9)
    s_barrier
    s_add_u32 m0, s46, 43008
    s_add_u32 s52, s48, 30720
    buffer_load_dwordx4 v11, s[16:19], s52 offen lds
    s_add_u32 m0, s45, 44032
    s_add_u32 s52, s51, 30720
    buffer_load_dwordx4 v9, s[12:15], s52 offen lds
    s_add_u32 m0, s46, 44032
    s_add_u32 s52, s48, 46080
    buffer_load_dwordx4 v11, s[16:19], s52 offen lds
    s_add_u32 m0, s45, 45056
    s_add_u32 s52, s51, 40960
    buffer_load_dwordx4 v8, s[12:15], s52 offen lds
    s_add_u32 m0, s45, 46080
    s_add_u32 s52, s51, 51200
    buffer_load_dwordx4 v9, s[12:15], s52 offen lds
    s_lshl_b32 s47, s49, 7
    s_mul_i32 s48, s49, 245760
    s_add_u32 s51, s44, s47
    s_add_u32 s48, s48, s50
    s_add_u32 s49, s49, 1
    s_cmp_eq_u32 s49, 10
    s_cselect_b32 s49, 0, s49
    s_add_u32 m0, s46, 81920
    s_add_u32 s52, s48, 0
    buffer_load_dwordx4 v10, s[16:19], s52 offen lds
    s_add_u32 m0, s45, 81920
    s_max_i32 s52, s51, s47
    buffer_load_dwordx4 v8, s[12:15], s52 offen lds
    s_add_u32 m0, s46, 82944
    s_add_u32 s52, s48, 15360
    buffer_load_dwordx4 v10, s[16:19], s52 offen lds
    s_add_u32 m0, s45, 82944
    s_add_u32 s52, s51, 10240
    s_max_i32 s52, s52, s47
    buffer_load_dwordx4 v9, s[12:15], s52 offen lds
    s_add_u32 m0, s45, 83968
    s_add_u32 s52, s51, 20480
    buffer_load_dwordx4 v8, s[12:15], s52 offen lds
    s_waitcnt vmcnt(5)
    s_barrier
    s_add_u32 m0, s46, 83968
    s_add_u32 s52, s48, 30720
    buffer_load_dwordx4 v11, s[16:19], s52 offen lds
    s_add_u32 m0, s45, 84992
    s_add_u32 s52, s51, 30720
    buffer_load_dwordx4 v9, s[12:15], s52 offen lds
    s_add_u32 m0, s46, 84992
    s_add_u32 s52, s48, 46080
    buffer_load_dwordx4 v11, s[16:19], s52 offen lds
    s_add_u32 m0, s45, 86016
    s_add_u32 s52, s51, 40960
    buffer_load_dwordx4 v8, s[12:15], s52 offen lds
    s_add_u32 m0, s45, 87040
    s_add_u32 s52, s51, 51200
    buffer_load_dwordx4 v9, s[12:15], s52 offen lds
    s_lshl_b32 s47, s49, 7
    s_mul_i32 s48, s49, 245760
    s_add_u32 s51, s44, s47
    s_add_u32 s48, s48, s50
    s_add_u32 s49, s49, 1
    s_cmp_eq_u32 s49, 10
    s_cselect_b32 s49, 0, s49
    s_add_u32 m0, s46, 0
    s_add_u32 s52, s48, 0
    buffer_load_dwordx4 v10, s[16:19], s52 offen lds
    s_add_u32 m0, s45, 0
    s_max_i32 s52, s51, s47
    buffer_load_dwordx4 v8, s[12:15], s52 offen lds
    s_add_u32 m0, s46, 1024
    s_add_u32 s52, s48, 15360
    buffer_load_dwordx4 v10, s[16:19], s52 offen lds
    s_add_u32 m0, s45, 1024
    s_add_u32 s52, s51, 10240
    s_max_i32 s52, s52, s47
    buffer_load_dwordx4 v9, s[12:15], s52 offen lds
    s_add_u32 m0, s45, 2048
    s_branch K_J13c8
K_STM4:
    s_branch K_STM8
K_STA4:
    s_branch K_STA8
K_J13c8:
    s_add_u32 s52, s51, 20480
    buffer_load_dwordx4 v8, s[12:15], s52 offen lds
    s_waitcnt vmcnt(5)
    s_barrier
    s_add_u32 m0, s46, 2048
    s_add_u32 s52, s48, 30720
    buffer_load_dwordx4 v11, s[16:19], s52 offen lds
    s_add_u32 m0, s45, 3072
    s_add_u32 s52, s51, 30720
    buffer_load_dwordx4 v9, s[12:15], s52 offen lds
    s_add_u32 m0, s46, 3072
    s_add_u32 s52, s48, 46080
    buffer_load_dwordx4 v11, s[16:19], s52 offen lds
    s_add_u32 m0, s45, 4096
    s_add_u32 s52, s51, 40960
    buffer_load_dwordx4 v8, s[12:15], s52 offen lds
    s_add_u32 m0, s45, 5120
    s_add_u32 s52, s51, 51200
    buffer_load_dwordx4 v9, s[12:15], s52 offen lds
    s_lshl_b32 s47, s49, 7
    s_mul_i32 s48, s49, 245760
    s_add_u32 s51, s44, s47
    s_add_u32 s48, s48, s50
    s_add_u32 s49, s49, 1
    s_cmp_eq_u32 s49, 10
    s_cselect_b32 s49, 0, s49
    s_add_u32 m0, s46, 40960
    s_add_u32 s52, s48, 0
    buffer_load_dwordx4 v10, s[16:19], s52 offen lds
    s_add_u32 m0, s45, 40960
    s_max_i32 s52, s51, s47
    buffer_load_dwordx4 v8, s[12:15], s52 offen lds
    s_add_u32 m0, s46, 41984
    s_add_u32 s52, s48, 15360
    buffer_load_dwordx4 v10, s[16:19], s52 offen lds
    s_add_u32 m0, s45, 41984
    s_add_u32 s52, s51, 10240
    s_max_i32 s52, s52, s47
    buffer_load_dwordx4 v9, s[12:15], s52 offen lds
    s_add_u32 m0, s45, 43008
    s_add_u32 s52, s51, 20480
    buffer_load_dwordx4 v8, s[12:15], s52 offen lds
    s_waitcnt vmcnt(5)
    s_barrier
    s_add_u32 m0, s46, 43008
    s_add_u32 s52, s48, 30720
    buffer_load_dwordx4 v11, s[16:19], s52 offen lds
    s_add_u32 m0, s45, 44032
    s_add_u32 s52, s51, 30720
    buffer_load_dwordx4 v9, s[12:15], s52 offen lds
    s_add_u32 m0, s46, 44032
    s_add_u32 s52, s48, 46080
    buffer_load_dwordx4 v11, s[16:19], s52 offen lds
    s_add_u32 m0, s45, 45056
    s_add_u32 s52, s51, 40960
    buffer_load_dwordx4 v8, s[12:15], s52 offen lds
    s_add_u32 m0, s45, 46080
    s_add_u32 s52, s51, 51200
    buffer_load_dwordx4 v9, s[12:15], s52 offen lds
    s_waitcnt vmcnt(0)
    s_barrier
    s_load_dword s49, s[4:5], 192
    s_cmp_eq_u32 s34, -1
    s_cbranch_scc1 K_NOLT
    v_lshrrev_b32 v2, 3, v1
    v_mul_u32_u24 v2, 1280, v2
    v_lshrrev_b32 v3, 2, v1
    v_and_b32 v3, 4, v3
    v_and_b32 v4, 7, v1
    v_xor_b32 v3, v3, v4
    v_lshl_add_u32 v2, v3, 4, v2
    s_lshl_b32 s33, s41, 7
    v_add_u32 v22, s33, v2
    v_lshrrev_b32 v5, 5, v1
    v_mul_u32_u24 v5, 97280, v5
    v_add_u32 v5, v5, v22
    s_lshl_b32 s47, s43, 2
    s_lshr_b32 s47, 0x7520, s47
    s_and_b32 s47, s47, 7
    s_mul_i32 s47, s47, 51200
    s_lshl_b32 s48, s43, 12
    s_add_u32 s3, s47, 0
    s_add_u32 m0, s48, 0
    s_nop 0
    buffer_load_dwordx4 v22, s[24:27], s3 offen lds
    s_add_u32 s3, s47, 10240
    s_add_u32 m0, s48, 1024
    s_nop 0
    buffer_load_dwordx4 v22, s[24:27], s3 offen lds
    s_add_u32 s3, s47, 25600
    s_add_u32 m0, s48, 2048
    s_nop 0
    buffer_load_dwordx4 v22, s[24:27], s3 offen lds
    s_add_u32 s3, s47, 35840
    s_add_u32 m0, s48, 3072
    s_nop 0
    buffer_load_dwordx4 v22, s[24:27], s3 offen lds
    s_add_u32 s3, s47, 409600
    s_add_u32 m0, s48, 20480
    s_nop 0
    buffer_load_dwordx4 v22, s[24:27], s3 offen lds
    s_add_u32 s3, s47, 419840
    s_add_u32 m0, s48, 21504
    s_nop 0
    buffer_load_dwordx4 v22, s[24:27], s3 offen lds
    s_add_u32 s3, s47, 435200
    s_add_u32 m0, s48, 22528
    s_nop 0
    buffer_load_dwordx4 v22, s[24:27], s3 offen lds
    s_add_u32 s3, s47, 445440
    s_add_u32 m0, s48, 23552
    s_nop 0
    buffer_load_dwordx4 v22, s[24:27], s3 offen lds
    s_and_b32 s47, s43, 1
    s_mul_i32 s47, s47, 256000
    s_lshr_b32 s48, s43, 1
    s_mul_i32 s48, s48, 25600
    s_add_u32 s47, s47, s48
    s_lshl_b32 s48, s43, 10
    s_add_u32 s3, s47, 20480
    s_add_u32 m0, s48, 16384
    s_nop 0
    buffer_load_dwordx4 v5, s[24:27], s3 offen lds
    s_add_u32 s3, s47, 430080
    s_add_u32 m0, s48, 36864
    s_nop 0
    buffer_load_dwordx4 v5, s[24:27], s3 offen lds
    s_waitcnt lgkmcnt(0)
    s_cmp_ge_u32 s49, 8
    s_cbranch_scc1 K_ZO0
    s_load_dword s33, s[4:5], 128
    s_waitcnt lgkmcnt(0)
    s_cmp_ge_u32 s33, 8
    s_cbranch_scc1 K_ZO0
    s_sleep 8
    s_mov_b32 s3, 16384
K_ZB0:
    s_load_dword s33, s[4:5], 128 glc
    s_waitcnt lgkmcnt(0)
    s_cmp_ge_u32 s33, 8
    s_cbranch_scc1 K_ZO0
    s_sleep 32
    s_sub_u32 s3, s3, 1
    s_cbranch_scc0 K_ZB0
K_ZO0:
    s_waitcnt vmcnt(10)
    s_barrier
    s_lshl_b32 s47, s43, 2
    s_lshr_b32 s47, 0x6431, s47
    s_and_b32 s47, s47, 7
    s_mul_i32 s47, s47, 51200
    s_lshl_b32 s48, s43, 12
    s_add_u32 s3, s47, 0
    s_branch K_J178c
K_STM5:
    s_branch K_STM9
K_STA5:
    s_branch K_STA9
K_J178c:
    s_add_u32 m0, s48, 40960
    s_nop 0
    buffer_load_dwordx4 v22, s[24:27], s3 offen lds
    s_add_u32 s3, s47, 10240
    s_add_u32 m0, s48, 41984
    s_nop 0
    buffer_load_dwordx4 v22, s[24:27], s3 offen lds
    s_add_u32 s3, s47, 25600
    s_add_u32 m0, s48, 43008
    s_nop 0
    buffer_load_dwordx4 v22, s[24:27], s3 offen lds
    s_add_u32 s3, s47, 35840
    s_add_u32 m0, s48, 44032
    s_nop 0
    buffer_load_dwordx4 v22, s[24:27], s3 offen lds
    s_add_u32 s3, s47, 409600
    s_add_u32 m0, s48, 61440
    s_nop 0
    buffer_load_dwordx4 v22, s[24:27], s3 offen lds
    s_add_u32 s3, s47, 419840
    s_add_u32 m0, s48, 62464
    s_nop 0
    buffer_load_dwordx4 v22, s[24:27], s3 offen lds
    s_add_u32 s3, s47, 435200
    s_add_u32 m0, s48, 63488
    s_nop 0
    buffer_load_dwordx4 v22, s[24:27], s3 offen lds
    s_add_u32 s3, s47, 445440
    s_add_u32 m0, s48, 64512
    s_nop 0
    buffer_load_dwordx4 v22, s[24:27], s3 offen lds
    s_and_b32 s47, s43, 1
    s_mul_i32 s47, s47, 153600
    s_lshr_b32 s48, s43, 1
    s_mul_i32 s48, s48, 25600
    s_add_u32 s47, s47, s48
    s_lshl_b32 s48, s43, 10
    s_add_u32 s3, s47, 71680
    s_add_u32 m0, s48, 57344
    s_nop 0
    buffer_load_dwordx4 v5, s[24:27], s3 offen lds
    s_add_u32 s3, s47, 481280
    s_add_u32 m0, s48, 77824
    s_nop 0
    buffer_load_dwordx4 v5, s[24:27], s3 offen lds
    s_branch K_JOIN2
K_NOLT:
    s_waitcnt lgkmcnt(0)
    s_cmp_ge_u32 s49, 8
    s_cbranch_scc1 K_ZO1
    s_load_dword s33, s[4:5], 128
    s_waitcnt lgkmcnt(0)
    s_cmp_ge_u32 s33, 8
    s_cbranch_scc1 K_ZO1
    s_sleep 8
    s_mov_b32 s3, 16384
K_ZB1:
    s_load_dword s33, s[4:5], 128 glc
    s_waitcnt lgkmcnt(0)
    s_cmp_ge_u32 s33, 8
    s_cbranch_scc1 K_ZO1
    s_sleep 32
    s_sub_u32 s3, s3, 1
    s_cbranch_scc0 K_ZB1
K_ZO1:
    s_waitcnt vmcnt(0)
    s_branch K_JOIN
K_CONS:
    s_mov_b32 s36, 0
    s_mov_b32 s37, 0
    v_mov_b32 v27, 0
    v_and_b32 v1, 63, v0
    v_mov_b32 v7, 0
    s_and_b32 s28, s2, 7
    s_lshr_b32 s29, s2, 3
    s_xor_b32 s30, s30, 4
    s_lshr_b32 s34, s29, 3
    s_lshl_b32 s34, s34, 2
    s_and_b32 s3, s29, 3
    s_add_u32 s34, s34, s3
    s_add_u32 s34, s34, 4
    s_bitcmp1_b32 s29, 2
    s_cselect_b32 s34, -1, s34
    s_cmp_lt_u32 s29, 8
    s_cselect_b32 s34, s29, s34
    s_lshl_b32 s40, s28, 1
    s_cmp_ge_u32 s34, 10
    s_addc_u32 s40, s40, 0
    s_sub_u32 s41, s34, 10
    s_cmp_ge_u32 s34, 10
    s_cselect_b32 s41, s41, s34
    s_mul_i32 s42, s28, 20
    s_add_u32 s42, s42, s34
    s_and_b32 s42, s42, 255
    s_lshl_b32 s42, s42, 9
    s_add_u32 s42, s42, 524288
    v_mov_b32 v3, 158736
    ds_write2_b32 v3, v7, v7 offset0:0 offset1:1
    ds_write2_b32 v3, v7, v7 offset0:2 offset1:3
    ds_write2_b32 v3, v7, v7 offset0:4 offset1:5
    ds_write2_b32 v3, v7, v7 offset0:6 offset1:7
    ds_write2_b32 v3, v7, v7 offset0:8 offset1:9
    s_lshr_b32 s31, s28, 1
    s_mul_i32 s31, s31, 3
    s_lshr_b32 s3, s29, 3
    s_add_u32 s31, s31, s3
    s_sub_u32 s31, s31, 1
    s_and_b32 s32, s28, 1
    s_lshl_b32 s32, s32, 3
    s_and_b32 s3, s29, 7
    s_lshl_b32 s3, s3, 2
    s_lshr_b32 s3, 0x64317520, s3
    s_and_b32 s3, s3, 7
    s_add_u32 s32, s32, s3
    s_and_b32 s35, s29, 3
    s_and_b32 s3, s29, 4
    s_lshl_b32 s3, s3, 1
    s_add_u32 s35, s35, s3
    s_and_b32 s3, s28, 1
    s_lshl_b32 s3, s3, 2
    s_add_u32 s35, s35, s3
    v_and_b32 v12, 15, v1
    v_lshrrev_b32 v13, 4, v1
    v_bfe_u32 v14, v1, 2, 2
    v_and_b32 v15, 3, v1
    s_lshr_b32 s63, s30, 1
    s_and_b32 s64, s30, 1
    v_lshrrev_b32 v2, 1, v12
    v_xor_b32 v2, v2, v13
    v_lshlrev_b32 v2, 4, v2
    v_lshl_add_u32 v2, v12, 7, v2
    s_mul_i32 s3, s63, 12288
    v_add_u32 v44, s3, v2
    v_xor_b32 v45, 64, v44
    v_add_u32 v46, 81920, v44
    v_add_u32 v47, 81920, v45
    v_and_b32 v2, 1, v13
    v_lshl_or_b32 v2, v2, 2, v14
    v_lshl_add_u32 v3, v13, 3, v14
    v_lshlrev_b32 v3, 8, v3
    v_lshl_add_u32 v3, v15, 3, v3
    v_add_u32 v3, 24576, v3
    s_lshl_b32 s3, s64, 2
    v_add_u32 v2, s3, v2
    v_add_u32 v4, 0, v2
    v_and_b32 v4, 7, v4
    v_lshl_add_u32 v48, v4, 5, v3
    v_add_u32 v52, 81920, v48
    v_add_u32 v4, 1, v2
    v_and_b32 v4, 7, v4
    v_lshl_add_u32 v49, v4, 5, v3
    v_add_u32 v53, 81920, v49
    v_add_u32 v4, 2, v2
    v_and_b32 v4, 7, v4
    v_lshl_add_u32 v50, v4, 5, v3
    v_add_u32 v54, 81920, v50
    v_add_u32 v4, 3, v2
    v_and_b32 v4, 7, v4
    v_lshl_add_u32 v51, v4, 5, v3
    v_add_u32 v55, 81920, v51
    v_mul_u32_u24 v56, 272, v12
    v_lshl_add_u32 v56, v13, 3, v56
    s_mul_i32 s3, s63, 26112
    s_lshl_b32 s33, s64, 7
    s_add_u32 s3, s3, s33
    s_add_u32 s3, s3, 81920
    v_add_u32 v56, s3, v56
    s_waitcnt lgkmcnt(0)
    s_mov_b32 s24, s8
    s_mov_b32 s25, s9
    s_mov_b32 s26, 0xc8000
    s_mov_b32 s27, 0x20000
    s_add_u32 s20, s6, 0x100000
    s_addc_u32 s21, s7, 0
    s_mov_b32 s22, 0x280000
    s_branch K_J1b54
K_STM6:
    s_branch K_STM10
K_STA6:
    s_branch K_STA10
K_J1b54:
    s_mov_b32 s23, 0x20000
    s_lshr_b32 s3, s30, 1
    s_mul_i32 s3, s3, 3
    s_mul_i32 s53, s31, 11
    s_add_u32 s53, s53, s3
    s_mul_i32 s3, s3, 4352
    s_and_b32 s33, s30, 1
    s_mul_i32 s56, s33, 40
    s_add_u32 s3, s3, s56
    s_add_u32 s3, s3, 81920
    v_mul_u32_u24 v17, 272, v12
    v_lshl_add_u32 v16, v13, 3, v17
    v_add_u32 v16, s3, v16
    v_add3_u32 v17, v17, 32, s3
    s_sub_u32 s56, 48, s56
    v_add_u32 v2, s56, v17
    v_cmp_eq_u32 vcc, 0, v13
    s_nop 1
    v_cndmask_b32 v26, v2, v17, vcc
    v_lshl_add_u32 v18, v13, 2, v14
    v_mul_u32_u24 v18, 272, v18
    v_lshl_add_u32 v18, v15, 3, v18
    v_add_u32 v18, s3, v18
    v_mov_b32 v21, 0xf149f2ca
    v_lshlrev_b32 v2, 2, v13
    v_sub_u32 v2, v12, v2
    s_cmp_eq_u32 s53, 0
    s_cselect_b32 s3, 0xf149f2ca, 0
    v_subrev_u32 v3, 0, v2
    v_and_b32 v4, 0x80000001, v3
    v_cmp_eq_u32 vcc, 0, v4
    s_nop 1
    v_cndmask_b32 v32, v21, 0, vcc
    v_cmp_eq_u32 vcc, 0x80000000, v4
    s_nop 1
    v_cndmask_b32 v28, v21, 0, vcc
    v_add_f32 v36, s3, v28
    v_subrev_u32 v3, 1, v2
    v_and_b32 v4, 0x80000001, v3
    v_cmp_eq_u32 vcc, 0, v4
    s_nop 1
    v_cndmask_b32 v33, v21, 0, vcc
    v_cmp_eq_u32 vcc, 0x80000000, v4
    s_nop 1
    v_cndmask_b32 v29, v21, 0, vcc
    v_add_f32 v37, s3, v29
    v_subrev_u32 v3, 2, v2
    v_and_b32 v4, 0x80000001, v3
    v_cmp_eq_u32 vcc, 0, v4
    s_nop 1
    v_cndmask_b32 v34, v21, 0, vcc
    v_cmp_eq_u32 vcc, 0x80000000, v4
    s_nop 1
    v_cndmask_b32 v30, v21, 0, vcc
    v_add_f32 v38, s3, v30
    v_subrev_u32 v3, 3, v2
    v_and_b32 v4, 0x80000001, v3
    v_cmp_eq_u32 vcc, 0, v4
    s_nop 1
    v_cndmask_b32 v35, v21, 0, vcc
    v_cmp_eq_u32 vcc, 0x80000000, v4
    s_nop 1
    v_cndmask_b32 v31, v21, 0, vcc
    v_add_f32 v39, s3, v31
    v_mov_b32 v3, 0x0c0c0c0c
    v_mov_b32 v4, 0xc0c0100
    v_cmp_eq_u32 vcc, 0, v28
    v_mov_b32 v5, 0x1000c0c
    s_nop 0
    v_cndmask_b32 v3, v3, v4, vcc
    v_cmp_eq_u32 vcc, 0, v29
    s_nop 1
    v_cndmask_b32 v40, v3, v5, vcc
    v_mov_b32 v3, 0x0c0c0c0c
    v_mov_b32 v4, 0xc0c0302
    v_cmp_eq_u32 vcc, 0, v30
    v_mov_b32 v5, 0x3020c0c
    s_nop 0
    v_cndmask_b32 v3, v3, v4, vcc
    v_cmp_eq_u32 vcc, 0, v31
    s_nop 1
    v_cndmask_b32 v41, v3, v5, vcc
    v_mov_b32 v3, 0x0c0c0c0c
    v_mov_b32 v4, 0xc0c0100
    v_cmp_eq_u32 vcc, 0, v32
    v_mov_b32 v5, 0x1000c0c
    s_nop 0
    v_cndmask_b32 v3, v3, v4, vcc
    v_cmp_eq_u32 vcc, 0, v33
    s_nop 1
    v_cndmask_b32 v42, v3, v5, vcc
    v_mov_b32 v3, 0x0c0c0c0c
    v_mov_b32 v4, 0xc0c0302
    v_cmp_eq_u32 vcc, 0, v34
    v_mov_b32 v5, 0x3020c0c
    s_nop 0
    v_cndmask_b32 v3, v3, v4, vcc
    v_cmp_eq_u32 vcc, 0, v35
    s_nop 1
    v_cndmask_b32 v43, v3, v5, vcc
    s_lshr_b32 s3, s30, 1
    s_mul_i32 s3, s3, 3
    s_and_b32 s33, s30, 1
    s_lshl_b32 s33, s33, 3
    v_lshl_add_u32 v2, v1, 4, s33
    s_lshl_b32 s33, s3, 10
    s_add_u32 s33, s33, 140288
    v_add_u32 v23, s33, v2
    s_lshl_b32 s33, s3, 8
    s_add_u32 s33, s33, 152576
    v_add_u32 v24, s33, v2
    s_lshl_b32 s33, s30, 10
    s_add_u32 s33, s33, 140288
    v_lshl_add_u32 v25, v1, 4, s33
    s_mul_i32 s60, s31, 11
    s_add_u32 s3, s60, s30
    s_lshr_b32 s33, s3, 2
    s_mul_i32 s33, s33, 76
    s_add_u32 s3, s3, s33
    s_lshr_b32 s61, s35, 2
    s_add_u32 s33, s61, s35
    s_lshl2_add_u32 s3, s33, s3
    s_lshl_b32 s3, s3, 10
    v_lshl_add_u32 v19, v1, 4, s3
    v_add_u32 v3, 163840, v19
    s_sub_u32 s3, s30, 4
    s_lshl_b32 s3, s3, 2
    v_add_u32 v4, s3, v13
    v_add_u32 v5, s60, v4
    v_lshrrev_b32 v2, 2, v5
    v_mul_u32_u24 v2, 76, v2
    v_add_lshl_u32 v2, v2, v5, 10
    v_lshl_add_u32 v2, v12, 4, v2
    s_mul_i32 s33, s61, 19456
    s_lshl_b32 s3, s35, 8
    s_add_u32 s33, s33, s3
    s_add_u32 s33, s33, 16384
    v_add_u32 v2, s33, v2
    v_mov_b32 v5, 0x10000000
    v_cmp_gt_u32 vcc, 11, v4
    s_nop 1
    v_cndmask_b32 v2, v5, v2, vcc
    s_cmp_lt_u32 s30, 3
    s_cselect_b64 vcc, -1, 0
    s_nop 1
    v_cndmask_b32 v20, v2, v3, vcc
    s_mov_b64 s[54:55], 0xffff
    s_mov_b32 s56, 0x3fb8aa3b
    s_mov_b32 s57, s56
    s_mov_b32 s58, 0x3e64f92e
    s_mov_b32 s59, s58
    s_cmp_eq_u32 s30, 0
    s_cbranch_scc1 K_CHM0
    s_cmp_eq_u32 s30, 1
    s_cbranch_scc1 K_CHM1
    s_cmp_eq_u32 s30, 2
    s_cbranch_scc1 K_CHM2
    s_branch K_CHM3
K_WRET_M:
    s_setprio 2
    s_barrier
    ds_read_b64_tr_b16 v[204:205], v48 offset:40960
    ds_read_b64_tr_b16 v[206:207], v48 offset:41984
    ds_read_b128 v[156:159], v44 offset:40960
    ds_read_b64_tr_b16 v[208:209], v49 offset:40960
    ds_read_b64_tr_b16 v[210:211], v49 offset:41984
    ds_read_b128 v[160:163], v44 offset:43008
    ds_read_b64_tr_b16 v[212:213], v50 offset:40960
    ds_read_b64_tr_b16 v[214:215], v50 offset:41984
    ds_read_b128 v[164:167], v44 offset:45056
    ds_read_b64_tr_b16 v[216:217], v51 offset:40960
    ds_read_b64_tr_b16 v[218:219], v51 offset:41984
    s_branch K_J1f18
K_STM7:
    s_branch K_STM11
K_STA7:
    s_branch K_STA11
K_J1f18:
    ds_read_b128 v[168:171], v44 offset:47104
    ds_read_b128 v[172:175], v44 offset:49152
    ds_read_b128 v[176:179], v44 offset:51200
    s_waitcnt lgkmcnt(0)
    v_mfma_f32_16x16x32_bf16 v[60:63], v[204:207], v[156:159], 0
    ds_read_b64_tr_b16 v[220:221], v48 offset:49152
    v_mfma_f32_16x16x32_bf16 v[64:67], v[208:211], v[156:159], 0
    ds_read_b64_tr_b16 v[222:223], v48 offset:50176
    v_mfma_f32_16x16x32_bf16 v[68:71], v[212:215], v[156:159], 0
    ds_read_b128 v[180:183], v45 offset:40960
    v_mfma_f32_16x16x32_bf16 v[72:75], v[216:219], v[156:159], 0
    ds_read_b64_tr_b16 v[224:225], v49 offset:49152
    v_mfma_f32_16x16x32_bf16 v[88:91], v[216:219], v[160:163], 0
    ds_read_b64_tr_b16 v[226:227], v49 offset:50176
    v_mfma_f32_16x16x32_bf16 v[84:87], v[212:215], v[160:163], 0
    ds_read_b128 v[184:187], v45 offset:43008
    v_mfma_f32_16x16x32_bf16 v[80:83], v[208:211], v[160:163], 0
    ds_read_b64_tr_b16 v[228:229], v50 offset:49152
    v_mfma_f32_16x16x32_bf16 v[76:79], v[204:207], v[160:163], 0
    ds_read_b64_tr_b16 v[230:231], v50 offset:50176
    v_mfma_f32_16x16x32_bf16 v[92:95], v[204:207], v[164:167], 0
    ds_read_b128 v[188:191], v45 offset:45056
    v_mfma_f32_16x16x32_bf16 v[96:99], v[208:211], v[164:167], 0
    ds_read_b64_tr_b16 v[232:233], v51 offset:49152
    v_mfma_f32_16x16x32_bf16 v[100:103], v[212:215], v[164:167], 0
    ds_read_b64_tr_b16 v[234:235], v51 offset:50176
    v_mfma_f32_16x16x32_bf16 v[104:107], v[216:219], v[164:167], 0
    s_branch K_PG1
.p2align 12
K_STM8:
    s_branch K_STM12
K_STA8:
    s_branch K_STA12
K_PG1:
    ds_read_b128 v[192:195], v45 offset:47104
    v_mfma_f32_16x16x32_bf16 v[120:123], v[216:219], v[168:171], 0
    ds_read_b128 v[196:199], v45 offset:49152
    v_mfma_f32_16x16x32_bf16 v[116:119], v[212:215], v[168:171], 0
    ds_read_b128 v[200:203], v45 offset:51200
    v_mfma_f32_16x16x32_bf16 v[112:115], v[208:211], v[168:171], 0
    v_mfma_f32_16x16x32_bf16 v[108:111], v[204:207], v[168:171], 0
    v_mfma_f32_16x16x32_bf16 v[124:127], v[204:207], v[172:175], 0
    v_mfma_f32_16x16x32_bf16 v[128:131], v[208:211], v[172:175], 0
    v_mfma_f32_16x16x32_bf16 v[132:135], v[212:215], v[172:175], 0
    v_mfma_f32_16x16x32_bf16 v[136:139], v[216:219], v[172:175], 0
    v_mfma_f32_16x16x32_bf16 v[152:155], v[216:219], v[176:179], 0
    v_mfma_f32_16x16x32_bf16 v[148:151], v[212:215], v[176:179], 0
    v_mfma_f32_16x16x32_bf16 v[144:147], v[208:211], v[176:179], 0
    v_mfma_f32_16x16x32_bf16 v[140:143], v[204:207], v[176:179], 0
    s_waitcnt lgkmcnt(0)
    s_barrier
    v_mfma_f32_16x16x32_bf16 v[60:63], v[220:223], v[180:183], v[60:63]
    ds_read_b64_tr_b16 v[204:205], v52 offset:0
    v_mfma_f32_16x16x32_bf16 v[64:67], v[224:227], v[180:183], v[64:67]
    ds_read_b64_tr_b16 v[206:207], v52 offset:1024
    v_mfma_f32_16x16x32_bf16 v[68:71], v[228:231], v[180:183], v[68:71]
    ds_read_b128 v[156:159], v46 offset:0
    v_mfma_f32_16x16x32_bf16 v[72:75], v[232:235], v[180:183], v[72:75]
    ds_read_b64_tr_b16 v[208:209], v53 offset:0
    v_mfma_f32_16x16x32_bf16 v[88:91], v[232:235], v[184:187], v[88:91]
    ds_read_b64_tr_b16 v[210:211], v53 offset:1024
    v_mfma_f32_16x16x32_bf16 v[84:87], v[228:231], v[184:187], v[84:87]
    ds_read_b128 v[160:163], v46 offset:2048
    v_mfma_f32_16x16x32_bf16 v[80:83], v[224:227], v[184:187], v[80:83]
    ds_read_b64_tr_b16 v[212:213], v54 offset:0
    v_mfma_f32_16x16x32_bf16 v[76:79], v[220:223], v[184:187], v[76:79]
    ds_read_b64_tr_b16 v[214:215], v54 offset:1024
    v_mfma_f32_16x16x32_bf16 v[92:95], v[220:223], v[188:191], v[92:95]
    ds_read_b128 v[164:167], v46 offset:4096
    v_mfma_f32_16x16x32_bf16 v[96:99], v[224:227], v[188:191], v[96:99]
    ds_read_b64_tr_b16 v[216:217], v55 offset:0
    v_mfma_f32_16x16x32_bf16 v[100:103], v[228:231], v[188:191], v[100:103]
    ds_read_b64_tr_b16 v[218:219], v55 offset:1024
    v_mfma_f32_16x16x32_bf16 v[104:107], v[232:235], v[188:191], v[104:107]
    ds_read_b128 v[168:171], v46 offset:6144
    v_mfma_f32_16x16x32_bf16 v[120:123], v[232:235], v[192:195], v[120:123]
    ds_read_b128 v[172:175], v46 offset:8192
    v_mfma_f32_16x16x32_bf16 v[116:119], v[228:231], v[192:195], v[116:119]
    ds_read_b128 v[176:179], v46 offset:10240
    v_mfma_f32_16x16x32_bf16 v[112:115], v[224:227], v[192:195], v[112:115]
    v_mfma_f32_16x16x32_bf16 v[108:111], v[220:223], v[192:195], v[108:111]
    v_mfma_f32_16x16x32_bf16 v[124:127], v[220:223], v[196:199], v[124:127]
    v_mfma_f32_16x16x32_bf16 v[128:131], v[224:227], v[196:199], v[128:131]
    v_mfma_f32_16x16x32_bf16 v[132:135], v[228:231], v[196:199], v[132:135]
    v_mfma_f32_16x16x32_bf16 v[136:139], v[232:235], v[196:199], v[136:139]
    v_mfma_f32_16x16x32_bf16 v[152:155], v[232:235], v[200:203], v[152:155]
    v_mfma_f32_16x16x32_bf16 v[148:151], v[228:231], v[200:203], v[148:151]
    v_mfma_f32_16x16x32_bf16 v[144:147], v[224:227], v[200:203], v[144:147]
    v_mfma_f32_16x16x32_bf16 v[140:143], v[220:223], v[200:203], v[140:143]
    s_waitcnt lgkmcnt(0)
    v_mfma_f32_16x16x32_bf16 v[60:63], v[204:207], v[156:159], v[60:63]
    ds_read_b64_tr_b16 v[220:221], v52 offset:8192
    v_mfma_f32_16x16x32_bf16 v[64:67], v[208:211], v[156:159], v[64:67]
    ds_read_b64_tr_b16 v[222:223], v52 offset:9216
    v_mfma_f32_16x16x32_bf16 v[68:71], v[212:215], v[156:159], v[68:71]
    ds_read_b128 v[180:183], v47 offset:0
    v_mfma_f32_16x16x32_bf16 v[72:75], v[216:219], v[156:159], v[72:75]
    ds_read_b64_tr_b16 v[224:225], v53 offset:8192
    v_mfma_f32_16x16x32_bf16 v[88:91], v[216:219], v[160:163], v[88:91]
    ds_read_b64_tr_b16 v[226:227], v53 offset:9216
    v_mfma_f32_16x16x32_bf16 v[84:87], v[212:215], v[160:163], v[84:87]
    ds_read_b128 v[184:187], v47 offset:2048
    v_mfma_f32_16x16x32_bf16 v[80:83], v[208:211], v[160:163], v[80:83]
    ds_read_b64_tr_b16 v[228:229], v54 offset:8192
    v_mfma_f32_16x16x32_bf16 v[76:79], v[204:207], v[160:163], v[76:79]
    ds_read_b64_tr_b16 v[230:231], v54 offset:9216
    v_mfma_f32_16x16x32_bf16 v[92:95], v[204:207], v[164:167], v[92:95]
    ds_read_b128 v[188:191], v47 offset:4096
    v_mfma_f32_16x16x32_bf16 v[96:99], v[208:211], v[164:167], v[96:99]
    ds_read_b64_tr_b16 v[232:233], v55 offset:8192
    v_mfma_f32_16x16x32_bf16 v[100:103], v[212:215], v[164:167], v[100:103]
    ds_read_b64_tr_b16 v[234:235], v55 offset:9216
    v_mfma_f32_16x16x32_bf16 v[104:107], v[216:219], v[164:167], v[104:107]
    ds_read_b128 v[192:195], v47 offset:6144
    v_mfma_f32_16x16x32_bf16 v[120:123], v[216:219], v[168:171], v[120:123]
    ds_read_b128 v[196:199], v47 offset:8192
    v_mfma_f32_16x16x32_bf16 v[116:119], v[212:215], v[168:171], v[116:119]
    ds_read_b128 v[200:203], v47 offset:10240
    v_mfma_f32_16x16x32_bf16 v[112:115], v[208:211], v[168:171], v[112:115]
    v_mfma_f32_16x16x32_bf16 v[108:111], v[204:207], v[168:171], v[108:111]
    v_mfma_f32_16x16x32_bf16 v[124:127], v[204:207], v[172:175], v[124:127]
    v_mfma_f32_16x16x32_bf16 v[128:131], v[208:211], v[172:175], v[128:131]
    v_mfma_f32_16x16x32_bf16 v[132:135], v[212:215], v[172:175], v[132:135]
    v_mfma_f32_16x16x32_bf16 v[136:139], v[216:219], v[172:175], v[136:139]
    v_mfma_f32_16x16x32_bf16 v[152:155], v[216:219], v[176:179], v[152:155]
    v_mfma_f32_16x16x32_bf16 v[148:151], v[212:215], v[176:179], v[148:151]
    v_mfma_f32_16x16x32_bf16 v[144:147], v[208:211], v[176:179], v[144:147]
    v_mfma_f32_16x16x32_bf16 v[140:143], v[204:207], v[176:179], v[140:143]
    s_waitcnt lgkmcnt(0)
    s_barrier
    v_mfma_f32_16x16x32_bf16 v[60:63], v[220:223], v[180:183], v[60:63]
    ds_read_b64_tr_b16 v[204:205], v48 offset:0
    v_mfma_f32_16x16x32_bf16 v[64:67], v[224:227], v[180:183], v[64:67]
    ds_read_b64_tr_b16 v[206:207], v48 offset:1024
    v_mfma_f32_16x16x32_bf16 v[68:71], v[228:231], v[180:183], v[68:71]
    ds_read_b128 v[156:159], v44 offset:0
    v_mfma_f32_16x16x32_bf16 v[72:75], v[232:235], v[180:183], v[72:75]
    ds_read_b64_tr_b16 v[208:209], v49 offset:0
    v_mfma_f32_16x16x32_bf16 v[88:91], v[232:235], v[184:187], v[88:91]
    ds_read_b64_tr_b16 v[210:211], v49 offset:1024
    v_mfma_f32_16x16x32_bf16 v[84:87], v[228:231], v[184:187], v[84:87]
    ds_read_b128 v[160:163], v44 offset:2048
    v_mfma_f32_16x16x32_bf16 v[80:83], v[224:227], v[184:187], v[80:83]
    ds_read_b64_tr_b16 v[212:213], v50 offset:0
    v_mfma_f32_16x16x32_bf16 v[76:79], v[220:223], v[184:187], v[76:79]
    ds_read_b64_tr_b16 v[214:215], v50 offset:1024
    v_mfma_f32_16x16x32_bf16 v[92:95], v[220:223], v[188:191], v[92:95]
    ds_read_b128 v[164:167], v44 offset:4096
    v_mfma_f32_16x16x32_bf16 v[96:99], v[224:227], v[188:191], v[96:99]
    ds_read_b64_tr_b16 v[216:217], v51 offset:0
    v_mfma_f32_16x16x32_bf16 v[100:103], v[228:231], v[188:191], v[100:103]
    ds_read_b64_tr_b16 v[218:219], v51 offset:1024
    v_mfma_f32_16x16x32_bf16 v[104:107], v[232:235], v[188:191], v[104:107]
    ds_read_b128 v[168:171], v44 offset:6144
    v_mfma_f32_16x16x32_bf16 v[120:123], v[232:235], v[192:195], v[120:123]
    ds_read_b128 v[172:175], v44 offset:8192
    v_mfma_f32_16x16x32_bf16 v[116:119], v[228:231], v[192:195], v[116:119]
    s_branch K_J23cc
K_STM9:
    s_branch K_STM13
K_STA9:
    s_branch K_STA13
K_J23cc:
    ds_read_b128 v[176:179], v44 offset:10240
    v_mfma_f32_16x16x32_bf16 v[112:115], v[224:227], v[192:195], v[112:115]
    v_mfma_f32_16x16x32_bf16 v[108:111], v[220:223], v[192:195], v[108:111]
    v_mfma_f32_16x16x32_bf16 v[124:127], v[220:223], v[196:199], v[124:127]
    v_mfma_f32_16x16x32_bf16 v[128:131], v[224:227], v[196:199], v[128:131]
    v_mfma_f32_16x16x32_bf16 v[132:135], v[228:231], v[196:199], v[132:135]
    v_mfma_f32_16x16x32_bf16 v[136:139], v[232:235], v[196:199], v[136:139]
    v_mfma_f32_16x16x32_bf16 v[152:155], v[232:235], v[200:203], v[152:155]
    v_mfma_f32_16x16x32_bf16 v[148:151], v[228:231], v[200:203], v[148:151]
    v_mfma_f32_16x16x32_bf16 v[144:147], v[224:227], v[200:203], v[144:147]
    v_mfma_f32_16x16x32_bf16 v[140:143], v[220:223], v[200:203], v[140:143]
    s_waitcnt lgkmcnt(0)
    v_mfma_f32_16x16x32_bf16 v[60:63], v[204:207], v[156:159], v[60:63]
    ds_read_b64_tr_b16 v[220:221], v48 offset:8192
    v_mfma_f32_16x16x32_bf16 v[64:67], v[208:211], v[156:159], v[64:67]
    ds_read_b64_tr_b16 v[222:223], v48 offset:9216
    v_mfma_f32_16x16x32_bf16 v[68:71], v[212:215], v[156:159], v[68:71]
    ds_read_b128 v[180:183], v45 offset:0
    v_mfma_f32_16x16x32_bf16 v[72:75], v[216:219], v[156:159], v[72:75]
    ds_read_b64_tr_b16 v[224:225], v49 offset:8192
    v_mfma_f32_16x16x32_bf16 v[88:91], v[216:219], v[160:163], v[88:91]
    ds_read_b64_tr_b16 v[226:227], v49 offset:9216
    v_mfma_f32_16x16x32_bf16 v[84:87], v[212:215], v[160:163], v[84:87]
    ds_read_b128 v[184:187], v45 offset:2048
    v_mfma_f32_16x16x32_bf16 v[80:83], v[208:211], v[160:163], v[80:83]
    ds_read_b64_tr_b16 v[228:229], v50 offset:8192
    v_mfma_f32_16x16x32_bf16 v[76:79], v[204:207], v[160:163], v[76:79]
    ds_read_b64_tr_b16 v[230:231], v50 offset:9216
    v_mfma_f32_16x16x32_bf16 v[92:95], v[204:207], v[164:167], v[92:95]
    ds_read_b128 v[188:191], v45 offset:4096
    v_mfma_f32_16x16x32_bf16 v[96:99], v[208:211], v[164:167], v[96:99]
    ds_read_b64_tr_b16 v[232:233], v51 offset:8192
    v_mfma_f32_16x16x32_bf16 v[100:103], v[212:215], v[164:167], v[100:103]
    ds_read_b64_tr_b16 v[234:235], v51 offset:9216
    v_mfma_f32_16x16x32_bf16 v[104:107], v[216:219], v[164:167], v[104:107]
    ds_read_b128 v[192:195], v45 offset:6144
    v_mfma_f32_16x16x32_bf16 v[120:123], v[216:219], v[168:171], v[120:123]
    ds_read_b128 v[196:199], v45 offset:8192
    v_mfma_f32_16x16x32_bf16 v[116:119], v[212:215], v[168:171], v[116:119]
    ds_read_b128 v[200:203], v45 offset:10240
    v_mfma_f32_16x16x32_bf16 v[112:115], v[208:211], v[168:171], v[112:115]
    v_mfma_f32_16x16x32_bf16 v[108:111], v[204:207], v[168:171], v[108:111]
    v_mfma_f32_16x16x32_bf16 v[124:127], v[204:207], v[172:175], v[124:127]
    v_mfma_f32_16x16x32_bf16 v[128:131], v[208:211], v[172:175], v[128:131]
    v_mfma_f32_16x16x32_bf16 v[132:135], v[212:215], v[172:175], v[132:135]
    v_mfma_f32_16x16x32_bf16 v[136:139], v[216:219], v[172:175], v[136:139]
    v_mfma_f32_16x16x32_bf16 v[152:155], v[216:219], v[176:179], v[152:155]
    v_mfma_f32_16x16x32_bf16 v[148:151], v[212:215], v[176:179], v[148:151]
    v_mfma_f32_16x16x32_bf16 v[144:147], v[208:211], v[176:179], v[144:147]
    v_mfma_f32_16x16x32_bf16 v[140:143], v[204:207], v[176:179], v[140:143]
    s_waitcnt lgkmcnt(0)
    s_barrier
    v_mfma_f32_16x16x32_bf16 v[60:63], v[220:223], v[180:183], v[60:63]
    ds_read_b64_tr_b16 v[204:205], v48 offset:40960
    v_mfma_f32_16x16x32_bf16 v[64:67], v[224:227], v[180:183], v[64:67]
    ds_read_b64_tr_b16 v[206:207], v48 offset:41984
    v_mfma_f32_16x16x32_bf16 v[68:71], v[228:231], v[180:183], v[68:71]
    ds_read_b128 v[156:159], v44 offset:40960
    v_mfma_f32_16x16x32_bf16 v[72:75], v[232:235], v[180:183], v[72:75]
    ds_read_b64_tr_b16 v[208:209], v49 offset:40960
    v_mfma_f32_16x16x32_bf16 v[88:91], v[232:235], v[184:187], v[88:91]
    ds_read_b64_tr_b16 v[210:211], v49 offset:41984
    v_mfma_f32_16x16x32_bf16 v[84:87], v[228:231], v[184:187], v[84:87]
    ds_read_b128 v[160:163], v44 offset:43008
    v_mfma_f32_16x16x32_bf16 v[80:83], v[224:227], v[184:187], v[80:83]
    ds_read_b64_tr_b16 v[212:213], v50 offset:40960
    v_mfma_f32_16x16x32_bf16 v[76:79], v[220:223], v[184:187], v[76:79]
    ds_read_b64_tr_b16 v[214:215], v50 offset:41984
    v_mfma_f32_16x16x32_bf16 v[92:95], v[220:223], v[188:191], v[92:95]
    ds_read_b128 v[164:167], v44 offset:45056
    v_mfma_f32_16x16x32_bf16 v[96:99], v[224:227], v[188:191], v[96:99]
    ds_read_b64_tr_b16 v[216:217], v51 offset:40960
    v_mfma_f32_16x16x32_bf16 v[100:103], v[228:231], v[188:191], v[100:103]
    ds_read_b64_tr_b16 v[218:219], v51 offset:41984
    v_mfma_f32_16x16x32_bf16 v[104:107], v[232:235], v[188:191], v[104:107]
    ds_read_b128 v[168:171], v44 offset:47104
    v_mfma_f32_16x16x32_bf16 v[120:123], v[232:235], v[192:195], v[120:123]
    ds_read_b128 v[172:175], v44 offset:49152
    v_mfma_f32_16x16x32_bf16 v[116:119], v[228:231], v[192:195], v[116:119]
    ds_read_b128 v[176:179], v44 offset:51200
    v_mfma_f32_16x16x32_bf16 v[112:115], v[224:227], v[192:195], v[112:115]
    v_mfma_f32_16x16x32_bf16 v[108:111], v[220:223], v[192:195], v[108:111]
    v_mfma_f32_16x16x32_bf16 v[124:127], v[220:223], v[196:199], v[124:127]
    v_mfma_f32_16x16x32_bf16 v[128:131], v[224:227], v[196:199], v[128:131]
    v_mfma_f32_16x16x32_bf16 v[132:135], v[228:231], v[196:199], v[132:135]
    v_mfma_f32_16x16x32_bf16 v[136:139], v[232:235], v[196:199], v[136:139]
    v_mfma_f32_16x16x32_bf16 v[152:155], v[232:235], v[200:203], v[152:155]
    v_mfma_f32_16x16x32_bf16 v[148:151], v[228:231], v[200:203], v[148:151]
    v_mfma_f32_16x16x32_bf16 v[144:147], v[224:227], v[200:203], v[144:147]
    v_mfma_f32_16x16x32_bf16 v[140:143], v[220:223], v[200:203], v[140:143]
    s_waitcnt lgkmcnt(0)
    v_mfma_f32_16x16x32_bf16 v[60:63], v[204:207], v[156:159], v[60:63]
    ds_read_b64_tr_b16 v[220:221], v48 offset:49152
    v_mfma_f32_16x16x32_bf16 v[64:67], v[208:211], v[156:159], v[64:67]
    ds_read_b64_tr_b16 v[222:223], v48 offset:50176
    v_mfma_f32_16x16x32_bf16 v[68:71], v[212:215], v[156:159], v[68:71]
    ds_read_b128 v[180:183], v45 offset:40960
    v_mfma_f32_16x16x32_bf16 v[72:75], v[216:219], v[156:159], v[72:75]
    ds_read_b64_tr_b16 v[224:225], v49 offset:49152
    v_mfma_f32_16x16x32_bf16 v[88:91], v[216:219], v[160:163], v[88:91]
    ds_read_b64_tr_b16 v[226:227], v49 offset:50176
    v_mfma_f32_16x16x32_bf16 v[84:87], v[212:215], v[160:163], v[84:87]
    ds_read_b128 v[184:187], v45 offset:43008
    v_mfma_f32_16x16x32_bf16 v[80:83], v[208:211], v[160:163], v[80:83]
    ds_read_b64_tr_b16 v[228:229], v50 offset:49152
    v_mfma_f32_16x16x32_bf16 v[76:79], v[204:207], v[160:163], v[76:79]
    ds_read_b64_tr_b16 v[230:231], v50 offset:50176
    v_mfma_f32_16x16x32_bf16 v[92:95], v[204:207], v[164:167], v[92:95]
    ds_read_b128 v[188:191], v45 offset:45056
    v_mfma_f32_16x16x32_bf16 v[96:99], v[208:211], v[164:167], v[96:99]
    ds_read_b64_tr_b16 v[232:233], v51 offset:49152
    v_mfma_f32_16x16x32_bf16 v[100:103], v[212:215], v[164:167], v[100:103]
    ds_read_b64_tr_b16 v[234:235], v51 offset:50176
    v_mfma_f32_16x16x32_bf16 v[104:107], v[216:219], v[164:167], v[104:107]
    ds_read_b128 v[192:195], v45 offset:47104
    v_mfma_f32_16x16x32_bf16 v[120:123], v[216:219], v[168:171], v[120:123]
    ds_read_b128 v[196:199], v45 offset:49152
    v_mfma_f32_16x16x32_bf16 v[116:119], v[212:215], v[168:171], v[116:119]
    ds_read_b128 v[200:203], v45 offset:51200
    v_mfma_f32_16x16x32_bf16 v[112:115], v[208:211], v[168:171], v[112:115]
    v_mfma_f32_16x16x32_bf16 v[108:111], v[204:207], v[168:171], v[108:111]
    s_branch K_J2790
K_STM10:
    s_branch K_STM14
K_STA10:
    s_branch K_STA14
K_J2790:
    v_mfma_f32_16x16x32_bf16 v[124:127], v[204:207], v[172:175], v[124:127]
    v_mfma_f32_16x16x32_bf16 v[128:131], v[208:211], v[172:175], v[128:131]
    v_mfma_f32_16x16x32_bf16 v[132:135], v[212:215], v[172:175], v[132:135]
    v_mfma_f32_16x16x32_bf16 v[136:139], v[216:219], v[172:175], v[136:139]
    v_mfma_f32_16x16x32_bf16 v[152:155], v[216:219], v[176:179], v[152:155]
    v_mfma_f32_16x16x32_bf16 v[148:151], v[212:215], v[176:179], v[148:151]
    v_mfma_f32_16x16x32_bf16 v[144:147], v[208:211], v[176:179], v[144:147]
    v_mfma_f32_16x16x32_bf16 v[140:143], v[204:207], v[176:179], v[140:143]
    s_waitcnt lgkmcnt(0)
    s_barrier
    v_mfma_f32_16x16x32_bf16 v[60:63], v[220:223], v[180:183], v[60:63]
    ds_read_b64_tr_b16 v[204:205], v52 offset:0
    v_mfma_f32_16x16x32_bf16 v[64:67], v[224:227], v[180:183], v[64:67]
    ds_read_b64_tr_b16 v[206:207], v52 offset:1024
    v_mfma_f32_16x16x32_bf16 v[68:71], v[228:231], v[180:183], v[68:71]
    ds_read_b128 v[156:159], v46 offset:0
    v_mfma_f32_16x16x32_bf16 v[72:75], v[232:235], v[180:183], v[72:75]
    ds_read_b64_tr_b16 v[208:209], v53 offset:0
    v_mfma_f32_16x16x32_bf16 v[88:91], v[232:235], v[184:187], v[88:91]
    ds_read_b64_tr_b16 v[210:211], v53 offset:1024
    v_mfma_f32_16x16x32_bf16 v[84:87], v[228:231], v[184:187], v[84:87]
    ds_read_b128 v[160:163], v46 offset:2048
    v_mfma_f32_16x16x32_bf16 v[80:83], v[224:227], v[184:187], v[80:83]
    ds_read_b64_tr_b16 v[212:213], v54 offset:0
    v_mfma_f32_16x16x32_bf16 v[76:79], v[220:223], v[184:187], v[76:79]
    ds_read_b64_tr_b16 v[214:215], v54 offset:1024
    v_mfma_f32_16x16x32_bf16 v[92:95], v[220:223], v[188:191], v[92:95]
    ds_read_b128 v[164:167], v46 offset:4096
    v_mfma_f32_16x16x32_bf16 v[96:99], v[224:227], v[188:191], v[96:99]
    ds_read_b64_tr_b16 v[216:217], v55 offset:0
    v_mfma_f32_16x16x32_bf16 v[100:103], v[228:231], v[188:191], v[100:103]
    ds_read_b64_tr_b16 v[218:219], v55 offset:1024
    v_mfma_f32_16x16x32_bf16 v[104:107], v[232:235], v[188:191], v[104:107]
    ds_read_b128 v[168:171], v46 offset:6144
    v_mfma_f32_16x16x32_bf16 v[120:123], v[232:235], v[192:195], v[120:123]
    ds_read_b128 v[172:175], v46 offset:8192
    v_mfma_f32_16x16x32_bf16 v[116:119], v[228:231], v[192:195], v[116:119]
    ds_read_b128 v[176:179], v46 offset:10240
    v_mfma_f32_16x16x32_bf16 v[112:115], v[224:227], v[192:195], v[112:115]
    v_mfma_f32_16x16x32_bf16 v[108:111], v[220:223], v[192:195], v[108:111]
    v_mfma_f32_16x16x32_bf16 v[124:127], v[220:223], v[196:199], v[124:127]
    v_mfma_f32_16x16x32_bf16 v[128:131], v[224:227], v[196:199], v[128:131]
    v_mfma_f32_16x16x32_bf16 v[132:135], v[228:231], v[196:199], v[132:135]
    v_mfma_f32_16x16x32_bf16 v[136:139], v[232:235], v[196:199], v[136:139]
    v_mfma_f32_16x16x32_bf16 v[152:155], v[232:235], v[200:203], v[152:155]
    v_mfma_f32_16x16x32_bf16 v[148:151], v[228:231], v[200:203], v[148:151]
    v_mfma_f32_16x16x32_bf16 v[144:147], v[224:227], v[200:203], v[144:147]
    v_mfma_f32_16x16x32_bf16 v[140:143], v[220:223], v[200:203], v[140:143]
    s_waitcnt lgkmcnt(0)
    v_mfma_f32_16x16x32_bf16 v[60:63], v[204:207], v[156:159], v[60:63]
    ds_read_b64_tr_b16 v[220:221], v52 offset:8192
    v_mfma_f32_16x16x32_bf16 v[64:67], v[208:211], v[156:159], v[64:67]
    ds_read_b64_tr_b16 v[222:223], v52 offset:9216
    v_mfma_f32_16x16x32_bf16 v[68:71], v[212:215], v[156:159], v[68:71]
    ds_read_b128 v[180:183], v47 offset:0
    v_mfma_f32_16x16x32_bf16 v[72:75], v[216:219], v[156:159], v[72:75]
    ds_read_b64_tr_b16 v[224:225], v53 offset:8192
    v_mfma_f32_16x16x32_bf16 v[88:91], v[216:219], v[160:163], v[88:91]
    ds_read_b64_tr_b16 v[226:227], v53 offset:9216
    v_mfma_f32_16x16x32_bf16 v[84:87], v[212:215], v[160:163], v[84:87]
    ds_read_b128 v[184:187], v47 offset:2048
    v_mfma_f32_16x16x32_bf16 v[80:83], v[208:211], v[160:163], v[80:83]
    ds_read_b64_tr_b16 v[228:229], v54 offset:8192
    v_mfma_f32_16x16x32_bf16 v[76:79], v[204:207], v[160:163], v[76:79]
    ds_read_b64_tr_b16 v[230:231], v54 offset:9216
    v_mfma_f32_16x16x32_bf16 v[92:95], v[204:207], v[164:167], v[92:95]
    ds_read_b128 v[188:191], v47 offset:4096
    v_mfma_f32_16x16x32_bf16 v[96:99], v[208:211], v[164:167], v[96:99]
    ds_read_b64_tr_b16 v[232:233], v55 offset:8192
    v_mfma_f32_16x16x32_bf16 v[100:103], v[212:215], v[164:167], v[100:103]
    ds_read_b64_tr_b16 v[234:235], v55 offset:9216
    v_mfma_f32_16x16x32_bf16 v[104:107], v[216:219], v[164:167], v[104:107]
    ds_read_b128 v[192:195], v47 offset:6144
    v_mfma_f32_16x16x32_bf16 v[120:123], v[216:219], v[168:171], v[120:123]
    ds_read_b128 v[196:199], v47 offset:8192
    v_mfma_f32_16x16x32_bf16 v[116:119], v[212:215], v[168:171], v[116:119]
    ds_read_b128 v[200:203], v47 offset:10240
    v_mfma_f32_16x16x32_bf16 v[112:115], v[208:211], v[168:171], v[112:115]
    v_mfma_f32_16x16x32_bf16 v[108:111], v[204:207], v[168:171], v[108:111]
    v_mfma_f32_16x16x32_bf16 v[124:127], v[204:207], v[172:175], v[124:127]
    v_mfma_f32_16x16x32_bf16 v[128:131], v[208:211], v[172:175], v[128:131]
    v_mfma_f32_16x16x32_bf16 v[132:135], v[212:215], v[172:175], v[132:135]
    v_mfma_f32_16x16x32_bf16 v[136:139], v[216:219], v[172:175], v[136:139]
    v_mfma_f32_16x16x32_bf16 v[152:155], v[216:219], v[176:179], v[152:155]
    v_mfma_f32_16x16x32_bf16 v[148:151], v[212:215], v[176:179], v[148:151]
    v_mfma_f32_16x16x32_bf16 v[144:147], v[208:211], v[176:179], v[144:147]
    v_mfma_f32_16x16x32_bf16 v[140:143], v[204:207], v[176:179], v[140:143]
    s_waitcnt lgkmcnt(0)
    s_barrier
    v_mfma_f32_16x16x32_bf16 v[60:63], v[220:223], v[180:183], v[60:63]
    ds_read_b64_tr_b16 v[204:205], v48 offset:0
    v_mfma_f32_16x16x32_bf16 v[64:67], v[224:227], v[180:183], v[64:67]
    ds_read_b64_tr_b16 v[206:207], v48 offset:1024
    v_mfma_f32_16x16x32_bf16 v[68:71], v[228:231], v[180:183], v[68:71]
    ds_read_b128 v[156:159], v44 offset:0
    v_mfma_f32_16x16x32_bf16 v[72:75], v[232:235], v[180:183], v[72:75]
    ds_read_b64_tr_b16 v[208:209], v49 offset:0
    v_mfma_f32_16x16x32_bf16 v[88:91], v[232:235], v[184:187], v[88:91]
    ds_read_b64_tr_b16 v[210:211], v49 offset:1024
    v_mfma_f32_16x16x32_bf16 v[84:87], v[228:231], v[184:187], v[84:87]
    ds_read_b128 v[160:163], v44 offset:2048
    v_mfma_f32_16x16x32_bf16 v[80:83], v[224:227], v[184:187], v[80:83]
    ds_read_b64_tr_b16 v[212:213], v50 offset:0
    v_mfma_f32_16x16x32_bf16 v[76:79], v[220:223], v[184:187], v[76:79]
    ds_read_b64_tr_b16 v[214:215], v50 offset:1024
    v_mfma_f32_16x16x32_bf16 v[92:95], v[220:223], v[188:191], v[92:95]
    ds_read_b128 v[164:167], v44 offset:4096
    v_mfma_f32_16x16x32_bf16 v[96:99], v[224:227], v[188:191], v[96:99]
    ds_read_b64_tr_b16 v[216:217], v51 offset:0
    v_mfma_f32_16x16x32_bf16 v[100:103], v[228:231], v[188:191], v[100:103]
    ds_read_b64_tr_b16 v[218:219], v51 offset:1024
    v_mfma_f32_16x16x32_bf16 v[104:107], v[232:235], v[188:191], v[104:107]
    ds_read_b128 v[168:171], v44 offset:6144
    v_mfma_f32_16x16x32_bf16 v[120:123], v[232:235], v[192:195], v[120:123]
    ds_read_b128 v[172:175], v44 offset:8192
    v_mfma_f32_16x16x32_bf16 v[116:119], v[228:231], v[192:195], v[116:119]
    ds_read_b128 v[176:179], v44 offset:10240
    v_mfma_f32_16x16x32_bf16 v[112:115], v[224:227], v[192:195], v[112:115]
    v_mfma_f32_16x16x32_bf16 v[108:111], v[220:223], v[192:195], v[108:111]
    v_mfma_f32_16x16x32_bf16 v[124:127], v[220:223], v[196:199], v[124:127]
    v_mfma_f32_16x16x32_bf16 v[128:131], v[224:227], v[196:199], v[128:131]
    v_mfma_f32_16x16x32_bf16 v[132:135], v[228:231], v[196:199], v[132:135]
    s_branch K_J2b58
K_STM11:
    s_branch K_STM15
K_STA11:
    s_branch K_STA15
K_J2b58:
    v_mfma_f32_16x16x32_bf16 v[136:139], v[232:235], v[196:199], v[136:139]
    v_mfma_f32_16x16x32_bf16 v[152:155], v[232:235], v[200:203], v[152:155]
    v_mfma_f32_16x16x32_bf16 v[148:151], v[228:231], v[200:203], v[148:151]
    v_mfma_f32_16x16x32_bf16 v[144:147], v[224:227], v[200:203], v[144:147]
    v_mfma_f32_16x16x32_bf16 v[140:143], v[220:223], v[200:203], v[140:143]
    s_waitcnt lgkmcnt(0)
    v_mfma_f32_16x16x32_bf16 v[60:63], v[204:207], v[156:159], v[60:63]
    ds_read_b64_tr_b16 v[220:221], v48 offset:8192
    v_mfma_f32_16x16x32_bf16 v[64:67], v[208:211], v[156:159], v[64:67]
    ds_read_b64_tr_b16 v[222:223], v48 offset:9216
    v_mfma_f32_16x16x32_bf16 v[68:71], v[212:215], v[156:159], v[68:71]
    ds_read_b128 v[180:183], v45 offset:0
    v_mfma_f32_16x16x32_bf16 v[72:75], v[216:219], v[156:159], v[72:75]
    ds_read_b64_tr_b16 v[224:225], v49 offset:8192
    v_mfma_f32_16x16x32_bf16 v[88:91], v[216:219], v[160:163], v[88:91]
    ds_read_b64_tr_b16 v[226:227], v49 offset:9216
    v_mfma_f32_16x16x32_bf16 v[84:87], v[212:215], v[160:163], v[84:87]
    ds_read_b128 v[184:187], v45 offset:2048
    v_mfma_f32_16x16x32_bf16 v[80:83], v[208:211], v[160:163], v[80:83]
    ds_read_b64_tr_b16 v[228:229], v50 offset:8192
    v_mfma_f32_16x16x32_bf16 v[76:79], v[204:207], v[160:163], v[76:79]
    ds_read_b64_tr_b16 v[230:231], v50 offset:9216
    v_mfma_f32_16x16x32_bf16 v[92:95], v[204:207], v[164:167], v[92:95]
    ds_read_b128 v[188:191], v45 offset:4096
    v_mfma_f32_16x16x32_bf16 v[96:99], v[208:211], v[164:167], v[96:99]
    ds_read_b64_tr_b16 v[232:233], v51 offset:8192
    v_mfma_f32_16x16x32_bf16 v[100:103], v[212:215], v[164:167], v[100:103]
    ds_read_b64_tr_b16 v[234:235], v51 offset:9216
    v_mfma_f32_16x16x32_bf16 v[104:107], v[216:219], v[164:167], v[104:107]
    ds_read_b128 v[192:195], v45 offset:6144
    v_mfma_f32_16x16x32_bf16 v[120:123], v[216:219], v[168:171], v[120:123]
    ds_read_b128 v[196:199], v45 offset:8192
    v_mfma_f32_16x16x32_bf16 v[116:119], v[212:215], v[168:171], v[116:119]
    ds_read_b128 v[200:203], v45 offset:10240
    v_mfma_f32_16x16x32_bf16 v[112:115], v[208:211], v[168:171], v[112:115]
    v_mfma_f32_16x16x32_bf16 v[108:111], v[204:207], v[168:171], v[108:111]
    v_mfma_f32_16x16x32_bf16 v[124:127], v[204:207], v[172:175], v[124:127]
    v_mfma_f32_16x16x32_bf16 v[128:131], v[208:211], v[172:175], v[128:131]
    v_mfma_f32_16x16x32_bf16 v[132:135], v[212:215], v[172:175], v[132:135]
    v_mfma_f32_16x16x32_bf16 v[136:139], v[216:219], v[172:175], v[136:139]
    v_mfma_f32_16x16x32_bf16 v[152:155], v[216:219], v[176:179], v[152:155]
    v_mfma_f32_16x16x32_bf16 v[148:151], v[212:215], v[176:179], v[148:151]
    v_mfma_f32_16x16x32_bf16 v[144:147], v[208:211], v[176:179], v[144:147]
    v_mfma_f32_16x16x32_bf16 v[140:143], v[204:207], v[176:179], v[140:143]
    s_waitcnt lgkmcnt(0)
    s_barrier
    v_mfma_f32_16x16x32_bf16 v[60:63], v[220:223], v[180:183], v[60:63]
    ds_read_b64_tr_b16 v[204:205], v48 offset:40960
    v_mfma_f32_16x16x32_bf16 v[64:67], v[224:227], v[180:183], v[64:67]
    ds_read_b64_tr_b16 v[206:207], v48 offset:41984
    v_mfma_f32_16x16x32_bf16 v[68:71], v[228:231], v[180:183], v[68:71]
    ds_read_b128 v[156:159], v44 offset:40960
    v_mfma_f32_16x16x32_bf16 v[72:75], v[232:235], v[180:183], v[72:75]
    ds_read_b64_tr_b16 v[208:209], v49 offset:40960
    v_mfma_f32_16x16x32_bf16 v[88:91], v[232:235], v[184:187], v[88:91]
    ds_read_b64_tr_b16 v[210:211], v49 offset:41984
    v_mfma_f32_16x16x32_bf16 v[84:87], v[228:231], v[184:187], v[84:87]
    ds_read_b128 v[160:163], v44 offset:43008
    v_mfma_f32_16x16x32_bf16 v[80:83], v[224:227], v[184:187], v[80:83]
    ds_read_b64_tr_b16 v[212:213], v50 offset:40960
    v_mfma_f32_16x16x32_bf16 v[76:79], v[220:223], v[184:187], v[76:79]
    ds_read_b64_tr_b16 v[214:215], v50 offset:41984
    v_mfma_f32_16x16x32_bf16 v[92:95], v[220:223], v[188:191], v[92:95]
    ds_read_b128 v[164:167], v44 offset:45056
    v_mfma_f32_16x16x32_bf16 v[96:99], v[224:227], v[188:191], v[96:99]
    ds_read_b64_tr_b16 v[216:217], v51 offset:40960
    v_mfma_f32_16x16x32_bf16 v[100:103], v[228:231], v[188:191], v[100:103]
    ds_read_b64_tr_b16 v[218:219], v51 offset:41984
    v_mfma_f32_16x16x32_bf16 v[104:107], v[232:235], v[188:191], v[104:107]
    ds_read_b128 v[168:171], v44 offset:47104
    v_mfma_f32_16x16x32_bf16 v[120:123], v[232:235], v[192:195], v[120:123]
    ds_read_b128 v[172:175], v44 offset:49152
    v_mfma_f32_16x16x32_bf16 v[116:119], v[228:231], v[192:195], v[116:119]
    ds_read_b128 v[176:179], v44 offset:51200
    v_mfma_f32_16x16x32_bf16 v[112:115], v[224:227], v[192:195], v[112:115]
    v_mfma_f32_16x16x32_bf16 v[108:111], v[220:223], v[192:195], v[108:111]
    v_mfma_f32_16x16x32_bf16 v[124:127], v[220:223], v[196:199], v[124:127]
    v_mfma_f32_16x16x32_bf16 v[128:131], v[224:227], v[196:199], v[128:131]
    v_mfma_f32_16x16x32_bf16 v[132:135], v[228:231], v[196:199], v[132:135]
    v_mfma_f32_16x16x32_bf16 v[136:139], v[232:235], v[196:199], v[136:139]
    v_mfma_f32_16x16x32_bf16 v[152:155], v[232:235], v[200:203], v[152:155]
    v_mfma_f32_16x16x32_bf16 v[148:151], v[228:231], v[200:203], v[148:151]
    v_mfma_f32_16x16x32_bf16 v[144:147], v[224:227], v[200:203], v[144:147]
    v_mfma_f32_16x16x32_bf16 v[140:143], v[220:223], v[200:203], v[140:143]
    s_waitcnt lgkmcnt(0)
    v_mfma_f32_16x16x32_bf16 v[60:63], v[204:207], v[156:159], v[60:63]
    ds_read_b64_tr_b16 v[220:221], v48 offset:49152
    v_mfma_f32_16x16x32_bf16 v[64:67], v[208:211], v[156:159], v[64:67]
    ds_read_b64_tr_b16 v[222:223], v48 offset:50176
    v_mfma_f32_16x16x32_bf16 v[68:71], v[212:215], v[156:159], v[68:71]
    ds_read_b128 v[180:183], v45 offset:40960
    v_mfma_f32_16x16x32_bf16 v[72:75], v[216:219], v[156:159], v[72:75]
    ds_read_b64_tr_b16 v[224:225], v49 offset:49152
    v_mfma_f32_16x16x32_bf16 v[88:91], v[216:219], v[160:163], v[88:91]
    ds_read_b64_tr_b16 v[226:227], v49 offset:50176
    v_mfma_f32_16x16x32_bf16 v[84:87], v[212:215], v[160:163], v[84:87]
    ds_read_b128 v[184:187], v45 offset:43008
    v_mfma_f32_16x16x32_bf16 v[80:83], v[208:211], v[160:163], v[80:83]
    ds_read_b64_tr_b16 v[228:229], v50 offset:49152
    v_mfma_f32_16x16x32_bf16 v[76:79], v[204:207], v[160:163], v[76:79]
    ds_read_b64_tr_b16 v[230:231], v50 offset:50176
    v_mfma_f32_16x16x32_bf16 v[92:95], v[204:207], v[164:167], v[92:95]
    ds_read_b128 v[188:191], v45 offset:45056
    v_mfma_f32_16x16x32_bf16 v[96:99], v[208:211], v[164:167], v[96:99]
    ds_read_b64_tr_b16 v[232:233], v51 offset:49152
    v_mfma_f32_16x16x32_bf16 v[100:103], v[212:215], v[164:167], v[100:103]
    ds_read_b64_tr_b16 v[234:235], v51 offset:50176
    v_mfma_f32_16x16x32_bf16 v[104:107], v[216:219], v[164:167], v[104:107]
    ds_read_b128 v[192:195], v45 offset:47104
    v_mfma_f32_16x16x32_bf16 v[120:123], v[216:219], v[168:171], v[120:123]
    ds_read_b128 v[196:199], v45 offset:49152
    v_mfma_f32_16x16x32_bf16 v[116:119], v[212:215], v[168:171], v[116:119]
    ds_read_b128 v[200:203], v45 offset:51200
    v_mfma_f32_16x16x32_bf16 v[112:115], v[208:211], v[168:171], v[112:115]
    v_mfma_f32_16x16x32_bf16 v[108:111], v[204:207], v[168:171], v[108:111]
    v_mfma_f32_16x16x32_bf16 v[124:127], v[204:207], v[172:175], v[124:127]
    v_mfma_f32_16x16x32_bf16 v[128:131], v[208:211], v[172:175], v[128:131]
    v_mfma_f32_16x16x32_bf16 v[132:135], v[212:215], v[172:175], v[132:135]
    v_mfma_f32_16x16x32_bf16 v[136:139], v[216:219], v[172:175], v[136:139]
    v_mfma_f32_16x16x32_bf16 v[152:155], v[216:219], v[176:179], v[152:155]
    v_mfma_f32_16x16x32_bf16 v[148:151], v[212:215], v[176:179], v[148:151]
    s_branch K_J2f1c
K_STM12:
    s_branch K_STM16
K_STA12:
    s_branch K_STA16
K_J2f1c:
    v_mfma_f32_16x16x32_bf16 v[144:147], v[208:211], v[176:179], v[144:147]
    v_mfma_f32_16x16x32_bf16 v[140:143], v[204:207], v[176:179], v[140:143]
    s_waitcnt lgkmcnt(0)
    s_barrier
    v_mfma_f32_16x16x32_bf16 v[60:63], v[220:223], v[180:183], v[60:63]
    ds_read_b64_tr_b16 v[204:205], v52 offset:0
    v_mfma_f32_16x16x32_bf16 v[64:67], v[224:227], v[180:183], v[64:67]
    ds_read_b64_tr_b16 v[206:207], v52 offset:1024
    v_mfma_f32_16x16x32_bf16 v[68:71], v[228:231], v[180:183], v[68:71]
    ds_read_b128 v[156:159], v46 offset:0
    v_mfma_f32_16x16x32_bf16 v[72:75], v[232:235], v[180:183], v[72:75]
    ds_read_b64_tr_b16 v[208:209], v53 offset:0
    v_mfma_f32_16x16x32_bf16 v[88:91], v[232:235], v[184:187], v[88:91]
    ds_read_b64_tr_b16 v[210:211], v53 offset:1024
    v_mfma_f32_16x16x32_bf16 v[84:87], v[228:231], v[184:187], v[84:87]
    ds_read_b128 v[160:163], v46 offset:2048
    v_mfma_f32_16x16x32_bf16 v[80:83], v[224:227], v[184:187], v[80:83]
    ds_read_b64_tr_b16 v[212:213], v54 offset:0
    v_mfma_f32_16x16x32_bf16 v[76:79], v[220:223], v[184:187], v[76:79]
    ds_read_b64_tr_b16 v[214:215], v54 offset:1024
    v_mfma_f32_16x16x32_bf16 v[92:95], v[220:223], v[188:191], v[92:95]
    ds_read_b128 v[164:167], v46 offset:4096
    v_mfma_f32_16x16x32_bf16 v[96:99], v[224:227], v[188:191], v[96:99]
    ds_read_b64_tr_b16 v[216:217], v55 offset:0
    v_mfma_f32_16x16x32_bf16 v[100:103], v[228:231], v[188:191], v[100:103]
    ds_read_b64_tr_b16 v[218:219], v55 offset:1024
    v_mfma_f32_16x16x32_bf16 v[104:107], v[232:235], v[188:191], v[104:107]
    s_branch K_PG2
.p2align 12
K_STM13:
    s_branch K_STM17
K_STA13:
    s_branch K_STA17
K_PG2:
    ds_read_b128 v[168:171], v46 offset:6144
    v_mfma_f32_16x16x32_bf16 v[120:123], v[232:235], v[192:195], v[120:123]
    ds_read_b128 v[172:175], v46 offset:8192
    v_mfma_f32_16x16x32_bf16 v[116:119], v[228:231], v[192:195], v[116:119]
    ds_read_b128 v[176:179], v46 offset:10240
    v_mfma_f32_16x16x32_bf16 v[112:115], v[224:227], v[192:195], v[112:115]
    v_mfma_f32_16x16x32_bf16 v[108:111], v[220:223], v[192:195], v[108:111]
    v_mfma_f32_16x16x32_bf16 v[124:127], v[220:223], v[196:199], v[124:127]
    v_mfma_f32_16x16x32_bf16 v[128:131], v[224:227], v[196:199], v[128:131]
    v_mfma_f32_16x16x32_bf16 v[132:135], v[228:231], v[196:199], v[132:135]
    v_mfma_f32_16x16x32_bf16 v[136:139], v[232:235], v[196:199], v[136:139]
    v_mfma_f32_16x16x32_bf16 v[152:155], v[232:235], v[200:203], v[152:155]
    v_mfma_f32_16x16x32_bf16 v[148:151], v[228:231], v[200:203], v[148:151]
    v_mfma_f32_16x16x32_bf16 v[144:147], v[224:227], v[200:203], v[144:147]
    v_mfma_f32_16x16x32_bf16 v[140:143], v[220:223], v[200:203], v[140:143]
    s_waitcnt lgkmcnt(0)
    v_mfma_f32_16x16x32_bf16 v[60:63], v[204:207], v[156:159], v[60:63]
    ds_read_b64_tr_b16 v[220:221], v52 offset:8192
    v_mfma_f32_16x16x32_bf16 v[64:67], v[208:211], v[156:159], v[64:67]
    ds_read_b64_tr_b16 v[222:223], v52 offset:9216
    v_mfma_f32_16x16x32_bf16 v[68:71], v[212:215], v[156:159], v[68:71]
    ds_read_b128 v[180:183], v47 offset:0
    v_mfma_f32_16x16x32_bf16 v[72:75], v[216:219], v[156:159], v[72:75]
    ds_read_b64_tr_b16 v[224:225], v53 offset:8192
    v_mfma_f32_16x16x32_bf16 v[88:91], v[216:219], v[160:163], v[88:91]
    ds_read_b64_tr_b16 v[226:227], v53 offset:9216
    v_mfma_f32_16x16x32_bf16 v[84:87], v[212:215], v[160:163], v[84:87]
    ds_read_b128 v[184:187], v47 offset:2048
    v_mfma_f32_16x16x32_bf16 v[80:83], v[208:211], v[160:163], v[80:83]
    ds_read_b64_tr_b16 v[228:229], v54 offset:8192
    v_mfma_f32_16x16x32_bf16 v[76:79], v[204:207], v[160:163], v[76:79]
    ds_read_b64_tr_b16 v[230:231], v54 offset:9216
    v_mfma_f32_16x16x32_bf16 v[92:95], v[204:207], v[164:167], v[92:95]
    ds_read_b128 v[188:191], v47 offset:4096
    v_mfma_f32_16x16x32_bf16 v[96:99], v[208:211], v[164:167], v[96:99]
    ds_read_b64_tr_b16 v[232:233], v55 offset:8192
    v_mfma_f32_16x16x32_bf16 v[100:103], v[212:215], v[164:167], v[100:103]
    ds_read_b64_tr_b16 v[234:235], v55 offset:9216
    v_mfma_f32_16x16x32_bf16 v[104:107], v[216:219], v[164:167], v[104:107]
    ds_read_b128 v[192:195], v47 offset:6144
    v_mfma_f32_16x16x32_bf16 v[120:123], v[216:219], v[168:171], v[120:123]
    ds_read_b128 v[196:199], v47 offset:8192
    v_mfma_f32_16x16x32_bf16 v[116:119], v[212:215], v[168:171], v[116:119]
    ds_read_b128 v[200:203], v47 offset:10240
    v_mfma_f32_16x16x32_bf16 v[112:115], v[208:211], v[168:171], v[112:115]
    v_mfma_f32_16x16x32_bf16 v[108:111], v[204:207], v[168:171], v[108:111]
    v_mfma_f32_16x16x32_bf16 v[124:127], v[204:207], v[172:175], v[124:127]
    v_mfma_f32_16x16x32_bf16 v[128:131], v[208:211], v[172:175], v[128:131]
    v_mfma_f32_16x16x32_bf16 v[132:135], v[212:215], v[172:175], v[132:135]
    v_mfma_f32_16x16x32_bf16 v[136:139], v[216:219], v[172:175], v[136:139]
    v_mfma_f32_16x16x32_bf16 v[152:155], v[216:219], v[176:179], v[152:155]
    v_mfma_f32_16x16x32_bf16 v[148:151], v[212:215], v[176:179], v[148:151]
    v_mfma_f32_16x16x32_bf16 v[144:147], v[208:211], v[176:179], v[144:147]
    v_mfma_f32_16x16x32_bf16 v[140:143], v[204:207], v[176:179], v[140:143]
    s_waitcnt lgkmcnt(0)
    s_barrier
    v_mfma_f32_16x16x32_bf16 v[60:63], v[220:223], v[180:183], v[60:63]
    ds_read_b64_tr_b16 v[204:205], v48 offset:0
    v_mfma_f32_16x16x32_bf16 v[64:67], v[224:227], v[180:183], v[64:67]
    ds_read_b64_tr_b16 v[206:207], v48 offset:1024
    v_mfma_f32_16x16x32_bf16 v[68:71], v[228:231], v[180:183], v[68:71]
    ds_read_b128 v[156:159], v44 offset:0
    v_mfma_f32_16x16x32_bf16 v[72:75], v[232:235], v[180:183], v[72:75]
    ds_read_b64_tr_b16 v[208:209], v49 offset:0
    v_mfma_f32_16x16x32_bf16 v[88:91], v[232:235], v[184:187], v[88:91]
    ds_read_b64_tr_b16 v[210:211], v49 offset:1024
    v_mfma_f32_16x16x32_bf16 v[84:87], v[228:231], v[184:187], v[84:87]
    ds_read_b128 v[160:163], v44 offset:2048
    v_mfma_f32_16x16x32_bf16 v[80:83], v[224:227], v[184:187], v[80:83]
    ds_read_b64_tr_b16 v[212:213], v50 offset:0
    v_mfma_f32_16x16x32_bf16 v[76:79], v[220:223], v[184:187], v[76:79]
    ds_read_b64_tr_b16 v[214:215], v50 offset:1024
    v_mfma_f32_16x16x32_bf16 v[92:95], v[220:223], v[188:191], v[92:95]
    ds_read_b128 v[164:167], v44 offset:4096
    v_mfma_f32_16x16x32_bf16 v[96:99], v[224:227], v[188:191], v[96:99]
    ds_read_b64_tr_b16 v[216:217], v51 offset:0
    v_mfma_f32_16x16x32_bf16 v[100:103], v[228:231], v[188:191], v[100:103]
    ds_read_b64_tr_b16 v[218:219], v51 offset:1024
    v_mfma_f32_16x16x32_bf16 v[104:107], v[232:235], v[188:191], v[104:107]
    ds_read_b128 v[168:171], v44 offset:6144
    v_mfma_f32_16x16x32_bf16 v[120:123], v[232:235], v[192:195], v[120:123]
    ds_read_b128 v[172:175], v44 offset:8192
    v_mfma_f32_16x16x32_bf16 v[116:119], v[228:231], v[192:195], v[116:119]
    ds_read_b128 v[176:179], v44 offset:10240
    v_mfma_f32_16x16x32_bf16 v[112:115], v[224:227], v[192:195], v[112:115]
    v_mfma_f32_16x16x32_bf16 v[108:111], v[220:223], v[192:195], v[108:111]
    v_mfma_f32_16x16x32_bf16 v[124:127], v[220:223], v[196:199], v[124:127]
    v_mfma_f32_16x16x32_bf16 v[128:131], v[224:227], v[196:199], v[128:131]
    v_mfma_f32_16x16x32_bf16 v[132:135], v[228:231], v[196:199], v[132:135]
    v_mfma_f32_16x16x32_bf16 v[136:139], v[232:235], v[196:199], v[136:139]
    v_mfma_f32_16x16x32_bf16 v[152:155], v[232:235], v[200:203], v[152:155]
    v_mfma_f32_16x16x32_bf16 v[148:151], v[228:231], v[200:203], v[148:151]
    v_mfma_f32_16x16x32_bf16 v[144:147], v[224:227], v[200:203], v[144:147]
    v_mfma_f32_16x16x32_bf16 v[140:143], v[220:223], v[200:203], v[140:143]
    s_waitcnt lgkmcnt(0)
    v_mfma_f32_16x16x32_bf16 v[60:63], v[204:207], v[156:159], v[60:63]
    ds_read_b64_tr_b16 v[220:221], v48 offset:8192
    v_mfma_f32_16x16x32_bf16 v[64:67], v[208:211], v[156:159], v[64:67]
    ds_read_b64_tr_b16 v[222:223], v48 offset:9216
    v_mfma_f32_16x16x32_bf16 v[68:71], v[212:215], v[156:159], v[68:71]
    ds_read_b128 v[180:183], v45 offset:0
    v_mfma_f32_16x16x32_bf16 v[72:75], v[216:219], v[156:159], v[72:75]
    ds_read_b64_tr_b16 v[224:225], v49 offset:8192
    v_mfma_f32_16x16x32_bf16 v[88:91], v[216:219], v[160:163], v[88:91]
    ds_read_b64_tr_b16 v[226:227], v49 offset:9216
    v_mfma_f32_16x16x32_bf16 v[84:87], v[212:215], v[160:163], v[84:87]
    ds_read_b128 v[184:187], v45 offset:2048
    v_mfma_f32_16x16x32_bf16 v[80:83], v[208:211], v[160:163], v[80:83]
    ds_read_b64_tr_b16 v[228:229], v50 offset:8192
    v_mfma_f32_16x16x32_bf16 v[76:79], v[204:207], v[160:163], v[76:79]
    ds_read_b64_tr_b16 v[230:231], v50 offset:9216
    v_mfma_f32_16x16x32_bf16 v[92:95], v[204:207], v[164:167], v[92:95]
    ds_read_b128 v[188:191], v45 offset:4096
    v_mfma_f32_16x16x32_bf16 v[96:99], v[208:211], v[164:167], v[96:99]
    ds_read_b64_tr_b16 v[232:233], v51 offset:8192
    v_mfma_f32_16x16x32_bf16 v[100:103], v[212:215], v[164:167], v[100:103]
    ds_read_b64_tr_b16 v[234:235], v51 offset:9216
    v_mfma_f32_16x16x32_bf16 v[104:107], v[216:219], v[164:167], v[104:107]
    ds_read_b128 v[192:195], v45 offset:6144
    v_mfma_f32_16x16x32_bf16 v[120:123], v[216:219], v[168:171], v[120:123]
    ds_read_b128 v[196:199], v45 offset:8192
    v_mfma_f32_16x16x32_bf16 v[116:119], v[212:215], v[168:171], v[116:119]
    s_branch K_J33c8
K_STM14:
    s_branch K_STM18
K_STA14:
    s_branch K_STA18
K_J33c8:
    ds_read_b128 v[200:203], v45 offset:10240
    v_mfma_f32_16x16x32_bf16 v[112:115], v[208:211], v[168:171], v[112:115]
    v_mfma_f32_16x16x32_bf16 v[108:111], v[204:207], v[168:171], v[108:111]
    v_mfma_f32_16x16x32_bf16 v[124:127], v[204:207], v[172:175], v[124:127]
    v_mfma_f32_16x16x32_bf16 v[128:131], v[208:211], v[172:175], v[128:131]
    v_mfma_f32_16x16x32_bf16 v[132:135], v[212:215], v[172:175], v[132:135]
    v_mfma_f32_16x16x32_bf16 v[136:139], v[216:219], v[172:175], v[136:139]
    v_mfma_f32_16x16x32_bf16 v[152:155], v[216:219], v[176:179], v[152:155]
    v_mfma_f32_16x16x32_bf16 v[148:151], v[212:215], v[176:179], v[148:151]
    v_mfma_f32_16x16x32_bf16 v[144:147], v[208:211], v[176:179], v[144:147]
    v_mfma_f32_16x16x32_bf16 v[140:143], v[204:207], v[176:179], v[140:143]
    s_waitcnt lgkmcnt(0)
    s_barrier
    v_mfma_f32_16x16x32_bf16 v[60:63], v[220:223], v[180:183], v[60:63]
    ds_read_b64_tr_b16 v[204:205], v48 offset:40960
    v_mfma_f32_16x16x32_bf16 v[64:67], v[224:227], v[180:183], v[64:67]
    ds_read_b64_tr_b16 v[206:207], v48 offset:41984
    v_mfma_f32_16x16x32_bf16 v[68:71], v[228:231], v[180:183], v[68:71]
    ds_read_b128 v[156:159], v44 offset:40960
    v_mfma_f32_16x16x32_bf16 v[72:75], v[232:235], v[180:183], v[72:75]
    ds_read_b64_tr_b16 v[208:209], v49 offset:40960
    v_mfma_f32_16x16x32_bf16 v[88:91], v[232:235], v[184:187], v[88:91]
    ds_read_b64_tr_b16 v[210:211], v49 offset:41984
    v_mfma_f32_16x16x32_bf16 v[84:87], v[228:231], v[184:187], v[84:87]
    ds_read_b128 v[160:163], v44 offset:43008
    v_mfma_f32_16x16x32_bf16 v[80:83], v[224:227], v[184:187], v[80:83]
    ds_read_b64_tr_b16 v[212:213], v50 offset:40960
    v_mfma_f32_16x16x32_bf16 v[76:79], v[220:223], v[184:187], v[76:79]
    ds_read_b64_tr_b16 v[214:215], v50 offset:41984
    v_mfma_f32_16x16x32_bf16 v[92:95], v[220:223], v[188:191], v[92:95]
    ds_read_b128 v[164:167], v44 offset:45056
    v_mfma_f32_16x16x32_bf16 v[96:99], v[224:227], v[188:191], v[96:99]
    ds_read_b64_tr_b16 v[216:217], v51 offset:40960
    v_mfma_f32_16x16x32_bf16 v[100:103], v[228:231], v[188:191], v[100:103]
    ds_read_b64_tr_b16 v[218:219], v51 offset:41984
    v_mfma_f32_16x16x32_bf16 v[104:107], v[232:235], v[188:191], v[104:107]
    ds_read_b128 v[168:171], v44 offset:47104
    v_mfma_f32_16x16x32_bf16 v[120:123], v[232:235], v[192:195], v[120:123]
    ds_read_b128 v[172:175], v44 offset:49152
    v_mfma_f32_16x16x32_bf16 v[116:119], v[228:231], v[192:195], v[116:119]
    ds_read_b128 v[176:179], v44 offset:51200
    v_mfma_f32_16x16x32_bf16 v[112:115], v[224:227], v[192:195], v[112:115]
    v_mfma_f32_16x16x32_bf16 v[108:111], v[220:223], v[192:195], v[108:111]
    v_mfma_f32_16x16x32_bf16 v[124:127], v[220:223], v[196:199], v[124:127]
    v_mfma_f32_16x16x32_bf16 v[128:131], v[224:227], v[196:199], v[128:131]
    v_mfma_f32_16x16x32_bf16 v[132:135], v[228:231], v[196:199], v[132:135]
    v_mfma_f32_16x16x32_bf16 v[136:139], v[232:235], v[196:199], v[136:139]
    v_mfma_f32_16x16x32_bf16 v[152:155], v[232:235], v[200:203], v[152:155]
    v_mfma_f32_16x16x32_bf16 v[148:151], v[228:231], v[200:203], v[148:151]
    v_mfma_f32_16x16x32_bf16 v[144:147], v[224:227], v[200:203], v[144:147]
    v_mfma_f32_16x16x32_bf16 v[140:143], v[220:223], v[200:203], v[140:143]
    s_waitcnt lgkmcnt(0)
    v_mfma_f32_16x16x32_bf16 v[60:63], v[204:207], v[156:159], v[60:63]
    ds_read_b64_tr_b16 v[220:221], v48 offset:49152
    v_mfma_f32_16x16x32_bf16 v[64:67], v[208:211], v[156:159], v[64:67]
    ds_read_b64_tr_b16 v[222:223], v48 offset:50176
    v_mfma_f32_16x16x32_bf16 v[68:71], v[212:215], v[156:159], v[68:71]
    ds_read_b128 v[180:183], v45 offset:40960
    v_mfma_f32_16x16x32_bf16 v[72:75], v[216:219], v[156:159], v[72:75]
    ds_read_b64_tr_b16 v[224:225], v49 offset:49152
    v_mfma_f32_16x16x32_bf16 v[76:79], v[204:207], v[160:163], v[76:79]
    ds_read_b64_tr_b16 v[226:227], v49 offset:50176
    v_mfma_f32_16x16x32_bf16 v[80:83], v[208:211], v[160:163], v[80:83]
    ds_read_b128 v[184:187], v45 offset:43008
    v_mfma_f32_16x16x32_bf16 v[84:87], v[212:215], v[160:163], v[84:87]
    ds_read_b64_tr_b16 v[228:229], v50 offset:49152
    v_mfma_f32_16x16x32_bf16 v[88:91], v[216:219], v[160:163], v[88:91]
    ds_read_b64_tr_b16 v[230:231], v50 offset:50176
    v_mfma_f32_16x16x32_bf16 v[92:95], v[204:207], v[164:167], v[92:95]
    ds_read_b128 v[188:191], v45 offset:45056
    v_mfma_f32_16x16x32_bf16 v[96:99], v[208:211], v[164:167], v[96:99]
    ds_read_b64_tr_b16 v[232:233], v51 offset:49152
    v_mfma_f32_16x16x32_bf16 v[100:103], v[212:215], v[164:167], v[100:103]
    ds_read_b64_tr_b16 v[234:235], v51 offset:50176
    v_mfma_f32_16x16x32_bf16 v[104:107], v[216:219], v[164:167], v[104:107]
    ds_read_b128 v[192:195], v45 offset:47104
    v_mfma_f32_16x16x32_bf16 v[108:111], v[204:207], v[168:171], v[108:111]
    ds_read_b128 v[196:199], v45 offset:49152
    v_mfma_f32_16x16x32_bf16 v[112:115], v[208:211], v[168:171], v[112:115]
    ds_read_b128 v[200:203], v45 offset:51200
    v_mfma_f32_16x16x32_bf16 v[116:119], v[212:215], v[168:171], v[116:119]
    v_mfma_f32_16x16x32_bf16 v[120:123], v[216:219], v[168:171], v[120:123]
    s_waitcnt lgkmcnt(0)
    v_mfma_f32_16x16x32_bf16 v[60:63], v[220:223], v[180:183], v[60:63]
    v_mfma_f32_16x16x32_bf16 v[64:67], v[224:227], v[180:183], v[64:67]
    v_mfma_f32_16x16x32_bf16 v[68:71], v[228:231], v[180:183], v[68:71]
    v_mfma_f32_16x16x32_bf16 v[72:75], v[232:235], v[180:183], v[72:75]
    v_mfma_f32_16x16x32_bf16 v[76:79], v[220:223], v[184:187], v[76:79]
    v_mfma_f32_16x16x32_bf16 v[80:83], v[224:227], v[184:187], v[80:83]
    v_mfma_f32_16x16x32_bf16 v[84:87], v[228:231], v[184:187], v[84:87]
    v_mfma_f32_16x16x32_bf16 v[88:91], v[232:235], v[184:187], v[88:91]
    v_mfma_f32_16x16x32_bf16 v[92:95], v[220:223], v[188:191], v[92:95]
    v_cvt_pk_bf16_f32 v236, v60, v61
    v_cvt_pk_bf16_f32 v237, v62, v63
    ds_write_b64 v56, v[236:237] offset:0
    v_mfma_f32_16x16x32_bf16 v[96:99], v[224:227], v[188:191], v[96:99]
    v_cvt_pk_bf16_f32 v238, v64, v65
    v_cvt_pk_bf16_f32 v239, v66, v67
    ds_write_b64 v56, v[238:239] offset:32
    v_mfma_f32_16x16x32_bf16 v[100:103], v[228:231], v[188:191], v[100:103]
    v_cvt_pk_bf16_f32 v240, v68, v69
    v_cvt_pk_bf16_f32 v241, v70, v71
    ds_write_b64 v56, v[240:241] offset:64
    v_mfma_f32_16x16x32_bf16 v[104:107], v[232:235], v[188:191], v[104:107]
    v_cvt_pk_bf16_f32 v242, v72, v73
    v_cvt_pk_bf16_f32 v243, v74, v75
    ds_write_b64 v56, v[242:243] offset:96
    v_mfma_f32_16x16x32_bf16 v[108:111], v[220:223], v[192:195], v[108:111]
    v_cvt_pk_bf16_f32 v236, v76, v77
    v_cvt_pk_bf16_f32 v237, v78, v79
    ds_write_b64 v56, v[236:237] offset:4352
    v_mfma_f32_16x16x32_bf16 v[112:115], v[224:227], v[192:195], v[112:115]
    v_cvt_pk_bf16_f32 v238, v80, v81
    v_cvt_pk_bf16_f32 v239, v82, v83
    ds_write_b64 v56, v[238:239] offset:4384
    v_mfma_f32_16x16x32_bf16 v[116:119], v[228:231], v[192:195], v[116:119]
    v_cvt_pk_bf16_f32 v240, v84, v85
    v_cvt_pk_bf16_f32 v241, v86, v87
    ds_write_b64 v56, v[240:241] offset:4416
    v_mfma_f32_16x16x32_bf16 v[120:123], v[232:235], v[192:195], v[120:123]
    v_cvt_pk_bf16_f32 v242, v88, v89
    s_branch K_J378c
K_STM15:
    s_branch K_STM19
K_STA15:
    s_branch K_STA19
K_J378c:
    v_cvt_pk_bf16_f32 v243, v90, v91
    ds_write_b64 v56, v[242:243] offset:4448
    v_mfma_f32_16x16x32_bf16 v[124:127], v[204:207], v[172:175], v[124:127]
    v_cvt_pk_bf16_f32 v236, v92, v93
    v_cvt_pk_bf16_f32 v237, v94, v95
    ds_write_b64 v56, v[236:237] offset:8704
    v_mfma_f32_16x16x32_bf16 v[128:131], v[208:211], v[172:175], v[128:131]
    v_cvt_pk_bf16_f32 v238, v96, v97
    v_cvt_pk_bf16_f32 v239, v98, v99
    ds_write_b64 v56, v[238:239] offset:8736
    v_mfma_f32_16x16x32_bf16 v[132:135], v[212:215], v[172:175], v[132:135]
    v_cvt_pk_bf16_f32 v240, v100, v101
    v_cvt_pk_bf16_f32 v241, v102, v103
    ds_write_b64 v56, v[240:241] offset:8768
    v_mfma_f32_16x16x32_bf16 v[136:139], v[216:219], v[172:175], v[136:139]
    v_cvt_pk_bf16_f32 v242, v104, v105
    v_cvt_pk_bf16_f32 v243, v106, v107
    ds_write_b64 v56, v[242:243] offset:8800
    v_mfma_f32_16x16x32_bf16 v[124:127], v[220:223], v[196:199], v[124:127]
    v_cvt_pk_bf16_f32 v236, v108, v109
    v_cvt_pk_bf16_f32 v237, v110, v111
    ds_write_b64 v56, v[236:237] offset:13056
    v_mfma_f32_16x16x32_bf16 v[128:131], v[224:227], v[196:199], v[128:131]
    v_cvt_pk_bf16_f32 v238, v112, v113
    v_cvt_pk_bf16_f32 v239, v114, v115
    ds_write_b64 v56, v[238:239] offset:13088
    v_mfma_f32_16x16x32_bf16 v[132:135], v[228:231], v[196:199], v[132:135]
    v_cvt_pk_bf16_f32 v240, v116, v117
    v_cvt_pk_bf16_f32 v241, v118, v119
    ds_write_b64 v56, v[240:241] offset:13120
    v_mfma_f32_16x16x32_bf16 v[136:139], v[232:235], v[196:199], v[136:139]
    v_cvt_pk_bf16_f32 v242, v120, v121
    v_cvt_pk_bf16_f32 v243, v122, v123
    ds_write_b64 v56, v[242:243] offset:13152
    v_mfma_f32_16x16x32_bf16 v[140:143], v[204:207], v[176:179], v[140:143]
    v_cvt_pk_bf16_f32 v236, v124, v125
    v_cvt_pk_bf16_f32 v237, v126, v127
    ds_write_b64 v56, v[236:237] offset:17408
    v_mfma_f32_16x16x32_bf16 v[144:147], v[208:211], v[176:179], v[144:147]
    v_cvt_pk_bf16_f32 v238, v128, v129
    v_cvt_pk_bf16_f32 v239, v130, v131
    ds_write_b64 v56, v[238:239] offset:17440
    v_mfma_f32_16x16x32_bf16 v[148:151], v[212:215], v[176:179], v[148:151]
    v_cvt_pk_bf16_f32 v240, v132, v133
    v_cvt_pk_bf16_f32 v241, v134, v135
    ds_write_b64 v56, v[240:241] offset:17472
    v_mfma_f32_16x16x32_bf16 v[152:155], v[216:219], v[176:179], v[152:155]
    v_cvt_pk_bf16_f32 v242, v136, v137
    v_cvt_pk_bf16_f32 v243, v138, v139
    ds_write_b64 v56, v[242:243] offset:17504
    v_mfma_f32_16x16x32_bf16 v[140:143], v[220:223], v[200:203], v[140:143]
    v_mfma_f32_16x16x32_bf16 v[144:147], v[224:227], v[200:203], v[144:147]
    v_mfma_f32_16x16x32_bf16 v[148:151], v[228:231], v[200:203], v[148:151]
    v_mfma_f32_16x16x32_bf16 v[152:155], v[232:235], v[200:203], v[152:155]
    s_nop 7
    v_cvt_pk_bf16_f32 v236, v140, v141
    v_cvt_pk_bf16_f32 v237, v142, v143
    ds_write_b64 v56, v[236:237] offset:21760
    v_cvt_pk_bf16_f32 v238, v144, v145
    v_cvt_pk_bf16_f32 v239, v146, v147
    ds_write_b64 v56, v[238:239] offset:21792
    v_cvt_pk_bf16_f32 v240, v148, v149
    v_cvt_pk_bf16_f32 v241, v150, v151
    ds_write_b64 v56, v[240:241] offset:21824
    v_cvt_pk_bf16_f32 v242, v152, v153
    v_cvt_pk_bf16_f32 v243, v154, v155
    ds_write_b64 v56, v[242:243] offset:21856
    s_waitcnt vmcnt(0) lgkmcnt(0)
    s_setprio 0
K_JOIN:
    s_barrier
K_JOIN2:
    ds_read_b64 v[56:57], v16 offset:0
    ds_read_b64 v[58:59], v17 offset:0
    ds_read_b64 v[44:45], v16 offset:4512
    ds_read_b64 v[46:47], v26 offset:4512
    ds_read_b64 v[60:61], v16 offset:4352
    ds_read_b64 v[62:63], v17 offset:4352
    ds_read_b64 v[48:49], v16 offset:8864
    ds_read_b64 v[50:51], v26 offset:8864
    ds_read_b64 v[64:65], v16 offset:8704
    ds_read_b64 v[66:67], v17 offset:8704
    ds_read_b64 v[52:53], v16 offset:13216
    ds_read_b64 v[54:55], v26 offset:13216
    ds_read_b64 v[68:69], v16 offset:13056
    ds_read_b64 v[70:71], v17 offset:13056
    s_waitcnt lgkmcnt(8)
    v_mfma_f32_16x16x32_bf16 v[88:91], v[56:59], v[44:47], v[36:39]
    v_mfma_f32_16x16x32_bf16 v[92:95], v[60:63], v[44:47], v[32:35]
    s_waitcnt lgkmcnt(4)
    v_mfma_f32_16x16x32_bf16 v[96:99], v[60:63], v[48:51], v[28:31]
    v_mfma_f32_16x16x32_bf16 v[100:103], v[64:67], v[48:51], v[32:35]
    s_waitcnt lgkmcnt(0)
    v_mfma_f32_16x16x32_bf16 v[104:107], v[64:67], v[52:55], v[28:31]
    v_mfma_f32_16x16x32_bf16 v[108:111], v[68:71], v[52:55], v[32:35]
    ds_read_b64_tr_b16 v[72:73], v18 offset:80
    ds_read_b64_tr_b16 v[80:81], v18 offset:112
    ds_read_b64_tr_b16 v[74:75], v18 offset:4432
    ds_read_b64_tr_b16 v[82:83], v18 offset:4464
    ds_read_b64_tr_b16 v[76:77], v18 offset:8784
    ds_read_b64_tr_b16 v[84:85], v18 offset:8816
    ds_read_b64_tr_b16 v[78:79], v18 offset:13136
    ds_read_b64_tr_b16 v[86:87], v18 offset:13168
    v_max3_f32 v148, v88, v89, v92
    v_max3_f32 v149, v90, v91, v94
    v_max_f32 v148, v148, v93
    v_max_f32 v149, v149, v95
    v_max3_f32 v150, v96, v97, v100
    v_max3_f32 v151, v98, v99, v102
    v_max_f32 v150, v150, v101
    v_max_f32 v151, v151, v103
    v_max3_f32 v152, v104, v105, v108
    v_max3_f32 v153, v106, v107, v110
    v_max_f32 v152, v152, v109
    v_max_f32 v153, v153, v111
    v_cvt_pk_bf16_f32 v149, v148, v149
    v_cvt_pk_bf16_f32 v151, v150, v151
    v_cvt_pk_bf16_f32 v153, v152, v153
    v_lshlrev_b32 v148, 16, v149
    v_and_b32 v149, 0xffff0000, v149
    v_lshlrev_b32 v150, 16, v151
    v_and_b32 v151, 0xffff0000, v151
    v_lshlrev_b32 v152, 16, v153
    v_and_b32 v153, 0xffff0000, v153
    v_pk_mul_f32 v[148:149], v[148:149], s[58:59]
    v_pk_mul_f32 v[150:151], v[150:151], s[58:59]
    v_pk_mul_f32 v[152:153], v[152:153], s[58:59]
    v_cvt_pk_bf16_f32 v149, v148, v149
    v_cvt_pk_bf16_f32 v151, v150, v151
    s_branch K_J3b50
K_STM16:
    s_branch K_STM20
K_STA16:
    s_branch K_STA20
K_J3b50:
    v_cvt_pk_bf16_f32 v153, v152, v153
    v_lshlrev_b32 v148, 16, v149
    v_and_b32 v149, 0xffff0000, v149
    v_lshlrev_b32 v150, 16, v151
    v_and_b32 v151, 0xffff0000, v151
    v_lshlrev_b32 v152, 16, v153
    v_and_b32 v153, 0xffff0000, v153
    v_max_f32 v154, v148, v149
    v_max_f32 v156, v150, v151
    v_max_f32 v158, v152, v153
    v_mov_b32 v168, v158
    v_permlane16_swap_b32 v154, v156
    s_nop 0
    v_permlane16_swap_b32 v158, v168
    v_max_f32 v154, v154, v156
    v_max_f32 v158, v158, v168
    v_mov_b32 v156, v154
    v_mov_b32 v168, v158
    s_nop 0
    v_permlane32_swap_b32 v154, v156
    v_permlane32_swap_b32 v158, v168
    v_max_f32 v154, v154, v156
    v_mov_b32 v156, v154
    v_max_f32 v158, v158, v168
    s_nop 0
    v_permlane16_swap_b32 v154, v156
    v_pk_add_f32 v[148:149], v[148:149], v[154:155] op_sel_hi:[1,0] neg_lo:[0,1] neg_hi:[0,1]
    v_pk_add_f32 v[150:151], v[150:151], v[156:157] op_sel_hi:[1,0] neg_lo:[0,1] neg_hi:[0,1]
    v_pk_add_f32 v[152:153], v[152:153], v[158:159] op_sel_hi:[1,0] neg_lo:[0,1] neg_hi:[0,1]
    v_pk_mul_f32 v[148:149], v[148:149], s[56:57]
    v_pk_mul_f32 v[150:151], v[150:151], s[56:57]
    v_pk_mul_f32 v[152:153], v[152:153], s[56:57]
    v_exp_f32 v148, v148
    v_exp_f32 v149, v149
    v_exp_f32 v150, v150
    v_exp_f32 v151, v151
    v_exp_f32 v152, v152
    v_exp_f32 v153, v153
    s_nop 0
    v_add_f32 v160, v148, v149
    v_add_f32 v162, v150, v151
    v_add_f32 v164, v152, v153
    v_mov_b32 v168, v164
    v_permlane16_swap_b32 v160, v162
    s_nop 0
    v_permlane16_swap_b32 v164, v168
    v_add_f32 v160, v160, v162
    v_add_f32 v164, v164, v168
    v_mov_b32 v162, v160
    v_mov_b32 v168, v164
    s_nop 0
    v_permlane32_swap_b32 v160, v162
    v_permlane32_swap_b32 v164, v168
    v_add_f32 v160, v160, v162
    v_mov_b32 v162, v160
    v_add_f32 v164, v164, v168
    s_nop 0
    v_permlane16_swap_b32 v160, v162
    v_rcp_f32 v160, v160
    v_rcp_f32 v162, v162
    v_rcp_f32 v164, v164
    s_waitcnt lgkmcnt(0)
    v_pk_mul_f32 v[148:149], v[148:149], v[160:161] op_sel_hi:[1,0]
    v_pk_mul_f32 v[150:151], v[150:151], v[162:163] op_sel_hi:[1,0]
    v_pk_mul_f32 v[152:153], v[152:153], v[164:165] op_sel_hi:[1,0]
    v_cvt_pk_bf16_f32 v148, v148, v149
    v_cvt_pk_bf16_f32 v150, v150, v151
    v_cvt_pk_bf16_f32 v152, v152, v153
    v_perm_b32 v112, v148, v148, v40
    v_perm_b32 v113, v148, v148, v41
    v_perm_b32 v114, v148, v148, v42
    v_perm_b32 v115, v148, v148, v43
    v_perm_b32 v116, v150, v150, v40
    v_perm_b32 v117, v150, v150, v41
    v_perm_b32 v118, v150, v150, v42
    v_perm_b32 v119, v150, v150, v43
    v_mfma_f32_16x16x32_bf16 v[124:127], v[72:75], v[112:115], 0
    v_mfma_f32_16x16x32_bf16 v[128:131], v[80:83], v[112:115], 0
    v_perm_b32 v120, v152, v152, v40
    v_perm_b32 v121, v152, v152, v41
    v_perm_b32 v122, v152, v152, v42
    v_perm_b32 v123, v152, v152, v43
    v_mfma_f32_16x16x32_bf16 v[132:135], v[74:77], v[116:119], 0
    v_mfma_f32_16x16x32_bf16 v[136:139], v[82:85], v[116:119], 0
    s_nop 0
    v_mfma_f32_16x16x32_bf16 v[140:143], v[76:79], v[120:123], 0
    v_mfma_f32_16x16x32_bf16 v[144:147], v[84:87], v[120:123], 0
    s_nop 1
    v_cvt_pk_bf16_f32 v172, v124, v125
    v_cvt_pk_bf16_f32 v173, v126, v127
    v_cvt_pk_bf16_f32 v174, v128, v129
    v_cvt_pk_bf16_f32 v175, v130, v131
    ds_write_b64 v23, v[172:173] offset:0
    v_cvt_pk_bf16_f32 v176, v132, v133
    v_cvt_pk_bf16_f32 v177, v134, v135
    v_cvt_pk_bf16_f32 v178, v136, v137
    v_cvt_pk_bf16_f32 v179, v138, v139
    ds_write_b64 v23, v[176:177] offset:1024
    v_cvt_pk_bf16_f32 v180, v140, v141
    v_cvt_pk_bf16_f32 v181, v142, v143
    v_cvt_pk_bf16_f32 v182, v144, v145
    v_cvt_pk_bf16_f32 v183, v146, v147
    ds_write_b64 v23, v[180:181] offset:2048
    s_mov_b64 exec, s[54:55]
    ds_write_b64 v24, v[174:175] offset:0
    ds_write_b64 v24, v[178:179] offset:256
    ds_write_b64 v24, v[182:183] offset:512
    s_mov_b64 exec, -1
    s_waitcnt lgkmcnt(0)
    s_cmp_eq_u32 s36, 0
    s_cbranch_scc1 K_NOHINT
    v_mov_b32 v3, s36
    s_mov_b32 exec_lo, s37
    s_mov_b32 exec_hi, 0
    global_atomic_add v27, v3, s[6:7] sc1
    s_mov_b64 exec, -1
K_NOHINT:
    s_barrier
    ds_read_b128 v[172:175], v25
    ds_read_b128 v[176:179], v25 offset:8192
    s_waitcnt lgkmcnt(1)
    v_min_u32 v172, -2, v172
    buffer_store_dwordx4 v[172:175], v19, s[20:23], 0 offen sc1
    s_waitcnt lgkmcnt(0)
    v_min_u32 v176, -2, v176
    buffer_store_dwordx4 v[176:179], v20, s[20:23], 0 offen sc1
K_ATT_DONE:
    s_cmp_eq_u32 s34, -1
    s_cbranch_scc1 K_END
    s_cmp_lt_u32 s30, 4
    s_cbranch_scc1 K_P2_EARLY
    s_cmp_eq_u32 s30, 7
    s_cbranch_scc1 K_P2_W7
    s_cmp_lg_u32 s30, 6
    s_cbranch_scc1 K_NOS6
    v_lshl_add_u32 v2, v1, 2, s42
    global_load_dword v7, v2, s[6:7] offset:256 sc1
    v_and_b32 v2, 0xfffffe04, v2
    global_load_dword v6, v2, s[6:7] offset:128 sc1
    s_waitcnt vmcnt(4)
    s_barrier
    s_branch K_P2_HELP
K_STM17:
    s_branch K_STM21
K_STA17:
    s_branch K_STA21
K_NOS6:
    s_waitcnt vmcnt(2)
    s_barrier
    s_branch K_P2_HELP
K_P2_EARLY:
    s_lshl_b32 s54, s40, 7
    v_lshrrev_b32 v8, 3, v1
    v_lshrrev_b32 v9, 4, v1
    v_mov_b32 v15, 158720
    s_lshl_b32 s53, s40, 3
    s_add_u32 s53, s53, s30
    s_mul_i32 s3, s53, 20480
    s_lshl_b32 s33, s41, 7
    s_add_u32 s3, s3, s33
    v_and_b32 v2, 7, v1
    v_lshlrev_b32 v2, 4, v2
    v_mul_u32_u24 v4, 1280, v8
    v_add3_u32 v10, v2, v4, s3
    s_lshl_b32 s3, s30, 7
    s_add_u32 s3, s3, 159744
    v_lshl_add_u32 v11, v8, 3, s3
    s_mov_b32 s55, 10240
    s_add_u32 s20, s6, 0x100000
    s_addc_u32 s21, s7, 0
    s_mov_b32 s22, 0x280000
    s_mov_b32 s23, 0x20000
    s_mov_b32 s48, s10
    s_mov_b32 s49, s11
    s_mov_b32 s50, 0x280000
    s_mov_b32 s51, 0x20000
    v_mul_u32_u24 v3, 144, v8
    v_add_u32 v3, v2, v3
    s_mov_b32 s75, 140288
    s_cmp_ge_u32 s29, 8
    s_cselect_b32 s75, 81920, s75
    s_mul_i32 s3, s30, 2304
    s_add_u32 s3, s3, s75
    v_add_u32 v14, s3, v3
    buffer_load_dwordx4 v[16:19], v10, s[12:15], 0 offen
    buffer_load_dwordx4 v[20:23], v10, s[12:15], s55 offen
    v_bfe_u32 v48, v1, 2, 2
    v_and_b32 v49, 3, v1
    s_add_u32 s3, s53, s30
    s_lshr_b32 s33, s3, 2
    s_mul_i32 s33, s33, 76
    s_add_u32 s3, s3, s33
    s_lshl_b32 s3, s3, 10
    v_and_b32 v2, 15, v1
    v_lshl_add_u32 v2, v2, 4, s3
    v_lshrrev_b32 v3, 5, v1
    v_lshl_add_u32 v2, v3, 8, v2
    v_and_b32 v4, 1, v9
    v_lshl_add_u32 v52, v4, 10, v2
    v_mov_b32 v53, 0x1f000
    v_lshl_add_u32 v2, v3, 2, v48
    v_lshlrev_b32 v2, 7, v2
    v_lshl_add_u32 v2, v49, 3, v2
    v_lshl_add_u32 v2, v4, 5, v2
    v_lshrrev_b32 v4, 1, v48
    v_lshl_add_u32 v54, v4, 6, v2
    v_xor_b32 v55, 64, v54
    v_and_b32 v2, 31, v1
    v_mul_u32_u24 v2, 144, v2
    v_lshl_add_u32 v2, v3, 3, v2
    s_branch K_PG3
.p2align 12
K_STM18:
    s_branch K_STM22
K_CHA0:
K_STA18:
    s_branch K_STA22
K_PG3:
    s_mul_i32 s3, s30, 4608
    s_add_u32 s3, s3, s75
    v_add_u32 v50, s3, v2
    s_lshl_b32 s3, s40, 3
    s_mul_i32 s33, s3, 187
    s_lshr_b32 s33, s33, 11
    s_add_u32 s33, s33, 1
    s_mul_i32 s33, s33, 11
    s_add_u32 s3, s53, s30
    s_add_u32 s3, s3, 1
    s_cmp_ge_u32 s3, s33
    s_cselect_b32 s52, 24, 16
    s_cmp_gt_u32 s3, s33
    s_cselect_b32 s52, 20, s52
    v_add_u32 v58, s52, v15
    s_mov_b32 s67, -1
    s_mov_b32 s68, -1
    s_mov_b32 s69, -1
    s_mov_b32 s70, -1
    s_mov_b32 s71, -1
    s_mov_b32 s72, -1
    s_mov_b32 s73, 0xfffff
    s_mov_b32 s74, 131072
    v_mov_b32 v108, 0
    v_mov_b32 v109, 0
    v_mov_b32 v110, 0
    v_mov_b32 v111, 0
    v_mov_b32 v112, 0
    v_mov_b32 v113, 0
    v_mov_b32 v114, 0
    v_mov_b32 v115, 0
    v_mov_b32 v116, 0
    v_mov_b32 v117, 0
    v_mov_b32 v118, 0
    v_mov_b32 v119, 0
    v_mov_b32 v120, 0
    v_mov_b32 v121, 0
    v_mov_b32 v122, 0
    v_mov_b32 v123, 0
    v_mov_b32 v124, 0
    v_mov_b32 v125, 0
    v_mov_b32 v126, 0
    v_mov_b32 v127, 0
    v_mov_b32 v128, 0
    v_mov_b32 v129, 0
    v_mov_b32 v130, 0
    v_mov_b32 v131, 0
    v_mov_b32 v132, 0
    v_mov_b32 v133, 0
    v_mov_b32 v134, 0
    v_mov_b32 v135, 0
    v_mov_b32 v136, 0
    v_mov_b32 v137, 0
    v_mov_b32 v138, 0
    v_mov_b32 v139, 0
    s_barrier
    s_cmp_lt_u32 s29, 8
    s_cbranch_scc1 K_P2_AUXW
K_P2_GEMM:
    s_setprio 2
    ds_read_b32 v59, v58
    s_waitcnt lgkmcnt(0)
K_IT0:
    s_cmp_lt_i32 s68, 0
    s_cbranch_scc1 K_SK0
    s_waitcnt vmcnt(8) lgkmcnt(8)
    v_max_u32 v2, v68, v72
    v_cmp_eq_u32 vcc, -1, v2
    s_cbranch_vccnz K_FX0
K_GO0:
    v_mfma_f32_32x32x16_bf16 v[108:123], v[156:159], v[68:71], v[108:123]
    v_readfirstlane_b32 s58, v59
    ds_read_b32 v59, v58
    v_and_or_b32 v56, s70, v53, v54
    s_and_b32 s33, s58, s73
    ds_read_b64_tr_b16 v[140:141], v56 offset:0
    s_ff1_i32_b32 s59, s33
    ds_read_b64_tr_b16 v[142:143], v56 offset:2048
    s_lshl_b32 s67, s59, 12
    v_mfma_f32_32x32x16_bf16 v[124:139], v[164:167], v[68:71], v[124:139]
    buffer_load_dwordx4 v[60:63], v52, s[20:23], s67 offen offset:0 sc1
    ds_read_b64_tr_b16 v[144:145], v56 offset:1024
    v_and_or_b32 v57, s70, v53, v55
    ds_read_b64_tr_b16 v[146:147], v56 offset:3072
    ds_read_b64_tr_b16 v[148:149], v57 offset:0
    v_mfma_f32_32x32x16_bf16 v[108:123], v[160:163], v[72:75], v[108:123]
    buffer_load_dwordx4 v[64:67], v52, s[20:23], s67 offen offset:512 sc1
    ds_read_b64_tr_b16 v[150:151], v57 offset:2048
    ds_read_b64_tr_b16 v[152:153], v57 offset:1024
    ds_read_b64_tr_b16 v[154:155], v57 offset:3072
    s_bitset0_b32 s73, s59
    v_mfma_f32_32x32x16_bf16 v[124:139], v[168:171], v[72:75], v[124:139]
K_IT1:
    s_cmp_lt_i32 s69, 0
    s_cbranch_scc1 K_SK1
    s_waitcnt vmcnt(8) lgkmcnt(8)
    v_max_u32 v2, v76, v80
    v_cmp_eq_u32 vcc, -1, v2
    s_cbranch_vccnz K_FX1
K_GO1:
    v_mfma_f32_32x32x16_bf16 v[108:123], v[172:175], v[76:79], v[108:123]
    v_readfirstlane_b32 s58, v59
    ds_read_b32 v59, v58
    v_and_or_b32 v56, s71, v53, v54
    s_and_b32 s33, s58, s73
    ds_read_b64_tr_b16 v[156:157], v56 offset:0
    s_ff1_i32_b32 s59, s33
    ds_read_b64_tr_b16 v[158:159], v56 offset:2048
    s_lshl_b32 s68, s59, 12
    v_mfma_f32_32x32x16_bf16 v[124:139], v[180:183], v[76:79], v[124:139]
    buffer_load_dwordx4 v[68:71], v52, s[20:23], s68 offen offset:0 sc1
    ds_read_b64_tr_b16 v[160:161], v56 offset:1024
    v_and_or_b32 v57, s71, v53, v55
    ds_read_b64_tr_b16 v[162:163], v56 offset:3072
    ds_read_b64_tr_b16 v[164:165], v57 offset:0
    v_mfma_f32_32x32x16_bf16 v[108:123], v[176:179], v[80:83], v[108:123]
    buffer_load_dwordx4 v[72:75], v52, s[20:23], s68 offen offset:512 sc1
    ds_read_b64_tr_b16 v[166:167], v57 offset:2048
    ds_read_b64_tr_b16 v[168:169], v57 offset:1024
    ds_read_b64_tr_b16 v[170:171], v57 offset:3072
    s_bitset0_b32 s73, s59
    v_mfma_f32_32x32x16_bf16 v[124:139], v[184:187], v[80:83], v[124:139]
K_IT2:
    s_cmp_lt_i32 s70, 0
    s_cbranch_scc1 K_SK2
    s_waitcnt vmcnt(8) lgkmcnt(8)
    v_max_u32 v2, v84, v88
    v_cmp_eq_u32 vcc, -1, v2
    s_cbranch_vccnz K_FX2
K_GO2:
    v_mfma_f32_32x32x16_bf16 v[108:123], v[140:143], v[84:87], v[108:123]
    v_readfirstlane_b32 s58, v59
    ds_read_b32 v59, v58
    v_and_or_b32 v56, s72, v53, v54
    s_and_b32 s33, s58, s73
    ds_read_b64_tr_b16 v[172:173], v56 offset:0
    s_ff1_i32_b32 s59, s33
    ds_read_b64_tr_b16 v[174:175], v56 offset:2048
    s_lshl_b32 s69, s59, 12
    v_mfma_f32_32x32x16_bf16 v[124:139], v[148:151], v[84:87], v[124:139]
    buffer_load_dwordx4 v[76:79], v52, s[20:23], s69 offen offset:0 sc1
    ds_read_b64_tr_b16 v[176:177], v56 offset:1024
    v_and_or_b32 v57, s72, v53, v55
    ds_read_b64_tr_b16 v[178:179], v56 offset:3072
    ds_read_b64_tr_b16 v[180:181], v57 offset:0
    v_mfma_f32_32x32x16_bf16 v[108:123], v[144:147], v[88:91], v[108:123]
    buffer_load_dwordx4 v[80:83], v52, s[20:23], s69 offen offset:512 sc1
    ds_read_b64_tr_b16 v[182:183], v57 offset:2048
    ds_read_b64_tr_b16 v[184:185], v57 offset:1024
    ds_read_b64_tr_b16 v[186:187], v57 offset:3072
    s_bitset0_b32 s73, s59
    v_mfma_f32_32x32x16_bf16 v[124:139], v[152:155], v[88:91], v[124:139]
K_IT3:
    s_cmp_lt_i32 s71, 0
    s_cbranch_scc1 K_SK3
    s_waitcnt vmcnt(8) lgkmcnt(8)
    v_max_u32 v2, v92, v96
    v_cmp_eq_u32 vcc, -1, v2
    s_cbranch_vccnz K_FX3
K_GO3:
    v_mfma_f32_32x32x16_bf16 v[108:123], v[156:159], v[92:95], v[108:123]
    v_readfirstlane_b32 s58, v59
    ds_read_b32 v59, v58
    v_and_or_b32 v56, s67, v53, v54
    s_and_b32 s33, s58, s73
    ds_read_b64_tr_b16 v[140:141], v56 offset:0
    s_ff1_i32_b32 s59, s33
    ds_read_b64_tr_b16 v[142:143], v56 offset:2048
    s_lshl_b32 s70, s59, 12
    v_mfma_f32_32x32x16_bf16 v[124:139], v[164:167], v[92:95], v[124:139]
    buffer_load_dwordx4 v[84:87], v52, s[20:23], s70 offen offset:0 sc1
    ds_read_b64_tr_b16 v[144:145], v56 offset:1024
    v_and_or_b32 v57, s67, v53, v55
    ds_read_b64_tr_b16 v[146:147], v56 offset:3072
    ds_read_b64_tr_b16 v[148:149], v57 offset:0
    v_mfma_f32_32x32x16_bf16 v[108:123], v[160:163], v[96:99], v[108:123]
    buffer_load_dwordx4 v[88:91], v52, s[20:23], s70 offen offset:512 sc1
    ds_read_b64_tr_b16 v[150:151], v57 offset:2048
    ds_read_b64_tr_b16 v[152:153], v57 offset:1024
    s_branch K_J43cc
K_STM19:
    s_branch K_STM23
K_CHA1:
K_STA19:
    s_branch K_STA23
K_J43cc:
    ds_read_b64_tr_b16 v[154:155], v57 offset:3072
    s_bitset0_b32 s73, s59
    v_mfma_f32_32x32x16_bf16 v[124:139], v[168:171], v[96:99], v[124:139]
K_IT4:
    s_cmp_lt_i32 s72, 0
    s_cbranch_scc1 K_SK4
    s_waitcnt vmcnt(8) lgkmcnt(8)
    v_max_u32 v2, v100, v104
    v_cmp_eq_u32 vcc, -1, v2
    s_cbranch_vccnz K_FX4
K_GO4:
    v_mfma_f32_32x32x16_bf16 v[108:123], v[172:175], v[100:103], v[108:123]
    v_readfirstlane_b32 s58, v59
    ds_read_b32 v59, v58
    v_and_or_b32 v56, s68, v53, v54
    s_and_b32 s33, s58, s73
    ds_read_b64_tr_b16 v[156:157], v56 offset:0
    s_ff1_i32_b32 s59, s33
    ds_read_b64_tr_b16 v[158:159], v56 offset:2048
    s_lshl_b32 s71, s59, 12
    v_mfma_f32_32x32x16_bf16 v[124:139], v[180:183], v[100:103], v[124:139]
    buffer_load_dwordx4 v[92:95], v52, s[20:23], s71 offen offset:0 sc1
    ds_read_b64_tr_b16 v[160:161], v56 offset:1024
    v_and_or_b32 v57, s68, v53, v55
    ds_read_b64_tr_b16 v[162:163], v56 offset:3072
    ds_read_b64_tr_b16 v[164:165], v57 offset:0
    v_mfma_f32_32x32x16_bf16 v[108:123], v[176:179], v[104:107], v[108:123]
    buffer_load_dwordx4 v[96:99], v52, s[20:23], s71 offen offset:512 sc1
    ds_read_b64_tr_b16 v[166:167], v57 offset:2048
    ds_read_b64_tr_b16 v[168:169], v57 offset:1024
    ds_read_b64_tr_b16 v[170:171], v57 offset:3072
    s_bitset0_b32 s73, s59
    v_mfma_f32_32x32x16_bf16 v[124:139], v[184:187], v[104:107], v[124:139]
K_IT5:
    s_cmp_lt_i32 s67, 0
    s_cbranch_scc1 K_SK5
    s_waitcnt vmcnt(8) lgkmcnt(8)
    v_max_u32 v2, v60, v64
    v_cmp_eq_u32 vcc, -1, v2
    s_cbranch_vccnz K_FX5
K_GO5:
    v_mfma_f32_32x32x16_bf16 v[108:123], v[140:143], v[60:63], v[108:123]
    v_readfirstlane_b32 s58, v59
    ds_read_b32 v59, v58
    v_and_or_b32 v56, s69, v53, v54
    s_and_b32 s33, s58, s73
    ds_read_b64_tr_b16 v[172:173], v56 offset:0
    s_ff1_i32_b32 s59, s33
    ds_read_b64_tr_b16 v[174:175], v56 offset:2048
    s_lshl_b32 s72, s59, 12
    v_mfma_f32_32x32x16_bf16 v[124:139], v[148:151], v[60:63], v[124:139]
    buffer_load_dwordx4 v[100:103], v52, s[20:23], s72 offen offset:0 sc1
    ds_read_b64_tr_b16 v[176:177], v56 offset:1024
    v_and_or_b32 v57, s69, v53, v55
    ds_read_b64_tr_b16 v[178:179], v56 offset:3072
    ds_read_b64_tr_b16 v[180:181], v57 offset:0
    v_mfma_f32_32x32x16_bf16 v[108:123], v[144:147], v[64:67], v[108:123]
    buffer_load_dwordx4 v[104:107], v52, s[20:23], s72 offen offset:512 sc1
    ds_read_b64_tr_b16 v[182:183], v57 offset:2048
    ds_read_b64_tr_b16 v[184:185], v57 offset:1024
    ds_read_b64_tr_b16 v[186:187], v57 offset:3072
    s_bitset0_b32 s73, s59
    v_mfma_f32_32x32x16_bf16 v[124:139], v[152:155], v[64:67], v[124:139]
    s_branch K_IT0
K_FX0:
    s_sub_u32 s74, s74, 1
    s_cbranch_scc1 K_GO0
    s_lshr_b32 s59, s68, 12
    s_bitset1_b32 s73, s59
K_SK0:
    s_waitcnt lgkmcnt(8)
    v_readfirstlane_b32 s58, v59
    ds_read_b32 v59, v58
    s_and_b32 s33, s58, s73
    s_cbranch_scc0 K_NUL0
K_BK0:
    s_ff1_i32_b32 s59, s33
    s_lshl_b32 s67, s59, 12
    buffer_load_dwordx4 v[60:63], v52, s[20:23], s67 offen offset:0 sc1
    buffer_load_dwordx4 v[64:67], v52, s[20:23], s67 offen offset:512 sc1
    s_bitset0_b32 s73, s59
    v_and_or_b32 v56, s70, v53, v54
    v_and_or_b32 v57, s70, v53, v55
    ds_read_b64_tr_b16 v[140:141], v56 offset:0
    ds_read_b64_tr_b16 v[142:143], v56 offset:2048
    ds_read_b64_tr_b16 v[144:145], v56 offset:1024
    ds_read_b64_tr_b16 v[146:147], v56 offset:3072
    ds_read_b64_tr_b16 v[148:149], v57 offset:0
    ds_read_b64_tr_b16 v[150:151], v57 offset:2048
    ds_read_b64_tr_b16 v[152:153], v57 offset:1024
    ds_read_b64_tr_b16 v[154:155], v57 offset:3072
    s_branch K_IT1
K_STM20:
    s_branch K_STM24
K_CHA2:
K_STA20:
    s_branch K_STA24
K_NUL0:
    s_and_b32 s59, s69, s70
    s_and_b32 s59, s59, s71
    s_and_b32 s59, s59, s72
    s_cmp_lt_i32 s59, 0
    s_cbranch_scc0 K_PC0
    s_cmp_eq_u32 s73, 0
    s_cbranch_scc1 K_P2_MM
K_SPN0:
    s_waitcnt lgkmcnt(0)
    v_readfirstlane_b32 s58, v59
    ds_read_b32 v59, v58
    s_and_b32 s33, s58, s73
    s_cbranch_scc0 K_SPN0
    s_branch K_BK0
K_PC0:
    s_cmp_eq_u32 s73, 0
    s_cbranch_scc1 K_BK0
    s_waitcnt lgkmcnt(0)
    v_readfirstlane_b32 s58, v59
    ds_read_b32 v59, v58
    s_and_b32 s33, s58, s73
    s_cbranch_scc1 K_BK0
    s_branch K_BK0
K_FX1:
    s_sub_u32 s74, s74, 1
    s_cbranch_scc1 K_GO1
    s_lshr_b32 s59, s69, 12
    s_bitset1_b32 s73, s59
K_SK1:
    s_waitcnt lgkmcnt(8)
    v_readfirstlane_b32 s58, v59
    ds_read_b32 v59, v58
    s_and_b32 s33, s58, s73
    s_cbranch_scc0 K_NUL1
K_BK1:
    s_ff1_i32_b32 s59, s33
    s_lshl_b32 s68, s59, 12
    buffer_load_dwordx4 v[68:71], v52, s[20:23], s68 offen offset:0 sc1
    buffer_load_dwordx4 v[72:75], v52, s[20:23], s68 offen offset:512 sc1
    s_bitset0_b32 s73, s59
    v_and_or_b32 v56, s71, v53, v54
    v_and_or_b32 v57, s71, v53, v55
    ds_read_b64_tr_b16 v[156:157], v56 offset:0
    ds_read_b64_tr_b16 v[158:159], v56 offset:2048
    ds_read_b64_tr_b16 v[160:161], v56 offset:1024
    ds_read_b64_tr_b16 v[162:163], v56 offset:3072
    ds_read_b64_tr_b16 v[164:165], v57 offset:0
    ds_read_b64_tr_b16 v[166:167], v57 offset:2048
    ds_read_b64_tr_b16 v[168:169], v57 offset:1024
    ds_read_b64_tr_b16 v[170:171], v57 offset:3072
    s_branch K_IT2
K_NUL1:
    s_and_b32 s59, s67, s70
    s_and_b32 s59, s59, s71
    s_and_b32 s59, s59, s72
    s_cmp_lt_i32 s59, 0
    s_cbranch_scc0 K_PC1
    s_cmp_eq_u32 s73, 0
    s_cbranch_scc1 K_P2_MM
K_SPN1:
    s_waitcnt lgkmcnt(0)
    v_readfirstlane_b32 s58, v59
    ds_read_b32 v59, v58
    s_and_b32 s33, s58, s73
    s_cbranch_scc0 K_SPN1
    s_branch K_BK1
K_PC1:
    s_cmp_eq_u32 s73, 0
    s_cbranch_scc1 K_BK1
    s_waitcnt lgkmcnt(0)
    v_readfirstlane_b32 s58, v59
    ds_read_b32 v59, v58
    s_and_b32 s33, s58, s73
    s_cbranch_scc1 K_BK1
    s_branch K_BK1
K_FX2:
    s_sub_u32 s74, s74, 1
    s_cbranch_scc1 K_GO2
    s_lshr_b32 s59, s70, 12
    s_bitset1_b32 s73, s59
K_SK2:
    s_waitcnt lgkmcnt(8)
    v_readfirstlane_b32 s58, v59
    ds_read_b32 v59, v58
    s_and_b32 s33, s58, s73
    s_cbranch_scc0 K_NUL2
K_BK2:
    s_ff1_i32_b32 s59, s33
    s_lshl_b32 s69, s59, 12
    buffer_load_dwordx4 v[76:79], v52, s[20:23], s69 offen offset:0 sc1
    buffer_load_dwordx4 v[80:83], v52, s[20:23], s69 offen offset:512 sc1
    s_bitset0_b32 s73, s59
    v_and_or_b32 v56, s72, v53, v54
    v_and_or_b32 v57, s72, v53, v55
    ds_read_b64_tr_b16 v[172:173], v56 offset:0
    ds_read_b64_tr_b16 v[174:175], v56 offset:2048
    ds_read_b64_tr_b16 v[176:177], v56 offset:1024
    ds_read_b64_tr_b16 v[178:179], v56 offset:3072
    ds_read_b64_tr_b16 v[180:181], v57 offset:0
    ds_read_b64_tr_b16 v[182:183], v57 offset:2048
    ds_read_b64_tr_b16 v[184:185], v57 offset:1024
    ds_read_b64_tr_b16 v[186:187], v57 offset:3072
    s_branch K_IT3
K_NUL2:
    s_and_b32 s59, s67, s68
    s_and_b32 s59, s59, s71
    s_and_b32 s59, s59, s72
    s_cmp_lt_i32 s59, 0
    s_cbranch_scc0 K_PC2
    s_cmp_eq_u32 s73, 0
    s_cbranch_scc1 K_P2_MM
K_SPN2:
    s_waitcnt lgkmcnt(0)
    v_readfirstlane_b32 s58, v59
    ds_read_b32 v59, v58
    s_and_b32 s33, s58, s73
    s_cbranch_scc0 K_SPN2
    s_branch K_BK2
K_STM21:
    s_branch K_STM25
K_CHA3:
K_STA21:
    s_branch K_STA25
K_PC2:
    s_cmp_eq_u32 s73, 0
    s_cbranch_scc1 K_BK2
    s_waitcnt lgkmcnt(0)
    v_readfirstlane_b32 s58, v59
    ds_read_b32 v59, v58
    s_and_b32 s33, s58, s73
    s_cbranch_scc1 K_BK2
    s_branch K_BK2
K_FX3:
    s_sub_u32 s74, s74, 1
    s_cbranch_scc1 K_GO3
    s_lshr_b32 s59, s71, 12
    s_bitset1_b32 s73, s59
K_SK3:
    s_waitcnt lgkmcnt(8)
    v_readfirstlane_b32 s58, v59
    ds_read_b32 v59, v58
    s_and_b32 s33, s58, s73
    s_cbranch_scc0 K_NUL3
K_BK3:
    s_ff1_i32_b32 s59, s33
    s_lshl_b32 s70, s59, 12
    buffer_load_dwordx4 v[84:87], v52, s[20:23], s70 offen offset:0 sc1
    buffer_load_dwordx4 v[88:91], v52, s[20:23], s70 offen offset:512 sc1
    s_bitset0_b32 s73, s59
    v_and_or_b32 v56, s67, v53, v54
    v_and_or_b32 v57, s67, v53, v55
    ds_read_b64_tr_b16 v[140:141], v56 offset:0
    ds_read_b64_tr_b16 v[142:143], v56 offset:2048
    ds_read_b64_tr_b16 v[144:145], v56 offset:1024
    ds_read_b64_tr_b16 v[146:147], v56 offset:3072
    ds_read_b64_tr_b16 v[148:149], v57 offset:0
    ds_read_b64_tr_b16 v[150:151], v57 offset:2048
    ds_read_b64_tr_b16 v[152:153], v57 offset:1024
    ds_read_b64_tr_b16 v[154:155], v57 offset:3072
    s_branch K_IT4
K_NUL3:
    s_and_b32 s59, s67, s68
    s_and_b32 s59, s59, s69
    s_and_b32 s59, s59, s72
    s_cmp_lt_i32 s59, 0
    s_cbranch_scc0 K_PC3
    s_cmp_eq_u32 s73, 0
    s_cbranch_scc1 K_P2_MM
K_SPN3:
    s_waitcnt lgkmcnt(0)
    v_readfirstlane_b32 s58, v59
    ds_read_b32 v59, v58
    s_and_b32 s33, s58, s73
    s_cbranch_scc0 K_SPN3
    s_branch K_BK3
K_PC3:
    s_cmp_eq_u32 s73, 0
    s_cbranch_scc1 K_BK3
    s_waitcnt lgkmcnt(0)
    v_readfirstlane_b32 s58, v59
    ds_read_b32 v59, v58
    s_and_b32 s33, s58, s73
    s_cbranch_scc1 K_BK3
    s_branch K_BK3
K_FX4:
    s_sub_u32 s74, s74, 1
    s_cbranch_scc1 K_GO4
    s_lshr_b32 s59, s72, 12
    s_bitset1_b32 s73, s59
K_SK4:
    s_waitcnt lgkmcnt(8)
    v_readfirstlane_b32 s58, v59
    ds_read_b32 v59, v58
    s_and_b32 s33, s58, s73
    s_cbranch_scc0 K_NUL4
K_BK4:
    s_ff1_i32_b32 s59, s33
    s_lshl_b32 s71, s59, 12
    buffer_load_dwordx4 v[92:95], v52, s[20:23], s71 offen offset:0 sc1
    buffer_load_dwordx4 v[96:99], v52, s[20:23], s71 offen offset:512 sc1
    s_bitset0_b32 s73, s59
    v_and_or_b32 v56, s68, v53, v54
    v_and_or_b32 v57, s68, v53, v55
    ds_read_b64_tr_b16 v[156:157], v56 offset:0
    ds_read_b64_tr_b16 v[158:159], v56 offset:2048
    ds_read_b64_tr_b16 v[160:161], v56 offset:1024
    ds_read_b64_tr_b16 v[162:163], v56 offset:3072
    ds_read_b64_tr_b16 v[164:165], v57 offset:0
    ds_read_b64_tr_b16 v[166:167], v57 offset:2048
    ds_read_b64_tr_b16 v[168:169], v57 offset:1024
    ds_read_b64_tr_b16 v[170:171], v57 offset:3072
    s_branch K_IT5
K_NUL4:
    s_and_b32 s59, s67, s68
    s_and_b32 s59, s59, s69
    s_and_b32 s59, s59, s70
    s_cmp_lt_i32 s59, 0
    s_cbranch_scc0 K_PC4
    s_cmp_eq_u32 s73, 0
    s_cbranch_scc1 K_P2_MM
K_SPN4:
    s_waitcnt lgkmcnt(0)
    v_readfirstlane_b32 s58, v59
    ds_read_b32 v59, v58
    s_and_b32 s33, s58, s73
    s_cbranch_scc0 K_SPN4
    s_branch K_BK4
K_PC4:
    s_cmp_eq_u32 s73, 0
    s_cbranch_scc1 K_BK4
    s_waitcnt lgkmcnt(0)
    v_readfirstlane_b32 s58, v59
    ds_read_b32 v59, v58
    s_and_b32 s33, s58, s73
    s_cbranch_scc1 K_BK4
    s_branch K_BK4
K_STM22:
    s_branch K_STM26
K_STA22:
    s_branch K_STA26
K_FX5:
    s_sub_u32 s74, s74, 1
    s_cbranch_scc1 K_GO5
    s_lshr_b32 s59, s67, 12
    s_bitset1_b32 s73, s59
K_SK5:
    s_waitcnt lgkmcnt(8)
    v_readfirstlane_b32 s58, v59
    ds_read_b32 v59, v58
    s_and_b32 s33, s58, s73
    s_cbranch_scc0 K_NUL5
K_BK5:
    s_ff1_i32_b32 s59, s33
    s_lshl_b32 s72, s59, 12
    buffer_load_dwordx4 v[100:103], v52, s[20:23], s72 offen offset:0 sc1
    buffer_load_dwordx4 v[104:107], v52, s[20:23], s72 offen offset:512 sc1
    s_bitset0_b32 s73, s59
    v_and_or_b32 v56, s69, v53, v54
    v_and_or_b32 v57, s69, v53, v55
    ds_read_b64_tr_b16 v[172:173], v56 offset:0
    ds_read_b64_tr_b16 v[174:175], v56 offset:2048
    ds_read_b64_tr_b16 v[176:177], v56 offset:1024
    ds_read_b64_tr_b16 v[178:179], v56 offset:3072
    ds_read_b64_tr_b16 v[180:181], v57 offset:0
    ds_read_b64_tr_b16 v[182:183], v57 offset:2048
    ds_read_b64_tr_b16 v[184:185], v57 offset:1024
    ds_read_b64_tr_b16 v[186:187], v57 offset:3072
    s_branch K_IT0
K_NUL5:
    s_and_b32 s59, s68, s69
    s_and_b32 s59, s59, s70
    s_and_b32 s59, s59, s71
    s_cmp_lt_i32 s59, 0
    s_cbranch_scc0 K_PC5
    s_cmp_eq_u32 s73, 0
    s_cbranch_scc1 K_P2_MM
K_SPN5:
    s_waitcnt lgkmcnt(0)
    v_readfirstlane_b32 s58, v59
    ds_read_b32 v59, v58
    s_and_b32 s33, s58, s73
    s_cbranch_scc0 K_SPN5
    s_branch K_BK5
K_PC5:
    s_cmp_eq_u32 s73, 0
    s_cbranch_scc1 K_BK5
    s_waitcnt lgkmcnt(0)
    v_readfirstlane_b32 s58, v59
    ds_read_b32 v59, v58
    s_and_b32 s33, s58, s73
    s_cbranch_scc1 K_BK5
    s_branch K_BK5
K_P2_MM:
    v_cvt_pk_bf16_f32 v188, v108, v109
    v_cvt_pk_bf16_f32 v189, v110, v111
    ds_write_b64 v50, v[188:189] offset:0
    v_cvt_pk_bf16_f32 v190, v112, v113
    v_cvt_pk_bf16_f32 v191, v114, v115
    ds_write_b64 v50, v[190:191] offset:16
    v_cvt_pk_bf16_f32 v192, v116, v117
    v_cvt_pk_bf16_f32 v193, v118, v119
    ds_write_b64 v50, v[192:193] offset:32
    v_cvt_pk_bf16_f32 v194, v120, v121
    v_cvt_pk_bf16_f32 v195, v122, v123
    ds_write_b64 v50, v[194:195] offset:48
    v_cvt_pk_bf16_f32 v188, v124, v125
    v_cvt_pk_bf16_f32 v189, v126, v127
    ds_write_b64 v50, v[188:189] offset:64
    v_cvt_pk_bf16_f32 v190, v128, v129
    v_cvt_pk_bf16_f32 v191, v130, v131
    ds_write_b64 v50, v[190:191] offset:80
    v_cvt_pk_bf16_f32 v192, v132, v133
    v_cvt_pk_bf16_f32 v193, v134, v135
    ds_write_b64 v50, v[192:193] offset:96
    v_cvt_pk_bf16_f32 v194, v136, v137
    v_cvt_pk_bf16_f32 v195, v138, v139
    ds_write_b64 v50, v[194:195] offset:112
    v_lshlrev_b32 v32, 16, v16
    v_and_b32 v33, 0xffff0000, v16
    v_lshlrev_b32 v34, 16, v17
    v_and_b32 v35, 0xffff0000, v17
    v_lshlrev_b32 v36, 16, v18
    v_and_b32 v37, 0xffff0000, v18
    v_lshlrev_b32 v38, 16, v19
    v_and_b32 v39, 0xffff0000, v19
    v_lshlrev_b32 v40, 16, v20
    v_and_b32 v41, 0xffff0000, v20
    v_lshlrev_b32 v42, 16, v21
    v_and_b32 v43, 0xffff0000, v21
    v_lshlrev_b32 v44, 16, v22
    v_and_b32 v45, 0xffff0000, v22
    v_lshlrev_b32 v46, 16, v23
    v_and_b32 v47, 0xffff0000, v23
K_P2_E2:
    s_waitcnt vmcnt(0) lgkmcnt(0)
    s_lshl_b32 s76, s53, 4
    s_barrier
    ds_read_b64 v[28:29], v15
    ds_read_b64 v[24:25], v11
    ds_read_b128 v[48:51], v14
    ds_read_b64 v[26:27], v11 offset:64
    ds_read_b128 v[52:55], v14 offset:1152
    s_waitcnt lgkmcnt(4)
    v_readfirstlane_b32 s56, v28
    v_readfirstlane_b32 s57, v29
    s_sub_u32 s3, s56, s76
    s_cmp_lt_u32 s3, 16
    s_cbranch_scc1 K_YROW0
K_NOY0:
    s_sub_u32 s3, s57, s76
    s_cmp_lt_u32 s3, 16
    s_cbranch_scc1 K_YROW1
K_NOY1:
    s_waitcnt lgkmcnt(3)
    v_pk_mul_f32 v[32:33], v[32:33], v[24:25] op_sel:[0,1] op_sel_hi:[1,1]
    v_pk_mul_f32 v[34:35], v[34:35], v[24:25] op_sel:[0,1] op_sel_hi:[1,1]
    v_pk_mul_f32 v[36:37], v[36:37], v[24:25] op_sel:[0,1] op_sel_hi:[1,1]
    v_pk_mul_f32 v[38:39], v[38:39], v[24:25] op_sel:[0,1] op_sel_hi:[1,1]
    s_waitcnt lgkmcnt(2)
    v_lshlrev_b32 v68, 16, v48
    v_and_b32 v69, 0xffff0000, v48
    v_pk_fma_f32 v[68:69], v[68:69], v[24:25], v[32:33] op_sel_hi:[1,0,1]
    v_cvt_pk_bf16_f32 v48, v68, v69
    v_lshlrev_b32 v70, 16, v49
    v_and_b32 v71, 0xffff0000, v49
    v_pk_fma_f32 v[70:71], v[70:71], v[24:25], v[34:35] op_sel_hi:[1,0,1]
    v_cvt_pk_bf16_f32 v49, v70, v71
    v_lshlrev_b32 v68, 16, v50
    v_and_b32 v69, 0xffff0000, v50
    v_pk_fma_f32 v[68:69], v[68:69], v[24:25], v[36:37] op_sel_hi:[1,0,1]
    v_cvt_pk_bf16_f32 v50, v68, v69
    v_lshlrev_b32 v70, 16, v51
    v_and_b32 v71, 0xffff0000, v51
    v_pk_fma_f32 v[70:71], v[70:71], v[24:25], v[38:39] op_sel_hi:[1,0,1]
    v_cvt_pk_bf16_f32 v51, v70, v71
    buffer_store_dwordx4 v[48:51], v10, s[48:51], 0 offen sc1
    s_waitcnt lgkmcnt(1)
    v_pk_mul_f32 v[40:41], v[40:41], v[26:27] op_sel:[0,1] op_sel_hi:[1,1]
    v_pk_mul_f32 v[42:43], v[42:43], v[26:27] op_sel:[0,1] op_sel_hi:[1,1]
    v_pk_mul_f32 v[44:45], v[44:45], v[26:27] op_sel:[0,1] op_sel_hi:[1,1]
    v_pk_mul_f32 v[46:47], v[46:47], v[26:27] op_sel:[0,1] op_sel_hi:[1,1]
    s_waitcnt lgkmcnt(0)
    v_lshlrev_b32 v68, 16, v52
    v_and_b32 v69, 0xffff0000, v52
    v_pk_fma_f32 v[68:69], v[68:69], v[26:27], v[40:41] op_sel_hi:[1,0,1]
    v_cvt_pk_bf16_f32 v52, v68, v69
    v_lshlrev_b32 v70, 16, v53
    v_and_b32 v71, 0xffff0000, v53
    v_pk_fma_f32 v[70:71], v[70:71], v[26:27], v[42:43] op_sel_hi:[1,0,1]
    v_cvt_pk_bf16_f32 v53, v70, v71
    v_lshlrev_b32 v68, 16, v54
    v_and_b32 v69, 0xffff0000, v54
    v_pk_fma_f32 v[68:69], v[68:69], v[26:27], v[44:45] op_sel_hi:[1,0,1]
    v_cvt_pk_bf16_f32 v54, v68, v69
    v_lshlrev_b32 v70, 16, v55
    v_and_b32 v71, 0xffff0000, v55
    v_pk_fma_f32 v[70:71], v[70:71], v[26:27], v[46:47] op_sel_hi:[1,0,1]
    v_cvt_pk_bf16_f32 v55, v70, v71
    buffer_store_dwordx4 v[52:55], v10, s[48:51], s55 offen sc1
K_END:
K_EXIT:
    s_endpgm
K_YROW0:
    v_and_b32 v2, 7, v1
    v_lshlrev_b32 v2, 5, v2
    s_branch K_J4dec
K_STM23:
    s_branch K_STM27
K_STA23:
    s_branch K_STA27
K_J4dec:
    v_add_u32 v2, 158976, v2
    ds_read_b128 v[56:59], v2
    ds_read_b128 v[60:63], v2 offset:16
    s_and_b32 s33, s3, 7
    v_cmp_eq_u32 vcc, s33, v8
    s_cmp_ge_u32 s3, 8
    s_cbranch_scc1 K_YR1_0
    s_waitcnt lgkmcnt(0)
    v_add_f32 v64, v32, v56
    v_cvt_pk_bf16_f32 v64, v64, v64
    v_lshlrev_b32 v64, 16, v64
    v_cndmask_b32 v32, v32, v64, vcc
    v_add_f32 v65, v33, v57
    v_cvt_pk_bf16_f32 v65, v65, v65
    v_lshlrev_b32 v65, 16, v65
    v_cndmask_b32 v33, v33, v65, vcc
    v_add_f32 v66, v34, v58
    v_cvt_pk_bf16_f32 v66, v66, v66
    v_lshlrev_b32 v66, 16, v66
    v_cndmask_b32 v34, v34, v66, vcc
    v_add_f32 v67, v35, v59
    v_cvt_pk_bf16_f32 v67, v67, v67
    v_lshlrev_b32 v67, 16, v67
    v_cndmask_b32 v35, v35, v67, vcc
    v_add_f32 v64, v36, v60
    v_cvt_pk_bf16_f32 v64, v64, v64
    v_lshlrev_b32 v64, 16, v64
    v_cndmask_b32 v36, v36, v64, vcc
    v_add_f32 v65, v37, v61
    v_cvt_pk_bf16_f32 v65, v65, v65
    v_lshlrev_b32 v65, 16, v65
    v_cndmask_b32 v37, v37, v65, vcc
    v_add_f32 v66, v38, v62
    v_cvt_pk_bf16_f32 v66, v66, v66
    v_lshlrev_b32 v66, 16, v66
    v_cndmask_b32 v38, v38, v66, vcc
    v_add_f32 v67, v39, v63
    v_cvt_pk_bf16_f32 v67, v67, v67
    v_lshlrev_b32 v67, 16, v67
    v_cndmask_b32 v39, v39, v67, vcc
    s_branch K_NOY0
K_YR1_0:
    s_waitcnt lgkmcnt(0)
    v_add_f32 v64, v40, v56
    v_cvt_pk_bf16_f32 v64, v64, v64
    v_lshlrev_b32 v64, 16, v64
    v_cndmask_b32 v40, v40, v64, vcc
    v_add_f32 v65, v41, v57
    v_cvt_pk_bf16_f32 v65, v65, v65
    v_lshlrev_b32 v65, 16, v65
    v_cndmask_b32 v41, v41, v65, vcc
    v_add_f32 v66, v42, v58
    v_cvt_pk_bf16_f32 v66, v66, v66
    v_lshlrev_b32 v66, 16, v66
    v_cndmask_b32 v42, v42, v66, vcc
    v_add_f32 v67, v43, v59
    v_cvt_pk_bf16_f32 v67, v67, v67
    v_lshlrev_b32 v67, 16, v67
    v_cndmask_b32 v43, v43, v67, vcc
    v_add_f32 v64, v44, v60
    v_cvt_pk_bf16_f32 v64, v64, v64
    v_lshlrev_b32 v64, 16, v64
    v_cndmask_b32 v44, v44, v64, vcc
    v_add_f32 v65, v45, v61
    v_cvt_pk_bf16_f32 v65, v65, v65
    v_lshlrev_b32 v65, 16, v65
    v_cndmask_b32 v45, v45, v65, vcc
    v_add_f32 v66, v46, v62
    v_cvt_pk_bf16_f32 v66, v66, v66
    v_lshlrev_b32 v66, 16, v66
    v_cndmask_b32 v46, v46, v66, vcc
    v_add_f32 v67, v47, v63
    v_cvt_pk_bf16_f32 v67, v67, v67
    v_lshlrev_b32 v67, 16, v67
    v_cndmask_b32 v47, v47, v67, vcc
    s_branch K_NOY0
K_YROW1:
    v_and_b32 v2, 7, v1
    v_lshlrev_b32 v2, 5, v2
    v_add_u32 v2, 159232, v2
    ds_read_b128 v[56:59], v2
    ds_read_b128 v[60:63], v2 offset:16
    s_and_b32 s33, s3, 7
    v_cmp_eq_u32 vcc, s33, v8
    s_cmp_ge_u32 s3, 8
    s_cbranch_scc1 K_YR1_1
    s_waitcnt lgkmcnt(0)
    v_add_f32 v64, v32, v56
    v_cvt_pk_bf16_f32 v64, v64, v64
    v_lshlrev_b32 v64, 16, v64
    v_cndmask_b32 v32, v32, v64, vcc
    v_add_f32 v65, v33, v57
    v_cvt_pk_bf16_f32 v65, v65, v65
    v_lshlrev_b32 v65, 16, v65
    v_cndmask_b32 v33, v33, v65, vcc
    v_add_f32 v66, v34, v58
    v_cvt_pk_bf16_f32 v66, v66, v66
    v_lshlrev_b32 v66, 16, v66
    v_cndmask_b32 v34, v34, v66, vcc
    v_add_f32 v67, v35, v59
    v_cvt_pk_bf16_f32 v67, v67, v67
    v_lshlrev_b32 v67, 16, v67
    v_cndmask_b32 v35, v35, v67, vcc
    v_add_f32 v64, v36, v60
    s_branch K_PG4
.p2align 12
K_STM24:
    s_branch K_STM28
K_STA24:
    s_branch K_STA28
K_PG4:
    v_cvt_pk_bf16_f32 v64, v64, v64
    v_lshlrev_b32 v64, 16, v64
    v_cndmask_b32 v36, v36, v64, vcc
    v_add_f32 v65, v37, v61
    v_cvt_pk_bf16_f32 v65, v65, v65
    v_lshlrev_b32 v65, 16, v65
    v_cndmask_b32 v37, v37, v65, vcc
    v_add_f32 v66, v38, v62
    v_cvt_pk_bf16_f32 v66, v66, v66
    v_lshlrev_b32 v66, 16, v66
    v_cndmask_b32 v38, v38, v66, vcc
    v_add_f32 v67, v39, v63
    v_cvt_pk_bf16_f32 v67, v67, v67
    v_lshlrev_b32 v67, 16, v67
    v_cndmask_b32 v39, v39, v67, vcc
    s_branch K_NOY1
K_YR1_1:
    s_waitcnt lgkmcnt(0)
    v_add_f32 v64, v40, v56
    v_cvt_pk_bf16_f32 v64, v64, v64
    v_lshlrev_b32 v64, 16, v64
    v_cndmask_b32 v40, v40, v64, vcc
    v_add_f32 v65, v41, v57
    v_cvt_pk_bf16_f32 v65, v65, v65
    v_lshlrev_b32 v65, 16, v65
    v_cndmask_b32 v41, v41, v65, vcc
    v_add_f32 v66, v42, v58
    v_cvt_pk_bf16_f32 v66, v66, v66
    v_lshlrev_b32 v66, 16, v66
    v_cndmask_b32 v42, v42, v66, vcc
    v_add_f32 v67, v43, v59
    v_cvt_pk_bf16_f32 v67, v67, v67
    v_lshlrev_b32 v67, 16, v67
    v_cndmask_b32 v43, v43, v67, vcc
    v_add_f32 v64, v44, v60
    v_cvt_pk_bf16_f32 v64, v64, v64
    v_lshlrev_b32 v64, 16, v64
    v_cndmask_b32 v44, v44, v64, vcc
    v_add_f32 v65, v45, v61
    v_cvt_pk_bf16_f32 v65, v65, v65
    v_lshlrev_b32 v65, 16, v65
    v_cndmask_b32 v45, v45, v65, vcc
    v_add_f32 v66, v46, v62
    v_cvt_pk_bf16_f32 v66, v66, v66
    v_lshlrev_b32 v66, 16, v66
    v_cndmask_b32 v46, v46, v66, vcc
    v_add_f32 v67, v47, v63
    v_cvt_pk_bf16_f32 v67, v67, v67
    v_lshlrev_b32 v67, 16, v67
    v_cndmask_b32 v47, v47, v67, vcc
    s_branch K_NOY1
K_P2:
    s_cmp_ge_u32 s30, 4
    s_cbranch_scc1 K_P2_HELP
    s_lshl_b32 s54, s40, 7
    v_lshrrev_b32 v8, 3, v1
    v_lshrrev_b32 v9, 4, v1
    v_mov_b32 v15, 158720
    s_lshl_b32 s53, s40, 3
    s_add_u32 s53, s53, s30
    s_mul_i32 s3, s53, 20480
    s_lshl_b32 s33, s41, 7
    s_add_u32 s3, s3, s33
    v_and_b32 v2, 7, v1
    v_lshlrev_b32 v2, 4, v2
    v_mul_u32_u24 v4, 1280, v8
    v_add3_u32 v10, v2, v4, s3
    s_lshl_b32 s3, s30, 7
    s_add_u32 s3, s3, 159744
    v_lshl_add_u32 v11, v8, 3, s3
    s_mov_b32 s55, 10240
    s_add_u32 s20, s6, 0x100000
    s_addc_u32 s21, s7, 0
    s_mov_b32 s22, 0x280000
    s_mov_b32 s23, 0x20000
    s_mov_b32 s48, s10
    s_mov_b32 s49, s11
    s_mov_b32 s50, 0x280000
    s_mov_b32 s51, 0x20000
    v_mul_u32_u24 v3, 144, v8
    v_add_u32 v3, v2, v3
    s_mov_b32 s75, 140288
    s_cmp_ge_u32 s29, 8
    s_cselect_b32 s75, 81920, s75
    s_mul_i32 s3, s30, 2304
    s_add_u32 s3, s3, s75
    v_add_u32 v14, s3, v3
    buffer_load_dwordx4 v[16:19], v10, s[12:15], 0 offen
    buffer_load_dwordx4 v[20:23], v10, s[12:15], s55 offen
    v_bfe_u32 v48, v1, 2, 2
    v_and_b32 v49, 3, v1
    s_add_u32 s3, s53, s30
    s_lshr_b32 s33, s3, 2
    s_mul_i32 s33, s33, 76
    s_add_u32 s3, s3, s33
    s_lshl_b32 s3, s3, 10
    v_and_b32 v2, 15, v1
    v_lshl_add_u32 v2, v2, 4, s3
    v_lshrrev_b32 v3, 5, v1
    v_lshl_add_u32 v2, v3, 8, v2
    v_and_b32 v4, 1, v9
    v_lshl_add_u32 v52, v4, 10, v2
    v_mov_b32 v53, 0x1f000
    v_lshl_add_u32 v2, v3, 2, v48
    v_lshlrev_b32 v2, 7, v2
    v_lshl_add_u32 v2, v49, 3, v2
    v_lshl_add_u32 v2, v4, 5, v2
    v_lshrrev_b32 v4, 1, v48
    v_lshl_add_u32 v54, v4, 6, v2
    v_xor_b32 v55, 64, v54
    v_and_b32 v2, 31, v1
    v_mul_u32_u24 v2, 144, v2
    v_lshl_add_u32 v2, v3, 3, v2
    s_mul_i32 s3, s30, 4608
    s_add_u32 s3, s3, s75
    v_add_u32 v50, s3, v2
    s_lshl_b32 s3, s40, 3
    s_mul_i32 s33, s3, 187
    s_lshr_b32 s33, s33, 11
    s_add_u32 s33, s33, 1
    s_mul_i32 s33, s33, 11
    s_add_u32 s3, s53, s30
    s_add_u32 s3, s3, 1
    s_cmp_ge_u32 s3, s33
    s_cselect_b32 s52, 24, 16
    s_cmp_gt_u32 s3, s33
    s_cselect_b32 s52, 20, s52
    v_add_u32 v58, s52, v15
    s_mov_b32 s67, -1
    s_mov_b32 s68, -1
    s_mov_b32 s69, -1
    s_mov_b32 s70, -1
    s_mov_b32 s71, -1
    s_mov_b32 s72, -1
    s_mov_b32 s73, 0xfffff
    s_mov_b32 s74, 131072
    v_mov_b32 v108, 0
    v_mov_b32 v109, 0
    v_mov_b32 v110, 0
    v_mov_b32 v111, 0
    v_mov_b32 v112, 0
    v_mov_b32 v113, 0
    v_mov_b32 v114, 0
    v_mov_b32 v115, 0
    v_mov_b32 v116, 0
    v_mov_b32 v117, 0
    v_mov_b32 v118, 0
    v_mov_b32 v119, 0
    v_mov_b32 v120, 0
    v_mov_b32 v121, 0
    v_mov_b32 v122, 0
    v_mov_b32 v123, 0
    v_mov_b32 v124, 0
    v_mov_b32 v125, 0
    v_mov_b32 v126, 0
    v_mov_b32 v127, 0
    v_mov_b32 v128, 0
    v_mov_b32 v129, 0
    v_mov_b32 v130, 0
    v_mov_b32 v131, 0
    v_mov_b32 v132, 0
    v_mov_b32 v133, 0
    v_mov_b32 v134, 0
    v_mov_b32 v135, 0
    v_mov_b32 v136, 0
    v_mov_b32 v137, 0
    v_mov_b32 v138, 0
    v_mov_b32 v139, 0
K_P2_AUXW:
    v_lshrrev_b32 v2, 3, v1
    v_mul_u32_u24 v2, 1280, v2
    v_lshrrev_b32 v3, 2, v1
    v_and_b32 v3, 4, v3
    v_and_b32 v4, 7, v1
    v_xor_b32 v3, v3, v4
    v_lshl_add_u32 v2, v3, 4, v2
    s_lshl_b32 s33, s41, 7
    v_add_u32 v51, s33, v2
    v_lshrrev_b32 v5, 5, v1
    v_mul_u32_u24 v5, 97280, v5
    v_add_u32 v5, v5, v51
    s_lshl_b32 s60, s30, 2
    s_lshr_b32 s60, 0x7520, s60
    s_and_b32 s60, s60, 7
    s_mul_i32 s60, s60, 51200
    s_lshl_b32 s61, s30, 12
    s_add_u32 s52, s60, 0
    s_add_u32 m0, s61, 0
    s_waitcnt vmcnt(5)
    buffer_load_dwordx4 v51, s[24:27], s52 offen lds
    s_add_u32 s52, s60, 10240
    s_branch K_J53cc
K_STM25:
    s_branch K_WRET_M
K_STA25:
    s_branch K_WRET_A
K_J53cc:
    s_add_u32 m0, s61, 1024
    s_waitcnt vmcnt(5)
    buffer_load_dwordx4 v51, s[24:27], s52 offen lds
    s_add_u32 s52, s60, 25600
    s_add_u32 m0, s61, 2048
    s_waitcnt vmcnt(5)
    buffer_load_dwordx4 v51, s[24:27], s52 offen lds
    s_add_u32 s52, s60, 35840
    s_add_u32 m0, s61, 3072
    s_waitcnt vmcnt(5)
    buffer_load_dwordx4 v51, s[24:27], s52 offen lds
    s_add_u32 s52, s60, 409600
    s_add_u32 m0, s61, 20480
    s_waitcnt vmcnt(5)
    buffer_load_dwordx4 v51, s[24:27], s52 offen lds
    s_add_u32 s52, s60, 419840
    s_add_u32 m0, s61, 21504
    s_waitcnt vmcnt(5)
    buffer_load_dwordx4 v51, s[24:27], s52 offen lds
    v_mov_b32 v3, 1
    s_mov_b64 exec, 1
    ds_add_u32 v15, v3 offset:52
    s_mov_b64 exec, -1
    s_add_u32 s52, s60, 435200
    s_add_u32 m0, s61, 22528
    s_waitcnt vmcnt(5)
    buffer_load_dwordx4 v51, s[24:27], s52 offen lds
    s_add_u32 s52, s60, 445440
    s_add_u32 m0, s61, 23552
    s_waitcnt vmcnt(5)
    buffer_load_dwordx4 v51, s[24:27], s52 offen lds
    s_and_b32 s60, s30, 1
    s_mul_i32 s60, s60, 256000
    s_lshr_b32 s61, s30, 1
    s_mul_i32 s61, s61, 25600
    s_add_u32 s60, s60, s61
    s_lshl_b32 s61, s30, 10
    s_add_u32 s52, s60, 20480
    s_add_u32 m0, s61, 16384
    s_waitcnt vmcnt(5)
    buffer_load_dwordx4 v5, s[24:27], s52 offen lds
    s_add_u32 s52, s60, 430080
    s_add_u32 m0, s61, 36864
    s_waitcnt vmcnt(5)
    buffer_load_dwordx4 v5, s[24:27], s52 offen lds
    s_lshl_b32 s60, s30, 2
    s_lshr_b32 s60, 0x6431, s60
    s_and_b32 s60, s60, 7
    s_mul_i32 s60, s60, 51200
    s_lshl_b32 s61, s30, 12
    s_add_u32 s52, s60, 0
    s_add_u32 m0, s61, 40960
    s_waitcnt vmcnt(5)
    buffer_load_dwordx4 v51, s[24:27], s52 offen lds
    s_add_u32 s52, s60, 10240
    s_add_u32 m0, s61, 41984
    s_waitcnt vmcnt(5)
    buffer_load_dwordx4 v51, s[24:27], s52 offen lds
    s_add_u32 s52, s60, 25600
    s_add_u32 m0, s61, 43008
    s_waitcnt vmcnt(5)
    buffer_load_dwordx4 v51, s[24:27], s52 offen lds
    s_add_u32 s52, s60, 35840
    s_add_u32 m0, s61, 44032
    s_waitcnt vmcnt(5)
    buffer_load_dwordx4 v51, s[24:27], s52 offen lds
    s_add_u32 s52, s60, 409600
    s_add_u32 m0, s61, 61440
    s_waitcnt vmcnt(5)
    buffer_load_dwordx4 v51, s[24:27], s52 offen lds
    s_add_u32 s52, s60, 419840
    s_add_u32 m0, s61, 62464
    s_waitcnt vmcnt(5)
    buffer_load_dwordx4 v51, s[24:27], s52 offen lds
    s_add_u32 s52, s60, 435200
    s_add_u32 m0, s61, 63488
    s_waitcnt vmcnt(5)
    buffer_load_dwordx4 v51, s[24:27], s52 offen lds
    s_add_u32 s52, s60, 445440
    s_add_u32 m0, s61, 64512
    s_waitcnt vmcnt(5)
    buffer_load_dwordx4 v51, s[24:27], s52 offen lds
    s_and_b32 s60, s30, 1
    s_mul_i32 s60, s60, 153600
    s_lshr_b32 s61, s30, 1
    s_mul_i32 s61, s61, 25600
    s_add_u32 s60, s60, s61
    s_lshl_b32 s61, s30, 10
    s_add_u32 s52, s60, 71680
    s_add_u32 m0, s61, 57344
    s_waitcnt vmcnt(5)
    buffer_load_dwordx4 v5, s[24:27], s52 offen lds
    s_add_u32 s52, s60, 481280
    s_add_u32 m0, s61, 77824
    s_waitcnt vmcnt(5)
    buffer_load_dwordx4 v5, s[24:27], s52 offen lds
    s_cmp_eq_u32 s30, 0
    s_cbranch_scc1 K_CHA0
    s_cmp_eq_u32 s30, 1
    s_cbranch_scc1 K_CHA1
    s_cmp_eq_u32 s30, 2
    s_cbranch_scc1 K_CHA2
    s_branch K_CHA3
K_WRET_A:
    v_mov_b32 v3, 1
    s_waitcnt vmcnt(0)
    s_mov_b64 exec, 1
    ds_add_u32 v15, v3 offset:44
    s_mov_b64 exec, -1
    s_mov_b32 s3, 1048576
K_P2_GWA:
    ds_read_b32 v2, v15 offset:44
    s_sub_u32 s3, s3, 1
    s_waitcnt lgkmcnt(0)
    v_readfirstlane_b32 s33, v2
    s_nop 3
    s_cselect_b32 s33, 4, s33
    s_cmp_lt_u32 s33, 4
    s_cbranch_scc1 K_P2_GWA
    s_branch K_P2_GEMM
K_STM26:
    s_branch K_WRET_M
K_STA26:
    s_branch K_WRET_A
K_P2_HELP:
    s_setprio 3
    s_cmp_eq_u32 s30, 7
    s_cbranch_scc1 K_P2_W7
    s_lshl_b32 s54, s40, 7
    v_lshrrev_b32 v8, 3, v1
    v_lshrrev_b32 v9, 4, v1
    v_mov_b32 v15, 158720
    s_lshl_b32 s53, s40, 3
    s_add_u32 s53, s53, s30
    s_mul_i32 s3, s53, 20480
    s_lshl_b32 s33, s41, 7
    s_add_u32 s3, s3, s33
    v_and_b32 v2, 7, v1
    v_lshlrev_b32 v2, 4, v2
    v_mul_u32_u24 v4, 1280, v8
    v_add3_u32 v10, v2, v4, s3
    s_lshl_b32 s3, s30, 7
    s_add_u32 s3, s3, 159744
    v_lshl_add_u32 v11, v8, 3, s3
    s_mov_b32 s55, 10240
    s_add_u32 s20, s6, 0x100000
    s_addc_u32 s21, s7, 0
    s_mov_b32 s22, 0x280000
    s_mov_b32 s23, 0x20000
    s_mov_b32 s48, s10
    s_mov_b32 s49, s11
    s_mov_b32 s50, 0x280000
    s_mov_b32 s51, 0x20000
    v_mul_u32_u24 v3, 144, v8
    v_add_u32 v3, v2, v3
    s_mov_b32 s75, 140288
    s_cmp_ge_u32 s29, 8
    s_cselect_b32 s75, 81920, s75
    s_mul_i32 s3, s30, 2304
    s_add_u32 s3, s3, s75
    v_add_u32 v14, s3, v3
    s_add_u32 s44, s6, 0x10000
    s_addc_u32 s45, s7, 0
    s_mov_b32 s46, 0x43800
    s_mov_b32 s47, 0x20000
    v_mov_b32 v108, 1
    buffer_load_dwordx4 v[16:19], v10, s[12:15], 0 offen
    buffer_load_dwordx4 v[20:23], v10, s[12:15], s55 offen
    s_cmp_lg_u32 s30, 6
    s_cbranch_scc1 K_P2_HW
    s_mov_b32 s3, 131072
    s_waitcnt vmcnt(2)
K_P2_DPOLL:
    v_min_u32 v2, v7, v6
    v_cmp_eq_u32 vcc, 0, v2
    s_cbranch_vccz K_P2_DOK
    s_cmp_eq_u32 s3, 131072
    s_cbranch_scc1 K_P2_DNS
    s_sleep 12
K_P2_DNS:
    v_lshl_add_u32 v13, v1, 2, s42
    global_load_dword v7, v13, s[6:7] offset:256 sc1
    v_and_b32 v13, 0xfffffe04, v13
    global_load_dword v6, v13, s[6:7] offset:128 sc1
    s_sub_u32 s3, s3, 1
    s_waitcnt vmcnt(0)
    s_cmp_lg_u32 s3, 0
    s_cbranch_scc1 K_P2_DPOLL
K_P2_DOK:
    v_readlane_b32 s60, v6, 0
    v_readlane_b32 s61, v6, 1
    s_nop 1
    s_and_b32 s3, s60, 0x7ff
    s_sub_u32 s3, 2047, s3
    v_mov_b32 v48, s3
    v_mov_b32 v4, s60
    v_and_b32 v4, 0xffff0000, v4
    v_ashrrev_i32 v5, 31, v4
    v_not_b32 v5, v5
    v_or_b32 v5, 0x80000000, v5
    v_xor_b32 v4, v4, v5
    v_and_b32 v4, 0xffff0000, v4
    v_mul_f32 v5, 0xbfb8aa3b, v4
    v_exp_f32 v5, v5
    s_nop 0
    v_add_f32 v5, 1.0, v5
    v_rcp_f32 v4, v5
    s_nop 0
    v_cvt_pk_bf16_f32 v50, v4, v4
    v_lshlrev_b32 v50, 16, v50
    s_and_b32 s3, s61, 0x7ff
    s_sub_u32 s3, 2047, s3
    v_mov_b32 v49, s3
    v_mov_b32 v4, s61
    v_and_b32 v4, 0xffff0000, v4
    v_ashrrev_i32 v5, 31, v4
    v_not_b32 v5, v5
    v_or_b32 v5, 0x80000000, v5
    v_xor_b32 v4, v4, v5
    v_and_b32 v4, 0xffff0000, v4
    v_mul_f32 v5, 0xbfb8aa3b, v4
    v_exp_f32 v5, v5
    s_nop 0
    v_add_f32 v5, 1.0, v5
    v_rcp_f32 v4, v5
    s_nop 0
    v_cvt_pk_bf16_f32 v51, v4, v4
    v_lshlrev_b32 v51, 16, v51
    ds_write_b128 v15, v[48:51]
    ds_write_b32 v15, v108 offset:40
    v_lshl_add_u32 v13, v1, 4, v15
    v_lshlrev_b32 v52, 16, v7
    v_and_b32 v52, 0x7fff0000, v52
    v_and_b32 v54, 0x7fff0000, v7
    v_sub_f32 v53, 1.0, v52
    v_cvt_pk_bf16_f32 v53, v53, v53
    v_lshlrev_b32 v53, 16, v53
    v_sub_f32 v55, 1.0, v54
    v_cvt_pk_bf16_f32 v55, v55, v55
    v_lshlrev_b32 v55, 16, v55
    ds_write_b128 v13, v[52:55] offset:1024
    s_branch K_P2_E
K_STM27:
    s_branch K_WRET_M
K_STA27:
    s_branch K_WRET_A
K_P2_HW:
    s_mov_b32 s3, 1048576
K_P2_GS2:
    ds_read_b32 v2, v15 offset:40
    s_sleep 1
    s_sub_u32 s3, s3, 1
    s_waitcnt lgkmcnt(0)
    v_readfirstlane_b32 s33, v2
    s_nop 3
    s_cselect_b32 s33, 1, s33
    s_cmp_lt_u32 s33, 1
    s_cbranch_scc1 K_P2_GS2
    ds_read_b128 v[28:31], v15
    s_waitcnt lgkmcnt(0)
    s_cmp_eq_u32 s30, 4
    s_cselect_b64 vcc, -1, 0
    s_nop 1
    v_cndmask_b32 v2, v29, v28, vcc
    v_cndmask_b32 v5, v31, v30, vcc
    s_nop 0
    v_readfirstlane_b32 s60, v2
    s_nop 3
    s_sub_u32 s3, s60, s54
    s_cmp_lt_u32 s3, 128
    s_cbranch_scc0 K_P2_E
    s_mov_b32 s3, 131072
K_P2_YPOLL:
    s_load_dword s33, s[6:7], s42 offset:136 glc
    s_waitcnt lgkmcnt(0)
    s_cmp_lg_u32 s33, 0
    s_cbranch_scc1 K_P2_YGO
    s_sleep 4
    s_sub_u32 s3, s3, 1
    s_cbranch_scc0 K_P2_YPOLL
K_P2_YGO:
    v_and_b32 v2, 15, v1
    v_lshlrev_b32 v2, 4, v2
    v_mul_u32_u24 v4, 5120, v9
    s_sub_u32 s61, s30, 4
    s_mul_i32 s33, s61, 2560
    s_lshl_b32 s3, s41, 8
    s_add_u32 s3, s3, s33
    v_add3_u32 v3, v2, v4, s3
    s_mov_b32 s52, 0
    buffer_load_dwordx4 v[52:55], v3, s[44:47], s52 offen sc1
    s_mov_b32 s52, 20480
    buffer_load_dwordx4 v[56:59], v3, s[44:47], s52 offen sc1
    s_mov_b32 s52, 40960
    buffer_load_dwordx4 v[60:63], v3, s[44:47], s52 offen sc1
    s_mov_b32 s52, 61440
    buffer_load_dwordx4 v[64:67], v3, s[44:47], s52 offen sc1
    s_mov_b32 s52, 81920
    buffer_load_dwordx4 v[68:71], v3, s[44:47], s52 offen sc1
    s_mov_b32 s52, 102400
    buffer_load_dwordx4 v[72:75], v3, s[44:47], s52 offen sc1
    s_mov_b32 s52, 122880
    buffer_load_dwordx4 v[76:79], v3, s[44:47], s52 offen sc1
    s_mov_b32 s52, 143360
    buffer_load_dwordx4 v[80:83], v3, s[44:47], s52 offen sc1
    s_mov_b32 s52, 163840
    buffer_load_dwordx4 v[84:87], v3, s[44:47], s52 offen sc1
    s_mov_b32 s52, 184320
    buffer_load_dwordx4 v[88:91], v3, s[44:47], s52 offen sc1
    s_mov_b32 s52, 204800
    buffer_load_dwordx4 v[92:95], v3, s[44:47], s52 offen sc1
    s_mov_b32 s52, 225280
    buffer_load_dwordx4 v[96:99], v3, s[44:47], s52 offen sc1
    s_mov_b32 s52, 245760
    buffer_load_dwordx4 v[100:103], v3, s[44:47], s52 offen sc1
    s_mov_b32 s52, 266240
    buffer_load_dwordx4 v[104:107], v3, s[44:47], s52 offen sc1
    s_waitcnt vmcnt(12)
    v_add_f32 v48, v52, v56
    v_add_f32 v49, v53, v57
    v_add_f32 v50, v54, v58
    v_add_f32 v51, v55, v59
    s_waitcnt vmcnt(11)
    v_add_f32 v48, v48, v60
    v_add_f32 v49, v49, v61
    v_add_f32 v50, v50, v62
    v_add_f32 v51, v51, v63
    s_waitcnt vmcnt(10)
    v_add_f32 v48, v48, v64
    v_add_f32 v49, v49, v65
    v_add_f32 v50, v50, v66
    v_add_f32 v51, v51, v67
    s_waitcnt vmcnt(9)
    v_add_f32 v48, v48, v68
    v_add_f32 v49, v49, v69
    v_add_f32 v50, v50, v70
    v_add_f32 v51, v51, v71
    s_waitcnt vmcnt(8)
    v_add_f32 v48, v48, v72
    v_add_f32 v49, v49, v73
    v_add_f32 v50, v50, v74
    v_add_f32 v51, v51, v75
    s_waitcnt vmcnt(7)
    v_add_f32 v48, v48, v76
    v_add_f32 v49, v49, v77
    v_add_f32 v50, v50, v78
    v_add_f32 v51, v51, v79
    s_waitcnt vmcnt(6)
    v_add_f32 v48, v48, v80
    v_add_f32 v49, v49, v81
    v_add_f32 v50, v50, v82
    v_add_f32 v51, v51, v83
    s_waitcnt vmcnt(5)
    v_add_f32 v48, v48, v84
    v_add_f32 v49, v49, v85
    v_add_f32 v50, v50, v86
    v_add_f32 v51, v51, v87
    s_waitcnt vmcnt(4)
    v_add_f32 v48, v48, v88
    v_add_f32 v49, v49, v89
    v_add_f32 v50, v50, v90
    v_add_f32 v51, v51, v91
    s_waitcnt vmcnt(3)
    v_add_f32 v48, v48, v92
    v_add_f32 v49, v49, v93
    v_add_f32 v50, v50, v94
    v_add_f32 v51, v51, v95
    s_waitcnt vmcnt(2)
    v_add_f32 v48, v48, v96
    v_add_f32 v49, v49, v97
    v_add_f32 v50, v50, v98
    v_add_f32 v51, v51, v99
    s_waitcnt vmcnt(1)
    v_add_f32 v48, v48, v100
    v_add_f32 v49, v49, v101
    v_add_f32 v50, v50, v102
    v_add_f32 v51, v51, v103
    s_waitcnt vmcnt(0)
    v_add_f32 v48, v48, v104
    v_add_f32 v49, v49, v105
    v_add_f32 v50, v50, v106
    v_add_f32 v51, v51, v107
    v_mov_b32 v52, v48
    v_mov_b32 v53, v49
    v_mov_b32 v54, v50
    v_mov_b32 v55, v51
    s_nop 0
    v_permlane16_swap_b32 v48, v52
    v_permlane16_swap_b32 v49, v53
    v_permlane16_swap_b32 v50, v54
    v_permlane16_swap_b32 v51, v55
    v_add_f32 v48, v48, v52
    v_add_f32 v49, v49, v53
    v_add_f32 v50, v50, v54
    v_add_f32 v51, v51, v55
    v_mov_b32 v52, v48
    v_mov_b32 v53, v49
    v_mov_b32 v54, v50
    v_mov_b32 v55, v51
    s_nop 0
    v_permlane32_swap_b32 v48, v52
    v_permlane32_swap_b32 v49, v53
    v_permlane32_swap_b32 v50, v54
    v_permlane32_swap_b32 v51, v55
    v_add_f32 v48, v48, v52
    v_add_f32 v49, v49, v53
    v_add_f32 v50, v50, v54
    v_add_f32 v51, v51, v55
    v_cvt_pk_bf16_f32 v48, v48, v48
    v_lshlrev_b32 v48, 16, v48
    v_mul_f32 v48, v5, v48
    v_cvt_pk_bf16_f32 v48, v48, v48
    v_lshlrev_b32 v48, 16, v48
    v_cvt_pk_bf16_f32 v49, v49, v49
    v_lshlrev_b32 v49, 16, v49
    v_mul_f32 v49, v5, v49
    v_cvt_pk_bf16_f32 v49, v49, v49
    v_lshlrev_b32 v49, 16, v49
    v_cvt_pk_bf16_f32 v50, v50, v50
    v_lshlrev_b32 v50, 16, v50
    v_mul_f32 v50, v5, v50
    v_cvt_pk_bf16_f32 v50, v50, v50
    v_lshlrev_b32 v50, 16, v50
    v_cvt_pk_bf16_f32 v51, v51, v51
    v_lshlrev_b32 v51, 16, v51
    v_mul_f32 v51, v5, v51
    v_cvt_pk_bf16_f32 v51, v51, v51
    v_lshlrev_b32 v51, 16, v51
    s_lshl_b32 s3, s61, 8
    s_add_u32 s3, s3, 158976
    v_add_u32 v2, s3, v2
    ds_write_b128 v2, v[48:51]
    s_branch K_P2_E
K_STM28:
    s_branch K_WRET_M
K_STA28:
    s_branch K_WRET_A
K_P2_W7:
    s_lshl_b32 s53, s40, 3
    s_mul_i32 s60, s53, 187
    s_lshr_b32 s60, s60, 11
    s_add_u32 s3, s53, 7
    s_mul_i32 s61, s3, 187
    s_lshr_b32 s61, s61, 11
    s_sub_u32 s61, s61, s60
    s_mov_b32 s37, s42
    s_waitcnt lgkmcnt(0)
    s_load_dwordx2 s[56:57], s[6:7], s37 glc
    s_mov_b32 s46, 0x84210
    s_mov_b32 s47, s46
    v_mov_b32 v15, 158720
    s_waitcnt lgkmcnt(0)
    s_cmp_eq_u32 s61, 0
    s_cselect_b32 s57, s56, s57
    s_lshl_b64 s[58:59], s[56:57], 1
    s_and_b64 s[58:59], s[58:59], s[56:57]
    s_lshl_b64 vcc, s[58:59], 2
    s_and_b64 s[58:59], s[58:59], vcc
    s_lshl_b64 s[58:59], s[58:59], 1
    s_and_b64 s[58:59], s[58:59], s[46:47]
    s_or_b64 s[56:57], s[56:57], s[58:59]
    s_and_b32 s60, s56, s57
    v_mov_b32 v48, s56
    v_mov_b32 v49, s57
    v_mov_b32 v50, s60
    ds_write_b96 v15, v[48:50] offset:16
    s_load_dwordx2 s[56:57], s[6:7], s37 glc
    s_cmp_lt_u32 s29, 8
    s_cbranch_scc1 K_P2_W7A
    s_waitcnt vmcnt(2)
    s_barrier
    s_setprio 3
K_P2_W7A:
    s_lshl_b32 s54, s40, 7
    v_lshrrev_b32 v8, 3, v1
    v_lshrrev_b32 v9, 4, v1
    v_mov_b32 v15, 158720
    s_lshl_b32 s53, s40, 3
    s_add_u32 s53, s53, s30
    s_mul_i32 s3, s53, 20480
    s_lshl_b32 s33, s41, 7
    s_add_u32 s3, s3, s33
    v_and_b32 v2, 7, v1
    v_lshlrev_b32 v2, 4, v2
    v_mul_u32_u24 v4, 1280, v8
    v_add3_u32 v10, v2, v4, s3
    s_lshl_b32 s3, s30, 7
    s_add_u32 s3, s3, 159744
    v_lshl_add_u32 v11, v8, 3, s3
    s_mov_b32 s55, 10240
    s_add_u32 s20, s6, 0x100000
    s_addc_u32 s21, s7, 0
    s_mov_b32 s22, 0x280000
    s_mov_b32 s23, 0x20000
    s_mov_b32 s48, s10
    s_mov_b32 s49, s11
    s_mov_b32 s50, 0x280000
    s_mov_b32 s51, 0x20000
    v_mul_u32_u24 v3, 144, v8
    v_add_u32 v3, v2, v3
    s_mov_b32 s75, 140288
    s_cmp_ge_u32 s29, 8
    s_cselect_b32 s75, 81920, s75
    s_mul_i32 s3, s30, 2304
    s_add_u32 s3, s3, s75
    v_add_u32 v14, s3, v3
    buffer_load_dwordx4 v[16:19], v10, s[12:15], 0 offen
    buffer_load_dwordx4 v[20:23], v10, s[12:15], s55 offen
    s_mov_b32 s3, 131072
    s_waitcnt lgkmcnt(0)
K_P2_FCHK:
    s_cmp_eq_u32 s61, 0
    s_cselect_b32 s57, s56, s57
    s_lshl_b64 s[58:59], s[56:57], 1
    s_and_b64 s[58:59], s[58:59], s[56:57]
    s_lshl_b64 vcc, s[58:59], 2
    s_and_b64 s[58:59], s[58:59], vcc
    s_lshl_b64 s[58:59], s[58:59], 1
    s_and_b64 s[58:59], s[58:59], s[46:47]
    s_or_b64 s[56:57], s[56:57], s[58:59]
    s_and_b32 s60, s56, s57
    v_mov_b32 v48, s56
    v_mov_b32 v49, s57
    v_mov_b32 v50, s60
    ds_write_b96 v15, v[48:50] offset:16
    s_cmp_eq_u32 s60, 0xfffff
    s_cbranch_scc1 K_P2_FGO
    s_cmp_lg_u64 s[56:57], 0
    s_cbranch_scc1 K_P2_FS
    s_sleep 8
K_P2_FS:
    s_sleep 2
    s_load_dwordx2 s[56:57], s[6:7], s37 glc
    s_sub_u32 s3, s3, 1
    s_waitcnt lgkmcnt(0)
    s_cbranch_scc0 K_P2_FCHK
    v_mov_b32 v48, -1
    v_mov_b32 v49, -1
    v_mov_b32 v50, -1
    ds_write_b96 v15, v[48:50] offset:16
K_P2_FGO:
K_P2_E:
    s_setprio 0
    s_waitcnt vmcnt(0)
    v_lshlrev_b32 v32, 16, v16
    v_and_b32 v33, 0xffff0000, v16
    v_lshlrev_b32 v34, 16, v17
    v_and_b32 v35, 0xffff0000, v17
    v_lshlrev_b32 v36, 16, v18
    v_and_b32 v37, 0xffff0000, v18
    v_lshlrev_b32 v38, 16, v19
    v_and_b32 v39, 0xffff0000, v19
    v_lshlrev_b32 v40, 16, v20
    v_and_b32 v41, 0xffff0000, v20
    v_lshlrev_b32 v42, 16, v21
    v_and_b32 v43, 0xffff0000, v21
    v_lshlrev_b32 v44, 16, v22
    v_and_b32 v45, 0xffff0000, v22
    v_lshlrev_b32 v46, 16, v23
    v_and_b32 v47, 0xffff0000, v23
    s_branch K_P2_E2
K_CHEND:
K_AUX:
    s_cmp_ge_u32 s30, 4
    s_cbranch_scc1 K_AUX_L
    s_and_b32 s3, s2, 7
    s_lshr_b32 s70, s2, 3
    s_lshl3_add_u32 s3, s3, s70
    s_lshl_b32 s3, s3, 5
    s_lshl3_add_u32 s3, s30, s3
    v_bfe_u32 v8, v0, 4, 2
    v_add_u32 v8, s3, v8
    v_and_b32 v10, 15, v0
    v_lshlrev_b32 v10, 4, v10
    v_mul_u32_u24 v9, 1280, v8
    v_add_u32 v9, v9, v10
    v_and_b32 v2, 63, v0
    v_lshlrev_b32 v2, 4, v2
    s_lshl_b32 s71, s30, 12
    s_add_u32 s71, s71, 126016
    s_mov_b32 s70, 5120
    s_mov_b32 m0, s71
    s_waitcnt lgkmcnt(0)
    s_mov_b32 s16, s44
    s_mov_b32 s17, s45
    s_mov_b32 s18, 0x500
    s_mov_b32 s19, 0x20000
    s_mov_b32 s20, s52
    s_mov_b32 s21, s53
    s_mov_b32 s22, 0x500
    s_mov_b32 s23, 0x20000
    buffer_load_dwordx4 v2, s[16:19], 0 offen lds
    s_branch K_PG5
.p2align 12
K_PG5:
    buffer_load_dwordx4 v2, s[16:19], 0 offen offset:1024 lds
    s_add_u32 m0, s71, 2048
    v_add_u32 v10, s71, v10
    buffer_load_dwordx4 v2, s[20:23], 0 offen lds
    buffer_load_dwordx4 v2, s[20:23], 0 offen offset:1024 lds
    buffer_load_dwordx4 v[16:19], v9, s[12:15], 0 offen offset:0
    buffer_load_dwordx4 v[20:23], v9, s[12:15], s70 offen offset:0
    buffer_load_dwordx4 v[24:27], v9, s[12:15], 0 offen offset:256
    buffer_load_dwordx4 v[28:31], v9, s[12:15], s70 offen offset:256
    buffer_load_dwordx4 v[32:35], v9, s[12:15], 0 offen offset:512
    buffer_load_dwordx4 v[36:39], v9, s[12:15], s70 offen offset:512
    buffer_load_dwordx4 v[40:43], v9, s[12:15], 0 offen offset:768
    buffer_load_dwordx4 v[44:47], v9, s[12:15], s70 offen offset:768
    buffer_load_dwordx4 v[48:51], v9, s[12:15], 0 offen offset:1024
    buffer_load_dwordx4 v[52:55], v9, s[12:15], s70 offen offset:1024
    s_barrier
    v_and_b32 v1, 63, v0
    v_mov_b32 v7, 0
    s_and_b32 s28, s2, 7
    s_lshr_b32 s29, s2, 3
    s_xor_b32 s30, s30, 4
    s_lshr_b32 s34, s29, 3
    s_lshl_b32 s34, s34, 2
    s_and_b32 s3, s29, 3
    s_add_u32 s34, s34, s3
    s_add_u32 s34, s34, 4
    s_bitcmp1_b32 s29, 2
    s_cselect_b32 s34, -1, s34
    s_cmp_lt_u32 s29, 8
    s_cselect_b32 s34, s29, s34
    s_lshl_b32 s40, s28, 1
    s_cmp_ge_u32 s34, 10
    s_addc_u32 s40, s40, 0
    s_sub_u32 s41, s34, 10
    s_cmp_ge_u32 s34, 10
    s_cselect_b32 s41, s41, s34
    s_mul_i32 s42, s28, 20
    s_add_u32 s42, s42, s34
    s_and_b32 s42, s42, 255
    s_lshl_b32 s42, s42, 9
    s_add_u32 s42, s42, 524288
    s_mul_i32 s43, s28, 7
    s_add_u32 s43, s43, s29
    s_sub_u32 s43, s43, 1
    s_cmp_lt_u32 s43, 54
    s_cselect_b32 s43, s43, 63
    s_cmp_eq_u32 s29, 0
    s_cselect_b32 s43, 63, s43
    s_mov_b32 s24, s8
    s_mov_b32 s25, s9
    s_mov_b32 s26, 0xc8000
    s_mov_b32 s27, 0x20000
    s_add_u32 s64, s6, 0x80000
    s_addc_u32 s65, s7, 0
    s_mov_b32 s66, 0x14400
    s_mov_b32 s67, 0x20000
    s_add_u32 s60, s6, 0x10000
    s_addc_u32 s61, s7, 0
    s_mov_b32 s62, 0x43800
    s_mov_b32 s63, 0x20000
    v_mov_b32 v96, 0
    v_mov_b32 v97, 0
    v_mov_b32 v98, 0
    v_mov_b32 v99, 0
    v_mov_b32 v13, 158720
    s_waitcnt vmcnt(10)
    ds_read_b128 v[56:59], v10 offset:0
    ds_read_b128 v[76:79], v10 offset:2048
    ds_read_b128 v[60:63], v10 offset:256
    ds_read_b128 v[80:83], v10 offset:2304
    ds_read_b128 v[64:67], v10 offset:512
    ds_read_b128 v[84:87], v10 offset:2560
    ds_read_b128 v[68:71], v10 offset:768
    ds_read_b128 v[88:91], v10 offset:2816
    ds_read_b128 v[72:75], v10 offset:1024
    ds_read_b128 v[92:95], v10 offset:3072
    s_waitcnt vmcnt(8) lgkmcnt(8)
    v_dot2c_f32_bf16 v96, v16, v56
    v_dot2c_f32_bf16 v98, v16, v76
    v_dot2c_f32_bf16 v97, v20, v56
    v_dot2c_f32_bf16 v99, v20, v76
    v_dot2c_f32_bf16 v96, v17, v57
    v_dot2c_f32_bf16 v98, v17, v77
    v_dot2c_f32_bf16 v97, v21, v57
    v_dot2c_f32_bf16 v99, v21, v77
    v_dot2c_f32_bf16 v96, v18, v58
    v_dot2c_f32_bf16 v98, v18, v78
    v_dot2c_f32_bf16 v97, v22, v58
    v_dot2c_f32_bf16 v99, v22, v78
    v_dot2c_f32_bf16 v96, v19, v59
    v_dot2c_f32_bf16 v98, v19, v79
    v_dot2c_f32_bf16 v97, v23, v59
    v_dot2c_f32_bf16 v99, v23, v79
    s_waitcnt vmcnt(6) lgkmcnt(6)
    v_dot2c_f32_bf16 v96, v24, v60
    v_dot2c_f32_bf16 v98, v24, v80
    v_dot2c_f32_bf16 v97, v28, v60
    v_dot2c_f32_bf16 v99, v28, v80
    v_dot2c_f32_bf16 v96, v25, v61
    v_dot2c_f32_bf16 v98, v25, v81
    v_dot2c_f32_bf16 v97, v29, v61
    v_dot2c_f32_bf16 v99, v29, v81
    v_dot2c_f32_bf16 v96, v26, v62
    v_dot2c_f32_bf16 v98, v26, v82
    v_dot2c_f32_bf16 v97, v30, v62
    v_dot2c_f32_bf16 v99, v30, v82
    v_dot2c_f32_bf16 v96, v27, v63
    v_dot2c_f32_bf16 v98, v27, v83
    v_dot2c_f32_bf16 v97, v31, v63
    v_dot2c_f32_bf16 v99, v31, v83
    s_waitcnt vmcnt(4) lgkmcnt(4)
    v_dot2c_f32_bf16 v96, v32, v64
    v_dot2c_f32_bf16 v98, v32, v84
    v_dot2c_f32_bf16 v97, v36, v64
    v_dot2c_f32_bf16 v99, v36, v84
    v_dot2c_f32_bf16 v96, v33, v65
    v_dot2c_f32_bf16 v98, v33, v85
    v_dot2c_f32_bf16 v97, v37, v65
    v_dot2c_f32_bf16 v99, v37, v85
    v_dot2c_f32_bf16 v96, v34, v66
    v_dot2c_f32_bf16 v98, v34, v86
    v_dot2c_f32_bf16 v97, v38, v66
    v_dot2c_f32_bf16 v99, v38, v86
    v_dot2c_f32_bf16 v96, v35, v67
    v_dot2c_f32_bf16 v98, v35, v87
    v_dot2c_f32_bf16 v97, v39, v67
    v_dot2c_f32_bf16 v99, v39, v87
    s_waitcnt vmcnt(2) lgkmcnt(2)
    v_dot2c_f32_bf16 v96, v40, v68
    v_dot2c_f32_bf16 v98, v40, v88
    v_dot2c_f32_bf16 v97, v44, v68
    v_dot2c_f32_bf16 v99, v44, v88
    v_dot2c_f32_bf16 v96, v41, v69
    v_dot2c_f32_bf16 v98, v41, v89
    v_dot2c_f32_bf16 v97, v45, v69
    v_dot2c_f32_bf16 v99, v45, v89
    v_dot2c_f32_bf16 v96, v42, v70
    v_dot2c_f32_bf16 v98, v42, v90
    v_dot2c_f32_bf16 v97, v46, v70
    v_dot2c_f32_bf16 v99, v46, v90
    v_dot2c_f32_bf16 v96, v43, v71
    v_dot2c_f32_bf16 v98, v43, v91
    v_dot2c_f32_bf16 v97, v47, v71
    v_dot2c_f32_bf16 v99, v47, v91
    s_waitcnt vmcnt(0) lgkmcnt(0)
    v_dot2c_f32_bf16 v96, v48, v72
    v_dot2c_f32_bf16 v98, v48, v92
    v_dot2c_f32_bf16 v97, v52, v72
    v_dot2c_f32_bf16 v99, v52, v92
    v_dot2c_f32_bf16 v96, v49, v73
    v_dot2c_f32_bf16 v98, v49, v93
    v_dot2c_f32_bf16 v97, v53, v73
    v_dot2c_f32_bf16 v99, v53, v93
    v_dot2c_f32_bf16 v96, v50, v74
    v_dot2c_f32_bf16 v98, v50, v94
    v_dot2c_f32_bf16 v97, v54, v74
    v_dot2c_f32_bf16 v99, v54, v94
    v_dot2c_f32_bf16 v96, v51, v75
    v_dot2c_f32_bf16 v98, v51, v95
    v_dot2c_f32_bf16 v97, v55, v75
    v_dot2c_f32_bf16 v99, v55, v95
    s_nop 2
    v_add_f32_dpp v96, v96, v96 quad_perm:[1,0,3,2] row_mask:0xf bank_mask:0xf
    v_add_f32_dpp v97, v97, v97 quad_perm:[1,0,3,2] row_mask:0xf bank_mask:0xf
    v_add_f32_dpp v98, v98, v98 quad_perm:[1,0,3,2] row_mask:0xf bank_mask:0xf
    v_add_f32_dpp v99, v99, v99 quad_perm:[1,0,3,2] row_mask:0xf bank_mask:0xf
    v_add_f32_dpp v96, v96, v96 quad_perm:[2,3,0,1] row_mask:0xf bank_mask:0xf
    v_add_f32_dpp v97, v97, v97 quad_perm:[2,3,0,1] row_mask:0xf bank_mask:0xf
    v_add_f32_dpp v98, v98, v98 quad_perm:[2,3,0,1] row_mask:0xf bank_mask:0xf
    v_add_f32_dpp v99, v99, v99 quad_perm:[2,3,0,1] row_mask:0xf bank_mask:0xf
    v_add_f32_dpp v96, v96, v96 row_half_mirror row_mask:0xf bank_mask:0xf
    v_add_f32_dpp v97, v97, v97 row_half_mirror row_mask:0xf bank_mask:0xf
    v_add_f32_dpp v98, v98, v98 row_half_mirror row_mask:0xf bank_mask:0xf
    v_add_f32_dpp v99, v99, v99 row_half_mirror row_mask:0xf bank_mask:0xf
    v_add_f32_dpp v96, v96, v96 row_mirror row_mask:0xf bank_mask:0xf
    v_add_f32_dpp v97, v97, v97 row_mirror row_mask:0xf bank_mask:0xf
    v_add_f32_dpp v98, v98, v98 row_mirror row_mask:0xf bank_mask:0xf
    v_add_f32_dpp v99, v99, v99 row_mirror row_mask:0xf bank_mask:0xf
    v_and_b32 v4, 31, v8
    v_lshlrev_b32 v11, 2, v4
    v_add_u32 v11, 122880, v11
    v_lshlrev_b32 v12, 1, v4
    v_add_u32 v12, 123008, v12
    v_cvt_pk_bf16_f32 v2, v96, v96
    v_lshlrev_b32 v2, 16, v2
    v_ashrrev_i32 v3, 31, v2
    v_or_b32 v3, 0x80000000, v3
    v_xor_b32 v2, v2, v3
    v_and_b32 v2, 0xffff0000, v2
    v_sub_u32 v3, 0x87ff, v8
    v_or_b32 v96, v2, v3
    ds_write_b32 v11, v96 offset:0
    v_cvt_pk_bf16_f32 v98, v98, v98
    v_lshlrev_b32 v98, 16, v98
    v_mul_f32 v5, 0xbfb8aa3b, v98
    v_exp_f32 v5, v5
    s_nop 0
    v_add_f32 v5, 1.0, v5
    v_rcp_f32 v98, v5
    s_nop 0
    v_cvt_pk_bf16_f32 v98, v98, v98
    v_or_b32 v98, 0x8000, v98
    ds_write_b16 v12, v98 offset:0
    v_cvt_pk_bf16_f32 v2, v97, v97
    v_lshlrev_b32 v2, 16, v2
    v_ashrrev_i32 v3, 31, v2
    v_or_b32 v3, 0x80000000, v3
    v_xor_b32 v2, v2, v3
    v_and_b32 v2, 0xffff0000, v2
    v_sub_u32 v3, 0x87fb, v8
    v_or_b32 v97, v2, v3
    ds_write_b32 v11, v97 offset:16
    v_cvt_pk_bf16_f32 v99, v99, v99
    v_lshlrev_b32 v99, 16, v99
    v_mul_f32 v5, 0xbfb8aa3b, v99
    v_exp_f32 v5, v5
    s_nop 0
    v_add_f32 v5, 1.0, v5
    v_rcp_f32 v99, v5
    s_nop 0
    v_cvt_pk_bf16_f32 v99, v99, v99
    v_or_b32 v99, 0x8000, v99
    ds_write_b16 v12, v99 offset:8
    v_mov_b32 v3, 1
    s_mov_b64 exec, 1
    ds_add_u32 v13, v3 offset:48
    s_mov_b64 exec, -1
    s_cmp_ge_u32 s30, 6
    s_cbranch_scc1 K_AUX_G1
    s_mov_b32 s3, 1048576
K_FGR:
    ds_read_b32 v2, v13 offset:48
    s_sleep 1
    s_sub_u32 s3, s3, 1
    s_waitcnt lgkmcnt(0)
    v_readfirstlane_b32 s33, v2
    s_nop 3
    s_cselect_b32 s33, 4, s33
    s_cmp_lt_u32 s33, 4
    s_cbranch_scc1 K_FGR
    s_cmp_lg_u32 s30, 4
    s_cbranch_scc1 K_AUX_G0
    v_and_b32 v3, 31, v1
    v_lshlrev_b32 v3, 2, v3
    v_add_u32 v3, 122880, v3
    ds_read_b32 v2, v3
    s_waitcnt lgkmcnt(0)
    s_nop 1
    v_max_u32_dpp v3, v2, v2 quad_perm:[1,0,3,2] row_mask:0xf bank_mask:0xf
    s_nop 1
    v_max_u32_dpp v3, v3, v3 quad_perm:[2,3,0,1] row_mask:0xf bank_mask:0xf
    s_nop 1
    v_max_u32_dpp v3, v3, v3 row_half_mirror row_mask:0xf bank_mask:0xf
    s_nop 1
    v_max_u32_dpp v3, v3, v3 row_mirror row_mask:0xf bank_mask:0xf
    s_nop 1
    v_readlane_b32 s68, v3, 0
    v_readlane_b32 s76, v3, 16
    v_readlane_b32 s77, v3, 32
    v_readlane_b32 s78, v3, 48
    s_nop 3
    s_max_u32 s68, s68, s76
    s_max_u32 s77, s77, s78
    s_max_u32 s68, s68, s77
    v_cmp_ne_u32 vcc, s68, v2
    s_nop 1
    v_cndmask_b32 v2, 0, v2, vcc
    s_nop 1
    v_max_u32_dpp v3, v2, v2 quad_perm:[1,0,3,2] row_mask:0xf bank_mask:0xf
    s_nop 1
    v_max_u32_dpp v3, v3, v3 quad_perm:[2,3,0,1] row_mask:0xf bank_mask:0xf
    s_nop 1
    v_max_u32_dpp v3, v3, v3 row_half_mirror row_mask:0xf bank_mask:0xf
    s_nop 1
    v_max_u32_dpp v3, v3, v3 row_mirror row_mask:0xf bank_mask:0xf
    s_nop 1
    v_readlane_b32 s69, v3, 0
    v_readlane_b32 s76, v3, 16
    v_readlane_b32 s77, v3, 32
    v_readlane_b32 s78, v3, 48
    s_nop 3
    s_max_u32 s69, s69, s76
    s_max_u32 s77, s77, s78
    s_max_u32 s69, s69, s77
    s_load_dword s33, s[4:5], 0
    s_waitcnt lgkmcnt(0)
    s_cmp_ge_u32 s33, 1
    s_cbranch_scc1 K_ZO3
    s_sleep 8
    s_load_dword s33, s[4:5], 64
    s_waitcnt lgkmcnt(0)
    s_cmp_ge_u32 s33, 1
    s_cbranch_scc1 K_ZO3
    s_sleep 8
    s_mov_b32 s3, 16384
K_ZB3:
    s_load_dword s33, s[4:5], 0 glc
    s_waitcnt lgkmcnt(0)
    s_cmp_ge_u32 s33, 1
    s_cbranch_scc1 K_ZO3
    s_sleep 32
    s_sub_u32 s3, s3, 1
    s_cbranch_scc0 K_ZB3
K_ZO3:
    s_lshl_b32 s3, s2, 3
    s_add_u32 s3, s3, 606208
    s_atomic_add_x2 s[68:69], s[6:7], s3
    s_cmp_lg_u32 s2, 63
    s_cbranch_scc1 K_AUX_G1
    s_mov_b32 s70, 81920
    v_lshlrev_b32 v3, 3, v1
    s_mov_b32 s3, 131072
K_AUX_POLL:
    buffer_load_dwordx2 v[176:177], v3, s[64:67], s70 offen sc1
    s_waitcnt vmcnt(0)
    v_min_u32 v2, v176, v177
    v_cmp_eq_u32 vcc, 0, v2
    s_cbranch_vccz K_AUX_GOT
    s_sleep 2
    s_sub_u32 s3, s3, 1
    s_cmp_lg_u32 s3, 0
    s_cbranch_scc1 K_AUX_POLL
K_AUX_GOT:
    s_waitcnt lgkmcnt(0)
    s_nop 1
    v_max_u32_dpp v3, v176, v176 quad_perm:[1,0,3,2] row_mask:0xf bank_mask:0xf
    s_nop 1
    v_max_u32_dpp v3, v3, v3 quad_perm:[2,3,0,1] row_mask:0xf bank_mask:0xf
    s_nop 1
    v_max_u32_dpp v3, v3, v3 row_half_mirror row_mask:0xf bank_mask:0xf
    s_nop 1
    v_max_u32_dpp v3, v3, v3 row_mirror row_mask:0xf bank_mask:0xf
    s_nop 1
    v_readlane_b32 s68, v3, 0
    v_readlane_b32 s76, v3, 16
    v_readlane_b32 s77, v3, 32
    v_readlane_b32 s78, v3, 48
    s_nop 3
    s_max_u32 s68, s68, s76
    s_max_u32 s77, s77, s78
    s_max_u32 s68, s68, s77
    v_cmp_ne_u32 vcc, s68, v176
    s_nop 1
    v_cndmask_b32 v2, v177, v176, vcc
    s_nop 1
    v_max_u32_dpp v3, v2, v2 quad_perm:[1,0,3,2] row_mask:0xf bank_mask:0xf
    s_nop 1
    v_max_u32_dpp v3, v3, v3 quad_perm:[2,3,0,1] row_mask:0xf bank_mask:0xf
    s_nop 1
    v_max_u32_dpp v3, v3, v3 row_half_mirror row_mask:0xf bank_mask:0xf
    s_nop 1
    v_max_u32_dpp v3, v3, v3 row_mirror row_mask:0xf bank_mask:0xf
    s_nop 1
    v_readlane_b32 s69, v3, 0
    v_readlane_b32 s76, v3, 16
    v_readlane_b32 s77, v3, 32
    v_readlane_b32 s78, v3, 48
    s_nop 3
    s_max_u32 s69, s69, s76
    s_max_u32 s77, s77, s78
    s_max_u32 s69, s69, s77
    v_mov_b32 v176, s68
    v_mov_b32 v177, s69
    s_mov_b32 s3, 1048576
K_FGZ:
    ds_read_b32 v2, v13 offset:36
    s_sleep 1
    s_sub_u32 s3, s3, 1
    s_waitcnt lgkmcnt(0)
    v_readfirstlane_b32 s33, v2
    s_nop 3
    s_cselect_b32 s33, 1, s33
    s_cmp_lt_u32 s33, 1
    s_cbranch_scc1 K_FGZ
    v_lshlrev_b32 v3, 9, v1
    s_mov_b32 s66, 81920
    s_mov_b32 s70, 0
    buffer_store_dwordx2 v[176:177], v3, s[64:67], s70 offen offset:128 sc1
    s_mov_b32 s70, 32768
    buffer_store_dwordx2 v[176:177], v3, s[64:67], s70 offen offset:128 sc1
    s_mov_b32 s70, 65536
    buffer_store_dwordx2 v[176:177], v3, s[64:67], s70 offen offset:128 sc1
    v_mov_b32 v3, 16
    ds_write_b32 v13, v3 offset:48
    s_branch K_AUX_G1
K_AUX_G0:
    v_and_b32 v3, 3, v1
    v_lshlrev_b32 v3, 4, v3
    v_add_u32 v2, 123008, v3
    ds_read_b128 v[176:179], v2
    v_lshrrev_b32 v2, 2, v1
    v_lshl_add_u32 v3, v2, 9, v3
    s_sleep 12
    s_load_dword s33, s[4:5], 128
    s_waitcnt lgkmcnt(0)
    s_cmp_ge_u32 s33, 8
    s_cbranch_scc1 K_ZO4
    s_sleep 8
    s_mov_b32 s3, 16384
K_ZB4:
    s_load_dword s33, s[4:5], 128 glc
    s_waitcnt lgkmcnt(0)
    s_cmp_ge_u32 s33, 8
    s_cbranch_scc1 K_ZO4
    s_sleep 32
    s_sub_u32 s3, s3, 1
    s_cbranch_scc0 K_ZB4
K_ZO4:
    v_mov_b32 v2, 1
    ds_write_b32 v13, v2 offset:36
    s_lshr_b32 s3, s29, 2
    s_lshl1_add_u32 s3, s28, s3
    s_mul_i32 s3, s3, 5120
    s_and_b32 s70, s29, 3
    s_lshl_b32 s70, s70, 6
    s_add_u32 s3, s3, s70
    s_mov_b32 exec_hi, 0xff
    s_waitcnt lgkmcnt(0)
    buffer_store_dwordx4 v[176:179], v3, s[64:67], s3 offen offset:256 sc1
    s_mov_b64 exec, -1
K_AUX_G1:
    s_cmp_lg_u32 s43, 63
    s_cbranch_scc1 K_FFN_C
    s_cmp_lg_u32 s29, 0
    s_cbranch_scc1 K_AUX_NT
    s_mul_i32 s3, s30, 160
    s_sub_u32 s3, s3, 640
    v_lshrrev_b32 v2, 1, v1
    v_add_u32 v2, s3, v2
    v_mul_u32_u24 v2, 1280, v2
    v_and_b32 v3, 1, v1
    v_lshl_add_u32 v2, v3, 7, v2
    s_mov_b32 s70, 0
    buffer_load_dword v5, v2, s[24:27], s70 offen offset:1024
    s_mov_b32 s70, 40960
    buffer_load_dword v5, v2, s[24:27], s70 offen offset:1024
    s_mov_b32 s70, 81920
    buffer_load_dword v5, v2, s[24:27], s70 offen offset:1024
    s_mov_b32 s70, 122880
    buffer_load_dword v5, v2, s[24:27], s70 offen offset:1024
    s_mov_b32 s70, 163840
    buffer_load_dword v5, v2, s[24:27], s70 offen offset:1024
K_AUX_NT:
    s_mov_b32 s3, 1048576
K_FGZ2:
    ds_read_b32 v2, v13 offset:36
    s_sleep 1
    s_sub_u32 s3, s3, 1
    s_waitcnt lgkmcnt(0)
    v_readfirstlane_b32 s33, v2
    s_nop 3
    s_cselect_b32 s33, 1, s33
    s_cmp_lt_u32 s33, 1
    s_cbranch_scc1 K_FGZ2
    s_waitcnt vmcnt(0)
    s_branch K_P2
K_AUX_L:
    v_and_b32 v1, 63, v0
    v_mov_b32 v7, 0
    s_and_b32 s28, s2, 7
    s_lshr_b32 s29, s2, 3
    s_xor_b32 s30, s30, 4
    s_lshr_b32 s34, s29, 3
    s_lshl_b32 s34, s34, 2
    s_and_b32 s3, s29, 3
    s_add_u32 s34, s34, s3
    s_add_u32 s34, s34, 4
    s_bitcmp1_b32 s29, 2
    s_cselect_b32 s34, -1, s34
    s_cmp_lt_u32 s29, 8
    s_cselect_b32 s34, s29, s34
    s_lshl_b32 s40, s28, 1
    s_cmp_ge_u32 s34, 10
    s_addc_u32 s40, s40, 0
    s_sub_u32 s41, s34, 10
    s_cmp_ge_u32 s34, 10
    s_cselect_b32 s41, s41, s34
    s_mul_i32 s42, s28, 20
    s_add_u32 s42, s42, s34
    s_and_b32 s42, s42, 255
    s_lshl_b32 s42, s42, 9
    s_add_u32 s42, s42, 524288
    s_mul_i32 s43, s28, 7
    s_add_u32 s43, s43, s29
    s_sub_u32 s43, s43, 1
    s_cmp_lt_u32 s43, 54
    s_cselect_b32 s43, s43, 63
    s_cmp_eq_u32 s29, 0
    s_cselect_b32 s43, 63, s43
    v_mov_b32 v3, 158736
    ds_write2_b32 v3, v7, v7 offset0:0 offset1:1
    ds_write2_b32 v3, v7, v7 offset0:2 offset1:3
    ds_write2_b32 v3, v7, v7 offset0:4 offset1:5
    ds_write2_b32 v3, v7, v7 offset0:6 offset1:7
    ds_write2_b32 v3, v7, v7 offset0:8 offset1:9
    v_lshrrev_b32 v3, 2, v1
    v_mul_u32_u24 v11, 3456, v3
    v_and_b32 v3, 3, v1
    v_lshl_add_u32 v11, v3, 4, v11
    s_mul_i32 s3, s30, 552960
    s_lshl_b32 s70, s43, 6
    s_add_u32 s3, s3, s70
    v_add_u32 v11, s3, v11
    s_mul_i32 s68, s30, 10240
    s_add_u32 s72, s68, 40960
    s_bitcmp1_b32 s43, 0
    s_cselect_b32 s71, s72, s68
    s_cselect_b32 s72, s68, s72
    v_lshlrev_b32 v8, 4, v1
    s_waitcnt lgkmcnt(0)
    s_barrier
    s_mov_b32 s24, s8
    s_mov_b32 s25, s9
    s_mov_b32 s26, 0xc8000
    s_mov_b32 s27, 0x20000
    s_cmp_lg_u32 s43, 63
    s_cbranch_scc1 K_AUX_FFN1
    s_cmp_lg_u32 s30, 0
    s_cbranch_scc1 K_AUX_NR
    s_cmp_eq_u32 s2, 55
    s_cbranch_scc1 K_AUX_NR
    s_cmp_eq_u32 s2, 63
    s_cselect_b32 s70, 0, 128
    s_mov_b32 s3, 1
    s_waitcnt vmcnt(0)
    s_atomic_add s3, s[4:5], s70
    s_atomic_add s3, s[4:5], s70 offset:64
    s_waitcnt lgkmcnt(0)
K_AUX_NR:
    s_cmp_lg_u32 s2, 63
    s_cbranch_scc1 K_AUX_NH
    v_mov_b32 v13, 158720
    s_mov_b32 s3, 1048576
K_FGH:
    ds_read_b32 v2, v13 offset:48
    s_sleep 1
    s_sub_u32 s3, s3, 1
    s_waitcnt lgkmcnt(0)
    v_readfirstlane_b32 s33, v2
    s_nop 3
    s_cselect_b32 s33, 16, s33
    s_cmp_lt_u32 s33, 16
    s_cbranch_scc1 K_FGH
K_AUX_NH:
    s_branch K_P2
K_AUX_FFN1:
    s_bitcmp1_b32 s43, 0
    s_cselect_b64 s[56:57], s[48:49], s[46:47]
    s_cselect_b64 s[60:61], s[46:47], s[48:49]
    s_mov_b32 s58, 2211840
    s_mov_b32 s59, 0x20000
    s_mov_b32 s62, 2211840
    s_mov_b32 s63, 0x20000
    s_add_u32 m0, s71, 0
    s_mov_b32 s70, 0
    buffer_load_dwordx4 v11, s[56:59], s70 offen  lds
    s_add_u32 m0, s71, 1024
    s_mov_b32 s70, 55296
    buffer_load_dwordx4 v11, s[56:59], s70 offen  lds
    s_add_u32 m0, s71, 2048
    s_mov_b32 s70, 110592
    buffer_load_dwordx4 v11, s[56:59], s70 offen  lds
    s_add_u32 m0, s71, 3072
    s_mov_b32 s70, 165888
    buffer_load_dwordx4 v11, s[56:59], s70 offen  lds
    s_add_u32 m0, s71, 4096
    s_mov_b32 s70, 221184
    buffer_load_dwordx4 v11, s[56:59], s70 offen  lds
    s_add_u32 m0, s71, 5120
    s_mov_b32 s70, 276480
    buffer_load_dwordx4 v11, s[56:59], s70 offen  lds
    s_add_u32 m0, s71, 6144
    s_mov_b32 s70, 331776
    buffer_load_dwordx4 v11, s[56:59], s70 offen  lds
    s_add_u32 m0, s71, 7168
    s_mov_b32 s70, 387072
    buffer_load_dwordx4 v11, s[56:59], s70 offen  lds
    s_add_u32 m0, s71, 8192
    s_mov_b32 s70, 442368
    buffer_load_dwordx4 v11, s[56:59], s70 offen  lds
    s_add_u32 m0, s71, 9216
    s_mov_b32 s70, 497664
    buffer_load_dwordx4 v11, s[56:59], s70 offen  lds
    s_add_u32 m0, s72, 0
    s_mov_b32 s70, 0
    buffer_load_dwordx4 v11, s[60:63], s70 offen  lds
    s_add_u32 m0, s72, 1024
    s_mov_b32 s70, 55296
    buffer_load_dwordx4 v11, s[60:63], s70 offen  lds
    s_add_u32 m0, s72, 2048
    s_mov_b32 s70, 110592
    buffer_load_dwordx4 v11, s[60:63], s70 offen  lds
    s_add_u32 m0, s72, 3072
    s_mov_b32 s70, 165888
    buffer_load_dwordx4 v11, s[60:63], s70 offen  lds
    s_add_u32 m0, s72, 4096
    s_mov_b32 s70, 221184
    buffer_load_dwordx4 v11, s[60:63], s70 offen  lds
    s_add_u32 m0, s72, 5120
    s_mov_b32 s70, 276480
    buffer_load_dwordx4 v11, s[60:63], s70 offen  lds
    s_add_u32 m0, s72, 6144
    s_mov_b32 s70, 331776
    buffer_load_dwordx4 v11, s[60:63], s70 offen  lds
    s_add_u32 m0, s72, 7168
    s_mov_b32 s70, 387072
    buffer_load_dwordx4 v11, s[60:63], s70 offen  lds
    s_add_u32 m0, s72, 8192
    s_mov_b32 s70, 442368
    buffer_load_dwordx4 v11, s[60:63], s70 offen  lds
    s_add_u32 m0, s72, 9216
    s_mov_b32 s70, 497664
    buffer_load_dwordx4 v11, s[60:63], s70 offen  lds
    s_mov_b32 s64, s50
    s_mov_b32 s65, s51
    s_mov_b32 s66, 0x21c000
    s_mov_b32 s67, 0x20000
    s_mul_i32 s3, s43, 40960
    s_add_u32 s3, s3, s68
    v_add_u32 v12, s3, v8
    s_add_u32 m0, s68, 81920
    s_mov_b32 s70, 0
    buffer_load_dwordx4 v12, s[64:67], s70 offen  lds
    s_add_u32 m0, s68, 82944
    s_mov_b32 s70, 1024
    buffer_load_dwordx4 v12, s[64:67], s70 offen  lds
    s_add_u32 m0, s68, 83968
    s_mov_b32 s70, 2048
    buffer_load_dwordx4 v12, s[64:67], s70 offen  lds
    s_add_u32 m0, s68, 84992
    s_mov_b32 s70, 3072
    buffer_load_dwordx4 v12, s[64:67], s70 offen  lds
    s_add_u32 m0, s68, 86016
    s_mov_b32 s70, 4096
    buffer_load_dwordx4 v12, s[64:67], s70 offen  lds
    s_add_u32 m0, s68, 87040
    s_mov_b32 s70, 5120
    buffer_load_dwordx4 v12, s[64:67], s70 offen  lds
    s_add_u32 m0, s68, 88064
    s_mov_b32 s70, 6144
    buffer_load_dwordx4 v12, s[64:67], s70 offen  lds
    s_add_u32 m0, s68, 89088
    s_mov_b32 s70, 7168
    buffer_load_dwordx4 v12, s[64:67], s70 offen  lds
    s_add_u32 m0, s68, 90112
    s_mov_b32 s70, 8192
    buffer_load_dwordx4 v12, s[64:67], s70 offen  lds
    s_add_u32 m0, s68, 91136
    s_mov_b32 s70, 9216
    buffer_load_dwordx4 v12, s[64:67], s70 offen  lds
    s_waitcnt vmcnt(10)
    s_barrier
    s_branch K_P2_EARLY
K_FFN_C:
    v_lshrrev_b32 v180, 4, v1
    v_bfe_u32 v2, v1, 2, 2
    v_lshl_add_u32 v2, v180, 3, v2
    v_and_b32 v3, 3, v1
    v_lshlrev_b32 v3, 3, v3
    v_lshl_add_u32 v181, v2, 6, v3
    s_bfe_u32 s3, s30, 0x10001
    s_mul_i32 s3, s3, 40960
    s_and_b32 s70, s30, 1
    s_lshl_b32 s70, s70, 5
    s_add_u32 s3, s3, s70
    s_add_u32 s3, s3, 0
    v_add_u32 v181, s3, v181
    v_mul_u32_u24 v182, 1280, v2
    s_and_b32 s3, s30, 3
    s_mul_i32 s3, s3, 320
    s_add_u32 s3, s3, 81920
    v_add3_u32 v182, v182, v3, s3
    v_mov_b32 v183, 123904
    s_cmp_lg_u32 s30, 5
    s_cbranch_scc1 K_KW
    s_mov_b32 s3, 131072
K_KPOLL:
    s_load_dwordx2 s[68:69], s[6:7], s42 offset:128 glc
    s_waitcnt lgkmcnt(0)
    s_min_u32 s33, s68, s69
    s_cmp_lg_u32 s33, 0
    s_cbranch_scc1 K_KGOT
    s_sleep 2
    s_sub_u32 s3, s3, 1
    s_cbranch_scc0 K_KPOLL
K_KGOT:
    v_mov_b32 v176, s68
    v_mov_b32 v177, s69
    ds_write_b64 v183, v[176:177]
    v_lshlrev_b32 v2, 4, v1
    s_and_b32 s70, s68, 0x7ff
    s_sub_u32 s70, 2047, s70
    s_mul_i32 s70, s70, 1280
    s_mov_b32 m0, 134208
    s_mov_b64 exec, -1
    buffer_load_dwordx4 v2, s[12:15], s70 offen lds
    s_mov_b64 exec, 0xffff
    buffer_load_dwordx4 v2, s[12:15], s70 offen offset:1024 lds
    s_and_b32 s70, s69, 0x7ff
    s_sub_u32 s70, 2047, s70
    s_mul_i32 s70, s70, 1280
    s_mov_b32 m0, 135552
    s_mov_b64 exec, -1
    buffer_load_dwordx4 v2, s[12:15], s70 offen lds
    s_mov_b64 exec, 0xffff
    buffer_load_dwordx4 v2, s[12:15], s70 offen offset:1024 lds
    s_mov_b64 exec, -1
    v_mov_b32 v3, 16
    s_waitcnt vmcnt(0)
    ds_write_b32 v13, v3 offset:48
    s_branch K_KW2
K_KW:
    s_cmp_lt_u32 s30, 6
    s_cbranch_scc1 K_KW2
    s_cmp_eq_u32 s30, 6
    s_cbranch_scc1 K_CHF0
    s_branch K_CHF1
K_WRET_F:
K_KW2:
    s_branch K_J6f78
K_CHF0:
K_STF29:
    s_branch K_STF31
    s_nop 0
K_J6f78:
    v_and_b32 v2, 1, v1
    v_mul_u32_u24 v9, 1344, v2
    v_lshl_add_u32 v9, v180, 4, v9
    v_add_u32 v9, 134208, v9
    v_and_b32 v2, 1, v1
    v_lshlrev_b32 v192, 6, v2
    v_lshl_add_u32 v192, v180, 4, v192
    s_and_b32 s3, s30, 3
    s_lshl_b32 s3, s3, 7
    v_add3_u32 v193, v192, s3, v183
    v_add_u32 v192, 64, v193
    v_add_u32 v193, 1088, v193
    v_lshrrev_b32 v2, 5, v1
    v_bfe_u32 v3, v1, 4, 1
    v_lshl_add_u32 v3, v3, 1, v2
    v_lshlrev_b32 v3, 6, v3
    v_and_b32 v4, 15, v1
    v_lshl_add_u32 v3, v4, 2, v3
    v_add_u32 v194, 123968, v3
    v_lshlrev_b32 v4, 1, v1
    s_branch K_PG6
.p2align 12
K_CHF1:
K_STF30:
    s_branch K_WRET_F
    s_nop 0
K_PG6:
    s_add_u32 s3, s3, 124992
    v_add_u32 v195, s3, v4
    v_and_b32 v2, 1, v1
    v_mul_u32_u24 v2, 2560, v2
    v_lshl_add_u32 v196, v180, 4, v2
    s_mul_i32 s70, s30, 640
    s_add_u32 s70, s70, 123456
    v_add_u32 v196, s70, v196
    v_mov_b32 v3, 1
    s_mov_b32 s3, 1048576
K_FGK:
    ds_read_b32 v2, v13 offset:48
    s_sleep 1
    s_sub_u32 s3, s3, 1
    s_waitcnt lgkmcnt(0)
    v_readfirstlane_b32 s33, v2
    s_nop 3
    s_cselect_b32 s33, 16, s33
    s_cmp_lt_u32 s33, 16
    s_cbranch_scc1 K_FGK
    ds_read_b128 v[96:99], v9 offset:0
    ds_read_b128 v[100:103], v9 offset:64
    ds_read_b128 v[104:107], v9 offset:128
    ds_read_b128 v[108:111], v9 offset:192
    ds_read_b128 v[112:115], v9 offset:256
    ds_read_b128 v[116:119], v9 offset:320
    ds_read_b128 v[120:123], v9 offset:384
    ds_read_b128 v[124:127], v9 offset:448
    ds_read_b128 v[128:131], v9 offset:512
    ds_read_b128 v[132:135], v9 offset:576
    ds_read_b128 v[136:139], v9 offset:640
    ds_read_b128 v[140:143], v9 offset:704
    ds_read_b128 v[144:147], v9 offset:768
    ds_read_b128 v[148:151], v9 offset:832
    ds_read_b128 v[152:155], v9 offset:896
    ds_read_b128 v[156:159], v9 offset:960
    ds_read_b128 v[160:163], v9 offset:1024
    ds_read_b128 v[164:167], v9 offset:1088
    ds_read_b128 v[168:171], v9 offset:1152
    ds_read_b128 v[172:175], v9 offset:1216
    s_setprio 3
    s_barrier
    ds_read_b64_tr_b16 v[16:17], v181 offset:0
    ds_read_b64_tr_b16 v[18:19], v181 offset:256
    ds_read_b64_tr_b16 v[20:21], v181 offset:2048
    ds_read_b64_tr_b16 v[22:23], v181 offset:2304
    ds_read_b64_tr_b16 v[24:25], v181 offset:4096
    ds_read_b64_tr_b16 v[26:27], v181 offset:4352
    ds_read_b64_tr_b16 v[28:29], v181 offset:6144
    ds_read_b64_tr_b16 v[30:31], v181 offset:6400
    ds_read_b64_tr_b16 v[32:33], v181 offset:8192
    ds_read_b64_tr_b16 v[34:35], v181 offset:8448
    ds_read_b64_tr_b16 v[36:37], v181 offset:10240
    ds_read_b64_tr_b16 v[38:39], v181 offset:10496
    ds_read_b64_tr_b16 v[40:41], v181 offset:12288
    ds_read_b64_tr_b16 v[42:43], v181 offset:12544
    ds_read_b64_tr_b16 v[44:45], v181 offset:14336
    ds_read_b64_tr_b16 v[46:47], v181 offset:14592
    ds_read_b64_tr_b16 v[48:49], v181 offset:16384
    ds_read_b64_tr_b16 v[50:51], v181 offset:16640
    ds_read_b64_tr_b16 v[52:53], v181 offset:18432
    ds_read_b64_tr_b16 v[54:55], v181 offset:18688
    ds_read_b64_tr_b16 v[56:57], v181 offset:20480
    ds_read_b64_tr_b16 v[58:59], v181 offset:20736
    ds_read_b64_tr_b16 v[60:61], v181 offset:22528
    ds_read_b64_tr_b16 v[62:63], v181 offset:22784
    ds_read_b64_tr_b16 v[64:65], v181 offset:24576
    ds_read_b64_tr_b16 v[66:67], v181 offset:24832
    ds_read_b64_tr_b16 v[68:69], v181 offset:26624
    ds_read_b64_tr_b16 v[70:71], v181 offset:26880
    ds_read_b64_tr_b16 v[72:73], v181 offset:28672
    ds_read_b64_tr_b16 v[74:75], v181 offset:28928
    ds_read_b64_tr_b16 v[76:77], v181 offset:30720
    ds_read_b64_tr_b16 v[78:79], v181 offset:30976
    ds_read_b64_tr_b16 v[80:81], v181 offset:32768
    ds_read_b64_tr_b16 v[82:83], v181 offset:33024
    ds_read_b64_tr_b16 v[84:85], v181 offset:34816
    ds_read_b64_tr_b16 v[86:87], v181 offset:35072
    ds_read_b64_tr_b16 v[88:89], v181 offset:36864
    ds_read_b64_tr_b16 v[90:91], v181 offset:37120
    ds_read_b64_tr_b16 v[92:93], v181 offset:38912
    ds_read_b64_tr_b16 v[94:95], v181 offset:39168
    s_waitcnt lgkmcnt(0)
    s_barrier
    v_mfma_f32_16x16x32_bf16 v[184:187], v[16:19], v[96:99], 0
    v_mfma_f32_16x16x32_bf16 v[188:191], v[20:23], v[100:103], 0
    v_mfma_f32_16x16x32_bf16 v[184:187], v[24:27], v[104:107], v[184:187]
    v_mfma_f32_16x16x32_bf16 v[188:191], v[28:31], v[108:111], v[188:191]
    v_mfma_f32_16x16x32_bf16 v[184:187], v[32:35], v[112:115], v[184:187]
    v_mfma_f32_16x16x32_bf16 v[188:191], v[36:39], v[116:119], v[188:191]
    v_mfma_f32_16x16x32_bf16 v[184:187], v[40:43], v[120:123], v[184:187]
    v_mfma_f32_16x16x32_bf16 v[188:191], v[44:47], v[124:127], v[188:191]
    v_mfma_f32_16x16x32_bf16 v[184:187], v[48:51], v[128:131], v[184:187]
    v_mfma_f32_16x16x32_bf16 v[188:191], v[52:55], v[132:135], v[188:191]
    v_mfma_f32_16x16x32_bf16 v[184:187], v[56:59], v[136:139], v[184:187]
    v_mfma_f32_16x16x32_bf16 v[188:191], v[60:63], v[140:143], v[188:191]
    v_mfma_f32_16x16x32_bf16 v[184:187], v[64:67], v[144:147], v[184:187]
    v_mfma_f32_16x16x32_bf16 v[188:191], v[68:71], v[148:151], v[188:191]
    v_mfma_f32_16x16x32_bf16 v[184:187], v[72:75], v[152:155], v[184:187]
    v_mfma_f32_16x16x32_bf16 v[188:191], v[76:79], v[156:159], v[188:191]
    v_mfma_f32_16x16x32_bf16 v[184:187], v[80:83], v[160:163], v[184:187]
    v_mfma_f32_16x16x32_bf16 v[188:191], v[84:87], v[164:167], v[188:191]
    v_mfma_f32_16x16x32_bf16 v[184:187], v[88:91], v[168:171], v[184:187]
    v_mfma_f32_16x16x32_bf16 v[188:191], v[92:95], v[172:175], v[188:191]
    s_nop 7
    v_add_f32 v184, v184, v188
    v_add_f32 v185, v185, v189
    v_add_f32 v186, v186, v190
    v_add_f32 v187, v187, v191
    s_mov_b32 exec_lo, 0x00030003
    s_mov_b32 exec_hi, 0x00030003
    ds_write_b128 v192, v[184:187]
    s_mov_b64 exec, 1
    ds_add_u32 v13, v3 offset:52
    s_mov_b64 exec, -1
    s_cmp_lg_u32 s30, 6
    s_cbranch_scc1 K_NOS6B
    v_lshl_add_u32 v4, v1, 2, s42
    global_load_dword v7, v4, s[6:7] offset:256 sc1
    v_and_b32 v4, 0xfffffe04, v4
    global_load_dword v6, v4, s[6:7] offset:128 sc1
K_NOS6B:
    s_mov_b32 s3, 1048576
K_FGP:
    ds_read_b32 v2, v13 offset:52
    s_sleep 1
    s_sub_u32 s3, s3, 1
    s_waitcnt lgkmcnt(0)
    v_readfirstlane_b32 s33, v2
    s_nop 3
    s_cselect_b32 s33, 8, s33
    s_cmp_lt_u32 s33, 8
    s_cbranch_scc1 K_FGP
    ds_read_b32 v200, v194
    ds_read_b32 v202, v194 offset:256
    ds_read_b64_tr_b16 v[16:17], v182 offset:0
    ds_read_b64_tr_b16 v[18:19], v182 offset:5120
    ds_read_b64_tr_b16 v[20:21], v182 offset:32
    ds_read_b64_tr_b16 v[22:23], v182 offset:5152
    ds_read_b64_tr_b16 v[24:25], v182 offset:64
    s_branch K_J73cc
K_STF31:
    s_branch K_WRET_F
    s_nop 0
K_J73cc:
    ds_read_b64_tr_b16 v[26:27], v182 offset:5184
    ds_read_b64_tr_b16 v[28:29], v182 offset:96
    ds_read_b64_tr_b16 v[30:31], v182 offset:5216
    ds_read_b64_tr_b16 v[32:33], v182 offset:128
    ds_read_b64_tr_b16 v[34:35], v182 offset:5248
    ds_read_b64_tr_b16 v[36:37], v182 offset:160
    ds_read_b64_tr_b16 v[38:39], v182 offset:5280
    ds_read_b64_tr_b16 v[40:41], v182 offset:192
    ds_read_b64_tr_b16 v[42:43], v182 offset:5312
    s_waitcnt lgkmcnt(14)
    v_cvt_pk_bf16_f32 v200, v200, v200
    v_lshlrev_b32 v200, 16, v200
    v_cvt_pk_bf16_f32 v202, v202, v202
    v_lshlrev_b32 v202, 16, v202
    v_mul_f32 v201, 0xbfb8aa3b, v200
    v_exp_f32 v201, v201
    s_nop 0
    v_add_f32 v201, 1.0, v201
    v_rcp_f32 v201, v201
    s_nop 0
    v_mul_f32 v200, v200, v201
    v_cvt_pk_bf16_f32 v200, v200, v200
    v_lshlrev_b32 v200, 16, v200
    v_mul_f32 v200, v200, v202
    v_cvt_pk_bf16_f32 v200, v200, v200
    ds_write_b16 v195, v200
    s_waitcnt lgkmcnt(0)
    ds_read_b128 v[200:203], v193
    ds_read_b64_tr_b16 v[44:45], v182 offset:224
    ds_read_b64_tr_b16 v[46:47], v182 offset:5344
    ds_read_b64_tr_b16 v[48:49], v182 offset:256
    ds_read_b64_tr_b16 v[50:51], v182 offset:5376
    ds_read_b64_tr_b16 v[52:53], v182 offset:288
    ds_read_b64_tr_b16 v[54:55], v182 offset:5408
    s_waitcnt lgkmcnt(6)
    v_mfma_f32_16x16x32_bf16 v[96:99], v[16:19], v[200:203], 0
    v_mfma_f32_16x16x32_bf16 v[100:103], v[20:23], v[200:203], 0
    v_mfma_f32_16x16x32_bf16 v[104:107], v[24:27], v[200:203], 0
    v_mfma_f32_16x16x32_bf16 v[108:111], v[28:31], v[200:203], 0
    v_mfma_f32_16x16x32_bf16 v[112:115], v[32:35], v[200:203], 0
    v_mfma_f32_16x16x32_bf16 v[116:119], v[36:39], v[200:203], 0
    v_mfma_f32_16x16x32_bf16 v[120:123], v[40:43], v[200:203], 0
    s_waitcnt lgkmcnt(4)
    v_mfma_f32_16x16x32_bf16 v[124:127], v[44:47], v[200:203], 0
    s_waitcnt lgkmcnt(2)
    v_mfma_f32_16x16x32_bf16 v[128:131], v[48:51], v[200:203], 0
    s_waitcnt lgkmcnt(0)
    v_mfma_f32_16x16x32_bf16 v[132:135], v[52:55], v[200:203], 0
    s_mov_b32 exec_lo, 0x00030003
    s_mov_b32 exec_hi, 0x00030003
    ds_write_b128 v196, v[96:99] offset:0
    ds_write_b128 v196, v[100:103] offset:64
    ds_write_b128 v196, v[104:107] offset:128
    ds_write_b128 v196, v[108:111] offset:192
    ds_write_b128 v196, v[112:115] offset:256
    ds_write_b128 v196, v[116:119] offset:320
    ds_write_b128 v196, v[120:123] offset:384
    ds_write_b128 v196, v[124:127] offset:448
    ds_write_b128 v196, v[128:131] offset:512
    ds_write_b128 v196, v[132:135] offset:576
    v_mov_b32 v3, 1
    s_mov_b64 exec, 1
    ds_add_u32 v13, v3 offset:52
    s_mov_b64 exec, -1
    s_cmp_lg_u32 s30, 4
    s_cbranch_scc1 K_P2
    v_lshlrev_b32 v3, 4, v1
    v_add_u32 v4, 126016, v3
    s_mul_i32 s70, s43, 5120
    s_add_u32 s71, s70, 4096
    s_mov_b32 s3, 1048576
K_FGQ:
    ds_read_b32 v2, v13 offset:52
    s_sleep 1
    s_sub_u32 s3, s3, 1
    s_waitcnt lgkmcnt(0)
    v_readfirstlane_b32 s33, v2
    s_nop 3
    s_cselect_b32 s33, 12, s33
    s_cmp_lt_u32 s33, 12
    s_cbranch_scc1 K_FGQ
    ds_read_b128 v[16:19], v4 offset:0
    ds_read_b128 v[20:23], v4 offset:1024
    ds_read_b128 v[24:27], v4 offset:2048
    ds_read_b128 v[28:31], v4 offset:3072
    ds_read_b128 v[32:35], v4 offset:4096
    s_waitcnt lgkmcnt(4)
    buffer_store_dwordx4 v[16:19], v3, s[60:63], s70 offen offset:0 sc1
    s_waitcnt lgkmcnt(3)
    buffer_store_dwordx4 v[20:23], v3, s[60:63], s70 offen offset:1024 sc1
    s_waitcnt lgkmcnt(2)
    buffer_store_dwordx4 v[24:27], v3, s[60:63], s70 offen offset:2048 sc1
    s_waitcnt lgkmcnt(1)
    buffer_store_dwordx4 v[28:31], v3, s[60:63], s70 offen offset:3072 sc1
    s_waitcnt lgkmcnt(0)
    buffer_store_dwordx4 v[32:35], v3, s[60:63], s71 offen offset:0 sc1
    s_mov_b32 s3, 1
    s_waitcnt vmcnt(0)
    s_atomic_add s3, s[6:7], 606720 glc
    ds_read_b64 v[176:177], v183
    s_waitcnt lgkmcnt(0)
    s_cmp_lg_u32 s3, 53
    s_cbranch_scc1 K_P2
    v_readfirstlane_b32 s70, v176
    s_and_b32 s70, s70, 0x7ff
    s_sub_u32 s70, 2047, s70
    s_lshr_b32 s70, s70, 7
    s_mul_i32 s70, s70, 5120
    s_atomic_add s3, s[6:7], s70 offset:524424
    s_atomic_add s3, s[6:7], s70 offset:524936
    s_atomic_add s3, s[6:7], s70 offset:525448
    s_atomic_add s3, s[6:7], s70 offset:525960
    s_atomic_add s3, s[6:7], s70 offset:526472
    s_atomic_add s3, s[6:7], s70 offset:526984
    s_atomic_add s3, s[6:7], s70 offset:527496
    s_atomic_add s3, s[6:7], s70 offset:528008
    s_atomic_add s3, s[6:7], s70 offset:528520
    s_atomic_add s3, s[6:7], s70 offset:529032
    v_readfirstlane_b32 s70, v177
    s_and_b32 s70, s70, 0x7ff
    s_sub_u32 s70, 2047, s70
    s_lshr_b32 s70, s70, 7
    s_mul_i32 s70, s70, 5120
    s_atomic_add s3, s[6:7], s70 offset:524424
    s_atomic_add s3, s[6:7], s70 offset:524936
    s_atomic_add s3, s[6:7], s70 offset:525448
    s_atomic_add s3, s[6:7], s70 offset:525960
    s_atomic_add s3, s[6:7], s70 offset:526472
    s_atomic_add s3, s[6:7], s70 offset:526984
    s_atomic_add s3, s[6:7], s70 offset:527496
    s_atomic_add s3, s[6:7], s70 offset:528008
    s_atomic_add s3, s[6:7], s70 offset:528520
    s_atomic_add s3, s[6:7], s70 offset:529032
    s_waitcnt lgkmcnt(0)
    s_branch K_P2
K_CODE_END:
.section .rodata,"a"
.p2align 6
.amdhsa_kernel gated_mix__sliding_local_dilated__moe_arch_mod__prompt_kernel
  .amdhsa_next_free_vgpr 248
  .amdhsa_next_free_sgpr 79
  .amdhsa_accum_offset 248
  .amdhsa_group_segment_fixed_size 0
  .amdhsa_kernarg_size 96
  .amdhsa_user_sgpr_count 2
  .amdhsa_user_sgpr_kernarg_segment_ptr 1
  .amdhsa_system_sgpr_workgroup_id_x 1
.end_amdhsa_kernel
```

```asm
; @launch grid=(256,1,1) block=(512,1,1) lds=163840
.amdgcn_target "amdgcn-amd-amdhsa--gfx950"
.text
K_CPL = 32
.p2align 12
.p2align 8
.globl gated_mix__sliding_local_dilated__moe_arch_mod__prompt_kernel
.type gated_mix__sliding_local_dilated__moe_arch_mod__prompt_kernel,@function
gated_mix__sliding_local_dilated__moe_arch_mod__prompt_kernel:
    s_cmp_ge_u32 s2, 256
    s_cbranch_scc1 K_EXIT
    s_load_dwordx2 s[12:13], s[0:1], 0
    s_load_dwordx2 s[16:17], s[0:1], 8
    s_load_dwordx4 s[4:7], s[0:1], 80
    s_load_dwordx2 s[8:9], s[0:1], 16
    s_load_dwordx2 s[10:11], s[0:1], 72
    v_readfirstlane_b32 s30, v0
    s_mov_b32 s14, 0x280000
    s_mov_b32 s15, 0x20000
    s_lshr_b32 s30, s30, 6
    s_cmp_ge_u32 s2, 64
    s_cbranch_scc1 K_MAIN
    s_load_dwordx8 s[44:51], s[0:1], 32
    s_load_dwordx2 s[52:53], s[0:1], 64
    s_getpc_b64 s[38:39]
K_PC:
    s_lshr_b32 s3, s2, 3
    s_mul_i32 s3, s3, K_CPL
    v_add_u32 v2, s3, v0
    v_lshlrev_b32 v2, 7, v2
    v_min_u32 v2, K_CODE_END-K_PC-4, v2
    v_cmp_gt_u32 vcc, K_CPL, v0
    s_and_saveexec_b64 s[20:21], vcc
    s_cbranch_execz K_NOPF
    global_load_dword v6, v2, s[38:39]
K_NOPF:
    s_mov_b64 exec, -1
    s_cmp_lg_u32 s30, 4
    s_cbranch_scc1 K_AUX
    s_min_u32 s3, s2, 8
    s_mul_i32 s3, s3, 10240
    s_add_u32 s33, s3, 10240
    s_cmp_lt_u32 s2, 8
    s_cbranch_scc1 K_ZS
    s_cmp_lg_u32 s2, 63
    s_cbranch_scc1 K_AUX
    s_mov_b32 s33, 0
K_ZS:
    v_lshlrev_b32 v2, 4, v0
    v_mov_b32 v8, 0
    v_mov_b32 v9, 0
    v_mov_b32 v10, 0
    v_mov_b32 v11, 0
    s_waitcnt lgkmcnt(0)
    s_add_u32 s20, s6, 0x7f000
    s_addc_u32 s21, s7, 0
    s_mov_b32 s22, 0x15400
    s_mov_b32 s23, 0x20000
K_ZL:
    buffer_store_dwordx4 v[8:11], v2, s[20:23], s3 offen sc1
    s_add_u32 s3, s3, 1024
    s_cmp_lt_u32 s3, s33
    s_cbranch_scc1 K_ZL
    s_branch K_AUX
K_MAIN:
    s_cmp_ge_u32 s30, 4
    s_cbranch_scc1 K_CONS
    s_bfe_u32 s3, s2, 0x20001
    s_mul_i32 s44, s3, 675840
    s_lshr_b32 s33, s2, 6
    s_mul_i32 s3, s33, 225280
    s_add_u32 s44, s44, s3
    s_mul_i32 s3, s30, 61440
    s_add_u32 s44, s44, s3
    s_sub_u32 s44, s44, 245760
    v_bfe_u32 v3, v0, 4, 2
    s_lshr_b32 s3, s2, 1
    s_and_b32 s3, s3, 28
    s_or_b32 s3, s3, 0x40000
    v_lshlrev_b32 v2, 1, v3
    v_sub_u32 v2, v0, v2
    s_mov_b32 s49, 0x26375904
    s_cmp_eq_u32 s33, 2
    s_cselect_b32 s49, 0x60719348, s49
    s_cmp_eq_u32 s33, 3
    s_cselect_b32 s49, 0x4153782, s49
    s_bfe_u32 s49, s49, s3
    s_bfe_u32 s32, 0x64317520, s3
    v_and_b32 v2, 15, v2
    v_mul_u32_u24 v5, 3840, v3
    s_and_b32 s3, s2, 7
    s_add_u32 s49, s49, s3
    s_mov_b32 s33, 0x00a55a
    v_subrev_u32 v5, 160, v5
    s_sub_u32 s3, s49, 10
    s_cselect_b32 s49, s49, s3
    v_mul_u32_u24 v4, 52, v2
    v_lshrrev_b32 v4, 5, v4
    v_and_b32 v4, 24, v4
    v_bfe_u32 v4, s33, v4, 8
    v_add_u32 v4, v4, v2
    v_lshl_add_u32 v10, v4, 4, v5
    v_add_u32 v4, 1, v2
    v_lshrrev_b32 v4, 4, v4
    v_lshl_add_u32 v10, v4, 28, v10
    v_xor_b32 v2, 8, v2
    v_mul_u32_u24 v4, 52, v2
    v_lshrrev_b32 v4, 5, v4
    v_and_b32 v4, 24, v4
    v_bfe_u32 v4, s33, v4, 8
    v_add_u32 v4, v4, v2
    v_lshl_add_u32 v11, v4, 4, v5
    v_add_u32 v4, 1, v2
    v_lshrrev_b32 v4, 4, v4
    v_lshl_add_u32 v11, v4, 28, v11
    s_bitcmp1_b32 s2, 0
    s_cselect_b32 s3, 8, 0
    s_add_u32 s32, s32, s3
    s_mul_i32 s50, s32, 80
    s_mul_i32 s3, s30, 61440
    s_add_u32 s50, s50, s3
    s_lshl_b32 s46, s30, 12
    s_add_u32 s46, s46, 24576
    s_mul_i32 s45, s30, 6144
    s_mov_b32 s18, 0x258000
    s_mov_b32 s19, 0x20000
    v_xor_b32 v3, v3, v0
    v_and_b32 v3, 7, v3
    v_bfe_u32 v2, v0, 3, 3
    v_mul_u32_u24 v2, 1280, v2
    v_lshl_add_u32 v8, v3, 4, v2
    v_xor_b32 v9, 64, v8
    s_lshl_b32 s47, s49, 7
    s_mul_i32 s48, s49, 245760
    s_add_u32 s51, s44, s47
    s_add_u32 s48, s48, s50
    s_add_u32 s49, s49, 1
    s_cmp_eq_u32 s49, 10
    s_cselect_b32 s49, 0, s49
    s_waitcnt lgkmcnt(0)
    s_add_u32 m0, s46, 81920
    s_add_u32 s52, s48, 0
    buffer_load_dwordx4 v10, s[16:19], s52 offen lds
    s_add_u32 m0, s45, 81920
    s_max_i32 s52, s51, s47
    buffer_load_dwordx4 v8, s[12:15], s52 offen lds
    s_add_u32 m0, s46, 82944
    s_add_u32 s52, s48, 15360
    buffer_load_dwordx4 v10, s[16:19], s52 offen lds
    s_add_u32 m0, s45, 82944
    s_add_u32 s52, s51, 10240
    s_max_i32 s52, s52, s47
    buffer_load_dwordx4 v9, s[12:15], s52 offen lds
    s_add_u32 m0, s45, 83968
    s_add_u32 s52, s51, 20480
    buffer_load_dwordx4 v8, s[12:15], s52 offen lds
    s_add_u32 m0, s46, 83968
    s_add_u32 s52, s48, 30720
    buffer_load_dwordx4 v11, s[16:19], s52 offen lds
    s_add_u32 m0, s45, 84992
    s_add_u32 s52, s51, 30720
    buffer_load_dwordx4 v9, s[12:15], s52 offen lds
    s_add_u32 m0, s46, 84992
    s_add_u32 s52, s48, 46080
    buffer_load_dwordx4 v11, s[16:19], s52 offen lds
    s_add_u32 m0, s45, 86016
    s_add_u32 s52, s51, 40960
    buffer_load_dwordx4 v8, s[12:15], s52 offen lds
    s_add_u32 m0, s45, 87040
    s_add_u32 s52, s51, 51200
    buffer_load_dwordx4 v9, s[12:15], s52 offen lds
    s_lshl_b32 s47, s49, 7
    s_mul_i32 s48, s49, 245760
    s_add_u32 s51, s44, s47
    s_add_u32 s48, s48, s50
    s_add_u32 s49, s49, 1
    s_cmp_eq_u32 s49, 10
    s_cselect_b32 s49, 0, s49
    s_add_u32 m0, s46, 0
    s_add_u32 s52, s48, 0
    buffer_load_dwordx4 v10, s[16:19], s52 offen lds
    s_add_u32 m0, s45, 0
    s_max_i32 s52, s51, s47
    buffer_load_dwordx4 v8, s[12:15], s52 offen lds
    s_add_u32 m0, s46, 1024
    s_add_u32 s52, s48, 15360
    buffer_load_dwordx4 v10, s[16:19], s52 offen lds
    s_add_u32 m0, s45, 1024
    s_add_u32 s52, s51, 10240
    s_max_i32 s52, s52, s47
    buffer_load_dwordx4 v9, s[12:15], s52 offen lds
    s_add_u32 m0, s45, 2048
    s_add_u32 s52, s51, 20480
    buffer_load_dwordx4 v8, s[12:15], s52 offen lds
    s_mov_b32 s43, s30
    v_and_b32 v1, 63, v0
    v_mov_b32 v7, 0
    s_and_b32 s28, s2, 7
    s_lshr_b32 s29, s2, 3
    s_xor_b32 s30, s30, 4
    s_lshr_b32 s34, s29, 3
    s_lshl_b32 s34, s34, 2
    s_and_b32 s3, s29, 3
    s_add_u32 s34, s34, s3
    s_add_u32 s34, s34, 4
    s_bitcmp1_b32 s29, 2
    s_cselect_b32 s34, -1, s34
    s_cmp_lt_u32 s29, 8
    s_cselect_b32 s34, s29, s34
    s_lshl_b32 s40, s28, 1
    s_cmp_ge_u32 s34, 10
    s_addc_u32 s40, s40, 0
    s_sub_u32 s41, s34, 10
    s_cmp_ge_u32 s34, 10
    s_cselect_b32 s41, s41, s34
    s_mul_i32 s42, s28, 20
    s_add_u32 s42, s42, s34
    s_and_b32 s42, s42, 255
    s_lshl_b32 s42, s42, 9
    s_add_u32 s42, s42, 524288
    s_lshr_b32 s31, s28, 1
    s_mul_i32 s31, s31, 3
    s_lshr_b32 s3, s29, 3
    s_add_u32 s31, s31, s3
    s_sub_u32 s31, s31, 1
    s_and_b32 s32, s28, 1
    s_lshl_b32 s32, s32, 3
    s_and_b32 s3, s29, 7
    s_lshl_b32 s3, s3, 2
    s_lshr_b32 s3, 0x64317520, s3
    s_and_b32 s3, s3, 7
    s_add_u32 s32, s32, s3
    s_and_b32 s35, s29, 3
    s_and_b32 s3, s29, 4
    s_lshl_b32 s3, s3, 1
    s_add_u32 s35, s35, s3
    s_and_b32 s3, s28, 1
    s_lshl_b32 s3, s3, 2
    s_add_u32 s35, s35, s3
K_LOADER:
    s_branch K_J7fc
K_CHM0:
K_STM0:
    s_branch K_STM4
K_STA0:
    s_branch K_STA4
K_J7fc:
    s_mov_b32 s24, s8
    s_mov_b32 s25, s9
    s_mov_b32 s26, 0xc8000
    s_mov_b32 s27, 0x20000
    v_and_b32 v12, 15, v1
    v_lshrrev_b32 v13, 4, v1
    v_bfe_u32 v14, v1, 2, 2
    v_and_b32 v15, 3, v1
    s_add_u32 s20, s6, 0x100000
    s_addc_u32 s21, s7, 0
    s_mov_b32 s22, 0x280000
    s_mov_b32 s23, 0x20000
    s_lshr_b32 s53, s35, 2
    s_add_u32 s3, s53, s35
    s_lshl_b32 s3, s3, 12
    s_mul_i32 s33, s53, 19456
    s_lshl_b32 s53, s35, 8
    s_add_u32 s33, s33, s53
    s_add_u32 s33, s33, 16384
    s_mul_i32 s53, s31, 11
    s_add_u32 s54, s53, s43
    v_mov_b32 v3, s54
    v_lshrrev_b32 v2, 2, v3
    v_mul_u32_u24 v2, 76, v2
    v_add_lshl_u32 v2, v2, v3, 10
    v_lshl_add_u32 v2, v12, 4, v2
    v_add_u32 v16, s3, v2
    v_lshl_add_u32 v16, v13, 8, v16
    s_lshl_b32 s3, s43, 2
    v_add_u32 v4, s3, v13
    v_add_u32 v3, s53, v4
    v_lshrrev_b32 v2, 2, v3
    v_mul_u32_u24 v2, 76, v2
    v_add_lshl_u32 v2, v2, v3, 10
    v_lshl_add_u32 v2, v12, 4, v2
    v_add_u32 v17, s33, v2
    v_mov_b32 v5, 0x10000000
    v_cmp_gt_u32 vcc, 11, v4
    v_mov_b32 v20, -1
    v_mov_b32 v21, -1
    v_mov_b32 v22, -1
    v_mov_b32 v23, -1
    v_cndmask_b32 v17, v5, v17, vcc
    v_lshrrev_b32 v2, 3, v1
    v_mul_u32_u24 v2, 1280, v2
    v_lshrrev_b32 v3, 2, v1
    v_and_b32 v3, 4, v3
    v_and_b32 v4, 7, v1
    v_xor_b32 v3, v3, v4
    v_lshl_add_u32 v2, v3, 4, v2
    s_lshl_b32 s33, s41, 7
    v_add_u32 v18, s33, v2
    v_lshrrev_b32 v5, 5, v1
    v_mul_u32_u24 v5, 20480, v5
    v_add_u32 v5, v5, v18
    s_waitcnt vmcnt(5)
    s_barrier
    s_add_u32 m0, s46, 2048
    s_add_u32 s52, s48, 30720
    buffer_load_dwordx4 v11, s[16:19], s52 offen lds
    s_add_u32 m0, s45, 3072
    s_add_u32 s52, s51, 30720
    buffer_load_dwordx4 v9, s[12:15], s52 offen lds
    s_add_u32 m0, s46, 3072
    s_add_u32 s52, s48, 46080
    buffer_load_dwordx4 v11, s[16:19], s52 offen lds
    s_add_u32 m0, s45, 4096
    s_add_u32 s52, s51, 40960
    buffer_load_dwordx4 v8, s[12:15], s52 offen lds
    s_add_u32 m0, s45, 5120
    s_add_u32 s52, s51, 51200
    buffer_load_dwordx4 v9, s[12:15], s52 offen lds
    s_lshl_b32 s47, s49, 7
    s_mul_i32 s48, s49, 245760
    s_add_u32 s51, s44, s47
    s_add_u32 s48, s48, s50
    s_add_u32 s49, s49, 1
    s_cmp_eq_u32 s49, 10
    s_cselect_b32 s49, 0, s49
    s_add_u32 m0, s46, 40960
    s_add_u32 s52, s48, 0
    buffer_load_dwordx4 v10, s[16:19], s52 offen lds
    s_add_u32 m0, s45, 40960
    s_max_i32 s52, s51, s47
    buffer_load_dwordx4 v8, s[12:15], s52 offen lds
    s_add_u32 m0, s46, 41984
    s_add_u32 s52, s48, 15360
    buffer_load_dwordx4 v10, s[16:19], s52 offen lds
    s_add_u32 m0, s45, 41984
    s_add_u32 s52, s51, 10240
    s_max_i32 s52, s52, s47
    buffer_load_dwordx4 v9, s[12:15], s52 offen lds
    s_add_u32 m0, s45, 43008
    s_add_u32 s52, s51, 20480
    buffer_load_dwordx4 v8, s[12:15], s52 offen lds
    s_waitcnt vmcnt(5)
    s_barrier
    s_add_u32 m0, s46, 43008
    s_add_u32 s52, s48, 30720
    buffer_load_dwordx4 v11, s[16:19], s52 offen lds
    s_add_u32 m0, s45, 44032
    s_add_u32 s52, s51, 30720
    buffer_load_dwordx4 v9, s[12:15], s52 offen lds
    s_add_u32 m0, s46, 44032
    s_add_u32 s52, s48, 46080
    buffer_load_dwordx4 v11, s[16:19], s52 offen lds
    s_add_u32 m0, s45, 45056
    s_add_u32 s52, s51, 40960
    buffer_load_dwordx4 v8, s[12:15], s52 offen lds
    s_add_u32 m0, s45, 46080
    s_add_u32 s52, s51, 51200
    buffer_load_dwordx4 v9, s[12:15], s52 offen lds
    s_lshl_b32 s47, s49, 7
    s_mul_i32 s48, s49, 245760
    s_add_u32 s51, s44, s47
    s_add_u32 s48, s48, s50
    s_add_u32 s49, s49, 1
    s_cmp_eq_u32 s49, 10
    s_cselect_b32 s49, 0, s49
    s_add_u32 m0, s46, 81920
    s_add_u32 s52, s48, 0
    buffer_load_dwordx4 v10, s[16:19], s52 offen lds
    s_add_u32 m0, s45, 81920
    s_max_i32 s52, s51, s47
    buffer_load_dwordx4 v8, s[12:15], s52 offen lds
    s_add_u32 m0, s46, 82944
    s_add_u32 s52, s48, 15360
    buffer_load_dwordx4 v10, s[16:19], s52 offen lds
    s_add_u32 m0, s45, 82944
    s_add_u32 s52, s51, 10240
    s_max_i32 s52, s52, s47
    buffer_load_dwordx4 v9, s[12:15], s52 offen lds
    s_add_u32 m0, s45, 83968
    s_add_u32 s52, s51, 20480
    buffer_load_dwordx4 v8, s[12:15], s52 offen lds
    s_waitcnt vmcnt(5)
    s_barrier
    s_add_u32 m0, s46, 83968
    s_add_u32 s52, s48, 30720
    buffer_load_dwordx4 v11, s[16:19], s52 offen lds
    s_add_u32 m0, s45, 84992
    s_add_u32 s52, s51, 30720
    buffer_load_dwordx4 v9, s[12:15], s52 offen lds
    s_add_u32 m0, s46, 84992
    s_add_u32 s52, s48, 46080
    buffer_load_dwordx4 v11, s[16:19], s52 offen lds
    s_add_u32 m0, s45, 86016
    s_add_u32 s52, s51, 40960
    buffer_load_dwordx4 v8, s[12:15], s52 offen lds
    s_branch K_Jbc0
K_CHM1:
K_STM1:
    s_branch K_STM5
K_STA1:
    s_branch K_STA5
K_Jbc0:
    s_add_u32 m0, s45, 87040
    s_add_u32 s52, s51, 51200
    buffer_load_dwordx4 v9, s[12:15], s52 offen lds
    s_lshl_b32 s47, s49, 7
    s_mul_i32 s48, s49, 245760
    s_add_u32 s51, s44, s47
    s_add_u32 s48, s48, s50
    s_add_u32 s49, s49, 1
    s_cmp_eq_u32 s49, 10
    s_cselect_b32 s49, 0, s49
    s_add_u32 m0, s46, 0
    s_add_u32 s52, s48, 0
    buffer_load_dwordx4 v10, s[16:19], s52 offen lds
    s_add_u32 m0, s45, 0
    s_max_i32 s52, s51, s47
    buffer_load_dwordx4 v8, s[12:15], s52 offen lds
    s_add_u32 m0, s46, 1024
    s_add_u32 s52, s48, 15360
    buffer_load_dwordx4 v10, s[16:19], s52 offen lds
    s_add_u32 m0, s45, 1024
    s_add_u32 s52, s51, 10240
    s_max_i32 s52, s52, s47
    buffer_load_dwordx4 v9, s[12:15], s52 offen lds
    s_add_u32 m0, s45, 2048
    s_add_u32 s52, s51, 20480
    buffer_load_dwordx4 v8, s[12:15], s52 offen lds
    s_waitcnt vmcnt(5)
    s_barrier
    s_add_u32 m0, s46, 2048
    s_add_u32 s52, s48, 30720
    buffer_load_dwordx4 v11, s[16:19], s52 offen lds
    s_add_u32 m0, s45, 3072
    s_add_u32 s52, s51, 30720
    buffer_load_dwordx4 v9, s[12:15], s52 offen lds
    s_add_u32 m0, s46, 3072
    s_add_u32 s52, s48, 46080
    buffer_load_dwordx4 v11, s[16:19], s52 offen lds
    s_add_u32 m0, s45, 4096
    s_add_u32 s52, s51, 40960
    buffer_load_dwordx4 v8, s[12:15], s52 offen lds
    s_add_u32 m0, s45, 5120
    s_add_u32 s52, s51, 51200
    buffer_load_dwordx4 v9, s[12:15], s52 offen lds
    s_lshl_b32 s47, s49, 7
    s_mul_i32 s48, s49, 245760
    s_add_u32 s51, s44, s47
    s_add_u32 s48, s48, s50
    s_add_u32 s49, s49, 1
    s_cmp_eq_u32 s49, 10
    s_cselect_b32 s49, 0, s49
    s_add_u32 m0, s46, 40960
    s_add_u32 s52, s48, 0
    buffer_load_dwordx4 v10, s[16:19], s52 offen lds
    s_add_u32 m0, s45, 40960
    s_max_i32 s52, s51, s47
    buffer_load_dwordx4 v8, s[12:15], s52 offen lds
    s_add_u32 m0, s46, 41984
    s_add_u32 s52, s48, 15360
    buffer_load_dwordx4 v10, s[16:19], s52 offen lds
    s_add_u32 m0, s45, 41984
    s_add_u32 s52, s51, 10240
    s_max_i32 s52, s52, s47
    buffer_load_dwordx4 v9, s[12:15], s52 offen lds
    s_add_u32 m0, s45, 43008
    s_add_u32 s52, s51, 20480
    buffer_load_dwordx4 v8, s[12:15], s52 offen lds
    s_waitcnt vmcnt(5)
    s_barrier
    s_add_u32 m0, s46, 43008
    s_add_u32 s52, s48, 30720
    buffer_load_dwordx4 v11, s[16:19], s52 offen lds
    s_add_u32 m0, s45, 44032
    s_add_u32 s52, s51, 30720
    buffer_load_dwordx4 v9, s[12:15], s52 offen lds
    s_add_u32 m0, s46, 44032
    s_add_u32 s52, s48, 46080
    buffer_load_dwordx4 v11, s[16:19], s52 offen lds
    s_add_u32 m0, s45, 45056
    s_add_u32 s52, s51, 40960
    buffer_load_dwordx4 v8, s[12:15], s52 offen lds
    s_add_u32 m0, s45, 46080
    s_add_u32 s52, s51, 51200
    buffer_load_dwordx4 v9, s[12:15], s52 offen lds
    s_lshl_b32 s47, s49, 7
    s_mul_i32 s48, s49, 245760
    s_add_u32 s51, s44, s47
    s_add_u32 s48, s48, s50
    s_add_u32 s49, s49, 1
    s_cmp_eq_u32 s49, 10
    s_cselect_b32 s49, 0, s49
    s_add_u32 m0, s46, 81920
    s_add_u32 s52, s48, 0
    buffer_load_dwordx4 v10, s[16:19], s52 offen lds
    s_add_u32 m0, s45, 81920
    s_max_i32 s52, s51, s47
    buffer_load_dwordx4 v8, s[12:15], s52 offen lds
    s_add_u32 m0, s46, 82944
    s_add_u32 s52, s48, 15360
    buffer_load_dwordx4 v10, s[16:19], s52 offen lds
    s_add_u32 m0, s45, 82944
    s_add_u32 s52, s51, 10240
    s_max_i32 s52, s52, s47
    buffer_load_dwordx4 v9, s[12:15], s52 offen lds
    s_add_u32 m0, s45, 83968
    s_add_u32 s52, s51, 20480
    buffer_load_dwordx4 v8, s[12:15], s52 offen lds
    s_mov_b32 s33, 81920
    s_cmp_eq_u32 s43, 3
    s_cselect_b32 s3, 0, 163840
    buffer_store_dwordx4 v[20:23], v16, s[20:23], 0 offen sc1
    buffer_store_dwordx4 v[20:23], v16, s[20:23], s33 offen sc1
    buffer_store_dwordx4 v[20:23], v16, s[20:23], s3 offen sc1
    buffer_store_dwordx4 v[20:23], v17, s[20:23], 0 offen sc1
    s_waitcnt vmcnt(9)
    s_barrier
    s_add_u32 m0, s46, 83968
    s_add_u32 s52, s48, 30720
    buffer_load_dwordx4 v11, s[16:19], s52 offen lds
    s_add_u32 m0, s45, 84992
    s_add_u32 s52, s51, 30720
    buffer_load_dwordx4 v9, s[12:15], s52 offen lds
    s_add_u32 m0, s46, 84992
    s_add_u32 s52, s48, 46080
    buffer_load_dwordx4 v11, s[16:19], s52 offen lds
    s_add_u32 m0, s45, 86016
    s_add_u32 s52, s51, 40960
    buffer_load_dwordx4 v8, s[12:15], s52 offen lds
    s_add_u32 m0, s45, 87040
    s_add_u32 s52, s51, 51200
    buffer_load_dwordx4 v9, s[12:15], s52 offen lds
    s_lshl_b32 s47, s49, 7
    s_mul_i32 s48, s49, 245760
    s_add_u32 s51, s44, s47
    s_add_u32 s48, s48, s50
    s_add_u32 s49, s49, 1
    s_cmp_eq_u32 s49, 10
    s_cselect_b32 s49, 0, s49
    s_add_u32 m0, s46, 0
    s_add_u32 s52, s48, 0
    buffer_load_dwordx4 v10, s[16:19], s52 offen lds
    s_add_u32 m0, s45, 0
    s_max_i32 s52, s51, s47
    s_branch K_Jf84
K_CHM2:
K_STM2:
    s_branch K_STM6
K_STA2:
    s_branch K_STA6
K_Jf84:
    buffer_load_dwordx4 v8, s[12:15], s52 offen lds
    s_add_u32 m0, s46, 1024
    s_add_u32 s52, s48, 15360
    buffer_load_dwordx4 v10, s[16:19], s52 offen lds
    s_add_u32 m0, s45, 1024
    s_add_u32 s52, s51, 10240
    s_max_i32 s52, s52, s47
    buffer_load_dwordx4 v9, s[12:15], s52 offen lds
    s_add_u32 m0, s45, 2048
    s_add_u32 s52, s51, 20480
    buffer_load_dwordx4 v8, s[12:15], s52 offen lds
    s_waitcnt vmcnt(5)
    s_barrier
    s_add_u32 m0, s46, 2048
    s_add_u32 s52, s48, 30720
    s_branch K_PG0
.p2align 12
K_CHM3:
K_STM3:
    s_branch K_STM7
K_STA3:
    s_branch K_STA7
K_PG0:
    buffer_load_dwordx4 v11, s[16:19], s52 offen lds
    s_add_u32 m0, s45, 3072
    s_add_u32 s52, s51, 30720
    buffer_load_dwordx4 v9, s[12:15], s52 offen lds
    s_add_u32 m0, s46, 3072
    s_add_u32 s52, s48, 46080
    buffer_load_dwordx4 v11, s[16:19], s52 offen lds
    s_add_u32 m0, s45, 4096
    s_add_u32 s52, s51, 40960
    buffer_load_dwordx4 v8, s[12:15], s52 offen lds
    s_add_u32 m0, s45, 5120
    s_add_u32 s52, s51, 51200
    buffer_load_dwordx4 v9, s[12:15], s52 offen lds
    s_lshl_b32 s47, s49, 7
    s_mul_i32 s48, s49, 245760
    s_add_u32 s51, s44, s47
    s_add_u32 s48, s48, s50
    s_add_u32 s49, s49, 1
    s_cmp_eq_u32 s49, 10
    s_cselect_b32 s49, 0, s49
    s_add_u32 m0, s46, 40960
    s_add_u32 s52, s48, 0
    buffer_load_dwordx4 v10, s[16:19], s52 offen lds
    s_add_u32 m0, s45, 40960
    s_max_i32 s52, s51, s47
    buffer_load_dwordx4 v8, s[12:15], s52 offen lds
    s_add_u32 m0, s46, 41984
    s_add_u32 s52, s48, 15360
    buffer_load_dwordx4 v10, s[16:19], s52 offen lds
    s_add_u32 m0, s45, 41984
    s_add_u32 s52, s51, 10240
    s_max_i32 s52, s52, s47
    buffer_load_dwordx4 v9, s[12:15], s52 offen lds
    s_add_u32 m0, s45, 43008
    s_add_u32 s52, s51, 20480
    buffer_load_dwordx4 v8, s[12:15], s52 offen lds
    s_waitcnt vmcnt(5)
    s_barrier
    s_add_u32 m0, s46, 43008
    s_add_u32 s52, s48, 30720
    buffer_load_dwordx4 v11, s[16:19], s52 offen lds
    s_add_u32 m0, s45, 44032
    s_add_u32 s52, s51, 30720
    buffer_load_dwordx4 v9, s[12:15], s52 offen lds
    s_add_u32 m0, s46, 44032
    s_add_u32 s52, s48, 46080
    buffer_load_dwordx4 v11, s[16:19], s52 offen lds
    s_add_u32 m0, s45, 45056
    s_add_u32 s52, s51, 40960
    buffer_load_dwordx4 v8, s[12:15], s52 offen lds
    s_add_u32 m0, s45, 46080
    s_add_u32 s52, s51, 51200
    buffer_load_dwordx4 v9, s[12:15], s52 offen lds
    s_lshl_b32 s47, s49, 7
    s_mul_i32 s48, s49, 245760
    s_add_u32 s51, s44, s47
    s_add_u32 s48, s48, s50
    s_add_u32 s49, s49, 1
    s_cmp_eq_u32 s49, 10
    s_cselect_b32 s49, 0, s49
    s_add_u32 m0, s46, 81920
    s_add_u32 s52, s48, 0
    buffer_load_dwordx4 v10, s[16:19], s52 offen lds
    s_add_u32 m0, s45, 81920
    s_max_i32 s52, s51, s47
    buffer_load_dwordx4 v8, s[12:15], s52 offen lds
    s_add_u32 m0, s46, 82944
    s_add_u32 s52, s48, 15360
    buffer_load_dwordx4 v10, s[16:19], s52 offen lds
    s_add_u32 m0, s45, 82944
    s_add_u32 s52, s51, 10240
    s_max_i32 s52, s52, s47
    buffer_load_dwordx4 v9, s[12:15], s52 offen lds
    s_add_u32 m0, s45, 83968
    s_add_u32 s52, s51, 20480
    buffer_load_dwordx4 v8, s[12:15], s52 offen lds
    s_waitcnt vmcnt(5)
    s_barrier
    s_load_dword s54, s[4:5], 192
    s_add_u32 m0, s46, 83968
    s_add_u32 s52, s48, 30720
    buffer_load_dwordx4 v11, s[16:19], s52 offen lds
    s_add_u32 m0, s45, 84992
    s_add_u32 s52, s51, 30720
    buffer_load_dwordx4 v9, s[12:15], s52 offen lds
    s_add_u32 m0, s46, 84992
    s_add_u32 s52, s48, 46080
    buffer_load_dwordx4 v11, s[16:19], s52 offen lds
    s_add_u32 m0, s45, 86016
    s_add_u32 s52, s51, 40960
    buffer_load_dwordx4 v8, s[12:15], s52 offen lds
    s_add_u32 m0, s45, 87040
    s_add_u32 s52, s51, 51200
    buffer_load_dwordx4 v9, s[12:15], s52 offen lds
    s_waitcnt lgkmcnt(0)
    s_cmp_ge_u32 s54, 8
    s_cbranch_scc1 K_ZO0
    s_load_dword s33, s[4:5], 128
    s_waitcnt lgkmcnt(0)
    s_cmp_ge_u32 s33, 8
    s_cbranch_scc1 K_ZO0
    s_sleep 8
    s_mov_b32 s3, 16384
K_ZB0:
    s_load_dword s33, s[4:5], 128 glc
    s_waitcnt lgkmcnt(0)
    s_cmp_ge_u32 s33, 8
    s_cbranch_scc1 K_ZO0
    s_sleep 32
    s_sub_u32 s3, s3, 1
    s_cbranch_scc0 K_ZB0
K_ZO0:
    s_cmp_eq_u32 s34, -1
    s_cbranch_scc1 K_NOLT
    s_lshl_b32 s47, s43, 2
    s_lshr_b32 s47, 0x7520, s47
    s_and_b32 s47, s47, 7
    s_mul_i32 s47, s47, 51200
    s_lshl_b32 s48, s43, 12
    s_add_u32 s3, s47, 0
    s_add_u32 m0, s48, 0
    s_nop 0
    buffer_load_dwordx4 v18, s[24:27], s3 offen lds
    s_add_u32 s3, s47, 10240
    s_add_u32 m0, s48, 1024
    s_nop 0
    buffer_load_dwordx4 v18, s[24:27], s3 offen lds
    s_add_u32 s3, s47, 25600
    s_add_u32 m0, s48, 2048
    s_nop 0
    buffer_load_dwordx4 v18, s[24:27], s3 offen lds
    s_add_u32 s3, s47, 35840
    s_add_u32 m0, s48, 3072
    s_nop 0
    buffer_load_dwordx4 v18, s[24:27], s3 offen lds
    s_add_u32 s3, s47, 409600
    s_add_u32 m0, s48, 20480
    s_nop 0
    buffer_load_dwordx4 v18, s[24:27], s3 offen lds
    s_add_u32 s3, s47, 419840
    s_add_u32 m0, s48, 21504
    s_nop 0
    buffer_load_dwordx4 v18, s[24:27], s3 offen lds
    s_add_u32 s3, s47, 435200
    s_add_u32 m0, s48, 22528
    s_nop 0
    buffer_load_dwordx4 v18, s[24:27], s3 offen lds
    s_branch K_J13cc
K_STM4:
    s_branch K_STM8
K_STA4:
    s_branch K_STA8
K_J13cc:
    s_add_u32 s3, s47, 445440
    s_add_u32 m0, s48, 23552
    s_nop 0
    buffer_load_dwordx4 v18, s[24:27], s3 offen lds
    s_lshl_b32 s48, s43, 10
    s_add_u32 s3, s47, 20480
    s_add_u32 m0, s48, 16384
    s_nop 0
    buffer_load_dwordx4 v5, s[24:27], s3 offen lds
    s_add_u32 s3, s47, 430080
    s_add_u32 m0, s48, 36864
    s_nop 0
    buffer_load_dwordx4 v5, s[24:27], s3 offen lds
    s_waitcnt vmcnt(10)
    s_barrier
    s_lshl_b32 s47, s43, 2
    s_lshr_b32 s47, 0x6431, s47
    s_and_b32 s47, s47, 7
    s_mul_i32 s47, s47, 51200
    s_lshl_b32 s48, s43, 12
    s_add_u32 s3, s47, 0
    s_add_u32 m0, s48, 40960
    s_nop 0
    buffer_load_dwordx4 v18, s[24:27], s3 offen lds
    s_add_u32 s3, s47, 10240
    s_add_u32 m0, s48, 41984
    s_nop 0
    buffer_load_dwordx4 v18, s[24:27], s3 offen lds
    s_add_u32 s3, s47, 25600
    s_add_u32 m0, s48, 43008
    s_nop 0
    buffer_load_dwordx4 v18, s[24:27], s3 offen lds
    s_add_u32 s3, s47, 35840
    s_add_u32 m0, s48, 44032
    s_nop 0
    buffer_load_dwordx4 v18, s[24:27], s3 offen lds
    s_add_u32 s3, s47, 409600
    s_add_u32 m0, s48, 61440
    s_nop 0
    buffer_load_dwordx4 v18, s[24:27], s3 offen lds
    s_add_u32 s3, s47, 419840
    s_add_u32 m0, s48, 62464
    s_nop 0
    buffer_load_dwordx4 v18, s[24:27], s3 offen lds
    s_add_u32 s3, s47, 435200
    s_add_u32 m0, s48, 63488
    s_nop 0
    buffer_load_dwordx4 v18, s[24:27], s3 offen lds
    s_add_u32 s3, s47, 445440
    s_add_u32 m0, s48, 64512
    s_nop 0
    buffer_load_dwordx4 v18, s[24:27], s3 offen lds
    s_lshl_b32 s48, s43, 10
    s_add_u32 s3, s47, 20480
    s_add_u32 m0, s48, 57344
    s_nop 0
    buffer_load_dwordx4 v5, s[24:27], s3 offen lds
    s_add_u32 s3, s47, 430080
    s_add_u32 m0, s48, 77824
    s_nop 0
    buffer_load_dwordx4 v5, s[24:27], s3 offen lds
    s_mov_b32 s30, s43
    s_branch K_P2_GM
K_NOLT:
    s_waitcnt vmcnt(0)
    s_barrier
    s_branch K_END
K_CONS:
    v_and_b32 v1, 63, v0
    v_mov_b32 v7, 0
    s_and_b32 s28, s2, 7
    s_lshr_b32 s29, s2, 3
    s_xor_b32 s30, s30, 4
    s_lshr_b32 s34, s29, 3
    s_lshl_b32 s34, s34, 2
    s_and_b32 s3, s29, 3
    s_add_u32 s34, s34, s3
    s_add_u32 s34, s34, 4
    s_bitcmp1_b32 s29, 2
    s_cselect_b32 s34, -1, s34
    s_cmp_lt_u32 s29, 8
    s_cselect_b32 s34, s29, s34
    s_lshl_b32 s40, s28, 1
    s_cmp_ge_u32 s34, 10
    s_addc_u32 s40, s40, 0
    s_sub_u32 s41, s34, 10
    s_cmp_ge_u32 s34, 10
    s_cselect_b32 s41, s41, s34
    s_mul_i32 s42, s28, 20
    s_add_u32 s42, s42, s34
    s_and_b32 s42, s42, 255
    s_lshl_b32 s42, s42, 9
    s_add_u32 s42, s42, 524288
    v_mov_b32 v3, 158736
    ds_write2_b32 v3, v7, v7 offset0:0 offset1:1
    ds_write2_b32 v3, v7, v7 offset0:2 offset1:3
    ds_write2_b32 v3, v7, v7 offset0:4 offset1:5
    ds_write2_b32 v3, v7, v7 offset0:6 offset1:7
    ds_write2_b32 v3, v7, v7 offset0:8 offset1:9
    s_lshr_b32 s31, s28, 1
    s_mul_i32 s31, s31, 3
    s_lshr_b32 s3, s29, 3
    s_add_u32 s31, s31, s3
    s_sub_u32 s31, s31, 1
    s_and_b32 s32, s28, 1
    s_lshl_b32 s32, s32, 3
    s_and_b32 s3, s29, 7
    s_lshl_b32 s3, s3, 2
    s_lshr_b32 s3, 0x64317520, s3
    s_and_b32 s3, s3, 7
    s_add_u32 s32, s32, s3
    s_and_b32 s35, s29, 3
    s_and_b32 s3, s29, 4
    s_lshl_b32 s3, s3, 1
    s_add_u32 s35, s35, s3
    s_and_b32 s3, s28, 1
    s_lshl_b32 s3, s3, 2
    s_add_u32 s35, s35, s3
    v_and_b32 v8, 15, v1
    v_lshrrev_b32 v9, 4, v1
    v_bfe_u32 v10, v1, 2, 2
    v_and_b32 v11, 3, v1
    s_lshr_b32 s54, s30, 1
    s_and_b32 s55, s30, 1
    v_lshrrev_b32 v2, 1, v8
    v_xor_b32 v2, v2, v9
    v_lshlrev_b32 v2, 4, v2
    v_lshl_add_u32 v2, v8, 7, v2
    s_mul_i32 s3, s54, 12288
    v_add_u32 v39, s3, v2
    v_xor_b32 v40, 64, v39
    v_add_u32 v41, 81920, v39
    v_add_u32 v42, 81920, v40
    v_and_b32 v2, 1, v9
    v_lshl_or_b32 v2, v2, 2, v10
    s_mul_i32 s3, s55, 40
    v_lshl_add_u32 v2, v2, 5, s3
    v_lshl_add_u32 v3, v9, 3, v10
    v_lshlrev_b32 v3, 8, v3
    v_add_u32 v3, 24576, v3
    v_lshl_add_u32 v5, v11, 3, v2
    s_mul_i32 s33, s55, 805306368
    s_sub_u32 s33, 0xf870c020, s33
    v_add_u32 v4, 0, v5
    v_and_b32 v4, 255, v4
    v_add_u32 v43, v4, v3
    v_add_u32 v47, 81920, v43
    v_add_u32 v4, 160, v5
    v_and_b32 v4, 255, v4
    v_add_u32 v44, v4, v3
    v_add_u32 v48, 81920, v44
    v_add_u32 v4, 80, v5
    v_and_b32 v4, 255, v4
    v_add_u32 v45, v4, v3
    v_add_u32 v49, 81920, v45
    v_lshlrev_b32 v4, 3, v11
    v_bfe_u32 v4, s33, v4, 8
    v_add_u32 v4, v4, v2
    v_and_b32 v4, 255, v4
    v_add_u32 v46, v4, v3
    v_add_u32 v50, 81920, v46
    s_or_b32 s56, s31, s54
    v_mov_b32 v37, 0xf149f2ca
    v_lshlrev_b32 v2, 2, v9
    v_sub_u32 v2, v8, v2
    s_cmp_eq_u32 s56, 0
    s_cselect_b32 s3, 0xf149f2ca, 0
    s_branch K_J1794
K_STM5:
    s_branch K_STM9
K_STA5:
    s_branch K_STA9
K_J1794:
    v_subrev_u32 v3, 0, v2
    v_and_b32 v4, 0x80000001, v3
    v_cmp_eq_u32 vcc, 0, v4
    s_nop 1
    v_cndmask_b32 v16, v37, 0, vcc
    v_cmp_eq_u32 vcc, 0x80000000, v4
    s_nop 1
    v_cndmask_b32 v12, v37, 0, vcc
    v_add_f32 v20, s3, v12
    v_subrev_u32 v3, 1, v2
    v_and_b32 v4, 0x80000001, v3
    v_cmp_eq_u32 vcc, 0, v4
    s_nop 1
    v_cndmask_b32 v17, v37, 0, vcc
    v_cmp_eq_u32 vcc, 0x80000000, v4
    s_nop 1
    v_cndmask_b32 v13, v37, 0, vcc
    v_add_f32 v21, s3, v13
    v_subrev_u32 v3, 2, v2
    v_and_b32 v4, 0x80000001, v3
    v_cmp_eq_u32 vcc, 0, v4
    s_nop 1
    v_cndmask_b32 v18, v37, 0, vcc
    v_cmp_eq_u32 vcc, 0x80000000, v4
    s_nop 1
    v_cndmask_b32 v14, v37, 0, vcc
    v_add_f32 v22, s3, v14
    v_subrev_u32 v3, 3, v2
    v_and_b32 v4, 0x80000001, v3
    v_cmp_eq_u32 vcc, 0, v4
    s_nop 1
    v_cndmask_b32 v19, v37, 0, vcc
    v_cmp_eq_u32 vcc, 0x80000000, v4
    s_nop 1
    v_cndmask_b32 v15, v37, 0, vcc
    v_add_f32 v23, s3, v15
    v_mov_b32 v3, 0x0c0c0c0c
    v_mov_b32 v4, 0xc0c0100
    v_cmp_eq_u32 vcc, 0, v12
    v_mov_b32 v5, 0x1000c0c
    s_nop 0
    v_cndmask_b32 v3, v3, v4, vcc
    v_cmp_eq_u32 vcc, 0, v13
    s_nop 1
    v_cndmask_b32 v24, v3, v5, vcc
    v_mov_b32 v3, 0x0c0c0c0c
    v_mov_b32 v4, 0xc0c0302
    v_cmp_eq_u32 vcc, 0, v14
    v_mov_b32 v5, 0x3020c0c
    s_nop 0
    v_cndmask_b32 v3, v3, v4, vcc
    v_cmp_eq_u32 vcc, 0, v15
    s_nop 1
    v_cndmask_b32 v25, v3, v5, vcc
    v_mov_b32 v3, 0x0c0c0c0c
    v_mov_b32 v4, 0xc0c0100
    v_cmp_eq_u32 vcc, 0, v16
    v_mov_b32 v5, 0x1000c0c
    s_nop 0
    v_cndmask_b32 v3, v3, v4, vcc
    v_cmp_eq_u32 vcc, 0, v17
    s_nop 1
    v_cndmask_b32 v26, v3, v5, vcc
    v_mov_b32 v3, 0x0c0c0c0c
    v_mov_b32 v4, 0xc0c0302
    v_cmp_eq_u32 vcc, 0, v18
    v_mov_b32 v5, 0x3020c0c
    s_nop 0
    v_cndmask_b32 v3, v3, v4, vcc
    v_cmp_eq_u32 vcc, 0, v19
    s_nop 1
    v_cndmask_b32 v27, v3, v5, vcc
    s_mul_i32 s3, s55, 1664
    s_mul_i32 s33, s54, 768
    s_add_u32 s3, s3, s33
    s_add_u32 s3, s3, 125952
    v_lshl_add_u32 v2, v9, 2, v10
    v_lshl_add_u32 v33, v2, 3, s3
    v_lshl_add_u32 v2, v8, 3, s3
    v_lshlrev_b32 v3, 3, v1
    v_add_u32 v3, 129280, v3
    v_cmp_eq_u32 vcc, 2, v9
    s_mul_i32 s3, s55, 1536
    s_add_u32 s3, s3, 122880
    v_cndmask_b32 v32, v3, v2, vcc
    v_lshl_add_u32 v34, v1, 3, s3
    s_mul_i32 s3, s54, 1536
    s_add_u32 s3, s3, 131328
    s_lshl3_add_u32 s33, s55, s3
    v_lshl_add_u32 v35, v8, 4, s33
    v_cmp_eq_u32 vcc, 0, v9
    s_nop 1
    v_cndmask_b32 v35, v3, v35, vcc
    s_mul_i32 s33, s55, 768
    s_add_u32 s3, s3, s33
    v_lshl_add_u32 v36, v1, 4, s3
    v_mov_b32 v38, 158720
    s_waitcnt lgkmcnt(0)
    s_add_u32 s20, s6, 0x100000
    s_addc_u32 s21, s7, 0
    s_mov_b32 s22, 0x280000
    s_mov_b32 s23, 0x20000
    s_lshr_b32 s53, s35, 2
    s_add_u32 s58, s53, s35
    s_lshl_b32 s58, s58, 12
    s_mul_i32 s59, s53, 19456
    s_lshl_b32 s53, s35, 8
    s_add_u32 s59, s59, s53
    s_add_u32 s59, s59, 16384
    s_mul_i32 s53, s31, 11
    s_mul_i32 s3, s54, 6
    s_add_u32 s53, s53, s3
    s_add_u32 s53, s53, 3
    s_lshl_b32 s3, s55, 9
    s_add_u32 s58, s58, s3
    v_and_b32 v4, 1, v9
    v_lshrrev_b32 v5, 1, v9
    v_add_u32 v3, s53, v4
    v_lshrrev_b32 v2, 2, v3
    v_mul_u32_u24 v2, 76, v2
    v_add_lshl_u32 v2, v2, v3, 10
    v_lshl_add_u32 v2, v8, 4, v2
    v_add_u32 v30, s58, v2
    v_lshl_add_u32 v30, v5, 8, v30
    v_subrev_u32 v3, 2, v3
    v_lshrrev_b32 v2, 2, v3
    v_mul_u32_u24 v2, 76, v2
    v_add_lshl_u32 v2, v2, v3, 10
    v_lshl_add_u32 v2, v8, 4, v2
    v_add_u32 v29, s58, v2
    v_lshl_add_u32 v29, v5, 8, v29
    v_or_b32 v4, s54, v4
    v_cmp_eq_u32 vcc, 0, v4
    v_mov_b32 v5, 0x10000000
    v_subrev_u32 v28, 81920, v30
    v_cndmask_b32 v28, v28, v5, vcc
    s_mul_i32 s3, s55, 3
    s_add_u32 s53, s53, s3
    v_add_u32 v3, s53, v9
    v_lshrrev_b32 v2, 2, v3
    v_mul_u32_u24 v2, 76, v2
    v_add_lshl_u32 v2, v2, v3, 10
    v_lshl_add_u32 v2, v8, 4, v2
    v_add_u32 v31, s59, v2
    v_subrev_u32 v31, 81920, v31
    v_or_b32 v4, s30, v9
    v_cmp_eq_u32 vcc, 0, v4
    s_nop 1
    v_cndmask_b32 v31, v31, v5, vcc
    v_cmp_eq_u32 vcc, 3, v9
    s_nop 1
    v_cndmask_b32 v31, v31, v5, vcc
    s_mul_i32 s3, s31, 11
    s_add_u32 s33, s3, 10
    s_lshr_b32 s3, s3, 3
    s_lshr_b32 s33, s33, 3
    s_min_u32 s33, s33, 15
    s_sub_u32 s33, s33, s3
    s_add_u32 s33, s33, 1
    s_mul_i32 s33, s33, 10
    s_bfm_b32 s37, s33, 0
    v_mul_u32_u24 v2, 205, v1
    v_lshrrev_b32 v2, 11, v2
    v_add_u32 v2, s3, v2
    v_mul_u32_u24 v2, 1496, v2
    v_lshrrev_b32 v2, 11, v2
    v_sub_u32 v2, s31, v2
    v_and_b32 v2, 1, v2
    v_lshlrev_b32 v2, 2, v2
    v_lshl_add_u32 v2, v1, 9, v2
    s_mul_i32 s3, s3, 5120
    s_branch K_J1b58
K_STM6:
    s_branch K_STM10
K_STA6:
    s_branch K_STA10
K_J1b58:
    s_add_u32 s3, s3, 524288
    v_add_u32 v37, s3, v2
    s_lshr_b32 s36, s35, 2
    s_add_u32 s36, s36, s35
    s_lshl_b32 s36, 1, s36
    s_cmp_eq_u32 s30, 0
    s_cselect_b32 s36, s36, 0
    s_mov_b32 s58, 0x3fb8aa3b
    s_mov_b32 s59, s58
    s_mov_b32 s60, 0x3e64f92e
    s_mov_b32 s61, s60
    s_cmp_eq_u32 s30, 0
    s_cbranch_scc1 K_CHM0
    s_cmp_eq_u32 s30, 1
    s_cbranch_scc1 K_CHM1
    s_cmp_eq_u32 s30, 2
    s_cbranch_scc1 K_CHM2
    s_branch K_CHM3
K_WRET_M:
    s_setprio 2
    s_barrier
K_L0:
    ds_read_b64_tr_b16 v[196:197], v47 offset:0
    ds_read_b64_tr_b16 v[198:199], v47 offset:1024
    ds_read_b128 v[148:151], v41 offset:0
    ds_read_b64_tr_b16 v[200:201], v48 offset:0
    ds_read_b64_tr_b16 v[202:203], v48 offset:1024
    ds_read_b128 v[152:155], v41 offset:2048
    ds_read_b64_tr_b16 v[204:205], v49 offset:0
    ds_read_b64_tr_b16 v[206:207], v49 offset:1024
    ds_read_b128 v[156:159], v41 offset:4096
    ds_read_b64_tr_b16 v[208:209], v50 offset:0
    ds_read_b64_tr_b16 v[210:211], v50 offset:1024
    ds_read_b128 v[160:163], v41 offset:6144
    ds_read_b128 v[164:167], v41 offset:8192
    ds_read_b128 v[168:171], v41 offset:10240
    s_waitcnt lgkmcnt(0)
    v_mfma_f32_16x16x32_bf16 v[52:55], v[196:199], v[148:151], 0
    ds_read_b64_tr_b16 v[212:213], v47 offset:8192
    v_mfma_f32_16x16x32_bf16 v[56:59], v[200:203], v[148:151], 0
    ds_read_b64_tr_b16 v[214:215], v47 offset:9216
    v_mfma_f32_16x16x32_bf16 v[60:63], v[148:151], v[204:207], 0
    ds_read_b128 v[172:175], v42 offset:0
    v_mfma_f32_16x16x32_bf16 v[64:67], v[208:211], v[148:151], 0
    ds_read_b64_tr_b16 v[216:217], v48 offset:8192
    v_mfma_f32_16x16x32_bf16 v[80:83], v[208:211], v[152:155], 0
    ds_read_b64_tr_b16 v[218:219], v48 offset:9216
    v_mfma_f32_16x16x32_bf16 v[76:79], v[152:155], v[204:207], 0
    ds_read_b128 v[176:179], v42 offset:2048
    v_mfma_f32_16x16x32_bf16 v[72:75], v[200:203], v[152:155], 0
    ds_read_b64_tr_b16 v[220:221], v49 offset:8192
    v_mfma_f32_16x16x32_bf16 v[68:71], v[196:199], v[152:155], 0
    ds_read_b64_tr_b16 v[222:223], v49 offset:9216
    v_mfma_f32_16x16x32_bf16 v[84:87], v[196:199], v[156:159], 0
    ds_read_b128 v[180:183], v42 offset:4096
    v_mfma_f32_16x16x32_bf16 v[88:91], v[200:203], v[156:159], 0
    ds_read_b64_tr_b16 v[224:225], v50 offset:8192
    v_mfma_f32_16x16x32_bf16 v[92:95], v[156:159], v[204:207], 0
    ds_read_b64_tr_b16 v[226:227], v50 offset:9216
    v_mfma_f32_16x16x32_bf16 v[96:99], v[208:211], v[156:159], 0
    ds_read_b128 v[184:187], v42 offset:6144
    v_mfma_f32_16x16x32_bf16 v[112:115], v[208:211], v[160:163], 0
    ds_read_b128 v[188:191], v42 offset:8192
    v_mfma_f32_16x16x32_bf16 v[108:111], v[160:163], v[204:207], 0
    ds_read_b128 v[192:195], v42 offset:10240
    v_mfma_f32_16x16x32_bf16 v[104:107], v[200:203], v[160:163], 0
    v_mfma_f32_16x16x32_bf16 v[100:103], v[196:199], v[160:163], 0
    v_mfma_f32_16x16x32_bf16 v[116:119], v[196:199], v[164:167], 0
    v_mfma_f32_16x16x32_bf16 v[120:123], v[200:203], v[164:167], 0
    v_mfma_f32_16x16x32_bf16 v[124:127], v[164:167], v[204:207], 0
    v_mfma_f32_16x16x32_bf16 v[128:131], v[208:211], v[164:167], 0
    v_mfma_f32_16x16x32_bf16 v[144:147], v[208:211], v[168:171], 0
    v_mfma_f32_16x16x32_bf16 v[140:143], v[168:171], v[204:207], 0
    v_mfma_f32_16x16x32_bf16 v[136:139], v[200:203], v[168:171], 0
    v_mfma_f32_16x16x32_bf16 v[132:135], v[196:199], v[168:171], 0
    s_waitcnt lgkmcnt(0)
    s_barrier
    v_mfma_f32_16x16x32_bf16 v[52:55], v[212:215], v[172:175], v[52:55]
    ds_read_b64_tr_b16 v[196:197], v43 offset:0
    v_mfma_f32_16x16x32_bf16 v[56:59], v[216:219], v[172:175], v[56:59]
    ds_read_b64_tr_b16 v[198:199], v43 offset:1024
    v_mfma_f32_16x16x32_bf16 v[60:63], v[172:175], v[220:223], v[60:63]
    ds_read_b128 v[148:151], v39 offset:0
    v_mfma_f32_16x16x32_bf16 v[64:67], v[224:227], v[172:175], v[64:67]
    ds_read_b64_tr_b16 v[200:201], v44 offset:0
    v_mfma_f32_16x16x32_bf16 v[80:83], v[224:227], v[176:179], v[80:83]
    ds_read_b64_tr_b16 v[202:203], v44 offset:1024
    v_mfma_f32_16x16x32_bf16 v[76:79], v[176:179], v[220:223], v[76:79]
    ds_read_b128 v[152:155], v39 offset:2048
    v_mfma_f32_16x16x32_bf16 v[72:75], v[216:219], v[176:179], v[72:75]
    ds_read_b64_tr_b16 v[204:205], v45 offset:0
    v_mfma_f32_16x16x32_bf16 v[68:71], v[212:215], v[176:179], v[68:71]
    ds_read_b64_tr_b16 v[206:207], v45 offset:1024
    v_mfma_f32_16x16x32_bf16 v[84:87], v[212:215], v[180:183], v[84:87]
    ds_read_b128 v[156:159], v39 offset:4096
    v_mfma_f32_16x16x32_bf16 v[88:91], v[216:219], v[180:183], v[88:91]
    ds_read_b64_tr_b16 v[208:209], v46 offset:0
    v_mfma_f32_16x16x32_bf16 v[92:95], v[180:183], v[220:223], v[92:95]
    ds_read_b64_tr_b16 v[210:211], v46 offset:1024
    v_mfma_f32_16x16x32_bf16 v[96:99], v[224:227], v[180:183], v[96:99]
    ds_read_b128 v[160:163], v39 offset:6144
    v_mfma_f32_16x16x32_bf16 v[112:115], v[224:227], v[184:187], v[112:115]
    ds_read_b128 v[164:167], v39 offset:8192
    v_mfma_f32_16x16x32_bf16 v[108:111], v[184:187], v[220:223], v[108:111]
    ds_read_b128 v[168:171], v39 offset:10240
    v_mfma_f32_16x16x32_bf16 v[104:107], v[216:219], v[184:187], v[104:107]
    v_mfma_f32_16x16x32_bf16 v[100:103], v[212:215], v[184:187], v[100:103]
    v_mfma_f32_16x16x32_bf16 v[116:119], v[212:215], v[188:191], v[116:119]
    v_mfma_f32_16x16x32_bf16 v[120:123], v[216:219], v[188:191], v[120:123]
    v_mfma_f32_16x16x32_bf16 v[124:127], v[188:191], v[220:223], v[124:127]
    v_mfma_f32_16x16x32_bf16 v[128:131], v[224:227], v[188:191], v[128:131]
    v_mfma_f32_16x16x32_bf16 v[144:147], v[224:227], v[192:195], v[144:147]
    v_mfma_f32_16x16x32_bf16 v[140:143], v[192:195], v[220:223], v[140:143]
    v_mfma_f32_16x16x32_bf16 v[136:139], v[216:219], v[192:195], v[136:139]
    v_mfma_f32_16x16x32_bf16 v[132:135], v[212:215], v[192:195], v[132:135]
    s_waitcnt lgkmcnt(0)
    v_mfma_f32_16x16x32_bf16 v[52:55], v[196:199], v[148:151], v[52:55]
    ds_read_b64_tr_b16 v[212:213], v43 offset:8192
    v_mfma_f32_16x16x32_bf16 v[56:59], v[200:203], v[148:151], v[56:59]
    ds_read_b64_tr_b16 v[214:215], v43 offset:9216
    v_mfma_f32_16x16x32_bf16 v[60:63], v[148:151], v[204:207], v[60:63]
    ds_read_b128 v[172:175], v40 offset:0
    v_mfma_f32_16x16x32_bf16 v[64:67], v[208:211], v[148:151], v[64:67]
    ds_read_b64_tr_b16 v[216:217], v44 offset:8192
    v_mfma_f32_16x16x32_bf16 v[80:83], v[208:211], v[152:155], v[80:83]
    ds_read_b64_tr_b16 v[218:219], v44 offset:9216
    v_mfma_f32_16x16x32_bf16 v[76:79], v[152:155], v[204:207], v[76:79]
    ds_read_b128 v[176:179], v40 offset:2048
    v_mfma_f32_16x16x32_bf16 v[72:75], v[200:203], v[152:155], v[72:75]
    ds_read_b64_tr_b16 v[220:221], v45 offset:8192
    v_mfma_f32_16x16x32_bf16 v[68:71], v[196:199], v[152:155], v[68:71]
    ds_read_b64_tr_b16 v[222:223], v45 offset:9216
    s_branch K_J1f20
K_STM7:
    s_branch K_STM11
K_STA7:
    s_branch K_STA11
K_J1f20:
    v_mfma_f32_16x16x32_bf16 v[84:87], v[196:199], v[156:159], v[84:87]
    ds_read_b128 v[180:183], v40 offset:4096
    v_mfma_f32_16x16x32_bf16 v[88:91], v[200:203], v[156:159], v[88:91]
    ds_read_b64_tr_b16 v[224:225], v46 offset:8192
    v_mfma_f32_16x16x32_bf16 v[92:95], v[156:159], v[204:207], v[92:95]
    ds_read_b64_tr_b16 v[226:227], v46 offset:9216
    v_mfma_f32_16x16x32_bf16 v[96:99], v[208:211], v[156:159], v[96:99]
    ds_read_b128 v[184:187], v40 offset:6144
    v_mfma_f32_16x16x32_bf16 v[112:115], v[208:211], v[160:163], v[112:115]
    ds_read_b128 v[188:191], v40 offset:8192
    v_mfma_f32_16x16x32_bf16 v[108:111], v[160:163], v[204:207], v[108:111]
    ds_read_b128 v[192:195], v40 offset:10240
    v_mfma_f32_16x16x32_bf16 v[104:107], v[200:203], v[160:163], v[104:107]
    v_mfma_f32_16x16x32_bf16 v[100:103], v[196:199], v[160:163], v[100:103]
    v_mfma_f32_16x16x32_bf16 v[116:119], v[196:199], v[164:167], v[116:119]
    v_mfma_f32_16x16x32_bf16 v[120:123], v[200:203], v[164:167], v[120:123]
    v_mfma_f32_16x16x32_bf16 v[124:127], v[164:167], v[204:207], v[124:127]
    v_mfma_f32_16x16x32_bf16 v[128:131], v[208:211], v[164:167], v[128:131]
    v_mfma_f32_16x16x32_bf16 v[144:147], v[208:211], v[168:171], v[144:147]
    v_mfma_f32_16x16x32_bf16 v[140:143], v[168:171], v[204:207], v[140:143]
    v_mfma_f32_16x16x32_bf16 v[136:139], v[200:203], v[168:171], v[136:139]
    v_mfma_f32_16x16x32_bf16 v[132:135], v[196:199], v[168:171], v[132:135]
    s_waitcnt lgkmcnt(0)
    s_barrier
    v_mfma_f32_16x16x32_bf16 v[52:55], v[212:215], v[172:175], v[52:55]
    ds_read_b64_tr_b16 v[196:197], v43 offset:40960
    v_mfma_f32_16x16x32_bf16 v[56:59], v[216:219], v[172:175], v[56:59]
    s_branch K_PG1
.p2align 12
K_STM8:
    s_branch K_STM12
K_STA8:
    s_branch K_STA12
K_PG1:
    ds_read_b64_tr_b16 v[198:199], v43 offset:41984
    v_mfma_f32_16x16x32_bf16 v[60:63], v[172:175], v[220:223], v[60:63]
    ds_read_b128 v[148:151], v39 offset:40960
    v_mfma_f32_16x16x32_bf16 v[64:67], v[224:227], v[172:175], v[64:67]
    ds_read_b64_tr_b16 v[200:201], v44 offset:40960
    v_mfma_f32_16x16x32_bf16 v[80:83], v[224:227], v[176:179], v[80:83]
    ds_read_b64_tr_b16 v[202:203], v44 offset:41984
    v_mfma_f32_16x16x32_bf16 v[76:79], v[176:179], v[220:223], v[76:79]
    ds_read_b128 v[152:155], v39 offset:43008
    v_mfma_f32_16x16x32_bf16 v[72:75], v[216:219], v[176:179], v[72:75]
    ds_read_b64_tr_b16 v[204:205], v45 offset:40960
    v_mfma_f32_16x16x32_bf16 v[68:71], v[212:215], v[176:179], v[68:71]
    ds_read_b64_tr_b16 v[206:207], v45 offset:41984
    v_mfma_f32_16x16x32_bf16 v[84:87], v[212:215], v[180:183], v[84:87]
    ds_read_b128 v[156:159], v39 offset:45056
    v_mfma_f32_16x16x32_bf16 v[88:91], v[216:219], v[180:183], v[88:91]
    ds_read_b64_tr_b16 v[208:209], v46 offset:40960
    v_mfma_f32_16x16x32_bf16 v[92:95], v[180:183], v[220:223], v[92:95]
    ds_read_b64_tr_b16 v[210:211], v46 offset:41984
    v_mfma_f32_16x16x32_bf16 v[96:99], v[224:227], v[180:183], v[96:99]
    ds_read_b128 v[160:163], v39 offset:47104
    v_mfma_f32_16x16x32_bf16 v[112:115], v[224:227], v[184:187], v[112:115]
    ds_read_b128 v[164:167], v39 offset:49152
    v_mfma_f32_16x16x32_bf16 v[108:111], v[184:187], v[220:223], v[108:111]
    ds_read_b128 v[168:171], v39 offset:51200
    v_mfma_f32_16x16x32_bf16 v[104:107], v[216:219], v[184:187], v[104:107]
    v_mfma_f32_16x16x32_bf16 v[100:103], v[212:215], v[184:187], v[100:103]
    v_mfma_f32_16x16x32_bf16 v[116:119], v[212:215], v[188:191], v[116:119]
    v_mfma_f32_16x16x32_bf16 v[120:123], v[216:219], v[188:191], v[120:123]
    v_mfma_f32_16x16x32_bf16 v[124:127], v[188:191], v[220:223], v[124:127]
    v_mfma_f32_16x16x32_bf16 v[128:131], v[224:227], v[188:191], v[128:131]
    v_mfma_f32_16x16x32_bf16 v[144:147], v[224:227], v[192:195], v[144:147]
    v_mfma_f32_16x16x32_bf16 v[140:143], v[192:195], v[220:223], v[140:143]
    v_mfma_f32_16x16x32_bf16 v[136:139], v[216:219], v[192:195], v[136:139]
    v_mfma_f32_16x16x32_bf16 v[132:135], v[212:215], v[192:195], v[132:135]
    s_waitcnt lgkmcnt(0)
    v_mfma_f32_16x16x32_bf16 v[52:55], v[196:199], v[148:151], v[52:55]
    ds_read_b64_tr_b16 v[212:213], v43 offset:49152
    v_mfma_f32_16x16x32_bf16 v[56:59], v[200:203], v[148:151], v[56:59]
    ds_read_b64_tr_b16 v[214:215], v43 offset:50176
    v_mfma_f32_16x16x32_bf16 v[60:63], v[148:151], v[204:207], v[60:63]
    ds_read_b128 v[172:175], v40 offset:40960
    v_mfma_f32_16x16x32_bf16 v[64:67], v[208:211], v[148:151], v[64:67]
    ds_read_b64_tr_b16 v[216:217], v44 offset:49152
    v_mfma_f32_16x16x32_bf16 v[80:83], v[208:211], v[152:155], v[80:83]
    ds_read_b64_tr_b16 v[218:219], v44 offset:50176
    v_mfma_f32_16x16x32_bf16 v[76:79], v[152:155], v[204:207], v[76:79]
    ds_read_b128 v[176:179], v40 offset:43008
    v_mfma_f32_16x16x32_bf16 v[72:75], v[200:203], v[152:155], v[72:75]
    ds_read_b64_tr_b16 v[220:221], v45 offset:49152
    v_mfma_f32_16x16x32_bf16 v[68:71], v[196:199], v[152:155], v[68:71]
    ds_read_b64_tr_b16 v[222:223], v45 offset:50176
    v_mfma_f32_16x16x32_bf16 v[84:87], v[196:199], v[156:159], v[84:87]
    ds_read_b128 v[180:183], v40 offset:45056
    v_mfma_f32_16x16x32_bf16 v[88:91], v[200:203], v[156:159], v[88:91]
    ds_read_b64_tr_b16 v[224:225], v46 offset:49152
    v_mfma_f32_16x16x32_bf16 v[92:95], v[156:159], v[204:207], v[92:95]
    ds_read_b64_tr_b16 v[226:227], v46 offset:50176
    v_mfma_f32_16x16x32_bf16 v[96:99], v[208:211], v[156:159], v[96:99]
    ds_read_b128 v[184:187], v40 offset:47104
    v_mfma_f32_16x16x32_bf16 v[112:115], v[208:211], v[160:163], v[112:115]
    ds_read_b128 v[188:191], v40 offset:49152
    v_mfma_f32_16x16x32_bf16 v[108:111], v[160:163], v[204:207], v[108:111]
    ds_read_b128 v[192:195], v40 offset:51200
    v_mfma_f32_16x16x32_bf16 v[104:107], v[200:203], v[160:163], v[104:107]
    v_mfma_f32_16x16x32_bf16 v[100:103], v[196:199], v[160:163], v[100:103]
    v_mfma_f32_16x16x32_bf16 v[116:119], v[196:199], v[164:167], v[116:119]
    v_mfma_f32_16x16x32_bf16 v[120:123], v[200:203], v[164:167], v[120:123]
    v_mfma_f32_16x16x32_bf16 v[124:127], v[164:167], v[204:207], v[124:127]
    v_mfma_f32_16x16x32_bf16 v[128:131], v[208:211], v[164:167], v[128:131]
    v_mfma_f32_16x16x32_bf16 v[144:147], v[208:211], v[168:171], v[144:147]
    v_mfma_f32_16x16x32_bf16 v[140:143], v[168:171], v[204:207], v[140:143]
    v_mfma_f32_16x16x32_bf16 v[136:139], v[200:203], v[168:171], v[136:139]
    v_mfma_f32_16x16x32_bf16 v[132:135], v[196:199], v[168:171], v[132:135]
    s_waitcnt lgkmcnt(0)
    s_barrier
    v_mfma_f32_16x16x32_bf16 v[52:55], v[212:215], v[172:175], v[52:55]
    ds_read_b64_tr_b16 v[196:197], v47 offset:0
    v_mfma_f32_16x16x32_bf16 v[56:59], v[216:219], v[172:175], v[56:59]
    ds_read_b64_tr_b16 v[198:199], v47 offset:1024
    v_mfma_f32_16x16x32_bf16 v[60:63], v[172:175], v[220:223], v[60:63]
    ds_read_b128 v[148:151], v41 offset:0
    v_mfma_f32_16x16x32_bf16 v[64:67], v[224:227], v[172:175], v[64:67]
    ds_read_b64_tr_b16 v[200:201], v48 offset:0
    v_mfma_f32_16x16x32_bf16 v[80:83], v[224:227], v[176:179], v[80:83]
    ds_read_b64_tr_b16 v[202:203], v48 offset:1024
    v_mfma_f32_16x16x32_bf16 v[76:79], v[176:179], v[220:223], v[76:79]
    ds_read_b128 v[152:155], v41 offset:2048
    v_mfma_f32_16x16x32_bf16 v[72:75], v[216:219], v[176:179], v[72:75]
    ds_read_b64_tr_b16 v[204:205], v49 offset:0
    v_mfma_f32_16x16x32_bf16 v[68:71], v[212:215], v[176:179], v[68:71]
    ds_read_b64_tr_b16 v[206:207], v49 offset:1024
    v_mfma_f32_16x16x32_bf16 v[84:87], v[212:215], v[180:183], v[84:87]
    ds_read_b128 v[156:159], v41 offset:4096
    v_mfma_f32_16x16x32_bf16 v[88:91], v[216:219], v[180:183], v[88:91]
    ds_read_b64_tr_b16 v[208:209], v50 offset:0
    v_mfma_f32_16x16x32_bf16 v[92:95], v[180:183], v[220:223], v[92:95]
    ds_read_b64_tr_b16 v[210:211], v50 offset:1024
    v_mfma_f32_16x16x32_bf16 v[96:99], v[224:227], v[180:183], v[96:99]
    ds_read_b128 v[160:163], v41 offset:6144
    v_mfma_f32_16x16x32_bf16 v[112:115], v[224:227], v[184:187], v[112:115]
    ds_read_b128 v[164:167], v41 offset:8192
    v_mfma_f32_16x16x32_bf16 v[108:111], v[184:187], v[220:223], v[108:111]
    ds_read_b128 v[168:171], v41 offset:10240
    v_mfma_f32_16x16x32_bf16 v[104:107], v[216:219], v[184:187], v[104:107]
    v_mfma_f32_16x16x32_bf16 v[100:103], v[212:215], v[184:187], v[100:103]
    v_mfma_f32_16x16x32_bf16 v[116:119], v[212:215], v[188:191], v[116:119]
    v_mfma_f32_16x16x32_bf16 v[120:123], v[216:219], v[188:191], v[120:123]
    v_mfma_f32_16x16x32_bf16 v[124:127], v[188:191], v[220:223], v[124:127]
    v_mfma_f32_16x16x32_bf16 v[128:131], v[224:227], v[188:191], v[128:131]
    v_mfma_f32_16x16x32_bf16 v[144:147], v[224:227], v[192:195], v[144:147]
    v_mfma_f32_16x16x32_bf16 v[140:143], v[192:195], v[220:223], v[140:143]
    v_mfma_f32_16x16x32_bf16 v[136:139], v[216:219], v[192:195], v[136:139]
    v_mfma_f32_16x16x32_bf16 v[132:135], v[212:215], v[192:195], v[132:135]
    s_waitcnt lgkmcnt(0)
    v_mfma_f32_16x16x32_bf16 v[52:55], v[196:199], v[148:151], v[52:55]
    ds_read_b64_tr_b16 v[212:213], v47 offset:8192
    v_mfma_f32_16x16x32_bf16 v[56:59], v[200:203], v[148:151], v[56:59]
    ds_read_b64_tr_b16 v[214:215], v47 offset:9216
    v_mfma_f32_16x16x32_bf16 v[60:63], v[148:151], v[204:207], v[60:63]
    ds_read_b128 v[172:175], v42 offset:0
    v_mfma_f32_16x16x32_bf16 v[64:67], v[208:211], v[148:151], v[64:67]
    s_branch K_J23c8
K_STM9:
    s_branch K_STM13
K_STA9:
    s_branch K_STA13
K_J23c8:
    ds_read_b64_tr_b16 v[216:217], v48 offset:8192
    v_mfma_f32_16x16x32_bf16 v[80:83], v[208:211], v[152:155], v[80:83]
    ds_read_b64_tr_b16 v[218:219], v48 offset:9216
    v_mfma_f32_16x16x32_bf16 v[76:79], v[152:155], v[204:207], v[76:79]
    ds_read_b128 v[176:179], v42 offset:2048
    v_mfma_f32_16x16x32_bf16 v[72:75], v[200:203], v[152:155], v[72:75]
    ds_read_b64_tr_b16 v[220:221], v49 offset:8192
    v_mfma_f32_16x16x32_bf16 v[68:71], v[196:199], v[152:155], v[68:71]
    ds_read_b64_tr_b16 v[222:223], v49 offset:9216
    v_mfma_f32_16x16x32_bf16 v[84:87], v[196:199], v[156:159], v[84:87]
    ds_read_b128 v[180:183], v42 offset:4096
    v_mfma_f32_16x16x32_bf16 v[88:91], v[200:203], v[156:159], v[88:91]
    ds_read_b64_tr_b16 v[224:225], v50 offset:8192
    v_mfma_f32_16x16x32_bf16 v[92:95], v[156:159], v[204:207], v[92:95]
    ds_read_b64_tr_b16 v[226:227], v50 offset:9216
    v_mfma_f32_16x16x32_bf16 v[96:99], v[208:211], v[156:159], v[96:99]
    ds_read_b128 v[184:187], v42 offset:6144
    v_mfma_f32_16x16x32_bf16 v[112:115], v[208:211], v[160:163], v[112:115]
    ds_read_b128 v[188:191], v42 offset:8192
    v_mfma_f32_16x16x32_bf16 v[108:111], v[160:163], v[204:207], v[108:111]
    ds_read_b128 v[192:195], v42 offset:10240
    v_mfma_f32_16x16x32_bf16 v[104:107], v[200:203], v[160:163], v[104:107]
    v_mfma_f32_16x16x32_bf16 v[100:103], v[196:199], v[160:163], v[100:103]
    v_mfma_f32_16x16x32_bf16 v[116:119], v[196:199], v[164:167], v[116:119]
    v_mfma_f32_16x16x32_bf16 v[120:123], v[200:203], v[164:167], v[120:123]
    v_mfma_f32_16x16x32_bf16 v[124:127], v[164:167], v[204:207], v[124:127]
    v_mfma_f32_16x16x32_bf16 v[128:131], v[208:211], v[164:167], v[128:131]
    v_mfma_f32_16x16x32_bf16 v[144:147], v[208:211], v[168:171], v[144:147]
    v_mfma_f32_16x16x32_bf16 v[140:143], v[168:171], v[204:207], v[140:143]
    v_mfma_f32_16x16x32_bf16 v[136:139], v[200:203], v[168:171], v[136:139]
    v_mfma_f32_16x16x32_bf16 v[132:135], v[196:199], v[168:171], v[132:135]
    s_waitcnt lgkmcnt(0)
    s_barrier
    v_mfma_f32_16x16x32_bf16 v[52:55], v[212:215], v[172:175], v[52:55]
    ds_read_b64_tr_b16 v[196:197], v43 offset:0
    v_mfma_f32_16x16x32_bf16 v[56:59], v[216:219], v[172:175], v[56:59]
    ds_read_b64_tr_b16 v[198:199], v43 offset:1024
    v_mfma_f32_16x16x32_bf16 v[60:63], v[172:175], v[220:223], v[60:63]
    ds_read_b128 v[148:151], v39 offset:0
    v_mfma_f32_16x16x32_bf16 v[64:67], v[224:227], v[172:175], v[64:67]
    ds_read_b64_tr_b16 v[200:201], v44 offset:0
    v_mfma_f32_16x16x32_bf16 v[80:83], v[224:227], v[176:179], v[80:83]
    ds_read_b64_tr_b16 v[202:203], v44 offset:1024
    v_mfma_f32_16x16x32_bf16 v[76:79], v[176:179], v[220:223], v[76:79]
    ds_read_b128 v[152:155], v39 offset:2048
    v_mfma_f32_16x16x32_bf16 v[72:75], v[216:219], v[176:179], v[72:75]
    ds_read_b64_tr_b16 v[204:205], v45 offset:0
    v_mfma_f32_16x16x32_bf16 v[68:71], v[212:215], v[176:179], v[68:71]
    ds_read_b64_tr_b16 v[206:207], v45 offset:1024
    v_mfma_f32_16x16x32_bf16 v[84:87], v[212:215], v[180:183], v[84:87]
    ds_read_b128 v[156:159], v39 offset:4096
    v_mfma_f32_16x16x32_bf16 v[88:91], v[216:219], v[180:183], v[88:91]
    ds_read_b64_tr_b16 v[208:209], v46 offset:0
    v_mfma_f32_16x16x32_bf16 v[92:95], v[180:183], v[220:223], v[92:95]
    ds_read_b64_tr_b16 v[210:211], v46 offset:1024
    v_mfma_f32_16x16x32_bf16 v[96:99], v[224:227], v[180:183], v[96:99]
    ds_read_b128 v[160:163], v39 offset:6144
    v_mfma_f32_16x16x32_bf16 v[112:115], v[224:227], v[184:187], v[112:115]
    ds_read_b128 v[164:167], v39 offset:8192
    v_mfma_f32_16x16x32_bf16 v[108:111], v[184:187], v[220:223], v[108:111]
    ds_read_b128 v[168:171], v39 offset:10240
    v_mfma_f32_16x16x32_bf16 v[104:107], v[216:219], v[184:187], v[104:107]
    v_mfma_f32_16x16x32_bf16 v[100:103], v[212:215], v[184:187], v[100:103]
    v_mfma_f32_16x16x32_bf16 v[116:119], v[212:215], v[188:191], v[116:119]
    v_mfma_f32_16x16x32_bf16 v[120:123], v[216:219], v[188:191], v[120:123]
    v_mfma_f32_16x16x32_bf16 v[124:127], v[188:191], v[220:223], v[124:127]
    v_mfma_f32_16x16x32_bf16 v[128:131], v[224:227], v[188:191], v[128:131]
    v_mfma_f32_16x16x32_bf16 v[144:147], v[224:227], v[192:195], v[144:147]
    v_mfma_f32_16x16x32_bf16 v[140:143], v[192:195], v[220:223], v[140:143]
    v_mfma_f32_16x16x32_bf16 v[136:139], v[216:219], v[192:195], v[136:139]
    v_mfma_f32_16x16x32_bf16 v[132:135], v[212:215], v[192:195], v[132:135]
    s_waitcnt lgkmcnt(0)
    v_mfma_f32_16x16x32_bf16 v[52:55], v[196:199], v[148:151], v[52:55]
    ds_read_b64_tr_b16 v[212:213], v43 offset:8192
    v_mfma_f32_16x16x32_bf16 v[56:59], v[200:203], v[148:151], v[56:59]
    ds_read_b64_tr_b16 v[214:215], v43 offset:9216
    v_mfma_f32_16x16x32_bf16 v[60:63], v[148:151], v[204:207], v[60:63]
    ds_read_b128 v[172:175], v40 offset:0
    v_mfma_f32_16x16x32_bf16 v[64:67], v[208:211], v[148:151], v[64:67]
    ds_read_b64_tr_b16 v[216:217], v44 offset:8192
    v_mfma_f32_16x16x32_bf16 v[80:83], v[208:211], v[152:155], v[80:83]
    ds_read_b64_tr_b16 v[218:219], v44 offset:9216
    v_mfma_f32_16x16x32_bf16 v[76:79], v[152:155], v[204:207], v[76:79]
    ds_read_b128 v[176:179], v40 offset:2048
    v_mfma_f32_16x16x32_bf16 v[72:75], v[200:203], v[152:155], v[72:75]
    ds_read_b64_tr_b16 v[220:221], v45 offset:8192
    v_mfma_f32_16x16x32_bf16 v[68:71], v[196:199], v[152:155], v[68:71]
    ds_read_b64_tr_b16 v[222:223], v45 offset:9216
    v_mfma_f32_16x16x32_bf16 v[84:87], v[196:199], v[156:159], v[84:87]
    ds_read_b128 v[180:183], v40 offset:4096
    v_mfma_f32_16x16x32_bf16 v[88:91], v[200:203], v[156:159], v[88:91]
    ds_read_b64_tr_b16 v[224:225], v46 offset:8192
    v_mfma_f32_16x16x32_bf16 v[92:95], v[156:159], v[204:207], v[92:95]
    ds_read_b64_tr_b16 v[226:227], v46 offset:9216
    v_mfma_f32_16x16x32_bf16 v[96:99], v[208:211], v[156:159], v[96:99]
    ds_read_b128 v[184:187], v40 offset:6144
    v_mfma_f32_16x16x32_bf16 v[112:115], v[208:211], v[160:163], v[112:115]
    ds_read_b128 v[188:191], v40 offset:8192
    v_mfma_f32_16x16x32_bf16 v[108:111], v[160:163], v[204:207], v[108:111]
    ds_read_b128 v[192:195], v40 offset:10240
    v_mfma_f32_16x16x32_bf16 v[104:107], v[200:203], v[160:163], v[104:107]
    v_mfma_f32_16x16x32_bf16 v[100:103], v[196:199], v[160:163], v[100:103]
    v_mfma_f32_16x16x32_bf16 v[116:119], v[196:199], v[164:167], v[116:119]
    v_mfma_f32_16x16x32_bf16 v[120:123], v[200:203], v[164:167], v[120:123]
    v_mfma_f32_16x16x32_bf16 v[124:127], v[164:167], v[204:207], v[124:127]
    v_mfma_f32_16x16x32_bf16 v[128:131], v[208:211], v[164:167], v[128:131]
    v_mfma_f32_16x16x32_bf16 v[144:147], v[208:211], v[168:171], v[144:147]
    v_mfma_f32_16x16x32_bf16 v[140:143], v[168:171], v[204:207], v[140:143]
    v_mfma_f32_16x16x32_bf16 v[136:139], v[200:203], v[168:171], v[136:139]
    v_mfma_f32_16x16x32_bf16 v[132:135], v[196:199], v[168:171], v[132:135]
    s_waitcnt lgkmcnt(0)
    s_barrier
    v_mfma_f32_16x16x32_bf16 v[52:55], v[212:215], v[172:175], v[52:55]
    ds_read_b64_tr_b16 v[196:197], v43 offset:40960
    v_mfma_f32_16x16x32_bf16 v[56:59], v[216:219], v[172:175], v[56:59]
    ds_read_b64_tr_b16 v[198:199], v43 offset:41984
    v_mfma_f32_16x16x32_bf16 v[60:63], v[172:175], v[220:223], v[60:63]
    ds_read_b128 v[148:151], v39 offset:40960
    v_mfma_f32_16x16x32_bf16 v[64:67], v[224:227], v[172:175], v[64:67]
    ds_read_b64_tr_b16 v[200:201], v44 offset:40960
    v_mfma_f32_16x16x32_bf16 v[80:83], v[224:227], v[176:179], v[80:83]
    ds_read_b64_tr_b16 v[202:203], v44 offset:41984
    s_branch K_J2790
K_STM10:
    s_branch K_STM14
K_STA10:
    s_branch K_STA14
K_J2790:
    v_mfma_f32_16x16x32_bf16 v[76:79], v[176:179], v[220:223], v[76:79]
    ds_read_b128 v[152:155], v39 offset:43008
    v_mfma_f32_16x16x32_bf16 v[72:75], v[216:219], v[176:179], v[72:75]
    ds_read_b64_tr_b16 v[204:205], v45 offset:40960
    v_mfma_f32_16x16x32_bf16 v[68:71], v[212:215], v[176:179], v[68:71]
    ds_read_b64_tr_b16 v[206:207], v45 offset:41984
    v_mfma_f32_16x16x32_bf16 v[84:87], v[212:215], v[180:183], v[84:87]
    ds_read_b128 v[156:159], v39 offset:45056
    v_mfma_f32_16x16x32_bf16 v[88:91], v[216:219], v[180:183], v[88:91]
    ds_read_b64_tr_b16 v[208:209], v46 offset:40960
    v_mfma_f32_16x16x32_bf16 v[92:95], v[180:183], v[220:223], v[92:95]
    ds_read_b64_tr_b16 v[210:211], v46 offset:41984
    v_mfma_f32_16x16x32_bf16 v[96:99], v[224:227], v[180:183], v[96:99]
    ds_read_b128 v[160:163], v39 offset:47104
    v_mfma_f32_16x16x32_bf16 v[112:115], v[224:227], v[184:187], v[112:115]
    ds_read_b128 v[164:167], v39 offset:49152
    v_mfma_f32_16x16x32_bf16 v[108:111], v[184:187], v[220:223], v[108:111]
    ds_read_b128 v[168:171], v39 offset:51200
    v_mfma_f32_16x16x32_bf16 v[104:107], v[216:219], v[184:187], v[104:107]
    v_mfma_f32_16x16x32_bf16 v[100:103], v[212:215], v[184:187], v[100:103]
    v_mfma_f32_16x16x32_bf16 v[116:119], v[212:215], v[188:191], v[116:119]
    v_mfma_f32_16x16x32_bf16 v[120:123], v[216:219], v[188:191], v[120:123]
    v_mfma_f32_16x16x32_bf16 v[124:127], v[188:191], v[220:223], v[124:127]
    v_mfma_f32_16x16x32_bf16 v[128:131], v[224:227], v[188:191], v[128:131]
    v_mfma_f32_16x16x32_bf16 v[144:147], v[224:227], v[192:195], v[144:147]
    v_mfma_f32_16x16x32_bf16 v[140:143], v[192:195], v[220:223], v[140:143]
    v_mfma_f32_16x16x32_bf16 v[136:139], v[216:219], v[192:195], v[136:139]
    v_mfma_f32_16x16x32_bf16 v[132:135], v[212:215], v[192:195], v[132:135]
    s_waitcnt lgkmcnt(0)
    v_mfma_f32_16x16x32_bf16 v[52:55], v[196:199], v[148:151], v[52:55]
    ds_read_b64_tr_b16 v[212:213], v43 offset:49152
    v_mfma_f32_16x16x32_bf16 v[56:59], v[200:203], v[148:151], v[56:59]
    ds_read_b64_tr_b16 v[214:215], v43 offset:50176
    v_mfma_f32_16x16x32_bf16 v[60:63], v[148:151], v[204:207], v[60:63]
    ds_read_b128 v[172:175], v40 offset:40960
    v_mfma_f32_16x16x32_bf16 v[64:67], v[208:211], v[148:151], v[64:67]
    ds_read_b64_tr_b16 v[216:217], v44 offset:49152
    v_mfma_f32_16x16x32_bf16 v[80:83], v[208:211], v[152:155], v[80:83]
    ds_read_b64_tr_b16 v[218:219], v44 offset:50176
    v_mfma_f32_16x16x32_bf16 v[76:79], v[152:155], v[204:207], v[76:79]
    ds_read_b128 v[176:179], v40 offset:43008
    v_mfma_f32_16x16x32_bf16 v[72:75], v[200:203], v[152:155], v[72:75]
    ds_read_b64_tr_b16 v[220:221], v45 offset:49152
    v_mfma_f32_16x16x32_bf16 v[68:71], v[196:199], v[152:155], v[68:71]
    ds_read_b64_tr_b16 v[222:223], v45 offset:50176
    v_mfma_f32_16x16x32_bf16 v[84:87], v[196:199], v[156:159], v[84:87]
    ds_read_b128 v[180:183], v40 offset:45056
    v_mfma_f32_16x16x32_bf16 v[88:91], v[200:203], v[156:159], v[88:91]
    ds_read_b64_tr_b16 v[224:225], v46 offset:49152
    v_mfma_f32_16x16x32_bf16 v[92:95], v[156:159], v[204:207], v[92:95]
    ds_read_b64_tr_b16 v[226:227], v46 offset:50176
    v_mfma_f32_16x16x32_bf16 v[96:99], v[208:211], v[156:159], v[96:99]
    ds_read_b128 v[184:187], v40 offset:47104
    v_mfma_f32_16x16x32_bf16 v[112:115], v[208:211], v[160:163], v[112:115]
    ds_read_b128 v[188:191], v40 offset:49152
    v_mfma_f32_16x16x32_bf16 v[108:111], v[160:163], v[204:207], v[108:111]
    ds_read_b128 v[192:195], v40 offset:51200
    v_mfma_f32_16x16x32_bf16 v[104:107], v[200:203], v[160:163], v[104:107]
    v_mfma_f32_16x16x32_bf16 v[100:103], v[196:199], v[160:163], v[100:103]
    v_mfma_f32_16x16x32_bf16 v[116:119], v[196:199], v[164:167], v[116:119]
    v_mfma_f32_16x16x32_bf16 v[120:123], v[200:203], v[164:167], v[120:123]
    v_mfma_f32_16x16x32_bf16 v[124:127], v[164:167], v[204:207], v[124:127]
    v_mfma_f32_16x16x32_bf16 v[128:131], v[208:211], v[164:167], v[128:131]
    v_mfma_f32_16x16x32_bf16 v[144:147], v[208:211], v[168:171], v[144:147]
    v_mfma_f32_16x16x32_bf16 v[140:143], v[168:171], v[204:207], v[140:143]
    v_mfma_f32_16x16x32_bf16 v[136:139], v[200:203], v[168:171], v[136:139]
    v_mfma_f32_16x16x32_bf16 v[132:135], v[196:199], v[168:171], v[132:135]
    s_waitcnt lgkmcnt(0)
    s_barrier
    v_mfma_f32_16x16x32_bf16 v[52:55], v[212:215], v[172:175], v[52:55]
    ds_read_b64_tr_b16 v[196:197], v47 offset:0
    v_mfma_f32_16x16x32_bf16 v[56:59], v[216:219], v[172:175], v[56:59]
    ds_read_b64_tr_b16 v[198:199], v47 offset:1024
    v_mfma_f32_16x16x32_bf16 v[60:63], v[172:175], v[220:223], v[60:63]
    ds_read_b128 v[148:151], v41 offset:0
    v_mfma_f32_16x16x32_bf16 v[64:67], v[224:227], v[172:175], v[64:67]
    ds_read_b64_tr_b16 v[200:201], v48 offset:0
    v_mfma_f32_16x16x32_bf16 v[80:83], v[224:227], v[176:179], v[80:83]
    ds_read_b64_tr_b16 v[202:203], v48 offset:1024
    v_mfma_f32_16x16x32_bf16 v[76:79], v[176:179], v[220:223], v[76:79]
    ds_read_b128 v[152:155], v41 offset:2048
    v_mfma_f32_16x16x32_bf16 v[72:75], v[216:219], v[176:179], v[72:75]
    ds_read_b64_tr_b16 v[204:205], v49 offset:0
    v_mfma_f32_16x16x32_bf16 v[68:71], v[212:215], v[176:179], v[68:71]
    ds_read_b64_tr_b16 v[206:207], v49 offset:1024
    v_mfma_f32_16x16x32_bf16 v[84:87], v[212:215], v[180:183], v[84:87]
    ds_read_b128 v[156:159], v41 offset:4096
    v_mfma_f32_16x16x32_bf16 v[88:91], v[216:219], v[180:183], v[88:91]
    ds_read_b64_tr_b16 v[208:209], v50 offset:0
    v_mfma_f32_16x16x32_bf16 v[92:95], v[180:183], v[220:223], v[92:95]
    ds_read_b64_tr_b16 v[210:211], v50 offset:1024
    v_mfma_f32_16x16x32_bf16 v[96:99], v[224:227], v[180:183], v[96:99]
    ds_read_b128 v[160:163], v41 offset:6144
    v_mfma_f32_16x16x32_bf16 v[112:115], v[224:227], v[184:187], v[112:115]
    ds_read_b128 v[164:167], v41 offset:8192
    v_mfma_f32_16x16x32_bf16 v[108:111], v[184:187], v[220:223], v[108:111]
    ds_read_b128 v[168:171], v41 offset:10240
    v_mfma_f32_16x16x32_bf16 v[104:107], v[216:219], v[184:187], v[104:107]
    v_mfma_f32_16x16x32_bf16 v[100:103], v[212:215], v[184:187], v[100:103]
    v_mfma_f32_16x16x32_bf16 v[116:119], v[212:215], v[188:191], v[116:119]
    v_mfma_f32_16x16x32_bf16 v[120:123], v[216:219], v[188:191], v[120:123]
    v_mfma_f32_16x16x32_bf16 v[124:127], v[188:191], v[220:223], v[124:127]
    v_mfma_f32_16x16x32_bf16 v[128:131], v[224:227], v[188:191], v[128:131]
    v_mfma_f32_16x16x32_bf16 v[144:147], v[224:227], v[192:195], v[144:147]
    v_mfma_f32_16x16x32_bf16 v[140:143], v[192:195], v[220:223], v[140:143]
    v_mfma_f32_16x16x32_bf16 v[136:139], v[216:219], v[192:195], v[136:139]
    v_mfma_f32_16x16x32_bf16 v[132:135], v[212:215], v[192:195], v[132:135]
    s_waitcnt lgkmcnt(0)
    v_mfma_f32_16x16x32_bf16 v[52:55], v[196:199], v[148:151], v[52:55]
    ds_read_b64_tr_b16 v[212:213], v47 offset:8192
    v_mfma_f32_16x16x32_bf16 v[56:59], v[200:203], v[148:151], v[56:59]
    ds_read_b64_tr_b16 v[214:215], v47 offset:9216
    v_mfma_f32_16x16x32_bf16 v[60:63], v[148:151], v[204:207], v[60:63]
    ds_read_b128 v[172:175], v42 offset:0
    v_mfma_f32_16x16x32_bf16 v[64:67], v[208:211], v[148:151], v[64:67]
    ds_read_b64_tr_b16 v[216:217], v48 offset:8192
    v_mfma_f32_16x16x32_bf16 v[80:83], v[208:211], v[152:155], v[80:83]
    ds_read_b64_tr_b16 v[218:219], v48 offset:9216
    v_mfma_f32_16x16x32_bf16 v[76:79], v[152:155], v[204:207], v[76:79]
    ds_read_b128 v[176:179], v42 offset:2048
    v_mfma_f32_16x16x32_bf16 v[72:75], v[200:203], v[152:155], v[72:75]
    s_branch K_J2b54
K_STM11:
    s_branch K_STM15
K_STA11:
    s_branch K_STA15
K_J2b54:
    ds_read_b64_tr_b16 v[220:221], v49 offset:8192
    v_mfma_f32_16x16x32_bf16 v[68:71], v[196:199], v[152:155], v[68:71]
    ds_read_b64_tr_b16 v[222:223], v49 offset:9216
    v_mfma_f32_16x16x32_bf16 v[84:87], v[196:199], v[156:159], v[84:87]
    ds_read_b128 v[180:183], v42 offset:4096
    v_mfma_f32_16x16x32_bf16 v[88:91], v[200:203], v[156:159], v[88:91]
    ds_read_b64_tr_b16 v[224:225], v50 offset:8192
    v_mfma_f32_16x16x32_bf16 v[92:95], v[156:159], v[204:207], v[92:95]
    ds_read_b64_tr_b16 v[226:227], v50 offset:9216
    v_mfma_f32_16x16x32_bf16 v[96:99], v[208:211], v[156:159], v[96:99]
    ds_read_b128 v[184:187], v42 offset:6144
    v_mfma_f32_16x16x32_bf16 v[112:115], v[208:211], v[160:163], v[112:115]
    ds_read_b128 v[188:191], v42 offset:8192
    v_mfma_f32_16x16x32_bf16 v[108:111], v[160:163], v[204:207], v[108:111]
    ds_read_b128 v[192:195], v42 offset:10240
    v_mfma_f32_16x16x32_bf16 v[104:107], v[200:203], v[160:163], v[104:107]
    v_mfma_f32_16x16x32_bf16 v[100:103], v[196:199], v[160:163], v[100:103]
    v_mfma_f32_16x16x32_bf16 v[116:119], v[196:199], v[164:167], v[116:119]
    v_mfma_f32_16x16x32_bf16 v[120:123], v[200:203], v[164:167], v[120:123]
    v_mfma_f32_16x16x32_bf16 v[124:127], v[164:167], v[204:207], v[124:127]
    v_mfma_f32_16x16x32_bf16 v[128:131], v[208:211], v[164:167], v[128:131]
    v_mfma_f32_16x16x32_bf16 v[144:147], v[208:211], v[168:171], v[144:147]
    v_mfma_f32_16x16x32_bf16 v[140:143], v[168:171], v[204:207], v[140:143]
    v_mfma_f32_16x16x32_bf16 v[136:139], v[200:203], v[168:171], v[136:139]
    v_mfma_f32_16x16x32_bf16 v[132:135], v[196:199], v[168:171], v[132:135]
    s_waitcnt lgkmcnt(0)
    s_barrier
    v_mfma_f32_16x16x32_bf16 v[52:55], v[212:215], v[172:175], v[52:55]
    ds_read_b64_tr_b16 v[196:197], v43 offset:0
    v_mfma_f32_16x16x32_bf16 v[56:59], v[216:219], v[172:175], v[56:59]
    ds_read_b64_tr_b16 v[198:199], v43 offset:1024
    v_mfma_f32_16x16x32_bf16 v[60:63], v[172:175], v[220:223], v[60:63]
    ds_read_b128 v[148:151], v39 offset:0
    v_mfma_f32_16x16x32_bf16 v[64:67], v[224:227], v[172:175], v[64:67]
    ds_read_b64_tr_b16 v[200:201], v44 offset:0
    v_mfma_f32_16x16x32_bf16 v[80:83], v[224:227], v[176:179], v[80:83]
    ds_read_b64_tr_b16 v[202:203], v44 offset:1024
    v_mfma_f32_16x16x32_bf16 v[76:79], v[176:179], v[220:223], v[76:79]
    ds_read_b128 v[152:155], v39 offset:2048
    v_mfma_f32_16x16x32_bf16 v[72:75], v[216:219], v[176:179], v[72:75]
    ds_read_b64_tr_b16 v[204:205], v45 offset:0
    v_mfma_f32_16x16x32_bf16 v[68:71], v[212:215], v[176:179], v[68:71]
    ds_read_b64_tr_b16 v[206:207], v45 offset:1024
    v_mfma_f32_16x16x32_bf16 v[84:87], v[212:215], v[180:183], v[84:87]
    ds_read_b128 v[156:159], v39 offset:4096
    v_mfma_f32_16x16x32_bf16 v[88:91], v[216:219], v[180:183], v[88:91]
    ds_read_b64_tr_b16 v[208:209], v46 offset:0
    v_mfma_f32_16x16x32_bf16 v[92:95], v[180:183], v[220:223], v[92:95]
    ds_read_b64_tr_b16 v[210:211], v46 offset:1024
    v_mfma_f32_16x16x32_bf16 v[96:99], v[224:227], v[180:183], v[96:99]
    ds_read_b128 v[160:163], v39 offset:6144
    v_mfma_f32_16x16x32_bf16 v[112:115], v[224:227], v[184:187], v[112:115]
    ds_read_b128 v[164:167], v39 offset:8192
    v_mfma_f32_16x16x32_bf16 v[108:111], v[184:187], v[220:223], v[108:111]
    ds_read_b128 v[168:171], v39 offset:10240
    v_mfma_f32_16x16x32_bf16 v[104:107], v[216:219], v[184:187], v[104:107]
    v_mfma_f32_16x16x32_bf16 v[100:103], v[212:215], v[184:187], v[100:103]
    v_mfma_f32_16x16x32_bf16 v[116:119], v[212:215], v[188:191], v[116:119]
    v_mfma_f32_16x16x32_bf16 v[120:123], v[216:219], v[188:191], v[120:123]
    v_mfma_f32_16x16x32_bf16 v[124:127], v[188:191], v[220:223], v[124:127]
    v_mfma_f32_16x16x32_bf16 v[128:131], v[224:227], v[188:191], v[128:131]
    v_mfma_f32_16x16x32_bf16 v[144:147], v[224:227], v[192:195], v[144:147]
    v_mfma_f32_16x16x32_bf16 v[140:143], v[192:195], v[220:223], v[140:143]
    v_mfma_f32_16x16x32_bf16 v[136:139], v[216:219], v[192:195], v[136:139]
    v_mfma_f32_16x16x32_bf16 v[132:135], v[212:215], v[192:195], v[132:135]
    s_waitcnt lgkmcnt(0)
    v_mfma_f32_16x16x32_bf16 v[52:55], v[196:199], v[148:151], v[52:55]
    ds_read_b64_tr_b16 v[212:213], v43 offset:8192
    v_mfma_f32_16x16x32_bf16 v[56:59], v[200:203], v[148:151], v[56:59]
    ds_read_b64_tr_b16 v[214:215], v43 offset:9216
    v_mfma_f32_16x16x32_bf16 v[60:63], v[148:151], v[204:207], v[60:63]
    ds_read_b128 v[172:175], v40 offset:0
    v_mfma_f32_16x16x32_bf16 v[64:67], v[208:211], v[148:151], v[64:67]
    ds_read_b64_tr_b16 v[216:217], v44 offset:8192
    v_mfma_f32_16x16x32_bf16 v[80:83], v[208:211], v[152:155], v[80:83]
    ds_read_b64_tr_b16 v[218:219], v44 offset:9216
    v_mfma_f32_16x16x32_bf16 v[76:79], v[152:155], v[204:207], v[76:79]
    ds_read_b128 v[176:179], v40 offset:2048
    v_mfma_f32_16x16x32_bf16 v[72:75], v[200:203], v[152:155], v[72:75]
    ds_read_b64_tr_b16 v[220:221], v45 offset:8192
    v_mfma_f32_16x16x32_bf16 v[68:71], v[196:199], v[152:155], v[68:71]
    ds_read_b64_tr_b16 v[222:223], v45 offset:9216
    v_mfma_f32_16x16x32_bf16 v[84:87], v[196:199], v[156:159], v[84:87]
    ds_read_b128 v[180:183], v40 offset:4096
    v_mfma_f32_16x16x32_bf16 v[88:91], v[200:203], v[156:159], v[88:91]
    ds_read_b64_tr_b16 v[224:225], v46 offset:8192
    v_mfma_f32_16x16x32_bf16 v[92:95], v[156:159], v[204:207], v[92:95]
    ds_read_b64_tr_b16 v[226:227], v46 offset:9216
    v_mfma_f32_16x16x32_bf16 v[96:99], v[208:211], v[156:159], v[96:99]
    ds_read_b128 v[184:187], v40 offset:6144
    v_mfma_f32_16x16x32_bf16 v[112:115], v[208:211], v[160:163], v[112:115]
    ds_read_b128 v[188:191], v40 offset:8192
    v_mfma_f32_16x16x32_bf16 v[108:111], v[160:163], v[204:207], v[108:111]
    ds_read_b128 v[192:195], v40 offset:10240
    v_mfma_f32_16x16x32_bf16 v[104:107], v[200:203], v[160:163], v[104:107]
    v_mfma_f32_16x16x32_bf16 v[100:103], v[196:199], v[160:163], v[100:103]
    v_mfma_f32_16x16x32_bf16 v[116:119], v[196:199], v[164:167], v[116:119]
    v_mfma_f32_16x16x32_bf16 v[120:123], v[200:203], v[164:167], v[120:123]
    v_mfma_f32_16x16x32_bf16 v[124:127], v[164:167], v[204:207], v[124:127]
    v_mfma_f32_16x16x32_bf16 v[128:131], v[208:211], v[164:167], v[128:131]
    v_mfma_f32_16x16x32_bf16 v[144:147], v[208:211], v[168:171], v[144:147]
    v_mfma_f32_16x16x32_bf16 v[140:143], v[168:171], v[204:207], v[140:143]
    v_mfma_f32_16x16x32_bf16 v[136:139], v[200:203], v[168:171], v[136:139]
    v_mfma_f32_16x16x32_bf16 v[132:135], v[196:199], v[168:171], v[132:135]
    s_waitcnt lgkmcnt(0)
    s_barrier
    v_mfma_f32_16x16x32_bf16 v[52:55], v[212:215], v[172:175], v[52:55]
    ds_read_b64_tr_b16 v[196:197], v43 offset:40960
    v_mfma_f32_16x16x32_bf16 v[56:59], v[216:219], v[172:175], v[56:59]
    ds_read_b64_tr_b16 v[198:199], v43 offset:41984
    v_mfma_f32_16x16x32_bf16 v[60:63], v[172:175], v[220:223], v[60:63]
    ds_read_b128 v[148:151], v39 offset:40960
    v_mfma_f32_16x16x32_bf16 v[64:67], v[224:227], v[172:175], v[64:67]
    ds_read_b64_tr_b16 v[200:201], v44 offset:40960
    v_mfma_f32_16x16x32_bf16 v[80:83], v[224:227], v[176:179], v[80:83]
    ds_read_b64_tr_b16 v[202:203], v44 offset:41984
    v_mfma_f32_16x16x32_bf16 v[76:79], v[176:179], v[220:223], v[76:79]
    ds_read_b128 v[152:155], v39 offset:43008
    v_mfma_f32_16x16x32_bf16 v[72:75], v[216:219], v[176:179], v[72:75]
    ds_read_b64_tr_b16 v[204:205], v45 offset:40960
    v_mfma_f32_16x16x32_bf16 v[68:71], v[212:215], v[176:179], v[68:71]
    ds_read_b64_tr_b16 v[206:207], v45 offset:41984
    s_branch K_J2f1c
K_STM12:
    s_branch K_STM16
K_STA12:
    s_branch K_STA16
K_J2f1c:
    v_mfma_f32_16x16x32_bf16 v[84:87], v[212:215], v[180:183], v[84:87]
    ds_read_b128 v[156:159], v39 offset:45056
    v_mfma_f32_16x16x32_bf16 v[88:91], v[216:219], v[180:183], v[88:91]
    ds_read_b64_tr_b16 v[208:209], v46 offset:40960
    v_mfma_f32_16x16x32_bf16 v[92:95], v[180:183], v[220:223], v[92:95]
    ds_read_b64_tr_b16 v[210:211], v46 offset:41984
    v_mfma_f32_16x16x32_bf16 v[96:99], v[224:227], v[180:183], v[96:99]
    ds_read_b128 v[160:163], v39 offset:47104
    v_mfma_f32_16x16x32_bf16 v[112:115], v[224:227], v[184:187], v[112:115]
    ds_read_b128 v[164:167], v39 offset:49152
    v_mfma_f32_16x16x32_bf16 v[108:111], v[184:187], v[220:223], v[108:111]
    ds_read_b128 v[168:171], v39 offset:51200
    v_mfma_f32_16x16x32_bf16 v[104:107], v[216:219], v[184:187], v[104:107]
    v_mfma_f32_16x16x32_bf16 v[100:103], v[212:215], v[184:187], v[100:103]
    v_mfma_f32_16x16x32_bf16 v[116:119], v[212:215], v[188:191], v[116:119]
    v_mfma_f32_16x16x32_bf16 v[120:123], v[216:219], v[188:191], v[120:123]
    v_mfma_f32_16x16x32_bf16 v[124:127], v[188:191], v[220:223], v[124:127]
    v_mfma_f32_16x16x32_bf16 v[128:131], v[224:227], v[188:191], v[128:131]
    v_mfma_f32_16x16x32_bf16 v[144:147], v[224:227], v[192:195], v[144:147]
    v_mfma_f32_16x16x32_bf16 v[140:143], v[192:195], v[220:223], v[140:143]
    v_mfma_f32_16x16x32_bf16 v[136:139], v[216:219], v[192:195], v[136:139]
    v_mfma_f32_16x16x32_bf16 v[132:135], v[212:215], v[192:195], v[132:135]
    s_waitcnt lgkmcnt(0)
    v_mfma_f32_16x16x32_bf16 v[52:55], v[196:199], v[148:151], v[52:55]
    ds_read_b64_tr_b16 v[212:213], v43 offset:49152
    v_mfma_f32_16x16x32_bf16 v[56:59], v[200:203], v[148:151], v[56:59]
    ds_read_b64_tr_b16 v[214:215], v43 offset:50176
    s_branch K_PG2
.p2align 12
K_STM13:
    s_branch K_STM17
K_STA13:
    s_branch K_STA17
K_PG2:
    v_mfma_f32_16x16x32_bf16 v[60:63], v[148:151], v[204:207], v[60:63]
    ds_read_b128 v[172:175], v40 offset:40960
    v_mfma_f32_16x16x32_bf16 v[64:67], v[208:211], v[148:151], v[64:67]
    ds_read_b64_tr_b16 v[216:217], v44 offset:49152
    v_mfma_f32_16x16x32_bf16 v[80:83], v[208:211], v[152:155], v[80:83]
    ds_read_b64_tr_b16 v[218:219], v44 offset:50176
    v_mfma_f32_16x16x32_bf16 v[76:79], v[152:155], v[204:207], v[76:79]
    ds_read_b128 v[176:179], v40 offset:43008
    v_mfma_f32_16x16x32_bf16 v[72:75], v[200:203], v[152:155], v[72:75]
    ds_read_b64_tr_b16 v[220:221], v45 offset:49152
    v_mfma_f32_16x16x32_bf16 v[68:71], v[196:199], v[152:155], v[68:71]
    ds_read_b64_tr_b16 v[222:223], v45 offset:50176
    v_mfma_f32_16x16x32_bf16 v[84:87], v[196:199], v[156:159], v[84:87]
    ds_read_b128 v[180:183], v40 offset:45056
    v_mfma_f32_16x16x32_bf16 v[88:91], v[200:203], v[156:159], v[88:91]
    ds_read_b64_tr_b16 v[224:225], v46 offset:49152
    v_mfma_f32_16x16x32_bf16 v[92:95], v[156:159], v[204:207], v[92:95]
    ds_read_b64_tr_b16 v[226:227], v46 offset:50176
    v_mfma_f32_16x16x32_bf16 v[96:99], v[208:211], v[156:159], v[96:99]
    ds_read_b128 v[184:187], v40 offset:47104
    v_mfma_f32_16x16x32_bf16 v[112:115], v[208:211], v[160:163], v[112:115]
    ds_read_b128 v[188:191], v40 offset:49152
    v_mfma_f32_16x16x32_bf16 v[108:111], v[160:163], v[204:207], v[108:111]
    ds_read_b128 v[192:195], v40 offset:51200
    v_mfma_f32_16x16x32_bf16 v[104:107], v[200:203], v[160:163], v[104:107]
    v_mfma_f32_16x16x32_bf16 v[100:103], v[196:199], v[160:163], v[100:103]
    v_mfma_f32_16x16x32_bf16 v[116:119], v[196:199], v[164:167], v[116:119]
    v_mfma_f32_16x16x32_bf16 v[120:123], v[200:203], v[164:167], v[120:123]
    v_mfma_f32_16x16x32_bf16 v[124:127], v[164:167], v[204:207], v[124:127]
    v_mfma_f32_16x16x32_bf16 v[128:131], v[208:211], v[164:167], v[128:131]
    v_mfma_f32_16x16x32_bf16 v[144:147], v[208:211], v[168:171], v[144:147]
    v_mfma_f32_16x16x32_bf16 v[140:143], v[168:171], v[204:207], v[140:143]
    v_mfma_f32_16x16x32_bf16 v[136:139], v[200:203], v[168:171], v[136:139]
    v_mfma_f32_16x16x32_bf16 v[132:135], v[196:199], v[168:171], v[132:135]
    s_waitcnt lgkmcnt(0)
    s_barrier
    v_mfma_f32_16x16x32_bf16 v[52:55], v[212:215], v[172:175], v[52:55]
    ds_read_b64_tr_b16 v[196:197], v47 offset:0
    v_mfma_f32_16x16x32_bf16 v[56:59], v[216:219], v[172:175], v[56:59]
    ds_read_b64_tr_b16 v[198:199], v47 offset:1024
    v_mfma_f32_16x16x32_bf16 v[60:63], v[172:175], v[220:223], v[60:63]
    ds_read_b128 v[148:151], v41 offset:0
    v_mfma_f32_16x16x32_bf16 v[64:67], v[224:227], v[172:175], v[64:67]
    ds_read_b64_tr_b16 v[200:201], v48 offset:0
    v_mfma_f32_16x16x32_bf16 v[80:83], v[224:227], v[176:179], v[80:83]
    ds_read_b64_tr_b16 v[202:203], v48 offset:1024
    v_mfma_f32_16x16x32_bf16 v[76:79], v[176:179], v[220:223], v[76:79]
    ds_read_b128 v[152:155], v41 offset:2048
    v_mfma_f32_16x16x32_bf16 v[72:75], v[216:219], v[176:179], v[72:75]
    ds_read_b64_tr_b16 v[204:205], v49 offset:0
    v_mfma_f32_16x16x32_bf16 v[68:71], v[212:215], v[176:179], v[68:71]
    ds_read_b64_tr_b16 v[206:207], v49 offset:1024
    v_mfma_f32_16x16x32_bf16 v[84:87], v[212:215], v[180:183], v[84:87]
    ds_read_b128 v[156:159], v41 offset:4096
    v_mfma_f32_16x16x32_bf16 v[88:91], v[216:219], v[180:183], v[88:91]
    ds_read_b64_tr_b16 v[208:209], v50 offset:0
    v_mfma_f32_16x16x32_bf16 v[92:95], v[180:183], v[220:223], v[92:95]
    ds_read_b64_tr_b16 v[210:211], v50 offset:1024
    v_mfma_f32_16x16x32_bf16 v[96:99], v[224:227], v[180:183], v[96:99]
    ds_read_b128 v[160:163], v41 offset:6144
    v_mfma_f32_16x16x32_bf16 v[112:115], v[224:227], v[184:187], v[112:115]
    ds_read_b128 v[164:167], v41 offset:8192
    v_mfma_f32_16x16x32_bf16 v[108:111], v[184:187], v[220:223], v[108:111]
    ds_read_b128 v[168:171], v41 offset:10240
    v_mfma_f32_16x16x32_bf16 v[104:107], v[216:219], v[184:187], v[104:107]
    v_mfma_f32_16x16x32_bf16 v[100:103], v[212:215], v[184:187], v[100:103]
    v_mfma_f32_16x16x32_bf16 v[116:119], v[212:215], v[188:191], v[116:119]
    v_mfma_f32_16x16x32_bf16 v[120:123], v[216:219], v[188:191], v[120:123]
    v_mfma_f32_16x16x32_bf16 v[124:127], v[188:191], v[220:223], v[124:127]
    v_mfma_f32_16x16x32_bf16 v[128:131], v[224:227], v[188:191], v[128:131]
    v_mfma_f32_16x16x32_bf16 v[144:147], v[224:227], v[192:195], v[144:147]
    v_mfma_f32_16x16x32_bf16 v[140:143], v[192:195], v[220:223], v[140:143]
    v_mfma_f32_16x16x32_bf16 v[136:139], v[216:219], v[192:195], v[136:139]
    v_mfma_f32_16x16x32_bf16 v[132:135], v[212:215], v[192:195], v[132:135]
    s_waitcnt lgkmcnt(0)
    v_mfma_f32_16x16x32_bf16 v[132:135], v[196:199], v[168:171], v[132:135]
    ds_read_b64_tr_b16 v[212:213], v47 offset:8192
    ds_read_b64_tr_b16 v[214:215], v47 offset:9216
    v_mfma_f32_16x16x32_bf16 v[136:139], v[200:203], v[168:171], v[136:139]
    ds_read_b128 v[192:195], v42 offset:10240
    ds_read_b64_tr_b16 v[216:217], v48 offset:8192
    v_mfma_f32_16x16x32_bf16 v[140:143], v[168:171], v[204:207], v[140:143]
    ds_read_b64_tr_b16 v[218:219], v48 offset:9216
    ds_read_b64_tr_b16 v[220:221], v49 offset:8192
    v_mfma_f32_16x16x32_bf16 v[144:147], v[208:211], v[168:171], v[144:147]
    ds_read_b64_tr_b16 v[222:223], v49 offset:9216
    ds_read_b64_tr_b16 v[224:225], v50 offset:8192
    v_mfma_f32_16x16x32_bf16 v[116:119], v[196:199], v[164:167], v[116:119]
    ds_read_b64_tr_b16 v[226:227], v50 offset:9216
    ds_read_b128 v[188:191], v42 offset:8192
    v_mfma_f32_16x16x32_bf16 v[120:123], v[200:203], v[164:167], v[120:123]
    ds_read_b128 v[184:187], v42 offset:6144
    ds_read_b128 v[180:183], v42 offset:4096
    v_mfma_f32_16x16x32_bf16 v[124:127], v[164:167], v[204:207], v[124:127]
    ds_read_b128 v[176:179], v42 offset:2048
    ds_read_b128 v[172:175], v42 offset:0
    v_mfma_f32_16x16x32_bf16 v[128:131], v[208:211], v[164:167], v[128:131]
    s_waitcnt lgkmcnt(11)
    v_mfma_f32_16x16x32_bf16 v[132:135], v[212:215], v[192:195], v[132:135]
    s_waitcnt lgkmcnt(9)
    v_mfma_f32_16x16x32_bf16 v[136:139], v[216:219], v[192:195], v[136:139]
    s_waitcnt lgkmcnt(7)
    v_mfma_f32_16x16x32_bf16 v[140:143], v[192:195], v[220:223], v[140:143]
    s_waitcnt lgkmcnt(5)
    v_mfma_f32_16x16x32_bf16 v[144:147], v[224:227], v[192:195], v[144:147]
    s_waitcnt lgkmcnt(4)
    v_mfma_f32_16x16x32_bf16 v[116:119], v[212:215], v[188:191], v[116:119]
    v_mfma_f32_16x16x32_bf16 v[120:123], v[216:219], v[188:191], v[120:123]
    v_mfma_f32_16x16x32_bf16 v[124:127], v[188:191], v[220:223], v[124:127]
    v_mfma_f32_16x16x32_bf16 v[128:131], v[224:227], v[188:191], v[128:131]
    v_mfma_f32_16x16x32_bf16 v[100:103], v[196:199], v[160:163], v[100:103]
    v_mfma_f32_16x16x32_bf16 v[104:107], v[200:203], v[160:163], v[104:107]
    v_mfma_f32_16x16x32_bf16 v[108:111], v[160:163], v[204:207], v[108:111]
    v_cvt_pk_bf16_f32 v132, v132, v133
    v_cvt_pk_bf16_f32 v133, v134, v135
    v_mfma_f32_16x16x32_bf16 v[112:115], v[208:211], v[160:163], v[112:115]
    v_cvt_pk_bf16_f32 v136, v136, v137
    v_cvt_pk_bf16_f32 v137, v138, v139
    s_waitcnt lgkmcnt(3)
    v_mfma_f32_16x16x32_bf16 v[100:103], v[212:215], v[184:187], v[100:103]
    v_mov_b32 v138, 0
    v_mov_b32 v139, 0
    v_mfma_f32_16x16x32_bf16 v[104:107], v[216:219], v[184:187], v[104:107]
    v_cvt_pk_bf16_f32 v134, v144, v145
    v_cvt_pk_bf16_f32 v135, v146, v147
    v_mfma_f32_16x16x32_bf16 v[108:111], v[184:187], v[220:223], v[108:111]
    s_branch K_J33cc
K_STM14:
    s_branch K_STM18
K_STA14:
    s_branch K_STA18
K_J33cc:
    v_cvt_pk_bf16_f32 v240, v140, v141
    v_cvt_pk_bf16_f32 v241, v142, v143
    v_mfma_f32_16x16x32_bf16 v[112:115], v[224:227], v[184:187], v[112:115]
    v_permlane16_swap_b32 v134, v138
    v_permlane16_swap_b32 v135, v139
    ds_write_b64 v32, v[134:135] offset:768
    v_mfma_f32_16x16x32_bf16 v[84:87], v[196:199], v[156:159], v[84:87]
    s_cmp_lg_u32 s54, 0
    s_cbranch_scc1 K_NOX
    ds_write_b64 v34, v[132:133]
    ds_write_b64 v34, v[134:135] offset:512
    ds_write_b64 v34, v[240:241] offset:1024
    v_lshl_add_u32 v2, s55, 2, v38
    ds_write_b32 v2, v38 offset:28
K_NOX:
    v_mfma_f32_16x16x32_bf16 v[88:91], v[200:203], v[156:159], v[88:91]
    v_cvt_pk_bf16_f32 v116, v116, v117
    v_cvt_pk_bf16_f32 v117, v118, v119
    v_mfma_f32_16x16x32_bf16 v[192:195], v[132:135], v[136:139], v[16:19]
    v_cvt_pk_bf16_f32 v120, v120, v121
    v_cvt_pk_bf16_f32 v121, v122, v123
    v_mfma_f32_16x16x32_bf16 v[92:95], v[156:159], v[204:207], v[92:95]
    v_mov_b32 v122, 0
    v_mov_b32 v123, 0
    v_mfma_f32_16x16x32_bf16 v[96:99], v[208:211], v[156:159], v[96:99]
    v_cvt_pk_bf16_f32 v118, v128, v129
    v_cvt_pk_bf16_f32 v119, v130, v131
    s_waitcnt lgkmcnt(3)
    v_mfma_f32_16x16x32_bf16 v[84:87], v[212:215], v[180:183], v[84:87]
    v_cvt_pk_bf16_f32 v238, v124, v125
    v_cvt_pk_bf16_f32 v239, v126, v127
    v_mfma_f32_16x16x32_bf16 v[88:91], v[216:219], v[180:183], v[88:91]
    v_permlane16_swap_b32 v118, v122
    v_permlane16_swap_b32 v119, v123
    ds_write_b64 v32, v[118:119] offset:640
    v_mfma_f32_16x16x32_bf16 v[92:95], v[180:183], v[220:223], v[92:95]
    v_cvt_pk_bf16_f32 v100, v100, v101
    v_cvt_pk_bf16_f32 v101, v102, v103
    v_mfma_f32_16x16x32_bf16 v[168:171], v[116:119], v[136:139], v[12:15]
    v_cvt_pk_bf16_f32 v104, v104, v105
    v_cvt_pk_bf16_f32 v105, v106, v107
    v_mfma_f32_16x16x32_bf16 v[96:99], v[224:227], v[180:183], v[96:99]
    v_mov_b32 v106, 0
    v_mov_b32 v107, 0
    v_mfma_f32_16x16x32_bf16 v[188:191], v[116:119], v[120:123], v[16:19]
    v_cvt_pk_bf16_f32 v102, v112, v113
    v_cvt_pk_bf16_f32 v103, v114, v115
    v_mfma_f32_16x16x32_bf16 v[68:71], v[196:199], v[152:155], v[68:71]
    v_cvt_pk_bf16_f32 v236, v108, v109
    v_cvt_pk_bf16_f32 v237, v110, v111
    v_mfma_f32_16x16x32_bf16 v[72:75], v[200:203], v[152:155], v[72:75]
    v_permlane16_swap_b32 v102, v106
    v_permlane16_swap_b32 v103, v107
    ds_write_b64 v32, v[102:103] offset:512
    v_mfma_f32_16x16x32_bf16 v[76:79], v[152:155], v[204:207], v[76:79]
    v_max3_f32 v168, v168, v169, v192
    v_max3_f32 v170, v170, v171, v194
    v_mfma_f32_16x16x32_bf16 v[164:167], v[100:103], v[120:123], v[12:15]
    v_max_f32 v168, v168, v193
    v_max_f32 v169, v170, v195
    v_mfma_f32_16x16x32_bf16 v[80:83], v[208:211], v[152:155], v[80:83]
    v_cvt_pk_bf16_f32 v168, v168, v169
    v_cvt_pk_bf16_f32 v84, v84, v85
    v_mfma_f32_16x16x32_bf16 v[184:187], v[100:103], v[104:107], v[16:19]
    v_cvt_pk_bf16_f32 v85, v86, v87
    v_cvt_pk_bf16_f32 v88, v88, v89
    s_waitcnt lgkmcnt(4)
    v_mfma_f32_16x16x32_bf16 v[68:71], v[212:215], v[176:179], v[68:71]
    v_cvt_pk_bf16_f32 v89, v90, v91
    v_mov_b32 v90, 0
    v_mfma_f32_16x16x32_bf16 v[72:75], v[216:219], v[176:179], v[72:75]
    v_mov_b32 v91, 0
    v_cvt_pk_bf16_f32 v86, v96, v97
    v_mfma_f32_16x16x32_bf16 v[76:79], v[176:179], v[220:223], v[76:79]
    v_cvt_pk_bf16_f32 v87, v98, v99
    v_cvt_pk_bf16_f32 v234, v92, v93
    v_mfma_f32_16x16x32_bf16 v[80:83], v[224:227], v[176:179], v[80:83]
    v_cvt_pk_bf16_f32 v235, v94, v95
    v_permlane16_swap_b32 v86, v90
    v_mfma_f32_16x16x32_bf16 v[52:55], v[196:199], v[148:151], v[52:55]
    v_permlane16_swap_b32 v87, v91
    ds_write_b64 v32, v[86:87] offset:384
    v_mfma_f32_16x16x32_bf16 v[56:59], v[200:203], v[148:151], v[56:59]
    v_max3_f32 v164, v164, v165, v188
    v_max3_f32 v166, v166, v167, v190
    v_mfma_f32_16x16x32_bf16 v[160:163], v[84:87], v[104:107], v[12:15]
    v_max_f32 v164, v164, v189
    v_max_f32 v165, v166, v191
    v_mfma_f32_16x16x32_bf16 v[60:63], v[148:151], v[204:207], v[60:63]
    v_cvt_pk_bf16_f32 v164, v164, v165
    v_cvt_pk_bf16_f32 v68, v68, v69
    v_mfma_f32_16x16x32_bf16 v[180:183], v[84:87], v[88:91], v[16:19]
    v_cvt_pk_bf16_f32 v69, v70, v71
    v_cvt_pk_bf16_f32 v72, v72, v73
    v_mfma_f32_16x16x32_bf16 v[64:67], v[208:211], v[148:151], v[64:67]
    v_cvt_pk_bf16_f32 v73, v74, v75
    v_mov_b32 v74, 0
    s_waitcnt lgkmcnt(4)
    v_mfma_f32_16x16x32_bf16 v[52:55], v[212:215], v[172:175], v[52:55]
    v_mov_b32 v75, 0
    v_cvt_pk_bf16_f32 v70, v80, v81
    v_mfma_f32_16x16x32_bf16 v[56:59], v[216:219], v[172:175], v[56:59]
    v_cvt_pk_bf16_f32 v71, v82, v83
    v_cvt_pk_bf16_f32 v232, v76, v77
    v_mfma_f32_16x16x32_bf16 v[60:63], v[172:175], v[220:223], v[60:63]
    v_cvt_pk_bf16_f32 v233, v78, v79
    v_permlane16_swap_b32 v70, v74
    v_mfma_f32_16x16x32_bf16 v[64:67], v[224:227], v[172:175], v[64:67]
    v_permlane16_swap_b32 v71, v75
    ds_write_b64 v32, v[70:71] offset:256
    v_lshl_add_u32 v2, s55, 2, v38
    ds_read_b32 v3, v2 offset:28
    v_max3_f32 v160, v160, v161, v184
    v_max3_f32 v162, v162, v163, v186
    v_max_f32 v160, v160, v185
    v_mfma_f32_16x16x32_bf16 v[156:159], v[68:71], v[88:91], v[12:15]
    v_max_f32 v161, v162, v187
    v_cvt_pk_bf16_f32 v160, v160, v161
    v_cvt_pk_bf16_f32 v52, v52, v53
    v_mfma_f32_16x16x32_bf16 v[176:179], v[68:71], v[72:75], v[16:19]
    v_cvt_pk_bf16_f32 v53, v54, v55
    v_cvt_pk_bf16_f32 v56, v56, v57
    v_cvt_pk_bf16_f32 v57, v58, v59
    v_mov_b32 v58, 0
    v_mov_b32 v59, 0
    v_cvt_pk_bf16_f32 v54, v64, v65
    v_cvt_pk_bf16_f32 v55, v66, v67
    v_cvt_pk_bf16_f32 v230, v60, v61
    v_cvt_pk_bf16_f32 v231, v62, v63
    v_permlane16_swap_b32 v54, v58
    v_permlane16_swap_b32 v55, v59
    ds_write_b64 v32, v[54:55] offset:128
    v_max3_f32 v156, v156, v157, v180
    v_max3_f32 v158, v158, v159, v182
    v_max_f32 v156, v156, v181
    s_waitcnt lgkmcnt(0)
    v_readfirstlane_b32 s33, v3
    s_cmp_eq_u32 s33, 0
    s_cbranch_scc1 K_XW
K_XR:
    s_branch K_J3790
K_STM15:
    s_branch K_STM19
K_STA15:
    s_branch K_STA19
K_J3790:
    ds_read_b64 v[196:197], v34
    ds_read_b64 v[198:199], v34 offset:512
    ds_read_b64 v[228:229], v34 offset:1024
    ds_read_b64_tr_b16 v[200:201], v33 offset:0
    ds_read_b64_tr_b16 v[202:203], v33 offset:128
    ds_read_b64_tr_b16 v[204:205], v33 offset:256
    ds_read_b64_tr_b16 v[206:207], v33 offset:384
    ds_read_b64_tr_b16 v[208:209], v33 offset:512
    ds_read_b64_tr_b16 v[210:211], v33 offset:640
    ds_read_b64_tr_b16 v[212:213], v33 offset:768
    v_mfma_f32_16x16x32_bf16 v[152:155], v[52:55], v[72:75], v[20:23]
    v_max_f32 v157, v158, v183
    v_cvt_pk_bf16_f32 v156, v156, v157
    v_mfma_f32_16x16x32_bf16 v[172:175], v[52:55], v[56:59], v[16:19]
    s_nop 0
    s_nop 0
    s_nop 0
    s_nop 0
    s_nop 0
    v_max3_f32 v152, v152, v153, v176
    v_max3_f32 v154, v154, v155, v178
    v_max_f32 v152, v152, v177
    v_max_f32 v153, v154, v179
    v_cvt_pk_bf16_f32 v152, v152, v153
    s_waitcnt lgkmcnt(8)
    v_mfma_f32_16x16x32_bf16 v[148:151], v[196:199], v[56:59], v[12:15]
    v_permlane16_swap_b32 v164, v168
    v_permlane16_swap_b32 v156, v160
    s_nop 1
    v_permlane32_swap_b32 v156, v164
    v_permlane32_swap_b32 v160, v168
    v_lshlrev_b32 v220, 16, v156
    v_and_b32 v221, 0xffff0000, v156
    v_lshlrev_b32 v224, 16, v164
    v_and_b32 v225, 0xffff0000, v164
    v_max3_f32 v148, v148, v149, v172
    v_max3_f32 v150, v150, v151, v174
    v_max_f32 v148, v148, v173
    v_max_f32 v149, v150, v175
    v_cvt_pk_bf16_f32 v148, v148, v149
    v_lshlrev_b32 v222, 16, v160
    v_and_b32 v223, 0xffff0000, v160
    v_permlane16_swap_b32 v148, v152
    v_lshlrev_b32 v226, 16, v168
    v_and_b32 v227, 0xffff0000, v168
    v_lshlrev_b32 v216, 16, v148
    v_and_b32 v217, 0xffff0000, v148
    v_lshlrev_b32 v218, 16, v152
    v_and_b32 v219, 0xffff0000, v152
    v_pk_mul_f32 v[220:221], v[220:221], s[60:61]
    v_pk_mul_f32 v[224:225], v[224:225], s[60:61]
    v_pk_mul_f32 v[222:223], v[222:223], s[60:61]
    v_pk_mul_f32 v[226:227], v[226:227], s[60:61]
    v_pk_mul_f32 v[216:217], v[216:217], s[60:61]
    v_pk_mul_f32 v[218:219], v[218:219], s[60:61]
    v_cvt_pk_bf16_f32 v156, v220, v221
    v_cvt_pk_bf16_f32 v164, v224, v225
    v_cvt_pk_bf16_f32 v160, v222, v223
    v_cvt_pk_bf16_f32 v168, v226, v227
    v_cvt_pk_bf16_f32 v148, v216, v217
    v_cvt_pk_bf16_f32 v152, v218, v219
    v_lshlrev_b32 v218, 16, v152
    v_and_b32 v219, 0xffff0000, v152
    v_lshlrev_b32 v216, 16, v148
    v_and_b32 v217, 0xffff0000, v148
    v_lshlrev_b32 v226, 16, v168
    v_and_b32 v227, 0xffff0000, v168
    v_lshlrev_b32 v222, 16, v160
    v_and_b32 v223, 0xffff0000, v160
    v_lshlrev_b32 v224, 16, v164
    v_and_b32 v225, 0xffff0000, v164
    v_lshlrev_b32 v220, 16, v156
    v_and_b32 v221, 0xffff0000, v156
    v_max3_f32 v174, v216, v217, v218
    v_max3_f32 v172, v220, v221, v224
    v_max_f32 v174, v174, v219
    v_max3_f32 v172, v172, v225, v222
    v_mov_b32 v176, v174
    v_max3_f32 v172, v172, v223, v226
    v_max_f32 v172, v172, v227
    v_permlane32_swap_b32 v174, v176
    v_mul_f32 v172, s58, v172
    v_max_f32 v174, v174, v176
    v_mul_f32 v174, s58, v174
    v_pk_fma_f32 v[220:221], v[220:221], s[58:59], v[172:173] op_sel_hi:[1,1,0] neg_lo:[0,0,1] neg_hi:[0,0,1]
    v_pk_fma_f32 v[222:223], v[222:223], s[58:59], v[172:173] op_sel_hi:[1,1,0] neg_lo:[0,0,1] neg_hi:[0,0,1]
    v_pk_fma_f32 v[224:225], v[224:225], s[58:59], v[172:173] op_sel_hi:[1,1,0] neg_lo:[0,0,1] neg_hi:[0,0,1]
    v_pk_fma_f32 v[226:227], v[226:227], s[58:59], v[172:173] op_sel_hi:[1,1,0] neg_lo:[0,0,1] neg_hi:[0,0,1]
    v_pk_fma_f32 v[216:217], v[216:217], s[58:59], v[174:175] op_sel_hi:[1,1,0] neg_lo:[0,0,1] neg_hi:[0,0,1]
    v_pk_fma_f32 v[218:219], v[218:219], s[58:59], v[174:175] op_sel_hi:[1,1,0] neg_lo:[0,0,1] neg_hi:[0,0,1]
    v_exp_f32 v216, v216
    v_exp_f32 v217, v217
    v_exp_f32 v218, v218
    v_exp_f32 v219, v219
    v_exp_f32 v220, v220
    v_exp_f32 v221, v221
    v_exp_f32 v222, v222
    v_exp_f32 v223, v223
    v_exp_f32 v224, v224
    v_exp_f32 v225, v225
    v_exp_f32 v226, v226
    v_exp_f32 v227, v227
    v_pk_add_f32 v[174:175], v[216:217], v[218:219]
    v_pk_add_f32 v[172:173], v[220:221], v[222:223]
    v_add_f32 v174, v174, v175
    v_pk_add_f32 v[178:179], v[224:225], v[226:227]
    v_mov_b32 v176, v174
    v_pk_add_f32 v[172:173], v[172:173], v[178:179]
    v_add_f32 v172, v172, v173
    v_permlane32_swap_b32 v174, v176
    v_rcp_f32 v172, v172
    v_add_f32 v174, v174, v176
    v_rcp_f32 v174, v174
    v_pk_mul_f32 v[220:221], v[220:221], v[172:173] op_sel_hi:[1,0]
    v_pk_mul_f32 v[222:223], v[222:223], v[172:173] op_sel_hi:[1,0]
    v_pk_mul_f32 v[224:225], v[224:225], v[172:173] op_sel_hi:[1,0]
    v_pk_mul_f32 v[226:227], v[226:227], v[172:173] op_sel_hi:[1,0]
    v_pk_mul_f32 v[216:217], v[216:217], v[174:175] op_sel_hi:[1,0]
    v_pk_mul_f32 v[218:219], v[218:219], v[174:175] op_sel_hi:[1,0]
    v_cvt_pk_bf16_f32 v156, v220, v221
    v_cvt_pk_bf16_f32 v164, v224, v225
    v_cvt_pk_bf16_f32 v160, v222, v223
    v_cvt_pk_bf16_f32 v168, v226, v227
    v_cvt_pk_bf16_f32 v148, v216, v217
    v_cvt_pk_bf16_f32 v152, v218, v219
    v_permlane32_swap_b32 v156, v164
    v_permlane32_swap_b32 v160, v168
    v_permlane16_swap_b32 v148, v152
    s_waitcnt lgkmcnt(0)
    v_permlane16_swap_b32 v156, v160
    v_permlane16_swap_b32 v164, v168
    s_cmp_eq_u32 s36, 0
    s_cbranch_scc1 K_NOHINT
    v_mov_b32 v4, s36
    s_mov_b32 exec_lo, s37
    s_mov_b32 exec_hi, 0
    global_atomic_add v37, v4, s[6:7] sc1
    s_mov_b64 exec, -1
K_NOHINT:
    v_perm_b32 v56, v148, v148, v24
    v_perm_b32 v57, v148, v148, v25
    v_perm_b32 v58, v148, v148, v26
    v_perm_b32 v59, v148, v148, v27
    v_perm_b32 v72, v152, v152, v24
    v_perm_b32 v73, v152, v152, v25
    v_perm_b32 v74, v152, v152, v26
    v_perm_b32 v75, v152, v152, v27
    v_mfma_f32_16x16x32_bf16 v[64:67], v[200:203], v[56:59], 0
    v_mfma_f32_16x16x32_bf16 v[60:63], v[228:231], v[56:59], 0
    v_perm_b32 v88, v156, v156, v24
    v_perm_b32 v89, v156, v156, v25
    v_perm_b32 v90, v156, v156, v26
    v_perm_b32 v91, v156, v156, v27
    v_mfma_f32_16x16x32_bf16 v[80:83], v[202:205], v[72:75], 0
    s_branch K_J3b58
K_STM16:
    s_branch K_STM20
K_STA16:
    s_branch K_STA20
K_J3b58:
    v_mfma_f32_16x16x32_bf16 v[76:79], v[230:233], v[72:75], 0
    v_perm_b32 v104, v160, v160, v24
    v_perm_b32 v105, v160, v160, v25
    v_perm_b32 v106, v160, v160, v26
    v_perm_b32 v107, v160, v160, v27
    v_mfma_f32_16x16x32_bf16 v[96:99], v[204:207], v[88:91], 0
    v_mfma_f32_16x16x32_bf16 v[92:95], v[232:235], v[88:91], 0
    v_cvt_pk_bf16_f32 v68, v64, v65
    v_cvt_pk_bf16_f32 v69, v66, v67
    ds_write_b64 v35, v[68:69] offset:0
    v_perm_b32 v120, v164, v164, v24
    v_perm_b32 v121, v164, v164, v25
    v_perm_b32 v122, v164, v164, v26
    v_perm_b32 v123, v164, v164, v27
    v_mfma_f32_16x16x32_bf16 v[112:115], v[206:209], v[104:107], 0
    v_mfma_f32_16x16x32_bf16 v[108:111], v[234:237], v[104:107], 0
    v_cvt_pk_bf16_f32 v70, v80, v81
    v_cvt_pk_bf16_f32 v71, v82, v83
    ds_write_b64 v35, v[70:71] offset:256
    v_perm_b32 v136, v168, v168, v24
    v_perm_b32 v137, v168, v168, v25
    v_perm_b32 v138, v168, v168, v26
    v_perm_b32 v139, v168, v168, v27
    v_mfma_f32_16x16x32_bf16 v[128:131], v[208:211], v[120:123], 0
    v_mfma_f32_16x16x32_bf16 v[124:127], v[236:239], v[120:123], 0
    v_cvt_pk_bf16_f32 v100, v96, v97
    v_cvt_pk_bf16_f32 v101, v98, v99
    ds_write_b64 v35, v[100:101] offset:512
    v_mov_b32 v3, 1
    v_mfma_f32_16x16x32_bf16 v[144:147], v[210:213], v[136:139], 0
    v_mfma_f32_16x16x32_bf16 v[140:143], v[238:241], v[136:139], 0
    v_lshl_add_u32 v2, s54, 2, v38
    v_cvt_pk_bf16_f32 v102, v112, v113
    v_cvt_pk_bf16_f32 v103, v114, v115
    ds_write_b64 v35, v[102:103] offset:768
    v_cvt_pk_bf16_f32 v132, v128, v129
    v_cvt_pk_bf16_f32 v133, v130, v131
    ds_write_b64 v35, v[132:133] offset:1024
    s_nop 0
    v_cvt_pk_bf16_f32 v134, v144, v145
    v_cvt_pk_bf16_f32 v135, v146, v147
    ds_write_b64 v35, v[134:135] offset:1280
    s_mov_b64 exec, 1
    ds_add_u32 v2, v3 offset:48
    s_mov_b64 exec, -1
    v_cvt_pk_bf16_f32 v52, v60, v61
    v_cvt_pk_bf16_f32 v54, v76, v77
    v_cvt_pk_bf16_f32 v53, v62, v63
    v_cvt_pk_bf16_f32 v55, v78, v79
    s_nop 0
    v_permlane16_swap_b32 v52, v54
    v_permlane16_swap_b32 v53, v55
    v_min_u32 v52, -2, v52
    buffer_store_dwordx4 v[52:55], v28, s[20:23], 0 offen sc1
    v_cvt_pk_bf16_f32 v84, v92, v93
    v_cvt_pk_bf16_f32 v86, v108, v109
    v_cvt_pk_bf16_f32 v85, v94, v95
    v_cvt_pk_bf16_f32 v87, v110, v111
    s_nop 0
    v_permlane16_swap_b32 v84, v86
    v_permlane16_swap_b32 v85, v87
    v_min_u32 v84, -2, v84
    buffer_store_dwordx4 v[84:87], v29, s[20:23], 0 offen sc1
    ds_read_b32 v3, v2 offset:48
    ds_read_b128 v[196:199], v36
    v_cvt_pk_bf16_f32 v116, v124, v125
    v_cvt_pk_bf16_f32 v118, v140, v141
    v_cvt_pk_bf16_f32 v117, v126, v127
    v_cvt_pk_bf16_f32 v119, v142, v143
    s_nop 0
    v_permlane16_swap_b32 v116, v118
    v_permlane16_swap_b32 v117, v119
    v_min_u32 v116, -2, v116
    buffer_store_dwordx4 v[116:119], v30, s[20:23], 0 offen sc1
    s_waitcnt lgkmcnt(0)
    v_readfirstlane_b32 s33, v3
    s_cmp_lt_u32 s33, 2
    s_cbranch_scc1 K_TW
K_TR:
    v_min_u32 v196, -2, v196
    buffer_store_dwordx4 v[196:199], v31, s[20:23], 0 offen sc1
    s_cmp_eq_u32 s34, -1
    s_cbranch_scc1 K_END
    s_add_u32 s30, s30, 4
    s_branch K_P2_HELP
K_STM17:
    s_branch K_STM21
K_STA17:
    s_branch K_STA21
K_XW:
    s_mov_b32 s3, 1048576
K_CGX:
    ds_read_b32 v3, v2 offset:28
    s_sub_u32 s3, s3, 1
    s_waitcnt lgkmcnt(0)
    v_readfirstlane_b32 s33, v3
    s_cselect_b32 s33, 1, s33
    s_cmp_lt_u32 s33, 1
    s_cbranch_scc1 K_CGX
    s_branch K_XR
K_TW:
    s_mov_b32 s3, 1048576
K_CGT:
    ds_read_b32 v3, v2 offset:48
    s_sub_u32 s3, s3, 1
    s_waitcnt lgkmcnt(0)
    v_readfirstlane_b32 s33, v3
    s_cselect_b32 s33, 2, s33
    s_cmp_lt_u32 s33, 2
    s_cbranch_scc1 K_CGT
    ds_read_b128 v[196:199], v36
    s_waitcnt lgkmcnt(0)
    s_branch K_TR
K_P2_EARLY:
    s_lshl_b32 s54, s40, 7
    v_lshrrev_b32 v8, 3, v1
    v_lshrrev_b32 v9, 4, v1
    v_mov_b32 v15, 158720
    s_lshl_b32 s53, s40, 3
    s_add_u32 s53, s53, s30
    s_mul_i32 s3, s53, 20480
    s_lshl_b32 s33, s41, 7
    s_add_u32 s3, s3, s33
    v_and_b32 v2, 7, v1
    v_lshlrev_b32 v2, 4, v2
    v_mul_u32_u24 v4, 1280, v8
    v_add3_u32 v10, v2, v4, s3
    s_lshl_b32 s3, s30, 7
    s_add_u32 s3, s3, 159744
    v_lshl_add_u32 v11, v8, 3, s3
    s_mov_b32 s55, 10240
    s_add_u32 s20, s6, 0x100000
    s_addc_u32 s21, s7, 0
    s_mov_b32 s22, 0x280000
    s_mov_b32 s23, 0x20000
    s_mov_b32 s48, s10
    s_mov_b32 s49, s11
    s_mov_b32 s50, 0x280000
    s_mov_b32 s51, 0x20000
    v_mul_u32_u24 v3, 144, v8
    v_add_u32 v3, v2, v3
    s_mul_i32 s3, s30, 2304
    s_add_u32 s3, s3, 140288
    v_add_u32 v14, s3, v3
    buffer_load_dwordx4 v[16:19], v10, s[12:15], 0 offen
    buffer_load_dwordx4 v[20:23], v10, s[12:15], s55 offen
    v_bfe_u32 v48, v1, 2, 2
    v_and_b32 v49, 3, v1
    s_add_u32 s3, s53, s30
    s_lshr_b32 s33, s3, 2
    s_mul_i32 s33, s33, 76
    s_add_u32 s3, s3, s33
    s_lshl_b32 s3, s3, 10
    v_and_b32 v2, 15, v1
    v_lshl_add_u32 v2, v2, 4, s3
    v_lshrrev_b32 v3, 5, v1
    v_lshl_add_u32 v2, v3, 8, v2
    v_and_b32 v4, 1, v9
    v_lshl_add_u32 v52, v4, 10, v2
    v_mov_b32 v53, 0x1f000
    v_lshl_add_u32 v2, v3, 3, v48
    v_lshlrev_b32 v2, 7, v2
    v_lshl_add_u32 v2, v49, 3, v2
    v_lshl_add_u32 v2, v4, 5, v2
    v_lshrrev_b32 v4, 1, v48
    v_lshl_add_u32 v54, v4, 6, v2
    v_xor_b32 v55, 64, v54
    v_mov_b32 v56, v54
    v_mov_b32 v57, v54
    v_and_b32 v2, 31, v1
    v_mul_u32_u24 v2, 144, v2
    v_lshl_add_u32 v2, v3, 3, v2
    s_mul_i32 s3, s30, 4608
    s_add_u32 s3, s3, 140288
    v_add_u32 v50, s3, v2
    s_lshl_b32 s3, s40, 3
    s_mul_i32 s33, s3, 187
    s_lshr_b32 s33, s33, 11
    s_add_u32 s33, s33, 1
    s_mul_i32 s33, s33, 11
    s_add_u32 s3, s53, s30
    s_add_u32 s3, s3, 1
    s_cmp_ge_u32 s3, s33
    s_cselect_b32 s52, 24, 16
    s_cmp_gt_u32 s3, s33
    s_cselect_b32 s52, 20, s52
    v_add_u32 v58, s52, v15
    s_mov_b32 s67, -1
    s_mov_b32 s68, -1
    s_mov_b32 s69, -1
    s_mov_b32 s70, -1
    s_mov_b32 s71, -1
    s_mov_b32 s72, -1
    s_mov_b32 s73, 0xfffff
    s_mov_b32 s74, 131072
    v_mov_b32 v108, 0
    v_mov_b32 v109, 0
    v_mov_b32 v110, 0
    v_mov_b32 v111, 0
    v_mov_b32 v112, 0
    v_mov_b32 v113, 0
    v_mov_b32 v114, 0
    v_mov_b32 v115, 0
    v_mov_b32 v116, 0
    s_branch K_PG3
.p2align 12
K_STM18:
    s_branch K_STM22
K_CHA0:
K_STA18:
    s_branch K_STA22
K_PG3:
    v_mov_b32 v117, 0
    v_mov_b32 v118, 0
    v_mov_b32 v119, 0
    v_mov_b32 v120, 0
    v_mov_b32 v121, 0
    v_mov_b32 v122, 0
    v_mov_b32 v123, 0
    v_mov_b32 v124, 0
    v_mov_b32 v125, 0
    v_mov_b32 v126, 0
    v_mov_b32 v127, 0
    v_mov_b32 v128, 0
    v_mov_b32 v129, 0
    v_mov_b32 v130, 0
    v_mov_b32 v131, 0
    v_mov_b32 v132, 0
    v_mov_b32 v133, 0
    v_mov_b32 v134, 0
    v_mov_b32 v135, 0
    v_mov_b32 v136, 0
    v_mov_b32 v137, 0
    v_mov_b32 v138, 0
    v_mov_b32 v139, 0
    s_barrier
    s_branch K_P2_AUXW
K_P2_GM:
    s_lshl_b32 s54, s40, 7
    v_lshrrev_b32 v8, 3, v1
    v_lshrrev_b32 v9, 4, v1
    v_mov_b32 v15, 158720
    s_lshl_b32 s53, s40, 3
    s_add_u32 s53, s53, s30
    s_mul_i32 s3, s53, 20480
    s_lshl_b32 s33, s41, 7
    s_add_u32 s3, s3, s33
    v_and_b32 v2, 7, v1
    v_lshlrev_b32 v2, 4, v2
    v_mul_u32_u24 v4, 1280, v8
    v_add3_u32 v10, v2, v4, s3
    s_lshl_b32 s3, s30, 7
    s_add_u32 s3, s3, 159744
    v_lshl_add_u32 v11, v8, 3, s3
    s_mov_b32 s55, 10240
    s_add_u32 s20, s6, 0x100000
    s_addc_u32 s21, s7, 0
    s_mov_b32 s22, 0x280000
    s_mov_b32 s23, 0x20000
    s_mov_b32 s48, s10
    s_mov_b32 s49, s11
    s_mov_b32 s50, 0x280000
    s_mov_b32 s51, 0x20000
    v_mul_u32_u24 v3, 144, v8
    v_add_u32 v3, v2, v3
    s_mul_i32 s3, s30, 2304
    s_add_u32 s3, s3, 140288
    v_add_u32 v14, s3, v3
    buffer_load_dwordx4 v[16:19], v10, s[12:15], 0 offen
    buffer_load_dwordx4 v[20:23], v10, s[12:15], s55 offen
    v_bfe_u32 v48, v1, 2, 2
    v_and_b32 v49, 3, v1
    s_add_u32 s3, s53, s30
    s_lshr_b32 s33, s3, 2
    s_mul_i32 s33, s33, 76
    s_add_u32 s3, s3, s33
    s_lshl_b32 s3, s3, 10
    v_and_b32 v2, 15, v1
    v_lshl_add_u32 v2, v2, 4, s3
    v_lshrrev_b32 v3, 5, v1
    v_lshl_add_u32 v2, v3, 8, v2
    v_and_b32 v4, 1, v9
    v_lshl_add_u32 v52, v4, 10, v2
    v_mov_b32 v53, 0x1f000
    v_lshl_add_u32 v2, v3, 3, v48
    v_lshlrev_b32 v2, 7, v2
    v_lshl_add_u32 v2, v49, 3, v2
    v_lshl_add_u32 v2, v4, 5, v2
    v_lshrrev_b32 v4, 1, v48
    v_lshl_add_u32 v54, v4, 6, v2
    v_xor_b32 v55, 64, v54
    v_mov_b32 v56, v54
    v_mov_b32 v57, v54
    v_and_b32 v2, 31, v1
    v_mul_u32_u24 v2, 144, v2
    v_lshl_add_u32 v2, v3, 3, v2
    s_mul_i32 s3, s30, 4608
    s_add_u32 s3, s3, 140288
    v_add_u32 v50, s3, v2
    s_lshl_b32 s3, s40, 3
    s_mul_i32 s33, s3, 187
    s_lshr_b32 s33, s33, 11
    s_add_u32 s33, s33, 1
    s_mul_i32 s33, s33, 11
    s_add_u32 s3, s53, s30
    s_add_u32 s3, s3, 1
    s_cmp_ge_u32 s3, s33
    s_cselect_b32 s52, 24, 16
    s_cmp_gt_u32 s3, s33
    s_cselect_b32 s52, 20, s52
    v_add_u32 v58, s52, v15
    s_mov_b32 s67, -1
    s_mov_b32 s68, -1
    s_mov_b32 s69, -1
    s_mov_b32 s70, -1
    s_mov_b32 s71, -1
    s_mov_b32 s72, -1
    s_mov_b32 s73, 0xfffff
    s_mov_b32 s74, 131072
    v_mov_b32 v108, 0
    v_mov_b32 v109, 0
    v_mov_b32 v110, 0
    v_mov_b32 v111, 0
    v_mov_b32 v112, 0
    v_mov_b32 v113, 0
    v_mov_b32 v114, 0
    v_mov_b32 v115, 0
    v_mov_b32 v116, 0
    v_mov_b32 v117, 0
    v_mov_b32 v118, 0
    v_mov_b32 v119, 0
    v_mov_b32 v120, 0
    v_mov_b32 v121, 0
    v_mov_b32 v122, 0
    v_mov_b32 v123, 0
    v_mov_b32 v124, 0
    v_mov_b32 v125, 0
    v_mov_b32 v126, 0
    v_mov_b32 v127, 0
    v_mov_b32 v128, 0
    v_mov_b32 v129, 0
    v_mov_b32 v130, 0
    v_mov_b32 v131, 0
    v_mov_b32 v132, 0
    v_mov_b32 v133, 0
    v_mov_b32 v134, 0
    v_mov_b32 v135, 0
    v_mov_b32 v136, 0
    v_mov_b32 v137, 0
    v_mov_b32 v138, 0
    v_mov_b32 v139, 0
    v_mov_b32 v3, 1
    s_waitcnt vmcnt(2)
    s_mov_b64 exec, 1
    ds_add_u32 v15, v3 offset:44
    s_mov_b64 exec, -1
    s_cmp_eq_u32 s30, 0
    s_cbranch_scc1 K_P2_G0
K_P2_G0R:
    s_mov_b32 s3, 1048576
K_P2_GWM:
    ds_read_b32 v2, v15 offset:44
    s_sleep 1
    s_sub_u32 s3, s3, 1
    s_waitcnt lgkmcnt(0)
    v_readfirstlane_b32 s33, v2
    s_nop 3
    s_cselect_b32 s33, 4, s33
    s_cmp_lt_u32 s33, 4
    s_cbranch_scc1 K_P2_GWM
K_P2_GEMM:
    s_setprio 2
    s_mov_b32 s58, 0
    s_waitcnt vmcnt(0)
    v_lshlrev_b32 v32, 16, v16
    v_and_b32 v33, 0xffff0000, v16
    v_lshlrev_b32 v34, 16, v17
    v_and_b32 v35, 0xffff0000, v17
    v_lshlrev_b32 v36, 16, v18
    v_and_b32 v37, 0xffff0000, v18
    v_lshlrev_b32 v38, 16, v19
    v_and_b32 v39, 0xffff0000, v19
    v_lshlrev_b32 v40, 16, v20
    v_and_b32 v41, 0xffff0000, v20
    v_lshlrev_b32 v42, 16, v21
    v_and_b32 v43, 0xffff0000, v21
    v_lshlrev_b32 v44, 16, v22
    v_and_b32 v45, 0xffff0000, v22
    v_lshlrev_b32 v46, 16, v23
    v_and_b32 v47, 0xffff0000, v23
    s_branch K_SK0
K_IT0:
    v_mfma_f32_32x32x16_bf16 v[108:123], v[156:159], v[68:71], v[108:123]
    ds_read_b64_tr_b16 v[140:141], v56 offset:0
    ds_read_b64_tr_b16 v[142:143], v56 offset:512
    s_and_b32 s33, s58, s73
    s_cbranch_scc0 K_RF0
K_RB0:
    s_ff1_i32_b32 s59, s33
    ds_read_b64_tr_b16 v[144:145], v56 offset:2048
    v_mfma_f32_32x32x16_bf16 v[124:139], v[164:167], v[68:71], v[124:139]
    s_bitset0_b32 s73, s59
    s_lshl_b32 s67, s59, 12
    buffer_load_dwordx4 v[60:63], v52, s[20:23], s67 offen offset:0 sc1
    ds_read_b64_tr_b16 v[146:147], v56 offset:2560
    ds_read_b64_tr_b16 v[148:149], v57 offset:0
    s_branch K_J43cc
K_STM19:
    s_branch K_STM23
K_CHA1:
K_STA19:
    s_branch K_STA23
K_J43cc:
    v_mfma_f32_32x32x16_bf16 v[108:123], v[160:163], v[72:75], v[108:123]
    buffer_load_dwordx4 v[64:67], v52, s[20:23], s67 offen offset:512 sc1
    ds_read_b64_tr_b16 v[150:151], v57 offset:512
    ds_read_b64_tr_b16 v[152:153], v57 offset:2048
    ds_read_b64_tr_b16 v[154:155], v57 offset:2560
    v_mfma_f32_32x32x16_bf16 v[124:139], v[168:171], v[72:75], v[124:139]
K_TL0:
    s_waitcnt vmcnt(8) lgkmcnt(8)
    v_cmp_u_f32 vcc, v76, v80
    v_and_or_b32 v56, s71, v53, v54
    v_and_or_b32 v57, s71, v53, v55
    s_cbranch_vccnz K_FX1
K_IT1:
    v_mfma_f32_32x32x16_bf16 v[108:123], v[172:175], v[76:79], v[108:123]
    ds_read_b64_tr_b16 v[156:157], v56 offset:0
    ds_read_b64_tr_b16 v[158:159], v56 offset:512
    s_and_b32 s33, s58, s73
    s_cbranch_scc0 K_RF1
K_RB1:
    s_ff1_i32_b32 s59, s33
    ds_read_b64_tr_b16 v[160:161], v56 offset:2048
    v_mfma_f32_32x32x16_bf16 v[124:139], v[180:183], v[76:79], v[124:139]
    s_bitset0_b32 s73, s59
    s_lshl_b32 s68, s59, 12
    buffer_load_dwordx4 v[68:71], v52, s[20:23], s68 offen offset:0 sc1
    ds_read_b64_tr_b16 v[162:163], v56 offset:2560
    ds_read_b64_tr_b16 v[164:165], v57 offset:0
    v_mfma_f32_32x32x16_bf16 v[108:123], v[176:179], v[80:83], v[108:123]
    buffer_load_dwordx4 v[72:75], v52, s[20:23], s68 offen offset:512 sc1
    ds_read_b64_tr_b16 v[166:167], v57 offset:512
    ds_read_b64_tr_b16 v[168:169], v57 offset:2048
    ds_read_b64_tr_b16 v[170:171], v57 offset:2560
    v_mfma_f32_32x32x16_bf16 v[124:139], v[184:187], v[80:83], v[124:139]
K_TL1:
    s_waitcnt vmcnt(8) lgkmcnt(8)
    v_cmp_u_f32 vcc, v84, v88
    v_and_or_b32 v56, s72, v53, v54
    v_and_or_b32 v57, s72, v53, v55
    s_cbranch_vccnz K_FX2
K_IT2:
    v_mfma_f32_32x32x16_bf16 v[108:123], v[140:143], v[84:87], v[108:123]
    ds_read_b64_tr_b16 v[172:173], v56 offset:0
    ds_read_b64_tr_b16 v[174:175], v56 offset:512
    s_and_b32 s33, s58, s73
    s_cbranch_scc0 K_RF2
K_RB2:
    s_ff1_i32_b32 s59, s33
    ds_read_b64_tr_b16 v[176:177], v56 offset:2048
    v_mfma_f32_32x32x16_bf16 v[124:139], v[148:151], v[84:87], v[124:139]
    s_bitset0_b32 s73, s59
    s_lshl_b32 s69, s59, 12
    buffer_load_dwordx4 v[76:79], v52, s[20:23], s69 offen offset:0 sc1
    ds_read_b64_tr_b16 v[178:179], v56 offset:2560
    ds_read_b64_tr_b16 v[180:181], v57 offset:0
    v_mfma_f32_32x32x16_bf16 v[108:123], v[144:147], v[88:91], v[108:123]
    buffer_load_dwordx4 v[80:83], v52, s[20:23], s69 offen offset:512 sc1
    ds_read_b64_tr_b16 v[182:183], v57 offset:512
    ds_read_b64_tr_b16 v[184:185], v57 offset:2048
    ds_read_b64_tr_b16 v[186:187], v57 offset:2560
    v_mfma_f32_32x32x16_bf16 v[124:139], v[152:155], v[88:91], v[124:139]
K_TL2:
    s_waitcnt vmcnt(8) lgkmcnt(8)
    v_cmp_u_f32 vcc, v92, v96
    v_and_or_b32 v56, s67, v53, v54
    v_and_or_b32 v57, s67, v53, v55
    s_cbranch_vccnz K_FX3
K_IT3:
    v_mfma_f32_32x32x16_bf16 v[108:123], v[156:159], v[92:95], v[108:123]
    ds_read_b64_tr_b16 v[140:141], v56 offset:0
    ds_read_b64_tr_b16 v[142:143], v56 offset:512
    s_and_b32 s33, s58, s73
    s_cbranch_scc0 K_RF3
K_RB3:
    s_ff1_i32_b32 s59, s33
    ds_read_b64_tr_b16 v[144:145], v56 offset:2048
    v_mfma_f32_32x32x16_bf16 v[124:139], v[164:167], v[92:95], v[124:139]
    s_bitset0_b32 s73, s59
    s_lshl_b32 s70, s59, 12
    buffer_load_dwordx4 v[84:87], v52, s[20:23], s70 offen offset:0 sc1
    ds_read_b64_tr_b16 v[146:147], v56 offset:2560
    ds_read_b64_tr_b16 v[148:149], v57 offset:0
    v_mfma_f32_32x32x16_bf16 v[108:123], v[160:163], v[96:99], v[108:123]
    buffer_load_dwordx4 v[88:91], v52, s[20:23], s70 offen offset:512 sc1
    ds_read_b64_tr_b16 v[150:151], v57 offset:512
    ds_read_b64_tr_b16 v[152:153], v57 offset:2048
    ds_read_b64_tr_b16 v[154:155], v57 offset:2560
    v_mfma_f32_32x32x16_bf16 v[124:139], v[168:171], v[96:99], v[124:139]
K_TL3:
    s_waitcnt vmcnt(8) lgkmcnt(8)
    v_cmp_u_f32 vcc, v100, v104
    v_and_or_b32 v56, s68, v53, v54
    v_and_or_b32 v57, s68, v53, v55
    s_cbranch_vccnz K_FX4
K_IT4:
    v_mfma_f32_32x32x16_bf16 v[108:123], v[172:175], v[100:103], v[108:123]
    ds_read_b64_tr_b16 v[156:157], v56 offset:0
    ds_read_b64_tr_b16 v[158:159], v56 offset:512
    s_and_b32 s33, s58, s73
    s_cbranch_scc0 K_RF4
K_RB4:
    s_ff1_i32_b32 s59, s33
    ds_read_b64_tr_b16 v[160:161], v56 offset:2048
    v_mfma_f32_32x32x16_bf16 v[124:139], v[180:183], v[100:103], v[124:139]
    s_bitset0_b32 s73, s59
    s_lshl_b32 s71, s59, 12
    buffer_load_dwordx4 v[92:95], v52, s[20:23], s71 offen offset:0 sc1
    ds_read_b64_tr_b16 v[162:163], v56 offset:2560
    ds_read_b64_tr_b16 v[164:165], v57 offset:0
    v_mfma_f32_32x32x16_bf16 v[108:123], v[176:179], v[104:107], v[108:123]
    buffer_load_dwordx4 v[96:99], v52, s[20:23], s71 offen offset:512 sc1
    ds_read_b64_tr_b16 v[166:167], v57 offset:512
    ds_read_b64_tr_b16 v[168:169], v57 offset:2048
    ds_read_b64_tr_b16 v[170:171], v57 offset:2560
    v_mfma_f32_32x32x16_bf16 v[124:139], v[184:187], v[104:107], v[124:139]
K_TL4:
    s_waitcnt vmcnt(8) lgkmcnt(8)
    v_cmp_u_f32 vcc, v60, v64
    v_and_or_b32 v56, s69, v53, v54
    v_and_or_b32 v57, s69, v53, v55
    s_cbranch_vccnz K_FX5
K_IT5:
    v_mfma_f32_32x32x16_bf16 v[108:123], v[140:143], v[60:63], v[108:123]
    ds_read_b64_tr_b16 v[172:173], v56 offset:0
    ds_read_b64_tr_b16 v[174:175], v56 offset:512
    s_and_b32 s33, s58, s73
    s_cbranch_scc0 K_RF5
K_RB5:
    s_ff1_i32_b32 s59, s33
    ds_read_b64_tr_b16 v[176:177], v56 offset:2048
    v_mfma_f32_32x32x16_bf16 v[124:139], v[148:151], v[60:63], v[124:139]
    s_bitset0_b32 s73, s59
    s_lshl_b32 s72, s59, 12
    buffer_load_dwordx4 v[100:103], v52, s[20:23], s72 offen offset:0 sc1
    ds_read_b64_tr_b16 v[178:179], v56 offset:2560
    ds_read_b64_tr_b16 v[180:181], v57 offset:0
    v_mfma_f32_32x32x16_bf16 v[108:123], v[144:147], v[64:67], v[108:123]
    buffer_load_dwordx4 v[104:107], v52, s[20:23], s72 offen offset:512 sc1
    ds_read_b64_tr_b16 v[182:183], v57 offset:512
    ds_read_b64_tr_b16 v[184:185], v57 offset:2048
    ds_read_b64_tr_b16 v[186:187], v57 offset:2560
    v_mfma_f32_32x32x16_bf16 v[124:139], v[152:155], v[64:67], v[124:139]
K_TL5:
    s_waitcnt vmcnt(8) lgkmcnt(8)
    v_cmp_u_f32 vcc, v68, v72
    v_and_or_b32 v56, s70, v53, v54
    v_and_or_b32 v57, s70, v53, v55
    s_cbranch_vccnz K_FX0
    s_branch K_IT0
K_DR0:
    v_mfma_f32_32x32x16_bf16 v[108:123], v[156:159], v[68:71], v[108:123]
    ds_read_b64_tr_b16 v[140:141], v56 offset:0
    ds_read_b64_tr_b16 v[142:143], v56 offset:512
K_DM0:
    ds_read_b64_tr_b16 v[144:145], v56 offset:2048
    s_mov_b32 s67, -1
    v_mfma_f32_32x32x16_bf16 v[124:139], v[164:167], v[68:71], v[124:139]
    buffer_load_dword v3, v52, s[20:23], s67 offen
    ds_read_b64_tr_b16 v[146:147], v56 offset:2560
    ds_read_b64_tr_b16 v[148:149], v57 offset:0
    v_mfma_f32_32x32x16_bf16 v[108:123], v[160:163], v[72:75], v[108:123]
    s_branch K_J4794
K_STM20:
    s_branch K_STM24
K_CHA2:
K_STA20:
    s_branch K_STA24
K_J4794:
    buffer_load_dword v3, v52, s[20:23], s67 offen
    ds_read_b64_tr_b16 v[150:151], v57 offset:512
    ds_read_b64_tr_b16 v[152:153], v57 offset:2048
    ds_read_b64_tr_b16 v[154:155], v57 offset:2560
    v_mfma_f32_32x32x16_bf16 v[124:139], v[168:171], v[72:75], v[124:139]
    s_waitcnt vmcnt(8) lgkmcnt(8)
    v_cmp_u_f32 vcc, v76, v80
    v_and_or_b32 v56, s71, v53, v54
    v_and_or_b32 v57, s71, v53, v55
    v_mov_b32 v60, -1
    s_cbranch_vccnz K_FX1
K_DR1:
    v_mfma_f32_32x32x16_bf16 v[108:123], v[172:175], v[76:79], v[108:123]
    ds_read_b64_tr_b16 v[156:157], v56 offset:0
    ds_read_b64_tr_b16 v[158:159], v56 offset:512
K_DM1:
    ds_read_b64_tr_b16 v[160:161], v56 offset:2048
    s_mov_b32 s68, -1
    v_mfma_f32_32x32x16_bf16 v[124:139], v[180:183], v[76:79], v[124:139]
    buffer_load_dword v3, v52, s[20:23], s68 offen
    ds_read_b64_tr_b16 v[162:163], v56 offset:2560
    ds_read_b64_tr_b16 v[164:165], v57 offset:0
    v_mfma_f32_32x32x16_bf16 v[108:123], v[176:179], v[80:83], v[108:123]
    buffer_load_dword v3, v52, s[20:23], s68 offen
    ds_read_b64_tr_b16 v[166:167], v57 offset:512
    ds_read_b64_tr_b16 v[168:169], v57 offset:2048
    ds_read_b64_tr_b16 v[170:171], v57 offset:2560
    v_mfma_f32_32x32x16_bf16 v[124:139], v[184:187], v[80:83], v[124:139]
    s_waitcnt vmcnt(8) lgkmcnt(8)
    v_cmp_u_f32 vcc, v84, v88
    v_and_or_b32 v56, s72, v53, v54
    v_and_or_b32 v57, s72, v53, v55
    v_mov_b32 v68, -1
    s_cbranch_vccnz K_FX2
K_DR2:
    v_mfma_f32_32x32x16_bf16 v[108:123], v[140:143], v[84:87], v[108:123]
    ds_read_b64_tr_b16 v[172:173], v56 offset:0
    ds_read_b64_tr_b16 v[174:175], v56 offset:512
K_DM2:
    ds_read_b64_tr_b16 v[176:177], v56 offset:2048
    s_mov_b32 s69, -1
    v_mfma_f32_32x32x16_bf16 v[124:139], v[148:151], v[84:87], v[124:139]
    buffer_load_dword v3, v52, s[20:23], s69 offen
    ds_read_b64_tr_b16 v[178:179], v56 offset:2560
    ds_read_b64_tr_b16 v[180:181], v57 offset:0
    v_mfma_f32_32x32x16_bf16 v[108:123], v[144:147], v[88:91], v[108:123]
    buffer_load_dword v3, v52, s[20:23], s69 offen
    ds_read_b64_tr_b16 v[182:183], v57 offset:512
    ds_read_b64_tr_b16 v[184:185], v57 offset:2048
    ds_read_b64_tr_b16 v[186:187], v57 offset:2560
    v_mfma_f32_32x32x16_bf16 v[124:139], v[152:155], v[88:91], v[124:139]
    s_waitcnt vmcnt(8) lgkmcnt(8)
    v_cmp_u_f32 vcc, v92, v96
    v_and_or_b32 v56, s67, v53, v54
    v_and_or_b32 v57, s67, v53, v55
    v_mov_b32 v76, -1
    s_cbranch_vccnz K_FX3
K_DR3:
    v_mfma_f32_32x32x16_bf16 v[108:123], v[156:159], v[92:95], v[108:123]
    ds_read_b64_tr_b16 v[140:141], v56 offset:0
    ds_read_b64_tr_b16 v[142:143], v56 offset:512
K_DM3:
    ds_read_b64_tr_b16 v[144:145], v56 offset:2048
    s_mov_b32 s70, -1
    v_mfma_f32_32x32x16_bf16 v[124:139], v[164:167], v[92:95], v[124:139]
    buffer_load_dword v3, v52, s[20:23], s70 offen
    ds_read_b64_tr_b16 v[146:147], v56 offset:2560
    ds_read_b64_tr_b16 v[148:149], v57 offset:0
    v_mfma_f32_32x32x16_bf16 v[108:123], v[160:163], v[96:99], v[108:123]
    buffer_load_dword v3, v52, s[20:23], s70 offen
    ds_read_b64_tr_b16 v[150:151], v57 offset:512
    ds_read_b64_tr_b16 v[152:153], v57 offset:2048
    ds_read_b64_tr_b16 v[154:155], v57 offset:2560
    v_mfma_f32_32x32x16_bf16 v[124:139], v[168:171], v[96:99], v[124:139]
    s_waitcnt vmcnt(8) lgkmcnt(8)
    v_cmp_u_f32 vcc, v100, v104
    v_and_or_b32 v56, s68, v53, v54
    v_and_or_b32 v57, s68, v53, v55
    v_mov_b32 v84, -1
    s_cbranch_vccnz K_FX4
K_DR4:
    v_mfma_f32_32x32x16_bf16 v[108:123], v[172:175], v[100:103], v[108:123]
    ds_read_b64_tr_b16 v[156:157], v56 offset:0
    ds_read_b64_tr_b16 v[158:159], v56 offset:512
K_DM4:
    ds_read_b64_tr_b16 v[160:161], v56 offset:2048
    s_mov_b32 s71, -1
    v_mfma_f32_32x32x16_bf16 v[124:139], v[180:183], v[100:103], v[124:139]
    buffer_load_dword v3, v52, s[20:23], s71 offen
    ds_read_b64_tr_b16 v[162:163], v56 offset:2560
    ds_read_b64_tr_b16 v[164:165], v57 offset:0
    v_mfma_f32_32x32x16_bf16 v[108:123], v[176:179], v[104:107], v[108:123]
    buffer_load_dword v3, v52, s[20:23], s71 offen
    ds_read_b64_tr_b16 v[166:167], v57 offset:512
    ds_read_b64_tr_b16 v[168:169], v57 offset:2048
    ds_read_b64_tr_b16 v[170:171], v57 offset:2560
    v_mfma_f32_32x32x16_bf16 v[124:139], v[184:187], v[104:107], v[124:139]
    s_waitcnt vmcnt(8) lgkmcnt(8)
    v_cmp_u_f32 vcc, v60, v64
    v_and_or_b32 v56, s69, v53, v54
    v_and_or_b32 v57, s69, v53, v55
    v_mov_b32 v92, -1
    s_cbranch_vccnz K_FX5
K_DR5:
    v_mfma_f32_32x32x16_bf16 v[108:123], v[140:143], v[60:63], v[108:123]
    ds_read_b64_tr_b16 v[172:173], v56 offset:0
    ds_read_b64_tr_b16 v[174:175], v56 offset:512
K_DM5:
    ds_read_b64_tr_b16 v[176:177], v56 offset:2048
    s_mov_b32 s72, -1
    v_mfma_f32_32x32x16_bf16 v[124:139], v[148:151], v[60:63], v[124:139]
    buffer_load_dword v3, v52, s[20:23], s72 offen
    ds_read_b64_tr_b16 v[178:179], v56 offset:2560
    ds_read_b64_tr_b16 v[180:181], v57 offset:0
    v_mfma_f32_32x32x16_bf16 v[108:123], v[144:147], v[64:67], v[108:123]
    buffer_load_dword v3, v52, s[20:23], s72 offen
    ds_read_b64_tr_b16 v[182:183], v57 offset:512
    ds_read_b64_tr_b16 v[184:185], v57 offset:2048
    ds_read_b64_tr_b16 v[186:187], v57 offset:2560
    v_mfma_f32_32x32x16_bf16 v[124:139], v[152:155], v[64:67], v[124:139]
    s_waitcnt vmcnt(8) lgkmcnt(8)
    v_cmp_u_f32 vcc, v68, v72
    v_and_or_b32 v56, s70, v53, v54
    v_and_or_b32 v57, s70, v53, v55
    v_mov_b32 v100, -1
    s_cbranch_vccnz K_FX0
    s_branch K_DR0
K_STM21:
    s_branch K_STM25
K_CHA3:
K_STA21:
    s_branch K_STA25
K_RF0:
    s_cmp_eq_u32 s73, 0
    s_cbranch_scc1 K_DM0
    ds_read_b32 v59, v58
    s_waitcnt lgkmcnt(0)
    v_readfirstlane_b32 s58, v59
    s_and_b32 s33, s58, s73
    s_cbranch_scc1 K_RB0
K_NV0:
    ds_read_b64_tr_b16 v[144:145], v56 offset:2048
    v_mfma_f32_32x32x16_bf16 v[124:139], v[164:167], v[68:71], v[124:139]
    s_mov_b32 s67, -1
    v_mov_b32 v60, -1
    buffer_load_dword v3, v52, s[20:23], s67 offen
    ds_read_b64_tr_b16 v[146:147], v56 offset:2560
    ds_read_b64_tr_b16 v[148:149], v57 offset:0
    v_mfma_f32_32x32x16_bf16 v[108:123], v[160:163], v[72:75], v[108:123]
    buffer_load_dword v3, v52, s[20:23], s67 offen
    ds_read_b64_tr_b16 v[150:151], v57 offset:512
    ds_read_b64_tr_b16 v[152:153], v57 offset:2048
    ds_read_b64_tr_b16 v[154:155], v57 offset:2560
    v_mfma_f32_32x32x16_bf16 v[124:139], v[168:171], v[72:75], v[124:139]
    s_branch K_TL0
K_FX0:
    s_cmp_lt_i32 s68, 0
    s_cbranch_scc1 K_SK0
    v_max_u32 v2, v68, v72
    v_cmp_eq_u32 vcc, -1, v2
    s_cbranch_vccz K_IT0
    s_sub_u32 s74, s74, 1
    s_cbranch_scc1 K_IT0
    s_lshr_b32 s59, s68, 12
    s_bitset1_b32 s73, s59
K_SK0:
    s_and_b32 s33, s58, s73
    s_cbranch_scc0 K_NUL0
K_BK0:
    s_ff1_i32_b32 s59, s33
    s_lshl_b32 s67, s59, 12
    buffer_load_dwordx4 v[60:63], v52, s[20:23], s67 offen offset:0 sc1
    buffer_load_dwordx4 v[64:67], v52, s[20:23], s67 offen offset:512 sc1
    s_bitset0_b32 s73, s59
K_RD0:
    ds_read_b64_tr_b16 v[140:141], v56 offset:0
    ds_read_b64_tr_b16 v[142:143], v56 offset:512
    ds_read_b64_tr_b16 v[144:145], v56 offset:2048
    ds_read_b64_tr_b16 v[146:147], v56 offset:2560
    ds_read_b64_tr_b16 v[148:149], v57 offset:0
    ds_read_b64_tr_b16 v[150:151], v57 offset:512
    ds_read_b64_tr_b16 v[152:153], v57 offset:2048
    ds_read_b64_tr_b16 v[154:155], v57 offset:2560
    s_cmp_lt_i32 s69, 0
    s_cbranch_scc0 K_TL0
    v_and_or_b32 v56, s71, v53, v54
    v_and_or_b32 v57, s71, v53, v55
    s_branch K_SK1
K_NUL0:
    s_and_b32 s59, s69, s70
    s_and_b32 s59, s59, s71
    s_and_b32 s59, s59, s72
    s_cmp_lt_i32 s59, 0
    s_cbranch_scc0 K_PC0
    s_cmp_eq_u32 s73, 0
    s_cbranch_scc1 K_P2_MM
K_SPN0:
    ds_read_b32 v59, v58
    s_waitcnt lgkmcnt(0)
    v_readfirstlane_b32 s58, v59
    s_and_b32 s33, s58, s73
    s_cbranch_scc1 K_BK0
    s_sleep 1
    s_branch K_SPN0
K_PC0:
    s_cmp_eq_u32 s73, 0
    s_cbranch_scc1 K_NI0
    ds_read_b32 v59, v58
    s_waitcnt lgkmcnt(0)
    v_readfirstlane_b32 s58, v59
    s_and_b32 s33, s58, s73
    s_cbranch_scc1 K_BK0
    ds_read_b32 v59, v58
    s_waitcnt lgkmcnt(0)
    v_readfirstlane_b32 s58, v59
    s_and_b32 s33, s58, s73
    s_cbranch_scc1 K_BK0
K_NI0:
    s_mov_b32 s67, -1
    v_mov_b32 v60, -1
    buffer_load_dword v3, v52, s[20:23], s67 offen
    buffer_load_dword v3, v52, s[20:23], s67 offen
    s_branch K_RD0
K_RF1:
    s_cmp_eq_u32 s73, 0
    s_cbranch_scc1 K_DM1
    ds_read_b32 v59, v58
    s_waitcnt lgkmcnt(0)
    v_readfirstlane_b32 s58, v59
    s_and_b32 s33, s58, s73
    s_cbranch_scc1 K_RB1
K_NV1:
    ds_read_b64_tr_b16 v[160:161], v56 offset:2048
    v_mfma_f32_32x32x16_bf16 v[124:139], v[180:183], v[76:79], v[124:139]
    s_mov_b32 s68, -1
    v_mov_b32 v68, -1
    buffer_load_dword v3, v52, s[20:23], s68 offen
    ds_read_b64_tr_b16 v[162:163], v56 offset:2560
    ds_read_b64_tr_b16 v[164:165], v57 offset:0
    v_mfma_f32_32x32x16_bf16 v[108:123], v[176:179], v[80:83], v[108:123]
    buffer_load_dword v3, v52, s[20:23], s68 offen
    ds_read_b64_tr_b16 v[166:167], v57 offset:512
    ds_read_b64_tr_b16 v[168:169], v57 offset:2048
    ds_read_b64_tr_b16 v[170:171], v57 offset:2560
    v_mfma_f32_32x32x16_bf16 v[124:139], v[184:187], v[80:83], v[124:139]
    s_branch K_TL1
K_STM22:
    s_branch K_STM26
K_STA22:
    s_branch K_STA26
K_FX1:
    s_cmp_lt_i32 s69, 0
    s_cbranch_scc1 K_SK1
    v_max_u32 v2, v76, v80
    v_cmp_eq_u32 vcc, -1, v2
    s_cbranch_vccz K_IT1
    s_sub_u32 s74, s74, 1
    s_cbranch_scc1 K_IT1
    s_lshr_b32 s59, s69, 12
    s_bitset1_b32 s73, s59
K_SK1:
    s_and_b32 s33, s58, s73
    s_cbranch_scc0 K_NUL1
K_BK1:
    s_ff1_i32_b32 s59, s33
    s_lshl_b32 s68, s59, 12
    buffer_load_dwordx4 v[68:71], v52, s[20:23], s68 offen offset:0 sc1
    buffer_load_dwordx4 v[72:75], v52, s[20:23], s68 offen offset:512 sc1
    s_bitset0_b32 s73, s59
K_RD1:
    ds_read_b64_tr_b16 v[156:157], v56 offset:0
    ds_read_b64_tr_b16 v[158:159], v56 offset:512
    ds_read_b64_tr_b16 v[160:161], v56 offset:2048
    ds_read_b64_tr_b16 v[162:163], v56 offset:2560
    ds_read_b64_tr_b16 v[164:165], v57 offset:0
    ds_read_b64_tr_b16 v[166:167], v57 offset:512
    ds_read_b64_tr_b16 v[168:169], v57 offset:2048
    ds_read_b64_tr_b16 v[170:171], v57 offset:2560
    s_cmp_lt_i32 s70, 0
    s_cbranch_scc0 K_TL1
    v_and_or_b32 v56, s72, v53, v54
    v_and_or_b32 v57, s72, v53, v55
    s_branch K_SK2
K_NUL1:
    s_and_b32 s59, s67, s70
    s_and_b32 s59, s59, s71
    s_and_b32 s59, s59, s72
    s_cmp_lt_i32 s59, 0
    s_cbranch_scc0 K_PC1
    s_cmp_eq_u32 s73, 0
    s_cbranch_scc1 K_P2_MM
K_SPN1:
    ds_read_b32 v59, v58
    s_waitcnt lgkmcnt(0)
    v_readfirstlane_b32 s58, v59
    s_and_b32 s33, s58, s73
    s_cbranch_scc1 K_BK1
    s_sleep 1
    s_branch K_SPN1
K_PC1:
    s_cmp_eq_u32 s73, 0
    s_cbranch_scc1 K_NI1
    ds_read_b32 v59, v58
    s_waitcnt lgkmcnt(0)
    v_readfirstlane_b32 s58, v59
    s_and_b32 s33, s58, s73
    s_cbranch_scc1 K_BK1
    ds_read_b32 v59, v58
    s_waitcnt lgkmcnt(0)
    v_readfirstlane_b32 s58, v59
    s_and_b32 s33, s58, s73
    s_cbranch_scc1 K_BK1
K_NI1:
    s_mov_b32 s68, -1
    v_mov_b32 v68, -1
    buffer_load_dword v3, v52, s[20:23], s68 offen
    buffer_load_dword v3, v52, s[20:23], s68 offen
    s_branch K_RD1
K_RF2:
    s_cmp_eq_u32 s73, 0
    s_cbranch_scc1 K_DM2
    ds_read_b32 v59, v58
    s_waitcnt lgkmcnt(0)
    v_readfirstlane_b32 s58, v59
    s_and_b32 s33, s58, s73
    s_cbranch_scc1 K_RB2
K_NV2:
    ds_read_b64_tr_b16 v[176:177], v56 offset:2048
    v_mfma_f32_32x32x16_bf16 v[124:139], v[148:151], v[84:87], v[124:139]
    s_mov_b32 s69, -1
    v_mov_b32 v76, -1
    buffer_load_dword v3, v52, s[20:23], s69 offen
    ds_read_b64_tr_b16 v[178:179], v56 offset:2560
    ds_read_b64_tr_b16 v[180:181], v57 offset:0
    v_mfma_f32_32x32x16_bf16 v[108:123], v[144:147], v[88:91], v[108:123]
    buffer_load_dword v3, v52, s[20:23], s69 offen
    ds_read_b64_tr_b16 v[182:183], v57 offset:512
    ds_read_b64_tr_b16 v[184:185], v57 offset:2048
    ds_read_b64_tr_b16 v[186:187], v57 offset:2560
    v_mfma_f32_32x32x16_bf16 v[124:139], v[152:155], v[88:91], v[124:139]
    s_branch K_TL2
K_FX2:
    s_cmp_lt_i32 s70, 0
    s_cbranch_scc1 K_SK2
    v_max_u32 v2, v84, v88
    v_cmp_eq_u32 vcc, -1, v2
    s_cbranch_vccz K_IT2
    s_sub_u32 s74, s74, 1
    s_cbranch_scc1 K_IT2
    s_lshr_b32 s59, s70, 12
    s_bitset1_b32 s73, s59
K_SK2:
    s_and_b32 s33, s58, s73
    s_cbranch_scc0 K_NUL2
K_BK2:
    s_ff1_i32_b32 s59, s33
    s_lshl_b32 s69, s59, 12
    buffer_load_dwordx4 v[76:79], v52, s[20:23], s69 offen offset:0 sc1
    buffer_load_dwordx4 v[80:83], v52, s[20:23], s69 offen offset:512 sc1
    s_bitset0_b32 s73, s59
K_RD2:
    ds_read_b64_tr_b16 v[172:173], v56 offset:0
    ds_read_b64_tr_b16 v[174:175], v56 offset:512
    ds_read_b64_tr_b16 v[176:177], v56 offset:2048
    ds_read_b64_tr_b16 v[178:179], v56 offset:2560
    ds_read_b64_tr_b16 v[180:181], v57 offset:0
    ds_read_b64_tr_b16 v[182:183], v57 offset:512
    ds_read_b64_tr_b16 v[184:185], v57 offset:2048
    ds_read_b64_tr_b16 v[186:187], v57 offset:2560
    s_cmp_lt_i32 s71, 0
    s_cbranch_scc0 K_TL2
    v_and_or_b32 v56, s67, v53, v54
    v_and_or_b32 v57, s67, v53, v55
    s_branch K_SK3
K_STM23:
    s_branch K_STM27
K_STA23:
    s_branch K_STA27
K_NUL2:
    s_and_b32 s59, s67, s68
    s_and_b32 s59, s59, s71
    s_and_b32 s59, s59, s72
    s_cmp_lt_i32 s59, 0
    s_cbranch_scc0 K_PC2
    s_cmp_eq_u32 s73, 0
    s_cbranch_scc1 K_P2_MM
K_SPN2:
    ds_read_b32 v59, v58
    s_waitcnt lgkmcnt(0)
    v_readfirstlane_b32 s58, v59
    s_and_b32 s33, s58, s73
    s_cbranch_scc1 K_BK2
    s_sleep 1
    s_branch K_SPN2
K_PC2:
    s_cmp_eq_u32 s73, 0
    s_cbranch_scc1 K_NI2
    ds_read_b32 v59, v58
    s_waitcnt lgkmcnt(0)
    v_readfirstlane_b32 s58, v59
    s_and_b32 s33, s58, s73
    s_cbranch_scc1 K_BK2
    ds_read_b32 v59, v58
    s_waitcnt lgkmcnt(0)
    v_readfirstlane_b32 s58, v59
    s_and_b32 s33, s58, s73
    s_cbranch_scc1 K_BK2
K_NI2:
    s_mov_b32 s69, -1
    v_mov_b32 v76, -1
    s_branch K_PG4
.p2align 12
K_STM24:
    s_branch K_STM28
K_STA24:
    s_branch K_STA28
K_PG4:
    buffer_load_dword v3, v52, s[20:23], s69 offen
    buffer_load_dword v3, v52, s[20:23], s69 offen
    s_branch K_RD2
K_RF3:
    s_cmp_eq_u32 s73, 0
    s_cbranch_scc1 K_DM3
    ds_read_b32 v59, v58
    s_waitcnt lgkmcnt(0)
    v_readfirstlane_b32 s58, v59
    s_and_b32 s33, s58, s73
    s_cbranch_scc1 K_RB3
K_NV3:
    ds_read_b64_tr_b16 v[144:145], v56 offset:2048
    v_mfma_f32_32x32x16_bf16 v[124:139], v[164:167], v[92:95], v[124:139]
    s_mov_b32 s70, -1
    v_mov_b32 v84, -1
    buffer_load_dword v3, v52, s[20:23], s70 offen
    ds_read_b64_tr_b16 v[146:147], v56 offset:2560
    ds_read_b64_tr_b16 v[148:149], v57 offset:0
    v_mfma_f32_32x32x16_bf16 v[108:123], v[160:163], v[96:99], v[108:123]
    buffer_load_dword v3, v52, s[20:23], s70 offen
    ds_read_b64_tr_b16 v[150:151], v57 offset:512
    ds_read_b64_tr_b16 v[152:153], v57 offset:2048
    ds_read_b64_tr_b16 v[154:155], v57 offset:2560
    v_mfma_f32_32x32x16_bf16 v[124:139], v[168:171], v[96:99], v[124:139]
    s_branch K_TL3
K_FX3:
    s_cmp_lt_i32 s71, 0
    s_cbranch_scc1 K_SK3
    v_max_u32 v2, v92, v96
    v_cmp_eq_u32 vcc, -1, v2
    s_cbranch_vccz K_IT3
    s_sub_u32 s74, s74, 1
    s_cbranch_scc1 K_IT3
    s_lshr_b32 s59, s71, 12
    s_bitset1_b32 s73, s59
K_SK3:
    s_and_b32 s33, s58, s73
    s_cbranch_scc0 K_NUL3
K_BK3:
    s_ff1_i32_b32 s59, s33
    s_lshl_b32 s70, s59, 12
    buffer_load_dwordx4 v[84:87], v52, s[20:23], s70 offen offset:0 sc1
    buffer_load_dwordx4 v[88:91], v52, s[20:23], s70 offen offset:512 sc1
    s_bitset0_b32 s73, s59
K_RD3:
    ds_read_b64_tr_b16 v[140:141], v56 offset:0
    ds_read_b64_tr_b16 v[142:143], v56 offset:512
    ds_read_b64_tr_b16 v[144:145], v56 offset:2048
    ds_read_b64_tr_b16 v[146:147], v56 offset:2560
    ds_read_b64_tr_b16 v[148:149], v57 offset:0
    ds_read_b64_tr_b16 v[150:151], v57 offset:512
    ds_read_b64_tr_b16 v[152:153], v57 offset:2048
    ds_read_b64_tr_b16 v[154:155], v57 offset:2560
    s_cmp_lt_i32 s72, 0
    s_cbranch_scc0 K_TL3
    v_and_or_b32 v56, s68, v53, v54
    v_and_or_b32 v57, s68, v53, v55
    s_branch K_SK4
K_NUL3:
    s_and_b32 s59, s67, s68
    s_and_b32 s59, s59, s69
    s_and_b32 s59, s59, s72
    s_cmp_lt_i32 s59, 0
    s_cbranch_scc0 K_PC3
    s_cmp_eq_u32 s73, 0
    s_cbranch_scc1 K_P2_MM
K_SPN3:
    ds_read_b32 v59, v58
    s_waitcnt lgkmcnt(0)
    v_readfirstlane_b32 s58, v59
    s_and_b32 s33, s58, s73
    s_cbranch_scc1 K_BK3
    s_sleep 1
    s_branch K_SPN3
K_PC3:
    s_cmp_eq_u32 s73, 0
    s_cbranch_scc1 K_NI3
    ds_read_b32 v59, v58
    s_waitcnt lgkmcnt(0)
    v_readfirstlane_b32 s58, v59
    s_and_b32 s33, s58, s73
    s_cbranch_scc1 K_BK3
    ds_read_b32 v59, v58
    s_waitcnt lgkmcnt(0)
    v_readfirstlane_b32 s58, v59
    s_and_b32 s33, s58, s73
    s_cbranch_scc1 K_BK3
K_NI3:
    s_mov_b32 s70, -1
    v_mov_b32 v84, -1
    buffer_load_dword v3, v52, s[20:23], s70 offen
    buffer_load_dword v3, v52, s[20:23], s70 offen
    s_branch K_RD3
K_RF4:
    s_cmp_eq_u32 s73, 0
    s_cbranch_scc1 K_DM4
    ds_read_b32 v59, v58
    s_waitcnt lgkmcnt(0)
    v_readfirstlane_b32 s58, v59
    s_and_b32 s33, s58, s73
    s_cbranch_scc1 K_RB4
K_NV4:
    ds_read_b64_tr_b16 v[160:161], v56 offset:2048
    v_mfma_f32_32x32x16_bf16 v[124:139], v[180:183], v[100:103], v[124:139]
    s_mov_b32 s71, -1
    v_mov_b32 v92, -1
    buffer_load_dword v3, v52, s[20:23], s71 offen
    ds_read_b64_tr_b16 v[162:163], v56 offset:2560
    ds_read_b64_tr_b16 v[164:165], v57 offset:0
    v_mfma_f32_32x32x16_bf16 v[108:123], v[176:179], v[104:107], v[108:123]
    buffer_load_dword v3, v52, s[20:23], s71 offen
    ds_read_b64_tr_b16 v[166:167], v57 offset:512
    ds_read_b64_tr_b16 v[168:169], v57 offset:2048
    ds_read_b64_tr_b16 v[170:171], v57 offset:2560
    v_mfma_f32_32x32x16_bf16 v[124:139], v[184:187], v[104:107], v[124:139]
    s_branch K_TL4
K_STM25:
    s_branch K_STM29
K_STA25:
    s_branch K_STA29
K_FX4:
    s_cmp_lt_i32 s72, 0
    s_cbranch_scc1 K_SK4
    v_max_u32 v2, v100, v104
    v_cmp_eq_u32 vcc, -1, v2
    s_cbranch_vccz K_IT4
    s_sub_u32 s74, s74, 1
    s_cbranch_scc1 K_IT4
    s_lshr_b32 s59, s72, 12
    s_bitset1_b32 s73, s59
K_SK4:
    s_and_b32 s33, s58, s73
    s_cbranch_scc0 K_NUL4
K_BK4:
    s_ff1_i32_b32 s59, s33
    s_lshl_b32 s71, s59, 12
    buffer_load_dwordx4 v[92:95], v52, s[20:23], s71 offen offset:0 sc1
    buffer_load_dwordx4 v[96:99], v52, s[20:23], s71 offen offset:512 sc1
    s_bitset0_b32 s73, s59
K_RD4:
    ds_read_b64_tr_b16 v[156:157], v56 offset:0
    ds_read_b64_tr_b16 v[158:159], v56 offset:512
    ds_read_b64_tr_b16 v[160:161], v56 offset:2048
    ds_read_b64_tr_b16 v[162:163], v56 offset:2560
    ds_read_b64_tr_b16 v[164:165], v57 offset:0
    ds_read_b64_tr_b16 v[166:167], v57 offset:512
    ds_read_b64_tr_b16 v[168:169], v57 offset:2048
    ds_read_b64_tr_b16 v[170:171], v57 offset:2560
    s_cmp_lt_i32 s67, 0
    s_cbranch_scc0 K_TL4
    v_and_or_b32 v56, s69, v53, v54
    v_and_or_b32 v57, s69, v53, v55
    s_branch K_SK5
K_NUL4:
    s_and_b32 s59, s67, s68
    s_and_b32 s59, s59, s69
    s_and_b32 s59, s59, s70
    s_cmp_lt_i32 s59, 0
    s_cbranch_scc0 K_PC4
    s_cmp_eq_u32 s73, 0
    s_cbranch_scc1 K_P2_MM
K_SPN4:
    ds_read_b32 v59, v58
    s_waitcnt lgkmcnt(0)
    v_readfirstlane_b32 s58, v59
    s_and_b32 s33, s58, s73
    s_cbranch_scc1 K_BK4
    s_sleep 1
    s_branch K_SPN4
K_PC4:
    s_cmp_eq_u32 s73, 0
    s_cbranch_scc1 K_NI4
    ds_read_b32 v59, v58
    s_waitcnt lgkmcnt(0)
    v_readfirstlane_b32 s58, v59
    s_and_b32 s33, s58, s73
    s_cbranch_scc1 K_BK4
    ds_read_b32 v59, v58
    s_waitcnt lgkmcnt(0)
    v_readfirstlane_b32 s58, v59
    s_and_b32 s33, s58, s73
    s_cbranch_scc1 K_BK4
K_NI4:
    s_mov_b32 s71, -1
    v_mov_b32 v92, -1
    buffer_load_dword v3, v52, s[20:23], s71 offen
    buffer_load_dword v3, v52, s[20:23], s71 offen
    s_branch K_RD4
K_RF5:
    s_cmp_eq_u32 s73, 0
    s_cbranch_scc1 K_DM5
    ds_read_b32 v59, v58
    s_waitcnt lgkmcnt(0)
    v_readfirstlane_b32 s58, v59
    s_and_b32 s33, s58, s73
    s_cbranch_scc1 K_RB5
K_NV5:
    ds_read_b64_tr_b16 v[176:177], v56 offset:2048
    v_mfma_f32_32x32x16_bf16 v[124:139], v[148:151], v[60:63], v[124:139]
    s_mov_b32 s72, -1
    v_mov_b32 v100, -1
    buffer_load_dword v3, v52, s[20:23], s72 offen
    ds_read_b64_tr_b16 v[178:179], v56 offset:2560
    ds_read_b64_tr_b16 v[180:181], v57 offset:0
    v_mfma_f32_32x32x16_bf16 v[108:123], v[144:147], v[64:67], v[108:123]
    buffer_load_dword v3, v52, s[20:23], s72 offen
    ds_read_b64_tr_b16 v[182:183], v57 offset:512
    ds_read_b64_tr_b16 v[184:185], v57 offset:2048
    ds_read_b64_tr_b16 v[186:187], v57 offset:2560
    v_mfma_f32_32x32x16_bf16 v[124:139], v[152:155], v[64:67], v[124:139]
    s_branch K_TL5
K_FX5:
    s_cmp_lt_i32 s67, 0
    s_cbranch_scc1 K_SK5
    v_max_u32 v2, v60, v64
    v_cmp_eq_u32 vcc, -1, v2
    s_cbranch_vccz K_IT5
    s_sub_u32 s74, s74, 1
    s_cbranch_scc1 K_IT5
    s_lshr_b32 s59, s67, 12
    s_bitset1_b32 s73, s59
K_SK5:
    s_and_b32 s33, s58, s73
    s_cbranch_scc0 K_NUL5
K_BK5:
    s_ff1_i32_b32 s59, s33
    s_lshl_b32 s72, s59, 12
    buffer_load_dwordx4 v[100:103], v52, s[20:23], s72 offen offset:0 sc1
    buffer_load_dwordx4 v[104:107], v52, s[20:23], s72 offen offset:512 sc1
    s_bitset0_b32 s73, s59
K_RD5:
    ds_read_b64_tr_b16 v[172:173], v56 offset:0
    ds_read_b64_tr_b16 v[174:175], v56 offset:512
    ds_read_b64_tr_b16 v[176:177], v56 offset:2048
    ds_read_b64_tr_b16 v[178:179], v56 offset:2560
    ds_read_b64_tr_b16 v[180:181], v57 offset:0
    ds_read_b64_tr_b16 v[182:183], v57 offset:512
    ds_read_b64_tr_b16 v[184:185], v57 offset:2048
    ds_read_b64_tr_b16 v[186:187], v57 offset:2560
    s_cmp_lt_i32 s68, 0
    s_cbranch_scc0 K_TL5
    v_and_or_b32 v56, s70, v53, v54
    v_and_or_b32 v57, s70, v53, v55
    s_branch K_SK0
K_STM26:
    s_branch K_STM30
K_STA26:
    s_branch K_STA30
K_NUL5:
    s_and_b32 s59, s68, s69
    s_and_b32 s59, s59, s70
    s_and_b32 s59, s59, s71
    s_cmp_lt_i32 s59, 0
    s_cbranch_scc0 K_PC5
    s_cmp_eq_u32 s73, 0
    s_cbranch_scc1 K_P2_MM
K_SPN5:
    ds_read_b32 v59, v58
    s_waitcnt lgkmcnt(0)
    v_readfirstlane_b32 s58, v59
    s_and_b32 s33, s58, s73
    s_cbranch_scc1 K_BK5
    s_sleep 1
    s_branch K_SPN5
K_PC5:
    s_cmp_eq_u32 s73, 0
    s_cbranch_scc1 K_NI5
    ds_read_b32 v59, v58
    s_waitcnt lgkmcnt(0)
    v_readfirstlane_b32 s58, v59
    s_and_b32 s33, s58, s73
    s_cbranch_scc1 K_BK5
    ds_read_b32 v59, v58
    s_waitcnt lgkmcnt(0)
    v_readfirstlane_b32 s58, v59
    s_and_b32 s33, s58, s73
    s_cbranch_scc1 K_BK5
K_NI5:
    s_mov_b32 s72, -1
    v_mov_b32 v100, -1
    buffer_load_dword v3, v52, s[20:23], s72 offen
    buffer_load_dword v3, v52, s[20:23], s72 offen
    s_branch K_RD5
K_P2_MM:
    v_cvt_pk_bf16_f32 v188, v108, v109
    v_cvt_pk_bf16_f32 v189, v110, v111
    ds_write_b64 v50, v[188:189] offset:0
    v_cvt_pk_bf16_f32 v190, v112, v113
    v_cvt_pk_bf16_f32 v191, v114, v115
    ds_write_b64 v50, v[190:191] offset:16
    v_cvt_pk_bf16_f32 v192, v116, v117
    v_cvt_pk_bf16_f32 v193, v118, v119
    ds_write_b64 v50, v[192:193] offset:32
    v_cvt_pk_bf16_f32 v194, v120, v121
    v_cvt_pk_bf16_f32 v195, v122, v123
    ds_write_b64 v50, v[194:195] offset:48
    v_cvt_pk_bf16_f32 v188, v124, v125
    v_cvt_pk_bf16_f32 v189, v126, v127
    ds_write_b64 v50, v[188:189] offset:64
    v_cvt_pk_bf16_f32 v190, v128, v129
    v_cvt_pk_bf16_f32 v191, v130, v131
    ds_write_b64 v50, v[190:191] offset:80
    v_cvt_pk_bf16_f32 v192, v132, v133
    v_cvt_pk_bf16_f32 v193, v134, v135
    ds_write_b64 v50, v[192:193] offset:96
    v_cvt_pk_bf16_f32 v194, v136, v137
    v_cvt_pk_bf16_f32 v195, v138, v139
    ds_write_b64 v50, v[194:195] offset:112
K_P2_E2:
    s_waitcnt vmcnt(0) lgkmcnt(0)
    s_lshl_b32 s75, s53, 4
    s_barrier
    ds_read_b64 v[28:29], v15
    ds_read_b64 v[24:25], v11
    ds_read_b128 v[48:51], v14
    ds_read_b64 v[26:27], v11 offset:64
    ds_read_b128 v[52:55], v14 offset:1152
    s_waitcnt lgkmcnt(4)
    v_readfirstlane_b32 s56, v28
    v_readfirstlane_b32 s57, v29
    s_sub_u32 s3, s56, s75
    s_cmp_lt_u32 s3, 16
    s_cbranch_scc1 K_YROW0
K_NOY0:
    s_sub_u32 s3, s57, s75
    s_cmp_lt_u32 s3, 16
    s_cbranch_scc1 K_YROW1
K_NOY1:
    s_waitcnt lgkmcnt(3)
    v_pk_mul_f32 v[32:33], v[32:33], v[24:25] op_sel:[0,1] op_sel_hi:[1,1]
    v_pk_mul_f32 v[34:35], v[34:35], v[24:25] op_sel:[0,1] op_sel_hi:[1,1]
    v_pk_mul_f32 v[36:37], v[36:37], v[24:25] op_sel:[0,1] op_sel_hi:[1,1]
    v_pk_mul_f32 v[38:39], v[38:39], v[24:25] op_sel:[0,1] op_sel_hi:[1,1]
    s_waitcnt lgkmcnt(2)
    v_lshlrev_b32 v68, 16, v48
    v_and_b32 v69, 0xffff0000, v48
    v_pk_fma_f32 v[68:69], v[68:69], v[24:25], v[32:33] op_sel_hi:[1,0,1]
    v_cvt_pk_bf16_f32 v48, v68, v69
    v_lshlrev_b32 v70, 16, v49
    v_and_b32 v71, 0xffff0000, v49
    v_pk_fma_f32 v[70:71], v[70:71], v[24:25], v[34:35] op_sel_hi:[1,0,1]
    v_cvt_pk_bf16_f32 v49, v70, v71
    v_lshlrev_b32 v68, 16, v50
    v_and_b32 v69, 0xffff0000, v50
    v_pk_fma_f32 v[68:69], v[68:69], v[24:25], v[36:37] op_sel_hi:[1,0,1]
    v_cvt_pk_bf16_f32 v50, v68, v69
    v_lshlrev_b32 v70, 16, v51
    v_and_b32 v71, 0xffff0000, v51
    v_pk_fma_f32 v[70:71], v[70:71], v[24:25], v[38:39] op_sel_hi:[1,0,1]
    v_cvt_pk_bf16_f32 v51, v70, v71
    buffer_store_dwordx4 v[48:51], v10, s[48:51], 0 offen sc1
    s_waitcnt lgkmcnt(1)
    v_pk_mul_f32 v[40:41], v[40:41], v[26:27] op_sel:[0,1] op_sel_hi:[1,1]
    v_pk_mul_f32 v[42:43], v[42:43], v[26:27] op_sel:[0,1] op_sel_hi:[1,1]
    v_pk_mul_f32 v[44:45], v[44:45], v[26:27] op_sel:[0,1] op_sel_hi:[1,1]
    v_pk_mul_f32 v[46:47], v[46:47], v[26:27] op_sel:[0,1] op_sel_hi:[1,1]
    s_waitcnt lgkmcnt(0)
    v_lshlrev_b32 v68, 16, v52
    v_and_b32 v69, 0xffff0000, v52
    v_pk_fma_f32 v[68:69], v[68:69], v[26:27], v[40:41] op_sel_hi:[1,0,1]
    v_cvt_pk_bf16_f32 v52, v68, v69
    v_lshlrev_b32 v70, 16, v53
    v_and_b32 v71, 0xffff0000, v53
    v_pk_fma_f32 v[70:71], v[70:71], v[26:27], v[42:43] op_sel_hi:[1,0,1]
    v_cvt_pk_bf16_f32 v53, v70, v71
    v_lshlrev_b32 v68, 16, v54
    v_and_b32 v69, 0xffff0000, v54
    v_pk_fma_f32 v[68:69], v[68:69], v[26:27], v[44:45] op_sel_hi:[1,0,1]
    v_cvt_pk_bf16_f32 v54, v68, v69
    v_lshlrev_b32 v70, 16, v55
    v_and_b32 v71, 0xffff0000, v55
    v_pk_fma_f32 v[70:71], v[70:71], v[26:27], v[46:47] op_sel_hi:[1,0,1]
    v_cvt_pk_bf16_f32 v55, v70, v71
    buffer_store_dwordx4 v[52:55], v10, s[48:51], s55 offen sc1
K_END:
K_EXIT:
    s_endpgm
K_YROW0:
    v_and_b32 v2, 7, v1
    v_lshlrev_b32 v2, 5, v2
    v_add_u32 v2, 158976, v2
    ds_read_b128 v[56:59], v2
    ds_read_b128 v[60:63], v2 offset:16
    s_and_b32 s33, s3, 7
    v_cmp_eq_u32 vcc, s33, v8
    s_cmp_ge_u32 s3, 8
    s_cbranch_scc1 K_YR1_0
    s_waitcnt lgkmcnt(0)
    v_add_f32 v64, v32, v56
    v_cvt_pk_bf16_f32 v64, v64, v64
    v_lshlrev_b32 v64, 16, v64
    v_cndmask_b32 v32, v32, v64, vcc
    v_add_f32 v65, v33, v57
    v_cvt_pk_bf16_f32 v65, v65, v65
    v_lshlrev_b32 v65, 16, v65
    v_cndmask_b32 v33, v33, v65, vcc
    v_add_f32 v66, v34, v58
    v_cvt_pk_bf16_f32 v66, v66, v66
    v_lshlrev_b32 v66, 16, v66
    v_cndmask_b32 v34, v34, v66, vcc
    v_add_f32 v67, v35, v59
    v_cvt_pk_bf16_f32 v67, v67, v67
    v_lshlrev_b32 v67, 16, v67
    v_cndmask_b32 v35, v35, v67, vcc
    v_add_f32 v64, v36, v60
    v_cvt_pk_bf16_f32 v64, v64, v64
    v_lshlrev_b32 v64, 16, v64
    v_cndmask_b32 v36, v36, v64, vcc
    v_add_f32 v65, v37, v61
    v_cvt_pk_bf16_f32 v65, v65, v65
    v_lshlrev_b32 v65, 16, v65
    v_cndmask_b32 v37, v37, v65, vcc
    v_add_f32 v66, v38, v62
    v_cvt_pk_bf16_f32 v66, v66, v66
    v_lshlrev_b32 v66, 16, v66
    v_cndmask_b32 v38, v38, v66, vcc
    v_add_f32 v67, v39, v63
    v_cvt_pk_bf16_f32 v67, v67, v67
    s_branch K_J587c
K_STM27:
    s_branch K_STM31
K_STA27:
    s_branch K_STA31
K_J587c:
    v_lshlrev_b32 v67, 16, v67
    v_cndmask_b32 v39, v39, v67, vcc
    s_branch K_NOY0
K_YR1_0:
    s_waitcnt lgkmcnt(0)
    v_add_f32 v64, v40, v56
    v_cvt_pk_bf16_f32 v64, v64, v64
    v_lshlrev_b32 v64, 16, v64
    v_cndmask_b32 v40, v40, v64, vcc
    v_add_f32 v65, v41, v57
    v_cvt_pk_bf16_f32 v65, v65, v65
    v_lshlrev_b32 v65, 16, v65
    v_cndmask_b32 v41, v41, v65, vcc
    v_add_f32 v66, v42, v58
    v_cvt_pk_bf16_f32 v66, v66, v66
    v_lshlrev_b32 v66, 16, v66
    v_cndmask_b32 v42, v42, v66, vcc
    v_add_f32 v67, v43, v59
    v_cvt_pk_bf16_f32 v67, v67, v67
    v_lshlrev_b32 v67, 16, v67
    v_cndmask_b32 v43, v43, v67, vcc
    v_add_f32 v64, v44, v60
    v_cvt_pk_bf16_f32 v64, v64, v64
    v_lshlrev_b32 v64, 16, v64
    v_cndmask_b32 v44, v44, v64, vcc
    v_add_f32 v65, v45, v61
    v_cvt_pk_bf16_f32 v65, v65, v65
    v_lshlrev_b32 v65, 16, v65
    v_cndmask_b32 v45, v45, v65, vcc
    v_add_f32 v66, v46, v62
    v_cvt_pk_bf16_f32 v66, v66, v66
    v_lshlrev_b32 v66, 16, v66
    v_cndmask_b32 v46, v46, v66, vcc
    v_add_f32 v67, v47, v63
    v_cvt_pk_bf16_f32 v67, v67, v67
    v_lshlrev_b32 v67, 16, v67
    v_cndmask_b32 v47, v47, v67, vcc
    s_branch K_NOY0
K_YROW1:
    v_and_b32 v2, 7, v1
    v_lshlrev_b32 v2, 5, v2
    v_add_u32 v2, 159232, v2
    ds_read_b128 v[56:59], v2
    ds_read_b128 v[60:63], v2 offset:16
    s_and_b32 s33, s3, 7
    v_cmp_eq_u32 vcc, s33, v8
    s_cmp_ge_u32 s3, 8
    s_cbranch_scc1 K_YR1_1
    s_waitcnt lgkmcnt(0)
    v_add_f32 v64, v32, v56
    v_cvt_pk_bf16_f32 v64, v64, v64
    v_lshlrev_b32 v64, 16, v64
    v_cndmask_b32 v32, v32, v64, vcc
    v_add_f32 v65, v33, v57
    v_cvt_pk_bf16_f32 v65, v65, v65
    v_lshlrev_b32 v65, 16, v65
    v_cndmask_b32 v33, v33, v65, vcc
    v_add_f32 v66, v34, v58
    v_cvt_pk_bf16_f32 v66, v66, v66
    v_lshlrev_b32 v66, 16, v66
    v_cndmask_b32 v34, v34, v66, vcc
    v_add_f32 v67, v35, v59
    v_cvt_pk_bf16_f32 v67, v67, v67
    v_lshlrev_b32 v67, 16, v67
    v_cndmask_b32 v35, v35, v67, vcc
    v_add_f32 v64, v36, v60
    v_cvt_pk_bf16_f32 v64, v64, v64
    v_lshlrev_b32 v64, 16, v64
    v_cndmask_b32 v36, v36, v64, vcc
    v_add_f32 v65, v37, v61
    v_cvt_pk_bf16_f32 v65, v65, v65
    v_lshlrev_b32 v65, 16, v65
    v_cndmask_b32 v37, v37, v65, vcc
    v_add_f32 v66, v38, v62
    v_cvt_pk_bf16_f32 v66, v66, v66
    v_lshlrev_b32 v66, 16, v66
    v_cndmask_b32 v38, v38, v66, vcc
    v_add_f32 v67, v39, v63
    v_cvt_pk_bf16_f32 v67, v67, v67
    v_lshlrev_b32 v67, 16, v67
    v_cndmask_b32 v39, v39, v67, vcc
    s_branch K_NOY1
K_YR1_1:
    s_waitcnt lgkmcnt(0)
    v_add_f32 v64, v40, v56
    v_cvt_pk_bf16_f32 v64, v64, v64
    v_lshlrev_b32 v64, 16, v64
    v_cndmask_b32 v40, v40, v64, vcc
    v_add_f32 v65, v41, v57
    v_cvt_pk_bf16_f32 v65, v65, v65
    v_lshlrev_b32 v65, 16, v65
    v_cndmask_b32 v41, v41, v65, vcc
    v_add_f32 v66, v42, v58
    v_cvt_pk_bf16_f32 v66, v66, v66
    v_lshlrev_b32 v66, 16, v66
    v_cndmask_b32 v42, v42, v66, vcc
    v_add_f32 v67, v43, v59
    v_cvt_pk_bf16_f32 v67, v67, v67
    v_lshlrev_b32 v67, 16, v67
    v_cndmask_b32 v43, v43, v67, vcc
    v_add_f32 v64, v44, v60
    v_cvt_pk_bf16_f32 v64, v64, v64
    v_lshlrev_b32 v64, 16, v64
    v_cndmask_b32 v44, v44, v64, vcc
    v_add_f32 v65, v45, v61
    v_cvt_pk_bf16_f32 v65, v65, v65
    v_lshlrev_b32 v65, 16, v65
    v_cndmask_b32 v45, v45, v65, vcc
    v_add_f32 v66, v46, v62
    v_cvt_pk_bf16_f32 v66, v66, v66
    v_lshlrev_b32 v66, 16, v66
    v_cndmask_b32 v46, v46, v66, vcc
    v_add_f32 v67, v47, v63
    v_cvt_pk_bf16_f32 v67, v67, v67
    v_lshlrev_b32 v67, 16, v67
    v_cndmask_b32 v47, v47, v67, vcc
    s_branch K_NOY1
K_STM28:
    s_branch K_STM32
K_STA28:
    s_branch K_STA32
K_P2:
    s_cmp_ge_u32 s30, 4
    s_cbranch_scc1 K_P2_HELP
    s_lshl_b32 s54, s40, 7
    v_lshrrev_b32 v8, 3, v1
    v_lshrrev_b32 v9, 4, v1
    v_mov_b32 v15, 158720
    s_lshl_b32 s53, s40, 3
    s_add_u32 s53, s53, s30
    s_mul_i32 s3, s53, 20480
    s_lshl_b32 s33, s41, 7
    s_add_u32 s3, s3, s33
    v_and_b32 v2, 7, v1
    v_lshlrev_b32 v2, 4, v2
    v_mul_u32_u24 v4, 1280, v8
    v_add3_u32 v10, v2, v4, s3
    s_lshl_b32 s3, s30, 7
    s_add_u32 s3, s3, 159744
    v_lshl_add_u32 v11, v8, 3, s3
    s_mov_b32 s55, 10240
    s_add_u32 s20, s6, 0x100000
    s_addc_u32 s21, s7, 0
    s_mov_b32 s22, 0x280000
    s_mov_b32 s23, 0x20000
    s_mov_b32 s48, s10
    s_mov_b32 s49, s11
    s_mov_b32 s50, 0x280000
    s_mov_b32 s51, 0x20000
    v_mul_u32_u24 v3, 144, v8
    v_add_u32 v3, v2, v3
    s_mul_i32 s3, s30, 2304
    s_add_u32 s3, s3, 140288
    v_add_u32 v14, s3, v3
    buffer_load_dwordx4 v[16:19], v10, s[12:15], 0 offen
    buffer_load_dwordx4 v[20:23], v10, s[12:15], s55 offen
    v_bfe_u32 v48, v1, 2, 2
    v_and_b32 v49, 3, v1
    s_add_u32 s3, s53, s30
    s_lshr_b32 s33, s3, 2
    s_mul_i32 s33, s33, 76
    s_add_u32 s3, s3, s33
    s_lshl_b32 s3, s3, 10
    v_and_b32 v2, 15, v1
    v_lshl_add_u32 v2, v2, 4, s3
    v_lshrrev_b32 v3, 5, v1
    v_lshl_add_u32 v2, v3, 8, v2
    v_and_b32 v4, 1, v9
    v_lshl_add_u32 v52, v4, 10, v2
    v_mov_b32 v53, 0x1f000
    v_lshl_add_u32 v2, v3, 3, v48
    v_lshlrev_b32 v2, 7, v2
    v_lshl_add_u32 v2, v49, 3, v2
    v_lshl_add_u32 v2, v4, 5, v2
    v_lshrrev_b32 v4, 1, v48
    v_lshl_add_u32 v54, v4, 6, v2
    v_xor_b32 v55, 64, v54
    v_mov_b32 v56, v54
    v_mov_b32 v57, v54
    v_and_b32 v2, 31, v1
    v_mul_u32_u24 v2, 144, v2
    v_lshl_add_u32 v2, v3, 3, v2
    s_mul_i32 s3, s30, 4608
    s_add_u32 s3, s3, 140288
    v_add_u32 v50, s3, v2
    s_lshl_b32 s3, s40, 3
    s_mul_i32 s33, s3, 187
    s_lshr_b32 s33, s33, 11
    s_add_u32 s33, s33, 1
    s_mul_i32 s33, s33, 11
    s_add_u32 s3, s53, s30
    s_add_u32 s3, s3, 1
    s_cmp_ge_u32 s3, s33
    s_cselect_b32 s52, 24, 16
    s_cmp_gt_u32 s3, s33
    s_cselect_b32 s52, 20, s52
    v_add_u32 v58, s52, v15
    s_mov_b32 s67, -1
    s_mov_b32 s68, -1
    s_mov_b32 s69, -1
    s_mov_b32 s70, -1
    s_mov_b32 s71, -1
    s_mov_b32 s72, -1
    s_mov_b32 s73, 0xfffff
    s_mov_b32 s74, 131072
    v_mov_b32 v108, 0
    v_mov_b32 v109, 0
    v_mov_b32 v110, 0
    v_mov_b32 v111, 0
    v_mov_b32 v112, 0
    v_mov_b32 v113, 0
    v_mov_b32 v114, 0
    v_mov_b32 v115, 0
    v_mov_b32 v116, 0
    v_mov_b32 v117, 0
    v_mov_b32 v118, 0
    v_mov_b32 v119, 0
    v_mov_b32 v120, 0
    v_mov_b32 v121, 0
    v_mov_b32 v122, 0
    v_mov_b32 v123, 0
    v_mov_b32 v124, 0
    v_mov_b32 v125, 0
    v_mov_b32 v126, 0
    v_mov_b32 v127, 0
    v_mov_b32 v128, 0
    v_mov_b32 v129, 0
    v_mov_b32 v130, 0
    v_mov_b32 v131, 0
    v_mov_b32 v132, 0
    v_mov_b32 v133, 0
    v_mov_b32 v134, 0
    v_mov_b32 v135, 0
    v_mov_b32 v136, 0
    v_mov_b32 v137, 0
    v_mov_b32 v138, 0
    v_mov_b32 v139, 0
K_P2_AUXW:
    v_lshrrev_b32 v2, 3, v1
    v_mul_u32_u24 v2, 1280, v2
    v_lshrrev_b32 v3, 2, v1
    v_and_b32 v3, 4, v3
    v_and_b32 v4, 7, v1
    v_xor_b32 v3, v3, v4
    v_lshl_add_u32 v2, v3, 4, v2
    s_lshl_b32 s33, s41, 7
    v_add_u32 v51, s33, v2
    v_lshrrev_b32 v5, 5, v1
    v_mul_u32_u24 v5, 20480, v5
    v_add_u32 v5, v5, v51
    s_lshl_b32 s60, s30, 2
    s_lshr_b32 s60, 0x7520, s60
    s_and_b32 s60, s60, 7
    s_mul_i32 s60, s60, 51200
    s_lshl_b32 s61, s30, 12
    s_add_u32 s52, s60, 0
    s_add_u32 m0, s61, 0
    s_waitcnt vmcnt(5)
    buffer_load_dwordx4 v51, s[24:27], s52 offen lds
    s_add_u32 s52, s60, 10240
    s_add_u32 m0, s61, 1024
    s_waitcnt vmcnt(5)
    buffer_load_dwordx4 v51, s[24:27], s52 offen lds
    s_add_u32 s52, s60, 25600
    s_add_u32 m0, s61, 2048
    s_waitcnt vmcnt(5)
    buffer_load_dwordx4 v51, s[24:27], s52 offen lds
    s_add_u32 s52, s60, 35840
    s_add_u32 m0, s61, 3072
    s_waitcnt vmcnt(5)
    buffer_load_dwordx4 v51, s[24:27], s52 offen lds
    s_add_u32 s52, s60, 409600
    s_add_u32 m0, s61, 20480
    s_waitcnt vmcnt(5)
    buffer_load_dwordx4 v51, s[24:27], s52 offen lds
    s_add_u32 s52, s60, 419840
    s_add_u32 m0, s61, 21504
    s_waitcnt vmcnt(5)
    buffer_load_dwordx4 v51, s[24:27], s52 offen lds
    v_mov_b32 v3, 1
    s_mov_b64 exec, 1
    ds_add_u32 v15, v3 offset:52
    s_mov_b64 exec, -1
    s_add_u32 s52, s60, 435200
    s_add_u32 m0, s61, 22528
    s_waitcnt vmcnt(5)
    buffer_load_dwordx4 v51, s[24:27], s52 offen lds
    s_add_u32 s52, s60, 445440
    s_add_u32 m0, s61, 23552
    s_waitcnt vmcnt(5)
    buffer_load_dwordx4 v51, s[24:27], s52 offen lds
    s_lshl_b32 s61, s30, 10
    s_add_u32 s52, s60, 20480
    s_add_u32 m0, s61, 16384
    s_waitcnt vmcnt(5)
    buffer_load_dwordx4 v5, s[24:27], s52 offen lds
    s_branch K_J5e7c
K_STM29:
    s_branch K_STM33
K_STA29:
    s_branch K_STA33
K_J5e7c:
    s_add_u32 s52, s60, 430080
    s_add_u32 m0, s61, 36864
    s_waitcnt vmcnt(5)
    buffer_load_dwordx4 v5, s[24:27], s52 offen lds
    s_lshl_b32 s60, s30, 2
    s_lshr_b32 s60, 0x6431, s60
    s_and_b32 s60, s60, 7
    s_mul_i32 s60, s60, 51200
    s_lshl_b32 s61, s30, 12
    s_add_u32 s52, s60, 0
    s_add_u32 m0, s61, 40960
    s_waitcnt vmcnt(5)
    buffer_load_dwordx4 v51, s[24:27], s52 offen lds
    s_add_u32 s52, s60, 10240
    s_add_u32 m0, s61, 41984
    s_waitcnt vmcnt(5)
    buffer_load_dwordx4 v51, s[24:27], s52 offen lds
    s_add_u32 s52, s60, 25600
    s_add_u32 m0, s61, 43008
    s_waitcnt vmcnt(5)
    buffer_load_dwordx4 v51, s[24:27], s52 offen lds
    s_add_u32 s52, s60, 35840
    s_add_u32 m0, s61, 44032
    s_waitcnt vmcnt(5)
    buffer_load_dwordx4 v51, s[24:27], s52 offen lds
    s_add_u32 s52, s60, 409600
    s_add_u32 m0, s61, 61440
    s_waitcnt vmcnt(5)
    buffer_load_dwordx4 v51, s[24:27], s52 offen lds
    s_add_u32 s52, s60, 419840
    s_add_u32 m0, s61, 62464
    s_waitcnt vmcnt(5)
    buffer_load_dwordx4 v51, s[24:27], s52 offen lds
    s_add_u32 s52, s60, 435200
    s_add_u32 m0, s61, 63488
    s_waitcnt vmcnt(5)
    buffer_load_dwordx4 v51, s[24:27], s52 offen lds
    s_add_u32 s52, s60, 445440
    s_add_u32 m0, s61, 64512
    s_waitcnt vmcnt(5)
    buffer_load_dwordx4 v51, s[24:27], s52 offen lds
    s_lshl_b32 s61, s30, 10
    s_add_u32 s52, s60, 20480
    s_add_u32 m0, s61, 57344
    s_waitcnt vmcnt(5)
    buffer_load_dwordx4 v5, s[24:27], s52 offen lds
    s_add_u32 s52, s60, 430080
    s_add_u32 m0, s61, 77824
    s_waitcnt vmcnt(5)
    buffer_load_dwordx4 v5, s[24:27], s52 offen lds
    s_cmp_eq_u32 s30, 0
    s_cbranch_scc1 K_CHA0
    s_cmp_eq_u32 s30, 1
    s_cbranch_scc1 K_CHA1
    s_cmp_eq_u32 s30, 2
    s_cbranch_scc1 K_CHA2
    s_branch K_CHA3
K_WRET_A:
    v_mov_b32 v3, 1
    s_waitcnt vmcnt(0)
    s_branch K_PG5
.p2align 12
K_STM30:
    s_branch K_WRET_M
K_STA30:
    s_branch K_WRET_A
K_PG5:
    s_mov_b64 exec, 1
    ds_add_u32 v15, v3 offset:44
    s_mov_b64 exec, -1
    s_mov_b32 s3, 1048576
K_P2_GWA:
    ds_read_b32 v2, v15 offset:44
    s_sub_u32 s3, s3, 1
    s_waitcnt lgkmcnt(0)
    v_readfirstlane_b32 s33, v2
    s_nop 3
    s_cselect_b32 s33, 4, s33
    s_cmp_lt_u32 s33, 4
    s_cbranch_scc1 K_P2_GWA
    s_branch K_P2_GEMM
K_P2_HELP:
    s_setprio 3
    s_cmp_eq_u32 s30, 7
    s_cbranch_scc1 K_P2_W7
    s_lshl_b32 s54, s40, 7
    v_lshrrev_b32 v8, 3, v1
    v_lshrrev_b32 v9, 4, v1
    v_mov_b32 v15, 158720
    s_lshl_b32 s53, s40, 3
    s_add_u32 s53, s53, s30
    s_mul_i32 s3, s53, 20480
    s_lshl_b32 s33, s41, 7
    s_add_u32 s3, s3, s33
    v_and_b32 v2, 7, v1
    v_lshlrev_b32 v2, 4, v2
    v_mul_u32_u24 v4, 1280, v8
    v_add3_u32 v10, v2, v4, s3
    s_lshl_b32 s3, s30, 7
    s_add_u32 s3, s3, 159744
    v_lshl_add_u32 v11, v8, 3, s3
    s_mov_b32 s55, 10240
    s_add_u32 s20, s6, 0x100000
    s_addc_u32 s21, s7, 0
    s_mov_b32 s22, 0x280000
    s_mov_b32 s23, 0x20000
    s_mov_b32 s48, s10
    s_mov_b32 s49, s11
    s_mov_b32 s50, 0x280000
    s_mov_b32 s51, 0x20000
    v_mul_u32_u24 v3, 144, v8
    v_add_u32 v3, v2, v3
    s_mul_i32 s3, s30, 2304
    s_add_u32 s3, s3, 140288
    v_add_u32 v14, s3, v3
    s_add_u32 s44, s6, 0x10000
    s_addc_u32 s45, s7, 0
    s_mov_b32 s46, 0x43800
    s_mov_b32 s47, 0x20000
    v_mov_b32 v108, 1
    buffer_load_dwordx4 v[16:19], v10, s[12:15], 0 offen
    buffer_load_dwordx4 v[20:23], v10, s[12:15], s55 offen
    s_cmp_lg_u32 s30, 6
    s_cbranch_scc1 K_P2_HW
    s_mov_b32 s3, 131072
    s_waitcnt vmcnt(2)
K_P2_DPOLL:
    v_min_u32 v2, v7, v6
    v_cmp_eq_u32 vcc, 0, v2
    s_cbranch_vccz K_P2_DOK
    s_cmp_eq_u32 s3, 131072
    s_cbranch_scc1 K_P2_DNS
    s_sleep 12
K_P2_DNS:
    v_lshl_add_u32 v13, v1, 2, s42
    global_load_dword v7, v13, s[6:7] offset:256 sc1
    v_and_b32 v13, 0xfffffe04, v13
    global_load_dword v6, v13, s[6:7] offset:128 sc1
    s_sub_u32 s3, s3, 1
    s_waitcnt vmcnt(0)
    s_cmp_lg_u32 s3, 0
    s_cbranch_scc1 K_P2_DPOLL
K_P2_DOK:
    v_readlane_b32 s60, v6, 0
    v_readlane_b32 s61, v6, 1
    s_nop 1
    s_and_b32 s3, s60, 0x7ff
    s_sub_u32 s3, 2047, s3
    v_mov_b32 v48, s3
    v_mov_b32 v4, s60
    v_and_b32 v4, 0xffff0000, v4
    v_ashrrev_i32 v5, 31, v4
    v_not_b32 v5, v5
    v_or_b32 v5, 0x80000000, v5
    v_xor_b32 v4, v4, v5
    v_and_b32 v4, 0xffff0000, v4
    v_mul_f32 v5, 0xbfb8aa3b, v4
    v_exp_f32 v5, v5
    s_nop 0
    v_add_f32 v5, 1.0, v5
    v_rcp_f32 v4, v5
    s_nop 0
    v_cvt_pk_bf16_f32 v50, v4, v4
    v_lshlrev_b32 v50, 16, v50
    s_and_b32 s3, s61, 0x7ff
    s_sub_u32 s3, 2047, s3
    v_mov_b32 v49, s3
    v_mov_b32 v4, s61
    v_and_b32 v4, 0xffff0000, v4
    v_ashrrev_i32 v5, 31, v4
    v_not_b32 v5, v5
    v_or_b32 v5, 0x80000000, v5
    v_xor_b32 v4, v4, v5
    v_and_b32 v4, 0xffff0000, v4
    v_mul_f32 v5, 0xbfb8aa3b, v4
    v_exp_f32 v5, v5
    s_nop 0
    v_add_f32 v5, 1.0, v5
    v_rcp_f32 v4, v5
    s_nop 0
    v_cvt_pk_bf16_f32 v51, v4, v4
    v_lshlrev_b32 v51, 16, v51
    ds_write_b128 v15, v[48:51]
    ds_write_b32 v15, v108 offset:40
    v_lshl_add_u32 v13, v1, 4, v15
    v_lshlrev_b32 v52, 16, v7
    v_and_b32 v52, 0x7fff0000, v52
    v_and_b32 v54, 0x7fff0000, v7
    v_sub_f32 v53, 1.0, v52
    v_cvt_pk_bf16_f32 v53, v53, v53
    v_lshlrev_b32 v53, 16, v53
    v_sub_f32 v55, 1.0, v54
    v_cvt_pk_bf16_f32 v55, v55, v55
    v_lshlrev_b32 v55, 16, v55
    ds_write_b128 v13, v[52:55] offset:1024
    s_branch K_P2_E
K_STM31:
    s_branch K_WRET_M
K_STA31:
    s_branch K_WRET_A
K_P2_HW:
    s_mov_b32 s3, 1048576
K_P2_GS2:
    ds_read_b32 v2, v15 offset:40
    s_sleep 1
    s_sub_u32 s3, s3, 1
    s_waitcnt lgkmcnt(0)
    v_readfirstlane_b32 s33, v2
    s_nop 3
    s_cselect_b32 s33, 1, s33
    s_cmp_lt_u32 s33, 1
    s_cbranch_scc1 K_P2_GS2
    ds_read_b128 v[28:31], v15
    s_waitcnt lgkmcnt(0)
    s_cmp_eq_u32 s30, 4
    s_cselect_b64 vcc, -1, 0
    s_nop 1
    v_cndmask_b32 v2, v29, v28, vcc
    v_cndmask_b32 v5, v31, v30, vcc
    s_nop 0
    v_readfirstlane_b32 s60, v2
    s_nop 3
    s_sub_u32 s3, s60, s54
    s_cmp_lt_u32 s3, 128
    s_cbranch_scc0 K_P2_E
    s_mov_b32 s3, 131072
K_P2_YPOLL:
    s_load_dword s33, s[6:7], s42 offset:136 glc
    s_waitcnt lgkmcnt(0)
    s_cmp_lg_u32 s33, 0
    s_cbranch_scc1 K_P2_YGO
    s_sleep 4
    s_sub_u32 s3, s3, 1
    s_cbranch_scc0 K_P2_YPOLL
K_P2_YGO:
    v_and_b32 v2, 15, v1
    v_lshlrev_b32 v2, 4, v2
    v_mul_u32_u24 v4, 5120, v9
    s_sub_u32 s61, s30, 4
    s_mul_i32 s33, s61, 2560
    s_lshl_b32 s3, s41, 8
    s_add_u32 s3, s3, s33
    v_add3_u32 v3, v2, v4, s3
    s_mov_b32 s52, 0
    buffer_load_dwordx4 v[52:55], v3, s[44:47], s52 offen sc1
    s_mov_b32 s52, 20480
    buffer_load_dwordx4 v[56:59], v3, s[44:47], s52 offen sc1
    s_mov_b32 s52, 40960
    buffer_load_dwordx4 v[60:63], v3, s[44:47], s52 offen sc1
    s_mov_b32 s52, 61440
    buffer_load_dwordx4 v[64:67], v3, s[44:47], s52 offen sc1
    s_mov_b32 s52, 81920
    buffer_load_dwordx4 v[68:71], v3, s[44:47], s52 offen sc1
    s_mov_b32 s52, 102400
    buffer_load_dwordx4 v[72:75], v3, s[44:47], s52 offen sc1
    s_mov_b32 s52, 122880
    buffer_load_dwordx4 v[76:79], v3, s[44:47], s52 offen sc1
    s_mov_b32 s52, 143360
    buffer_load_dwordx4 v[80:83], v3, s[44:47], s52 offen sc1
    s_mov_b32 s52, 163840
    buffer_load_dwordx4 v[84:87], v3, s[44:47], s52 offen sc1
    s_mov_b32 s52, 184320
    buffer_load_dwordx4 v[88:91], v3, s[44:47], s52 offen sc1
    s_mov_b32 s52, 204800
    buffer_load_dwordx4 v[92:95], v3, s[44:47], s52 offen sc1
    s_mov_b32 s52, 225280
    buffer_load_dwordx4 v[96:99], v3, s[44:47], s52 offen sc1
    s_mov_b32 s52, 245760
    buffer_load_dwordx4 v[100:103], v3, s[44:47], s52 offen sc1
    s_mov_b32 s52, 266240
    buffer_load_dwordx4 v[104:107], v3, s[44:47], s52 offen sc1
    s_waitcnt vmcnt(12)
    v_add_f32 v48, v52, v56
    v_add_f32 v49, v53, v57
    v_add_f32 v50, v54, v58
    v_add_f32 v51, v55, v59
    s_waitcnt vmcnt(11)
    v_add_f32 v48, v48, v60
    v_add_f32 v49, v49, v61
    v_add_f32 v50, v50, v62
    v_add_f32 v51, v51, v63
    s_waitcnt vmcnt(10)
    v_add_f32 v48, v48, v64
    v_add_f32 v49, v49, v65
    v_add_f32 v50, v50, v66
    v_add_f32 v51, v51, v67
    s_waitcnt vmcnt(9)
    v_add_f32 v48, v48, v68
    v_add_f32 v49, v49, v69
    v_add_f32 v50, v50, v70
    v_add_f32 v51, v51, v71
    s_waitcnt vmcnt(8)
    v_add_f32 v48, v48, v72
    v_add_f32 v49, v49, v73
    v_add_f32 v50, v50, v74
    v_add_f32 v51, v51, v75
    s_waitcnt vmcnt(7)
    v_add_f32 v48, v48, v76
    v_add_f32 v49, v49, v77
    v_add_f32 v50, v50, v78
    v_add_f32 v51, v51, v79
    s_waitcnt vmcnt(6)
    v_add_f32 v48, v48, v80
    v_add_f32 v49, v49, v81
    v_add_f32 v50, v50, v82
    v_add_f32 v51, v51, v83
    s_waitcnt vmcnt(5)
    v_add_f32 v48, v48, v84
    v_add_f32 v49, v49, v85
    v_add_f32 v50, v50, v86
    v_add_f32 v51, v51, v87
    s_waitcnt vmcnt(4)
    v_add_f32 v48, v48, v88
    v_add_f32 v49, v49, v89
    v_add_f32 v50, v50, v90
    v_add_f32 v51, v51, v91
    s_waitcnt vmcnt(3)
    v_add_f32 v48, v48, v92
    v_add_f32 v49, v49, v93
    v_add_f32 v50, v50, v94
    v_add_f32 v51, v51, v95
    s_waitcnt vmcnt(2)
    v_add_f32 v48, v48, v96
    v_add_f32 v49, v49, v97
    v_add_f32 v50, v50, v98
    v_add_f32 v51, v51, v99
    s_waitcnt vmcnt(1)
    v_add_f32 v48, v48, v100
    v_add_f32 v49, v49, v101
    v_add_f32 v50, v50, v102
    v_add_f32 v51, v51, v103
    s_waitcnt vmcnt(0)
    v_add_f32 v48, v48, v104
    v_add_f32 v49, v49, v105
    v_add_f32 v50, v50, v106
    v_add_f32 v51, v51, v107
    v_mov_b32 v52, v48
    v_mov_b32 v53, v49
    v_mov_b32 v54, v50
    v_mov_b32 v55, v51
    s_nop 0
    v_permlane16_swap_b32 v48, v52
    v_permlane16_swap_b32 v49, v53
    v_permlane16_swap_b32 v50, v54
    v_permlane16_swap_b32 v51, v55
    v_add_f32 v48, v48, v52
    v_add_f32 v49, v49, v53
    v_add_f32 v50, v50, v54
    v_add_f32 v51, v51, v55
    v_mov_b32 v52, v48
    v_mov_b32 v53, v49
    v_mov_b32 v54, v50
    v_mov_b32 v55, v51
    s_nop 0
    v_permlane32_swap_b32 v48, v52
    v_permlane32_swap_b32 v49, v53
    v_permlane32_swap_b32 v50, v54
    v_permlane32_swap_b32 v51, v55
    v_add_f32 v48, v48, v52
    v_add_f32 v49, v49, v53
    v_add_f32 v50, v50, v54
    v_add_f32 v51, v51, v55
    v_cvt_pk_bf16_f32 v48, v48, v48
    v_lshlrev_b32 v48, 16, v48
    v_mul_f32 v48, v5, v48
    v_cvt_pk_bf16_f32 v48, v48, v48
    v_lshlrev_b32 v48, 16, v48
    v_cvt_pk_bf16_f32 v49, v49, v49
    v_lshlrev_b32 v49, 16, v49
    v_mul_f32 v49, v5, v49
    v_cvt_pk_bf16_f32 v49, v49, v49
    v_lshlrev_b32 v49, 16, v49
    v_cvt_pk_bf16_f32 v50, v50, v50
    v_lshlrev_b32 v50, 16, v50
    v_mul_f32 v50, v5, v50
    v_cvt_pk_bf16_f32 v50, v50, v50
    v_lshlrev_b32 v50, 16, v50
    v_cvt_pk_bf16_f32 v51, v51, v51
    v_lshlrev_b32 v51, 16, v51
    v_mul_f32 v51, v5, v51
    v_cvt_pk_bf16_f32 v51, v51, v51
    v_lshlrev_b32 v51, 16, v51
    s_lshl_b32 s3, s61, 8
    s_add_u32 s3, s3, 158976
    v_add_u32 v2, s3, v2
    ds_write_b128 v2, v[48:51]
    s_branch K_P2_E
K_STM32:
    s_branch K_WRET_M
K_STA32:
    s_branch K_WRET_A
K_P2_W7:
    s_lshl_b32 s53, s40, 3
    s_mul_i32 s60, s53, 187
    s_lshr_b32 s60, s60, 11
    s_add_u32 s3, s53, 7
    s_mul_i32 s61, s3, 187
    s_lshr_b32 s61, s61, 11
    s_sub_u32 s61, s61, s60
    s_mov_b32 s37, s42
    s_waitcnt lgkmcnt(0)
    s_load_dwordx2 s[56:57], s[6:7], s37 glc
    s_mov_b32 s46, 0x84210
    s_mov_b32 s47, s46
    v_mov_b32 v15, 158720
    v_mov_b32 v48, 0x80000000
    s_mov_b64 exec, 1
    ds_or_b32 v15, v48 offset:20
    s_waitcnt lgkmcnt(0)
    s_cmp_eq_u32 s61, 0
    s_cselect_b32 s57, s56, s57
    s_lshl_b64 s[58:59], s[56:57], 1
    s_and_b64 s[58:59], s[58:59], s[56:57]
    s_lshl_b64 vcc, s[58:59], 2
    s_and_b64 s[58:59], s[58:59], vcc
    s_lshl_b64 s[58:59], s[58:59], 1
    s_and_b64 s[58:59], s[58:59], s[46:47]
    s_or_b64 s[56:57], s[56:57], s[58:59]
    s_and_b32 s60, s56, s57
    v_mov_b32 v48, s56
    v_mov_b32 v49, s57
    v_mov_b32 v50, s60
    s_mov_b64 exec, 1
    ds_or_b64 v15, v[48:49] offset:16
    ds_or_b32 v15, v50 offset:24
    s_mov_b64 exec, -1
    s_load_dwordx2 s[56:57], s[6:7], s37 glc
    s_lshl_b32 s54, s40, 7
    v_lshrrev_b32 v8, 3, v1
    v_lshrrev_b32 v9, 4, v1
    v_mov_b32 v15, 158720
    s_lshl_b32 s53, s40, 3
    s_add_u32 s53, s53, s30
    s_mul_i32 s3, s53, 20480
    s_lshl_b32 s33, s41, 7
    s_add_u32 s3, s3, s33
    v_and_b32 v2, 7, v1
    v_lshlrev_b32 v2, 4, v2
    v_mul_u32_u24 v4, 1280, v8
    v_add3_u32 v10, v2, v4, s3
    s_lshl_b32 s3, s30, 7
    s_add_u32 s3, s3, 159744
    v_lshl_add_u32 v11, v8, 3, s3
    s_mov_b32 s55, 10240
    s_add_u32 s20, s6, 0x100000
    s_addc_u32 s21, s7, 0
    s_mov_b32 s22, 0x280000
    s_mov_b32 s23, 0x20000
    s_mov_b32 s48, s10
    s_mov_b32 s49, s11
    s_mov_b32 s50, 0x280000
    s_mov_b32 s51, 0x20000
    v_mul_u32_u24 v3, 144, v8
    v_add_u32 v3, v2, v3
    s_mul_i32 s3, s30, 2304
    s_add_u32 s3, s3, 140288
    v_add_u32 v14, s3, v3
    buffer_load_dwordx4 v[16:19], v10, s[12:15], 0 offen
    buffer_load_dwordx4 v[20:23], v10, s[12:15], s55 offen
    s_mov_b32 s3, 131072
    s_waitcnt lgkmcnt(0)
K_P2_FCHK:
    s_cmp_eq_u32 s61, 0
    s_cselect_b32 s57, s56, s57
    s_lshl_b64 s[58:59], s[56:57], 1
    s_and_b64 s[58:59], s[58:59], s[56:57]
    s_lshl_b64 vcc, s[58:59], 2
    s_and_b64 s[58:59], s[58:59], vcc
    s_lshl_b64 s[58:59], s[58:59], 1
    s_and_b64 s[58:59], s[58:59], s[46:47]
    s_or_b64 s[56:57], s[56:57], s[58:59]
    s_and_b32 s60, s56, s57
    v_mov_b32 v48, s56
    v_mov_b32 v49, s57
    v_mov_b32 v50, s60
    s_mov_b64 exec, 1
    ds_or_b64 v15, v[48:49] offset:16
    ds_or_b32 v15, v50 offset:24
    s_mov_b64 exec, -1
    s_cmp_eq_u32 s60, 0xfffff
    s_cbranch_scc1 K_P2_FGO
    s_cmp_lg_u64 s[56:57], 0
    s_cbranch_scc1 K_P2_FS
    s_sleep 8
K_P2_FS:
    s_sleep 2
    s_load_dwordx2 s[56:57], s[6:7], s37 glc
    s_sub_u32 s3, s3, 1
    s_waitcnt lgkmcnt(0)
    s_cbranch_scc0 K_P2_FCHK
    v_mov_b32 v48, -1
    v_mov_b32 v49, -1
    v_mov_b32 v50, -1
    ds_write_b96 v15, v[48:50] offset:16
K_P2_FGO:
K_P2_E:
    s_setprio 0
    s_waitcnt vmcnt(0)
    v_lshlrev_b32 v32, 16, v16
    v_and_b32 v33, 0xffff0000, v16
    v_lshlrev_b32 v34, 16, v17
    v_and_b32 v35, 0xffff0000, v17
    v_lshlrev_b32 v36, 16, v18
    v_and_b32 v37, 0xffff0000, v18
    v_lshlrev_b32 v38, 16, v19
    v_and_b32 v39, 0xffff0000, v19
    v_lshlrev_b32 v40, 16, v20
    v_and_b32 v41, 0xffff0000, v20
    v_lshlrev_b32 v42, 16, v21
    v_and_b32 v43, 0xffff0000, v21
    v_lshlrev_b32 v44, 16, v22
    v_and_b32 v45, 0xffff0000, v22
    v_lshlrev_b32 v46, 16, v23
    v_and_b32 v47, 0xffff0000, v23
    s_branch K_P2_E2
K_STM33:
    s_branch K_WRET_M
K_STA33:
    s_branch K_WRET_A
K_P2_G0:
    s_mul_i32 s60, s53, 187
    s_lshr_b32 s60, s60, 11
    s_add_u32 s3, s53, 7
    s_mul_i32 s61, s3, 187
    s_lshr_b32 s61, s61, 11
    s_sub_u32 s61, s61, s60
    s_mov_b32 s37, s42
    s_mov_b32 s46, 0x84210
    s_mov_b32 s47, s46
K_P2_G0L:
    s_load_dwordx2 s[56:57], s[6:7], s37 glc
    ds_read_b32 v2, v15 offset:20
    s_waitcnt lgkmcnt(0)
    v_readfirstlane_b32 s33, v2
    s_cmp_eq_u32 s61, 0
    s_cselect_b32 s57, s56, s57
    s_lshl_b64 s[58:59], s[56:57], 1
    s_and_b64 s[58:59], s[58:59], s[56:57]
    s_lshl_b64 vcc, s[58:59], 2
    s_and_b64 s[58:59], s[58:59], vcc
    s_lshl_b64 s[58:59], s[58:59], 1
    s_and_b64 s[58:59], s[58:59], s[46:47]
    s_or_b64 s[56:57], s[56:57], s[58:59]
    s_and_b32 s60, s56, s57
    v_mov_b32 v32, s56
    v_mov_b32 v33, s57
    v_mov_b32 v34, s60
    s_mov_b64 exec, 1
    ds_or_b64 v15, v[32:33] offset:16
    ds_or_b32 v15, v34 offset:24
    s_mov_b64 exec, -1
    s_bcnt1_i32_b32 s3, s56
    s_cmp_ge_u32 s3, 3
    s_cbranch_scc1 K_P2_G0R
    s_cmp_lt_i32 s33, 0
    s_cbranch_scc1 K_P2_G0R
    s_sleep 4
    s_sub_u32 s74, s74, 1
    s_cbranch_scc0 K_P2_G0L
    s_branch K_P2_G0R
K_CHEND:
K_AUX:
    s_cmp_ge_u32 s30, 4
    s_cbranch_scc1 K_AUX_L
    s_and_b32 s3, s2, 7
    s_lshr_b32 s70, s2, 3
    s_lshl3_add_u32 s3, s3, s70
    s_lshl_b32 s3, s3, 5
    s_lshl3_add_u32 s3, s30, s3
    v_bfe_u32 v8, v0, 4, 2
    v_add_u32 v8, s3, v8
    v_and_b32 v10, 15, v0
    v_lshlrev_b32 v10, 4, v10
    v_mul_u32_u24 v9, 1280, v8
    v_add_u32 v9, v9, v10
    v_and_b32 v2, 63, v0
    v_lshlrev_b32 v2, 4, v2
    s_lshl_b32 s71, s30, 12
    s_add_u32 s71, s71, 126016
    s_mov_b32 s70, 5120
    s_mov_b32 m0, s71
    s_waitcnt lgkmcnt(0)
    s_mov_b32 s16, s44
    s_mov_b32 s17, s45
    s_mov_b32 s18, 0x500
    s_mov_b32 s19, 0x20000
    s_mov_b32 s20, s52
    s_mov_b32 s21, s53
    s_mov_b32 s22, 0x500
    s_mov_b32 s23, 0x20000
    buffer_load_dwordx4 v2, s[16:19], 0 offen lds
    buffer_load_dwordx4 v2, s[16:19], 0 offen offset:1024 lds
    s_add_u32 m0, s71, 2048
    v_add_u32 v10, s71, v10
    buffer_load_dwordx4 v2, s[20:23], 0 offen lds
    buffer_load_dwordx4 v2, s[20:23], 0 offen offset:1024 lds
    buffer_load_dwordx4 v[16:19], v9, s[12:15], 0 offen offset:0
    buffer_load_dwordx4 v[20:23], v9, s[12:15], s70 offen offset:0
    buffer_load_dwordx4 v[24:27], v9, s[12:15], 0 offen offset:256
    buffer_load_dwordx4 v[28:31], v9, s[12:15], s70 offen offset:256
    buffer_load_dwordx4 v[32:35], v9, s[12:15], 0 offen offset:512
    buffer_load_dwordx4 v[36:39], v9, s[12:15], s70 offen offset:512
    buffer_load_dwordx4 v[40:43], v9, s[12:15], 0 offen offset:768
    buffer_load_dwordx4 v[44:47], v9, s[12:15], s70 offen offset:768
    buffer_load_dwordx4 v[48:51], v9, s[12:15], 0 offen offset:1024
    buffer_load_dwordx4 v[52:55], v9, s[12:15], s70 offen offset:1024
    s_barrier
    v_and_b32 v1, 63, v0
    v_mov_b32 v7, 0
    s_and_b32 s28, s2, 7
    s_lshr_b32 s29, s2, 3
    s_xor_b32 s30, s30, 4
    s_lshr_b32 s34, s29, 3
    s_lshl_b32 s34, s34, 2
    s_and_b32 s3, s29, 3
    s_add_u32 s34, s34, s3
    s_add_u32 s34, s34, 4
    s_bitcmp1_b32 s29, 2
    s_cselect_b32 s34, -1, s34
    s_cmp_lt_u32 s29, 8
    s_cselect_b32 s34, s29, s34
    s_lshl_b32 s40, s28, 1
    s_cmp_ge_u32 s34, 10
    s_addc_u32 s40, s40, 0
    s_sub_u32 s41, s34, 10
    s_cmp_ge_u32 s34, 10
    s_cselect_b32 s41, s41, s34
    s_mul_i32 s42, s28, 20
    s_add_u32 s42, s42, s34
    s_and_b32 s42, s42, 255
    s_lshl_b32 s42, s42, 9
    s_add_u32 s42, s42, 524288
    s_mul_i32 s43, s28, 7
    s_add_u32 s43, s43, s29
    s_sub_u32 s43, s43, 1
    s_cmp_lt_u32 s43, 54
    s_cselect_b32 s43, s43, 63
    s_cmp_eq_u32 s29, 0
    s_cselect_b32 s43, 63, s43
    s_mov_b32 s24, s8
    s_mov_b32 s25, s9
    s_mov_b32 s26, 0xc8000
    s_mov_b32 s27, 0x20000
    s_add_u32 s64, s6, 0x80000
    s_addc_u32 s65, s7, 0
    s_mov_b32 s66, 0x14400
    s_mov_b32 s67, 0x20000
    s_add_u32 s60, s6, 0x10000
    s_addc_u32 s61, s7, 0
    s_mov_b32 s62, 0x43800
    s_mov_b32 s63, 0x20000
    v_mov_b32 v96, 0
    v_mov_b32 v97, 0
    v_mov_b32 v98, 0
    v_mov_b32 v99, 0
    v_mov_b32 v13, 158720
    s_waitcnt vmcnt(10)
    ds_read_b128 v[56:59], v10 offset:0
    ds_read_b128 v[76:79], v10 offset:2048
    ds_read_b128 v[60:63], v10 offset:256
    ds_read_b128 v[80:83], v10 offset:2304
    ds_read_b128 v[64:67], v10 offset:512
    ds_read_b128 v[84:87], v10 offset:2560
    ds_read_b128 v[68:71], v10 offset:768
    ds_read_b128 v[88:91], v10 offset:2816
    ds_read_b128 v[72:75], v10 offset:1024
    ds_read_b128 v[92:95], v10 offset:3072
    s_waitcnt vmcnt(8) lgkmcnt(8)
    v_dot2c_f32_bf16 v96, v16, v56
    v_dot2c_f32_bf16 v98, v16, v76
    v_dot2c_f32_bf16 v97, v20, v56
    v_dot2c_f32_bf16 v99, v20, v76
    v_dot2c_f32_bf16 v96, v17, v57
    v_dot2c_f32_bf16 v98, v17, v77
    v_dot2c_f32_bf16 v97, v21, v57
    v_dot2c_f32_bf16 v99, v21, v77
    v_dot2c_f32_bf16 v96, v18, v58
    v_dot2c_f32_bf16 v98, v18, v78
    v_dot2c_f32_bf16 v97, v22, v58
    v_dot2c_f32_bf16 v99, v22, v78
    v_dot2c_f32_bf16 v96, v19, v59
    v_dot2c_f32_bf16 v98, v19, v79
    v_dot2c_f32_bf16 v97, v23, v59
    v_dot2c_f32_bf16 v99, v23, v79
    s_waitcnt vmcnt(6) lgkmcnt(6)
    v_dot2c_f32_bf16 v96, v24, v60
    v_dot2c_f32_bf16 v98, v24, v80
    v_dot2c_f32_bf16 v97, v28, v60
    v_dot2c_f32_bf16 v99, v28, v80
    v_dot2c_f32_bf16 v96, v25, v61
    v_dot2c_f32_bf16 v98, v25, v81
    v_dot2c_f32_bf16 v97, v29, v61
    v_dot2c_f32_bf16 v99, v29, v81
    v_dot2c_f32_bf16 v96, v26, v62
    v_dot2c_f32_bf16 v98, v26, v82
    v_dot2c_f32_bf16 v97, v30, v62
    v_dot2c_f32_bf16 v99, v30, v82
    v_dot2c_f32_bf16 v96, v27, v63
    v_dot2c_f32_bf16 v98, v27, v83
    v_dot2c_f32_bf16 v97, v31, v63
    v_dot2c_f32_bf16 v99, v31, v83
    s_waitcnt vmcnt(4) lgkmcnt(4)
    v_dot2c_f32_bf16 v96, v32, v64
    v_dot2c_f32_bf16 v98, v32, v84
    v_dot2c_f32_bf16 v97, v36, v64
    v_dot2c_f32_bf16 v99, v36, v84
    v_dot2c_f32_bf16 v96, v33, v65
    v_dot2c_f32_bf16 v98, v33, v85
    v_dot2c_f32_bf16 v97, v37, v65
    v_dot2c_f32_bf16 v99, v37, v85
    v_dot2c_f32_bf16 v96, v34, v66
    v_dot2c_f32_bf16 v98, v34, v86
    v_dot2c_f32_bf16 v97, v38, v66
    v_dot2c_f32_bf16 v99, v38, v86
    v_dot2c_f32_bf16 v96, v35, v67
    v_dot2c_f32_bf16 v98, v35, v87
    v_dot2c_f32_bf16 v97, v39, v67
    v_dot2c_f32_bf16 v99, v39, v87
    s_waitcnt vmcnt(2) lgkmcnt(2)
    v_dot2c_f32_bf16 v96, v40, v68
    v_dot2c_f32_bf16 v98, v40, v88
    v_dot2c_f32_bf16 v97, v44, v68
    v_dot2c_f32_bf16 v99, v44, v88
    v_dot2c_f32_bf16 v96, v41, v69
    v_dot2c_f32_bf16 v98, v41, v89
    v_dot2c_f32_bf16 v97, v45, v69
    v_dot2c_f32_bf16 v99, v45, v89
    v_dot2c_f32_bf16 v96, v42, v70
    v_dot2c_f32_bf16 v98, v42, v90
    v_dot2c_f32_bf16 v97, v46, v70
    v_dot2c_f32_bf16 v99, v46, v90
    v_dot2c_f32_bf16 v96, v43, v71
    v_dot2c_f32_bf16 v98, v43, v91
    v_dot2c_f32_bf16 v97, v47, v71
    v_dot2c_f32_bf16 v99, v47, v91
    s_waitcnt vmcnt(0) lgkmcnt(0)
    v_dot2c_f32_bf16 v96, v48, v72
    v_dot2c_f32_bf16 v98, v48, v92
    v_dot2c_f32_bf16 v97, v52, v72
    v_dot2c_f32_bf16 v99, v52, v92
    v_dot2c_f32_bf16 v96, v49, v73
    v_dot2c_f32_bf16 v98, v49, v93
    v_dot2c_f32_bf16 v97, v53, v73
    v_dot2c_f32_bf16 v99, v53, v93
    v_dot2c_f32_bf16 v96, v50, v74
    v_dot2c_f32_bf16 v98, v50, v94
    v_dot2c_f32_bf16 v97, v54, v74
    v_dot2c_f32_bf16 v99, v54, v94
    v_dot2c_f32_bf16 v96, v51, v75
    v_dot2c_f32_bf16 v98, v51, v95
    v_dot2c_f32_bf16 v97, v55, v75
    v_dot2c_f32_bf16 v99, v55, v95
    s_nop 2
    v_add_f32_dpp v96, v96, v96 quad_perm:[1,0,3,2] row_mask:0xf bank_mask:0xf
    v_add_f32_dpp v97, v97, v97 quad_perm:[1,0,3,2] row_mask:0xf bank_mask:0xf
    v_add_f32_dpp v98, v98, v98 quad_perm:[1,0,3,2] row_mask:0xf bank_mask:0xf
    v_add_f32_dpp v99, v99, v99 quad_perm:[1,0,3,2] row_mask:0xf bank_mask:0xf
    v_add_f32_dpp v96, v96, v96 quad_perm:[2,3,0,1] row_mask:0xf bank_mask:0xf
    v_add_f32_dpp v97, v97, v97 quad_perm:[2,3,0,1] row_mask:0xf bank_mask:0xf
    v_add_f32_dpp v98, v98, v98 quad_perm:[2,3,0,1] row_mask:0xf bank_mask:0xf
    v_add_f32_dpp v99, v99, v99 quad_perm:[2,3,0,1] row_mask:0xf bank_mask:0xf
    v_add_f32_dpp v96, v96, v96 row_half_mirror row_mask:0xf bank_mask:0xf
    v_add_f32_dpp v97, v97, v97 row_half_mirror row_mask:0xf bank_mask:0xf
    v_add_f32_dpp v98, v98, v98 row_half_mirror row_mask:0xf bank_mask:0xf
    v_add_f32_dpp v99, v99, v99 row_half_mirror row_mask:0xf bank_mask:0xf
    v_add_f32_dpp v96, v96, v96 row_mirror row_mask:0xf bank_mask:0xf
    v_add_f32_dpp v97, v97, v97 row_mirror row_mask:0xf bank_mask:0xf
    v_add_f32_dpp v98, v98, v98 row_mirror row_mask:0xf bank_mask:0xf
    v_add_f32_dpp v99, v99, v99 row_mirror row_mask:0xf bank_mask:0xf
    v_and_b32 v4, 31, v8
    v_lshlrev_b32 v11, 2, v4
    v_add_u32 v11, 122880, v11
    v_lshlrev_b32 v12, 1, v4
    v_add_u32 v12, 123008, v12
    v_cvt_pk_bf16_f32 v2, v96, v96
    v_lshlrev_b32 v2, 16, v2
    v_ashrrev_i32 v3, 31, v2
    v_or_b32 v3, 0x80000000, v3
    v_xor_b32 v2, v2, v3
    v_and_b32 v2, 0xffff0000, v2
    v_sub_u32 v3, 0x87ff, v8
    v_or_b32 v96, v2, v3
    ds_write_b32 v11, v96 offset:0
    v_cvt_pk_bf16_f32 v98, v98, v98
    v_lshlrev_b32 v98, 16, v98
    v_mul_f32 v5, 0xbfb8aa3b, v98
    v_exp_f32 v5, v5
    s_nop 0
    v_add_f32 v5, 1.0, v5
    v_rcp_f32 v98, v5
    s_nop 0
    v_cvt_pk_bf16_f32 v98, v98, v98
    v_or_b32 v98, 0x8000, v98
    ds_write_b16 v12, v98 offset:0
    v_cvt_pk_bf16_f32 v2, v97, v97
    v_lshlrev_b32 v2, 16, v2
    v_ashrrev_i32 v3, 31, v2
    v_or_b32 v3, 0x80000000, v3
    v_xor_b32 v2, v2, v3
    v_and_b32 v2, 0xffff0000, v2
    v_sub_u32 v3, 0x87fb, v8
    v_or_b32 v97, v2, v3
    ds_write_b32 v11, v97 offset:16
    v_cvt_pk_bf16_f32 v99, v99, v99
    v_lshlrev_b32 v99, 16, v99
    v_mul_f32 v5, 0xbfb8aa3b, v99
    v_exp_f32 v5, v5
    s_nop 0
    v_add_f32 v5, 1.0, v5
    v_rcp_f32 v99, v5
    s_nop 0
    v_cvt_pk_bf16_f32 v99, v99, v99
    v_or_b32 v99, 0x8000, v99
    ds_write_b16 v12, v99 offset:8
    v_mov_b32 v3, 1
    s_mov_b64 exec, 1
    ds_add_u32 v13, v3 offset:48
    s_mov_b64 exec, -1
    s_cmp_ge_u32 s30, 6
    s_cbranch_scc1 K_AUX_G1
    s_mov_b32 s3, 1048576
K_FGR:
    ds_read_b32 v2, v13 offset:48
    s_sleep 1
    s_sub_u32 s3, s3, 1
    s_waitcnt lgkmcnt(0)
    v_readfirstlane_b32 s33, v2
    s_nop 3
    s_cselect_b32 s33, 4, s33
    s_cmp_lt_u32 s33, 4
    s_cbranch_scc1 K_FGR
    s_cmp_lg_u32 s30, 4
    s_cbranch_scc1 K_AUX_G0
    v_and_b32 v3, 31, v1
    v_lshlrev_b32 v3, 2, v3
    v_add_u32 v3, 122880, v3
    ds_read_b32 v2, v3
    s_waitcnt lgkmcnt(0)
    s_nop 1
    v_max_u32_dpp v3, v2, v2 quad_perm:[1,0,3,2] row_mask:0xf bank_mask:0xf
    s_nop 1
    v_max_u32_dpp v3, v3, v3 quad_perm:[2,3,0,1] row_mask:0xf bank_mask:0xf
    s_nop 1
    v_max_u32_dpp v3, v3, v3 row_half_mirror row_mask:0xf bank_mask:0xf
    s_nop 1
    v_max_u32_dpp v3, v3, v3 row_mirror row_mask:0xf bank_mask:0xf
    s_nop 1
    v_readlane_b32 s68, v3, 0
    v_readlane_b32 s76, v3, 16
    v_readlane_b32 s77, v3, 32
    v_readlane_b32 s78, v3, 48
    s_nop 3
    s_max_u32 s68, s68, s76
    s_max_u32 s77, s77, s78
    s_max_u32 s68, s68, s77
    v_cmp_ne_u32 vcc, s68, v2
    s_nop 1
    v_cndmask_b32 v2, 0, v2, vcc
    s_nop 1
    v_max_u32_dpp v3, v2, v2 quad_perm:[1,0,3,2] row_mask:0xf bank_mask:0xf
    s_nop 1
    v_max_u32_dpp v3, v3, v3 quad_perm:[2,3,0,1] row_mask:0xf bank_mask:0xf
    s_nop 1
    v_max_u32_dpp v3, v3, v3 row_half_mirror row_mask:0xf bank_mask:0xf
    s_nop 1
    v_max_u32_dpp v3, v3, v3 row_mirror row_mask:0xf bank_mask:0xf
    s_nop 1
    s_branch K_PG6
.p2align 12
K_PG6:
    v_readlane_b32 s69, v3, 0
    v_readlane_b32 s76, v3, 16
    v_readlane_b32 s77, v3, 32
    v_readlane_b32 s78, v3, 48
    s_nop 3
    s_max_u32 s69, s69, s76
    s_max_u32 s77, s77, s78
    s_max_u32 s69, s69, s77
    s_load_dword s33, s[4:5], 0
    s_waitcnt lgkmcnt(0)
    s_cmp_ge_u32 s33, 1
    s_cbranch_scc1 K_ZO3
    s_sleep 8
    s_load_dword s33, s[4:5], 64
    s_waitcnt lgkmcnt(0)
    s_cmp_ge_u32 s33, 1
    s_cbranch_scc1 K_ZO3
    s_sleep 8
    s_mov_b32 s3, 16384
K_ZB3:
    s_load_dword s33, s[4:5], 0 glc
    s_waitcnt lgkmcnt(0)
    s_cmp_ge_u32 s33, 1
    s_cbranch_scc1 K_ZO3
    s_sleep 32
    s_sub_u32 s3, s3, 1
    s_cbranch_scc0 K_ZB3
K_ZO3:
    s_lshl_b32 s3, s2, 3
    s_add_u32 s3, s3, 606208
    s_atomic_add_x2 s[68:69], s[6:7], s3
    s_cmp_lg_u32 s2, 63
    s_cbranch_scc1 K_AUX_G1
    s_mov_b32 s70, 81920
    v_lshlrev_b32 v3, 3, v1
    s_mov_b32 s3, 131072
K_AUX_POLL:
    buffer_load_dwordx2 v[176:177], v3, s[64:67], s70 offen sc1
    s_waitcnt vmcnt(0)
    v_min_u32 v2, v176, v177
    v_cmp_eq_u32 vcc, 0, v2
    s_cbranch_vccz K_AUX_GOT
    s_sleep 2
    s_sub_u32 s3, s3, 1
    s_cmp_lg_u32 s3, 0
    s_cbranch_scc1 K_AUX_POLL
K_AUX_GOT:
    s_waitcnt lgkmcnt(0)
    s_nop 1
    v_max_u32_dpp v3, v176, v176 quad_perm:[1,0,3,2] row_mask:0xf bank_mask:0xf
    s_nop 1
    v_max_u32_dpp v3, v3, v3 quad_perm:[2,3,0,1] row_mask:0xf bank_mask:0xf
    s_nop 1
    v_max_u32_dpp v3, v3, v3 row_half_mirror row_mask:0xf bank_mask:0xf
    s_nop 1
    v_max_u32_dpp v3, v3, v3 row_mirror row_mask:0xf bank_mask:0xf
    s_nop 1
    v_readlane_b32 s68, v3, 0
    v_readlane_b32 s76, v3, 16
    v_readlane_b32 s77, v3, 32
    v_readlane_b32 s78, v3, 48
    s_nop 3
    s_max_u32 s68, s68, s76
    s_max_u32 s77, s77, s78
    s_max_u32 s68, s68, s77
    v_cmp_ne_u32 vcc, s68, v176
    s_nop 1
    v_cndmask_b32 v2, v177, v176, vcc
    s_nop 1
    v_max_u32_dpp v3, v2, v2 quad_perm:[1,0,3,2] row_mask:0xf bank_mask:0xf
    s_nop 1
    v_max_u32_dpp v3, v3, v3 quad_perm:[2,3,0,1] row_mask:0xf bank_mask:0xf
    s_nop 1
    v_max_u32_dpp v3, v3, v3 row_half_mirror row_mask:0xf bank_mask:0xf
    s_nop 1
    v_max_u32_dpp v3, v3, v3 row_mirror row_mask:0xf bank_mask:0xf
    s_nop 1
    v_readlane_b32 s69, v3, 0
    v_readlane_b32 s76, v3, 16
    v_readlane_b32 s77, v3, 32
    v_readlane_b32 s78, v3, 48
    s_nop 3
    s_max_u32 s69, s69, s76
    s_max_u32 s77, s77, s78
    s_max_u32 s69, s69, s77
    v_mov_b32 v176, s68
    v_mov_b32 v177, s69
    s_mov_b32 s3, 1048576
K_FGZ:
    ds_read_b32 v2, v13 offset:36
    s_sleep 1
    s_sub_u32 s3, s3, 1
    s_waitcnt lgkmcnt(0)
    v_readfirstlane_b32 s33, v2
    s_nop 3
    s_cselect_b32 s33, 1, s33
    s_cmp_lt_u32 s33, 1
    s_cbranch_scc1 K_FGZ
    v_lshlrev_b32 v3, 9, v1
    s_mov_b32 s66, 81920
    s_mov_b32 s70, 0
    buffer_store_dwordx2 v[176:177], v3, s[64:67], s70 offen offset:128 sc1
    s_mov_b32 s70, 32768
    buffer_store_dwordx2 v[176:177], v3, s[64:67], s70 offen offset:128 sc1
    s_mov_b32 s70, 65536
    buffer_store_dwordx2 v[176:177], v3, s[64:67], s70 offen offset:128 sc1
    v_mov_b32 v3, 16
    ds_write_b32 v13, v3 offset:48
    s_branch K_AUX_G1
K_AUX_G0:
    v_and_b32 v3, 3, v1
    v_lshlrev_b32 v3, 4, v3
    v_add_u32 v2, 123008, v3
    ds_read_b128 v[176:179], v2
    v_lshrrev_b32 v2, 2, v1
    v_lshl_add_u32 v3, v2, 9, v3
    s_sleep 12
    s_load_dword s33, s[4:5], 128
    s_waitcnt lgkmcnt(0)
    s_cmp_ge_u32 s33, 8
    s_cbranch_scc1 K_ZO4
    s_sleep 8
    s_mov_b32 s3, 16384
K_ZB4:
    s_load_dword s33, s[4:5], 128 glc
    s_waitcnt lgkmcnt(0)
    s_cmp_ge_u32 s33, 8
    s_cbranch_scc1 K_ZO4
    s_sleep 32
    s_sub_u32 s3, s3, 1
    s_cbranch_scc0 K_ZB4
K_ZO4:
    v_mov_b32 v2, 1
    ds_write_b32 v13, v2 offset:36
    s_lshr_b32 s3, s29, 2
    s_lshl1_add_u32 s3, s28, s3
    s_mul_i32 s3, s3, 5120
    s_and_b32 s70, s29, 3
    s_lshl_b32 s70, s70, 6
    s_add_u32 s3, s3, s70
    s_mov_b32 exec_hi, 0xff
    s_waitcnt lgkmcnt(0)
    buffer_store_dwordx4 v[176:179], v3, s[64:67], s3 offen offset:256 sc1
    s_mov_b64 exec, -1
K_AUX_G1:
    s_cmp_lg_u32 s43, 63
    s_cbranch_scc1 K_FFN_C
    s_cmp_lg_u32 s29, 0
    s_cbranch_scc1 K_AUX_NT
    s_mul_i32 s3, s30, 160
    s_sub_u32 s3, s3, 640
    v_lshrrev_b32 v2, 1, v1
    v_add_u32 v2, s3, v2
    v_mul_u32_u24 v2, 1280, v2
    v_and_b32 v3, 1, v1
    v_lshl_add_u32 v2, v3, 7, v2
    s_mov_b32 s70, 0
    buffer_load_dword v5, v2, s[24:27], s70 offen offset:1024
    s_mov_b32 s70, 40960
    buffer_load_dword v5, v2, s[24:27], s70 offen offset:1024
    s_mov_b32 s70, 81920
    buffer_load_dword v5, v2, s[24:27], s70 offen offset:1024
    s_mov_b32 s70, 122880
    buffer_load_dword v5, v2, s[24:27], s70 offen offset:1024
    s_mov_b32 s70, 163840
    buffer_load_dword v5, v2, s[24:27], s70 offen offset:1024
K_AUX_NT:
    s_mov_b32 s3, 1048576
K_FGZ2:
    ds_read_b32 v2, v13 offset:36
    s_sleep 1
    s_sub_u32 s3, s3, 1
    s_waitcnt lgkmcnt(0)
    v_readfirstlane_b32 s33, v2
    s_nop 3
    s_cselect_b32 s33, 1, s33
    s_cmp_lt_u32 s33, 1
    s_cbranch_scc1 K_FGZ2
    s_waitcnt vmcnt(0)
    s_branch K_P2
K_AUX_L:
    v_and_b32 v1, 63, v0
    v_mov_b32 v7, 0
    s_and_b32 s28, s2, 7
    s_lshr_b32 s29, s2, 3
    s_xor_b32 s30, s30, 4
    s_lshr_b32 s34, s29, 3
    s_lshl_b32 s34, s34, 2
    s_and_b32 s3, s29, 3
    s_add_u32 s34, s34, s3
    s_add_u32 s34, s34, 4
    s_bitcmp1_b32 s29, 2
    s_cselect_b32 s34, -1, s34
    s_cmp_lt_u32 s29, 8
    s_cselect_b32 s34, s29, s34
    s_lshl_b32 s40, s28, 1
    s_cmp_ge_u32 s34, 10
    s_addc_u32 s40, s40, 0
    s_sub_u32 s41, s34, 10
    s_cmp_ge_u32 s34, 10
    s_cselect_b32 s41, s41, s34
    s_mul_i32 s42, s28, 20
    s_add_u32 s42, s42, s34
    s_and_b32 s42, s42, 255
    s_lshl_b32 s42, s42, 9
    s_add_u32 s42, s42, 524288
    s_mul_i32 s43, s28, 7
    s_add_u32 s43, s43, s29
    s_sub_u32 s43, s43, 1
    s_cmp_lt_u32 s43, 54
    s_cselect_b32 s43, s43, 63
    s_cmp_eq_u32 s29, 0
    s_cselect_b32 s43, 63, s43
    v_mov_b32 v3, 158736
    ds_write2_b32 v3, v7, v7 offset0:0 offset1:1
    ds_write2_b32 v3, v7, v7 offset0:2 offset1:3
    ds_write2_b32 v3, v7, v7 offset0:4 offset1:5
    ds_write2_b32 v3, v7, v7 offset0:6 offset1:7
    ds_write2_b32 v3, v7, v7 offset0:8 offset1:9
    v_lshrrev_b32 v3, 2, v1
    v_mul_u32_u24 v11, 3456, v3
    v_and_b32 v3, 3, v1
    v_lshl_add_u32 v11, v3, 4, v11
    s_mul_i32 s3, s30, 552960
    s_lshl_b32 s70, s43, 6
    s_add_u32 s3, s3, s70
    v_add_u32 v11, s3, v11
    s_mul_i32 s68, s30, 10240
    s_add_u32 s72, s68, 40960
    s_bitcmp1_b32 s43, 0
    s_cselect_b32 s71, s72, s68
    s_cselect_b32 s72, s68, s72
    v_lshlrev_b32 v8, 4, v1
    s_waitcnt lgkmcnt(0)
    s_barrier
    s_mov_b32 s24, s8
    s_mov_b32 s25, s9
    s_mov_b32 s26, 0xc8000
    s_mov_b32 s27, 0x20000
    s_cmp_lg_u32 s43, 63
    s_cbranch_scc1 K_AUX_FFN1
    s_cmp_lg_u32 s30, 0
    s_cbranch_scc1 K_AUX_NR
    s_cmp_eq_u32 s2, 55
    s_cbranch_scc1 K_AUX_NR
    s_cmp_eq_u32 s2, 63
    s_cselect_b32 s70, 0, 128
    s_mov_b32 s3, 1
    s_waitcnt vmcnt(0)
    s_atomic_add s3, s[4:5], s70
    s_atomic_add s3, s[4:5], s70 offset:64
    s_waitcnt lgkmcnt(0)
K_AUX_NR:
    s_cmp_lg_u32 s2, 63
    s_cbranch_scc1 K_AUX_NH
    v_mov_b32 v13, 158720
    s_mov_b32 s3, 1048576
K_FGH:
    ds_read_b32 v2, v13 offset:48
    s_sleep 1
    s_sub_u32 s3, s3, 1
    s_waitcnt lgkmcnt(0)
    v_readfirstlane_b32 s33, v2
    s_nop 3
    s_cselect_b32 s33, 16, s33
    s_cmp_lt_u32 s33, 16
    s_cbranch_scc1 K_FGH
K_AUX_NH:
    s_branch K_P2
K_AUX_FFN1:
    s_bitcmp1_b32 s43, 0
    s_cselect_b64 s[56:57], s[48:49], s[46:47]
    s_cselect_b64 s[60:61], s[46:47], s[48:49]
    s_mov_b32 s58, 2211840
    s_mov_b32 s59, 0x20000
    s_mov_b32 s62, 2211840
    s_mov_b32 s63, 0x20000
    s_add_u32 m0, s71, 0
    s_mov_b32 s70, 0
    buffer_load_dwordx4 v11, s[56:59], s70 offen  lds
    s_add_u32 m0, s71, 1024
    s_mov_b32 s70, 55296
    buffer_load_dwordx4 v11, s[56:59], s70 offen  lds
    s_add_u32 m0, s71, 2048
    s_mov_b32 s70, 110592
    buffer_load_dwordx4 v11, s[56:59], s70 offen  lds
    s_add_u32 m0, s71, 3072
    s_mov_b32 s70, 165888
    buffer_load_dwordx4 v11, s[56:59], s70 offen  lds
    s_add_u32 m0, s71, 4096
    s_mov_b32 s70, 221184
    buffer_load_dwordx4 v11, s[56:59], s70 offen  lds
    s_add_u32 m0, s71, 5120
    s_mov_b32 s70, 276480
    buffer_load_dwordx4 v11, s[56:59], s70 offen  lds
    s_add_u32 m0, s71, 6144
    s_mov_b32 s70, 331776
    buffer_load_dwordx4 v11, s[56:59], s70 offen  lds
    s_add_u32 m0, s71, 7168
    s_mov_b32 s70, 387072
    buffer_load_dwordx4 v11, s[56:59], s70 offen  lds
    s_add_u32 m0, s71, 8192
    s_mov_b32 s70, 442368
    buffer_load_dwordx4 v11, s[56:59], s70 offen  lds
    s_add_u32 m0, s71, 9216
    s_mov_b32 s70, 497664
    buffer_load_dwordx4 v11, s[56:59], s70 offen  lds
    s_add_u32 m0, s72, 0
    s_mov_b32 s70, 0
    buffer_load_dwordx4 v11, s[60:63], s70 offen  lds
    s_add_u32 m0, s72, 1024
    s_mov_b32 s70, 55296
    buffer_load_dwordx4 v11, s[60:63], s70 offen  lds
    s_add_u32 m0, s72, 2048
    s_mov_b32 s70, 110592
    buffer_load_dwordx4 v11, s[60:63], s70 offen  lds
    s_add_u32 m0, s72, 3072
    s_mov_b32 s70, 165888
    buffer_load_dwordx4 v11, s[60:63], s70 offen  lds
    s_add_u32 m0, s72, 4096
    s_mov_b32 s70, 221184
    buffer_load_dwordx4 v11, s[60:63], s70 offen  lds
    s_add_u32 m0, s72, 5120
    s_mov_b32 s70, 276480
    buffer_load_dwordx4 v11, s[60:63], s70 offen  lds
    s_add_u32 m0, s72, 6144
    s_mov_b32 s70, 331776
    buffer_load_dwordx4 v11, s[60:63], s70 offen  lds
    s_add_u32 m0, s72, 7168
    s_mov_b32 s70, 387072
    buffer_load_dwordx4 v11, s[60:63], s70 offen  lds
    s_add_u32 m0, s72, 8192
    s_mov_b32 s70, 442368
    buffer_load_dwordx4 v11, s[60:63], s70 offen  lds
    s_add_u32 m0, s72, 9216
    s_mov_b32 s70, 497664
    buffer_load_dwordx4 v11, s[60:63], s70 offen  lds
    s_mov_b32 s64, s50
    s_mov_b32 s65, s51
    s_mov_b32 s66, 0x21c000
    s_mov_b32 s67, 0x20000
    s_mul_i32 s3, s43, 40960
    s_add_u32 s3, s3, s68
    v_add_u32 v12, s3, v8
    s_add_u32 m0, s68, 81920
    s_mov_b32 s70, 0
    buffer_load_dwordx4 v12, s[64:67], s70 offen  lds
    s_add_u32 m0, s68, 82944
    s_mov_b32 s70, 1024
    buffer_load_dwordx4 v12, s[64:67], s70 offen  lds
    s_add_u32 m0, s68, 83968
    s_mov_b32 s70, 2048
    buffer_load_dwordx4 v12, s[64:67], s70 offen  lds
    s_add_u32 m0, s68, 84992
    s_mov_b32 s70, 3072
    buffer_load_dwordx4 v12, s[64:67], s70 offen  lds
    s_add_u32 m0, s68, 86016
    s_mov_b32 s70, 4096
    buffer_load_dwordx4 v12, s[64:67], s70 offen  lds
    s_add_u32 m0, s68, 87040
    s_mov_b32 s70, 5120
    buffer_load_dwordx4 v12, s[64:67], s70 offen  lds
    s_add_u32 m0, s68, 88064
    s_mov_b32 s70, 6144
    buffer_load_dwordx4 v12, s[64:67], s70 offen  lds
    s_add_u32 m0, s68, 89088
    s_mov_b32 s70, 7168
    buffer_load_dwordx4 v12, s[64:67], s70 offen  lds
    s_add_u32 m0, s68, 90112
    s_mov_b32 s70, 8192
    buffer_load_dwordx4 v12, s[64:67], s70 offen  lds
    s_add_u32 m0, s68, 91136
    s_mov_b32 s70, 9216
    buffer_load_dwordx4 v12, s[64:67], s70 offen  lds
    s_waitcnt vmcnt(10)
    s_barrier
    s_branch K_P2_EARLY
K_FFN_C:
    v_lshrrev_b32 v180, 4, v1
    v_bfe_u32 v2, v1, 2, 2
    v_lshl_add_u32 v2, v180, 3, v2
    v_and_b32 v3, 3, v1
    v_lshlrev_b32 v3, 3, v3
    v_lshl_add_u32 v181, v2, 6, v3
    s_bfe_u32 s3, s30, 0x10001
    s_mul_i32 s3, s3, 40960
    s_and_b32 s70, s30, 1
    s_lshl_b32 s70, s70, 5
    s_add_u32 s3, s3, s70
    s_add_u32 s3, s3, 0
    v_add_u32 v181, s3, v181
    v_mul_u32_u24 v182, 1280, v2
    s_and_b32 s3, s30, 3
    s_mul_i32 s3, s3, 320
    s_add_u32 s3, s3, 81920
    v_add3_u32 v182, v182, v3, s3
    v_mov_b32 v183, 123904
    s_cmp_lg_u32 s30, 5
    s_cbranch_scc1 K_KW
    s_mov_b32 s3, 131072
K_KPOLL:
    s_load_dwordx2 s[68:69], s[6:7], s42 offset:128 glc
    s_waitcnt lgkmcnt(0)
    s_min_u32 s33, s68, s69
    s_cmp_lg_u32 s33, 0
    s_cbranch_scc1 K_KGOT
    s_sleep 2
    s_sub_u32 s3, s3, 1
    s_cbranch_scc0 K_KPOLL
K_KGOT:
    v_mov_b32 v176, s68
    v_mov_b32 v177, s69
    ds_write_b64 v183, v[176:177]
    v_lshlrev_b32 v2, 4, v1
    s_and_b32 s70, s68, 0x7ff
    s_sub_u32 s70, 2047, s70
    s_mul_i32 s70, s70, 1280
    s_mov_b32 m0, 134208
    s_mov_b64 exec, -1
    buffer_load_dwordx4 v2, s[12:15], s70 offen lds
    s_mov_b64 exec, 0xffff
    buffer_load_dwordx4 v2, s[12:15], s70 offen offset:1024 lds
    s_and_b32 s70, s69, 0x7ff
    s_sub_u32 s70, 2047, s70
    s_mul_i32 s70, s70, 1280
    s_mov_b32 m0, 135552
    s_mov_b64 exec, -1
    buffer_load_dwordx4 v2, s[12:15], s70 offen lds
    s_mov_b64 exec, 0xffff
    buffer_load_dwordx4 v2, s[12:15], s70 offen offset:1024 lds
    s_mov_b64 exec, -1
    v_mov_b32 v3, 16
    s_waitcnt vmcnt(0)
    ds_write_b32 v13, v3 offset:48
    s_branch K_KW2
K_KW:
    s_cmp_lt_u32 s30, 6
    s_cbranch_scc1 K_KW2
    s_cmp_eq_u32 s30, 6
    s_cbranch_scc1 K_CHF0
    s_branch K_CHF1
K_WRET_F:
K_KW2:
    s_branch K_J79c4
K_CHF0:
K_STF34:
    s_branch K_STF36
    s_nop 0
K_J79c4:
    v_and_b32 v2, 1, v1
    v_mul_u32_u24 v9, 1344, v2
    v_lshl_add_u32 v9, v180, 4, v9
    v_add_u32 v9, 134208, v9
    v_and_b32 v2, 1, v1
    v_lshlrev_b32 v192, 6, v2
    v_lshl_add_u32 v192, v180, 4, v192
    s_and_b32 s3, s30, 3
    s_lshl_b32 s3, s3, 7
    v_add3_u32 v193, v192, s3, v183
    v_add_u32 v192, 64, v193
    v_add_u32 v193, 1088, v193
    v_lshrrev_b32 v2, 5, v1
    v_bfe_u32 v3, v1, 4, 1
    v_lshl_add_u32 v3, v3, 1, v2
    v_lshlrev_b32 v3, 6, v3
    v_and_b32 v4, 15, v1
    v_lshl_add_u32 v3, v4, 2, v3
    v_add_u32 v194, 123968, v3
    v_lshlrev_b32 v4, 1, v1
    s_add_u32 s3, s3, 124992
    v_add_u32 v195, s3, v4
    v_and_b32 v2, 1, v1
    v_mul_u32_u24 v2, 2560, v2
    v_lshl_add_u32 v196, v180, 4, v2
    s_mul_i32 s70, s30, 640
    s_add_u32 s70, s70, 123456
    v_add_u32 v196, s70, v196
    v_mov_b32 v3, 1
    s_mov_b32 s3, 1048576
K_FGK:
    ds_read_b32 v2, v13 offset:48
    s_sleep 1
    s_sub_u32 s3, s3, 1
    s_waitcnt lgkmcnt(0)
    v_readfirstlane_b32 s33, v2
    s_nop 3
    s_cselect_b32 s33, 16, s33
    s_cmp_lt_u32 s33, 16
    s_cbranch_scc1 K_FGK
    ds_read_b128 v[96:99], v9 offset:0
    ds_read_b128 v[100:103], v9 offset:64
    ds_read_b128 v[104:107], v9 offset:128
    ds_read_b128 v[108:111], v9 offset:192
    ds_read_b128 v[112:115], v9 offset:256
    ds_read_b128 v[116:119], v9 offset:320
    ds_read_b128 v[120:123], v9 offset:384
    ds_read_b128 v[124:127], v9 offset:448
    ds_read_b128 v[128:131], v9 offset:512
    ds_read_b128 v[132:135], v9 offset:576
    ds_read_b128 v[136:139], v9 offset:640
    ds_read_b128 v[140:143], v9 offset:704
    ds_read_b128 v[144:147], v9 offset:768
    ds_read_b128 v[148:151], v9 offset:832
    ds_read_b128 v[152:155], v9 offset:896
    ds_read_b128 v[156:159], v9 offset:960
    ds_read_b128 v[160:163], v9 offset:1024
    ds_read_b128 v[164:167], v9 offset:1088
    ds_read_b128 v[168:171], v9 offset:1152
    ds_read_b128 v[172:175], v9 offset:1216
    s_setprio 3
    s_barrier
    ds_read_b64_tr_b16 v[16:17], v181 offset:0
    ds_read_b64_tr_b16 v[18:19], v181 offset:256
    ds_read_b64_tr_b16 v[20:21], v181 offset:2048
    ds_read_b64_tr_b16 v[22:23], v181 offset:2304
    ds_read_b64_tr_b16 v[24:25], v181 offset:4096
    ds_read_b64_tr_b16 v[26:27], v181 offset:4352
    ds_read_b64_tr_b16 v[28:29], v181 offset:6144
    ds_read_b64_tr_b16 v[30:31], v181 offset:6400
    ds_read_b64_tr_b16 v[32:33], v181 offset:8192
    ds_read_b64_tr_b16 v[34:35], v181 offset:8448
    ds_read_b64_tr_b16 v[36:37], v181 offset:10240
    ds_read_b64_tr_b16 v[38:39], v181 offset:10496
    ds_read_b64_tr_b16 v[40:41], v181 offset:12288
    ds_read_b64_tr_b16 v[42:43], v181 offset:12544
    ds_read_b64_tr_b16 v[44:45], v181 offset:14336
    ds_read_b64_tr_b16 v[46:47], v181 offset:14592
    ds_read_b64_tr_b16 v[48:49], v181 offset:16384
    ds_read_b64_tr_b16 v[50:51], v181 offset:16640
    ds_read_b64_tr_b16 v[52:53], v181 offset:18432
    ds_read_b64_tr_b16 v[54:55], v181 offset:18688
    ds_read_b64_tr_b16 v[56:57], v181 offset:20480
    ds_read_b64_tr_b16 v[58:59], v181 offset:20736
    ds_read_b64_tr_b16 v[60:61], v181 offset:22528
    ds_read_b64_tr_b16 v[62:63], v181 offset:22784
    ds_read_b64_tr_b16 v[64:65], v181 offset:24576
    ds_read_b64_tr_b16 v[66:67], v181 offset:24832
    ds_read_b64_tr_b16 v[68:69], v181 offset:26624
    ds_read_b64_tr_b16 v[70:71], v181 offset:26880
    ds_read_b64_tr_b16 v[72:73], v181 offset:28672
    ds_read_b64_tr_b16 v[74:75], v181 offset:28928
    ds_read_b64_tr_b16 v[76:77], v181 offset:30720
    ds_read_b64_tr_b16 v[78:79], v181 offset:30976
    ds_read_b64_tr_b16 v[80:81], v181 offset:32768
    ds_read_b64_tr_b16 v[82:83], v181 offset:33024
    ds_read_b64_tr_b16 v[84:85], v181 offset:34816
    ds_read_b64_tr_b16 v[86:87], v181 offset:35072
    ds_read_b64_tr_b16 v[88:89], v181 offset:36864
    ds_read_b64_tr_b16 v[90:91], v181 offset:37120
    ds_read_b64_tr_b16 v[92:93], v181 offset:38912
    ds_read_b64_tr_b16 v[94:95], v181 offset:39168
    s_waitcnt lgkmcnt(0)
    s_barrier
    v_mfma_f32_16x16x32_bf16 v[184:187], v[16:19], v[96:99], 0
    v_mfma_f32_16x16x32_bf16 v[188:191], v[20:23], v[100:103], 0
    v_mfma_f32_16x16x32_bf16 v[184:187], v[24:27], v[104:107], v[184:187]
    v_mfma_f32_16x16x32_bf16 v[188:191], v[28:31], v[108:111], v[188:191]
    v_mfma_f32_16x16x32_bf16 v[184:187], v[32:35], v[112:115], v[184:187]
    v_mfma_f32_16x16x32_bf16 v[188:191], v[36:39], v[116:119], v[188:191]
    v_mfma_f32_16x16x32_bf16 v[184:187], v[40:43], v[120:123], v[184:187]
    v_mfma_f32_16x16x32_bf16 v[188:191], v[44:47], v[124:127], v[188:191]
    v_mfma_f32_16x16x32_bf16 v[184:187], v[48:51], v[128:131], v[184:187]
    v_mfma_f32_16x16x32_bf16 v[188:191], v[52:55], v[132:135], v[188:191]
    v_mfma_f32_16x16x32_bf16 v[184:187], v[56:59], v[136:139], v[184:187]
    v_mfma_f32_16x16x32_bf16 v[188:191], v[60:63], v[140:143], v[188:191]
    v_mfma_f32_16x16x32_bf16 v[184:187], v[64:67], v[144:147], v[184:187]
    v_mfma_f32_16x16x32_bf16 v[188:191], v[68:71], v[148:151], v[188:191]
    v_mfma_f32_16x16x32_bf16 v[184:187], v[72:75], v[152:155], v[184:187]
    v_mfma_f32_16x16x32_bf16 v[188:191], v[76:79], v[156:159], v[188:191]
    v_mfma_f32_16x16x32_bf16 v[184:187], v[80:83], v[160:163], v[184:187]
    v_mfma_f32_16x16x32_bf16 v[188:191], v[84:87], v[164:167], v[188:191]
    v_mfma_f32_16x16x32_bf16 v[184:187], v[88:91], v[168:171], v[184:187]
    v_mfma_f32_16x16x32_bf16 v[188:191], v[92:95], v[172:175], v[188:191]
    s_nop 7
    v_add_f32 v184, v184, v188
    v_add_f32 v185, v185, v189
    v_add_f32 v186, v186, v190
    v_add_f32 v187, v187, v191
    s_mov_b32 exec_lo, 0x00030003
    s_mov_b32 exec_hi, 0x00030003
    ds_write_b128 v192, v[184:187]
    s_mov_b64 exec, 1
    ds_add_u32 v13, v3 offset:52
    s_mov_b64 exec, -1
    s_cmp_lg_u32 s30, 6
    s_cbranch_scc1 K_NOS6B
    v_lshl_add_u32 v4, v1, 2, s42
    s_branch K_J7d8c
K_CHF1:
K_STF35:
    s_branch K_WRET_F
    s_nop 0
K_J7d8c:
    global_load_dword v7, v4, s[6:7] offset:256 sc1
    v_and_b32 v4, 0xfffffe04, v4
    global_load_dword v6, v4, s[6:7] offset:128 sc1
K_NOS6B:
    s_mov_b32 s3, 1048576
K_FGP:
    ds_read_b32 v2, v13 offset:52
    s_sleep 1
    s_sub_u32 s3, s3, 1
    s_waitcnt lgkmcnt(0)
    v_readfirstlane_b32 s33, v2
    s_nop 3
    s_cselect_b32 s33, 8, s33
    s_cmp_lt_u32 s33, 8
    s_cbranch_scc1 K_FGP
    ds_read_b32 v200, v194
    ds_read_b32 v202, v194 offset:256
    ds_read_b64_tr_b16 v[16:17], v182 offset:0
    ds_read_b64_tr_b16 v[18:19], v182 offset:5120
    ds_read_b64_tr_b16 v[20:21], v182 offset:32
    ds_read_b64_tr_b16 v[22:23], v182 offset:5152
    ds_read_b64_tr_b16 v[24:25], v182 offset:64
    ds_read_b64_tr_b16 v[26:27], v182 offset:5184
    ds_read_b64_tr_b16 v[28:29], v182 offset:96
    ds_read_b64_tr_b16 v[30:31], v182 offset:5216
    ds_read_b64_tr_b16 v[32:33], v182 offset:128
    ds_read_b64_tr_b16 v[34:35], v182 offset:5248
    ds_read_b64_tr_b16 v[36:37], v182 offset:160
    ds_read_b64_tr_b16 v[38:39], v182 offset:5280
    ds_read_b64_tr_b16 v[40:41], v182 offset:192
    ds_read_b64_tr_b16 v[42:43], v182 offset:5312
    s_waitcnt lgkmcnt(14)
    v_cvt_pk_bf16_f32 v200, v200, v200
    v_lshlrev_b32 v200, 16, v200
    v_cvt_pk_bf16_f32 v202, v202, v202
    v_lshlrev_b32 v202, 16, v202
    v_mul_f32 v201, 0xbfb8aa3b, v200
    v_exp_f32 v201, v201
    s_nop 0
    v_add_f32 v201, 1.0, v201
    v_rcp_f32 v201, v201
    s_nop 0
    v_mul_f32 v200, v200, v201
    v_cvt_pk_bf16_f32 v200, v200, v200
    v_lshlrev_b32 v200, 16, v200
    v_mul_f32 v200, v200, v202
    v_cvt_pk_bf16_f32 v200, v200, v200
    ds_write_b16 v195, v200
    s_waitcnt lgkmcnt(0)
    ds_read_b128 v[200:203], v193
    ds_read_b64_tr_b16 v[44:45], v182 offset:224
    ds_read_b64_tr_b16 v[46:47], v182 offset:5344
    ds_read_b64_tr_b16 v[48:49], v182 offset:256
    ds_read_b64_tr_b16 v[50:51], v182 offset:5376
    ds_read_b64_tr_b16 v[52:53], v182 offset:288
    ds_read_b64_tr_b16 v[54:55], v182 offset:5408
    s_waitcnt lgkmcnt(6)
    v_mfma_f32_16x16x32_bf16 v[96:99], v[16:19], v[200:203], 0
    v_mfma_f32_16x16x32_bf16 v[100:103], v[20:23], v[200:203], 0
    v_mfma_f32_16x16x32_bf16 v[104:107], v[24:27], v[200:203], 0
    v_mfma_f32_16x16x32_bf16 v[108:111], v[28:31], v[200:203], 0
    v_mfma_f32_16x16x32_bf16 v[112:115], v[32:35], v[200:203], 0
    v_mfma_f32_16x16x32_bf16 v[116:119], v[36:39], v[200:203], 0
    v_mfma_f32_16x16x32_bf16 v[120:123], v[40:43], v[200:203], 0
    s_waitcnt lgkmcnt(4)
    v_mfma_f32_16x16x32_bf16 v[124:127], v[44:47], v[200:203], 0
    s_waitcnt lgkmcnt(2)
    v_mfma_f32_16x16x32_bf16 v[128:131], v[48:51], v[200:203], 0
    s_waitcnt lgkmcnt(0)
    v_mfma_f32_16x16x32_bf16 v[132:135], v[52:55], v[200:203], 0
    s_mov_b32 exec_lo, 0x00030003
    s_mov_b32 exec_hi, 0x00030003
    ds_write_b128 v196, v[96:99] offset:0
    ds_write_b128 v196, v[100:103] offset:64
    ds_write_b128 v196, v[104:107] offset:128
    ds_write_b128 v196, v[108:111] offset:192
    ds_write_b128 v196, v[112:115] offset:256
    ds_write_b128 v196, v[116:119] offset:320
    ds_write_b128 v196, v[120:123] offset:384
    ds_write_b128 v196, v[124:127] offset:448
    ds_write_b128 v196, v[128:131] offset:512
    ds_write_b128 v196, v[132:135] offset:576
    v_mov_b32 v3, 1
    s_mov_b64 exec, 1
    ds_add_u32 v13, v3 offset:52
    s_mov_b64 exec, -1
    s_cmp_lg_u32 s30, 4
    s_cbranch_scc1 K_P2
    v_lshlrev_b32 v3, 4, v1
    v_add_u32 v4, 126016, v3
    s_mul_i32 s70, s43, 5120
    s_add_u32 s71, s70, 4096
    s_mov_b32 s3, 1048576
K_FGQ:
    s_branch K_PG7
.p2align 12
K_STF36:
    s_branch K_WRET_F
    s_nop 0
K_PG7:
    ds_read_b32 v2, v13 offset:52
    s_sleep 1
    s_sub_u32 s3, s3, 1
    s_waitcnt lgkmcnt(0)
    v_readfirstlane_b32 s33, v2
    s_nop 3
    s_cselect_b32 s33, 12, s33
    s_cmp_lt_u32 s33, 12
    s_cbranch_scc1 K_FGQ
    ds_read_b128 v[16:19], v4 offset:0
    ds_read_b128 v[20:23], v4 offset:1024
    ds_read_b128 v[24:27], v4 offset:2048
    ds_read_b128 v[28:31], v4 offset:3072
    ds_read_b128 v[32:35], v4 offset:4096
    s_waitcnt lgkmcnt(4)
    buffer_store_dwordx4 v[16:19], v3, s[60:63], s70 offen offset:0 sc1
    s_waitcnt lgkmcnt(3)
    buffer_store_dwordx4 v[20:23], v3, s[60:63], s70 offen offset:1024 sc1
    s_waitcnt lgkmcnt(2)
    buffer_store_dwordx4 v[24:27], v3, s[60:63], s70 offen offset:2048 sc1
    s_waitcnt lgkmcnt(1)
    buffer_store_dwordx4 v[28:31], v3, s[60:63], s70 offen offset:3072 sc1
    s_waitcnt lgkmcnt(0)
    buffer_store_dwordx4 v[32:35], v3, s[60:63], s71 offen offset:0 sc1
    s_mov_b32 s3, 1
    s_waitcnt vmcnt(0)
    s_atomic_add s3, s[6:7], 606720 glc
    ds_read_b64 v[176:177], v183
    s_waitcnt lgkmcnt(0)
    s_cmp_lg_u32 s3, 53
    s_cbranch_scc1 K_P2
    v_readfirstlane_b32 s70, v176
    s_and_b32 s70, s70, 0x7ff
    s_sub_u32 s70, 2047, s70
    s_lshr_b32 s70, s70, 7
    s_mul_i32 s70, s70, 5120
    s_atomic_add s3, s[6:7], s70 offset:524424
    s_atomic_add s3, s[6:7], s70 offset:524936
    s_atomic_add s3, s[6:7], s70 offset:525448
    s_atomic_add s3, s[6:7], s70 offset:525960
    s_atomic_add s3, s[6:7], s70 offset:526472
    s_atomic_add s3, s[6:7], s70 offset:526984
    s_atomic_add s3, s[6:7], s70 offset:527496
    s_atomic_add s3, s[6:7], s70 offset:528008
    s_atomic_add s3, s[6:7], s70 offset:528520
    s_atomic_add s3, s[6:7], s70 offset:529032
    v_readfirstlane_b32 s70, v177
    s_and_b32 s70, s70, 0x7ff
    s_sub_u32 s70, 2047, s70
    s_lshr_b32 s70, s70, 7
    s_mul_i32 s70, s70, 5120
    s_atomic_add s3, s[6:7], s70 offset:524424
    s_atomic_add s3, s[6:7], s70 offset:524936
    s_atomic_add s3, s[6:7], s70 offset:525448
    s_atomic_add s3, s[6:7], s70 offset:525960
    s_atomic_add s3, s[6:7], s70 offset:526472
    s_atomic_add s3, s[6:7], s70 offset:526984
    s_atomic_add s3, s[6:7], s70 offset:527496
    s_atomic_add s3, s[6:7], s70 offset:528008
    s_atomic_add s3, s[6:7], s70 offset:528520
    s_atomic_add s3, s[6:7], s70 offset:529032
    s_waitcnt lgkmcnt(0)
    s_branch K_P2
K_CODE_END:
.section .rodata,"a"
.p2align 6
.amdhsa_kernel gated_mix__sliding_local_dilated__moe_arch_mod__prompt_kernel
  .amdhsa_next_free_vgpr 248
  .amdhsa_next_free_sgpr 79
  .amdhsa_accum_offset 248
  .amdhsa_group_segment_fixed_size 0
  .amdhsa_kernarg_size 96
  .amdhsa_user_sgpr_count 2
  .amdhsa_user_sgpr_kernarg_segment_ptr 1
  .amdhsa_system_sgpr_workgroup_id_x 1
.end_amdhsa_kernel
```

```asm
; @launch grid=(256,1,1) block=(512,1,1) lds=163840
.amdgcn_target "amdgcn-amd-amdhsa--gfx950"
.text
K_CPL = 32
.p2align 12
.p2align 8
.globl gated_mix__sliding_local_dilated__moe_arch_mod__prompt_kernel
.type gated_mix__sliding_local_dilated__moe_arch_mod__prompt_kernel,@function
gated_mix__sliding_local_dilated__moe_arch_mod__prompt_kernel:
    s_cmp_ge_u32 s2, 256
    s_cbranch_scc1 K_EXIT
    s_load_dwordx2 s[12:13], s[0:1], 0
    s_load_dwordx2 s[16:17], s[0:1], 8
    s_load_dwordx4 s[4:7], s[0:1], 80
    s_load_dwordx2 s[8:9], s[0:1], 16
    s_load_dwordx2 s[10:11], s[0:1], 72
    v_readfirstlane_b32 s30, v0
    s_mov_b32 s14, 0x280000
    s_mov_b32 s15, 0x20000
    s_lshr_b32 s30, s30, 6
    s_cmp_ge_u32 s2, 64
    s_cbranch_scc1 K_MAIN
    s_load_dwordx8 s[44:51], s[0:1], 32
    s_load_dwordx2 s[52:53], s[0:1], 64
    s_getpc_b64 s[38:39]
K_PC:
    s_lshr_b32 s3, s2, 3
    s_mul_i32 s3, s3, K_CPL
    v_add_u32 v2, s3, v0
    v_lshlrev_b32 v2, 7, v2
    v_min_u32 v2, K_CODE_END-K_PC-4, v2
    v_cmp_gt_u32 vcc, K_CPL, v0
    s_and_saveexec_b64 s[20:21], vcc
    s_cbranch_execz K_NOPF
    global_load_dword v6, v2, s[38:39]
K_NOPF:
    s_mov_b64 exec, -1
    s_cmp_lg_u32 s30, 4
    s_cbranch_scc1 K_AUX
    s_min_u32 s3, s2, 8
    s_mul_i32 s3, s3, 10240
    s_add_u32 s33, s3, 10240
    s_cmp_lt_u32 s2, 8
    s_cbranch_scc1 K_ZS
    s_cmp_lg_u32 s2, 63
    s_cbranch_scc1 K_AUX
    s_mov_b32 s33, 0
K_ZS:
    v_lshlrev_b32 v2, 4, v0
    v_mov_b32 v8, 0
    v_mov_b32 v9, 0
    v_mov_b32 v10, 0
    v_mov_b32 v11, 0
    s_waitcnt lgkmcnt(0)
    s_add_u32 s20, s6, 0x7f000
    s_addc_u32 s21, s7, 0
    s_mov_b32 s22, 0x15400
    s_mov_b32 s23, 0x20000
K_ZL:
    buffer_store_dwordx4 v[8:11], v2, s[20:23], s3 offen sc1
    s_add_u32 s3, s3, 1024
    s_cmp_lt_u32 s3, s33
    s_cbranch_scc1 K_ZL
    s_branch K_AUX
K_MAIN:
    s_cmp_ge_u32 s30, 4
    s_cbranch_scc1 K_CONS
    s_bfe_u32 s3, s2, 0x20001
    s_mul_i32 s44, s3, 675840
    s_lshr_b32 s33, s2, 6
    s_mul_i32 s3, s33, 225280
    s_add_u32 s44, s44, s3
    s_mul_i32 s3, s30, 61440
    s_add_u32 s44, s44, s3
    s_sub_u32 s44, s44, 245760
    v_bfe_u32 v3, v0, 4, 2
    s_lshr_b32 s3, s2, 1
    s_and_b32 s3, s3, 28
    s_or_b32 s3, s3, 0x40000
    v_lshlrev_b32 v2, 1, v3
    v_sub_u32 v2, v0, v2
    s_mov_b32 s49, 0x90729119
    s_cmp_eq_u32 s33, 2
    s_cselect_b32 s49, 0x55274425, s49
    s_cmp_eq_u32 s33, 3
    s_cselect_b32 s49, 0x60758960, s49
    s_bfe_u32 s49, s49, s3
    s_bfe_u32 s32, 0x64317520, s3
    v_and_b32 v2, 15, v2
    v_mul_u32_u24 v5, 3840, v3
    s_lshl_b32 s3, s2, 2
    s_lshr_b32 s3, 0x43622130, s3
    s_and_b32 s3, s3, 15
    s_add_u32 s49, s49, s3
    s_mov_b32 s33, 0x00a55a
    v_subrev_u32 v5, 160, v5
    s_sub_u32 s3, s49, 10
    s_cselect_b32 s49, s49, s3
    v_mul_u32_u24 v4, 52, v2
    v_lshrrev_b32 v4, 5, v4
    v_and_b32 v4, 24, v4
    v_bfe_u32 v4, s33, v4, 8
    v_add_u32 v4, v4, v2
    v_lshl_add_u32 v218, v4, 4, v5
    v_add_u32 v4, 1, v2
    v_lshrrev_b32 v4, 4, v4
    v_lshl_add_u32 v218, v4, 28, v218
    v_xor_b32 v2, 8, v2
    v_mul_u32_u24 v4, 52, v2
    v_lshrrev_b32 v4, 5, v4
    v_and_b32 v4, 24, v4
    v_bfe_u32 v4, s33, v4, 8
    v_add_u32 v4, v4, v2
    v_lshl_add_u32 v219, v4, 4, v5
    v_add_u32 v4, 1, v2
    v_lshrrev_b32 v4, 4, v4
    v_lshl_add_u32 v219, v4, 28, v219
    s_bitcmp1_b32 s2, 0
    s_cselect_b32 s3, 8, 0
    s_add_u32 s32, s32, s3
    s_mul_i32 s50, s32, 80
    s_mul_i32 s3, s30, 61440
    s_add_u32 s50, s50, s3
    s_lshl_b32 s46, s30, 12
    s_add_u32 s46, s46, 24576
    s_mul_i32 s45, s30, 6144
    s_mov_b32 s18, 0x258000
    s_mov_b32 s19, 0x20000
    v_xor_b32 v3, v3, v0
    v_and_b32 v3, 7, v3
    v_bfe_u32 v2, v0, 3, 3
    v_mul_u32_u24 v2, 1280, v2
    v_lshl_add_u32 v216, v3, 4, v2
    v_xor_b32 v217, 64, v216
    s_lshl_b32 s47, s49, 7
    s_mul_i32 s48, s49, 245760
    s_add_u32 s51, s44, s47
    s_add_u32 s48, s48, s50
    s_add_u32 s49, s49, 1
    s_cmp_eq_u32 s49, 10
    s_cselect_b32 s49, 0, s49
    s_waitcnt lgkmcnt(0)
    s_add_u32 m0, s46, 81920
    s_add_u32 s52, s48, 0
    buffer_load_dwordx4 v218, s[16:19], s52 offen lds
    s_add_u32 m0, s45, 81920
    s_max_i32 s52, s51, s47
    buffer_load_dwordx4 v216, s[12:15], s52 offen lds
    s_add_u32 m0, s46, 82944
    s_add_u32 s52, s48, 15360
    buffer_load_dwordx4 v218, s[16:19], s52 offen lds
    s_add_u32 m0, s45, 82944
    s_add_u32 s52, s51, 10240
    s_max_i32 s52, s52, s47
    buffer_load_dwordx4 v217, s[12:15], s52 offen lds
    s_add_u32 m0, s45, 83968
    s_add_u32 s52, s51, 20480
    buffer_load_dwordx4 v216, s[12:15], s52 offen lds
    s_add_u32 m0, s46, 83968
    s_add_u32 s52, s48, 30720
    buffer_load_dwordx4 v219, s[16:19], s52 offen lds
    s_add_u32 m0, s45, 84992
    s_add_u32 s52, s51, 30720
    buffer_load_dwordx4 v217, s[12:15], s52 offen lds
    s_add_u32 m0, s46, 84992
    s_add_u32 s52, s48, 46080
    buffer_load_dwordx4 v219, s[16:19], s52 offen lds
    s_add_u32 m0, s45, 86016
    s_add_u32 s52, s51, 40960
    buffer_load_dwordx4 v216, s[12:15], s52 offen lds
    s_add_u32 m0, s45, 87040
    s_add_u32 s52, s51, 51200
    buffer_load_dwordx4 v217, s[12:15], s52 offen lds
    s_lshl_b32 s47, s49, 7
    s_mul_i32 s48, s49, 245760
    s_add_u32 s51, s44, s47
    s_add_u32 s48, s48, s50
    s_add_u32 s49, s49, 1
    s_cmp_eq_u32 s49, 10
    s_cselect_b32 s49, 0, s49
    s_add_u32 m0, s46, 0
    s_add_u32 s52, s48, 0
    buffer_load_dwordx4 v218, s[16:19], s52 offen lds
    s_add_u32 m0, s45, 0
    s_max_i32 s52, s51, s47
    buffer_load_dwordx4 v216, s[12:15], s52 offen lds
    s_add_u32 m0, s46, 1024
    s_add_u32 s52, s48, 15360
    buffer_load_dwordx4 v218, s[16:19], s52 offen lds
    s_add_u32 m0, s45, 1024
    s_add_u32 s52, s51, 10240
    s_max_i32 s52, s52, s47
    buffer_load_dwordx4 v217, s[12:15], s52 offen lds
    s_add_u32 m0, s45, 2048
    s_add_u32 s52, s51, 20480
    buffer_load_dwordx4 v216, s[12:15], s52 offen lds
    s_add_u32 m0, s46, 2048
    s_add_u32 s52, s48, 30720
    buffer_load_dwordx4 v219, s[16:19], s52 offen lds
    s_mov_b32 s43, s30
    v_and_b32 v1, 63, v0
    v_mov_b32 v7, 0
    s_and_b32 s28, s2, 7
    s_lshr_b32 s29, s2, 3
    s_xor_b32 s30, s30, 4
    s_lshr_b32 s34, s29, 3
    s_lshl_b32 s34, s34, 2
    s_and_b32 s3, s29, 3
    s_add_u32 s34, s34, s3
    s_add_u32 s34, s34, 4
    s_bitcmp1_b32 s29, 2
    s_cselect_b32 s34, -1, s34
    s_cmp_lt_u32 s29, 8
    s_cselect_b32 s34, s29, s34
    s_lshl_b32 s40, s28, 1
    s_cmp_ge_u32 s34, 10
    s_addc_u32 s40, s40, 0
    s_sub_u32 s41, s34, 10
    s_cmp_ge_u32 s34, 10
    s_cselect_b32 s41, s41, s34
    s_mul_i32 s42, s28, 20
    s_add_u32 s42, s42, s34
    s_and_b32 s42, s42, 255
    s_lshl_b32 s42, s42, 9
    s_add_u32 s42, s42, 524288
    s_lshr_b32 s31, s28, 1
    s_mul_i32 s31, s31, 3
    s_lshr_b32 s3, s29, 3
    s_add_u32 s31, s31, s3
    s_sub_u32 s31, s31, 1
    s_and_b32 s32, s28, 1
    s_lshl_b32 s32, s32, 3
    s_and_b32 s3, s29, 7
    s_lshl_b32 s3, s3, 2
    s_lshr_b32 s3, 0x64317520, s3
    s_and_b32 s3, s3, 7
    s_add_u32 s32, s32, s3
    s_and_b32 s35, s29, 3
    s_and_b32 s3, s29, 4
    s_lshl_b32 s3, s3, 1
    s_add_u32 s35, s35, s3
    s_and_b32 s3, s28, 1
    s_lshl_b32 s3, s3, 2
    s_add_u32 s35, s35, s3
K_LOADER:
    s_mov_b32 s24, s8
    s_mov_b32 s25, s9
    s_mov_b32 s26, 0xc8000
    s_mov_b32 s27, 0x20000
    v_and_b32 v8, 15, v1
    v_lshrrev_b32 v9, 4, v1
    v_bfe_u32 v10, v1, 2, 2
    v_and_b32 v11, 3, v1
    s_add_u32 s20, s6, 0x100000
    s_addc_u32 s21, s7, 0
    s_mov_b32 s22, 0x280000
    s_mov_b32 s23, 0x20000
    s_lshr_b32 s53, s35, 2
    s_add_u32 s3, s53, s35
    s_lshl_b32 s3, s3, 12
    s_mul_i32 s33, s53, 19456
    s_lshl_b32 s53, s35, 8
    s_add_u32 s33, s33, s53
    s_add_u32 s33, s33, 16384
    s_mul_i32 s53, s31, 11
    s_add_u32 s54, s53, s43
    v_mov_b32 v3, s54
    v_lshrrev_b32 v2, 2, v3
    v_mul_u32_u24 v2, 76, v2
    v_add_lshl_u32 v2, v2, v3, 10
    v_lshl_add_u32 v2, v8, 4, v2
    v_add_u32 v220, s3, v2
    v_lshl_add_u32 v220, v9, 8, v220
    s_lshl_b32 s3, s43, 2
    v_add_u32 v4, s3, v9
    v_add_u32 v3, s53, v4
    v_lshrrev_b32 v2, 2, v3
    v_mul_u32_u24 v2, 76, v2
    v_add_lshl_u32 v2, v2, v3, 10
    v_lshl_add_u32 v2, v8, 4, v2
    v_add_u32 v221, s33, v2
    v_mov_b32 v5, 0x10000000
    v_cmp_gt_u32 vcc, 11, v4
    v_mov_b32 v224, -1
    v_mov_b32 v225, -1
    v_mov_b32 v226, -1
    v_mov_b32 v227, -1
    v_cndmask_b32 v221, v5, v221, vcc
    v_lshrrev_b32 v2, 3, v1
    v_mul_u32_u24 v2, 1280, v2
    v_lshrrev_b32 v3, 2, v1
    v_and_b32 v3, 4, v3
    v_and_b32 v4, 7, v1
    v_xor_b32 v3, v3, v4
    v_lshl_add_u32 v2, v3, 4, v2
    s_lshl_b32 s33, s41, 7
    v_add_u32 v222, s33, v2
    v_lshrrev_b32 v5, 5, v1
    v_mul_u32_u24 v5, 20480, v5
    v_add_u32 v5, v5, v222
    s_mov_b32 s30, s43
    s_waitcnt vmcnt(6)
    s_barrier
    s_add_u32 m0, s45, 3072
    s_add_u32 s52, s51, 30720
    buffer_load_dwordx4 v217, s[12:15], s52 offen lds
    s_add_u32 m0, s46, 3072
    s_add_u32 s52, s48, 46080
    buffer_load_dwordx4 v219, s[16:19], s52 offen lds
    s_add_u32 m0, s45, 4096
    s_add_u32 s52, s51, 40960
    buffer_load_dwordx4 v216, s[12:15], s52 offen lds
    s_add_u32 m0, s45, 5120
    s_add_u32 s52, s51, 51200
    buffer_load_dwordx4 v217, s[12:15], s52 offen lds
    s_lshl_b32 s47, s49, 7
    s_mul_i32 s48, s49, 245760
    s_add_u32 s51, s44, s47
    s_add_u32 s48, s48, s50
    s_add_u32 s49, s49, 1
    s_cmp_eq_u32 s49, 10
    s_cselect_b32 s49, 0, s49
    s_add_u32 m0, s46, 40960
    s_add_u32 s52, s48, 0
    buffer_load_dwordx4 v218, s[16:19], s52 offen lds
    s_add_u32 m0, s45, 40960
    s_max_i32 s52, s51, s47
    buffer_load_dwordx4 v216, s[12:15], s52 offen lds
    s_add_u32 m0, s46, 41984
    s_add_u32 s52, s48, 15360
    buffer_load_dwordx4 v218, s[16:19], s52 offen lds
    s_add_u32 m0, s45, 41984
    s_add_u32 s52, s51, 10240
    s_max_i32 s52, s52, s47
    buffer_load_dwordx4 v217, s[12:15], s52 offen lds
    s_add_u32 m0, s45, 43008
    s_add_u32 s52, s51, 20480
    buffer_load_dwordx4 v216, s[12:15], s52 offen lds
    s_add_u32 m0, s46, 43008
    s_add_u32 s52, s48, 30720
    buffer_load_dwordx4 v219, s[16:19], s52 offen lds
    s_waitcnt vmcnt(6)
    s_barrier
    s_add_u32 m0, s45, 44032
    s_add_u32 s52, s51, 30720
    buffer_load_dwordx4 v217, s[12:15], s52 offen lds
    s_add_u32 m0, s46, 44032
    s_add_u32 s52, s48, 46080
    buffer_load_dwordx4 v219, s[16:19], s52 offen lds
    s_add_u32 m0, s45, 45056
    s_add_u32 s52, s51, 40960
    buffer_load_dwordx4 v216, s[12:15], s52 offen lds
    s_add_u32 m0, s45, 46080
    s_add_u32 s52, s51, 51200
    buffer_load_dwordx4 v217, s[12:15], s52 offen lds
    s_lshl_b32 s47, s49, 7
    s_mul_i32 s48, s49, 245760
    s_add_u32 s51, s44, s47
    s_add_u32 s48, s48, s50
    s_add_u32 s49, s49, 1
    s_cmp_eq_u32 s49, 10
    s_cselect_b32 s49, 0, s49
    s_add_u32 m0, s46, 81920
    s_add_u32 s52, s48, 0
    buffer_load_dwordx4 v218, s[16:19], s52 offen lds
    s_add_u32 m0, s45, 81920
    s_max_i32 s52, s51, s47
    buffer_load_dwordx4 v216, s[12:15], s52 offen lds
    s_add_u32 m0, s46, 82944
    s_add_u32 s52, s48, 15360
    buffer_load_dwordx4 v218, s[16:19], s52 offen lds
    s_add_u32 m0, s45, 82944
    s_add_u32 s52, s51, 10240
    s_max_i32 s52, s52, s47
    buffer_load_dwordx4 v217, s[12:15], s52 offen lds
    s_add_u32 m0, s45, 83968
    s_add_u32 s52, s51, 20480
    buffer_load_dwordx4 v216, s[12:15], s52 offen lds
    s_add_u32 m0, s46, 83968
    s_add_u32 s52, s48, 30720
    buffer_load_dwordx4 v219, s[16:19], s52 offen lds
    s_waitcnt vmcnt(6)
    s_barrier
    s_add_u32 m0, s45, 84992
    s_add_u32 s52, s51, 30720
    buffer_load_dwordx4 v217, s[12:15], s52 offen lds
    s_add_u32 m0, s46, 84992
    s_add_u32 s52, s48, 46080
    buffer_load_dwordx4 v219, s[16:19], s52 offen lds
    s_add_u32 m0, s45, 86016
    s_add_u32 s52, s51, 40960
    buffer_load_dwordx4 v216, s[12:15], s52 offen lds
    s_add_u32 m0, s45, 87040
    s_add_u32 s52, s51, 51200
    buffer_load_dwordx4 v217, s[12:15], s52 offen lds
    s_lshl_b32 s47, s49, 7
    s_mul_i32 s48, s49, 245760
    s_add_u32 s51, s44, s47
    s_add_u32 s48, s48, s50
    s_add_u32 s49, s49, 1
    s_cmp_eq_u32 s49, 10
    s_cselect_b32 s49, 0, s49
    s_add_u32 m0, s46, 0
    s_add_u32 s52, s48, 0
    buffer_load_dwordx4 v218, s[16:19], s52 offen lds
    s_add_u32 m0, s45, 0
    s_max_i32 s52, s51, s47
    buffer_load_dwordx4 v216, s[12:15], s52 offen lds
    s_add_u32 m0, s46, 1024
    s_add_u32 s52, s48, 15360
    buffer_load_dwordx4 v218, s[16:19], s52 offen lds
    s_add_u32 m0, s45, 1024
    s_add_u32 s52, s51, 10240
    s_max_i32 s52, s52, s47
    buffer_load_dwordx4 v217, s[12:15], s52 offen lds
    s_add_u32 m0, s45, 2048
    s_add_u32 s52, s51, 20480
    buffer_load_dwordx4 v216, s[12:15], s52 offen lds
    s_add_u32 m0, s46, 2048
    s_add_u32 s52, s48, 30720
    buffer_load_dwordx4 v219, s[16:19], s52 offen lds
    s_waitcnt vmcnt(6)
    s_barrier
    s_add_u32 m0, s45, 3072
    s_add_u32 s52, s51, 30720
    buffer_load_dwordx4 v217, s[12:15], s52 offen lds
    s_add_u32 m0, s46, 3072
    s_add_u32 s52, s48, 46080
    buffer_load_dwordx4 v219, s[16:19], s52 offen lds
    s_add_u32 m0, s45, 4096
    s_add_u32 s52, s51, 40960
    buffer_load_dwordx4 v216, s[12:15], s52 offen lds
    s_add_u32 m0, s45, 5120
    s_add_u32 s52, s51, 51200
    buffer_load_dwordx4 v217, s[12:15], s52 offen lds
    s_lshl_b32 s47, s49, 7
    s_mul_i32 s48, s49, 245760
    s_add_u32 s51, s44, s47
    s_add_u32 s48, s48, s50
    s_add_u32 s49, s49, 1
    s_cmp_eq_u32 s49, 10
    s_cselect_b32 s49, 0, s49
    s_add_u32 m0, s46, 40960
    s_add_u32 s52, s48, 0
    buffer_load_dwordx4 v218, s[16:19], s52 offen lds
    s_add_u32 m0, s45, 40960
    s_max_i32 s52, s51, s47
    buffer_load_dwordx4 v216, s[12:15], s52 offen lds
    s_add_u32 m0, s46, 41984
    s_add_u32 s52, s48, 15360
    buffer_load_dwordx4 v218, s[16:19], s52 offen lds
    s_add_u32 m0, s45, 41984
    s_add_u32 s52, s51, 10240
    s_max_i32 s52, s52, s47
    buffer_load_dwordx4 v217, s[12:15], s52 offen lds
    s_add_u32 m0, s45, 43008
    s_add_u32 s52, s51, 20480
    buffer_load_dwordx4 v216, s[12:15], s52 offen lds
    s_add_u32 m0, s46, 43008
    s_add_u32 s52, s48, 30720
    buffer_load_dwordx4 v219, s[16:19], s52 offen lds
    s_waitcnt vmcnt(6)
    s_barrier
    s_add_u32 m0, s45, 44032
    s_add_u32 s52, s51, 30720
    buffer_load_dwordx4 v217, s[12:15], s52 offen lds
    s_add_u32 m0, s46, 44032
    s_add_u32 s52, s48, 46080
    buffer_load_dwordx4 v219, s[16:19], s52 offen lds
    s_add_u32 m0, s45, 45056
    s_add_u32 s52, s51, 40960
    buffer_load_dwordx4 v216, s[12:15], s52 offen lds
    s_add_u32 m0, s45, 46080
    s_add_u32 s52, s51, 51200
    buffer_load_dwordx4 v217, s[12:15], s52 offen lds
    s_lshl_b32 s47, s49, 7
    s_mul_i32 s48, s49, 245760
    s_add_u32 s51, s44, s47
    s_add_u32 s48, s48, s50
    s_add_u32 s49, s49, 1
    s_cmp_eq_u32 s49, 10
    s_cselect_b32 s49, 0, s49
    s_add_u32 m0, s46, 81920
    s_add_u32 s52, s48, 0
    buffer_load_dwordx4 v218, s[16:19], s52 offen lds
    s_add_u32 m0, s45, 81920
    s_max_i32 s52, s51, s47
    buffer_load_dwordx4 v216, s[12:15], s52 offen lds
    s_add_u32 m0, s46, 82944
    s_add_u32 s52, s48, 15360
    buffer_load_dwordx4 v218, s[16:19], s52 offen lds
    s_add_u32 m0, s45, 82944
    s_add_u32 s52, s51, 10240
    s_max_i32 s52, s52, s47
    buffer_load_dwordx4 v217, s[12:15], s52 offen lds
    s_add_u32 m0, s45, 83968
    s_add_u32 s52, s51, 20480
    buffer_load_dwordx4 v216, s[12:15], s52 offen lds
    s_add_u32 m0, s46, 83968
    s_add_u32 s52, s48, 30720
    buffer_load_dwordx4 v219, s[16:19], s52 offen lds
    s_waitcnt vmcnt(6)
    s_barrier
    s_add_u32 m0, s45, 84992
    s_add_u32 s52, s51, 30720
    buffer_load_dwordx4 v217, s[12:15], s52 offen lds
    s_add_u32 m0, s46, 84992
    s_add_u32 s52, s48, 46080
    buffer_load_dwordx4 v219, s[16:19], s52 offen lds
    s_add_u32 m0, s45, 86016
    s_add_u32 s52, s51, 40960
    buffer_load_dwordx4 v216, s[12:15], s52 offen lds
    s_add_u32 m0, s45, 87040
    s_add_u32 s52, s51, 51200
    buffer_load_dwordx4 v217, s[12:15], s52 offen lds
    s_lshl_b32 s47, s49, 7
    s_mul_i32 s48, s49, 245760
    s_add_u32 s51, s44, s47
    s_add_u32 s48, s48, s50
    s_add_u32 s49, s49, 1
    s_cmp_eq_u32 s49, 10
    s_cselect_b32 s49, 0, s49
    s_add_u32 m0, s46, 0
    s_add_u32 s52, s48, 0
    buffer_load_dwordx4 v218, s[16:19], s52 offen lds
    s_add_u32 m0, s45, 0
    s_max_i32 s52, s51, s47
    buffer_load_dwordx4 v216, s[12:15], s52 offen lds
    s_add_u32 m0, s46, 1024
    s_add_u32 s52, s48, 15360
    buffer_load_dwordx4 v218, s[16:19], s52 offen lds
    s_add_u32 m0, s45, 1024
    s_add_u32 s52, s51, 10240
    s_max_i32 s52, s52, s47
    buffer_load_dwordx4 v217, s[12:15], s52 offen lds
    s_add_u32 m0, s45, 2048
    s_add_u32 s52, s51, 20480
    buffer_load_dwordx4 v216, s[12:15], s52 offen lds
    s_add_u32 m0, s46, 2048
    s_add_u32 s52, s48, 30720
    buffer_load_dwordx4 v219, s[16:19], s52 offen lds
    s_waitcnt vmcnt(6)
    s_barrier
    s_add_u32 m0, s45, 3072
    s_add_u32 s52, s51, 30720
    buffer_load_dwordx4 v217, s[12:15], s52 offen lds
    s_add_u32 m0, s46, 3072
    s_add_u32 s52, s48, 46080
    buffer_load_dwordx4 v219, s[16:19], s52 offen lds
    s_add_u32 m0, s45, 4096
    s_add_u32 s52, s51, 40960
    s_branch K_PG0
.p2align 12
K_CHM0:
K_STM0:
    s_branch K_WRET_M
    s_nop 0
K_PG0:
    buffer_load_dwordx4 v216, s[12:15], s52 offen lds
    s_add_u32 m0, s45, 5120
    s_add_u32 s52, s51, 51200
    buffer_load_dwordx4 v217, s[12:15], s52 offen lds
    s_lshl_b32 s47, s49, 7
    s_mul_i32 s48, s49, 245760
    s_add_u32 s51, s44, s47
    s_add_u32 s48, s48, s50
    s_add_u32 s49, s49, 1
    s_cmp_eq_u32 s49, 10
    s_cselect_b32 s49, 0, s49
    s_add_u32 m0, s46, 40960
    s_add_u32 s52, s48, 0
    buffer_load_dwordx4 v218, s[16:19], s52 offen lds
    s_add_u32 m0, s45, 40960
    s_max_i32 s52, s51, s47
    buffer_load_dwordx4 v216, s[12:15], s52 offen lds
    s_add_u32 m0, s46, 41984
    s_add_u32 s52, s48, 15360
    buffer_load_dwordx4 v218, s[16:19], s52 offen lds
    s_add_u32 m0, s45, 41984
    s_add_u32 s52, s51, 10240
    s_max_i32 s52, s52, s47
    buffer_load_dwordx4 v217, s[12:15], s52 offen lds
    s_add_u32 m0, s45, 43008
    s_add_u32 s52, s51, 20480
    buffer_load_dwordx4 v216, s[12:15], s52 offen lds
    s_add_u32 m0, s46, 43008
    s_add_u32 s52, s48, 30720
    buffer_load_dwordx4 v219, s[16:19], s52 offen lds
    s_waitcnt vmcnt(6)
    s_barrier
    s_add_u32 m0, s45, 44032
    s_add_u32 s52, s51, 30720
    buffer_load_dwordx4 v217, s[12:15], s52 offen lds
    s_add_u32 m0, s46, 44032
    s_add_u32 s52, s48, 46080
    buffer_load_dwordx4 v219, s[16:19], s52 offen lds
    s_add_u32 m0, s45, 45056
    s_add_u32 s52, s51, 40960
    buffer_load_dwordx4 v216, s[12:15], s52 offen lds
    s_add_u32 m0, s45, 46080
    s_add_u32 s52, s51, 51200
    buffer_load_dwordx4 v217, s[12:15], s52 offen lds
    s_lshl_b32 s47, s49, 7
    s_mul_i32 s48, s49, 245760
    s_add_u32 s51, s44, s47
    s_add_u32 s48, s48, s50
    s_add_u32 s49, s49, 1
    s_cmp_eq_u32 s49, 10
    s_cselect_b32 s49, 0, s49
    s_add_u32 m0, s46, 81920
    s_add_u32 s52, s48, 0
    buffer_load_dwordx4 v218, s[16:19], s52 offen lds
    s_add_u32 m0, s45, 81920
    s_max_i32 s52, s51, s47
    buffer_load_dwordx4 v216, s[12:15], s52 offen lds
    s_add_u32 m0, s46, 82944
    s_add_u32 s52, s48, 15360
    buffer_load_dwordx4 v218, s[16:19], s52 offen lds
    s_add_u32 m0, s45, 82944
    s_add_u32 s52, s51, 10240
    s_max_i32 s52, s52, s47
    buffer_load_dwordx4 v217, s[12:15], s52 offen lds
    s_add_u32 m0, s45, 83968
    s_add_u32 s52, s51, 20480
    buffer_load_dwordx4 v216, s[12:15], s52 offen lds
    s_add_u32 m0, s46, 83968
    s_add_u32 s52, s48, 30720
    buffer_load_dwordx4 v219, s[16:19], s52 offen lds
    s_waitcnt vmcnt(6)
    s_barrier
    s_load_dword s54, s[4:5], 192
    s_add_u32 m0, s45, 84992
    s_add_u32 s52, s51, 30720
    buffer_load_dwordx4 v217, s[12:15], s52 offen lds
    s_add_u32 m0, s46, 84992
    s_add_u32 s52, s48, 46080
    buffer_load_dwordx4 v219, s[16:19], s52 offen lds
    s_add_u32 m0, s45, 86016
    s_add_u32 s52, s51, 40960
    buffer_load_dwordx4 v216, s[12:15], s52 offen lds
    s_add_u32 m0, s45, 87040
    s_add_u32 s52, s51, 51200
    buffer_load_dwordx4 v217, s[12:15], s52 offen lds
    s_waitcnt lgkmcnt(0)
    s_cmp_ge_u32 s54, 8
    s_cbranch_scc1 K_ZO0
    s_mov_b32 s3, 16384
K_ZB0:
    v_mov_b32 v4, 192
    global_load_dword v4, v4, s[4:5] sc1
    s_waitcnt vmcnt(0)
    v_readfirstlane_b32 s33, v4
    s_cmp_ge_u32 s33, 8
    s_cbranch_scc1 K_ZO0
    s_sleep 8
    s_sub_u32 s3, s3, 1
    s_cbranch_scc0 K_ZB0
K_ZO0:
    s_cmp_eq_u32 s34, -1
    s_cbranch_scc1 K_NOLT
    s_lshl_b32 s47, s43, 2
    s_lshr_b32 s47, 0x7520, s47
    s_and_b32 s47, s47, 7
    s_mul_i32 s47, s47, 51200
    s_lshl_b32 s48, s43, 12
    s_add_u32 s3, s47, 0
    s_add_u32 m0, s48, 0
    s_nop 0
    buffer_load_dwordx4 v222, s[24:27], s3 offen lds
    s_add_u32 s3, s47, 10240
    s_add_u32 m0, s48, 1024
    s_nop 0
    buffer_load_dwordx4 v222, s[24:27], s3 offen lds
    s_add_u32 s3, s47, 25600
    s_add_u32 m0, s48, 2048
    s_nop 0
    buffer_load_dwordx4 v222, s[24:27], s3 offen lds
    s_add_u32 s3, s47, 35840
    s_add_u32 m0, s48, 3072
    s_nop 0
    buffer_load_dwordx4 v222, s[24:27], s3 offen lds
    s_add_u32 s3, s47, 409600
    s_add_u32 m0, s48, 20480
    s_nop 0
    buffer_load_dwordx4 v222, s[24:27], s3 offen lds
    s_add_u32 s3, s47, 419840
    s_add_u32 m0, s48, 21504
    s_nop 0
    buffer_load_dwordx4 v222, s[24:27], s3 offen lds
    s_add_u32 s3, s47, 435200
    s_add_u32 m0, s48, 22528
    s_nop 0
    buffer_load_dwordx4 v222, s[24:27], s3 offen lds
    s_add_u32 s3, s47, 445440
    s_add_u32 m0, s48, 23552
    s_nop 0
    buffer_load_dwordx4 v222, s[24:27], s3 offen lds
    s_lshl_b32 s48, s43, 10
    s_add_u32 s3, s47, 20480
    s_add_u32 m0, s48, 16384
    s_nop 0
    buffer_load_dwordx4 v5, s[24:27], s3 offen lds
    s_add_u32 s3, s47, 430080
    s_add_u32 m0, s48, 36864
    s_nop 0
    buffer_load_dwordx4 v5, s[24:27], s3 offen lds
    s_waitcnt vmcnt(10)
    s_barrier
    s_mov_b32 s33, 81920
    s_cmp_eq_u32 s43, 3
    s_cselect_b32 s3, 0, 163840
    buffer_store_dwordx4 v[224:227], v220, s[20:23], 0 offen sc1
    buffer_store_dwordx4 v[224:227], v220, s[20:23], s33 offen sc1
    buffer_store_dwordx4 v[224:227], v220, s[20:23], s3 offen sc1
    buffer_store_dwordx4 v[224:227], v221, s[20:23], 0 offen sc1
    s_lshl_b32 s47, s43, 2
    s_lshr_b32 s47, 0x6431, s47
    s_and_b32 s47, s47, 7
    s_mul_i32 s47, s47, 51200
    s_lshl_b32 s48, s43, 12
    s_add_u32 s3, s47, 0
    s_add_u32 m0, s48, 40960
    s_nop 0
    buffer_load_dwordx4 v222, s[24:27], s3 offen lds
    s_add_u32 s3, s47, 10240
    s_add_u32 m0, s48, 41984
    s_nop 0
    buffer_load_dwordx4 v222, s[24:27], s3 offen lds
    s_add_u32 s3, s47, 25600
    s_add_u32 m0, s48, 43008
    s_nop 0
    buffer_load_dwordx4 v222, s[24:27], s3 offen lds
    s_add_u32 s3, s47, 35840
    s_add_u32 m0, s48, 44032
    s_nop 0
    buffer_load_dwordx4 v222, s[24:27], s3 offen lds
    s_add_u32 s3, s47, 409600
    s_add_u32 m0, s48, 61440
    s_nop 0
    buffer_load_dwordx4 v222, s[24:27], s3 offen lds
    s_add_u32 s3, s47, 419840
    s_add_u32 m0, s48, 62464
    s_nop 0
    buffer_load_dwordx4 v222, s[24:27], s3 offen lds
    s_add_u32 s3, s47, 435200
    s_add_u32 m0, s48, 63488
    s_nop 0
    buffer_load_dwordx4 v222, s[24:27], s3 offen lds
    s_add_u32 s3, s47, 445440
    s_add_u32 m0, s48, 64512
    s_nop 0
    buffer_load_dwordx4 v222, s[24:27], s3 offen lds
    s_lshl_b32 s48, s43, 10
    s_add_u32 s3, s47, 20480
    s_add_u32 m0, s48, 57344
    s_nop 0
    buffer_load_dwordx4 v5, s[24:27], s3 offen lds
    s_add_u32 s3, s47, 430080
    s_add_u32 m0, s48, 77824
    s_nop 0
    buffer_load_dwordx4 v5, s[24:27], s3 offen lds
    v_mov_b32 v2, 158720
    v_mov_b32 v3, 1
    s_waitcnt vmcnt(10)
    s_mov_b64 exec, 1
    ds_add_u32 v2, v3 offset:28
    ds_add_u32 v2, v3 offset:32
    s_mov_b64 exec, -1
    s_branch K_P2_GM
K_NOLT:
    s_waitcnt vmcnt(0)
    s_barrier
    s_mov_b32 s33, 81920
    s_cmp_eq_u32 s43, 3
    s_cselect_b32 s3, 0, 163840
    buffer_store_dwordx4 v[224:227], v220, s[20:23], 0 offen sc1
    buffer_store_dwordx4 v[224:227], v220, s[20:23], s33 offen sc1
    buffer_store_dwordx4 v[224:227], v220, s[20:23], s3 offen sc1
    buffer_store_dwordx4 v[224:227], v221, s[20:23], 0 offen sc1
    v_mov_b32 v2, 158720
    v_mov_b32 v3, 1
    s_waitcnt vmcnt(0)
    s_mov_b64 exec, 1
    ds_add_u32 v2, v3 offset:28
    ds_add_u32 v2, v3 offset:32
    s_mov_b64 exec, -1
    s_branch K_END
K_CONS:
    v_and_b32 v1, 63, v0
    v_and_b32 v8, 15, v1
    v_lshrrev_b32 v9, 4, v1
    v_bfe_u32 v10, v1, 2, 2
    v_and_b32 v11, 3, v1
    s_bfe_u32 s54, s30, 0x10001
    s_and_b32 s55, s30, 1
    v_lshrrev_b32 v2, 1, v8
    v_xor_b32 v2, v2, v9
    v_lshlrev_b32 v2, 4, v2
    v_lshl_add_u32 v2, v8, 7, v2
    s_mul_i32 s3, s54, 12288
    v_add_u32 v39, s3, v2
    v_xor_b32 v40, 64, v39
    v_add_u32 v41, 81920, v39
    v_add_u32 v42, 81920, v40
    v_and_b32 v2, 1, v9
    v_lshl_or_b32 v2, v2, 2, v10
    s_mul_i32 s3, s55, 40
    v_lshl_add_u32 v2, v2, 5, s3
    v_lshl_add_u32 v3, v9, 3, v10
    v_lshlrev_b32 v3, 8, v3
    v_add_u32 v3, 24576, v3
    v_lshl_add_u32 v5, v11, 3, v2
    s_mul_i32 s33, s55, 805306368
    s_sub_u32 s33, 0xf870c020, s33
    v_add_u32 v4, 0, v5
    v_and_b32 v4, 255, v4
    v_add_u32 v43, v4, v3
    v_add_u32 v47, 81920, v43
    v_add_u32 v4, 160, v5
    v_and_b32 v4, 255, v4
    v_add_u32 v44, v4, v3
    v_add_u32 v48, 81920, v44
    v_add_u32 v4, 80, v5
    v_and_b32 v4, 255, v4
    v_add_u32 v45, v4, v3
    v_add_u32 v49, 81920, v45
    v_lshlrev_b32 v4, 3, v11
    v_bfe_u32 v4, s33, v4, 8
    v_add_u32 v4, v4, v2
    v_and_b32 v4, 255, v4
    v_add_u32 v46, v4, v3
    v_add_u32 v50, 81920, v46
    v_and_b32 v1, 63, v0
    v_mov_b32 v7, 0
    s_and_b32 s28, s2, 7
    s_lshr_b32 s29, s2, 3
    s_xor_b32 s30, s30, 4
    s_lshr_b32 s34, s29, 3
    s_lshl_b32 s34, s34, 2
    s_and_b32 s3, s29, 3
    s_add_u32 s34, s34, s3
    s_add_u32 s34, s34, 4
    s_bitcmp1_b32 s29, 2
    s_cselect_b32 s34, -1, s34
    s_cmp_lt_u32 s29, 8
    s_cselect_b32 s34, s29, s34
    s_lshl_b32 s40, s28, 1
    s_cmp_ge_u32 s34, 10
    s_addc_u32 s40, s40, 0
    s_sub_u32 s41, s34, 10
    s_cmp_ge_u32 s34, 10
    s_cselect_b32 s41, s41, s34
    s_mul_i32 s42, s28, 20
    s_add_u32 s42, s42, s34
    s_and_b32 s42, s42, 255
    s_lshl_b32 s42, s42, 9
    s_add_u32 s42, s42, 524288
    v_mov_b32 v3, 158736
    ds_write2_b32 v3, v7, v7 offset0:0 offset1:1
    ds_write2_b32 v3, v7, v7 offset0:2 offset1:3
    ds_write2_b32 v3, v7, v7 offset0:4 offset1:5
    ds_write2_b32 v3, v7, v7 offset0:6 offset1:7
    ds_write2_b32 v3, v7, v7 offset0:8 offset1:9
    s_lshr_b32 s31, s28, 1
    s_mul_i32 s31, s31, 3
    s_lshr_b32 s3, s29, 3
    s_add_u32 s31, s31, s3
    s_sub_u32 s31, s31, 1
    s_and_b32 s32, s28, 1
    s_lshl_b32 s32, s32, 3
    s_and_b32 s3, s29, 7
    s_lshl_b32 s3, s3, 2
    s_lshr_b32 s3, 0x64317520, s3
    s_and_b32 s3, s3, 7
    s_add_u32 s32, s32, s3
    s_and_b32 s35, s29, 3
    s_and_b32 s3, s29, 4
    s_lshl_b32 s3, s3, 1
    s_add_u32 s35, s35, s3
    s_and_b32 s3, s28, 1
    s_lshl_b32 s3, s3, 2
    s_add_u32 s35, s35, s3
    s_or_b32 s56, s31, s54
    v_mov_b32 v37, 0xf149f2ca
    v_lshlrev_b32 v2, 2, v9
    v_sub_u32 v2, v8, v2
    s_cmp_eq_u32 s56, 0
    s_cselect_b32 s3, 0xf149f2ca, 0
    v_subrev_u32 v3, 0, v2
    v_and_b32 v4, 0x80000001, v3
    v_cmp_eq_u32 vcc, 0, v4
    s_nop 1
    v_cndmask_b32 v16, v37, 0, vcc
    v_cmp_eq_u32 vcc, 0x80000000, v4
    s_nop 1
    v_cndmask_b32 v12, v37, 0, vcc
    v_add_f32 v20, s3, v12
    v_subrev_u32 v3, 1, v2
    v_and_b32 v4, 0x80000001, v3
    v_cmp_eq_u32 vcc, 0, v4
    s_nop 1
    v_cndmask_b32 v17, v37, 0, vcc
    v_cmp_eq_u32 vcc, 0x80000000, v4
    s_nop 1
    v_cndmask_b32 v13, v37, 0, vcc
    v_add_f32 v21, s3, v13
    v_subrev_u32 v3, 2, v2
    v_and_b32 v4, 0x80000001, v3
    v_cmp_eq_u32 vcc, 0, v4
    s_nop 1
    v_cndmask_b32 v18, v37, 0, vcc
    v_cmp_eq_u32 vcc, 0x80000000, v4
    s_nop 1
    v_cndmask_b32 v14, v37, 0, vcc
    v_add_f32 v22, s3, v14
    v_subrev_u32 v3, 3, v2
    v_and_b32 v4, 0x80000001, v3
    v_cmp_eq_u32 vcc, 0, v4
    s_nop 1
    v_cndmask_b32 v19, v37, 0, vcc
    v_cmp_eq_u32 vcc, 0x80000000, v4
    s_nop 1
    v_cndmask_b32 v15, v37, 0, vcc
    v_add_f32 v23, s3, v15
    v_mov_b32 v3, 0x0c0c0c0c
    v_mov_b32 v4, 0xc0c0100
    v_cmp_eq_u32 vcc, 0, v12
    v_mov_b32 v5, 0x1000c0c
    s_nop 0
    v_cndmask_b32 v3, v3, v4, vcc
    v_cmp_eq_u32 vcc, 0, v13
    s_nop 1
    v_cndmask_b32 v24, v3, v5, vcc
    v_mov_b32 v3, 0x0c0c0c0c
    v_mov_b32 v4, 0xc0c0302
    v_cmp_eq_u32 vcc, 0, v14
    v_mov_b32 v5, 0x3020c0c
    s_nop 0
    v_cndmask_b32 v3, v3, v4, vcc
    v_cmp_eq_u32 vcc, 0, v15
    s_nop 1
    v_cndmask_b32 v25, v3, v5, vcc
    v_mov_b32 v3, 0x0c0c0c0c
    v_mov_b32 v4, 0xc0c0100
    v_cmp_eq_u32 vcc, 0, v16
    v_mov_b32 v5, 0x1000c0c
    s_nop 0
    v_cndmask_b32 v3, v3, v4, vcc
    v_cmp_eq_u32 vcc, 0, v17
    s_nop 1
    v_cndmask_b32 v26, v3, v5, vcc
    v_mov_b32 v3, 0x0c0c0c0c
    v_mov_b32 v4, 0xc0c0302
    v_cmp_eq_u32 vcc, 0, v18
    v_mov_b32 v5, 0x3020c0c
    s_nop 0
    v_cndmask_b32 v3, v3, v4, vcc
    v_cmp_eq_u32 vcc, 0, v19
    s_nop 1
    v_cndmask_b32 v27, v3, v5, vcc
    s_mul_i32 s3, s55, 1664
    s_mul_i32 s33, s54, 768
    s_add_u32 s3, s3, s33
    s_add_u32 s3, s3, 125952
    v_lshl_add_u32 v2, v9, 2, v10
    v_lshl_add_u32 v33, v2, 3, s3
    v_lshl_add_u32 v2, v8, 3, s3
    v_lshlrev_b32 v3, 3, v1
    v_add_u32 v3, 129280, v3
    v_cmp_eq_u32 vcc, 2, v9
    s_mul_i32 s3, s55, 1536
    s_add_u32 s3, s3, 122880
    v_cndmask_b32 v32, v3, v2, vcc
    v_lshl_add_u32 v34, v1, 3, s3
    s_mul_i32 s3, s54, 1536
    s_add_u32 s3, s3, 131328
    s_lshl3_add_u32 s33, s55, s3
    v_lshl_add_u32 v35, v8, 4, s33
    v_cmp_eq_u32 vcc, 0, v9
    s_nop 1
    v_cndmask_b32 v35, v3, v35, vcc
    s_mul_i32 s33, s55, 768
    s_add_u32 s3, s3, s33
    v_lshl_add_u32 v36, v1, 4, s3
    v_mov_b32 v38, 158720
    s_waitcnt lgkmcnt(0)
    s_add_u32 s20, s6, 0x100000
    s_addc_u32 s21, s7, 0
    s_mov_b32 s22, 0x280000
    s_mov_b32 s23, 0x20000
    s_lshr_b32 s53, s35, 2
    s_add_u32 s58, s53, s35
    s_lshl_b32 s58, s58, 12
    s_mul_i32 s59, s53, 19456
    s_lshl_b32 s53, s35, 8
    s_add_u32 s59, s59, s53
    s_add_u32 s59, s59, 16384
    s_mul_i32 s53, s31, 11
    s_mul_i32 s3, s54, 6
    s_add_u32 s53, s53, s3
    s_add_u32 s53, s53, 3
    s_lshl_b32 s3, s55, 9
    s_add_u32 s58, s58, s3
    v_and_b32 v4, 1, v9
    v_lshrrev_b32 v5, 1, v9
    v_add_u32 v3, s53, v4
    v_lshrrev_b32 v2, 2, v3
    v_mul_u32_u24 v2, 76, v2
    v_add_lshl_u32 v2, v2, v3, 10
    v_lshl_add_u32 v2, v8, 4, v2
    v_add_u32 v30, s58, v2
    v_lshl_add_u32 v30, v5, 8, v30
    v_subrev_u32 v3, 2, v3
    v_lshrrev_b32 v2, 2, v3
    v_mul_u32_u24 v2, 76, v2
    v_add_lshl_u32 v2, v2, v3, 10
    v_lshl_add_u32 v2, v8, 4, v2
    v_add_u32 v29, s58, v2
    v_lshl_add_u32 v29, v5, 8, v29
    v_or_b32 v4, s54, v4
    v_cmp_eq_u32 vcc, 0, v4
    v_mov_b32 v5, 0x10000000
    v_subrev_u32 v28, 81920, v30
    v_cndmask_b32 v28, v28, v5, vcc
    s_mul_i32 s3, s55, 3
    s_add_u32 s53, s53, s3
    v_add_u32 v3, s53, v9
    v_lshrrev_b32 v2, 2, v3
    v_mul_u32_u24 v2, 76, v2
    v_add_lshl_u32 v2, v2, v3, 10
    v_lshl_add_u32 v2, v8, 4, v2
    v_add_u32 v31, s59, v2
    v_subrev_u32 v31, 81920, v31
    v_or_b32 v4, s30, v9
    v_cmp_eq_u32 vcc, 0, v4
    s_nop 1
    v_cndmask_b32 v31, v31, v5, vcc
    v_cmp_eq_u32 vcc, 3, v9
    s_nop 1
    v_cndmask_b32 v31, v31, v5, vcc
    s_mul_i32 s3, s31, 11
    s_add_u32 s33, s3, 10
    s_lshr_b32 s3, s3, 3
    s_lshr_b32 s33, s33, 3
    s_min_u32 s33, s33, 15
    s_sub_u32 s33, s33, s3
    s_add_u32 s33, s33, 1
    s_mul_i32 s33, s33, 10
    s_bfm_b32 s37, s33, 0
    v_mul_u32_u24 v2, 205, v1
    v_lshrrev_b32 v2, 11, v2
    v_add_u32 v2, s3, v2
    v_mul_u32_u24 v2, 1496, v2
    v_lshrrev_b32 v2, 11, v2
    v_sub_u32 v2, s31, v2
    v_and_b32 v2, 1, v2
    v_lshlrev_b32 v2, 2, v2
    v_lshl_add_u32 v2, v1, 9, v2
    s_mul_i32 s3, s3, 5120
    s_add_u32 s3, s3, 524288
    v_add_u32 v37, s3, v2
    s_lshr_b32 s36, s35, 2
    s_add_u32 s36, s36, s35
    s_lshl_b32 s36, 1, s36
    s_cmp_eq_u32 s30, 0
    s_cselect_b32 s36, s36, 0
    s_mov_b32 s58, 0x3fb8aa3b
    s_mov_b32 s59, s58
    s_mov_b32 s60, 0x3e64f92e
    s_mov_b32 s61, s60
    s_cmp_eq_u32 s30, 0
    s_cbranch_scc1 K_CHM0
    s_cmp_eq_u32 s30, 1
    s_cbranch_scc1 K_CHM1
    s_cmp_eq_u32 s30, 2
    s_cbranch_scc1 K_CHM2
    s_branch K_CHM3
K_WRET_M:
    s_setprio 2
    s_barrier
K_L0:
    ds_read_b64_tr_b16 v[196:197], v47 offset:0
    ds_read_b64_tr_b16 v[198:199], v47 offset:1024
    ds_read_b128 v[148:151], v41 offset:0
    ds_read_b64_tr_b16 v[200:201], v48 offset:0
    ds_read_b64_tr_b16 v[202:203], v48 offset:1024
    ds_read_b128 v[152:155], v41 offset:2048
    ds_read_b64_tr_b16 v[204:205], v49 offset:0
    ds_read_b64_tr_b16 v[206:207], v49 offset:1024
    ds_read_b128 v[156:159], v41 offset:4096
    ds_read_b64_tr_b16 v[208:209], v50 offset:0
    ds_read_b64_tr_b16 v[210:211], v50 offset:1024
    ds_read_b128 v[160:163], v41 offset:6144
    ds_read_b128 v[164:167], v41 offset:8192
    ds_read_b128 v[168:171], v41 offset:10240
    s_waitcnt lgkmcnt(0)
    v_mfma_f32_16x16x32_bf16 v[52:55], v[196:199], v[148:151], 0
    ds_read_b64_tr_b16 v[212:213], v47 offset:8192
    v_mfma_f32_16x16x32_bf16 v[56:59], v[200:203], v[148:151], 0
    ds_read_b64_tr_b16 v[214:215], v47 offset:9216
    v_mfma_f32_16x16x32_bf16 v[60:63], v[148:151], v[204:207], 0
    ds_read_b128 v[172:175], v42 offset:0
    v_mfma_f32_16x16x32_bf16 v[64:67], v[208:211], v[148:151], 0
    ds_read_b64_tr_b16 v[216:217], v48 offset:8192
    v_mfma_f32_16x16x32_bf16 v[80:83], v[208:211], v[152:155], 0
    ds_read_b64_tr_b16 v[218:219], v48 offset:9216
    v_mfma_f32_16x16x32_bf16 v[76:79], v[152:155], v[204:207], 0
    ds_read_b128 v[176:179], v42 offset:2048
    v_mfma_f32_16x16x32_bf16 v[72:75], v[200:203], v[152:155], 0
    ds_read_b64_tr_b16 v[220:221], v49 offset:8192
    v_mfma_f32_16x16x32_bf16 v[68:71], v[196:199], v[152:155], 0
    ds_read_b64_tr_b16 v[222:223], v49 offset:9216
    v_mfma_f32_16x16x32_bf16 v[84:87], v[196:199], v[156:159], 0
    ds_read_b128 v[180:183], v42 offset:4096
    v_mfma_f32_16x16x32_bf16 v[88:91], v[200:203], v[156:159], 0
    ds_read_b64_tr_b16 v[224:225], v50 offset:8192
    v_mfma_f32_16x16x32_bf16 v[92:95], v[156:159], v[204:207], 0
    ds_read_b64_tr_b16 v[226:227], v50 offset:9216
    v_mfma_f32_16x16x32_bf16 v[96:99], v[208:211], v[156:159], 0
    ds_read_b128 v[184:187], v42 offset:6144
    v_mfma_f32_16x16x32_bf16 v[112:115], v[208:211], v[160:163], 0
    ds_read_b128 v[188:191], v42 offset:8192
    v_mfma_f32_16x16x32_bf16 v[108:111], v[160:163], v[204:207], 0
    ds_read_b128 v[192:195], v42 offset:10240
    v_mfma_f32_16x16x32_bf16 v[104:107], v[200:203], v[160:163], 0
    v_mfma_f32_16x16x32_bf16 v[100:103], v[196:199], v[160:163], 0
    v_mfma_f32_16x16x32_bf16 v[116:119], v[196:199], v[164:167], 0
    v_mfma_f32_16x16x32_bf16 v[120:123], v[200:203], v[164:167], 0
    v_mfma_f32_16x16x32_bf16 v[124:127], v[164:167], v[204:207], 0
    v_mfma_f32_16x16x32_bf16 v[128:131], v[208:211], v[164:167], 0
    v_mfma_f32_16x16x32_bf16 v[144:147], v[208:211], v[168:171], 0
    v_mfma_f32_16x16x32_bf16 v[140:143], v[168:171], v[204:207], 0
    v_mfma_f32_16x16x32_bf16 v[136:139], v[200:203], v[168:171], 0
    v_mfma_f32_16x16x32_bf16 v[132:135], v[196:199], v[168:171], 0
    s_waitcnt lgkmcnt(0)
    s_barrier
    v_mfma_f32_16x16x32_bf16 v[52:55], v[212:215], v[172:175], v[52:55]
    ds_read_b64_tr_b16 v[196:197], v43 offset:0
    v_mfma_f32_16x16x32_bf16 v[56:59], v[216:219], v[172:175], v[56:59]
    ds_read_b64_tr_b16 v[198:199], v43 offset:1024
    v_mfma_f32_16x16x32_bf16 v[60:63], v[172:175], v[220:223], v[60:63]
    ds_read_b128 v[148:151], v39 offset:0
    v_mfma_f32_16x16x32_bf16 v[64:67], v[224:227], v[172:175], v[64:67]
    ds_read_b64_tr_b16 v[200:201], v44 offset:0
    v_mfma_f32_16x16x32_bf16 v[80:83], v[224:227], v[176:179], v[80:83]
    ds_read_b64_tr_b16 v[202:203], v44 offset:1024
    v_mfma_f32_16x16x32_bf16 v[76:79], v[176:179], v[220:223], v[76:79]
    ds_read_b128 v[152:155], v39 offset:2048
    v_mfma_f32_16x16x32_bf16 v[72:75], v[216:219], v[176:179], v[72:75]
    ds_read_b64_tr_b16 v[204:205], v45 offset:0
    v_mfma_f32_16x16x32_bf16 v[68:71], v[212:215], v[176:179], v[68:71]
    ds_read_b64_tr_b16 v[206:207], v45 offset:1024
    v_mfma_f32_16x16x32_bf16 v[84:87], v[212:215], v[180:183], v[84:87]
    ds_read_b128 v[156:159], v39 offset:4096
    v_mfma_f32_16x16x32_bf16 v[88:91], v[216:219], v[180:183], v[88:91]
    ds_read_b64_tr_b16 v[208:209], v46 offset:0
    v_mfma_f32_16x16x32_bf16 v[92:95], v[180:183], v[220:223], v[92:95]
    ds_read_b64_tr_b16 v[210:211], v46 offset:1024
    v_mfma_f32_16x16x32_bf16 v[96:99], v[224:227], v[180:183], v[96:99]
    ds_read_b128 v[160:163], v39 offset:6144
    v_mfma_f32_16x16x32_bf16 v[112:115], v[224:227], v[184:187], v[112:115]
    ds_read_b128 v[164:167], v39 offset:8192
    v_mfma_f32_16x16x32_bf16 v[108:111], v[184:187], v[220:223], v[108:111]
    ds_read_b128 v[168:171], v39 offset:10240
    v_mfma_f32_16x16x32_bf16 v[104:107], v[216:219], v[184:187], v[104:107]
    v_mfma_f32_16x16x32_bf16 v[100:103], v[212:215], v[184:187], v[100:103]
    v_mfma_f32_16x16x32_bf16 v[116:119], v[212:215], v[188:191], v[116:119]
    v_mfma_f32_16x16x32_bf16 v[120:123], v[216:219], v[188:191], v[120:123]
    v_mfma_f32_16x16x32_bf16 v[124:127], v[188:191], v[220:223], v[124:127]
    v_mfma_f32_16x16x32_bf16 v[128:131], v[224:227], v[188:191], v[128:131]
    v_mfma_f32_16x16x32_bf16 v[144:147], v[224:227], v[192:195], v[144:147]
    v_mfma_f32_16x16x32_bf16 v[140:143], v[192:195], v[220:223], v[140:143]
    v_mfma_f32_16x16x32_bf16 v[136:139], v[216:219], v[192:195], v[136:139]
    v_mfma_f32_16x16x32_bf16 v[132:135], v[212:215], v[192:195], v[132:135]
    s_waitcnt lgkmcnt(0)
    v_mfma_f32_16x16x32_bf16 v[52:55], v[196:199], v[148:151], v[52:55]
    ds_read_b64_tr_b16 v[212:213], v43 offset:8192
    v_mfma_f32_16x16x32_bf16 v[56:59], v[200:203], v[148:151], v[56:59]
    ds_read_b64_tr_b16 v[214:215], v43 offset:9216
    v_mfma_f32_16x16x32_bf16 v[60:63], v[148:151], v[204:207], v[60:63]
    ds_read_b128 v[172:175], v40 offset:0
    v_mfma_f32_16x16x32_bf16 v[64:67], v[208:211], v[148:151], v[64:67]
    ds_read_b64_tr_b16 v[216:217], v44 offset:8192
    v_mfma_f32_16x16x32_bf16 v[80:83], v[208:211], v[152:155], v[80:83]
    ds_read_b64_tr_b16 v[218:219], v44 offset:9216
    v_mfma_f32_16x16x32_bf16 v[76:79], v[152:155], v[204:207], v[76:79]
    ds_read_b128 v[176:179], v40 offset:2048
    v_mfma_f32_16x16x32_bf16 v[72:75], v[200:203], v[152:155], v[72:75]
    ds_read_b64_tr_b16 v[220:221], v45 offset:8192
    v_mfma_f32_16x16x32_bf16 v[68:71], v[196:199], v[152:155], v[68:71]
    ds_read_b64_tr_b16 v[222:223], v45 offset:9216
    v_mfma_f32_16x16x32_bf16 v[84:87], v[196:199], v[156:159], v[84:87]
    ds_read_b128 v[180:183], v40 offset:4096
    v_mfma_f32_16x16x32_bf16 v[88:91], v[200:203], v[156:159], v[88:91]
    ds_read_b64_tr_b16 v[224:225], v46 offset:8192
    v_mfma_f32_16x16x32_bf16 v[92:95], v[156:159], v[204:207], v[92:95]
    ds_read_b64_tr_b16 v[226:227], v46 offset:9216
    v_mfma_f32_16x16x32_bf16 v[96:99], v[208:211], v[156:159], v[96:99]
    ds_read_b128 v[184:187], v40 offset:6144
    v_mfma_f32_16x16x32_bf16 v[112:115], v[208:211], v[160:163], v[112:115]
    ds_read_b128 v[188:191], v40 offset:8192
    v_mfma_f32_16x16x32_bf16 v[108:111], v[160:163], v[204:207], v[108:111]
    ds_read_b128 v[192:195], v40 offset:10240
    v_mfma_f32_16x16x32_bf16 v[104:107], v[200:203], v[160:163], v[104:107]
    v_mfma_f32_16x16x32_bf16 v[100:103], v[196:199], v[160:163], v[100:103]
    v_mfma_f32_16x16x32_bf16 v[116:119], v[196:199], v[164:167], v[116:119]
    v_mfma_f32_16x16x32_bf16 v[120:123], v[200:203], v[164:167], v[120:123]
    v_mfma_f32_16x16x32_bf16 v[124:127], v[164:167], v[204:207], v[124:127]
    v_mfma_f32_16x16x32_bf16 v[128:131], v[208:211], v[164:167], v[128:131]
    v_mfma_f32_16x16x32_bf16 v[144:147], v[208:211], v[168:171], v[144:147]
    s_branch K_PG1
.p2align 12
K_CHM1:
K_STM1:
    s_branch K_WRET_M
    s_nop 0
K_PG1:
    v_mfma_f32_16x16x32_bf16 v[140:143], v[168:171], v[204:207], v[140:143]
    v_mfma_f32_16x16x32_bf16 v[136:139], v[200:203], v[168:171], v[136:139]
    v_mfma_f32_16x16x32_bf16 v[132:135], v[196:199], v[168:171], v[132:135]
    s_waitcnt lgkmcnt(0)
    s_barrier
    v_mfma_f32_16x16x32_bf16 v[52:55], v[212:215], v[172:175], v[52:55]
    ds_read_b64_tr_b16 v[196:197], v43 offset:40960
    v_mfma_f32_16x16x32_bf16 v[56:59], v[216:219], v[172:175], v[56:59]
    ds_read_b64_tr_b16 v[198:199], v43 offset:41984
    v_mfma_f32_16x16x32_bf16 v[60:63], v[172:175], v[220:223], v[60:63]
    ds_read_b128 v[148:151], v39 offset:40960
    v_mfma_f32_16x16x32_bf16 v[64:67], v[224:227], v[172:175], v[64:67]
    ds_read_b64_tr_b16 v[200:201], v44 offset:40960
    v_mfma_f32_16x16x32_bf16 v[80:83], v[224:227], v[176:179], v[80:83]
    ds_read_b64_tr_b16 v[202:203], v44 offset:41984
    v_mfma_f32_16x16x32_bf16 v[76:79], v[176:179], v[220:223], v[76:79]
    ds_read_b128 v[152:155], v39 offset:43008
    v_mfma_f32_16x16x32_bf16 v[72:75], v[216:219], v[176:179], v[72:75]
    ds_read_b64_tr_b16 v[204:205], v45 offset:40960
    v_mfma_f32_16x16x32_bf16 v[68:71], v[212:215], v[176:179], v[68:71]
    ds_read_b64_tr_b16 v[206:207], v45 offset:41984
    v_mfma_f32_16x16x32_bf16 v[84:87], v[212:215], v[180:183], v[84:87]
    ds_read_b128 v[156:159], v39 offset:45056
    v_mfma_f32_16x16x32_bf16 v[88:91], v[216:219], v[180:183], v[88:91]
    ds_read_b64_tr_b16 v[208:209], v46 offset:40960
    v_mfma_f32_16x16x32_bf16 v[92:95], v[180:183], v[220:223], v[92:95]
    ds_read_b64_tr_b16 v[210:211], v46 offset:41984
    v_mfma_f32_16x16x32_bf16 v[96:99], v[224:227], v[180:183], v[96:99]
    ds_read_b128 v[160:163], v39 offset:47104
    v_mfma_f32_16x16x32_bf16 v[112:115], v[224:227], v[184:187], v[112:115]
    ds_read_b128 v[164:167], v39 offset:49152
    v_mfma_f32_16x16x32_bf16 v[108:111], v[184:187], v[220:223], v[108:111]
    ds_read_b128 v[168:171], v39 offset:51200
    v_mfma_f32_16x16x32_bf16 v[104:107], v[216:219], v[184:187], v[104:107]
    v_mfma_f32_16x16x32_bf16 v[100:103], v[212:215], v[184:187], v[100:103]
    v_mfma_f32_16x16x32_bf16 v[116:119], v[212:215], v[188:191], v[116:119]
    v_mfma_f32_16x16x32_bf16 v[120:123], v[216:219], v[188:191], v[120:123]
    v_mfma_f32_16x16x32_bf16 v[124:127], v[188:191], v[220:223], v[124:127]
    v_mfma_f32_16x16x32_bf16 v[128:131], v[224:227], v[188:191], v[128:131]
    v_mfma_f32_16x16x32_bf16 v[144:147], v[224:227], v[192:195], v[144:147]
    v_mfma_f32_16x16x32_bf16 v[140:143], v[192:195], v[220:223], v[140:143]
    v_mfma_f32_16x16x32_bf16 v[136:139], v[216:219], v[192:195], v[136:139]
    v_mfma_f32_16x16x32_bf16 v[132:135], v[212:215], v[192:195], v[132:135]
    s_waitcnt lgkmcnt(0)
    v_mfma_f32_16x16x32_bf16 v[52:55], v[196:199], v[148:151], v[52:55]
    ds_read_b64_tr_b16 v[212:213], v43 offset:49152
    v_mfma_f32_16x16x32_bf16 v[56:59], v[200:203], v[148:151], v[56:59]
    ds_read_b64_tr_b16 v[214:215], v43 offset:50176
    v_mfma_f32_16x16x32_bf16 v[60:63], v[148:151], v[204:207], v[60:63]
    ds_read_b128 v[172:175], v40 offset:40960
    v_mfma_f32_16x16x32_bf16 v[64:67], v[208:211], v[148:151], v[64:67]
    ds_read_b64_tr_b16 v[216:217], v44 offset:49152
    v_mfma_f32_16x16x32_bf16 v[80:83], v[208:211], v[152:155], v[80:83]
    ds_read_b64_tr_b16 v[218:219], v44 offset:50176
    v_mfma_f32_16x16x32_bf16 v[76:79], v[152:155], v[204:207], v[76:79]
    ds_read_b128 v[176:179], v40 offset:43008
    v_mfma_f32_16x16x32_bf16 v[72:75], v[200:203], v[152:155], v[72:75]
    ds_read_b64_tr_b16 v[220:221], v45 offset:49152
    v_mfma_f32_16x16x32_bf16 v[68:71], v[196:199], v[152:155], v[68:71]
    ds_read_b64_tr_b16 v[222:223], v45 offset:50176
    v_mfma_f32_16x16x32_bf16 v[84:87], v[196:199], v[156:159], v[84:87]
    ds_read_b128 v[180:183], v40 offset:45056
    v_mfma_f32_16x16x32_bf16 v[88:91], v[200:203], v[156:159], v[88:91]
    ds_read_b64_tr_b16 v[224:225], v46 offset:49152
    v_mfma_f32_16x16x32_bf16 v[92:95], v[156:159], v[204:207], v[92:95]
    ds_read_b64_tr_b16 v[226:227], v46 offset:50176
    v_mfma_f32_16x16x32_bf16 v[96:99], v[208:211], v[156:159], v[96:99]
    ds_read_b128 v[184:187], v40 offset:47104
    v_mfma_f32_16x16x32_bf16 v[112:115], v[208:211], v[160:163], v[112:115]
    ds_read_b128 v[188:191], v40 offset:49152
    v_mfma_f32_16x16x32_bf16 v[108:111], v[160:163], v[204:207], v[108:111]
    ds_read_b128 v[192:195], v40 offset:51200
    v_mfma_f32_16x16x32_bf16 v[104:107], v[200:203], v[160:163], v[104:107]
    v_mfma_f32_16x16x32_bf16 v[100:103], v[196:199], v[160:163], v[100:103]
    v_mfma_f32_16x16x32_bf16 v[116:119], v[196:199], v[164:167], v[116:119]
    v_mfma_f32_16x16x32_bf16 v[120:123], v[200:203], v[164:167], v[120:123]
    v_mfma_f32_16x16x32_bf16 v[124:127], v[164:167], v[204:207], v[124:127]
    v_mfma_f32_16x16x32_bf16 v[128:131], v[208:211], v[164:167], v[128:131]
    v_mfma_f32_16x16x32_bf16 v[144:147], v[208:211], v[168:171], v[144:147]
    v_mfma_f32_16x16x32_bf16 v[140:143], v[168:171], v[204:207], v[140:143]
    v_mfma_f32_16x16x32_bf16 v[136:139], v[200:203], v[168:171], v[136:139]
    v_mfma_f32_16x16x32_bf16 v[132:135], v[196:199], v[168:171], v[132:135]
    s_waitcnt lgkmcnt(0)
    s_barrier
    v_mfma_f32_16x16x32_bf16 v[52:55], v[212:215], v[172:175], v[52:55]
    ds_read_b64_tr_b16 v[196:197], v47 offset:0
    v_mfma_f32_16x16x32_bf16 v[56:59], v[216:219], v[172:175], v[56:59]
    ds_read_b64_tr_b16 v[198:199], v47 offset:1024
    v_mfma_f32_16x16x32_bf16 v[60:63], v[172:175], v[220:223], v[60:63]
    ds_read_b128 v[148:151], v41 offset:0
    v_mfma_f32_16x16x32_bf16 v[64:67], v[224:227], v[172:175], v[64:67]
    ds_read_b64_tr_b16 v[200:201], v48 offset:0
    v_mfma_f32_16x16x32_bf16 v[80:83], v[224:227], v[176:179], v[80:83]
    ds_read_b64_tr_b16 v[202:203], v48 offset:1024
    v_mfma_f32_16x16x32_bf16 v[76:79], v[176:179], v[220:223], v[76:79]
    ds_read_b128 v[152:155], v41 offset:2048
    v_mfma_f32_16x16x32_bf16 v[72:75], v[216:219], v[176:179], v[72:75]
    ds_read_b64_tr_b16 v[204:205], v49 offset:0
    v_mfma_f32_16x16x32_bf16 v[68:71], v[212:215], v[176:179], v[68:71]
    ds_read_b64_tr_b16 v[206:207], v49 offset:1024
    v_mfma_f32_16x16x32_bf16 v[84:87], v[212:215], v[180:183], v[84:87]
    ds_read_b128 v[156:159], v41 offset:4096
    v_mfma_f32_16x16x32_bf16 v[88:91], v[216:219], v[180:183], v[88:91]
    ds_read_b64_tr_b16 v[208:209], v50 offset:0
    v_mfma_f32_16x16x32_bf16 v[92:95], v[180:183], v[220:223], v[92:95]
    ds_read_b64_tr_b16 v[210:211], v50 offset:1024
    v_mfma_f32_16x16x32_bf16 v[96:99], v[224:227], v[180:183], v[96:99]
    ds_read_b128 v[160:163], v41 offset:6144
    v_mfma_f32_16x16x32_bf16 v[112:115], v[224:227], v[184:187], v[112:115]
    ds_read_b128 v[164:167], v41 offset:8192
    v_mfma_f32_16x16x32_bf16 v[108:111], v[184:187], v[220:223], v[108:111]
    ds_read_b128 v[168:171], v41 offset:10240
    v_mfma_f32_16x16x32_bf16 v[104:107], v[216:219], v[184:187], v[104:107]
    v_mfma_f32_16x16x32_bf16 v[100:103], v[212:215], v[184:187], v[100:103]
    v_mfma_f32_16x16x32_bf16 v[116:119], v[212:215], v[188:191], v[116:119]
    v_mfma_f32_16x16x32_bf16 v[120:123], v[216:219], v[188:191], v[120:123]
    v_mfma_f32_16x16x32_bf16 v[124:127], v[188:191], v[220:223], v[124:127]
    v_mfma_f32_16x16x32_bf16 v[128:131], v[224:227], v[188:191], v[128:131]
    v_mfma_f32_16x16x32_bf16 v[144:147], v[224:227], v[192:195], v[144:147]
    v_mfma_f32_16x16x32_bf16 v[140:143], v[192:195], v[220:223], v[140:143]
    v_mfma_f32_16x16x32_bf16 v[136:139], v[216:219], v[192:195], v[136:139]
    v_mfma_f32_16x16x32_bf16 v[132:135], v[212:215], v[192:195], v[132:135]
    s_waitcnt lgkmcnt(0)
    v_mfma_f32_16x16x32_bf16 v[52:55], v[196:199], v[148:151], v[52:55]
    ds_read_b64_tr_b16 v[212:213], v47 offset:8192
    v_mfma_f32_16x16x32_bf16 v[56:59], v[200:203], v[148:151], v[56:59]
    ds_read_b64_tr_b16 v[214:215], v47 offset:9216
    v_mfma_f32_16x16x32_bf16 v[60:63], v[148:151], v[204:207], v[60:63]
    ds_read_b128 v[172:175], v42 offset:0
    v_mfma_f32_16x16x32_bf16 v[64:67], v[208:211], v[148:151], v[64:67]
    ds_read_b64_tr_b16 v[216:217], v48 offset:8192
    v_mfma_f32_16x16x32_bf16 v[80:83], v[208:211], v[152:155], v[80:83]
    ds_read_b64_tr_b16 v[218:219], v48 offset:9216
    v_mfma_f32_16x16x32_bf16 v[76:79], v[152:155], v[204:207], v[76:79]
    ds_read_b128 v[176:179], v42 offset:2048
    v_mfma_f32_16x16x32_bf16 v[72:75], v[200:203], v[152:155], v[72:75]
    ds_read_b64_tr_b16 v[220:221], v49 offset:8192
    v_mfma_f32_16x16x32_bf16 v[68:71], v[196:199], v[152:155], v[68:71]
    ds_read_b64_tr_b16 v[222:223], v49 offset:9216
    v_mfma_f32_16x16x32_bf16 v[84:87], v[196:199], v[156:159], v[84:87]
    ds_read_b128 v[180:183], v42 offset:4096
    v_mfma_f32_16x16x32_bf16 v[88:91], v[200:203], v[156:159], v[88:91]
    ds_read_b64_tr_b16 v[224:225], v50 offset:8192
    v_mfma_f32_16x16x32_bf16 v[92:95], v[156:159], v[204:207], v[92:95]
    ds_read_b64_tr_b16 v[226:227], v50 offset:9216
    v_mfma_f32_16x16x32_bf16 v[96:99], v[208:211], v[156:159], v[96:99]
    ds_read_b128 v[184:187], v42 offset:6144
    v_mfma_f32_16x16x32_bf16 v[112:115], v[208:211], v[160:163], v[112:115]
    ds_read_b128 v[188:191], v42 offset:8192
    v_mfma_f32_16x16x32_bf16 v[108:111], v[160:163], v[204:207], v[108:111]
    ds_read_b128 v[192:195], v42 offset:10240
    v_mfma_f32_16x16x32_bf16 v[104:107], v[200:203], v[160:163], v[104:107]
    v_mfma_f32_16x16x32_bf16 v[100:103], v[196:199], v[160:163], v[100:103]
    v_mfma_f32_16x16x32_bf16 v[116:119], v[196:199], v[164:167], v[116:119]
    v_mfma_f32_16x16x32_bf16 v[120:123], v[200:203], v[164:167], v[120:123]
    v_mfma_f32_16x16x32_bf16 v[124:127], v[164:167], v[204:207], v[124:127]
    v_mfma_f32_16x16x32_bf16 v[128:131], v[208:211], v[164:167], v[128:131]
    v_mfma_f32_16x16x32_bf16 v[144:147], v[208:211], v[168:171], v[144:147]
    v_mfma_f32_16x16x32_bf16 v[140:143], v[168:171], v[204:207], v[140:143]
    v_mfma_f32_16x16x32_bf16 v[136:139], v[200:203], v[168:171], v[136:139]
    v_mfma_f32_16x16x32_bf16 v[132:135], v[196:199], v[168:171], v[132:135]
    s_waitcnt lgkmcnt(0)
    s_barrier
    v_mfma_f32_16x16x32_bf16 v[52:55], v[212:215], v[172:175], v[52:55]
    ds_read_b64_tr_b16 v[196:197], v43 offset:0
    v_mfma_f32_16x16x32_bf16 v[56:59], v[216:219], v[172:175], v[56:59]
    ds_read_b64_tr_b16 v[198:199], v43 offset:1024
    v_mfma_f32_16x16x32_bf16 v[60:63], v[172:175], v[220:223], v[60:63]
    ds_read_b128 v[148:151], v39 offset:0
    v_mfma_f32_16x16x32_bf16 v[64:67], v[224:227], v[172:175], v[64:67]
    ds_read_b64_tr_b16 v[200:201], v44 offset:0
    v_mfma_f32_16x16x32_bf16 v[80:83], v[224:227], v[176:179], v[80:83]
    ds_read_b64_tr_b16 v[202:203], v44 offset:1024
    v_mfma_f32_16x16x32_bf16 v[76:79], v[176:179], v[220:223], v[76:79]
    ds_read_b128 v[152:155], v39 offset:2048
    v_mfma_f32_16x16x32_bf16 v[72:75], v[216:219], v[176:179], v[72:75]
    ds_read_b64_tr_b16 v[204:205], v45 offset:0
    v_mfma_f32_16x16x32_bf16 v[68:71], v[212:215], v[176:179], v[68:71]
    ds_read_b64_tr_b16 v[206:207], v45 offset:1024
    v_mfma_f32_16x16x32_bf16 v[84:87], v[212:215], v[180:183], v[84:87]
    ds_read_b128 v[156:159], v39 offset:4096
    v_mfma_f32_16x16x32_bf16 v[88:91], v[216:219], v[180:183], v[88:91]
    ds_read_b64_tr_b16 v[208:209], v46 offset:0
    v_mfma_f32_16x16x32_bf16 v[92:95], v[180:183], v[220:223], v[92:95]
    ds_read_b64_tr_b16 v[210:211], v46 offset:1024
    v_mfma_f32_16x16x32_bf16 v[96:99], v[224:227], v[180:183], v[96:99]
    ds_read_b128 v[160:163], v39 offset:6144
    v_mfma_f32_16x16x32_bf16 v[112:115], v[224:227], v[184:187], v[112:115]
    ds_read_b128 v[164:167], v39 offset:8192
    v_mfma_f32_16x16x32_bf16 v[108:111], v[184:187], v[220:223], v[108:111]
    ds_read_b128 v[168:171], v39 offset:10240
    v_mfma_f32_16x16x32_bf16 v[104:107], v[216:219], v[184:187], v[104:107]
    v_mfma_f32_16x16x32_bf16 v[100:103], v[212:215], v[184:187], v[100:103]
    v_mfma_f32_16x16x32_bf16 v[116:119], v[212:215], v[188:191], v[116:119]
    v_mfma_f32_16x16x32_bf16 v[120:123], v[216:219], v[188:191], v[120:123]
    v_mfma_f32_16x16x32_bf16 v[124:127], v[188:191], v[220:223], v[124:127]
    v_mfma_f32_16x16x32_bf16 v[128:131], v[224:227], v[188:191], v[128:131]
    v_mfma_f32_16x16x32_bf16 v[144:147], v[224:227], v[192:195], v[144:147]
    v_mfma_f32_16x16x32_bf16 v[140:143], v[192:195], v[220:223], v[140:143]
    v_mfma_f32_16x16x32_bf16 v[136:139], v[216:219], v[192:195], v[136:139]
    v_mfma_f32_16x16x32_bf16 v[132:135], v[212:215], v[192:195], v[132:135]
    s_waitcnt lgkmcnt(0)
    v_mfma_f32_16x16x32_bf16 v[52:55], v[196:199], v[148:151], v[52:55]
    ds_read_b64_tr_b16 v[212:213], v43 offset:8192
    v_mfma_f32_16x16x32_bf16 v[56:59], v[200:203], v[148:151], v[56:59]
    ds_read_b64_tr_b16 v[214:215], v43 offset:9216
    v_mfma_f32_16x16x32_bf16 v[60:63], v[148:151], v[204:207], v[60:63]
    ds_read_b128 v[172:175], v40 offset:0
    v_mfma_f32_16x16x32_bf16 v[64:67], v[208:211], v[148:151], v[64:67]
    ds_read_b64_tr_b16 v[216:217], v44 offset:8192
    v_mfma_f32_16x16x32_bf16 v[80:83], v[208:211], v[152:155], v[80:83]
    ds_read_b64_tr_b16 v[218:219], v44 offset:9216
    v_mfma_f32_16x16x32_bf16 v[76:79], v[152:155], v[204:207], v[76:79]
    ds_read_b128 v[176:179], v40 offset:2048
    v_mfma_f32_16x16x32_bf16 v[72:75], v[200:203], v[152:155], v[72:75]
    ds_read_b64_tr_b16 v[220:221], v45 offset:8192
    v_mfma_f32_16x16x32_bf16 v[68:71], v[196:199], v[152:155], v[68:71]
    ds_read_b64_tr_b16 v[222:223], v45 offset:9216
    v_mfma_f32_16x16x32_bf16 v[84:87], v[196:199], v[156:159], v[84:87]
    ds_read_b128 v[180:183], v40 offset:4096
    v_mfma_f32_16x16x32_bf16 v[88:91], v[200:203], v[156:159], v[88:91]
    ds_read_b64_tr_b16 v[224:225], v46 offset:8192
    v_mfma_f32_16x16x32_bf16 v[92:95], v[156:159], v[204:207], v[92:95]
    ds_read_b64_tr_b16 v[226:227], v46 offset:9216
    v_mfma_f32_16x16x32_bf16 v[96:99], v[208:211], v[156:159], v[96:99]
    ds_read_b128 v[184:187], v40 offset:6144
    v_mfma_f32_16x16x32_bf16 v[112:115], v[208:211], v[160:163], v[112:115]
    ds_read_b128 v[188:191], v40 offset:8192
    v_mfma_f32_16x16x32_bf16 v[108:111], v[160:163], v[204:207], v[108:111]
    ds_read_b128 v[192:195], v40 offset:10240
    v_mfma_f32_16x16x32_bf16 v[104:107], v[200:203], v[160:163], v[104:107]
    v_mfma_f32_16x16x32_bf16 v[100:103], v[196:199], v[160:163], v[100:103]
    v_mfma_f32_16x16x32_bf16 v[116:119], v[196:199], v[164:167], v[116:119]
    v_mfma_f32_16x16x32_bf16 v[120:123], v[200:203], v[164:167], v[120:123]
    v_mfma_f32_16x16x32_bf16 v[124:127], v[164:167], v[204:207], v[124:127]
    v_mfma_f32_16x16x32_bf16 v[128:131], v[208:211], v[164:167], v[128:131]
    v_mfma_f32_16x16x32_bf16 v[144:147], v[208:211], v[168:171], v[144:147]
    v_mfma_f32_16x16x32_bf16 v[140:143], v[168:171], v[204:207], v[140:143]
    v_mfma_f32_16x16x32_bf16 v[136:139], v[200:203], v[168:171], v[136:139]
    v_mfma_f32_16x16x32_bf16 v[132:135], v[196:199], v[168:171], v[132:135]
    s_waitcnt lgkmcnt(0)
    s_barrier
    v_mfma_f32_16x16x32_bf16 v[52:55], v[212:215], v[172:175], v[52:55]
    ds_read_b64_tr_b16 v[196:197], v43 offset:40960
    v_mfma_f32_16x16x32_bf16 v[56:59], v[216:219], v[172:175], v[56:59]
    ds_read_b64_tr_b16 v[198:199], v43 offset:41984
    v_mfma_f32_16x16x32_bf16 v[60:63], v[172:175], v[220:223], v[60:63]
    ds_read_b128 v[148:151], v39 offset:40960
    v_mfma_f32_16x16x32_bf16 v[64:67], v[224:227], v[172:175], v[64:67]
    ds_read_b64_tr_b16 v[200:201], v44 offset:40960
    v_mfma_f32_16x16x32_bf16 v[80:83], v[224:227], v[176:179], v[80:83]
    ds_read_b64_tr_b16 v[202:203], v44 offset:41984
    v_mfma_f32_16x16x32_bf16 v[76:79], v[176:179], v[220:223], v[76:79]
    ds_read_b128 v[152:155], v39 offset:43008
    v_mfma_f32_16x16x32_bf16 v[72:75], v[216:219], v[176:179], v[72:75]
    ds_read_b64_tr_b16 v[204:205], v45 offset:40960
    v_mfma_f32_16x16x32_bf16 v[68:71], v[212:215], v[176:179], v[68:71]
    ds_read_b64_tr_b16 v[206:207], v45 offset:41984
    v_mfma_f32_16x16x32_bf16 v[84:87], v[212:215], v[180:183], v[84:87]
    ds_read_b128 v[156:159], v39 offset:45056
    v_mfma_f32_16x16x32_bf16 v[88:91], v[216:219], v[180:183], v[88:91]
    ds_read_b64_tr_b16 v[208:209], v46 offset:40960
    v_mfma_f32_16x16x32_bf16 v[92:95], v[180:183], v[220:223], v[92:95]
    ds_read_b64_tr_b16 v[210:211], v46 offset:41984
    v_mfma_f32_16x16x32_bf16 v[96:99], v[224:227], v[180:183], v[96:99]
    ds_read_b128 v[160:163], v39 offset:47104
    v_mfma_f32_16x16x32_bf16 v[112:115], v[224:227], v[184:187], v[112:115]
    ds_read_b128 v[164:167], v39 offset:49152
    v_mfma_f32_16x16x32_bf16 v[108:111], v[184:187], v[220:223], v[108:111]
    ds_read_b128 v[168:171], v39 offset:51200
    v_mfma_f32_16x16x32_bf16 v[104:107], v[216:219], v[184:187], v[104:107]
    v_mfma_f32_16x16x32_bf16 v[100:103], v[212:215], v[184:187], v[100:103]
    v_mfma_f32_16x16x32_bf16 v[116:119], v[212:215], v[188:191], v[116:119]
    v_mfma_f32_16x16x32_bf16 v[120:123], v[216:219], v[188:191], v[120:123]
    v_mfma_f32_16x16x32_bf16 v[124:127], v[188:191], v[220:223], v[124:127]
    v_mfma_f32_16x16x32_bf16 v[128:131], v[224:227], v[188:191], v[128:131]
    v_mfma_f32_16x16x32_bf16 v[144:147], v[224:227], v[192:195], v[144:147]
    v_mfma_f32_16x16x32_bf16 v[140:143], v[192:195], v[220:223], v[140:143]
    v_mfma_f32_16x16x32_bf16 v[136:139], v[216:219], v[192:195], v[136:139]
    v_mfma_f32_16x16x32_bf16 v[132:135], v[212:215], v[192:195], v[132:135]
    s_waitcnt lgkmcnt(0)
    v_mfma_f32_16x16x32_bf16 v[52:55], v[196:199], v[148:151], v[52:55]
    ds_read_b64_tr_b16 v[212:213], v43 offset:49152
    v_mfma_f32_16x16x32_bf16 v[56:59], v[200:203], v[148:151], v[56:59]
    ds_read_b64_tr_b16 v[214:215], v43 offset:50176
    v_mfma_f32_16x16x32_bf16 v[60:63], v[148:151], v[204:207], v[60:63]
    ds_read_b128 v[172:175], v40 offset:40960
    v_mfma_f32_16x16x32_bf16 v[64:67], v[208:211], v[148:151], v[64:67]
    ds_read_b64_tr_b16 v[216:217], v44 offset:49152
    v_mfma_f32_16x16x32_bf16 v[80:83], v[208:211], v[152:155], v[80:83]
    ds_read_b64_tr_b16 v[218:219], v44 offset:50176
    v_mfma_f32_16x16x32_bf16 v[76:79], v[152:155], v[204:207], v[76:79]
    ds_read_b128 v[176:179], v40 offset:43008
    v_mfma_f32_16x16x32_bf16 v[72:75], v[200:203], v[152:155], v[72:75]
    ds_read_b64_tr_b16 v[220:221], v45 offset:49152
    v_mfma_f32_16x16x32_bf16 v[68:71], v[196:199], v[152:155], v[68:71]
    ds_read_b64_tr_b16 v[222:223], v45 offset:50176
    v_mfma_f32_16x16x32_bf16 v[84:87], v[196:199], v[156:159], v[84:87]
    ds_read_b128 v[180:183], v40 offset:45056
    v_mfma_f32_16x16x32_bf16 v[88:91], v[200:203], v[156:159], v[88:91]
    ds_read_b64_tr_b16 v[224:225], v46 offset:49152
    v_mfma_f32_16x16x32_bf16 v[92:95], v[156:159], v[204:207], v[92:95]
    ds_read_b64_tr_b16 v[226:227], v46 offset:50176
    v_mfma_f32_16x16x32_bf16 v[96:99], v[208:211], v[156:159], v[96:99]
    ds_read_b128 v[184:187], v40 offset:47104
    v_mfma_f32_16x16x32_bf16 v[112:115], v[208:211], v[160:163], v[112:115]
    ds_read_b128 v[188:191], v40 offset:49152
    v_mfma_f32_16x16x32_bf16 v[108:111], v[160:163], v[204:207], v[108:111]
    ds_read_b128 v[192:195], v40 offset:51200
    v_mfma_f32_16x16x32_bf16 v[104:107], v[200:203], v[160:163], v[104:107]
    v_mfma_f32_16x16x32_bf16 v[100:103], v[196:199], v[160:163], v[100:103]
    v_mfma_f32_16x16x32_bf16 v[116:119], v[196:199], v[164:167], v[116:119]
    v_mfma_f32_16x16x32_bf16 v[120:123], v[200:203], v[164:167], v[120:123]
    v_mfma_f32_16x16x32_bf16 v[124:127], v[164:167], v[204:207], v[124:127]
    v_mfma_f32_16x16x32_bf16 v[128:131], v[208:211], v[164:167], v[128:131]
    v_mfma_f32_16x16x32_bf16 v[144:147], v[208:211], v[168:171], v[144:147]
    v_mfma_f32_16x16x32_bf16 v[140:143], v[168:171], v[204:207], v[140:143]
    v_mfma_f32_16x16x32_bf16 v[136:139], v[200:203], v[168:171], v[136:139]
    v_mfma_f32_16x16x32_bf16 v[132:135], v[196:199], v[168:171], v[132:135]
    s_waitcnt lgkmcnt(0)
    s_barrier
    v_mfma_f32_16x16x32_bf16 v[52:55], v[212:215], v[172:175], v[52:55]
    ds_read_b64_tr_b16 v[196:197], v47 offset:0
    v_mfma_f32_16x16x32_bf16 v[56:59], v[216:219], v[172:175], v[56:59]
    ds_read_b64_tr_b16 v[198:199], v47 offset:1024
    v_mfma_f32_16x16x32_bf16 v[60:63], v[172:175], v[220:223], v[60:63]
    ds_read_b128 v[148:151], v41 offset:0
    v_mfma_f32_16x16x32_bf16 v[64:67], v[224:227], v[172:175], v[64:67]
    ds_read_b64_tr_b16 v[200:201], v48 offset:0
    v_mfma_f32_16x16x32_bf16 v[80:83], v[224:227], v[176:179], v[80:83]
    ds_read_b64_tr_b16 v[202:203], v48 offset:1024
    v_mfma_f32_16x16x32_bf16 v[76:79], v[176:179], v[220:223], v[76:79]
    ds_read_b128 v[152:155], v41 offset:2048
    v_mfma_f32_16x16x32_bf16 v[72:75], v[216:219], v[176:179], v[72:75]
    ds_read_b64_tr_b16 v[204:205], v49 offset:0
    v_mfma_f32_16x16x32_bf16 v[68:71], v[212:215], v[176:179], v[68:71]
    ds_read_b64_tr_b16 v[206:207], v49 offset:1024
    v_mfma_f32_16x16x32_bf16 v[84:87], v[212:215], v[180:183], v[84:87]
    ds_read_b128 v[156:159], v41 offset:4096
    v_mfma_f32_16x16x32_bf16 v[88:91], v[216:219], v[180:183], v[88:91]
    ds_read_b64_tr_b16 v[208:209], v50 offset:0
    v_mfma_f32_16x16x32_bf16 v[92:95], v[180:183], v[220:223], v[92:95]
    ds_read_b64_tr_b16 v[210:211], v50 offset:1024
    v_mfma_f32_16x16x32_bf16 v[96:99], v[224:227], v[180:183], v[96:99]
    ds_read_b128 v[160:163], v41 offset:6144
    v_mfma_f32_16x16x32_bf16 v[112:115], v[224:227], v[184:187], v[112:115]
    ds_read_b128 v[164:167], v41 offset:8192
    v_mfma_f32_16x16x32_bf16 v[108:111], v[184:187], v[220:223], v[108:111]
    ds_read_b128 v[168:171], v41 offset:10240
    v_mfma_f32_16x16x32_bf16 v[104:107], v[216:219], v[184:187], v[104:107]
    v_mfma_f32_16x16x32_bf16 v[100:103], v[212:215], v[184:187], v[100:103]
    v_mfma_f32_16x16x32_bf16 v[116:119], v[212:215], v[188:191], v[116:119]
    v_mfma_f32_16x16x32_bf16 v[120:123], v[216:219], v[188:191], v[120:123]
    v_mfma_f32_16x16x32_bf16 v[124:127], v[188:191], v[220:223], v[124:127]
    v_mfma_f32_16x16x32_bf16 v[128:131], v[224:227], v[188:191], v[128:131]
    v_mfma_f32_16x16x32_bf16 v[144:147], v[224:227], v[192:195], v[144:147]
    v_mfma_f32_16x16x32_bf16 v[140:143], v[192:195], v[220:223], v[140:143]
    v_mfma_f32_16x16x32_bf16 v[136:139], v[216:219], v[192:195], v[136:139]
    v_mfma_f32_16x16x32_bf16 v[132:135], v[212:215], v[192:195], v[132:135]
    s_waitcnt lgkmcnt(0)
    v_mfma_f32_16x16x32_bf16 v[52:55], v[196:199], v[148:151], v[52:55]
    ds_read_b64_tr_b16 v[212:213], v47 offset:8192
    v_mfma_f32_16x16x32_bf16 v[56:59], v[200:203], v[148:151], v[56:59]
    ds_read_b64_tr_b16 v[214:215], v47 offset:9216
    v_mfma_f32_16x16x32_bf16 v[60:63], v[148:151], v[204:207], v[60:63]
    ds_read_b128 v[172:175], v42 offset:0
    v_mfma_f32_16x16x32_bf16 v[64:67], v[208:211], v[148:151], v[64:67]
    ds_read_b64_tr_b16 v[216:217], v48 offset:8192
    v_mfma_f32_16x16x32_bf16 v[80:83], v[208:211], v[152:155], v[80:83]
    ds_read_b64_tr_b16 v[218:219], v48 offset:9216
    v_mfma_f32_16x16x32_bf16 v[76:79], v[152:155], v[204:207], v[76:79]
    ds_read_b128 v[176:179], v42 offset:2048
    v_mfma_f32_16x16x32_bf16 v[72:75], v[200:203], v[152:155], v[72:75]
    ds_read_b64_tr_b16 v[220:221], v49 offset:8192
    v_mfma_f32_16x16x32_bf16 v[68:71], v[196:199], v[152:155], v[68:71]
    ds_read_b64_tr_b16 v[222:223], v49 offset:9216
    v_mfma_f32_16x16x32_bf16 v[84:87], v[196:199], v[156:159], v[84:87]
    ds_read_b128 v[180:183], v42 offset:4096
    v_mfma_f32_16x16x32_bf16 v[88:91], v[200:203], v[156:159], v[88:91]
    ds_read_b64_tr_b16 v[224:225], v50 offset:8192
    v_mfma_f32_16x16x32_bf16 v[92:95], v[156:159], v[204:207], v[92:95]
    ds_read_b64_tr_b16 v[226:227], v50 offset:9216
    v_mfma_f32_16x16x32_bf16 v[96:99], v[208:211], v[156:159], v[96:99]
    ds_read_b128 v[184:187], v42 offset:6144
    v_mfma_f32_16x16x32_bf16 v[112:115], v[208:211], v[160:163], v[112:115]
    ds_read_b128 v[188:191], v42 offset:8192
    v_mfma_f32_16x16x32_bf16 v[108:111], v[160:163], v[204:207], v[108:111]
    ds_read_b128 v[192:195], v42 offset:10240
    v_mfma_f32_16x16x32_bf16 v[104:107], v[200:203], v[160:163], v[104:107]
    v_mfma_f32_16x16x32_bf16 v[100:103], v[196:199], v[160:163], v[100:103]
    v_mfma_f32_16x16x32_bf16 v[116:119], v[196:199], v[164:167], v[116:119]
    v_mfma_f32_16x16x32_bf16 v[120:123], v[200:203], v[164:167], v[120:123]
    v_mfma_f32_16x16x32_bf16 v[124:127], v[164:167], v[204:207], v[124:127]
    v_mfma_f32_16x16x32_bf16 v[128:131], v[208:211], v[164:167], v[128:131]
    v_mfma_f32_16x16x32_bf16 v[144:147], v[208:211], v[168:171], v[144:147]
    v_mfma_f32_16x16x32_bf16 v[140:143], v[168:171], v[204:207], v[140:143]
    v_mfma_f32_16x16x32_bf16 v[136:139], v[200:203], v[168:171], v[136:139]
    v_mfma_f32_16x16x32_bf16 v[132:135], v[196:199], v[168:171], v[132:135]
    s_waitcnt lgkmcnt(0)
    s_barrier
    v_mfma_f32_16x16x32_bf16 v[52:55], v[212:215], v[172:175], v[52:55]
    ds_read_b64_tr_b16 v[196:197], v43 offset:0
    v_mfma_f32_16x16x32_bf16 v[56:59], v[216:219], v[172:175], v[56:59]
    ds_read_b64_tr_b16 v[198:199], v43 offset:1024
    v_mfma_f32_16x16x32_bf16 v[60:63], v[172:175], v[220:223], v[60:63]
    ds_read_b128 v[148:151], v39 offset:0
    v_mfma_f32_16x16x32_bf16 v[64:67], v[224:227], v[172:175], v[64:67]
    ds_read_b64_tr_b16 v[200:201], v44 offset:0
    v_mfma_f32_16x16x32_bf16 v[80:83], v[224:227], v[176:179], v[80:83]
    ds_read_b64_tr_b16 v[202:203], v44 offset:1024
    v_mfma_f32_16x16x32_bf16 v[76:79], v[176:179], v[220:223], v[76:79]
    ds_read_b128 v[152:155], v39 offset:2048
    v_mfma_f32_16x16x32_bf16 v[72:75], v[216:219], v[176:179], v[72:75]
    ds_read_b64_tr_b16 v[204:205], v45 offset:0
    v_mfma_f32_16x16x32_bf16 v[68:71], v[212:215], v[176:179], v[68:71]
    ds_read_b64_tr_b16 v[206:207], v45 offset:1024
    v_mfma_f32_16x16x32_bf16 v[84:87], v[212:215], v[180:183], v[84:87]
    ds_read_b128 v[156:159], v39 offset:4096
    v_mfma_f32_16x16x32_bf16 v[88:91], v[216:219], v[180:183], v[88:91]
    ds_read_b64_tr_b16 v[208:209], v46 offset:0
    v_mfma_f32_16x16x32_bf16 v[92:95], v[180:183], v[220:223], v[92:95]
    ds_read_b64_tr_b16 v[210:211], v46 offset:1024
    v_mfma_f32_16x16x32_bf16 v[96:99], v[224:227], v[180:183], v[96:99]
    ds_read_b128 v[160:163], v39 offset:6144
    v_mfma_f32_16x16x32_bf16 v[112:115], v[224:227], v[184:187], v[112:115]
    ds_read_b128 v[164:167], v39 offset:8192
    v_mfma_f32_16x16x32_bf16 v[108:111], v[184:187], v[220:223], v[108:111]
    ds_read_b128 v[168:171], v39 offset:10240
    v_mfma_f32_16x16x32_bf16 v[104:107], v[216:219], v[184:187], v[104:107]
    v_mfma_f32_16x16x32_bf16 v[100:103], v[212:215], v[184:187], v[100:103]
    v_mfma_f32_16x16x32_bf16 v[116:119], v[212:215], v[188:191], v[116:119]
    v_mfma_f32_16x16x32_bf16 v[120:123], v[216:219], v[188:191], v[120:123]
    v_mfma_f32_16x16x32_bf16 v[124:127], v[188:191], v[220:223], v[124:127]
    v_mfma_f32_16x16x32_bf16 v[128:131], v[224:227], v[188:191], v[128:131]
    v_mfma_f32_16x16x32_bf16 v[144:147], v[224:227], v[192:195], v[144:147]
    v_mfma_f32_16x16x32_bf16 v[140:143], v[192:195], v[220:223], v[140:143]
    v_mfma_f32_16x16x32_bf16 v[136:139], v[216:219], v[192:195], v[136:139]
    v_mfma_f32_16x16x32_bf16 v[132:135], v[212:215], v[192:195], v[132:135]
    s_waitcnt lgkmcnt(0)
    v_mfma_f32_16x16x32_bf16 v[52:55], v[196:199], v[148:151], v[52:55]
    ds_read_b64_tr_b16 v[212:213], v43 offset:8192
    v_mfma_f32_16x16x32_bf16 v[56:59], v[200:203], v[148:151], v[56:59]
    ds_read_b64_tr_b16 v[214:215], v43 offset:9216
    v_mfma_f32_16x16x32_bf16 v[60:63], v[148:151], v[204:207], v[60:63]
    ds_read_b128 v[172:175], v40 offset:0
    v_mfma_f32_16x16x32_bf16 v[64:67], v[208:211], v[148:151], v[64:67]
    ds_read_b64_tr_b16 v[216:217], v44 offset:8192
    v_mfma_f32_16x16x32_bf16 v[80:83], v[208:211], v[152:155], v[80:83]
    ds_read_b64_tr_b16 v[218:219], v44 offset:9216
    v_mfma_f32_16x16x32_bf16 v[76:79], v[152:155], v[204:207], v[76:79]
    ds_read_b128 v[176:179], v40 offset:2048
    v_mfma_f32_16x16x32_bf16 v[72:75], v[200:203], v[152:155], v[72:75]
    ds_read_b64_tr_b16 v[220:221], v45 offset:8192
    v_mfma_f32_16x16x32_bf16 v[68:71], v[196:199], v[152:155], v[68:71]
    ds_read_b64_tr_b16 v[222:223], v45 offset:9216
    v_mfma_f32_16x16x32_bf16 v[84:87], v[196:199], v[156:159], v[84:87]
    ds_read_b128 v[180:183], v40 offset:4096
    v_mfma_f32_16x16x32_bf16 v[88:91], v[200:203], v[156:159], v[88:91]
    ds_read_b64_tr_b16 v[224:225], v46 offset:8192
    v_mfma_f32_16x16x32_bf16 v[92:95], v[156:159], v[204:207], v[92:95]
    ds_read_b64_tr_b16 v[226:227], v46 offset:9216
    v_mfma_f32_16x16x32_bf16 v[96:99], v[208:211], v[156:159], v[96:99]
    ds_read_b128 v[184:187], v40 offset:6144
    v_mfma_f32_16x16x32_bf16 v[112:115], v[208:211], v[160:163], v[112:115]
    ds_read_b128 v[188:191], v40 offset:8192
    v_mfma_f32_16x16x32_bf16 v[108:111], v[160:163], v[204:207], v[108:111]
    ds_read_b128 v[192:195], v40 offset:10240
    v_mfma_f32_16x16x32_bf16 v[104:107], v[200:203], v[160:163], v[104:107]
    v_mfma_f32_16x16x32_bf16 v[100:103], v[196:199], v[160:163], v[100:103]
    v_mfma_f32_16x16x32_bf16 v[116:119], v[196:199], v[164:167], v[116:119]
    v_mfma_f32_16x16x32_bf16 v[120:123], v[200:203], v[164:167], v[120:123]
    v_mfma_f32_16x16x32_bf16 v[124:127], v[164:167], v[204:207], v[124:127]
    v_mfma_f32_16x16x32_bf16 v[128:131], v[208:211], v[164:167], v[128:131]
    v_mfma_f32_16x16x32_bf16 v[144:147], v[208:211], v[168:171], v[144:147]
    v_mfma_f32_16x16x32_bf16 v[140:143], v[168:171], v[204:207], v[140:143]
    v_mfma_f32_16x16x32_bf16 v[136:139], v[200:203], v[168:171], v[136:139]
    v_mfma_f32_16x16x32_bf16 v[132:135], v[196:199], v[168:171], v[132:135]
    s_waitcnt lgkmcnt(0)
    s_barrier
    v_mfma_f32_16x16x32_bf16 v[52:55], v[212:215], v[172:175], v[52:55]
    ds_read_b64_tr_b16 v[196:197], v43 offset:40960
    v_mfma_f32_16x16x32_bf16 v[56:59], v[216:219], v[172:175], v[56:59]
    ds_read_b64_tr_b16 v[198:199], v43 offset:41984
    v_mfma_f32_16x16x32_bf16 v[60:63], v[172:175], v[220:223], v[60:63]
    ds_read_b128 v[148:151], v39 offset:40960
    v_mfma_f32_16x16x32_bf16 v[64:67], v[224:227], v[172:175], v[64:67]
    ds_read_b64_tr_b16 v[200:201], v44 offset:40960
    v_mfma_f32_16x16x32_bf16 v[80:83], v[224:227], v[176:179], v[80:83]
    ds_read_b64_tr_b16 v[202:203], v44 offset:41984
    v_mfma_f32_16x16x32_bf16 v[76:79], v[176:179], v[220:223], v[76:79]
    ds_read_b128 v[152:155], v39 offset:43008
    v_mfma_f32_16x16x32_bf16 v[72:75], v[216:219], v[176:179], v[72:75]
    ds_read_b64_tr_b16 v[204:205], v45 offset:40960
    v_mfma_f32_16x16x32_bf16 v[68:71], v[212:215], v[176:179], v[68:71]
    ds_read_b64_tr_b16 v[206:207], v45 offset:41984
    v_mfma_f32_16x16x32_bf16 v[84:87], v[212:215], v[180:183], v[84:87]
    ds_read_b128 v[156:159], v39 offset:45056
    v_mfma_f32_16x16x32_bf16 v[88:91], v[216:219], v[180:183], v[88:91]
    ds_read_b64_tr_b16 v[208:209], v46 offset:40960
    v_mfma_f32_16x16x32_bf16 v[92:95], v[180:183], v[220:223], v[92:95]
    ds_read_b64_tr_b16 v[210:211], v46 offset:41984
    v_mfma_f32_16x16x32_bf16 v[96:99], v[224:227], v[180:183], v[96:99]
    ds_read_b128 v[160:163], v39 offset:47104
    v_mfma_f32_16x16x32_bf16 v[112:115], v[224:227], v[184:187], v[112:115]
    ds_read_b128 v[164:167], v39 offset:49152
    v_mfma_f32_16x16x32_bf16 v[108:111], v[184:187], v[220:223], v[108:111]
    ds_read_b128 v[168:171], v39 offset:51200
    v_mfma_f32_16x16x32_bf16 v[104:107], v[216:219], v[184:187], v[104:107]
    v_mfma_f32_16x16x32_bf16 v[100:103], v[212:215], v[184:187], v[100:103]
    v_mfma_f32_16x16x32_bf16 v[116:119], v[212:215], v[188:191], v[116:119]
    v_mfma_f32_16x16x32_bf16 v[120:123], v[216:219], v[188:191], v[120:123]
    v_mfma_f32_16x16x32_bf16 v[124:127], v[188:191], v[220:223], v[124:127]
    v_mfma_f32_16x16x32_bf16 v[128:131], v[224:227], v[188:191], v[128:131]
    v_mfma_f32_16x16x32_bf16 v[144:147], v[224:227], v[192:195], v[144:147]
    v_mfma_f32_16x16x32_bf16 v[140:143], v[192:195], v[220:223], v[140:143]
    v_mfma_f32_16x16x32_bf16 v[136:139], v[216:219], v[192:195], v[136:139]
    v_mfma_f32_16x16x32_bf16 v[132:135], v[212:215], v[192:195], v[132:135]
    s_waitcnt lgkmcnt(0)
    v_mfma_f32_16x16x32_bf16 v[52:55], v[196:199], v[148:151], v[52:55]
    ds_read_b64_tr_b16 v[212:213], v43 offset:49152
    v_mfma_f32_16x16x32_bf16 v[56:59], v[200:203], v[148:151], v[56:59]
    s_branch K_PG2
.p2align 12
K_CHM2:
K_STM2:
    s_branch K_WRET_M
    s_nop 0
K_PG2:
    ds_read_b64_tr_b16 v[214:215], v43 offset:50176
    v_mfma_f32_16x16x32_bf16 v[60:63], v[148:151], v[204:207], v[60:63]
    ds_read_b128 v[172:175], v40 offset:40960
    v_mfma_f32_16x16x32_bf16 v[64:67], v[208:211], v[148:151], v[64:67]
    ds_read_b64_tr_b16 v[216:217], v44 offset:49152
    v_mfma_f32_16x16x32_bf16 v[80:83], v[208:211], v[152:155], v[80:83]
    ds_read_b64_tr_b16 v[218:219], v44 offset:50176
    v_mfma_f32_16x16x32_bf16 v[76:79], v[152:155], v[204:207], v[76:79]
    ds_read_b128 v[176:179], v40 offset:43008
    v_mfma_f32_16x16x32_bf16 v[72:75], v[200:203], v[152:155], v[72:75]
    ds_read_b64_tr_b16 v[220:221], v45 offset:49152
    v_mfma_f32_16x16x32_bf16 v[68:71], v[196:199], v[152:155], v[68:71]
    ds_read_b64_tr_b16 v[222:223], v45 offset:50176
    v_mfma_f32_16x16x32_bf16 v[84:87], v[196:199], v[156:159], v[84:87]
    ds_read_b128 v[180:183], v40 offset:45056
    v_mfma_f32_16x16x32_bf16 v[88:91], v[200:203], v[156:159], v[88:91]
    ds_read_b64_tr_b16 v[224:225], v46 offset:49152
    v_mfma_f32_16x16x32_bf16 v[92:95], v[156:159], v[204:207], v[92:95]
    ds_read_b64_tr_b16 v[226:227], v46 offset:50176
    v_mfma_f32_16x16x32_bf16 v[96:99], v[208:211], v[156:159], v[96:99]
    ds_read_b128 v[184:187], v40 offset:47104
    v_mfma_f32_16x16x32_bf16 v[112:115], v[208:211], v[160:163], v[112:115]
    ds_read_b128 v[188:191], v40 offset:49152
    v_mfma_f32_16x16x32_bf16 v[108:111], v[160:163], v[204:207], v[108:111]
    ds_read_b128 v[192:195], v40 offset:51200
    v_mfma_f32_16x16x32_bf16 v[104:107], v[200:203], v[160:163], v[104:107]
    v_mfma_f32_16x16x32_bf16 v[100:103], v[196:199], v[160:163], v[100:103]
    v_mfma_f32_16x16x32_bf16 v[116:119], v[196:199], v[164:167], v[116:119]
    v_mfma_f32_16x16x32_bf16 v[120:123], v[200:203], v[164:167], v[120:123]
    v_mfma_f32_16x16x32_bf16 v[124:127], v[164:167], v[204:207], v[124:127]
    v_mfma_f32_16x16x32_bf16 v[128:131], v[208:211], v[164:167], v[128:131]
    v_mfma_f32_16x16x32_bf16 v[144:147], v[208:211], v[168:171], v[144:147]
    v_mfma_f32_16x16x32_bf16 v[140:143], v[168:171], v[204:207], v[140:143]
    v_mfma_f32_16x16x32_bf16 v[136:139], v[200:203], v[168:171], v[136:139]
    v_mfma_f32_16x16x32_bf16 v[132:135], v[196:199], v[168:171], v[132:135]
    s_waitcnt lgkmcnt(0)
    s_barrier
    v_mfma_f32_16x16x32_bf16 v[52:55], v[212:215], v[172:175], v[52:55]
    ds_read_b64_tr_b16 v[196:197], v47 offset:0
    v_mfma_f32_16x16x32_bf16 v[56:59], v[216:219], v[172:175], v[56:59]
    ds_read_b64_tr_b16 v[198:199], v47 offset:1024
    v_mfma_f32_16x16x32_bf16 v[60:63], v[172:175], v[220:223], v[60:63]
    ds_read_b128 v[148:151], v41 offset:0
    v_mfma_f32_16x16x32_bf16 v[64:67], v[224:227], v[172:175], v[64:67]
    ds_read_b64_tr_b16 v[200:201], v48 offset:0
    v_mfma_f32_16x16x32_bf16 v[80:83], v[224:227], v[176:179], v[80:83]
    ds_read_b64_tr_b16 v[202:203], v48 offset:1024
    v_mfma_f32_16x16x32_bf16 v[76:79], v[176:179], v[220:223], v[76:79]
    ds_read_b128 v[152:155], v41 offset:2048
    v_mfma_f32_16x16x32_bf16 v[72:75], v[216:219], v[176:179], v[72:75]
    ds_read_b64_tr_b16 v[204:205], v49 offset:0
    v_mfma_f32_16x16x32_bf16 v[68:71], v[212:215], v[176:179], v[68:71]
    ds_read_b64_tr_b16 v[206:207], v49 offset:1024
    v_mfma_f32_16x16x32_bf16 v[84:87], v[212:215], v[180:183], v[84:87]
    ds_read_b128 v[156:159], v41 offset:4096
    v_mfma_f32_16x16x32_bf16 v[88:91], v[216:219], v[180:183], v[88:91]
    ds_read_b64_tr_b16 v[208:209], v50 offset:0
    v_mfma_f32_16x16x32_bf16 v[92:95], v[180:183], v[220:223], v[92:95]
    ds_read_b64_tr_b16 v[210:211], v50 offset:1024
    v_mfma_f32_16x16x32_bf16 v[96:99], v[224:227], v[180:183], v[96:99]
    ds_read_b128 v[160:163], v41 offset:6144
    v_mfma_f32_16x16x32_bf16 v[112:115], v[224:227], v[184:187], v[112:115]
    ds_read_b128 v[164:167], v41 offset:8192
    v_mfma_f32_16x16x32_bf16 v[108:111], v[184:187], v[220:223], v[108:111]
    ds_read_b128 v[168:171], v41 offset:10240
    v_mfma_f32_16x16x32_bf16 v[104:107], v[216:219], v[184:187], v[104:107]
    v_mfma_f32_16x16x32_bf16 v[100:103], v[212:215], v[184:187], v[100:103]
    v_mfma_f32_16x16x32_bf16 v[116:119], v[212:215], v[188:191], v[116:119]
    v_mfma_f32_16x16x32_bf16 v[120:123], v[216:219], v[188:191], v[120:123]
    v_mfma_f32_16x16x32_bf16 v[124:127], v[188:191], v[220:223], v[124:127]
    v_mfma_f32_16x16x32_bf16 v[128:131], v[224:227], v[188:191], v[128:131]
    v_mfma_f32_16x16x32_bf16 v[144:147], v[224:227], v[192:195], v[144:147]
    v_mfma_f32_16x16x32_bf16 v[140:143], v[192:195], v[220:223], v[140:143]
    v_mfma_f32_16x16x32_bf16 v[136:139], v[216:219], v[192:195], v[136:139]
    v_mfma_f32_16x16x32_bf16 v[132:135], v[212:215], v[192:195], v[132:135]
    s_waitcnt lgkmcnt(0)
    v_mfma_f32_16x16x32_bf16 v[132:135], v[196:199], v[168:171], v[132:135]
    ds_read_b64_tr_b16 v[212:213], v47 offset:8192
    ds_read_b64_tr_b16 v[214:215], v47 offset:9216
    v_mfma_f32_16x16x32_bf16 v[136:139], v[200:203], v[168:171], v[136:139]
    ds_read_b128 v[192:195], v42 offset:10240
    ds_read_b64_tr_b16 v[216:217], v48 offset:8192
    v_mfma_f32_16x16x32_bf16 v[140:143], v[168:171], v[204:207], v[140:143]
    ds_read_b64_tr_b16 v[218:219], v48 offset:9216
    ds_read_b64_tr_b16 v[220:221], v49 offset:8192
    v_mfma_f32_16x16x32_bf16 v[144:147], v[208:211], v[168:171], v[144:147]
    ds_read_b64_tr_b16 v[222:223], v49 offset:9216
    ds_read_b64_tr_b16 v[224:225], v50 offset:8192
    v_mfma_f32_16x16x32_bf16 v[116:119], v[196:199], v[164:167], v[116:119]
    ds_read_b64_tr_b16 v[226:227], v50 offset:9216
    ds_read_b128 v[188:191], v42 offset:8192
    v_mfma_f32_16x16x32_bf16 v[120:123], v[200:203], v[164:167], v[120:123]
    ds_read_b128 v[184:187], v42 offset:6144
    ds_read_b128 v[180:183], v42 offset:4096
    v_mfma_f32_16x16x32_bf16 v[124:127], v[164:167], v[204:207], v[124:127]
    ds_read_b128 v[176:179], v42 offset:2048
    ds_read_b128 v[172:175], v42 offset:0
    v_mfma_f32_16x16x32_bf16 v[128:131], v[208:211], v[164:167], v[128:131]
    s_waitcnt lgkmcnt(11)
    v_mfma_f32_16x16x32_bf16 v[132:135], v[212:215], v[192:195], v[132:135]
    s_waitcnt lgkmcnt(9)
    v_mfma_f32_16x16x32_bf16 v[136:139], v[216:219], v[192:195], v[136:139]
    s_waitcnt lgkmcnt(7)
    v_mfma_f32_16x16x32_bf16 v[140:143], v[192:195], v[220:223], v[140:143]
    s_waitcnt lgkmcnt(5)
    v_mfma_f32_16x16x32_bf16 v[144:147], v[224:227], v[192:195], v[144:147]
    s_waitcnt lgkmcnt(4)
    v_mfma_f32_16x16x32_bf16 v[116:119], v[212:215], v[188:191], v[116:119]
    v_mfma_f32_16x16x32_bf16 v[120:123], v[216:219], v[188:191], v[120:123]
    v_mfma_f32_16x16x32_bf16 v[124:127], v[188:191], v[220:223], v[124:127]
    v_mfma_f32_16x16x32_bf16 v[128:131], v[224:227], v[188:191], v[128:131]
    v_mfma_f32_16x16x32_bf16 v[100:103], v[196:199], v[160:163], v[100:103]
    v_mfma_f32_16x16x32_bf16 v[104:107], v[200:203], v[160:163], v[104:107]
    v_mfma_f32_16x16x32_bf16 v[108:111], v[160:163], v[204:207], v[108:111]
    v_cvt_pk_bf16_f32 v132, v132, v133
    v_cvt_pk_bf16_f32 v133, v134, v135
    v_mfma_f32_16x16x32_bf16 v[112:115], v[208:211], v[160:163], v[112:115]
    v_cvt_pk_bf16_f32 v136, v136, v137
    v_cvt_pk_bf16_f32 v137, v138, v139
    s_waitcnt lgkmcnt(3)
    v_mfma_f32_16x16x32_bf16 v[100:103], v[212:215], v[184:187], v[100:103]
    v_mov_b32 v138, 0
    v_mov_b32 v139, 0
    v_mfma_f32_16x16x32_bf16 v[104:107], v[216:219], v[184:187], v[104:107]
    v_cvt_pk_bf16_f32 v134, v144, v145
    v_cvt_pk_bf16_f32 v135, v146, v147
    v_mfma_f32_16x16x32_bf16 v[108:111], v[184:187], v[220:223], v[108:111]
    v_cvt_pk_bf16_f32 v240, v140, v141
    v_cvt_pk_bf16_f32 v241, v142, v143
    v_mfma_f32_16x16x32_bf16 v[112:115], v[224:227], v[184:187], v[112:115]
    v_permlane16_swap_b32 v134, v138
    v_permlane16_swap_b32 v135, v139
    ds_write_b64 v32, v[134:135] offset:768
    v_mfma_f32_16x16x32_bf16 v[84:87], v[196:199], v[156:159], v[84:87]
    s_cmp_lg_u32 s54, 0
    s_cbranch_scc1 K_NOX
    ds_write_b64 v34, v[132:133]
    ds_write_b64 v34, v[134:135] offset:512
    ds_write_b64 v34, v[240:241] offset:1024
    v_lshl_add_u32 v2, s55, 2, v38
    ds_write_b16 v2, v38 offset:30
K_NOX:
    v_mfma_f32_16x16x32_bf16 v[88:91], v[200:203], v[156:159], v[88:91]
    v_cvt_pk_bf16_f32 v116, v116, v117
    v_cvt_pk_bf16_f32 v117, v118, v119
    v_mfma_f32_16x16x32_bf16 v[192:195], v[132:135], v[136:139], v[16:19]
    v_cvt_pk_bf16_f32 v120, v120, v121
    v_cvt_pk_bf16_f32 v121, v122, v123
    v_mfma_f32_16x16x32_bf16 v[92:95], v[156:159], v[204:207], v[92:95]
    v_mov_b32 v122, 0
    v_mov_b32 v123, 0
    v_mfma_f32_16x16x32_bf16 v[96:99], v[208:211], v[156:159], v[96:99]
    v_cvt_pk_bf16_f32 v118, v128, v129
    v_cvt_pk_bf16_f32 v119, v130, v131
    s_waitcnt lgkmcnt(3)
    v_mfma_f32_16x16x32_bf16 v[84:87], v[212:215], v[180:183], v[84:87]
    v_cvt_pk_bf16_f32 v238, v124, v125
    v_cvt_pk_bf16_f32 v239, v126, v127
    v_mfma_f32_16x16x32_bf16 v[88:91], v[216:219], v[180:183], v[88:91]
    v_permlane16_swap_b32 v118, v122
    v_permlane16_swap_b32 v119, v123
    ds_write_b64 v32, v[118:119] offset:640
    v_mfma_f32_16x16x32_bf16 v[92:95], v[180:183], v[220:223], v[92:95]
    v_cvt_pk_bf16_f32 v100, v100, v101
    v_cvt_pk_bf16_f32 v101, v102, v103
    v_mfma_f32_16x16x32_bf16 v[168:171], v[116:119], v[136:139], v[12:15]
    v_cvt_pk_bf16_f32 v104, v104, v105
    v_cvt_pk_bf16_f32 v105, v106, v107
    v_mfma_f32_16x16x32_bf16 v[96:99], v[224:227], v[180:183], v[96:99]
    v_mov_b32 v106, 0
    v_mov_b32 v107, 0
    v_mfma_f32_16x16x32_bf16 v[188:191], v[116:119], v[120:123], v[16:19]
    v_cvt_pk_bf16_f32 v102, v112, v113
    v_cvt_pk_bf16_f32 v103, v114, v115
    v_mfma_f32_16x16x32_bf16 v[68:71], v[196:199], v[152:155], v[68:71]
    v_cvt_pk_bf16_f32 v236, v108, v109
    v_cvt_pk_bf16_f32 v237, v110, v111
    v_mfma_f32_16x16x32_bf16 v[72:75], v[200:203], v[152:155], v[72:75]
    v_permlane16_swap_b32 v102, v106
    v_permlane16_swap_b32 v103, v107
    ds_write_b64 v32, v[102:103] offset:512
    v_mfma_f32_16x16x32_bf16 v[76:79], v[152:155], v[204:207], v[76:79]
    v_max3_f32 v168, v168, v169, v192
    v_max3_f32 v170, v170, v171, v194
    v_mfma_f32_16x16x32_bf16 v[164:167], v[100:103], v[120:123], v[12:15]
    v_max_f32 v168, v168, v193
    v_max_f32 v169, v170, v195
    v_mfma_f32_16x16x32_bf16 v[80:83], v[208:211], v[152:155], v[80:83]
    v_cvt_pk_bf16_f32 v168, v168, v169
    v_cvt_pk_bf16_f32 v84, v84, v85
    v_mfma_f32_16x16x32_bf16 v[184:187], v[100:103], v[104:107], v[16:19]
    v_cvt_pk_bf16_f32 v85, v86, v87
    v_cvt_pk_bf16_f32 v88, v88, v89
    s_waitcnt lgkmcnt(4)
    v_mfma_f32_16x16x32_bf16 v[68:71], v[212:215], v[176:179], v[68:71]
    v_cvt_pk_bf16_f32 v89, v90, v91
    v_mov_b32 v90, 0
    v_mfma_f32_16x16x32_bf16 v[72:75], v[216:219], v[176:179], v[72:75]
    v_mov_b32 v91, 0
    v_cvt_pk_bf16_f32 v86, v96, v97
    v_mfma_f32_16x16x32_bf16 v[76:79], v[176:179], v[220:223], v[76:79]
    v_cvt_pk_bf16_f32 v87, v98, v99
    v_cvt_pk_bf16_f32 v234, v92, v93
    v_mfma_f32_16x16x32_bf16 v[80:83], v[224:227], v[176:179], v[80:83]
    v_cvt_pk_bf16_f32 v235, v94, v95
    v_permlane16_swap_b32 v86, v90
    v_mfma_f32_16x16x32_bf16 v[52:55], v[196:199], v[148:151], v[52:55]
    v_permlane16_swap_b32 v87, v91
    ds_write_b64 v32, v[86:87] offset:384
    v_mfma_f32_16x16x32_bf16 v[56:59], v[200:203], v[148:151], v[56:59]
    v_max3_f32 v164, v164, v165, v188
    v_max3_f32 v166, v166, v167, v190
    v_mfma_f32_16x16x32_bf16 v[160:163], v[84:87], v[104:107], v[12:15]
    v_max_f32 v164, v164, v189
    v_max_f32 v165, v166, v191
    v_mfma_f32_16x16x32_bf16 v[60:63], v[148:151], v[204:207], v[60:63]
    v_cvt_pk_bf16_f32 v164, v164, v165
    v_cvt_pk_bf16_f32 v68, v68, v69
    v_mfma_f32_16x16x32_bf16 v[180:183], v[84:87], v[88:91], v[16:19]
    v_cvt_pk_bf16_f32 v69, v70, v71
    v_cvt_pk_bf16_f32 v72, v72, v73
    v_mfma_f32_16x16x32_bf16 v[64:67], v[208:211], v[148:151], v[64:67]
    v_cvt_pk_bf16_f32 v73, v74, v75
    v_mov_b32 v74, 0
    s_waitcnt lgkmcnt(4)
    v_mfma_f32_16x16x32_bf16 v[52:55], v[212:215], v[172:175], v[52:55]
    v_mov_b32 v75, 0
    v_cvt_pk_bf16_f32 v70, v80, v81
    v_mfma_f32_16x16x32_bf16 v[56:59], v[216:219], v[172:175], v[56:59]
    v_cvt_pk_bf16_f32 v71, v82, v83
    v_cvt_pk_bf16_f32 v232, v76, v77
    v_mfma_f32_16x16x32_bf16 v[60:63], v[172:175], v[220:223], v[60:63]
    v_cvt_pk_bf16_f32 v233, v78, v79
    v_permlane16_swap_b32 v70, v74
    v_mfma_f32_16x16x32_bf16 v[64:67], v[224:227], v[172:175], v[64:67]
    v_permlane16_swap_b32 v71, v75
    ds_write_b64 v32, v[70:71] offset:256
    v_lshl_add_u32 v2, s55, 2, v38
    ds_read_b32 v3, v2 offset:28
    v_max3_f32 v160, v160, v161, v184
    v_max3_f32 v162, v162, v163, v186
    v_max_f32 v160, v160, v185
    v_mfma_f32_16x16x32_bf16 v[156:159], v[68:71], v[88:91], v[12:15]
    v_max_f32 v161, v162, v187
    v_cvt_pk_bf16_f32 v160, v160, v161
    v_cvt_pk_bf16_f32 v52, v52, v53
    v_mfma_f32_16x16x32_bf16 v[176:179], v[68:71], v[72:75], v[16:19]
    v_cvt_pk_bf16_f32 v53, v54, v55
    v_cvt_pk_bf16_f32 v56, v56, v57
    v_cvt_pk_bf16_f32 v57, v58, v59
    v_mov_b32 v58, 0
    v_mov_b32 v59, 0
    v_cvt_pk_bf16_f32 v54, v64, v65
    v_cvt_pk_bf16_f32 v55, v66, v67
    v_cvt_pk_bf16_f32 v230, v60, v61
    v_cvt_pk_bf16_f32 v231, v62, v63
    v_permlane16_swap_b32 v54, v58
    v_permlane16_swap_b32 v55, v59
    ds_write_b64 v32, v[54:55] offset:128
    v_max3_f32 v156, v156, v157, v180
    v_max3_f32 v158, v158, v159, v182
    v_max_f32 v156, v156, v181
    s_waitcnt lgkmcnt(0)
    v_readfirstlane_b32 s33, v3
    s_cmp_lt_u32 s33, 1811939328
    s_cbranch_scc1 K_XW
K_XR:
    ds_read_b64 v[196:197], v34
    ds_read_b64 v[198:199], v34 offset:512
    ds_read_b64 v[228:229], v34 offset:1024
    ds_read_b64_tr_b16 v[200:201], v33 offset:0
    ds_read_b64_tr_b16 v[202:203], v33 offset:128
    ds_read_b64_tr_b16 v[204:205], v33 offset:256
    ds_read_b64_tr_b16 v[206:207], v33 offset:384
    ds_read_b64_tr_b16 v[208:209], v33 offset:512
    ds_read_b64_tr_b16 v[210:211], v33 offset:640
    ds_read_b64_tr_b16 v[212:213], v33 offset:768
    v_mfma_f32_16x16x32_bf16 v[152:155], v[52:55], v[72:75], v[20:23]
    v_max_f32 v157, v158, v183
    v_cvt_pk_bf16_f32 v156, v156, v157
    v_mfma_f32_16x16x32_bf16 v[172:175], v[52:55], v[56:59], v[16:19]
    s_nop 0
    s_nop 0
    s_nop 0
    s_nop 0
    s_nop 0
    v_max3_f32 v152, v152, v153, v176
    v_max3_f32 v154, v154, v155, v178
    v_max_f32 v152, v152, v177
    v_max_f32 v153, v154, v179
    v_cvt_pk_bf16_f32 v152, v152, v153
    s_waitcnt lgkmcnt(8)
    v_mfma_f32_16x16x32_bf16 v[148:151], v[196:199], v[56:59], v[12:15]
    v_permlane16_swap_b32 v164, v168
    v_permlane16_swap_b32 v156, v160
    s_nop 1
    v_permlane32_swap_b32 v156, v164
    v_permlane32_swap_b32 v160, v168
    v_lshlrev_b32 v220, 16, v156
    v_and_b32 v221, 0xffff0000, v156
    v_lshlrev_b32 v224, 16, v164
    v_and_b32 v225, 0xffff0000, v164
    v_max3_f32 v148, v148, v149, v172
    v_max3_f32 v150, v150, v151, v174
    v_max_f32 v148, v148, v173
    v_max_f32 v149, v150, v175
    v_cvt_pk_bf16_f32 v148, v148, v149
    v_lshlrev_b32 v222, 16, v160
    v_and_b32 v223, 0xffff0000, v160
    v_permlane16_swap_b32 v148, v152
    v_lshlrev_b32 v226, 16, v168
    v_and_b32 v227, 0xffff0000, v168
    v_lshlrev_b32 v216, 16, v148
    v_and_b32 v217, 0xffff0000, v148
    v_lshlrev_b32 v218, 16, v152
    v_and_b32 v219, 0xffff0000, v152
    v_pk_mul_f32 v[220:221], v[220:221], s[60:61]
    v_pk_mul_f32 v[224:225], v[224:225], s[60:61]
    v_pk_mul_f32 v[222:223], v[222:223], s[60:61]
    v_pk_mul_f32 v[226:227], v[226:227], s[60:61]
    v_pk_mul_f32 v[216:217], v[216:217], s[60:61]
    v_pk_mul_f32 v[218:219], v[218:219], s[60:61]
    v_cvt_pk_bf16_f32 v156, v220, v221
    v_cvt_pk_bf16_f32 v164, v224, v225
    v_cvt_pk_bf16_f32 v160, v222, v223
    v_cvt_pk_bf16_f32 v168, v226, v227
    v_cvt_pk_bf16_f32 v148, v216, v217
    v_cvt_pk_bf16_f32 v152, v218, v219
    v_lshlrev_b32 v218, 16, v152
    v_and_b32 v219, 0xffff0000, v152
    v_lshlrev_b32 v216, 16, v148
    v_and_b32 v217, 0xffff0000, v148
    v_lshlrev_b32 v226, 16, v168
    v_and_b32 v227, 0xffff0000, v168
    v_lshlrev_b32 v222, 16, v160
    v_and_b32 v223, 0xffff0000, v160
    v_lshlrev_b32 v224, 16, v164
    v_and_b32 v225, 0xffff0000, v164
    v_lshlrev_b32 v220, 16, v156
    v_and_b32 v221, 0xffff0000, v156
    v_max3_f32 v174, v216, v217, v218
    v_max3_f32 v172, v220, v221, v224
    v_max_f32 v174, v174, v219
    v_max3_f32 v172, v172, v225, v222
    v_mov_b32 v176, v174
    v_max3_f32 v172, v172, v223, v226
    v_max_f32 v172, v172, v227
    v_permlane32_swap_b32 v174, v176
    v_mul_f32 v172, s58, v172
    v_max_f32 v174, v174, v176
    v_mul_f32 v174, s58, v174
    v_pk_fma_f32 v[220:221], v[220:221], s[58:59], v[172:173] op_sel_hi:[1,1,0] neg_lo:[0,0,1] neg_hi:[0,0,1]
    v_pk_fma_f32 v[222:223], v[222:223], s[58:59], v[172:173] op_sel_hi:[1,1,0] neg_lo:[0,0,1] neg_hi:[0,0,1]
    v_pk_fma_f32 v[224:225], v[224:225], s[58:59], v[172:173] op_sel_hi:[1,1,0] neg_lo:[0,0,1] neg_hi:[0,0,1]
    v_pk_fma_f32 v[226:227], v[226:227], s[58:59], v[172:173] op_sel_hi:[1,1,0] neg_lo:[0,0,1] neg_hi:[0,0,1]
    v_pk_fma_f32 v[216:217], v[216:217], s[58:59], v[174:175] op_sel_hi:[1,1,0] neg_lo:[0,0,1] neg_hi:[0,0,1]
    v_pk_fma_f32 v[218:219], v[218:219], s[58:59], v[174:175] op_sel_hi:[1,1,0] neg_lo:[0,0,1] neg_hi:[0,0,1]
    v_exp_f32 v216, v216
    v_exp_f32 v217, v217
    v_exp_f32 v218, v218
    v_exp_f32 v219, v219
    v_exp_f32 v220, v220
    v_exp_f32 v221, v221
    v_exp_f32 v222, v222
    v_exp_f32 v223, v223
    v_exp_f32 v224, v224
    v_exp_f32 v225, v225
    v_exp_f32 v226, v226
    v_exp_f32 v227, v227
    ds_read_b32 v3, v2 offset:28
    v_pk_add_f32 v[174:175], v[216:217], v[218:219]
    v_pk_add_f32 v[172:173], v[220:221], v[222:223]
    v_add_f32 v174, v174, v175
    v_pk_add_f32 v[178:179], v[224:225], v[226:227]
    v_mov_b32 v176, v174
    v_pk_add_f32 v[172:173], v[172:173], v[178:179]
    v_add_f32 v172, v172, v173
    v_permlane32_swap_b32 v174, v176
    v_rcp_f32 v172, v172
    v_add_f32 v174, v174, v176
    v_rcp_f32 v174, v174
    v_pk_mul_f32 v[220:221], v[220:221], v[172:173] op_sel_hi:[1,0]
    v_pk_mul_f32 v[222:223], v[222:223], v[172:173] op_sel_hi:[1,0]
    v_pk_mul_f32 v[224:225], v[224:225], v[172:173] op_sel_hi:[1,0]
    v_pk_mul_f32 v[226:227], v[226:227], v[172:173] op_sel_hi:[1,0]
    v_pk_mul_f32 v[216:217], v[216:217], v[174:175] op_sel_hi:[1,0]
    v_pk_mul_f32 v[218:219], v[218:219], v[174:175] op_sel_hi:[1,0]
    v_cvt_pk_bf16_f32 v156, v220, v221
    v_cvt_pk_bf16_f32 v164, v224, v225
    v_cvt_pk_bf16_f32 v160, v222, v223
    v_cvt_pk_bf16_f32 v168, v226, v227
    v_cvt_pk_bf16_f32 v148, v216, v217
    v_cvt_pk_bf16_f32 v152, v218, v219
    v_permlane32_swap_b32 v156, v164
    v_permlane32_swap_b32 v160, v168
    v_permlane16_swap_b32 v148, v152
    s_waitcnt lgkmcnt(0)
    v_permlane16_swap_b32 v156, v160
    v_permlane16_swap_b32 v164, v168
    v_readfirstlane_b32 s33, v3
    s_cmp_lt_u32 s33, 1811939332
    s_cbranch_scc1 K_PW
K_PR:
    s_cmp_eq_u32 s36, 0
    s_cbranch_scc1 K_NOHINT
    v_mov_b32 v4, s36
    s_mov_b32 exec_lo, s37
    s_mov_b32 exec_hi, 0
    global_atomic_add v37, v4, s[6:7] sc1
    s_mov_b64 exec, -1
K_NOHINT:
    v_perm_b32 v56, v148, v148, v24
    v_perm_b32 v57, v148, v148, v25
    v_perm_b32 v58, v148, v148, v26
    v_perm_b32 v59, v148, v148, v27
    v_perm_b32 v72, v152, v152, v24
    v_perm_b32 v73, v152, v152, v25
    v_perm_b32 v74, v152, v152, v26
    v_perm_b32 v75, v152, v152, v27
    v_mfma_f32_16x16x32_bf16 v[64:67], v[200:203], v[56:59], 0
    v_mfma_f32_16x16x32_bf16 v[60:63], v[228:231], v[56:59], 0
    v_perm_b32 v88, v156, v156, v24
    v_perm_b32 v89, v156, v156, v25
    v_perm_b32 v90, v156, v156, v26
    v_perm_b32 v91, v156, v156, v27
    v_mfma_f32_16x16x32_bf16 v[80:83], v[202:205], v[72:75], 0
    v_mfma_f32_16x16x32_bf16 v[76:79], v[230:233], v[72:75], 0
    v_perm_b32 v104, v160, v160, v24
    v_perm_b32 v105, v160, v160, v25
    v_perm_b32 v106, v160, v160, v26
    v_perm_b32 v107, v160, v160, v27
    v_mfma_f32_16x16x32_bf16 v[96:99], v[204:207], v[88:91], 0
    v_mfma_f32_16x16x32_bf16 v[92:95], v[232:235], v[88:91], 0
    v_cvt_pk_bf16_f32 v68, v64, v65
    v_cvt_pk_bf16_f32 v69, v66, v67
    ds_write_b64 v35, v[68:69] offset:0
    v_perm_b32 v120, v164, v164, v24
    v_perm_b32 v121, v164, v164, v25
    v_perm_b32 v122, v164, v164, v26
    v_perm_b32 v123, v164, v164, v27
    v_mfma_f32_16x16x32_bf16 v[112:115], v[206:209], v[104:107], 0
    v_mfma_f32_16x16x32_bf16 v[108:111], v[234:237], v[104:107], 0
    v_cvt_pk_bf16_f32 v70, v80, v81
    v_cvt_pk_bf16_f32 v71, v82, v83
    ds_write_b64 v35, v[70:71] offset:256
    v_perm_b32 v136, v168, v168, v24
    v_perm_b32 v137, v168, v168, v25
    v_perm_b32 v138, v168, v168, v26
    v_perm_b32 v139, v168, v168, v27
    v_mfma_f32_16x16x32_bf16 v[128:131], v[208:211], v[120:123], 0
    v_mfma_f32_16x16x32_bf16 v[124:127], v[236:239], v[120:123], 0
    v_cvt_pk_bf16_f32 v100, v96, v97
    v_cvt_pk_bf16_f32 v101, v98, v99
    ds_write_b64 v35, v[100:101] offset:512
    v_mov_b32 v3, 1
    v_mfma_f32_16x16x32_bf16 v[144:147], v[210:213], v[136:139], 0
    v_mfma_f32_16x16x32_bf16 v[140:143], v[238:241], v[136:139], 0
    v_lshl_add_u32 v2, s54, 2, v38
    v_cvt_pk_bf16_f32 v102, v112, v113
    v_cvt_pk_bf16_f32 v103, v114, v115
    ds_write_b64 v35, v[102:103] offset:768
    v_cvt_pk_bf16_f32 v132, v128, v129
    v_cvt_pk_bf16_f32 v133, v130, v131
    ds_write_b64 v35, v[132:133] offset:1024
    s_nop 0
    v_cvt_pk_bf16_f32 v134, v144, v145
    v_cvt_pk_bf16_f32 v135, v146, v147
    ds_write_b64 v35, v[134:135] offset:1280
    s_mov_b64 exec, 1
    ds_add_u32 v2, v3 offset:48
    s_mov_b64 exec, -1
    v_cvt_pk_bf16_f32 v52, v60, v61
    v_cvt_pk_bf16_f32 v54, v76, v77
    v_cvt_pk_bf16_f32 v53, v62, v63
    v_cvt_pk_bf16_f32 v55, v78, v79
    s_nop 0
    v_permlane16_swap_b32 v52, v54
    v_permlane16_swap_b32 v53, v55
    v_min_u32 v52, -2, v52
    buffer_store_dwordx4 v[52:55], v28, s[20:23], 0 offen sc1
    v_cvt_pk_bf16_f32 v84, v92, v93
    v_cvt_pk_bf16_f32 v86, v108, v109
    v_cvt_pk_bf16_f32 v85, v94, v95
    v_cvt_pk_bf16_f32 v87, v110, v111
    s_nop 0
    v_permlane16_swap_b32 v84, v86
    v_permlane16_swap_b32 v85, v87
    v_min_u32 v84, -2, v84
    buffer_store_dwordx4 v[84:87], v29, s[20:23], 0 offen sc1
    ds_read_b32 v3, v2 offset:48
    ds_read_b128 v[196:199], v36
    v_cvt_pk_bf16_f32 v116, v124, v125
    v_cvt_pk_bf16_f32 v118, v140, v141
    v_cvt_pk_bf16_f32 v117, v126, v127
    v_cvt_pk_bf16_f32 v119, v142, v143
    s_nop 0
    v_permlane16_swap_b32 v116, v118
    v_permlane16_swap_b32 v117, v119
    v_min_u32 v116, -2, v116
    buffer_store_dwordx4 v[116:119], v30, s[20:23], 0 offen sc1
    s_waitcnt lgkmcnt(0)
    v_readfirstlane_b32 s33, v3
    s_cmp_lt_u32 s33, 2
    s_cbranch_scc1 K_TW
K_TR:
    v_min_u32 v196, -2, v196
    buffer_store_dwordx4 v[196:199], v31, s[20:23], 0 offen sc1
    s_cmp_eq_u32 s34, -1
    s_cbranch_scc1 K_END
    s_add_u32 s30, s30, 4
    s_branch K_P2_HELP
K_CHM3:
K_STM3:
    s_branch K_WRET_M
    s_nop 0
K_XW:
    s_mov_b32 s3, 1048576
K_CGX:
    ds_read_b32 v3, v2 offset:28
    s_sub_u32 s3, s3, 1
    s_waitcnt lgkmcnt(0)
    v_readfirstlane_b32 s33, v3
    s_cselect_b32 s33, 1811939328, s33
    s_cmp_lt_u32 s33, 1811939328
    s_cbranch_scc1 K_CGX
    s_branch K_XR
K_PW:
    s_mov_b32 s3, 1048576
K_CGP:
    ds_read_b32 v3, v2 offset:28
    s_sub_u32 s3, s3, 1
    s_waitcnt lgkmcnt(0)
    v_readfirstlane_b32 s33, v3
    s_cselect_b32 s33, 1811939332, s33
    s_cmp_lt_u32 s33, 1811939332
    s_cbranch_scc1 K_CGP
    s_branch K_PR
K_TW:
    s_mov_b32 s3, 1048576
K_CGT:
    ds_read_b32 v3, v2 offset:48
    s_sub_u32 s3, s3, 1
    s_waitcnt lgkmcnt(0)
    v_readfirstlane_b32 s33, v3
    s_cselect_b32 s33, 2, s33
    s_cmp_lt_u32 s33, 2
    s_cbranch_scc1 K_CGT
    ds_read_b128 v[196:199], v36
    s_waitcnt lgkmcnt(0)
    s_branch K_TR
K_P2_EARLY:
    s_lshl_b32 s62, s40, 7
    v_lshrrev_b32 v8, 3, v1
    v_lshrrev_b32 v9, 4, v1
    v_mov_b32 v15, 158720
    s_lshl_b32 s61, s40, 3
    s_add_u32 s61, s61, s30
    s_mul_i32 s3, s61, 20480
    s_lshl_b32 s33, s41, 7
    s_add_u32 s3, s3, s33
    v_and_b32 v2, 7, v1
    v_lshlrev_b32 v2, 4, v2
    v_mul_u32_u24 v4, 1280, v8
    v_add3_u32 v10, v2, v4, s3
    s_lshl_b32 s3, s30, 7
    s_add_u32 s3, s3, 159744
    v_lshl_add_u32 v11, v8, 3, s3
    s_mov_b32 s63, 10240
    s_add_u32 s20, s6, 0x100000
    s_addc_u32 s21, s7, 0
    s_mov_b32 s22, 0x280000
    s_mov_b32 s23, 0x20000
    s_mov_b32 s56, s10
    s_mov_b32 s57, s11
    s_mov_b32 s58, 0x280000
    s_mov_b32 s59, 0x20000
    v_mul_u32_u24 v3, 144, v8
    v_add_u32 v3, v2, v3
    s_mul_i32 s3, s30, 2304
    s_add_u32 s3, s3, 140288
    v_add_u32 v14, s3, v3
    buffer_load_dwordx4 v[16:19], v10, s[12:15], 0 offen
    buffer_load_dwordx4 v[20:23], v10, s[12:15], s63 offen
    v_bfe_u32 v48, v1, 2, 2
    v_and_b32 v49, 3, v1
    s_add_u32 s3, s61, s30
    s_lshr_b32 s33, s3, 2
    s_mul_i32 s33, s33, 76
    s_add_u32 s3, s3, s33
    s_lshl_b32 s3, s3, 10
    v_and_b32 v2, 15, v1
    v_lshl_add_u32 v2, v2, 4, s3
    v_lshrrev_b32 v3, 5, v1
    v_lshl_add_u32 v2, v3, 8, v2
    v_and_b32 v4, 1, v9
    v_lshl_add_u32 v52, v4, 10, v2
    v_mov_b32 v53, 0x1f000
    v_lshl_add_u32 v2, v3, 3, v48
    v_lshlrev_b32 v2, 7, v2
    v_lshl_add_u32 v2, v49, 3, v2
    v_lshl_add_u32 v2, v4, 5, v2
    v_lshrrev_b32 v4, 1, v48
    v_lshl_add_u32 v54, v4, 6, v2
    v_xor_b32 v55, 64, v54
    v_mov_b32 v56, v54
    v_mov_b32 v57, v54
    v_and_b32 v2, 31, v1
    v_mul_u32_u24 v2, 144, v2
    v_lshl_add_u32 v2, v3, 3, v2
    s_mul_i32 s3, s30, 4608
    s_add_u32 s3, s3, 140288
    v_add_u32 v50, s3, v2
    s_lshl_b32 s3, s40, 3
    s_mul_i32 s33, s3, 187
    s_lshr_b32 s33, s33, 11
    s_add_u32 s33, s33, 1
    s_mul_i32 s33, s33, 11
    s_add_u32 s3, s61, s30
    s_add_u32 s3, s3, 1
    s_cmp_ge_u32 s3, s33
    s_cselect_b32 s60, 24, 16
    s_cmp_gt_u32 s3, s33
    s_cselect_b32 s60, 20, s60
    v_add_u32 v58, s60, v15
    s_mov_b32 s64, -1
    s_mov_b32 s65, -1
    s_mov_b32 s66, -1
    s_mov_b32 s67, -1
    s_branch K_PG3
.p2align 12
K_CHA0:
K_STA4:
    s_branch K_STA8
K_CHB0:
K_STB4:
    s_branch K_STB8
K_PG3:
    s_mov_b32 s68, -1
    s_mov_b32 s69, -1
    s_mov_b32 s70, 0xfffff
    s_mov_b32 s71, 131072
    v_mov_b32 v108, 0
    v_mov_b32 v109, 0
    v_mov_b32 v110, 0
    v_mov_b32 v111, 0
    v_mov_b32 v112, 0
    v_mov_b32 v113, 0
    v_mov_b32 v114, 0
    v_mov_b32 v115, 0
    v_mov_b32 v116, 0
    v_mov_b32 v117, 0
    v_mov_b32 v118, 0
    v_mov_b32 v119, 0
    v_mov_b32 v120, 0
    v_mov_b32 v121, 0
    v_mov_b32 v122, 0
    v_mov_b32 v123, 0
    v_mov_b32 v124, 0
    v_mov_b32 v125, 0
    v_mov_b32 v126, 0
    v_mov_b32 v127, 0
    v_mov_b32 v128, 0
    v_mov_b32 v129, 0
    v_mov_b32 v130, 0
    v_mov_b32 v131, 0
    v_mov_b32 v132, 0
    v_mov_b32 v133, 0
    v_mov_b32 v134, 0
    v_mov_b32 v135, 0
    v_mov_b32 v136, 0
    v_mov_b32 v137, 0
    v_mov_b32 v138, 0
    v_mov_b32 v139, 0
    s_barrier
    s_branch K_P2_AUXW
K_P2_GM:
    s_lshl_b32 s62, s40, 7
    v_lshrrev_b32 v8, 3, v1
    v_lshrrev_b32 v9, 4, v1
    v_mov_b32 v15, 158720
    s_lshl_b32 s61, s40, 3
    s_add_u32 s61, s61, s30
    s_mul_i32 s3, s61, 20480
    s_lshl_b32 s33, s41, 7
    s_add_u32 s3, s3, s33
    v_and_b32 v2, 7, v1
    v_lshlrev_b32 v2, 4, v2
    v_mul_u32_u24 v4, 1280, v8
    v_add3_u32 v10, v2, v4, s3
    s_lshl_b32 s3, s30, 7
    s_add_u32 s3, s3, 159744
    v_lshl_add_u32 v11, v8, 3, s3
    s_mov_b32 s63, 10240
    s_add_u32 s20, s6, 0x100000
    s_addc_u32 s21, s7, 0
    s_mov_b32 s22, 0x280000
    s_mov_b32 s23, 0x20000
    s_mov_b32 s56, s10
    s_mov_b32 s57, s11
    s_mov_b32 s58, 0x280000
    s_mov_b32 s59, 0x20000
    v_mul_u32_u24 v3, 144, v8
    v_add_u32 v3, v2, v3
    s_mul_i32 s3, s30, 2304
    s_add_u32 s3, s3, 140288
    v_add_u32 v14, s3, v3
    buffer_load_dwordx4 v[16:19], v10, s[12:15], 0 offen
    buffer_load_dwordx4 v[20:23], v10, s[12:15], s63 offen
    v_bfe_u32 v48, v1, 2, 2
    v_and_b32 v49, 3, v1
    s_add_u32 s3, s61, s30
    s_lshr_b32 s33, s3, 2
    s_mul_i32 s33, s33, 76
    s_add_u32 s3, s3, s33
    s_lshl_b32 s3, s3, 10
    v_and_b32 v2, 15, v1
    v_lshl_add_u32 v2, v2, 4, s3
    v_lshrrev_b32 v3, 5, v1
    v_lshl_add_u32 v2, v3, 8, v2
    v_and_b32 v4, 1, v9
    v_lshl_add_u32 v52, v4, 10, v2
    v_mov_b32 v53, 0x1f000
    v_lshl_add_u32 v2, v3, 3, v48
    v_lshlrev_b32 v2, 7, v2
    v_lshl_add_u32 v2, v49, 3, v2
    v_lshl_add_u32 v2, v4, 5, v2
    v_lshrrev_b32 v4, 1, v48
    v_lshl_add_u32 v54, v4, 6, v2
    v_xor_b32 v55, 64, v54
    v_mov_b32 v56, v54
    v_mov_b32 v57, v54
    v_and_b32 v2, 31, v1
    v_mul_u32_u24 v2, 144, v2
    v_lshl_add_u32 v2, v3, 3, v2
    s_mul_i32 s3, s30, 4608
    s_add_u32 s3, s3, 140288
    v_add_u32 v50, s3, v2
    s_lshl_b32 s3, s40, 3
    s_mul_i32 s33, s3, 187
    s_lshr_b32 s33, s33, 11
    s_add_u32 s33, s33, 1
    s_mul_i32 s33, s33, 11
    s_add_u32 s3, s61, s30
    s_add_u32 s3, s3, 1
    s_cmp_ge_u32 s3, s33
    s_cselect_b32 s60, 24, 16
    s_cmp_gt_u32 s3, s33
    s_cselect_b32 s60, 20, s60
    v_add_u32 v58, s60, v15
    s_mov_b32 s64, -1
    s_mov_b32 s65, -1
    s_mov_b32 s66, -1
    s_mov_b32 s67, -1
    s_mov_b32 s68, -1
    s_mov_b32 s69, -1
    s_mov_b32 s70, 0xfffff
    s_mov_b32 s71, 131072
    v_mov_b32 v108, 0
    v_mov_b32 v109, 0
    v_mov_b32 v110, 0
    v_mov_b32 v111, 0
    v_mov_b32 v112, 0
    v_mov_b32 v113, 0
    v_mov_b32 v114, 0
    v_mov_b32 v115, 0
    v_mov_b32 v116, 0
    v_mov_b32 v117, 0
    v_mov_b32 v118, 0
    v_mov_b32 v119, 0
    v_mov_b32 v120, 0
    v_mov_b32 v121, 0
    v_mov_b32 v122, 0
    v_mov_b32 v123, 0
    v_mov_b32 v124, 0
    v_mov_b32 v125, 0
    v_mov_b32 v126, 0
    v_mov_b32 v127, 0
    v_mov_b32 v128, 0
    v_mov_b32 v129, 0
    v_mov_b32 v130, 0
    v_mov_b32 v131, 0
    v_mov_b32 v132, 0
    v_mov_b32 v133, 0
    v_mov_b32 v134, 0
    v_mov_b32 v135, 0
    v_mov_b32 v136, 0
    v_mov_b32 v137, 0
    v_mov_b32 v138, 0
    v_mov_b32 v139, 0
    s_cmp_eq_u32 s30, 0
    s_cbranch_scc1 K_CHB0
    s_cmp_eq_u32 s30, 1
    s_cbranch_scc1 K_CHB1
    s_cmp_eq_u32 s30, 2
    s_cbranch_scc1 K_CHB2
    s_branch K_CHB3
K_WRET_B:
    v_mov_b32 v3, 1
    s_waitcnt vmcnt(2)
    s_mov_b64 exec, 1
    ds_add_u32 v15, v3 offset:44
    s_mov_b64 exec, -1
    s_mov_b32 s3, 1048576
K_P2_GWM:
    ds_read_b32 v2, v15 offset:44
    s_sleep 1
    s_sub_u32 s3, s3, 1
    s_waitcnt lgkmcnt(0)
    v_readfirstlane_b32 s33, v2
    s_nop 3
    s_cselect_b32 s33, 4, s33
    s_cmp_lt_u32 s33, 4
    s_cbranch_scc1 K_P2_GWM
K_P2_GEMM:
    s_setprio 1
    s_mul_i32 s52, s40, 1496
    s_add_u32 s53, s52, 1309
    s_lshr_b32 s52, s52, 11
    s_lshr_b32 s53, s53, 11
    s_sub_u32 s53, s53, s52
    s_mov_b32 s46, 0x84210
    s_mov_b32 s47, s46
    s_waitcnt vmcnt(0)
    v_lshlrev_b32 v32, 16, v16
    v_and_b32 v33, 0xffff0000, v16
    v_lshlrev_b32 v34, 16, v17
    v_and_b32 v35, 0xffff0000, v17
    v_lshlrev_b32 v36, 16, v18
    v_and_b32 v37, 0xffff0000, v18
    v_lshlrev_b32 v38, 16, v19
    v_and_b32 v39, 0xffff0000, v19
    v_lshlrev_b32 v40, 16, v20
    v_and_b32 v41, 0xffff0000, v20
    v_lshlrev_b32 v42, 16, v21
    v_and_b32 v43, 0xffff0000, v21
    v_lshlrev_b32 v44, 16, v22
    v_and_b32 v45, 0xffff0000, v22
    v_lshlrev_b32 v46, 16, v23
    v_and_b32 v47, 0xffff0000, v23
    s_branch K_SPL
K_IT0:
    v_mfma_f32_32x32x16_bf16 v[108:123], v[156:159], v[68:71], v[108:123]
    ds_read_b64_tr_b16 v[140:141], v56 offset:0
    ds_read_b64_tr_b16 v[142:143], v56 offset:512
    s_and_b32 s33, s50, s70
    s_cbranch_scc0 K_RF0
K_RB0:
    s_ff1_i32_b32 s51, s33
    ds_read_b64_tr_b16 v[144:145], v56 offset:2048
    v_mfma_f32_32x32x16_bf16 v[124:139], v[164:167], v[68:71], v[124:139]
    s_bitset0_b32 s70, s51
    s_lshl_b32 s64, s51, 12
    buffer_load_dwordx4 v[60:63], v52, s[20:23], s64 offen offset:0 sc1
    ds_read_b64_tr_b16 v[146:147], v56 offset:2560
    ds_read_b64_tr_b16 v[148:149], v57 offset:0
    v_mfma_f32_32x32x16_bf16 v[108:123], v[160:163], v[72:75], v[108:123]
    buffer_load_dwordx4 v[64:67], v52, s[20:23], s64 offen offset:512 sc1
    ds_read_b64_tr_b16 v[150:151], v57 offset:512
    ds_read_b64_tr_b16 v[152:153], v57 offset:2048
    ds_read_b64_tr_b16 v[154:155], v57 offset:2560
    v_mfma_f32_32x32x16_bf16 v[124:139], v[168:171], v[72:75], v[124:139]
K_TL0:
    s_waitcnt vmcnt(8) lgkmcnt(8)
    v_cmp_u_f32 vcc, v76, v80
    v_and_or_b32 v56, s68, v53, v54
    v_and_or_b32 v57, s68, v53, v55
    s_cbranch_vccnz K_FX1
K_IT1:
    v_mfma_f32_32x32x16_bf16 v[108:123], v[172:175], v[76:79], v[108:123]
    ds_read_b64_tr_b16 v[156:157], v56 offset:0
    ds_read_b64_tr_b16 v[158:159], v56 offset:512
    s_and_b32 s33, s50, s70
    s_cbranch_scc0 K_RF1
K_RB1:
    s_ff1_i32_b32 s51, s33
    ds_read_b64_tr_b16 v[160:161], v56 offset:2048
    v_mfma_f32_32x32x16_bf16 v[124:139], v[180:183], v[76:79], v[124:139]
    s_bitset0_b32 s70, s51
    s_lshl_b32 s65, s51, 12
    buffer_load_dwordx4 v[68:71], v52, s[20:23], s65 offen offset:0 sc1
    ds_read_b64_tr_b16 v[162:163], v56 offset:2560
    ds_read_b64_tr_b16 v[164:165], v57 offset:0
    v_mfma_f32_32x32x16_bf16 v[108:123], v[176:179], v[80:83], v[108:123]
    buffer_load_dwordx4 v[72:75], v52, s[20:23], s65 offen offset:512 sc1
    ds_read_b64_tr_b16 v[166:167], v57 offset:512
    ds_read_b64_tr_b16 v[168:169], v57 offset:2048
    ds_read_b64_tr_b16 v[170:171], v57 offset:2560
    v_mfma_f32_32x32x16_bf16 v[124:139], v[184:187], v[80:83], v[124:139]
K_TL1:
    s_waitcnt vmcnt(8) lgkmcnt(8)
    v_cmp_u_f32 vcc, v84, v88
    v_and_or_b32 v56, s69, v53, v54
    v_and_or_b32 v57, s69, v53, v55
    s_cbranch_vccnz K_FX2
K_IT2:
    v_mfma_f32_32x32x16_bf16 v[108:123], v[140:143], v[84:87], v[108:123]
    ds_read_b64_tr_b16 v[172:173], v56 offset:0
    ds_read_b64_tr_b16 v[174:175], v56 offset:512
    s_and_b32 s33, s50, s70
    s_cbranch_scc0 K_RF2
K_RB2:
    s_ff1_i32_b32 s51, s33
    ds_read_b64_tr_b16 v[176:177], v56 offset:2048
    v_mfma_f32_32x32x16_bf16 v[124:139], v[148:151], v[84:87], v[124:139]
    s_bitset0_b32 s70, s51
    s_lshl_b32 s66, s51, 12
    buffer_load_dwordx4 v[76:79], v52, s[20:23], s66 offen offset:0 sc1
    ds_read_b64_tr_b16 v[178:179], v56 offset:2560
    ds_read_b64_tr_b16 v[180:181], v57 offset:0
    v_mfma_f32_32x32x16_bf16 v[108:123], v[144:147], v[88:91], v[108:123]
    buffer_load_dwordx4 v[80:83], v52, s[20:23], s66 offen offset:512 sc1
    ds_read_b64_tr_b16 v[182:183], v57 offset:512
    ds_read_b64_tr_b16 v[184:185], v57 offset:2048
    ds_read_b64_tr_b16 v[186:187], v57 offset:2560
    v_mfma_f32_32x32x16_bf16 v[124:139], v[152:155], v[88:91], v[124:139]
K_TL2:
    s_waitcnt vmcnt(8) lgkmcnt(8)
    v_cmp_u_f32 vcc, v92, v96
    v_and_or_b32 v56, s64, v53, v54
    v_and_or_b32 v57, s64, v53, v55
    s_cbranch_vccnz K_FX3
K_IT3:
    v_mfma_f32_32x32x16_bf16 v[108:123], v[156:159], v[92:95], v[108:123]
    ds_read_b64_tr_b16 v[140:141], v56 offset:0
    ds_read_b64_tr_b16 v[142:143], v56 offset:512
    s_and_b32 s33, s50, s70
    s_cbranch_scc0 K_RF3
K_RB3:
    s_ff1_i32_b32 s51, s33
    ds_read_b64_tr_b16 v[144:145], v56 offset:2048
    v_mfma_f32_32x32x16_bf16 v[124:139], v[164:167], v[92:95], v[124:139]
    s_bitset0_b32 s70, s51
    s_lshl_b32 s67, s51, 12
    buffer_load_dwordx4 v[84:87], v52, s[20:23], s67 offen offset:0 sc1
    ds_read_b64_tr_b16 v[146:147], v56 offset:2560
    ds_read_b64_tr_b16 v[148:149], v57 offset:0
    v_mfma_f32_32x32x16_bf16 v[108:123], v[160:163], v[96:99], v[108:123]
    buffer_load_dwordx4 v[88:91], v52, s[20:23], s67 offen offset:512 sc1
    ds_read_b64_tr_b16 v[150:151], v57 offset:512
    ds_read_b64_tr_b16 v[152:153], v57 offset:2048
    ds_read_b64_tr_b16 v[154:155], v57 offset:2560
    v_mfma_f32_32x32x16_bf16 v[124:139], v[168:171], v[96:99], v[124:139]
K_TL3:
    s_waitcnt vmcnt(8) lgkmcnt(8)
    v_cmp_u_f32 vcc, v100, v104
    v_and_or_b32 v56, s65, v53, v54
    v_and_or_b32 v57, s65, v53, v55
    s_cbranch_vccnz K_FX4
K_IT4:
    v_mfma_f32_32x32x16_bf16 v[108:123], v[172:175], v[100:103], v[108:123]
    ds_read_b64_tr_b16 v[156:157], v56 offset:0
    ds_read_b64_tr_b16 v[158:159], v56 offset:512
    s_and_b32 s33, s50, s70
    s_cbranch_scc0 K_RF4
K_RB4:
    s_ff1_i32_b32 s51, s33
    ds_read_b64_tr_b16 v[160:161], v56 offset:2048
    v_mfma_f32_32x32x16_bf16 v[124:139], v[180:183], v[100:103], v[124:139]
    s_bitset0_b32 s70, s51
    s_lshl_b32 s68, s51, 12
    buffer_load_dwordx4 v[92:95], v52, s[20:23], s68 offen offset:0 sc1
    ds_read_b64_tr_b16 v[162:163], v56 offset:2560
    ds_read_b64_tr_b16 v[164:165], v57 offset:0
    v_mfma_f32_32x32x16_bf16 v[108:123], v[176:179], v[104:107], v[108:123]
    buffer_load_dwordx4 v[96:99], v52, s[20:23], s68 offen offset:512 sc1
    ds_read_b64_tr_b16 v[166:167], v57 offset:512
    ds_read_b64_tr_b16 v[168:169], v57 offset:2048
    ds_read_b64_tr_b16 v[170:171], v57 offset:2560
    v_mfma_f32_32x32x16_bf16 v[124:139], v[184:187], v[104:107], v[124:139]
K_TL4:
    s_waitcnt vmcnt(8) lgkmcnt(8)
    v_cmp_u_f32 vcc, v60, v64
    v_and_or_b32 v56, s66, v53, v54
    v_and_or_b32 v57, s66, v53, v55
    s_cbranch_vccnz K_FX5
K_IT5:
    v_mfma_f32_32x32x16_bf16 v[108:123], v[140:143], v[60:63], v[108:123]
    ds_read_b64_tr_b16 v[172:173], v56 offset:0
    ds_read_b64_tr_b16 v[174:175], v56 offset:512
    s_and_b32 s33, s50, s70
    s_cbranch_scc0 K_RF5
K_RB5:
    s_ff1_i32_b32 s51, s33
    ds_read_b64_tr_b16 v[176:177], v56 offset:2048
    v_mfma_f32_32x32x16_bf16 v[124:139], v[148:151], v[60:63], v[124:139]
    s_bitset0_b32 s70, s51
    s_lshl_b32 s69, s51, 12
    buffer_load_dwordx4 v[100:103], v52, s[20:23], s69 offen offset:0 sc1
    ds_read_b64_tr_b16 v[178:179], v56 offset:2560
    ds_read_b64_tr_b16 v[180:181], v57 offset:0
    v_mfma_f32_32x32x16_bf16 v[108:123], v[144:147], v[64:67], v[108:123]
    buffer_load_dwordx4 v[104:107], v52, s[20:23], s69 offen offset:512 sc1
    ds_read_b64_tr_b16 v[182:183], v57 offset:512
    ds_read_b64_tr_b16 v[184:185], v57 offset:2048
    ds_read_b64_tr_b16 v[186:187], v57 offset:2560
    v_mfma_f32_32x32x16_bf16 v[124:139], v[152:155], v[64:67], v[124:139]
K_TL5:
    s_waitcnt vmcnt(8) lgkmcnt(8)
    v_cmp_u_f32 vcc, v68, v72
    v_and_or_b32 v56, s67, v53, v54
    v_and_or_b32 v57, s67, v53, v55
    s_cbranch_vccnz K_FX0
    s_branch K_IT0
K_DR0:
    v_mfma_f32_32x32x16_bf16 v[108:123], v[156:159], v[68:71], v[108:123]
    ds_read_b64_tr_b16 v[140:141], v56 offset:0
    ds_read_b64_tr_b16 v[142:143], v56 offset:512
K_DM0:
    ds_read_b64_tr_b16 v[144:145], v56 offset:2048
    s_mov_b32 s64, -1
    v_mfma_f32_32x32x16_bf16 v[124:139], v[164:167], v[68:71], v[124:139]
    buffer_load_dword v3, v52, s[20:23], s64 offen
    ds_read_b64_tr_b16 v[146:147], v56 offset:2560
    ds_read_b64_tr_b16 v[148:149], v57 offset:0
    v_mfma_f32_32x32x16_bf16 v[108:123], v[160:163], v[72:75], v[108:123]
    buffer_load_dword v3, v52, s[20:23], s64 offen
    ds_read_b64_tr_b16 v[150:151], v57 offset:512
    ds_read_b64_tr_b16 v[152:153], v57 offset:2048
    ds_read_b64_tr_b16 v[154:155], v57 offset:2560
    v_mfma_f32_32x32x16_bf16 v[124:139], v[168:171], v[72:75], v[124:139]
    s_waitcnt vmcnt(8) lgkmcnt(8)
    v_cmp_u_f32 vcc, v76, v80
    v_and_or_b32 v56, s68, v53, v54
    v_and_or_b32 v57, s68, v53, v55
    v_mov_b32 v60, -1
    s_cbranch_vccnz K_FX1
K_DR1:
    v_mfma_f32_32x32x16_bf16 v[108:123], v[172:175], v[76:79], v[108:123]
    ds_read_b64_tr_b16 v[156:157], v56 offset:0
    ds_read_b64_tr_b16 v[158:159], v56 offset:512
K_DM1:
    ds_read_b64_tr_b16 v[160:161], v56 offset:2048
    s_mov_b32 s65, -1
    v_mfma_f32_32x32x16_bf16 v[124:139], v[180:183], v[76:79], v[124:139]
    buffer_load_dword v3, v52, s[20:23], s65 offen
    ds_read_b64_tr_b16 v[162:163], v56 offset:2560
    ds_read_b64_tr_b16 v[164:165], v57 offset:0
    v_mfma_f32_32x32x16_bf16 v[108:123], v[176:179], v[80:83], v[108:123]
    buffer_load_dword v3, v52, s[20:23], s65 offen
    ds_read_b64_tr_b16 v[166:167], v57 offset:512
    ds_read_b64_tr_b16 v[168:169], v57 offset:2048
    ds_read_b64_tr_b16 v[170:171], v57 offset:2560
    v_mfma_f32_32x32x16_bf16 v[124:139], v[184:187], v[80:83], v[124:139]
    s_waitcnt vmcnt(8) lgkmcnt(8)
    v_cmp_u_f32 vcc, v84, v88
    v_and_or_b32 v56, s69, v53, v54
    v_and_or_b32 v57, s69, v53, v55
    v_mov_b32 v68, -1
    s_cbranch_vccnz K_FX2
K_DR2:
    v_mfma_f32_32x32x16_bf16 v[108:123], v[140:143], v[84:87], v[108:123]
    ds_read_b64_tr_b16 v[172:173], v56 offset:0
    ds_read_b64_tr_b16 v[174:175], v56 offset:512
K_DM2:
    ds_read_b64_tr_b16 v[176:177], v56 offset:2048
    s_mov_b32 s66, -1
    v_mfma_f32_32x32x16_bf16 v[124:139], v[148:151], v[84:87], v[124:139]
    buffer_load_dword v3, v52, s[20:23], s66 offen
    ds_read_b64_tr_b16 v[178:179], v56 offset:2560
    ds_read_b64_tr_b16 v[180:181], v57 offset:0
    v_mfma_f32_32x32x16_bf16 v[108:123], v[144:147], v[88:91], v[108:123]
    buffer_load_dword v3, v52, s[20:23], s66 offen
    ds_read_b64_tr_b16 v[182:183], v57 offset:512
    ds_read_b64_tr_b16 v[184:185], v57 offset:2048
    ds_read_b64_tr_b16 v[186:187], v57 offset:2560
    v_mfma_f32_32x32x16_bf16 v[124:139], v[152:155], v[88:91], v[124:139]
    s_waitcnt vmcnt(8) lgkmcnt(8)
    v_cmp_u_f32 vcc, v92, v96
    v_and_or_b32 v56, s64, v53, v54
    v_and_or_b32 v57, s64, v53, v55
    v_mov_b32 v76, -1
    s_cbranch_vccnz K_FX3
K_DR3:
    v_mfma_f32_32x32x16_bf16 v[108:123], v[156:159], v[92:95], v[108:123]
    ds_read_b64_tr_b16 v[140:141], v56 offset:0
    ds_read_b64_tr_b16 v[142:143], v56 offset:512
K_DM3:
    ds_read_b64_tr_b16 v[144:145], v56 offset:2048
    s_mov_b32 s67, -1
    v_mfma_f32_32x32x16_bf16 v[124:139], v[164:167], v[92:95], v[124:139]
    buffer_load_dword v3, v52, s[20:23], s67 offen
    ds_read_b64_tr_b16 v[146:147], v56 offset:2560
    ds_read_b64_tr_b16 v[148:149], v57 offset:0
    v_mfma_f32_32x32x16_bf16 v[108:123], v[160:163], v[96:99], v[108:123]
    buffer_load_dword v3, v52, s[20:23], s67 offen
    ds_read_b64_tr_b16 v[150:151], v57 offset:512
    ds_read_b64_tr_b16 v[152:153], v57 offset:2048
    ds_read_b64_tr_b16 v[154:155], v57 offset:2560
    v_mfma_f32_32x32x16_bf16 v[124:139], v[168:171], v[96:99], v[124:139]
    s_waitcnt vmcnt(8) lgkmcnt(8)
    v_cmp_u_f32 vcc, v100, v104
    v_and_or_b32 v56, s65, v53, v54
    v_and_or_b32 v57, s65, v53, v55
    v_mov_b32 v84, -1
    s_cbranch_vccnz K_FX4
K_DR4:
    v_mfma_f32_32x32x16_bf16 v[108:123], v[172:175], v[100:103], v[108:123]
    ds_read_b64_tr_b16 v[156:157], v56 offset:0
    ds_read_b64_tr_b16 v[158:159], v56 offset:512
K_DM4:
    ds_read_b64_tr_b16 v[160:161], v56 offset:2048
    s_mov_b32 s68, -1
    v_mfma_f32_32x32x16_bf16 v[124:139], v[180:183], v[100:103], v[124:139]
    buffer_load_dword v3, v52, s[20:23], s68 offen
    ds_read_b64_tr_b16 v[162:163], v56 offset:2560
    ds_read_b64_tr_b16 v[164:165], v57 offset:0
    v_mfma_f32_32x32x16_bf16 v[108:123], v[176:179], v[104:107], v[108:123]
    buffer_load_dword v3, v52, s[20:23], s68 offen
    ds_read_b64_tr_b16 v[166:167], v57 offset:512
    ds_read_b64_tr_b16 v[168:169], v57 offset:2048
    ds_read_b64_tr_b16 v[170:171], v57 offset:2560
    v_mfma_f32_32x32x16_bf16 v[124:139], v[184:187], v[104:107], v[124:139]
    s_waitcnt vmcnt(8) lgkmcnt(8)
    v_cmp_u_f32 vcc, v60, v64
    v_and_or_b32 v56, s66, v53, v54
    v_and_or_b32 v57, s66, v53, v55
    v_mov_b32 v92, -1
    s_cbranch_vccnz K_FX5
K_DR5:
    v_mfma_f32_32x32x16_bf16 v[108:123], v[140:143], v[60:63], v[108:123]
    ds_read_b64_tr_b16 v[172:173], v56 offset:0
    ds_read_b64_tr_b16 v[174:175], v56 offset:512
K_DM5:
    ds_read_b64_tr_b16 v[176:177], v56 offset:2048
    s_mov_b32 s69, -1
    v_mfma_f32_32x32x16_bf16 v[124:139], v[148:151], v[60:63], v[124:139]
    buffer_load_dword v3, v52, s[20:23], s69 offen
    ds_read_b64_tr_b16 v[178:179], v56 offset:2560
    ds_read_b64_tr_b16 v[180:181], v57 offset:0
    v_mfma_f32_32x32x16_bf16 v[108:123], v[144:147], v[64:67], v[108:123]
    buffer_load_dword v3, v52, s[20:23], s69 offen
    ds_read_b64_tr_b16 v[182:183], v57 offset:512
    ds_read_b64_tr_b16 v[184:185], v57 offset:2048
    ds_read_b64_tr_b16 v[186:187], v57 offset:2560
    v_mfma_f32_32x32x16_bf16 v[124:139], v[152:155], v[64:67], v[124:139]
    s_waitcnt vmcnt(8) lgkmcnt(8)
    v_cmp_u_f32 vcc, v68, v72
    v_and_or_b32 v56, s67, v53, v54
    v_and_or_b32 v57, s67, v53, v55
    v_mov_b32 v100, -1
    s_cbranch_vccnz K_FX0
    s_branch K_DR0
K_CHA1:
K_STA5:
    s_branch K_STA9
K_CHB1:
K_STB5:
    s_branch K_STB9
K_RF0:
    s_cmp_eq_u32 s70, 0
    s_cbranch_scc1 K_DM0
    ds_read_b32 v59, v58
    s_waitcnt lgkmcnt(0)
    v_readfirstlane_b32 s50, v59
    s_and_b32 s33, s50, s70
    s_cbranch_scc1 K_RB0
K_NV0:
    ds_read_b64_tr_b16 v[144:145], v56 offset:2048
    v_mfma_f32_32x32x16_bf16 v[124:139], v[164:167], v[68:71], v[124:139]
    s_mov_b32 s64, -1
    v_mov_b32 v60, -1
    buffer_load_dword v3, v52, s[20:23], s64 offen
    ds_read_b64_tr_b16 v[146:147], v56 offset:2560
    ds_read_b64_tr_b16 v[148:149], v57 offset:0
    v_mfma_f32_32x32x16_bf16 v[108:123], v[160:163], v[72:75], v[108:123]
    buffer_load_dword v3, v52, s[20:23], s64 offen
    ds_read_b64_tr_b16 v[150:151], v57 offset:512
    ds_read_b64_tr_b16 v[152:153], v57 offset:2048
    ds_read_b64_tr_b16 v[154:155], v57 offset:2560
    v_mfma_f32_32x32x16_bf16 v[124:139], v[168:171], v[72:75], v[124:139]
    s_branch K_TL0
K_FX0:
    s_cmp_lt_i32 s65, 0
    s_cbranch_scc1 K_SK0
    v_max_u32 v2, v68, v72
    v_cmp_eq_u32 vcc, -1, v2
    s_cbranch_vccz K_IT0
    s_sub_u32 s71, s71, 1
    s_cbranch_scc1 K_IT0
    s_lshr_b32 s51, s65, 12
    s_bitset1_b32 s70, s51
K_SK0:
    s_and_b32 s33, s50, s70
    s_cbranch_scc0 K_NUL0
K_BK0:
    s_ff1_i32_b32 s51, s33
    s_lshl_b32 s64, s51, 12
    buffer_load_dwordx4 v[60:63], v52, s[20:23], s64 offen offset:0 sc1
    buffer_load_dwordx4 v[64:67], v52, s[20:23], s64 offen offset:512 sc1
    s_bitset0_b32 s70, s51
K_RD0:
    ds_read_b64_tr_b16 v[140:141], v56 offset:0
    ds_read_b64_tr_b16 v[142:143], v56 offset:512
    ds_read_b64_tr_b16 v[144:145], v56 offset:2048
    ds_read_b64_tr_b16 v[146:147], v56 offset:2560
    ds_read_b64_tr_b16 v[148:149], v57 offset:0
    ds_read_b64_tr_b16 v[150:151], v57 offset:512
    ds_read_b64_tr_b16 v[152:153], v57 offset:2048
    ds_read_b64_tr_b16 v[154:155], v57 offset:2560
    s_cmp_lt_i32 s66, 0
    s_cbranch_scc0 K_TL0
    v_and_or_b32 v56, s68, v53, v54
    v_and_or_b32 v57, s68, v53, v55
    s_branch K_SK1
K_NUL0:
    s_and_b32 s51, s66, s67
    s_and_b32 s51, s51, s68
    s_and_b32 s51, s51, s69
    s_cmp_lt_i32 s51, 0
    s_cbranch_scc0 K_PC0
    s_cmp_eq_u32 s70, 0
    s_cbranch_scc1 K_P2_MM
    s_branch K_SPN
K_PC0:
    s_cmp_eq_u32 s70, 0
    s_cbranch_scc1 K_NI0
    ds_read_b32 v59, v58
    s_waitcnt lgkmcnt(0)
    v_readfirstlane_b32 s50, v59
    s_and_b32 s33, s50, s70
    s_cbranch_scc1 K_BK0
    ds_read_b32 v59, v58
    s_waitcnt lgkmcnt(0)
    v_readfirstlane_b32 s50, v59
    s_and_b32 s33, s50, s70
    s_cbranch_scc1 K_BK0
K_NI0:
    s_mov_b32 s64, -1
    v_mov_b32 v60, -1
    buffer_load_dword v3, v52, s[20:23], s64 offen
    buffer_load_dword v3, v52, s[20:23], s64 offen
    s_branch K_RD0
K_RF1:
    s_cmp_eq_u32 s70, 0
    s_cbranch_scc1 K_DM1
    ds_read_b32 v59, v58
    s_waitcnt lgkmcnt(0)
    v_readfirstlane_b32 s50, v59
    s_and_b32 s33, s50, s70
    s_cbranch_scc1 K_RB1
K_NV1:
    ds_read_b64_tr_b16 v[160:161], v56 offset:2048
    v_mfma_f32_32x32x16_bf16 v[124:139], v[180:183], v[76:79], v[124:139]
    s_mov_b32 s65, -1
    v_mov_b32 v68, -1
    buffer_load_dword v3, v52, s[20:23], s65 offen
    ds_read_b64_tr_b16 v[162:163], v56 offset:2560
    ds_read_b64_tr_b16 v[164:165], v57 offset:0
    v_mfma_f32_32x32x16_bf16 v[108:123], v[176:179], v[80:83], v[108:123]
    buffer_load_dword v3, v52, s[20:23], s65 offen
    ds_read_b64_tr_b16 v[166:167], v57 offset:512
    ds_read_b64_tr_b16 v[168:169], v57 offset:2048
    ds_read_b64_tr_b16 v[170:171], v57 offset:2560
    v_mfma_f32_32x32x16_bf16 v[124:139], v[184:187], v[80:83], v[124:139]
    s_branch K_TL1
K_CHA2:
K_STA6:
    s_branch K_STA10
K_CHB2:
K_STB6:
    s_branch K_STB10
K_FX1:
    s_cmp_lt_i32 s66, 0
    s_cbranch_scc1 K_SK1
    v_max_u32 v2, v76, v80
    v_cmp_eq_u32 vcc, -1, v2
    s_cbranch_vccz K_IT1
    s_sub_u32 s71, s71, 1
    s_cbranch_scc1 K_IT1
    s_lshr_b32 s51, s66, 12
    s_bitset1_b32 s70, s51
K_SK1:
    s_and_b32 s33, s50, s70
    s_cbranch_scc0 K_NUL1
K_BK1:
    s_ff1_i32_b32 s51, s33
    s_lshl_b32 s65, s51, 12
    buffer_load_dwordx4 v[68:71], v52, s[20:23], s65 offen offset:0 sc1
    buffer_load_dwordx4 v[72:75], v52, s[20:23], s65 offen offset:512 sc1
    s_bitset0_b32 s70, s51
K_RD1:
    ds_read_b64_tr_b16 v[156:157], v56 offset:0
    ds_read_b64_tr_b16 v[158:159], v56 offset:512
    ds_read_b64_tr_b16 v[160:161], v56 offset:2048
    ds_read_b64_tr_b16 v[162:163], v56 offset:2560
    ds_read_b64_tr_b16 v[164:165], v57 offset:0
    ds_read_b64_tr_b16 v[166:167], v57 offset:512
    ds_read_b64_tr_b16 v[168:169], v57 offset:2048
    ds_read_b64_tr_b16 v[170:171], v57 offset:2560
    s_cmp_lt_i32 s67, 0
    s_cbranch_scc0 K_TL1
    v_and_or_b32 v56, s69, v53, v54
    v_and_or_b32 v57, s69, v53, v55
    s_branch K_SK2
K_NUL1:
    s_and_b32 s51, s64, s67
    s_and_b32 s51, s51, s68
    s_and_b32 s51, s51, s69
    s_cmp_lt_i32 s51, 0
    s_cbranch_scc0 K_PC1
    s_cmp_eq_u32 s70, 0
    s_cbranch_scc1 K_P2_MM
    s_branch K_SPN
K_PC1:
    s_cmp_eq_u32 s70, 0
    s_cbranch_scc1 K_NI1
    ds_read_b32 v59, v58
    s_waitcnt lgkmcnt(0)
    v_readfirstlane_b32 s50, v59
    s_and_b32 s33, s50, s70
    s_cbranch_scc1 K_BK1
    ds_read_b32 v59, v58
    s_waitcnt lgkmcnt(0)
    v_readfirstlane_b32 s50, v59
    s_and_b32 s33, s50, s70
    s_cbranch_scc1 K_BK1
K_NI1:
    s_mov_b32 s65, -1
    v_mov_b32 v68, -1
    buffer_load_dword v3, v52, s[20:23], s65 offen
    buffer_load_dword v3, v52, s[20:23], s65 offen
    s_branch K_RD1
K_RF2:
    s_cmp_eq_u32 s70, 0
    s_cbranch_scc1 K_DM2
    ds_read_b32 v59, v58
    s_waitcnt lgkmcnt(0)
    v_readfirstlane_b32 s50, v59
    s_and_b32 s33, s50, s70
    s_cbranch_scc1 K_RB2
K_NV2:
    ds_read_b64_tr_b16 v[176:177], v56 offset:2048
    v_mfma_f32_32x32x16_bf16 v[124:139], v[148:151], v[84:87], v[124:139]
    s_mov_b32 s66, -1
    v_mov_b32 v76, -1
    buffer_load_dword v3, v52, s[20:23], s66 offen
    ds_read_b64_tr_b16 v[178:179], v56 offset:2560
    ds_read_b64_tr_b16 v[180:181], v57 offset:0
    v_mfma_f32_32x32x16_bf16 v[108:123], v[144:147], v[88:91], v[108:123]
    buffer_load_dword v3, v52, s[20:23], s66 offen
    ds_read_b64_tr_b16 v[182:183], v57 offset:512
    ds_read_b64_tr_b16 v[184:185], v57 offset:2048
    ds_read_b64_tr_b16 v[186:187], v57 offset:2560
    v_mfma_f32_32x32x16_bf16 v[124:139], v[152:155], v[88:91], v[124:139]
    s_branch K_TL2
K_FX2:
    s_cmp_lt_i32 s67, 0
    s_cbranch_scc1 K_SK2
    v_max_u32 v2, v84, v88
    v_cmp_eq_u32 vcc, -1, v2
    s_cbranch_vccz K_IT2
    s_sub_u32 s71, s71, 1
    s_cbranch_scc1 K_IT2
    s_lshr_b32 s51, s67, 12
    s_bitset1_b32 s70, s51
K_SK2:
    s_and_b32 s33, s50, s70
    s_cbranch_scc0 K_NUL2
K_BK2:
    s_ff1_i32_b32 s51, s33
    s_lshl_b32 s66, s51, 12
    buffer_load_dwordx4 v[76:79], v52, s[20:23], s66 offen offset:0 sc1
    buffer_load_dwordx4 v[80:83], v52, s[20:23], s66 offen offset:512 sc1
    s_bitset0_b32 s70, s51
K_RD2:
    ds_read_b64_tr_b16 v[172:173], v56 offset:0
    ds_read_b64_tr_b16 v[174:175], v56 offset:512
    ds_read_b64_tr_b16 v[176:177], v56 offset:2048
    ds_read_b64_tr_b16 v[178:179], v56 offset:2560
    ds_read_b64_tr_b16 v[180:181], v57 offset:0
    ds_read_b64_tr_b16 v[182:183], v57 offset:512
    ds_read_b64_tr_b16 v[184:185], v57 offset:2048
    ds_read_b64_tr_b16 v[186:187], v57 offset:2560
    s_cmp_lt_i32 s68, 0
    s_cbranch_scc0 K_TL2
    v_and_or_b32 v56, s64, v53, v54
    v_and_or_b32 v57, s64, v53, v55
    s_branch K_SK3
K_CHA3:
K_STA7:
    s_branch K_STA11
K_CHB3:
K_STB7:
    s_branch K_STB11
K_NUL2:
    s_and_b32 s51, s64, s65
    s_and_b32 s51, s51, s68
    s_and_b32 s51, s51, s69
    s_cmp_lt_i32 s51, 0
    s_cbranch_scc0 K_PC2
    s_cmp_eq_u32 s70, 0
    s_cbranch_scc1 K_P2_MM
    s_branch K_SPN
K_PC2:
    s_cmp_eq_u32 s70, 0
    s_cbranch_scc1 K_NI2
    ds_read_b32 v59, v58
    s_waitcnt lgkmcnt(0)
    v_readfirstlane_b32 s50, v59
    s_and_b32 s33, s50, s70
    s_cbranch_scc1 K_BK2
    ds_read_b32 v59, v58
    s_waitcnt lgkmcnt(0)
    v_readfirstlane_b32 s50, v59
    s_and_b32 s33, s50, s70
    s_cbranch_scc1 K_BK2
K_NI2:
    s_branch K_PG4
.p2align 12
K_STA8:
    s_branch K_STA12
K_STB8:
    s_branch K_STB12
K_PG4:
    s_mov_b32 s66, -1
    v_mov_b32 v76, -1
    buffer_load_dword v3, v52, s[20:23], s66 offen
    buffer_load_dword v3, v52, s[20:23], s66 offen
    s_branch K_RD2
K_RF3:
    s_cmp_eq_u32 s70, 0
    s_cbranch_scc1 K_DM3
    ds_read_b32 v59, v58
    s_waitcnt lgkmcnt(0)
    v_readfirstlane_b32 s50, v59
    s_and_b32 s33, s50, s70
    s_cbranch_scc1 K_RB3
K_NV3:
    ds_read_b64_tr_b16 v[144:145], v56 offset:2048
    v_mfma_f32_32x32x16_bf16 v[124:139], v[164:167], v[92:95], v[124:139]
    s_mov_b32 s67, -1
    v_mov_b32 v84, -1
    buffer_load_dword v3, v52, s[20:23], s67 offen
    ds_read_b64_tr_b16 v[146:147], v56 offset:2560
    ds_read_b64_tr_b16 v[148:149], v57 offset:0
    v_mfma_f32_32x32x16_bf16 v[108:123], v[160:163], v[96:99], v[108:123]
    buffer_load_dword v3, v52, s[20:23], s67 offen
    ds_read_b64_tr_b16 v[150:151], v57 offset:512
    ds_read_b64_tr_b16 v[152:153], v57 offset:2048
    ds_read_b64_tr_b16 v[154:155], v57 offset:2560
    v_mfma_f32_32x32x16_bf16 v[124:139], v[168:171], v[96:99], v[124:139]
    s_branch K_TL3
K_FX3:
    s_cmp_lt_i32 s68, 0
    s_cbranch_scc1 K_SK3
    v_max_u32 v2, v92, v96
    v_cmp_eq_u32 vcc, -1, v2
    s_cbranch_vccz K_IT3
    s_sub_u32 s71, s71, 1
    s_cbranch_scc1 K_IT3
    s_lshr_b32 s51, s68, 12
    s_bitset1_b32 s70, s51
K_SK3:
    s_and_b32 s33, s50, s70
    s_cbranch_scc0 K_NUL3
K_BK3:
    s_ff1_i32_b32 s51, s33
    s_lshl_b32 s67, s51, 12
    buffer_load_dwordx4 v[84:87], v52, s[20:23], s67 offen offset:0 sc1
    buffer_load_dwordx4 v[88:91], v52, s[20:23], s67 offen offset:512 sc1
    s_bitset0_b32 s70, s51
K_RD3:
    ds_read_b64_tr_b16 v[140:141], v56 offset:0
    ds_read_b64_tr_b16 v[142:143], v56 offset:512
    ds_read_b64_tr_b16 v[144:145], v56 offset:2048
    ds_read_b64_tr_b16 v[146:147], v56 offset:2560
    ds_read_b64_tr_b16 v[148:149], v57 offset:0
    ds_read_b64_tr_b16 v[150:151], v57 offset:512
    ds_read_b64_tr_b16 v[152:153], v57 offset:2048
    ds_read_b64_tr_b16 v[154:155], v57 offset:2560
    s_cmp_lt_i32 s69, 0
    s_cbranch_scc0 K_TL3
    v_and_or_b32 v56, s65, v53, v54
    v_and_or_b32 v57, s65, v53, v55
    s_branch K_SK4
K_NUL3:
    s_and_b32 s51, s64, s65
    s_and_b32 s51, s51, s66
    s_and_b32 s51, s51, s69
    s_cmp_lt_i32 s51, 0
    s_cbranch_scc0 K_PC3
    s_cmp_eq_u32 s70, 0
    s_cbranch_scc1 K_P2_MM
    s_branch K_SPN
K_PC3:
    s_cmp_eq_u32 s70, 0
    s_cbranch_scc1 K_NI3
    ds_read_b32 v59, v58
    s_waitcnt lgkmcnt(0)
    v_readfirstlane_b32 s50, v59
    s_and_b32 s33, s50, s70
    s_cbranch_scc1 K_BK3
    ds_read_b32 v59, v58
    s_waitcnt lgkmcnt(0)
    v_readfirstlane_b32 s50, v59
    s_and_b32 s33, s50, s70
    s_cbranch_scc1 K_BK3
K_NI3:
    s_mov_b32 s67, -1
    v_mov_b32 v84, -1
    buffer_load_dword v3, v52, s[20:23], s67 offen
    buffer_load_dword v3, v52, s[20:23], s67 offen
    s_branch K_RD3
K_RF4:
    s_cmp_eq_u32 s70, 0
    s_cbranch_scc1 K_DM4
    ds_read_b32 v59, v58
    s_waitcnt lgkmcnt(0)
    v_readfirstlane_b32 s50, v59
    s_and_b32 s33, s50, s70
    s_cbranch_scc1 K_RB4
K_NV4:
    ds_read_b64_tr_b16 v[160:161], v56 offset:2048
    v_mfma_f32_32x32x16_bf16 v[124:139], v[180:183], v[100:103], v[124:139]
    s_mov_b32 s68, -1
    v_mov_b32 v92, -1
    buffer_load_dword v3, v52, s[20:23], s68 offen
    ds_read_b64_tr_b16 v[162:163], v56 offset:2560
    ds_read_b64_tr_b16 v[164:165], v57 offset:0
    v_mfma_f32_32x32x16_bf16 v[108:123], v[176:179], v[104:107], v[108:123]
    buffer_load_dword v3, v52, s[20:23], s68 offen
    ds_read_b64_tr_b16 v[166:167], v57 offset:512
    ds_read_b64_tr_b16 v[168:169], v57 offset:2048
    ds_read_b64_tr_b16 v[170:171], v57 offset:2560
    v_mfma_f32_32x32x16_bf16 v[124:139], v[184:187], v[104:107], v[124:139]
    s_branch K_TL4
K_STA9:
    s_branch K_STA13
K_STB9:
    s_branch K_STB13
K_FX4:
    s_cmp_lt_i32 s69, 0
    s_cbranch_scc1 K_SK4
    v_max_u32 v2, v100, v104
    v_cmp_eq_u32 vcc, -1, v2
    s_cbranch_vccz K_IT4
    s_sub_u32 s71, s71, 1
    s_cbranch_scc1 K_IT4
    s_lshr_b32 s51, s69, 12
    s_bitset1_b32 s70, s51
K_SK4:
    s_and_b32 s33, s50, s70
    s_cbranch_scc0 K_NUL4
K_BK4:
    s_ff1_i32_b32 s51, s33
    s_lshl_b32 s68, s51, 12
    buffer_load_dwordx4 v[92:95], v52, s[20:23], s68 offen offset:0 sc1
    buffer_load_dwordx4 v[96:99], v52, s[20:23], s68 offen offset:512 sc1
    s_bitset0_b32 s70, s51
K_RD4:
    ds_read_b64_tr_b16 v[156:157], v56 offset:0
    ds_read_b64_tr_b16 v[158:159], v56 offset:512
    ds_read_b64_tr_b16 v[160:161], v56 offset:2048
    ds_read_b64_tr_b16 v[162:163], v56 offset:2560
    ds_read_b64_tr_b16 v[164:165], v57 offset:0
    ds_read_b64_tr_b16 v[166:167], v57 offset:512
    ds_read_b64_tr_b16 v[168:169], v57 offset:2048
    ds_read_b64_tr_b16 v[170:171], v57 offset:2560
    s_cmp_lt_i32 s64, 0
    s_cbranch_scc0 K_TL4
    v_and_or_b32 v56, s66, v53, v54
    v_and_or_b32 v57, s66, v53, v55
    s_branch K_SK5
K_NUL4:
    s_and_b32 s51, s64, s65
    s_and_b32 s51, s51, s66
    s_and_b32 s51, s51, s67
    s_cmp_lt_i32 s51, 0
    s_cbranch_scc0 K_PC4
    s_cmp_eq_u32 s70, 0
    s_cbranch_scc1 K_P2_MM
    s_branch K_SPN
K_PC4:
    s_cmp_eq_u32 s70, 0
    s_cbranch_scc1 K_NI4
    ds_read_b32 v59, v58
    s_waitcnt lgkmcnt(0)
    v_readfirstlane_b32 s50, v59
    s_and_b32 s33, s50, s70
    s_cbranch_scc1 K_BK4
    ds_read_b32 v59, v58
    s_waitcnt lgkmcnt(0)
    v_readfirstlane_b32 s50, v59
    s_and_b32 s33, s50, s70
    s_cbranch_scc1 K_BK4
K_NI4:
    s_mov_b32 s68, -1
    v_mov_b32 v92, -1
    buffer_load_dword v3, v52, s[20:23], s68 offen
    buffer_load_dword v3, v52, s[20:23], s68 offen
    s_branch K_RD4
K_RF5:
    s_cmp_eq_u32 s70, 0
    s_cbranch_scc1 K_DM5
    ds_read_b32 v59, v58
    s_waitcnt lgkmcnt(0)
    v_readfirstlane_b32 s50, v59
    s_and_b32 s33, s50, s70
    s_cbranch_scc1 K_RB5
K_NV5:
    ds_read_b64_tr_b16 v[176:177], v56 offset:2048
    v_mfma_f32_32x32x16_bf16 v[124:139], v[148:151], v[60:63], v[124:139]
    s_mov_b32 s69, -1
    v_mov_b32 v100, -1
    buffer_load_dword v3, v52, s[20:23], s69 offen
    ds_read_b64_tr_b16 v[178:179], v56 offset:2560
    ds_read_b64_tr_b16 v[180:181], v57 offset:0
    v_mfma_f32_32x32x16_bf16 v[108:123], v[144:147], v[64:67], v[108:123]
    buffer_load_dword v3, v52, s[20:23], s69 offen
    ds_read_b64_tr_b16 v[182:183], v57 offset:512
    ds_read_b64_tr_b16 v[184:185], v57 offset:2048
    ds_read_b64_tr_b16 v[186:187], v57 offset:2560
    v_mfma_f32_32x32x16_bf16 v[124:139], v[152:155], v[64:67], v[124:139]
    s_branch K_TL5
K_FX5:
    s_cmp_lt_i32 s64, 0
    s_cbranch_scc1 K_SK5
    v_max_u32 v2, v60, v64
    v_cmp_eq_u32 vcc, -1, v2
    s_cbranch_vccz K_IT5
    s_sub_u32 s71, s71, 1
    s_cbranch_scc1 K_IT5
    s_lshr_b32 s51, s64, 12
    s_bitset1_b32 s70, s51
K_SK5:
    s_and_b32 s33, s50, s70
    s_cbranch_scc0 K_NUL5
K_BK5:
    s_ff1_i32_b32 s51, s33
    s_lshl_b32 s69, s51, 12
    buffer_load_dwordx4 v[100:103], v52, s[20:23], s69 offen offset:0 sc1
    buffer_load_dwordx4 v[104:107], v52, s[20:23], s69 offen offset:512 sc1
    s_bitset0_b32 s70, s51
K_RD5:
    ds_read_b64_tr_b16 v[172:173], v56 offset:0
    ds_read_b64_tr_b16 v[174:175], v56 offset:512
    ds_read_b64_tr_b16 v[176:177], v56 offset:2048
    ds_read_b64_tr_b16 v[178:179], v56 offset:2560
    ds_read_b64_tr_b16 v[180:181], v57 offset:0
    ds_read_b64_tr_b16 v[182:183], v57 offset:512
    ds_read_b64_tr_b16 v[184:185], v57 offset:2048
    ds_read_b64_tr_b16 v[186:187], v57 offset:2560
    s_cmp_lt_i32 s65, 0
    s_cbranch_scc0 K_TL5
    v_and_or_b32 v56, s67, v53, v54
    v_and_or_b32 v57, s67, v53, v55
    s_branch K_SK0
K_STA10:
    s_branch K_STA14
K_STB10:
    s_branch K_STB14
K_NUL5:
    s_and_b32 s51, s65, s66
    s_and_b32 s51, s51, s67
    s_and_b32 s51, s51, s68
    s_cmp_lt_i32 s51, 0
    s_cbranch_scc0 K_PC5
    s_cmp_eq_u32 s70, 0
    s_cbranch_scc1 K_P2_MM
    s_branch K_SPN
K_PC5:
    s_cmp_eq_u32 s70, 0
    s_cbranch_scc1 K_NI5
    ds_read_b32 v59, v58
    s_waitcnt lgkmcnt(0)
    v_readfirstlane_b32 s50, v59
    s_and_b32 s33, s50, s70
    s_cbranch_scc1 K_BK5
    ds_read_b32 v59, v58
    s_waitcnt lgkmcnt(0)
    v_readfirstlane_b32 s50, v59
    s_and_b32 s33, s50, s70
    s_cbranch_scc1 K_BK5
K_NI5:
    s_mov_b32 s69, -1
    v_mov_b32 v100, -1
    buffer_load_dword v3, v52, s[20:23], s69 offen
    buffer_load_dword v3, v52, s[20:23], s69 offen
    s_branch K_RD5
K_P2_MM:
    v_cvt_pk_bf16_f32 v188, v108, v109
    v_cvt_pk_bf16_f32 v189, v110, v111
    ds_write_b64 v50, v[188:189] offset:0
    v_cvt_pk_bf16_f32 v190, v112, v113
    v_cvt_pk_bf16_f32 v191, v114, v115
    ds_write_b64 v50, v[190:191] offset:16
    v_cvt_pk_bf16_f32 v192, v116, v117
    v_cvt_pk_bf16_f32 v193, v118, v119
    ds_write_b64 v50, v[192:193] offset:32
    v_cvt_pk_bf16_f32 v194, v120, v121
    v_cvt_pk_bf16_f32 v195, v122, v123
    ds_write_b64 v50, v[194:195] offset:48
    v_cvt_pk_bf16_f32 v188, v124, v125
    v_cvt_pk_bf16_f32 v189, v126, v127
    ds_write_b64 v50, v[188:189] offset:64
    v_cvt_pk_bf16_f32 v190, v128, v129
    v_cvt_pk_bf16_f32 v191, v130, v131
    ds_write_b64 v50, v[190:191] offset:80
    v_cvt_pk_bf16_f32 v192, v132, v133
    v_cvt_pk_bf16_f32 v193, v134, v135
    ds_write_b64 v50, v[192:193] offset:96
    v_cvt_pk_bf16_f32 v194, v136, v137
    v_cvt_pk_bf16_f32 v195, v138, v139
    ds_write_b64 v50, v[194:195] offset:112
K_P2_E2:
    s_waitcnt vmcnt(0) lgkmcnt(0)
    s_lshl_b32 s72, s61, 4
    s_barrier
    ds_read_b64 v[28:29], v15
    ds_read_b64 v[24:25], v11
    ds_read_b128 v[48:51], v14
    ds_read_b64 v[26:27], v11 offset:64
    ds_read_b128 v[52:55], v14 offset:1152
    s_waitcnt lgkmcnt(4)
    v_readfirstlane_b32 s48, v28
    v_readfirstlane_b32 s49, v29
    s_sub_u32 s3, s48, s72
    s_cmp_lt_u32 s3, 16
    s_cbranch_scc1 K_YROW0
K_NOY0:
    s_sub_u32 s3, s49, s72
    s_cmp_lt_u32 s3, 16
    s_cbranch_scc1 K_YROW1
K_NOY1:
    s_waitcnt lgkmcnt(3)
    v_pk_mul_f32 v[32:33], v[32:33], v[24:25] op_sel:[0,1] op_sel_hi:[1,1]
    v_pk_mul_f32 v[34:35], v[34:35], v[24:25] op_sel:[0,1] op_sel_hi:[1,1]
    v_pk_mul_f32 v[36:37], v[36:37], v[24:25] op_sel:[0,1] op_sel_hi:[1,1]
    v_pk_mul_f32 v[38:39], v[38:39], v[24:25] op_sel:[0,1] op_sel_hi:[1,1]
    s_waitcnt lgkmcnt(2)
    v_lshlrev_b32 v68, 16, v48
    v_and_b32 v69, 0xffff0000, v48
    v_pk_fma_f32 v[68:69], v[68:69], v[24:25], v[32:33] op_sel_hi:[1,0,1]
    v_cvt_pk_bf16_f32 v48, v68, v69
    v_lshlrev_b32 v70, 16, v49
    v_and_b32 v71, 0xffff0000, v49
    v_pk_fma_f32 v[70:71], v[70:71], v[24:25], v[34:35] op_sel_hi:[1,0,1]
    v_cvt_pk_bf16_f32 v49, v70, v71
    v_lshlrev_b32 v68, 16, v50
    v_and_b32 v69, 0xffff0000, v50
    v_pk_fma_f32 v[68:69], v[68:69], v[24:25], v[36:37] op_sel_hi:[1,0,1]
    v_cvt_pk_bf16_f32 v50, v68, v69
    v_lshlrev_b32 v70, 16, v51
    v_and_b32 v71, 0xffff0000, v51
    v_pk_fma_f32 v[70:71], v[70:71], v[24:25], v[38:39] op_sel_hi:[1,0,1]
    v_cvt_pk_bf16_f32 v51, v70, v71
    buffer_store_dwordx4 v[48:51], v10, s[56:59], 0 offen sc1
    s_waitcnt lgkmcnt(1)
    v_pk_mul_f32 v[40:41], v[40:41], v[26:27] op_sel:[0,1] op_sel_hi:[1,1]
    v_pk_mul_f32 v[42:43], v[42:43], v[26:27] op_sel:[0,1] op_sel_hi:[1,1]
    v_pk_mul_f32 v[44:45], v[44:45], v[26:27] op_sel:[0,1] op_sel_hi:[1,1]
    v_pk_mul_f32 v[46:47], v[46:47], v[26:27] op_sel:[0,1] op_sel_hi:[1,1]
    s_waitcnt lgkmcnt(0)
    v_lshlrev_b32 v68, 16, v52
    v_and_b32 v69, 0xffff0000, v52
    v_pk_fma_f32 v[68:69], v[68:69], v[26:27], v[40:41] op_sel_hi:[1,0,1]
    v_cvt_pk_bf16_f32 v52, v68, v69
    v_lshlrev_b32 v70, 16, v53
    v_and_b32 v71, 0xffff0000, v53
    v_pk_fma_f32 v[70:71], v[70:71], v[26:27], v[42:43] op_sel_hi:[1,0,1]
    v_cvt_pk_bf16_f32 v53, v70, v71
    v_lshlrev_b32 v68, 16, v54
    v_and_b32 v69, 0xffff0000, v54
    v_pk_fma_f32 v[68:69], v[68:69], v[26:27], v[44:45] op_sel_hi:[1,0,1]
    v_cvt_pk_bf16_f32 v54, v68, v69
    v_lshlrev_b32 v70, 16, v55
    v_and_b32 v71, 0xffff0000, v55
    v_pk_fma_f32 v[70:71], v[70:71], v[26:27], v[46:47] op_sel_hi:[1,0,1]
    v_cvt_pk_bf16_f32 v55, v70, v71
    buffer_store_dwordx4 v[52:55], v10, s[56:59], s63 offen sc1
K_END:
K_EXIT:
    s_endpgm
K_YROW0:
    v_and_b32 v2, 7, v1
    v_lshlrev_b32 v2, 5, v2
    v_add_u32 v2, 158976, v2
    ds_read_b128 v[56:59], v2
    ds_read_b128 v[60:63], v2 offset:16
    s_and_b32 s33, s3, 7
    v_cmp_eq_u32 vcc, s33, v8
    s_cmp_ge_u32 s3, 8
    s_cbranch_scc1 K_YR1_0
    s_waitcnt lgkmcnt(0)
    v_add_f32 v64, v32, v56
    v_cvt_pk_bf16_f32 v64, v64, v64
    v_lshlrev_b32 v64, 16, v64
    v_cndmask_b32 v32, v32, v64, vcc
    v_add_f32 v65, v33, v57
    v_cvt_pk_bf16_f32 v65, v65, v65
    v_lshlrev_b32 v65, 16, v65
    v_cndmask_b32 v33, v33, v65, vcc
    v_add_f32 v66, v34, v58
    v_cvt_pk_bf16_f32 v66, v66, v66
    v_lshlrev_b32 v66, 16, v66
    v_cndmask_b32 v34, v34, v66, vcc
    v_add_f32 v67, v35, v59
    v_cvt_pk_bf16_f32 v67, v67, v67
    v_lshlrev_b32 v67, 16, v67
    v_cndmask_b32 v35, v35, v67, vcc
    v_add_f32 v64, v36, v60
    v_cvt_pk_bf16_f32 v64, v64, v64
    v_lshlrev_b32 v64, 16, v64
    v_cndmask_b32 v36, v36, v64, vcc
    v_add_f32 v65, v37, v61
    v_cvt_pk_bf16_f32 v65, v65, v65
    v_lshlrev_b32 v65, 16, v65
    v_cndmask_b32 v37, v37, v65, vcc
    v_add_f32 v66, v38, v62
    v_cvt_pk_bf16_f32 v66, v66, v66
    v_lshlrev_b32 v66, 16, v66
    v_cndmask_b32 v38, v38, v66, vcc
    v_add_f32 v67, v39, v63
    v_cvt_pk_bf16_f32 v67, v67, v67
    v_lshlrev_b32 v67, 16, v67
    v_cndmask_b32 v39, v39, v67, vcc
    s_branch K_NOY0
K_YR1_0:
    s_waitcnt lgkmcnt(0)
    v_add_f32 v64, v40, v56
    v_cvt_pk_bf16_f32 v64, v64, v64
    v_lshlrev_b32 v64, 16, v64
    v_cndmask_b32 v40, v40, v64, vcc
    v_add_f32 v65, v41, v57
    v_cvt_pk_bf16_f32 v65, v65, v65
    v_lshlrev_b32 v65, 16, v65
    v_cndmask_b32 v41, v41, v65, vcc
    v_add_f32 v66, v42, v58
    v_cvt_pk_bf16_f32 v66, v66, v66
    v_lshlrev_b32 v66, 16, v66
    v_cndmask_b32 v42, v42, v66, vcc
    v_add_f32 v67, v43, v59
    v_cvt_pk_bf16_f32 v67, v67, v67
    v_lshlrev_b32 v67, 16, v67
    v_cndmask_b32 v43, v43, v67, vcc
    v_add_f32 v64, v44, v60
    v_cvt_pk_bf16_f32 v64, v64, v64
    v_lshlrev_b32 v64, 16, v64
    v_cndmask_b32 v44, v44, v64, vcc
    v_add_f32 v65, v45, v61
    v_cvt_pk_bf16_f32 v65, v65, v65
    v_lshlrev_b32 v65, 16, v65
    v_cndmask_b32 v45, v45, v65, vcc
    v_add_f32 v66, v46, v62
    v_cvt_pk_bf16_f32 v66, v66, v66
    v_lshlrev_b32 v66, 16, v66
    v_cndmask_b32 v46, v46, v66, vcc
    v_add_f32 v67, v47, v63
    v_cvt_pk_bf16_f32 v67, v67, v67
    v_lshlrev_b32 v67, 16, v67
    v_cndmask_b32 v47, v47, v67, vcc
    s_branch K_NOY0
K_YROW1:
    v_and_b32 v2, 7, v1
    v_lshlrev_b32 v2, 5, v2
    v_add_u32 v2, 159232, v2
    ds_read_b128 v[56:59], v2
    ds_read_b128 v[60:63], v2 offset:16
    s_and_b32 s33, s3, 7
    v_cmp_eq_u32 vcc, s33, v8
    s_cmp_ge_u32 s3, 8
    s_cbranch_scc1 K_YR1_1
    s_waitcnt lgkmcnt(0)
    v_add_f32 v64, v32, v56
    v_cvt_pk_bf16_f32 v64, v64, v64
    v_lshlrev_b32 v64, 16, v64
    v_cndmask_b32 v32, v32, v64, vcc
    v_add_f32 v65, v33, v57
    v_cvt_pk_bf16_f32 v65, v65, v65
    v_lshlrev_b32 v65, 16, v65
    v_cndmask_b32 v33, v33, v65, vcc
    v_add_f32 v66, v34, v58
    v_cvt_pk_bf16_f32 v66, v66, v66
    v_lshlrev_b32 v66, 16, v66
    v_cndmask_b32 v34, v34, v66, vcc
    v_add_f32 v67, v35, v59
    v_cvt_pk_bf16_f32 v67, v67, v67
    v_lshlrev_b32 v67, 16, v67
    v_cndmask_b32 v35, v35, v67, vcc
    v_add_f32 v64, v36, v60
    v_cvt_pk_bf16_f32 v64, v64, v64
    v_lshlrev_b32 v64, 16, v64
    v_cndmask_b32 v36, v36, v64, vcc
    v_add_f32 v65, v37, v61
    v_cvt_pk_bf16_f32 v65, v65, v65
    v_lshlrev_b32 v65, 16, v65
    v_cndmask_b32 v37, v37, v65, vcc
    v_add_f32 v66, v38, v62
    v_cvt_pk_bf16_f32 v66, v66, v66
    v_lshlrev_b32 v66, 16, v66
    v_cndmask_b32 v38, v38, v66, vcc
    v_add_f32 v67, v39, v63
    v_cvt_pk_bf16_f32 v67, v67, v67
    v_lshlrev_b32 v67, 16, v67
    v_cndmask_b32 v39, v39, v67, vcc
    s_branch K_NOY1
K_YR1_1:
    s_waitcnt lgkmcnt(0)
    v_add_f32 v64, v40, v56
    v_cvt_pk_bf16_f32 v64, v64, v64
    v_lshlrev_b32 v64, 16, v64
    v_cndmask_b32 v40, v40, v64, vcc
    v_add_f32 v65, v41, v57
    v_cvt_pk_bf16_f32 v65, v65, v65
    v_lshlrev_b32 v65, 16, v65
    v_cndmask_b32 v41, v41, v65, vcc
    v_add_f32 v66, v42, v58
    v_cvt_pk_bf16_f32 v66, v66, v66
    v_lshlrev_b32 v66, 16, v66
    v_cndmask_b32 v42, v42, v66, vcc
    v_add_f32 v67, v43, v59
    v_cvt_pk_bf16_f32 v67, v67, v67
    v_lshlrev_b32 v67, 16, v67
    v_cndmask_b32 v43, v43, v67, vcc
    v_add_f32 v64, v44, v60
    v_cvt_pk_bf16_f32 v64, v64, v64
    v_lshlrev_b32 v64, 16, v64
    v_cndmask_b32 v44, v44, v64, vcc
    v_add_f32 v65, v45, v61
    v_cvt_pk_bf16_f32 v65, v65, v65
    v_lshlrev_b32 v65, 16, v65
    v_cndmask_b32 v45, v45, v65, vcc
    v_add_f32 v66, v46, v62
    v_cvt_pk_bf16_f32 v66, v66, v66
    v_lshlrev_b32 v66, 16, v66
    v_cndmask_b32 v46, v46, v66, vcc
    v_add_f32 v67, v47, v63
    v_cvt_pk_bf16_f32 v67, v67, v67
    v_lshlrev_b32 v67, 16, v67
    v_cndmask_b32 v47, v47, v67, vcc
    s_branch K_NOY1
K_STA11:
    s_branch K_STA15
K_STB11:
    s_branch K_STB15
K_P2:
    s_cmp_ge_u32 s30, 4
    s_cbranch_scc1 K_P2_HELP
    s_lshl_b32 s62, s40, 7
    v_lshrrev_b32 v8, 3, v1
    v_lshrrev_b32 v9, 4, v1
    v_mov_b32 v15, 158720
    s_lshl_b32 s61, s40, 3
    s_add_u32 s61, s61, s30
    s_mul_i32 s3, s61, 20480
    s_lshl_b32 s33, s41, 7
    s_add_u32 s3, s3, s33
    v_and_b32 v2, 7, v1
    v_lshlrev_b32 v2, 4, v2
    v_mul_u32_u24 v4, 1280, v8
    v_add3_u32 v10, v2, v4, s3
    s_lshl_b32 s3, s30, 7
    s_add_u32 s3, s3, 159744
    v_lshl_add_u32 v11, v8, 3, s3
    s_mov_b32 s63, 10240
    s_add_u32 s20, s6, 0x100000
    s_addc_u32 s21, s7, 0
    s_mov_b32 s22, 0x280000
    s_mov_b32 s23, 0x20000
    s_mov_b32 s56, s10
    s_mov_b32 s57, s11
    s_mov_b32 s58, 0x280000
    s_mov_b32 s59, 0x20000
    v_mul_u32_u24 v3, 144, v8
    v_add_u32 v3, v2, v3
    s_mul_i32 s3, s30, 2304
    s_add_u32 s3, s3, 140288
    v_add_u32 v14, s3, v3
    buffer_load_dwordx4 v[16:19], v10, s[12:15], 0 offen
    buffer_load_dwordx4 v[20:23], v10, s[12:15], s63 offen
    v_bfe_u32 v48, v1, 2, 2
    v_and_b32 v49, 3, v1
    s_add_u32 s3, s61, s30
    s_lshr_b32 s33, s3, 2
    s_mul_i32 s33, s33, 76
    s_add_u32 s3, s3, s33
    s_lshl_b32 s3, s3, 10
    v_and_b32 v2, 15, v1
    v_lshl_add_u32 v2, v2, 4, s3
    v_lshrrev_b32 v3, 5, v1
    v_lshl_add_u32 v2, v3, 8, v2
    v_and_b32 v4, 1, v9
    v_lshl_add_u32 v52, v4, 10, v2
    v_mov_b32 v53, 0x1f000
    v_lshl_add_u32 v2, v3, 3, v48
    v_lshlrev_b32 v2, 7, v2
    v_lshl_add_u32 v2, v49, 3, v2
    v_lshl_add_u32 v2, v4, 5, v2
    v_lshrrev_b32 v4, 1, v48
    v_lshl_add_u32 v54, v4, 6, v2
    v_xor_b32 v55, 64, v54
    v_mov_b32 v56, v54
    v_mov_b32 v57, v54
    v_and_b32 v2, 31, v1
    v_mul_u32_u24 v2, 144, v2
    v_lshl_add_u32 v2, v3, 3, v2
    s_mul_i32 s3, s30, 4608
    s_add_u32 s3, s3, 140288
    v_add_u32 v50, s3, v2
    s_lshl_b32 s3, s40, 3
    s_mul_i32 s33, s3, 187
    s_lshr_b32 s33, s33, 11
    s_add_u32 s33, s33, 1
    s_mul_i32 s33, s33, 11
    s_add_u32 s3, s61, s30
    s_add_u32 s3, s3, 1
    s_cmp_ge_u32 s3, s33
    s_cselect_b32 s60, 24, 16
    s_cmp_gt_u32 s3, s33
    s_cselect_b32 s60, 20, s60
    v_add_u32 v58, s60, v15
    s_mov_b32 s64, -1
    s_mov_b32 s65, -1
    s_mov_b32 s66, -1
    s_mov_b32 s67, -1
    s_mov_b32 s68, -1
    s_mov_b32 s69, -1
    s_mov_b32 s70, 0xfffff
    s_mov_b32 s71, 131072
    v_mov_b32 v108, 0
    v_mov_b32 v109, 0
    v_mov_b32 v110, 0
    v_mov_b32 v111, 0
    v_mov_b32 v112, 0
    v_mov_b32 v113, 0
    v_mov_b32 v114, 0
    v_mov_b32 v115, 0
    v_mov_b32 v116, 0
    v_mov_b32 v117, 0
    v_mov_b32 v118, 0
    v_mov_b32 v119, 0
    v_mov_b32 v120, 0
    v_mov_b32 v121, 0
    v_mov_b32 v122, 0
    v_mov_b32 v123, 0
    v_mov_b32 v124, 0
    v_mov_b32 v125, 0
    v_mov_b32 v126, 0
    v_mov_b32 v127, 0
    v_mov_b32 v128, 0
    v_mov_b32 v129, 0
    v_mov_b32 v130, 0
    v_mov_b32 v131, 0
    v_mov_b32 v132, 0
    v_mov_b32 v133, 0
    v_mov_b32 v134, 0
    v_mov_b32 v135, 0
    v_mov_b32 v136, 0
    v_mov_b32 v137, 0
    v_mov_b32 v138, 0
    v_mov_b32 v139, 0
K_P2_AUXW:
    v_lshrrev_b32 v2, 3, v1
    v_mul_u32_u24 v2, 1280, v2
    v_lshrrev_b32 v3, 2, v1
    v_and_b32 v3, 4, v3
    v_and_b32 v4, 7, v1
    v_xor_b32 v3, v3, v4
    v_lshl_add_u32 v2, v3, 4, v2
    s_lshl_b32 s33, s41, 7
    v_add_u32 v51, s33, v2
    v_lshrrev_b32 v5, 5, v1
    v_mul_u32_u24 v5, 20480, v5
    v_add_u32 v5, v5, v51
    s_lshl_b32 s52, s30, 2
    s_lshr_b32 s52, 0x7520, s52
    s_and_b32 s52, s52, 7
    s_mul_i32 s52, s52, 51200
    s_lshl_b32 s53, s30, 12
    s_add_u32 s60, s52, 0
    s_add_u32 m0, s53, 0
    s_waitcnt vmcnt(5)
    buffer_load_dwordx4 v51, s[24:27], s60 offen lds
    s_add_u32 s60, s52, 10240
    s_add_u32 m0, s53, 1024
    s_waitcnt vmcnt(5)
    buffer_load_dwordx4 v51, s[24:27], s60 offen lds
    s_add_u32 s60, s52, 25600
    s_add_u32 m0, s53, 2048
    s_waitcnt vmcnt(5)
    buffer_load_dwordx4 v51, s[24:27], s60 offen lds
    s_add_u32 s60, s52, 35840
    s_add_u32 m0, s53, 3072
    s_waitcnt vmcnt(5)
    buffer_load_dwordx4 v51, s[24:27], s60 offen lds
    s_add_u32 s60, s52, 409600
    s_add_u32 m0, s53, 20480
    s_waitcnt vmcnt(5)
    buffer_load_dwordx4 v51, s[24:27], s60 offen lds
    s_add_u32 s60, s52, 419840
    s_add_u32 m0, s53, 21504
    s_waitcnt vmcnt(5)
    buffer_load_dwordx4 v51, s[24:27], s60 offen lds
    v_mov_b32 v3, 1
    s_mov_b64 exec, 1
    ds_add_u32 v15, v3 offset:52
    s_mov_b64 exec, -1
    s_add_u32 s60, s52, 435200
    s_add_u32 m0, s53, 22528
    s_waitcnt vmcnt(5)
    buffer_load_dwordx4 v51, s[24:27], s60 offen lds
    s_add_u32 s60, s52, 445440
    s_add_u32 m0, s53, 23552
    s_waitcnt vmcnt(5)
    buffer_load_dwordx4 v51, s[24:27], s60 offen lds
    s_lshl_b32 s53, s30, 10
    s_add_u32 s60, s52, 20480
    s_add_u32 m0, s53, 16384
    s_waitcnt vmcnt(5)
    buffer_load_dwordx4 v5, s[24:27], s60 offen lds
    s_add_u32 s60, s52, 430080
    s_add_u32 m0, s53, 36864
    s_waitcnt vmcnt(5)
    buffer_load_dwordx4 v5, s[24:27], s60 offen lds
    s_lshl_b32 s52, s30, 2
    s_lshr_b32 s52, 0x6431, s52
    s_and_b32 s52, s52, 7
    s_mul_i32 s52, s52, 51200
    s_lshl_b32 s53, s30, 12
    s_add_u32 s60, s52, 0
    s_add_u32 m0, s53, 40960
    s_waitcnt vmcnt(5)
    buffer_load_dwordx4 v51, s[24:27], s60 offen lds
    s_add_u32 s60, s52, 10240
    s_add_u32 m0, s53, 41984
    s_waitcnt vmcnt(5)
    buffer_load_dwordx4 v51, s[24:27], s60 offen lds
    s_add_u32 s60, s52, 25600
    s_add_u32 m0, s53, 43008
    s_waitcnt vmcnt(5)
    buffer_load_dwordx4 v51, s[24:27], s60 offen lds
    s_add_u32 s60, s52, 35840
    s_add_u32 m0, s53, 44032
    s_waitcnt vmcnt(5)
    buffer_load_dwordx4 v51, s[24:27], s60 offen lds
    s_add_u32 s60, s52, 409600
    s_add_u32 m0, s53, 61440
    s_waitcnt vmcnt(5)
    buffer_load_dwordx4 v51, s[24:27], s60 offen lds
    s_add_u32 s60, s52, 419840
    s_add_u32 m0, s53, 62464
    s_waitcnt vmcnt(5)
    buffer_load_dwordx4 v51, s[24:27], s60 offen lds
    s_add_u32 s60, s52, 435200
    s_add_u32 m0, s53, 63488
    s_waitcnt vmcnt(5)
    buffer_load_dwordx4 v51, s[24:27], s60 offen lds
    s_add_u32 s60, s52, 445440
    s_add_u32 m0, s53, 64512
    s_waitcnt vmcnt(5)
    buffer_load_dwordx4 v51, s[24:27], s60 offen lds
    s_lshl_b32 s53, s30, 10
    s_add_u32 s60, s52, 20480
    s_add_u32 m0, s53, 57344
    s_waitcnt vmcnt(5)
    buffer_load_dwordx4 v5, s[24:27], s60 offen lds
    s_add_u32 s60, s52, 430080
    s_add_u32 m0, s53, 77824
    s_waitcnt vmcnt(5)
    buffer_load_dwordx4 v5, s[24:27], s60 offen lds
    s_cmp_eq_u32 s30, 0
    s_cbranch_scc1 K_CHA0
    s_cmp_eq_u32 s30, 1
    s_cbranch_scc1 K_CHA1
    s_cmp_eq_u32 s30, 2
    s_cbranch_scc1 K_CHA2
    s_branch K_CHA3
K_WRET_A:
    v_mov_b32 v3, 1
    s_waitcnt vmcnt(0)
    s_mov_b64 exec, 1
    ds_add_u32 v15, v3 offset:44
    s_mov_b64 exec, -1
    s_mov_b32 s3, 1048576
K_P2_GWA:
    ds_read_b32 v2, v15 offset:44
    s_sub_u32 s3, s3, 1
    s_waitcnt lgkmcnt(0)
    v_readfirstlane_b32 s33, v2
    s_nop 3
    s_cselect_b32 s33, 4, s33
    s_cmp_lt_u32 s33, 4
    s_cbranch_scc1 K_P2_GWA
    s_branch K_P2_GEMM
K_P2_HELP:
    s_setprio 3
    s_cmp_eq_u32 s30, 7
    s_cbranch_scc1 K_P2_W7
    s_lshl_b32 s62, s40, 7
    v_lshrrev_b32 v8, 3, v1
    v_lshrrev_b32 v9, 4, v1
    v_mov_b32 v15, 158720
    s_lshl_b32 s61, s40, 3
    s_branch K_PG5
.p2align 12
K_STA12:
    s_branch K_WRET_A
K_STB12:
    s_branch K_WRET_B
K_PG5:
    s_add_u32 s61, s61, s30
    s_mul_i32 s3, s61, 20480
    s_lshl_b32 s33, s41, 7
    s_add_u32 s3, s3, s33
    v_and_b32 v2, 7, v1
    v_lshlrev_b32 v2, 4, v2
    v_mul_u32_u24 v4, 1280, v8
    v_add3_u32 v10, v2, v4, s3
    s_lshl_b32 s3, s30, 7
    s_add_u32 s3, s3, 159744
    v_lshl_add_u32 v11, v8, 3, s3
    s_mov_b32 s63, 10240
    s_add_u32 s20, s6, 0x100000
    s_addc_u32 s21, s7, 0
    s_mov_b32 s22, 0x280000
    s_mov_b32 s23, 0x20000
    s_mov_b32 s56, s10
    s_mov_b32 s57, s11
    s_mov_b32 s58, 0x280000
    s_mov_b32 s59, 0x20000
    v_mul_u32_u24 v3, 144, v8
    v_add_u32 v3, v2, v3
    s_mul_i32 s3, s30, 2304
    s_add_u32 s3, s3, 140288
    v_add_u32 v14, s3, v3
    s_add_u32 s44, s6, 0x10000
    s_addc_u32 s45, s7, 0
    s_mov_b32 s46, 0x43800
    s_mov_b32 s47, 0x20000
    v_mov_b32 v108, 1
    buffer_load_dwordx4 v[16:19], v10, s[12:15], 0 offen
    buffer_load_dwordx4 v[20:23], v10, s[12:15], s63 offen
    s_cmp_lg_u32 s30, 6
    s_cbranch_scc1 K_P2_HW
    s_mov_b32 s3, 131072
    s_waitcnt vmcnt(2)
K_P2_DPOLL:
    v_min_u32 v2, v7, v6
    v_cmp_eq_u32 vcc, 0, v2
    s_cbranch_vccz K_P2_DOK
    s_cmp_eq_u32 s3, 131072
    s_cbranch_scc1 K_P2_DNS
    s_sleep 12
K_P2_DNS:
    v_lshl_add_u32 v13, v1, 2, s42
    global_load_dword v7, v13, s[6:7] offset:256 sc1
    v_and_b32 v13, 0xfffffe04, v13
    global_load_dword v6, v13, s[6:7] offset:128 sc1
    s_sub_u32 s3, s3, 1
    s_waitcnt vmcnt(0)
    s_cmp_lg_u32 s3, 0
    s_cbranch_scc1 K_P2_DPOLL
K_P2_DOK:
    v_readlane_b32 s52, v6, 0
    v_readlane_b32 s53, v6, 1
    s_nop 1
    s_and_b32 s3, s52, 0x7ff
    s_sub_u32 s3, 2047, s3
    v_mov_b32 v48, s3
    v_mov_b32 v4, s52
    v_and_b32 v4, 0xffff0000, v4
    v_ashrrev_i32 v5, 31, v4
    v_not_b32 v5, v5
    v_or_b32 v5, 0x80000000, v5
    v_xor_b32 v4, v4, v5
    v_and_b32 v4, 0xffff0000, v4
    v_mul_f32 v5, 0xbfb8aa3b, v4
    v_exp_f32 v5, v5
    s_nop 0
    v_add_f32 v5, 1.0, v5
    v_rcp_f32 v4, v5
    s_nop 0
    v_cvt_pk_bf16_f32 v50, v4, v4
    v_lshlrev_b32 v50, 16, v50
    s_and_b32 s3, s53, 0x7ff
    s_sub_u32 s3, 2047, s3
    v_mov_b32 v49, s3
    v_mov_b32 v4, s53
    v_and_b32 v4, 0xffff0000, v4
    v_ashrrev_i32 v5, 31, v4
    v_not_b32 v5, v5
    v_or_b32 v5, 0x80000000, v5
    v_xor_b32 v4, v4, v5
    v_and_b32 v4, 0xffff0000, v4
    v_mul_f32 v5, 0xbfb8aa3b, v4
    v_exp_f32 v5, v5
    s_nop 0
    v_add_f32 v5, 1.0, v5
    v_rcp_f32 v4, v5
    s_nop 0
    v_cvt_pk_bf16_f32 v51, v4, v4
    v_lshlrev_b32 v51, 16, v51
    ds_write_b128 v15, v[48:51]
    ds_write_b32 v15, v108 offset:40
    v_lshl_add_u32 v13, v1, 4, v15
    v_lshlrev_b32 v52, 16, v7
    v_and_b32 v52, 0x7fff0000, v52
    v_and_b32 v54, 0x7fff0000, v7
    v_sub_f32 v53, 1.0, v52
    v_cvt_pk_bf16_f32 v53, v53, v53
    v_lshlrev_b32 v53, 16, v53
    v_sub_f32 v55, 1.0, v54
    v_cvt_pk_bf16_f32 v55, v55, v55
    v_lshlrev_b32 v55, 16, v55
    ds_write_b128 v13, v[52:55] offset:1024
    s_branch K_P2_E
K_STA13:
    s_branch K_WRET_A
K_STB13:
    s_branch K_WRET_B
K_P2_HW:
    s_mov_b32 s3, 1048576
K_P2_GS2:
    ds_read_b32 v2, v15 offset:40
    s_sleep 1
    s_sub_u32 s3, s3, 1
    s_waitcnt lgkmcnt(0)
    v_readfirstlane_b32 s33, v2
    s_nop 3
    s_cselect_b32 s33, 1, s33
    s_cmp_lt_u32 s33, 1
    s_cbranch_scc1 K_P2_GS2
    ds_read_b128 v[28:31], v15
    s_waitcnt lgkmcnt(0)
    s_cmp_eq_u32 s30, 4
    s_cselect_b64 vcc, -1, 0
    s_nop 1
    v_cndmask_b32 v2, v29, v28, vcc
    v_cndmask_b32 v5, v31, v30, vcc
    s_nop 0
    v_readfirstlane_b32 s52, v2
    s_nop 3
    s_sub_u32 s3, s52, s62
    s_cmp_lt_u32 s3, 128
    s_cbranch_scc0 K_P2_E
    s_mov_b32 s3, 131072
K_P2_YPOLL:
    s_load_dword s33, s[6:7], s42 offset:136 glc
    s_waitcnt lgkmcnt(0)
    s_cmp_lg_u32 s33, 0
    s_cbranch_scc1 K_P2_YGO
    s_sleep 4
    s_sub_u32 s3, s3, 1
    s_cbranch_scc0 K_P2_YPOLL
K_P2_YGO:
    v_and_b32 v2, 15, v1
    v_lshlrev_b32 v2, 4, v2
    v_mul_u32_u24 v4, 5120, v9
    s_sub_u32 s53, s30, 4
    s_mul_i32 s33, s53, 2560
    s_lshl_b32 s3, s41, 8
    s_add_u32 s3, s3, s33
    v_add3_u32 v3, v2, v4, s3
    s_mov_b32 s60, 0
    buffer_load_dwordx4 v[52:55], v3, s[44:47], s60 offen sc1
    s_mov_b32 s60, 20480
    buffer_load_dwordx4 v[56:59], v3, s[44:47], s60 offen sc1
    s_mov_b32 s60, 40960
    buffer_load_dwordx4 v[60:63], v3, s[44:47], s60 offen sc1
    s_mov_b32 s60, 61440
    buffer_load_dwordx4 v[64:67], v3, s[44:47], s60 offen sc1
    s_mov_b32 s60, 81920
    buffer_load_dwordx4 v[68:71], v3, s[44:47], s60 offen sc1
    s_mov_b32 s60, 102400
    buffer_load_dwordx4 v[72:75], v3, s[44:47], s60 offen sc1
    s_mov_b32 s60, 122880
    buffer_load_dwordx4 v[76:79], v3, s[44:47], s60 offen sc1
    s_mov_b32 s60, 143360
    buffer_load_dwordx4 v[80:83], v3, s[44:47], s60 offen sc1
    s_mov_b32 s60, 163840
    buffer_load_dwordx4 v[84:87], v3, s[44:47], s60 offen sc1
    s_mov_b32 s60, 184320
    buffer_load_dwordx4 v[88:91], v3, s[44:47], s60 offen sc1
    s_mov_b32 s60, 204800
    buffer_load_dwordx4 v[92:95], v3, s[44:47], s60 offen sc1
    s_mov_b32 s60, 225280
    buffer_load_dwordx4 v[96:99], v3, s[44:47], s60 offen sc1
    s_mov_b32 s60, 245760
    buffer_load_dwordx4 v[100:103], v3, s[44:47], s60 offen sc1
    s_mov_b32 s60, 266240
    buffer_load_dwordx4 v[104:107], v3, s[44:47], s60 offen sc1
    s_waitcnt vmcnt(12)
    v_add_f32 v48, v52, v56
    v_add_f32 v49, v53, v57
    v_add_f32 v50, v54, v58
    v_add_f32 v51, v55, v59
    s_waitcnt vmcnt(11)
    v_add_f32 v48, v48, v60
    v_add_f32 v49, v49, v61
    v_add_f32 v50, v50, v62
    v_add_f32 v51, v51, v63
    s_waitcnt vmcnt(10)
    v_add_f32 v48, v48, v64
    v_add_f32 v49, v49, v65
    v_add_f32 v50, v50, v66
    v_add_f32 v51, v51, v67
    s_waitcnt vmcnt(9)
    v_add_f32 v48, v48, v68
    v_add_f32 v49, v49, v69
    v_add_f32 v50, v50, v70
    v_add_f32 v51, v51, v71
    s_waitcnt vmcnt(8)
    v_add_f32 v48, v48, v72
    v_add_f32 v49, v49, v73
    v_add_f32 v50, v50, v74
    v_add_f32 v51, v51, v75
    s_waitcnt vmcnt(7)
    v_add_f32 v48, v48, v76
    v_add_f32 v49, v49, v77
    v_add_f32 v50, v50, v78
    v_add_f32 v51, v51, v79
    s_waitcnt vmcnt(6)
    v_add_f32 v48, v48, v80
    v_add_f32 v49, v49, v81
    v_add_f32 v50, v50, v82
    v_add_f32 v51, v51, v83
    s_waitcnt vmcnt(5)
    v_add_f32 v48, v48, v84
    v_add_f32 v49, v49, v85
    v_add_f32 v50, v50, v86
    v_add_f32 v51, v51, v87
    s_waitcnt vmcnt(4)
    v_add_f32 v48, v48, v88
    v_add_f32 v49, v49, v89
    v_add_f32 v50, v50, v90
    v_add_f32 v51, v51, v91
    s_waitcnt vmcnt(3)
    v_add_f32 v48, v48, v92
    v_add_f32 v49, v49, v93
    v_add_f32 v50, v50, v94
    v_add_f32 v51, v51, v95
    s_waitcnt vmcnt(2)
    v_add_f32 v48, v48, v96
    v_add_f32 v49, v49, v97
    v_add_f32 v50, v50, v98
    v_add_f32 v51, v51, v99
    s_waitcnt vmcnt(1)
    v_add_f32 v48, v48, v100
    v_add_f32 v49, v49, v101
    v_add_f32 v50, v50, v102
    v_add_f32 v51, v51, v103
    s_waitcnt vmcnt(0)
    v_add_f32 v48, v48, v104
    v_add_f32 v49, v49, v105
    v_add_f32 v50, v50, v106
    v_add_f32 v51, v51, v107
    v_mov_b32 v52, v48
    v_mov_b32 v53, v49
    v_mov_b32 v54, v50
    v_mov_b32 v55, v51
    s_nop 0
    v_permlane16_swap_b32 v48, v52
    v_permlane16_swap_b32 v49, v53
    v_permlane16_swap_b32 v50, v54
    v_permlane16_swap_b32 v51, v55
    v_add_f32 v48, v48, v52
    v_add_f32 v49, v49, v53
    v_add_f32 v50, v50, v54
    v_add_f32 v51, v51, v55
    v_mov_b32 v52, v48
    v_mov_b32 v53, v49
    v_mov_b32 v54, v50
    v_mov_b32 v55, v51
    s_nop 0
    v_permlane32_swap_b32 v48, v52
    v_permlane32_swap_b32 v49, v53
    v_permlane32_swap_b32 v50, v54
    v_permlane32_swap_b32 v51, v55
    v_add_f32 v48, v48, v52
    v_add_f32 v49, v49, v53
    v_add_f32 v50, v50, v54
    v_add_f32 v51, v51, v55
    v_cvt_pk_bf16_f32 v48, v48, v48
    v_lshlrev_b32 v48, 16, v48
    v_mul_f32 v48, v5, v48
    v_cvt_pk_bf16_f32 v48, v48, v48
    v_lshlrev_b32 v48, 16, v48
    v_cvt_pk_bf16_f32 v49, v49, v49
    v_lshlrev_b32 v49, 16, v49
    v_mul_f32 v49, v5, v49
    v_cvt_pk_bf16_f32 v49, v49, v49
    v_lshlrev_b32 v49, 16, v49
    v_cvt_pk_bf16_f32 v50, v50, v50
    v_lshlrev_b32 v50, 16, v50
    v_mul_f32 v50, v5, v50
    v_cvt_pk_bf16_f32 v50, v50, v50
    v_lshlrev_b32 v50, 16, v50
    v_cvt_pk_bf16_f32 v51, v51, v51
    v_lshlrev_b32 v51, 16, v51
    v_mul_f32 v51, v5, v51
    v_cvt_pk_bf16_f32 v51, v51, v51
    v_lshlrev_b32 v51, 16, v51
    s_lshl_b32 s3, s53, 8
    s_add_u32 s3, s3, 158976
    v_add_u32 v2, s3, v2
    ds_write_b128 v2, v[48:51]
    s_branch K_P2_E
K_STA14:
    s_branch K_WRET_A
K_STB14:
    s_branch K_WRET_B
K_P2_W7:
    s_mov_b32 s37, s42
    s_waitcnt lgkmcnt(0)
    s_load_dwordx2 s[48:49], s[6:7], s37 glc
    s_mul_i32 s52, s40, 1496
    s_add_u32 s53, s52, 1309
    s_lshr_b32 s52, s52, 11
    s_lshr_b32 s53, s53, 11
    s_sub_u32 s53, s53, s52
    s_mov_b32 s46, 0x84210
    s_mov_b32 s47, s46
    v_mov_b32 v15, 158720
    v_mov_b32 v48, 0x80000000
    s_mov_b64 exec, 1
    ds_or_b32 v15, v48 offset:16
    ds_or_b32 v15, v48 offset:20
    ds_or_b32 v15, v48 offset:24
    s_waitcnt lgkmcnt(0)
    s_cmp_eq_u32 s53, 0
    s_cselect_b32 s49, s48, s49
    s_lshl_b64 s[50:51], s[48:49], 1
    s_and_b64 s[50:51], s[50:51], s[48:49]
    s_lshl_b64 vcc, s[50:51], 2
    s_and_b64 s[50:51], s[50:51], vcc
    s_lshl_b64 s[50:51], s[50:51], 1
    s_and_b64 s[50:51], s[50:51], s[46:47]
    s_or_b64 s[48:49], s[48:49], s[50:51]
    s_and_b32 s52, s48, s49
    v_mov_b32 v48, s48
    v_mov_b32 v49, s49
    v_mov_b32 v50, s52
    s_mov_b64 exec, 1
    ds_or_b64 v15, v[48:49] offset:16
    ds_or_b32 v15, v50 offset:24
    s_mov_b64 exec, -1
    s_load_dwordx2 s[48:49], s[6:7], s37 glc
    s_lshl_b32 s62, s40, 7
    v_lshrrev_b32 v8, 3, v1
    v_lshrrev_b32 v9, 4, v1
    v_mov_b32 v15, 158720
    s_lshl_b32 s61, s40, 3
    s_add_u32 s61, s61, s30
    s_mul_i32 s3, s61, 20480
    s_lshl_b32 s33, s41, 7
    s_add_u32 s3, s3, s33
    v_and_b32 v2, 7, v1
    v_lshlrev_b32 v2, 4, v2
    v_mul_u32_u24 v4, 1280, v8
    v_add3_u32 v10, v2, v4, s3
    s_lshl_b32 s3, s30, 7
    s_add_u32 s3, s3, 159744
    v_lshl_add_u32 v11, v8, 3, s3
    s_mov_b32 s63, 10240
    s_add_u32 s20, s6, 0x100000
    s_addc_u32 s21, s7, 0
    s_mov_b32 s22, 0x280000
    s_mov_b32 s23, 0x20000
    s_mov_b32 s56, s10
    s_mov_b32 s57, s11
    s_mov_b32 s58, 0x280000
    s_mov_b32 s59, 0x20000
    v_mul_u32_u24 v3, 144, v8
    v_add_u32 v3, v2, v3
    s_mul_i32 s3, s30, 2304
    s_add_u32 s3, s3, 140288
    v_add_u32 v14, s3, v3
    buffer_load_dwordx4 v[16:19], v10, s[12:15], 0 offen
    buffer_load_dwordx4 v[20:23], v10, s[12:15], s63 offen
    s_mov_b32 s3, 131072
    s_waitcnt lgkmcnt(0)
K_P2_FCHK:
    s_cmp_eq_u32 s53, 0
    s_cselect_b32 s49, s48, s49
    s_lshl_b64 s[50:51], s[48:49], 1
    s_and_b64 s[50:51], s[50:51], s[48:49]
    s_lshl_b64 vcc, s[50:51], 2
    s_and_b64 s[50:51], s[50:51], vcc
    s_lshl_b64 s[50:51], s[50:51], 1
    s_and_b64 s[50:51], s[50:51], s[46:47]
    s_or_b64 s[48:49], s[48:49], s[50:51]
    s_and_b32 s52, s48, s49
    v_mov_b32 v48, s48
    v_mov_b32 v49, s49
    v_mov_b32 v50, s52
    s_mov_b64 exec, 1
    ds_or_b64 v15, v[48:49] offset:16
    ds_or_b32 v15, v50 offset:24
    s_mov_b64 exec, -1
    s_cmp_eq_u32 s52, 0xfffff
    s_cbranch_scc1 K_P2_FGO
    s_cmp_lg_u64 s[48:49], 0
    s_cbranch_scc1 K_P2_FS
    s_sleep 8
K_P2_FS:
    s_sleep 2
    s_load_dwordx2 s[48:49], s[6:7], s37 glc
    s_sub_u32 s3, s3, 1
    s_waitcnt lgkmcnt(0)
    s_cbranch_scc0 K_P2_FCHK
    v_mov_b32 v48, -1
    v_mov_b32 v49, -1
    v_mov_b32 v50, -1
    ds_write_b96 v15, v[48:50] offset:16
K_P2_FGO:
K_P2_E:
    s_setprio 0
    s_waitcnt vmcnt(0)
    v_lshlrev_b32 v32, 16, v16
    v_and_b32 v33, 0xffff0000, v16
    v_lshlrev_b32 v34, 16, v17
    v_and_b32 v35, 0xffff0000, v17
    v_lshlrev_b32 v36, 16, v18
    v_and_b32 v37, 0xffff0000, v18
    v_lshlrev_b32 v38, 16, v19
    v_and_b32 v39, 0xffff0000, v19
    v_lshlrev_b32 v40, 16, v20
    v_and_b32 v41, 0xffff0000, v20
    v_lshlrev_b32 v42, 16, v21
    v_and_b32 v43, 0xffff0000, v21
    v_lshlrev_b32 v44, 16, v22
    v_and_b32 v45, 0xffff0000, v22
    v_lshlrev_b32 v46, 16, v23
    v_and_b32 v47, 0xffff0000, v23
    s_branch K_P2_E2
K_STA15:
    s_branch K_WRET_A
K_STB15:
    s_branch K_WRET_B
K_SPN:
    s_mov_b32 s64, -1
    s_mov_b32 s65, -1
    s_mov_b32 s66, -1
    s_mov_b32 s67, -1
    s_mov_b32 s68, -1
    s_mov_b32 s69, -1
K_SPL:
    ds_read_b32 v59, v58
    s_waitcnt lgkmcnt(0)
    v_readfirstlane_b32 s50, v59
    s_and_b32 s33, s50, s70
    s_cbranch_scc1 K_BK0
    s_cmp_lt_i32 s50, 0
    s_cbranch_scc0 K_SPG
    s_sleep 1
    s_branch K_SPL
K_SPG:
    s_load_dwordx2 s[48:49], s[6:7], s42 glc
    s_waitcnt lgkmcnt(0)
    s_cmp_eq_u32 s53, 0
    s_cselect_b32 s49, s48, s49
    s_lshl_b64 s[50:51], s[48:49], 1
    s_and_b64 s[50:51], s[50:51], s[48:49]
    s_lshl_b64 vcc, s[50:51], 2
    s_and_b64 s[50:51], s[50:51], vcc
    s_lshl_b64 s[50:51], s[50:51], 1
    s_and_b64 s[50:51], s[50:51], s[46:47]
    s_or_b64 s[48:49], s[48:49], s[50:51]
    s_and_b32 s52, s48, s49
    v_mov_b32 v188, s48
    v_mov_b32 v189, s49
    v_mov_b32 v190, s52
    s_mov_b64 exec, 1
    ds_or_b64 v15, v[188:189] offset:16
    ds_or_b32 v15, v190 offset:24
    s_mov_b64 exec, -1
    ds_read_b32 v59, v58
    s_waitcnt lgkmcnt(0)
    v_readfirstlane_b32 s50, v59
    s_and_b32 s33, s50, s70
    s_cbranch_scc1 K_BK0
    s_sleep 2
    ds_read_b32 v59, v58
    s_waitcnt lgkmcnt(0)
    v_readfirstlane_b32 s50, v59
    s_and_b32 s33, s50, s70
    s_cbranch_scc1 K_BK0
    s_sleep 2
    ds_read_b32 v59, v58
    s_waitcnt lgkmcnt(0)
    v_readfirstlane_b32 s50, v59
    s_and_b32 s33, s50, s70
    s_cbranch_scc1 K_BK0
    s_sleep 2
    ds_read_b32 v59, v58
    s_waitcnt lgkmcnt(0)
    v_readfirstlane_b32 s50, v59
    s_and_b32 s33, s50, s70
    s_cbranch_scc1 K_BK0
    s_branch K_SPL
K_CHEND:
K_AUX:
    s_cmp_ge_u32 s30, 4
    s_cbranch_scc1 K_AUX_L
    s_and_b32 s3, s2, 7
    s_lshr_b32 s70, s2, 3
    s_lshl3_add_u32 s3, s3, s70
    s_lshl_b32 s3, s3, 5
    s_lshl3_add_u32 s3, s30, s3
    v_bfe_u32 v8, v0, 4, 2
    v_add_u32 v8, s3, v8
    v_and_b32 v10, 15, v0
    v_lshlrev_b32 v10, 4, v10
    v_mul_u32_u24 v9, 1280, v8
    v_add_u32 v9, v9, v10
    v_and_b32 v2, 63, v0
    v_lshlrev_b32 v2, 4, v2
    s_lshl_b32 s71, s30, 12
    s_add_u32 s71, s71, 126016
    s_mov_b32 s70, 5120
    s_mov_b32 m0, s71
    s_waitcnt lgkmcnt(0)
    s_mov_b32 s16, s44
    s_mov_b32 s17, s45
    s_mov_b32 s18, 0x500
    s_mov_b32 s19, 0x20000
    s_mov_b32 s20, s52
    s_mov_b32 s21, s53
    s_mov_b32 s22, 0x500
    s_mov_b32 s23, 0x20000
    buffer_load_dwordx4 v2, s[16:19], 0 offen lds
    buffer_load_dwordx4 v2, s[16:19], 0 offen offset:1024 lds
    s_add_u32 m0, s71, 2048
    v_add_u32 v10, s71, v10
    buffer_load_dwordx4 v2, s[20:23], 0 offen lds
    buffer_load_dwordx4 v2, s[20:23], 0 offen offset:1024 lds
    buffer_load_dwordx4 v[16:19], v9, s[12:15], 0 offen offset:0
    buffer_load_dwordx4 v[20:23], v9, s[12:15], s70 offen offset:0
    buffer_load_dwordx4 v[24:27], v9, s[12:15], 0 offen offset:256
    buffer_load_dwordx4 v[28:31], v9, s[12:15], s70 offen offset:256
    buffer_load_dwordx4 v[32:35], v9, s[12:15], 0 offen offset:512
    buffer_load_dwordx4 v[36:39], v9, s[12:15], s70 offen offset:512
    buffer_load_dwordx4 v[40:43], v9, s[12:15], 0 offen offset:768
    buffer_load_dwordx4 v[44:47], v9, s[12:15], s70 offen offset:768
    buffer_load_dwordx4 v[48:51], v9, s[12:15], 0 offen offset:1024
    buffer_load_dwordx4 v[52:55], v9, s[12:15], s70 offen offset:1024
    s_barrier
    v_and_b32 v1, 63, v0
    v_mov_b32 v7, 0
    s_and_b32 s28, s2, 7
    s_lshr_b32 s29, s2, 3
    s_xor_b32 s30, s30, 4
    s_lshr_b32 s34, s29, 3
    s_lshl_b32 s34, s34, 2
    s_and_b32 s3, s29, 3
    s_add_u32 s34, s34, s3
    s_add_u32 s34, s34, 4
    s_bitcmp1_b32 s29, 2
    s_cselect_b32 s34, -1, s34
    s_cmp_lt_u32 s29, 8
    s_cselect_b32 s34, s29, s34
    s_lshl_b32 s40, s28, 1
    s_cmp_ge_u32 s34, 10
    s_addc_u32 s40, s40, 0
    s_sub_u32 s41, s34, 10
    s_cmp_ge_u32 s34, 10
    s_cselect_b32 s41, s41, s34
    s_mul_i32 s42, s28, 20
    s_add_u32 s42, s42, s34
    s_and_b32 s42, s42, 255
    s_lshl_b32 s42, s42, 9
    s_add_u32 s42, s42, 524288
    s_mul_i32 s43, s28, 7
    s_add_u32 s43, s43, s29
    s_sub_u32 s43, s43, 1
    s_cmp_lt_u32 s43, 54
    s_cselect_b32 s43, s43, 63
    s_cmp_eq_u32 s29, 0
    s_cselect_b32 s43, 63, s43
    s_mov_b32 s24, s8
    s_mov_b32 s25, s9
    s_mov_b32 s26, 0xc8000
    s_mov_b32 s27, 0x20000
    s_add_u32 s64, s6, 0x80000
    s_addc_u32 s65, s7, 0
    s_mov_b32 s66, 0x14400
    s_mov_b32 s67, 0x20000
    s_add_u32 s60, s6, 0x10000
    s_addc_u32 s61, s7, 0
    s_mov_b32 s62, 0x43800
    s_mov_b32 s63, 0x20000
    v_mov_b32 v96, 0
    v_mov_b32 v97, 0
    v_mov_b32 v98, 0
    v_mov_b32 v99, 0
    v_mov_b32 v13, 158720
    s_waitcnt vmcnt(10)
    ds_read_b128 v[56:59], v10 offset:0
    ds_read_b128 v[76:79], v10 offset:2048
    ds_read_b128 v[60:63], v10 offset:256
    ds_read_b128 v[80:83], v10 offset:2304
    ds_read_b128 v[64:67], v10 offset:512
    ds_read_b128 v[84:87], v10 offset:2560
    ds_read_b128 v[68:71], v10 offset:768
    ds_read_b128 v[88:91], v10 offset:2816
    ds_read_b128 v[72:75], v10 offset:1024
    ds_read_b128 v[92:95], v10 offset:3072
    s_waitcnt vmcnt(8) lgkmcnt(8)
    v_dot2c_f32_bf16 v96, v16, v56
    v_dot2c_f32_bf16 v98, v16, v76
    v_dot2c_f32_bf16 v97, v20, v56
    v_dot2c_f32_bf16 v99, v20, v76
    v_dot2c_f32_bf16 v96, v17, v57
    v_dot2c_f32_bf16 v98, v17, v77
    v_dot2c_f32_bf16 v97, v21, v57
    v_dot2c_f32_bf16 v99, v21, v77
    v_dot2c_f32_bf16 v96, v18, v58
    v_dot2c_f32_bf16 v98, v18, v78
    v_dot2c_f32_bf16 v97, v22, v58
    v_dot2c_f32_bf16 v99, v22, v78
    v_dot2c_f32_bf16 v96, v19, v59
    v_dot2c_f32_bf16 v98, v19, v79
    v_dot2c_f32_bf16 v97, v23, v59
    v_dot2c_f32_bf16 v99, v23, v79
    s_waitcnt vmcnt(6) lgkmcnt(6)
    v_dot2c_f32_bf16 v96, v24, v60
    v_dot2c_f32_bf16 v98, v24, v80
    v_dot2c_f32_bf16 v97, v28, v60
    v_dot2c_f32_bf16 v99, v28, v80
    v_dot2c_f32_bf16 v96, v25, v61
    v_dot2c_f32_bf16 v98, v25, v81
    v_dot2c_f32_bf16 v97, v29, v61
    v_dot2c_f32_bf16 v99, v29, v81
    v_dot2c_f32_bf16 v96, v26, v62
    v_dot2c_f32_bf16 v98, v26, v82
    v_dot2c_f32_bf16 v97, v30, v62
    v_dot2c_f32_bf16 v99, v30, v82
    v_dot2c_f32_bf16 v96, v27, v63
    v_dot2c_f32_bf16 v98, v27, v83
    v_dot2c_f32_bf16 v97, v31, v63
    v_dot2c_f32_bf16 v99, v31, v83
    s_waitcnt vmcnt(4) lgkmcnt(4)
    v_dot2c_f32_bf16 v96, v32, v64
    v_dot2c_f32_bf16 v98, v32, v84
    v_dot2c_f32_bf16 v97, v36, v64
    v_dot2c_f32_bf16 v99, v36, v84
    v_dot2c_f32_bf16 v96, v33, v65
    v_dot2c_f32_bf16 v98, v33, v85
    v_dot2c_f32_bf16 v97, v37, v65
    v_dot2c_f32_bf16 v99, v37, v85
    v_dot2c_f32_bf16 v96, v34, v66
    v_dot2c_f32_bf16 v98, v34, v86
    v_dot2c_f32_bf16 v97, v38, v66
    v_dot2c_f32_bf16 v99, v38, v86
    v_dot2c_f32_bf16 v96, v35, v67
    v_dot2c_f32_bf16 v98, v35, v87
    v_dot2c_f32_bf16 v97, v39, v67
    v_dot2c_f32_bf16 v99, v39, v87
    s_waitcnt vmcnt(2) lgkmcnt(2)
    v_dot2c_f32_bf16 v96, v40, v68
    v_dot2c_f32_bf16 v98, v40, v88
    v_dot2c_f32_bf16 v97, v44, v68
    v_dot2c_f32_bf16 v99, v44, v88
    v_dot2c_f32_bf16 v96, v41, v69
    v_dot2c_f32_bf16 v98, v41, v89
    v_dot2c_f32_bf16 v97, v45, v69
    v_dot2c_f32_bf16 v99, v45, v89
    v_dot2c_f32_bf16 v96, v42, v70
    v_dot2c_f32_bf16 v98, v42, v90
    v_dot2c_f32_bf16 v97, v46, v70
    v_dot2c_f32_bf16 v99, v46, v90
    v_dot2c_f32_bf16 v96, v43, v71
    v_dot2c_f32_bf16 v98, v43, v91
    v_dot2c_f32_bf16 v97, v47, v71
    v_dot2c_f32_bf16 v99, v47, v91
    s_waitcnt vmcnt(0) lgkmcnt(0)
    v_dot2c_f32_bf16 v96, v48, v72
    v_dot2c_f32_bf16 v98, v48, v92
    v_dot2c_f32_bf16 v97, v52, v72
    v_dot2c_f32_bf16 v99, v52, v92
    v_dot2c_f32_bf16 v96, v49, v73
    v_dot2c_f32_bf16 v98, v49, v93
    v_dot2c_f32_bf16 v97, v53, v73
    v_dot2c_f32_bf16 v99, v53, v93
    v_dot2c_f32_bf16 v96, v50, v74
    v_dot2c_f32_bf16 v98, v50, v94
    v_dot2c_f32_bf16 v97, v54, v74
    v_dot2c_f32_bf16 v99, v54, v94
    v_dot2c_f32_bf16 v96, v51, v75
    v_dot2c_f32_bf16 v98, v51, v95
    v_dot2c_f32_bf16 v97, v55, v75
    v_dot2c_f32_bf16 v99, v55, v95
    s_nop 2
    v_add_f32_dpp v96, v96, v96 quad_perm:[1,0,3,2] row_mask:0xf bank_mask:0xf
    v_add_f32_dpp v97, v97, v97 quad_perm:[1,0,3,2] row_mask:0xf bank_mask:0xf
    v_add_f32_dpp v98, v98, v98 quad_perm:[1,0,3,2] row_mask:0xf bank_mask:0xf
    v_add_f32_dpp v99, v99, v99 quad_perm:[1,0,3,2] row_mask:0xf bank_mask:0xf
    v_add_f32_dpp v96, v96, v96 quad_perm:[2,3,0,1] row_mask:0xf bank_mask:0xf
    v_add_f32_dpp v97, v97, v97 quad_perm:[2,3,0,1] row_mask:0xf bank_mask:0xf
    v_add_f32_dpp v98, v98, v98 quad_perm:[2,3,0,1] row_mask:0xf bank_mask:0xf
    v_add_f32_dpp v99, v99, v99 quad_perm:[2,3,0,1] row_mask:0xf bank_mask:0xf
    v_add_f32_dpp v96, v96, v96 row_half_mirror row_mask:0xf bank_mask:0xf
    v_add_f32_dpp v97, v97, v97 row_half_mirror row_mask:0xf bank_mask:0xf
    v_add_f32_dpp v98, v98, v98 row_half_mirror row_mask:0xf bank_mask:0xf
    v_add_f32_dpp v99, v99, v99 row_half_mirror row_mask:0xf bank_mask:0xf
    v_add_f32_dpp v96, v96, v96 row_mirror row_mask:0xf bank_mask:0xf
    v_add_f32_dpp v97, v97, v97 row_mirror row_mask:0xf bank_mask:0xf
    v_add_f32_dpp v98, v98, v98 row_mirror row_mask:0xf bank_mask:0xf
    v_add_f32_dpp v99, v99, v99 row_mirror row_mask:0xf bank_mask:0xf
    v_and_b32 v4, 31, v8
    v_lshlrev_b32 v11, 2, v4
    v_add_u32 v11, 122880, v11
    v_lshlrev_b32 v12, 1, v4
    v_add_u32 v12, 123008, v12
    v_cvt_pk_bf16_f32 v2, v96, v96
    v_lshlrev_b32 v2, 16, v2
    v_ashrrev_i32 v3, 31, v2
    v_or_b32 v3, 0x80000000, v3
    v_xor_b32 v2, v2, v3
    v_and_b32 v2, 0xffff0000, v2
    v_sub_u32 v3, 0x87ff, v8
    v_or_b32 v96, v2, v3
    ds_write_b32 v11, v96 offset:0
    v_cvt_pk_bf16_f32 v98, v98, v98
    v_lshlrev_b32 v98, 16, v98
    v_mul_f32 v5, 0xbfb8aa3b, v98
    v_exp_f32 v5, v5
    s_nop 0
    v_add_f32 v5, 1.0, v5
    v_rcp_f32 v98, v5
    s_nop 0
    v_cvt_pk_bf16_f32 v98, v98, v98
    v_or_b32 v98, 0x8000, v98
    ds_write_b16 v12, v98 offset:0
    v_cvt_pk_bf16_f32 v2, v97, v97
    v_lshlrev_b32 v2, 16, v2
    v_ashrrev_i32 v3, 31, v2
    v_or_b32 v3, 0x80000000, v3
    v_xor_b32 v2, v2, v3
    v_and_b32 v2, 0xffff0000, v2
    v_sub_u32 v3, 0x87fb, v8
    v_or_b32 v97, v2, v3
    ds_write_b32 v11, v97 offset:16
    v_cvt_pk_bf16_f32 v99, v99, v99
    v_lshlrev_b32 v99, 16, v99
    v_mul_f32 v5, 0xbfb8aa3b, v99
    v_exp_f32 v5, v5
    s_nop 0
    v_add_f32 v5, 1.0, v5
    v_rcp_f32 v99, v5
    s_nop 0
    v_cvt_pk_bf16_f32 v99, v99, v99
    v_or_b32 v99, 0x8000, v99
    ds_write_b16 v12, v99 offset:8
    v_mov_b32 v3, 1
    s_mov_b64 exec, 1
    ds_add_u32 v13, v3 offset:48
    s_mov_b64 exec, -1
    s_cmp_ge_u32 s30, 6
    s_cbranch_scc1 K_AUX_G1
    s_mov_b32 s3, 1048576
K_FGR:
    ds_read_b32 v2, v13 offset:48
    s_sleep 1
    s_sub_u32 s3, s3, 1
    s_waitcnt lgkmcnt(0)
    v_readfirstlane_b32 s33, v2
    s_nop 3
    s_cselect_b32 s33, 4, s33
    s_cmp_lt_u32 s33, 4
    s_cbranch_scc1 K_FGR
    s_cmp_lg_u32 s30, 4
    s_cbranch_scc1 K_AUX_G0
    v_and_b32 v3, 31, v1
    v_lshlrev_b32 v3, 2, v3
    v_add_u32 v3, 122880, v3
    ds_read_b32 v2, v3
    s_waitcnt lgkmcnt(0)
    s_nop 1
    v_max_u32_dpp v3, v2, v2 quad_perm:[1,0,3,2] row_mask:0xf bank_mask:0xf
    s_nop 1
    v_max_u32_dpp v3, v3, v3 quad_perm:[2,3,0,1] row_mask:0xf bank_mask:0xf
    s_nop 1
    v_max_u32_dpp v3, v3, v3 row_half_mirror row_mask:0xf bank_mask:0xf
    s_nop 1
    v_max_u32_dpp v3, v3, v3 row_mirror row_mask:0xf bank_mask:0xf
    s_nop 1
    v_readlane_b32 s68, v3, 0
    v_readlane_b32 s76, v3, 16
    v_readlane_b32 s77, v3, 32
    v_readlane_b32 s78, v3, 48
    s_nop 3
    s_max_u32 s68, s68, s76
    s_max_u32 s77, s77, s78
    s_max_u32 s68, s68, s77
    v_cmp_ne_u32 vcc, s68, v2
    s_nop 1
    v_cndmask_b32 v2, 0, v2, vcc
    s_nop 1
    v_max_u32_dpp v3, v2, v2 quad_perm:[1,0,3,2] row_mask:0xf bank_mask:0xf
    s_nop 1
    v_max_u32_dpp v3, v3, v3 quad_perm:[2,3,0,1] row_mask:0xf bank_mask:0xf
    s_nop 1
    v_max_u32_dpp v3, v3, v3 row_half_mirror row_mask:0xf bank_mask:0xf
    s_nop 1
    v_max_u32_dpp v3, v3, v3 row_mirror row_mask:0xf bank_mask:0xf
    s_nop 1
    v_readlane_b32 s69, v3, 0
    s_branch K_PG6
.p2align 12
K_PG6:
    v_readlane_b32 s76, v3, 16
    v_readlane_b32 s77, v3, 32
    v_readlane_b32 s78, v3, 48
    s_nop 3
    s_max_u32 s69, s69, s76
    s_max_u32 s77, s77, s78
    s_max_u32 s69, s69, s77
    s_load_dword s33, s[4:5], 0
    s_waitcnt lgkmcnt(0)
    s_cmp_ge_u32 s33, 1
    s_cbranch_scc1 K_ZO3
    s_sleep 8
    s_load_dword s33, s[4:5], 64
    s_waitcnt lgkmcnt(0)
    s_cmp_ge_u32 s33, 1
    s_cbranch_scc1 K_ZO3
    s_sleep 8
    s_mov_b32 s3, 16384
K_ZB3:
    v_mov_b32 v4, 0
    global_load_dword v4, v4, s[4:5] sc1
    s_waitcnt vmcnt(0)
    v_readfirstlane_b32 s33, v4
    s_cmp_ge_u32 s33, 1
    s_cbranch_scc1 K_ZO3
    s_sleep 8
    s_sub_u32 s3, s3, 1
    s_cbranch_scc0 K_ZB3
K_ZO3:
    s_lshl_b32 s3, s2, 3
    s_add_u32 s3, s3, 606208
    s_atomic_add_x2 s[68:69], s[6:7], s3
    s_cmp_lg_u32 s2, 63
    s_cbranch_scc1 K_AUX_G1
    s_mov_b32 s70, 81920
    v_lshlrev_b32 v3, 3, v1
    s_mov_b32 s3, 131072
K_AUX_POLL:
    buffer_load_dwordx2 v[176:177], v3, s[64:67], s70 offen sc1
    s_waitcnt vmcnt(0)
    v_min_u32 v2, v176, v177
    v_cmp_eq_u32 vcc, 0, v2
    s_cbranch_vccz K_AUX_GOT
    s_sleep 2
    s_sub_u32 s3, s3, 1
    s_cmp_lg_u32 s3, 0
    s_cbranch_scc1 K_AUX_POLL
K_AUX_GOT:
    s_waitcnt lgkmcnt(0)
    s_nop 1
    v_max_u32_dpp v3, v176, v176 quad_perm:[1,0,3,2] row_mask:0xf bank_mask:0xf
    s_nop 1
    v_max_u32_dpp v3, v3, v3 quad_perm:[2,3,0,1] row_mask:0xf bank_mask:0xf
    s_nop 1
    v_max_u32_dpp v3, v3, v3 row_half_mirror row_mask:0xf bank_mask:0xf
    s_nop 1
    v_max_u32_dpp v3, v3, v3 row_mirror row_mask:0xf bank_mask:0xf
    s_nop 1
    v_readlane_b32 s68, v3, 0
    v_readlane_b32 s76, v3, 16
    v_readlane_b32 s77, v3, 32
    v_readlane_b32 s78, v3, 48
    s_nop 3
    s_max_u32 s68, s68, s76
    s_max_u32 s77, s77, s78
    s_max_u32 s68, s68, s77
    v_cmp_ne_u32 vcc, s68, v176
    s_nop 1
    v_cndmask_b32 v2, v177, v176, vcc
    s_nop 1
    v_max_u32_dpp v3, v2, v2 quad_perm:[1,0,3,2] row_mask:0xf bank_mask:0xf
    s_nop 1
    v_max_u32_dpp v3, v3, v3 quad_perm:[2,3,0,1] row_mask:0xf bank_mask:0xf
    s_nop 1
    v_max_u32_dpp v3, v3, v3 row_half_mirror row_mask:0xf bank_mask:0xf
    s_nop 1
    v_max_u32_dpp v3, v3, v3 row_mirror row_mask:0xf bank_mask:0xf
    s_nop 1
    v_readlane_b32 s69, v3, 0
    v_readlane_b32 s76, v3, 16
    v_readlane_b32 s77, v3, 32
    v_readlane_b32 s78, v3, 48
    s_nop 3
    s_max_u32 s69, s69, s76
    s_max_u32 s77, s77, s78
    s_max_u32 s69, s69, s77
    v_mov_b32 v176, s68
    v_mov_b32 v177, s69
    s_mov_b32 s3, 1048576
K_FGZ:
    ds_read_b32 v2, v13 offset:36
    s_sleep 1
    s_sub_u32 s3, s3, 1
    s_waitcnt lgkmcnt(0)
    v_readfirstlane_b32 s33, v2
    s_nop 3
    s_cselect_b32 s33, 1, s33
    s_cmp_lt_u32 s33, 1
    s_cbranch_scc1 K_FGZ
    v_lshlrev_b32 v3, 9, v1
    s_mov_b32 s66, 81920
    s_mov_b32 s70, 0
    buffer_store_dwordx2 v[176:177], v3, s[64:67], s70 offen offset:128 sc1
    s_mov_b32 s70, 32768
    buffer_store_dwordx2 v[176:177], v3, s[64:67], s70 offen offset:128 sc1
    s_mov_b32 s70, 65536
    buffer_store_dwordx2 v[176:177], v3, s[64:67], s70 offen offset:128 sc1
    v_mov_b32 v3, 16
    ds_write_b32 v13, v3 offset:48
    s_branch K_AUX_G1
K_AUX_G0:
    v_and_b32 v3, 3, v1
    v_lshlrev_b32 v3, 4, v3
    v_add_u32 v2, 123008, v3
    ds_read_b128 v[176:179], v2
    v_lshrrev_b32 v2, 2, v1
    v_lshl_add_u32 v3, v2, 9, v3
    s_sleep 12
    s_load_dword s33, s[4:5], 128
    s_waitcnt lgkmcnt(0)
    s_cmp_ge_u32 s33, 8
    s_cbranch_scc1 K_ZO4
    s_sleep 8
    s_mov_b32 s3, 16384
K_ZB4:
    v_mov_b32 v4, 128
    global_load_dword v4, v4, s[4:5] sc1
    s_waitcnt vmcnt(0)
    v_readfirstlane_b32 s33, v4
    s_cmp_ge_u32 s33, 8
    s_cbranch_scc1 K_ZO4
    s_sleep 8
    s_sub_u32 s3, s3, 1
    s_cbranch_scc0 K_ZB4
K_ZO4:
    v_mov_b32 v2, 1
    ds_write_b32 v13, v2 offset:36
    s_lshr_b32 s3, s29, 2
    s_lshl1_add_u32 s3, s28, s3
    s_mul_i32 s3, s3, 5120
    s_and_b32 s70, s29, 3
    s_lshl_b32 s70, s70, 6
    s_add_u32 s3, s3, s70
    s_mov_b32 exec_hi, 0xff
    s_waitcnt lgkmcnt(0)
    buffer_store_dwordx4 v[176:179], v3, s[64:67], s3 offen offset:256 sc1
    s_mov_b64 exec, -1
K_AUX_G1:
    s_cmp_lg_u32 s43, 63
    s_cbranch_scc1 K_FFN_C
    s_cmp_lg_u32 s29, 0
    s_cbranch_scc1 K_AUX_NT
    s_lshl2_add_u32 s3, s28, s30
    s_sub_u32 s3, s3, 4
    s_mul_i32 s3, s3, 25600
    v_lshlrev_b32 v2, 7, v1
    buffer_load_dword v5, v2, s[24:27], s3 offen
    s_add_u32 s3, s3, 8192
    buffer_load_dword v5, v2, s[24:27], s3 offen
    s_add_u32 s3, s3, 8192
    buffer_load_dword v5, v2, s[24:27], s3 offen
    s_add_u32 s3, s3, 8192
    s_mov_b64 exec, 0xff
    buffer_load_dword v5, v2, s[24:27], s3 offen
    s_add_u32 s3, s3, 8192
    s_mov_b64 exec, -1
    s_mul_i32 s3, s30, 160
    s_sub_u32 s3, s3, 640
    v_lshrrev_b32 v2, 1, v1
    v_add_u32 v2, s3, v2
    v_mul_u32_u24 v2, 1280, v2
    v_and_b32 v3, 1, v1
    v_lshl_add_u32 v2, v3, 7, v2
    s_mov_b32 s70, 0
    buffer_load_dword v5, v2, s[24:27], s70 offen offset:1024
    s_mov_b32 s70, 40960
    buffer_load_dword v5, v2, s[24:27], s70 offen offset:1024
    s_mov_b32 s70, 81920
    buffer_load_dword v5, v2, s[24:27], s70 offen offset:1024
    s_mov_b32 s70, 122880
    buffer_load_dword v5, v2, s[24:27], s70 offen offset:1024
    s_mov_b32 s70, 163840
    buffer_load_dword v5, v2, s[24:27], s70 offen offset:1024
K_AUX_NT:
    s_mov_b32 s3, 1048576
K_FGZ2:
    ds_read_b32 v2, v13 offset:36
    s_sleep 1
    s_sub_u32 s3, s3, 1
    s_waitcnt lgkmcnt(0)
    v_readfirstlane_b32 s33, v2
    s_nop 3
    s_cselect_b32 s33, 1, s33
    s_cmp_lt_u32 s33, 1
    s_cbranch_scc1 K_FGZ2
    s_waitcnt vmcnt(0)
    s_branch K_P2
K_AUX_L:
    v_and_b32 v1, 63, v0
    v_mov_b32 v7, 0
    s_and_b32 s28, s2, 7
    s_lshr_b32 s29, s2, 3
    s_xor_b32 s30, s30, 4
    s_lshr_b32 s34, s29, 3
    s_lshl_b32 s34, s34, 2
    s_and_b32 s3, s29, 3
    s_add_u32 s34, s34, s3
    s_add_u32 s34, s34, 4
    s_bitcmp1_b32 s29, 2
    s_cselect_b32 s34, -1, s34
    s_cmp_lt_u32 s29, 8
    s_cselect_b32 s34, s29, s34
    s_lshl_b32 s40, s28, 1
    s_cmp_ge_u32 s34, 10
    s_addc_u32 s40, s40, 0
    s_sub_u32 s41, s34, 10
    s_cmp_ge_u32 s34, 10
    s_cselect_b32 s41, s41, s34
    s_mul_i32 s42, s28, 20
    s_add_u32 s42, s42, s34
    s_and_b32 s42, s42, 255
    s_lshl_b32 s42, s42, 9
    s_add_u32 s42, s42, 524288
    s_mul_i32 s43, s28, 7
    s_add_u32 s43, s43, s29
    s_sub_u32 s43, s43, 1
    s_cmp_lt_u32 s43, 54
    s_cselect_b32 s43, s43, 63
    s_cmp_eq_u32 s29, 0
    s_cselect_b32 s43, 63, s43
    v_mov_b32 v3, 158736
    ds_write2_b32 v3, v7, v7 offset0:0 offset1:1
    ds_write2_b32 v3, v7, v7 offset0:2 offset1:3
    ds_write2_b32 v3, v7, v7 offset0:4 offset1:5
    ds_write2_b32 v3, v7, v7 offset0:6 offset1:7
    ds_write2_b32 v3, v7, v7 offset0:8 offset1:9
    v_lshrrev_b32 v3, 2, v1
    v_mul_u32_u24 v11, 3456, v3
    v_and_b32 v3, 3, v1
    v_lshl_add_u32 v11, v3, 4, v11
    s_mul_i32 s3, s30, 552960
    s_lshl_b32 s70, s43, 6
    s_add_u32 s3, s3, s70
    v_add_u32 v11, s3, v11
    s_mul_i32 s68, s30, 10240
    s_add_u32 s72, s68, 40960
    s_bitcmp1_b32 s43, 0
    s_cselect_b32 s71, s72, s68
    s_cselect_b32 s72, s68, s72
    v_lshlrev_b32 v8, 4, v1
    s_waitcnt lgkmcnt(0)
    s_barrier
    s_mov_b32 s24, s8
    s_mov_b32 s25, s9
    s_mov_b32 s26, 0xc8000
    s_mov_b32 s27, 0x20000
    s_cmp_lg_u32 s43, 63
    s_cbranch_scc1 K_AUX_FFN1
    s_cmp_lg_u32 s30, 0
    s_cbranch_scc1 K_AUX_NR
    s_cmp_eq_u32 s2, 55
    s_cbranch_scc1 K_AUX_NR
    s_cmp_eq_u32 s2, 63
    s_cselect_b32 s70, 0, 128
    s_mov_b32 s3, 1
    s_waitcnt vmcnt(0)
    s_atomic_add s3, s[4:5], s70
    s_atomic_add s3, s[4:5], s70 offset:64
    s_waitcnt lgkmcnt(0)
K_AUX_NR:
    v_mov_b32 v13, 158720
    s_mov_b32 s3, 1048576
K_FGZ3:
    ds_read_b32 v2, v13 offset:36
    s_sleep 1
    s_sub_u32 s3, s3, 1
    s_waitcnt lgkmcnt(0)
    v_readfirstlane_b32 s33, v2
    s_nop 3
    s_cselect_b32 s33, 1, s33
    s_cmp_lt_u32 s33, 1
    s_cbranch_scc1 K_FGZ3
    s_cmp_lg_u32 s2, 63
    s_cbranch_scc1 K_AUX_NH
    s_mov_b32 s3, 1048576
K_FGH:
    ds_read_b32 v2, v13 offset:48
    s_sleep 1
    s_sub_u32 s3, s3, 1
    s_waitcnt lgkmcnt(0)
    v_readfirstlane_b32 s33, v2
    s_nop 3
    s_cselect_b32 s33, 16, s33
    s_cmp_lt_u32 s33, 16
    s_cbranch_scc1 K_FGH
K_AUX_NH:
    s_branch K_P2
K_AUX_FFN1:
    s_bitcmp1_b32 s43, 0
    s_cselect_b64 s[56:57], s[48:49], s[46:47]
    s_cselect_b64 s[60:61], s[46:47], s[48:49]
    s_mov_b32 s58, 2211840
    s_mov_b32 s59, 0x20000
    s_mov_b32 s62, 2211840
    s_mov_b32 s63, 0x20000
    s_add_u32 m0, s71, 0
    s_mov_b32 s70, 0
    buffer_load_dwordx4 v11, s[56:59], s70 offen  lds
    s_add_u32 m0, s71, 1024
    s_mov_b32 s70, 55296
    buffer_load_dwordx4 v11, s[56:59], s70 offen  lds
    s_add_u32 m0, s71, 2048
    s_mov_b32 s70, 110592
    buffer_load_dwordx4 v11, s[56:59], s70 offen  lds
    s_add_u32 m0, s71, 3072
    s_mov_b32 s70, 165888
    buffer_load_dwordx4 v11, s[56:59], s70 offen  lds
    s_add_u32 m0, s71, 4096
    s_mov_b32 s70, 221184
    buffer_load_dwordx4 v11, s[56:59], s70 offen  lds
    s_add_u32 m0, s71, 5120
    s_mov_b32 s70, 276480
    buffer_load_dwordx4 v11, s[56:59], s70 offen  lds
    s_add_u32 m0, s71, 6144
    s_mov_b32 s70, 331776
    buffer_load_dwordx4 v11, s[56:59], s70 offen  lds
    s_add_u32 m0, s71, 7168
    s_mov_b32 s70, 387072
    buffer_load_dwordx4 v11, s[56:59], s70 offen  lds
    s_add_u32 m0, s71, 8192
    s_mov_b32 s70, 442368
    buffer_load_dwordx4 v11, s[56:59], s70 offen  lds
    s_add_u32 m0, s71, 9216
    s_mov_b32 s70, 497664
    buffer_load_dwordx4 v11, s[56:59], s70 offen  lds
    s_add_u32 m0, s72, 0
    s_mov_b32 s70, 0
    buffer_load_dwordx4 v11, s[60:63], s70 offen  lds
    s_add_u32 m0, s72, 1024
    s_mov_b32 s70, 55296
    buffer_load_dwordx4 v11, s[60:63], s70 offen  lds
    s_add_u32 m0, s72, 2048
    s_mov_b32 s70, 110592
    buffer_load_dwordx4 v11, s[60:63], s70 offen  lds
    s_add_u32 m0, s72, 3072
    s_mov_b32 s70, 165888
    buffer_load_dwordx4 v11, s[60:63], s70 offen  lds
    s_add_u32 m0, s72, 4096
    s_mov_b32 s70, 221184
    buffer_load_dwordx4 v11, s[60:63], s70 offen  lds
    s_add_u32 m0, s72, 5120
    s_mov_b32 s70, 276480
    buffer_load_dwordx4 v11, s[60:63], s70 offen  lds
    s_add_u32 m0, s72, 6144
    s_mov_b32 s70, 331776
    buffer_load_dwordx4 v11, s[60:63], s70 offen  lds
    s_add_u32 m0, s72, 7168
    s_mov_b32 s70, 387072
    buffer_load_dwordx4 v11, s[60:63], s70 offen  lds
    s_add_u32 m0, s72, 8192
    s_mov_b32 s70, 442368
    buffer_load_dwordx4 v11, s[60:63], s70 offen  lds
    s_add_u32 m0, s72, 9216
    s_mov_b32 s70, 497664
    buffer_load_dwordx4 v11, s[60:63], s70 offen  lds
    s_mov_b32 s64, s50
    s_mov_b32 s65, s51
    s_mov_b32 s66, 0x21c000
    s_mov_b32 s67, 0x20000
    s_mul_i32 s3, s43, 40960
    s_add_u32 s3, s3, s68
    v_add_u32 v12, s3, v8
    s_add_u32 m0, s68, 81920
    s_mov_b32 s70, 0
    buffer_load_dwordx4 v12, s[64:67], s70 offen  lds
    s_add_u32 m0, s68, 82944
    s_mov_b32 s70, 1024
    buffer_load_dwordx4 v12, s[64:67], s70 offen  lds
    s_add_u32 m0, s68, 83968
    s_mov_b32 s70, 2048
    buffer_load_dwordx4 v12, s[64:67], s70 offen  lds
    s_add_u32 m0, s68, 84992
    s_mov_b32 s70, 3072
    buffer_load_dwordx4 v12, s[64:67], s70 offen  lds
    s_add_u32 m0, s68, 86016
    s_mov_b32 s70, 4096
    buffer_load_dwordx4 v12, s[64:67], s70 offen  lds
    s_add_u32 m0, s68, 87040
    s_mov_b32 s70, 5120
    buffer_load_dwordx4 v12, s[64:67], s70 offen  lds
    s_add_u32 m0, s68, 88064
    s_mov_b32 s70, 6144
    buffer_load_dwordx4 v12, s[64:67], s70 offen  lds
    s_add_u32 m0, s68, 89088
    s_mov_b32 s70, 7168
    buffer_load_dwordx4 v12, s[64:67], s70 offen  lds
    s_add_u32 m0, s68, 90112
    s_mov_b32 s70, 8192
    buffer_load_dwordx4 v12, s[64:67], s70 offen  lds
    s_add_u32 m0, s68, 91136
    s_mov_b32 s70, 9216
    buffer_load_dwordx4 v12, s[64:67], s70 offen  lds
    s_waitcnt vmcnt(10)
    s_barrier
    s_branch K_P2_EARLY
K_FFN_C:
    v_lshrrev_b32 v180, 4, v1
    v_bfe_u32 v2, v1, 2, 2
    v_lshl_add_u32 v2, v180, 3, v2
    v_and_b32 v3, 3, v1
    v_lshlrev_b32 v3, 3, v3
    v_lshl_add_u32 v181, v2, 6, v3
    s_bfe_u32 s3, s30, 0x10001
    s_mul_i32 s3, s3, 40960
    s_and_b32 s70, s30, 1
    s_lshl_b32 s70, s70, 5
    s_add_u32 s3, s3, s70
    s_add_u32 s3, s3, 0
    v_add_u32 v181, s3, v181
    v_mul_u32_u24 v182, 1280, v2
    s_and_b32 s3, s30, 3
    s_mul_i32 s3, s3, 320
    s_add_u32 s3, s3, 81920
    v_add3_u32 v182, v182, v3, s3
    v_mov_b32 v183, 123904
    s_cmp_lg_u32 s30, 5
    s_cbranch_scc1 K_KW
    s_mov_b32 s3, 131072
K_KPOLL:
    s_load_dwordx2 s[68:69], s[6:7], s42 offset:128 glc
    s_waitcnt lgkmcnt(0)
    s_min_u32 s33, s68, s69
    s_cmp_lg_u32 s33, 0
    s_cbranch_scc1 K_KGOT
    s_sleep 2
    s_sub_u32 s3, s3, 1
    s_cbranch_scc0 K_KPOLL
K_KGOT:
    v_mov_b32 v176, s68
    v_mov_b32 v177, s69
    ds_write_b64 v183, v[176:177]
    v_lshlrev_b32 v2, 4, v1
    s_and_b32 s70, s68, 0x7ff
    s_sub_u32 s70, 2047, s70
    s_mul_i32 s70, s70, 1280
    s_mov_b32 m0, 134208
    s_mov_b64 exec, -1
    buffer_load_dwordx4 v2, s[12:15], s70 offen lds
    s_mov_b64 exec, 0xffff
    buffer_load_dwordx4 v2, s[12:15], s70 offen offset:1024 lds
    s_and_b32 s70, s69, 0x7ff
    s_sub_u32 s70, 2047, s70
    s_mul_i32 s70, s70, 1280
    s_mov_b32 m0, 135552
    s_mov_b64 exec, -1
    buffer_load_dwordx4 v2, s[12:15], s70 offen lds
    s_mov_b64 exec, 0xffff
    buffer_load_dwordx4 v2, s[12:15], s70 offen offset:1024 lds
    s_mov_b64 exec, -1
    v_mov_b32 v3, 16
    s_waitcnt vmcnt(0)
    ds_write_b32 v13, v3 offset:48
    s_branch K_KW2
K_KW:
    s_cmp_lt_u32 s30, 6
    s_cbranch_scc1 K_KW2
    s_cmp_eq_u32 s30, 6
    s_cbranch_scc1 K_CHF0
    s_branch K_CHF1
K_WRET_F:
K_KW2:
    s_branch K_J7a60
K_CHF0:
K_STF16:
    s_branch K_STF18
    s_nop 0
K_J7a60:
    v_and_b32 v2, 1, v1
    v_mul_u32_u24 v9, 1344, v2
    v_lshl_add_u32 v9, v180, 4, v9
    v_add_u32 v9, 134208, v9
    v_and_b32 v2, 1, v1
    v_lshlrev_b32 v192, 6, v2
    v_lshl_add_u32 v192, v180, 4, v192
    s_and_b32 s3, s30, 3
    s_lshl_b32 s3, s3, 7
    v_add3_u32 v193, v192, s3, v183
    v_add_u32 v192, 64, v193
    v_add_u32 v193, 1088, v193
    v_lshrrev_b32 v2, 5, v1
    v_bfe_u32 v3, v1, 4, 1
    v_lshl_add_u32 v3, v3, 1, v2
    v_lshlrev_b32 v3, 6, v3
    v_and_b32 v4, 15, v1
    v_lshl_add_u32 v3, v4, 2, v3
    v_add_u32 v194, 123968, v3
    v_lshlrev_b32 v4, 1, v1
    s_add_u32 s3, s3, 124992
    v_add_u32 v195, s3, v4
    v_and_b32 v2, 1, v1
    v_mul_u32_u24 v2, 2560, v2
    v_lshl_add_u32 v196, v180, 4, v2
    s_mul_i32 s70, s30, 640
    s_add_u32 s70, s70, 123456
    v_add_u32 v196, s70, v196
    v_mov_b32 v3, 1
    s_mov_b32 s3, 1048576
K_FGK:
    ds_read_b32 v2, v13 offset:48
    s_sleep 1
    s_sub_u32 s3, s3, 1
    s_waitcnt lgkmcnt(0)
    v_readfirstlane_b32 s33, v2
    s_nop 3
    s_cselect_b32 s33, 16, s33
    s_cmp_lt_u32 s33, 16
    s_cbranch_scc1 K_FGK
    ds_read_b128 v[96:99], v9 offset:0
    ds_read_b128 v[100:103], v9 offset:64
    ds_read_b128 v[104:107], v9 offset:128
    ds_read_b128 v[108:111], v9 offset:192
    ds_read_b128 v[112:115], v9 offset:256
    ds_read_b128 v[116:119], v9 offset:320
    ds_read_b128 v[120:123], v9 offset:384
    ds_read_b128 v[124:127], v9 offset:448
    ds_read_b128 v[128:131], v9 offset:512
    ds_read_b128 v[132:135], v9 offset:576
    ds_read_b128 v[136:139], v9 offset:640
    ds_read_b128 v[140:143], v9 offset:704
    ds_read_b128 v[144:147], v9 offset:768
    ds_read_b128 v[148:151], v9 offset:832
    ds_read_b128 v[152:155], v9 offset:896
    ds_read_b128 v[156:159], v9 offset:960
    ds_read_b128 v[160:163], v9 offset:1024
    ds_read_b128 v[164:167], v9 offset:1088
    ds_read_b128 v[168:171], v9 offset:1152
    ds_read_b128 v[172:175], v9 offset:1216
    s_setprio 3
    s_barrier
    ds_read_b64_tr_b16 v[16:17], v181 offset:0
    ds_read_b64_tr_b16 v[18:19], v181 offset:256
    ds_read_b64_tr_b16 v[20:21], v181 offset:2048
    ds_read_b64_tr_b16 v[22:23], v181 offset:2304
    ds_read_b64_tr_b16 v[24:25], v181 offset:4096
    ds_read_b64_tr_b16 v[26:27], v181 offset:4352
    ds_read_b64_tr_b16 v[28:29], v181 offset:6144
    ds_read_b64_tr_b16 v[30:31], v181 offset:6400
    ds_read_b64_tr_b16 v[32:33], v181 offset:8192
    ds_read_b64_tr_b16 v[34:35], v181 offset:8448
    ds_read_b64_tr_b16 v[36:37], v181 offset:10240
    ds_read_b64_tr_b16 v[38:39], v181 offset:10496
    ds_read_b64_tr_b16 v[40:41], v181 offset:12288
    ds_read_b64_tr_b16 v[42:43], v181 offset:12544
    ds_read_b64_tr_b16 v[44:45], v181 offset:14336
    ds_read_b64_tr_b16 v[46:47], v181 offset:14592
    ds_read_b64_tr_b16 v[48:49], v181 offset:16384
    ds_read_b64_tr_b16 v[50:51], v181 offset:16640
    ds_read_b64_tr_b16 v[52:53], v181 offset:18432
    ds_read_b64_tr_b16 v[54:55], v181 offset:18688
    ds_read_b64_tr_b16 v[56:57], v181 offset:20480
    ds_read_b64_tr_b16 v[58:59], v181 offset:20736
    ds_read_b64_tr_b16 v[60:61], v181 offset:22528
    ds_read_b64_tr_b16 v[62:63], v181 offset:22784
    ds_read_b64_tr_b16 v[64:65], v181 offset:24576
    ds_read_b64_tr_b16 v[66:67], v181 offset:24832
    ds_read_b64_tr_b16 v[68:69], v181 offset:26624
    ds_read_b64_tr_b16 v[70:71], v181 offset:26880
    ds_read_b64_tr_b16 v[72:73], v181 offset:28672
    ds_read_b64_tr_b16 v[74:75], v181 offset:28928
    ds_read_b64_tr_b16 v[76:77], v181 offset:30720
    ds_read_b64_tr_b16 v[78:79], v181 offset:30976
    ds_read_b64_tr_b16 v[80:81], v181 offset:32768
    ds_read_b64_tr_b16 v[82:83], v181 offset:33024
    ds_read_b64_tr_b16 v[84:85], v181 offset:34816
    ds_read_b64_tr_b16 v[86:87], v181 offset:35072
    ds_read_b64_tr_b16 v[88:89], v181 offset:36864
    ds_read_b64_tr_b16 v[90:91], v181 offset:37120
    ds_read_b64_tr_b16 v[92:93], v181 offset:38912
    ds_read_b64_tr_b16 v[94:95], v181 offset:39168
    s_waitcnt lgkmcnt(0)
    s_barrier
    v_mfma_f32_16x16x32_bf16 v[184:187], v[16:19], v[96:99], 0
    v_mfma_f32_16x16x32_bf16 v[188:191], v[20:23], v[100:103], 0
    v_mfma_f32_16x16x32_bf16 v[184:187], v[24:27], v[104:107], v[184:187]
    v_mfma_f32_16x16x32_bf16 v[188:191], v[28:31], v[108:111], v[188:191]
    v_mfma_f32_16x16x32_bf16 v[184:187], v[32:35], v[112:115], v[184:187]
    v_mfma_f32_16x16x32_bf16 v[188:191], v[36:39], v[116:119], v[188:191]
    v_mfma_f32_16x16x32_bf16 v[184:187], v[40:43], v[120:123], v[184:187]
    v_mfma_f32_16x16x32_bf16 v[188:191], v[44:47], v[124:127], v[188:191]
    v_mfma_f32_16x16x32_bf16 v[184:187], v[48:51], v[128:131], v[184:187]
    v_mfma_f32_16x16x32_bf16 v[188:191], v[52:55], v[132:135], v[188:191]
    v_mfma_f32_16x16x32_bf16 v[184:187], v[56:59], v[136:139], v[184:187]
    v_mfma_f32_16x16x32_bf16 v[188:191], v[60:63], v[140:143], v[188:191]
    v_mfma_f32_16x16x32_bf16 v[184:187], v[64:67], v[144:147], v[184:187]
    v_mfma_f32_16x16x32_bf16 v[188:191], v[68:71], v[148:151], v[188:191]
    v_mfma_f32_16x16x32_bf16 v[184:187], v[72:75], v[152:155], v[184:187]
    v_mfma_f32_16x16x32_bf16 v[188:191], v[76:79], v[156:159], v[188:191]
    v_mfma_f32_16x16x32_bf16 v[184:187], v[80:83], v[160:163], v[184:187]
    v_mfma_f32_16x16x32_bf16 v[188:191], v[84:87], v[164:167], v[188:191]
    v_mfma_f32_16x16x32_bf16 v[184:187], v[88:91], v[168:171], v[184:187]
    v_mfma_f32_16x16x32_bf16 v[188:191], v[92:95], v[172:175], v[188:191]
    s_nop 7
    v_add_f32 v184, v184, v188
    v_add_f32 v185, v185, v189
    v_add_f32 v186, v186, v190
    v_add_f32 v187, v187, v191
    s_mov_b32 exec_lo, 0x00030003
    s_mov_b32 exec_hi, 0x00030003
    ds_write_b128 v192, v[184:187]
    s_mov_b64 exec, 1
    ds_add_u32 v13, v3 offset:52
    s_mov_b64 exec, -1
    s_cmp_lg_u32 s30, 6
    s_cbranch_scc1 K_NOS6B
    v_lshl_add_u32 v4, v1, 2, s42
    s_branch K_J7e28
K_CHF1:
K_STF17:
    s_branch K_WRET_F
    s_nop 0
K_J7e28:
    global_load_dword v7, v4, s[6:7] offset:256 sc1
    v_and_b32 v4, 0xfffffe04, v4
    global_load_dword v6, v4, s[6:7] offset:128 sc1
K_NOS6B:
    s_mov_b32 s3, 1048576
K_FGP:
    ds_read_b32 v2, v13 offset:52
    s_sleep 1
    s_sub_u32 s3, s3, 1
    s_waitcnt lgkmcnt(0)
    v_readfirstlane_b32 s33, v2
    s_nop 3
    s_cselect_b32 s33, 8, s33
    s_cmp_lt_u32 s33, 8
    s_cbranch_scc1 K_FGP
    ds_read_b32 v200, v194
    ds_read_b32 v202, v194 offset:256
    ds_read_b64_tr_b16 v[16:17], v182 offset:0
    ds_read_b64_tr_b16 v[18:19], v182 offset:5120
    ds_read_b64_tr_b16 v[20:21], v182 offset:32
    ds_read_b64_tr_b16 v[22:23], v182 offset:5152
    ds_read_b64_tr_b16 v[24:25], v182 offset:64
    ds_read_b64_tr_b16 v[26:27], v182 offset:5184
    ds_read_b64_tr_b16 v[28:29], v182 offset:96
    ds_read_b64_tr_b16 v[30:31], v182 offset:5216
    ds_read_b64_tr_b16 v[32:33], v182 offset:128
    ds_read_b64_tr_b16 v[34:35], v182 offset:5248
    ds_read_b64_tr_b16 v[36:37], v182 offset:160
    ds_read_b64_tr_b16 v[38:39], v182 offset:5280
    ds_read_b64_tr_b16 v[40:41], v182 offset:192
    ds_read_b64_tr_b16 v[42:43], v182 offset:5312
    s_waitcnt lgkmcnt(14)
    v_cvt_pk_bf16_f32 v200, v200, v200
    v_lshlrev_b32 v200, 16, v200
    v_cvt_pk_bf16_f32 v202, v202, v202
    v_lshlrev_b32 v202, 16, v202
    v_mul_f32 v201, 0xbfb8aa3b, v200
    v_exp_f32 v201, v201
    s_nop 0
    v_add_f32 v201, 1.0, v201
    v_rcp_f32 v201, v201
    s_nop 0
    v_mul_f32 v200, v200, v201
    v_cvt_pk_bf16_f32 v200, v200, v200
    v_lshlrev_b32 v200, 16, v200
    v_mul_f32 v200, v200, v202
    v_cvt_pk_bf16_f32 v200, v200, v200
    ds_write_b16 v195, v200
    s_waitcnt lgkmcnt(0)
    ds_read_b128 v[200:203], v193
    ds_read_b64_tr_b16 v[44:45], v182 offset:224
    ds_read_b64_tr_b16 v[46:47], v182 offset:5344
    ds_read_b64_tr_b16 v[48:49], v182 offset:256
    ds_read_b64_tr_b16 v[50:51], v182 offset:5376
    ds_read_b64_tr_b16 v[52:53], v182 offset:288
    ds_read_b64_tr_b16 v[54:55], v182 offset:5408
    s_waitcnt lgkmcnt(6)
    v_mfma_f32_16x16x32_bf16 v[96:99], v[16:19], v[200:203], 0
    v_mfma_f32_16x16x32_bf16 v[100:103], v[20:23], v[200:203], 0
    v_mfma_f32_16x16x32_bf16 v[104:107], v[24:27], v[200:203], 0
    v_mfma_f32_16x16x32_bf16 v[108:111], v[28:31], v[200:203], 0
    v_mfma_f32_16x16x32_bf16 v[112:115], v[32:35], v[200:203], 0
    v_mfma_f32_16x16x32_bf16 v[116:119], v[36:39], v[200:203], 0
    v_mfma_f32_16x16x32_bf16 v[120:123], v[40:43], v[200:203], 0
    s_waitcnt lgkmcnt(4)
    v_mfma_f32_16x16x32_bf16 v[124:127], v[44:47], v[200:203], 0
    s_waitcnt lgkmcnt(2)
    v_mfma_f32_16x16x32_bf16 v[128:131], v[48:51], v[200:203], 0
    s_waitcnt lgkmcnt(0)
    v_mfma_f32_16x16x32_bf16 v[132:135], v[52:55], v[200:203], 0
    s_mov_b32 exec_lo, 0x00030003
    s_branch K_PG7
.p2align 12
K_STF18:
    s_branch K_WRET_F
    s_nop 0
K_PG7:
    s_mov_b32 exec_hi, 0x00030003
    ds_write_b128 v196, v[96:99] offset:0
    ds_write_b128 v196, v[100:103] offset:64
    ds_write_b128 v196, v[104:107] offset:128
    ds_write_b128 v196, v[108:111] offset:192
    ds_write_b128 v196, v[112:115] offset:256
    ds_write_b128 v196, v[116:119] offset:320
    ds_write_b128 v196, v[120:123] offset:384
    ds_write_b128 v196, v[124:127] offset:448
    ds_write_b128 v196, v[128:131] offset:512
    ds_write_b128 v196, v[132:135] offset:576
    v_mov_b32 v3, 1
    s_mov_b64 exec, 1
    ds_add_u32 v13, v3 offset:52
    s_mov_b64 exec, -1
    s_cmp_lg_u32 s30, 4
    s_cbranch_scc1 K_P2
    v_lshlrev_b32 v3, 4, v1
    v_add_u32 v4, 126016, v3
    s_mul_i32 s70, s43, 5120
    s_add_u32 s71, s70, 4096
    s_mov_b32 s3, 1048576
K_FGQ:
    ds_read_b32 v2, v13 offset:52
    s_sleep 1
    s_sub_u32 s3, s3, 1
    s_waitcnt lgkmcnt(0)
    v_readfirstlane_b32 s33, v2
    s_nop 3
    s_cselect_b32 s33, 12, s33
    s_cmp_lt_u32 s33, 12
    s_cbranch_scc1 K_FGQ
    ds_read_b128 v[16:19], v4 offset:0
    ds_read_b128 v[20:23], v4 offset:1024
    ds_read_b128 v[24:27], v4 offset:2048
    ds_read_b128 v[28:31], v4 offset:3072
    ds_read_b128 v[32:35], v4 offset:4096
    s_waitcnt lgkmcnt(4)
    buffer_store_dwordx4 v[16:19], v3, s[60:63], s70 offen offset:0 sc1
    s_waitcnt lgkmcnt(3)
    buffer_store_dwordx4 v[20:23], v3, s[60:63], s70 offen offset:1024 sc1
    s_waitcnt lgkmcnt(2)
    buffer_store_dwordx4 v[24:27], v3, s[60:63], s70 offen offset:2048 sc1
    s_waitcnt lgkmcnt(1)
    buffer_store_dwordx4 v[28:31], v3, s[60:63], s70 offen offset:3072 sc1
    s_waitcnt lgkmcnt(0)
    buffer_store_dwordx4 v[32:35], v3, s[60:63], s71 offen offset:0 sc1
    s_mov_b32 s3, 1
    s_waitcnt vmcnt(0)
    s_atomic_add s3, s[6:7], 606720 glc
    ds_read_b64 v[176:177], v183
    s_waitcnt lgkmcnt(0)
    s_cmp_lg_u32 s3, 53
    s_cbranch_scc1 K_P2
    v_readfirstlane_b32 s70, v176
    s_and_b32 s70, s70, 0x7ff
    s_sub_u32 s70, 2047, s70
    s_lshr_b32 s70, s70, 7
    s_mul_i32 s70, s70, 5120
    s_atomic_add s3, s[6:7], s70 offset:524424
    s_atomic_add s3, s[6:7], s70 offset:524936
    s_atomic_add s3, s[6:7], s70 offset:525448
    s_atomic_add s3, s[6:7], s70 offset:525960
    s_atomic_add s3, s[6:7], s70 offset:526472
    s_atomic_add s3, s[6:7], s70 offset:526984
    s_atomic_add s3, s[6:7], s70 offset:527496
    s_atomic_add s3, s[6:7], s70 offset:528008
    s_atomic_add s3, s[6:7], s70 offset:528520
    s_atomic_add s3, s[6:7], s70 offset:529032
    v_readfirstlane_b32 s70, v177
    s_and_b32 s70, s70, 0x7ff
    s_sub_u32 s70, 2047, s70
    s_lshr_b32 s70, s70, 7
    s_mul_i32 s70, s70, 5120
    s_atomic_add s3, s[6:7], s70 offset:524424
    s_atomic_add s3, s[6:7], s70 offset:524936
    s_atomic_add s3, s[6:7], s70 offset:525448
    s_atomic_add s3, s[6:7], s70 offset:525960
    s_atomic_add s3, s[6:7], s70 offset:526472
    s_atomic_add s3, s[6:7], s70 offset:526984
    s_atomic_add s3, s[6:7], s70 offset:527496
    s_atomic_add s3, s[6:7], s70 offset:528008
    s_atomic_add s3, s[6:7], s70 offset:528520
    s_atomic_add s3, s[6:7], s70 offset:529032
    s_waitcnt lgkmcnt(0)
    s_branch K_P2
K_CODE_END:
.section .rodata,"a"
.p2align 6
.amdhsa_kernel gated_mix__sliding_local_dilated__moe_arch_mod__prompt_kernel
  .amdhsa_next_free_vgpr 248
  .amdhsa_next_free_sgpr 79
  .amdhsa_accum_offset 248
  .amdhsa_group_segment_fixed_size 0
  .amdhsa_kernarg_size 96
  .amdhsa_user_sgpr_count 2
  .amdhsa_user_sgpr_kernarg_segment_ptr 1
  .amdhsa_system_sgpr_workgroup_id_x 1
.end_amdhsa_kernel
```

```asm
; @launch grid=(256,1,1) block=(512,1,1) lds=163840
.amdgcn_target "amdgcn-amd-amdhsa--gfx950"
.text
K_CPL = 33
.p2align 12
.p2align 8
.globl gated_mix__sliding_local_dilated__moe_arch_mod__prompt_kernel
.type gated_mix__sliding_local_dilated__moe_arch_mod__prompt_kernel,@function
gated_mix__sliding_local_dilated__moe_arch_mod__prompt_kernel:
    s_cmp_ge_u32 s2, 256
    s_cbranch_scc1 K_EXIT
    s_load_dwordx2 s[12:13], s[0:1], 0
    s_load_dwordx2 s[16:17], s[0:1], 8
    s_load_dwordx4 s[4:7], s[0:1], 80
    s_load_dwordx2 s[8:9], s[0:1], 16
    s_load_dwordx2 s[10:11], s[0:1], 72
    v_readfirstlane_b32 s30, v0
    s_mov_b32 s14, 0x280000
    s_mov_b32 s15, 0x20000
    s_lshr_b32 s30, s30, 6
    s_cmp_ge_u32 s2, 64
    s_cbranch_scc1 K_MAIN
    s_load_dwordx8 s[44:51], s[0:1], 32
    s_load_dwordx2 s[52:53], s[0:1], 64
    s_getpc_b64 s[38:39]
K_PC:
    s_lshr_b32 s3, s2, 3
    s_mul_i32 s3, s3, K_CPL
    v_add_u32 v2, s3, v0
    v_lshlrev_b32 v2, 7, v2
    v_min_u32 v2, K_CODE_END-K_PC-4, v2
    v_cmp_gt_u32 vcc, K_CPL, v0
    s_and_saveexec_b64 s[20:21], vcc
    s_cbranch_execz K_NOPF
    global_load_dword v6, v2, s[38:39]
K_NOPF:
    s_mov_b64 exec, -1
    s_cmp_lg_u32 s30, 4
    s_cbranch_scc1 K_AUX
    s_min_u32 s3, s2, 8
    s_mul_i32 s3, s3, 10240
    s_add_u32 s33, s3, 10240
    s_cmp_lt_u32 s2, 8
    s_cbranch_scc1 K_ZS
    s_cmp_lg_u32 s2, 63
    s_cbranch_scc1 K_AUX
    s_mov_b32 s33, 0
K_ZS:
    v_lshlrev_b32 v2, 4, v0
    v_mov_b32 v8, 0
    v_mov_b32 v9, 0
    v_mov_b32 v10, 0
    v_mov_b32 v11, 0
    s_waitcnt lgkmcnt(0)
    s_add_u32 s20, s6, 0x7f000
    s_addc_u32 s21, s7, 0
    s_mov_b32 s22, 0x15400
    s_mov_b32 s23, 0x20000
K_ZL:
    buffer_store_dwordx4 v[8:11], v2, s[20:23], s3 offen sc1
    s_add_u32 s3, s3, 1024
    s_cmp_lt_u32 s3, s33
    s_cbranch_scc1 K_ZL
    s_branch K_AUX
K_MAIN:
    s_cmp_ge_u32 s30, 4
    s_cbranch_scc1 K_CONS
    s_bfe_u32 s3, s2, 0x20001
    s_mul_i32 s44, s3, 675840
    s_lshr_b32 s33, s2, 6
    s_mul_i32 s3, s33, 225280
    s_add_u32 s44, s44, s3
    s_mul_i32 s3, s30, 61440
    s_add_u32 s44, s44, s3
    s_sub_u32 s44, s44, 245760
    v_bfe_u32 v3, v0, 4, 2
    s_lshr_b32 s3, s2, 1
    s_and_b32 s3, s3, 28
    s_or_b32 s3, s3, 0x40000
    v_lshlrev_b32 v2, 1, v3
    v_sub_u32 v2, v0, v2
    s_and_b32 s50, s2, 0xc1
    s_mov_b32 s49, 0x225510
    s_cmpk_eq_u32 s50, 128
    s_cselect_b32 s49, 0x75275525, s49
    s_cmpk_eq_u32 s50, 192
    s_cselect_b32 s49, 0x37765750, s49
    s_cmpk_eq_u32 s50, 65
    s_cselect_b32 s49, 0x225510, s49
    s_cmpk_eq_u32 s50, 129
    s_cselect_b32 s49, 0x75275525, s49
    s_cmpk_eq_u32 s50, 193
    s_cselect_b32 s49, 0x37765750, s49
    s_bfe_u32 s49, s49, s3
    s_bfe_u32 s32, 0x64317520, s3
    v_and_b32 v2, 15, v2
    v_mul_u32_u24 v5, 3840, v3
    s_lshl_b32 s3, s2, 2
    s_lshr_b32 s3, 0x44032335, s3
    s_and_b32 s3, s3, 15
    s_add_u32 s49, s49, s3
    s_mov_b32 s33, 0x00a55a
    v_subrev_u32 v5, 160, v5
    s_sub_u32 s3, s49, 10
    s_cselect_b32 s49, s49, s3
    v_mul_u32_u24 v4, 52, v2
    v_lshrrev_b32 v4, 5, v4
    v_and_b32 v4, 24, v4
    v_bfe_u32 v4, s33, v4, 8
    v_add_u32 v4, v4, v2
    v_lshl_add_u32 v218, v4, 4, v5
    v_add_u32 v4, 1, v2
    v_lshrrev_b32 v4, 4, v4
    v_lshl_add_u32 v218, v4, 28, v218
    v_xor_b32 v2, 8, v2
    v_mul_u32_u24 v4, 52, v2
    v_lshrrev_b32 v4, 5, v4
    v_and_b32 v4, 24, v4
    v_bfe_u32 v4, s33, v4, 8
    v_add_u32 v4, v4, v2
    v_lshl_add_u32 v219, v4, 4, v5
    v_add_u32 v4, 1, v2
    v_lshrrev_b32 v4, 4, v4
    v_lshl_add_u32 v219, v4, 28, v219
    s_bitcmp1_b32 s2, 0
    s_cselect_b32 s3, 8, 0
    s_add_u32 s32, s32, s3
    s_mul_i32 s50, s32, 80
    s_mul_i32 s3, s30, 61440
    s_add_u32 s50, s50, s3
    s_lshl_b32 s46, s30, 12
    s_add_u32 s46, s46, 24576
    s_mul_i32 s45, s30, 6144
    s_mov_b32 s18, 0x258000
    s_mov_b32 s19, 0x20000
    v_xor_b32 v3, v3, v0
    v_and_b32 v3, 7, v3
    v_bfe_u32 v2, v0, 3, 3
    v_mul_u32_u24 v2, 1280, v2
    v_lshl_add_u32 v216, v3, 4, v2
    v_xor_b32 v217, 64, v216
    s_lshl_b32 s47, s49, 7
    s_mul_i32 s48, s49, 245760
    s_add_u32 s51, s44, s47
    s_add_u32 s48, s48, s50
    s_add_u32 s49, s49, 1
    s_cmp_eq_u32 s49, 10
    s_cselect_b32 s49, 0, s49
    s_waitcnt lgkmcnt(0)
    s_add_u32 m0, s46, 81920
    s_add_u32 s52, s48, 0
    buffer_load_dwordx4 v218, s[16:19], s52 offen lds
    s_add_u32 m0, s45, 81920
    s_max_i32 s52, s51, s47
    buffer_load_dwordx4 v216, s[12:15], s52 offen lds
    s_add_u32 m0, s46, 82944
    s_add_u32 s52, s48, 15360
    buffer_load_dwordx4 v218, s[16:19], s52 offen lds
    s_add_u32 m0, s45, 82944
    s_add_u32 s52, s51, 10240
    s_max_i32 s52, s52, s47
    buffer_load_dwordx4 v217, s[12:15], s52 offen lds
    s_add_u32 m0, s45, 83968
    s_add_u32 s52, s51, 20480
    buffer_load_dwordx4 v216, s[12:15], s52 offen lds
    s_add_u32 m0, s46, 83968
    s_add_u32 s52, s48, 30720
    buffer_load_dwordx4 v219, s[16:19], s52 offen lds
    s_add_u32 m0, s45, 84992
    s_add_u32 s52, s51, 30720
    buffer_load_dwordx4 v217, s[12:15], s52 offen lds
    s_add_u32 m0, s46, 84992
    s_add_u32 s52, s48, 46080
    buffer_load_dwordx4 v219, s[16:19], s52 offen lds
    s_add_u32 m0, s45, 86016
    s_add_u32 s52, s51, 40960
    buffer_load_dwordx4 v216, s[12:15], s52 offen lds
    s_add_u32 m0, s45, 87040
    s_add_u32 s52, s51, 51200
    buffer_load_dwordx4 v217, s[12:15], s52 offen lds
    s_lshl_b32 s47, s49, 7
    s_mul_i32 s48, s49, 245760
    s_add_u32 s51, s44, s47
    s_add_u32 s48, s48, s50
    s_add_u32 s49, s49, 1
    s_cmp_eq_u32 s49, 10
    s_cselect_b32 s49, 0, s49
    s_add_u32 m0, s46, 0
    s_add_u32 s52, s48, 0
    buffer_load_dwordx4 v218, s[16:19], s52 offen lds
    s_add_u32 m0, s45, 0
    s_max_i32 s52, s51, s47
    buffer_load_dwordx4 v216, s[12:15], s52 offen lds
    s_add_u32 m0, s46, 1024
    s_add_u32 s52, s48, 15360
    buffer_load_dwordx4 v218, s[16:19], s52 offen lds
    s_add_u32 m0, s45, 1024
    s_add_u32 s52, s51, 10240
    s_max_i32 s52, s52, s47
    buffer_load_dwordx4 v217, s[12:15], s52 offen lds
    s_add_u32 m0, s45, 2048
    s_add_u32 s52, s51, 20480
    buffer_load_dwordx4 v216, s[12:15], s52 offen lds
    s_add_u32 m0, s46, 2048
    s_add_u32 s52, s48, 30720
    buffer_load_dwordx4 v219, s[16:19], s52 offen lds
    s_mov_b32 s43, s30
    v_and_b32 v1, 63, v0
    v_mov_b32 v7, 0
    s_and_b32 s28, s2, 7
    s_lshr_b32 s29, s2, 3
    s_xor_b32 s30, s30, 4
    s_lshr_b32 s34, s29, 3
    s_lshl_b32 s34, s34, 2
    s_and_b32 s3, s29, 3
    s_add_u32 s34, s34, s3
    s_add_u32 s34, s34, 4
    s_bitcmp1_b32 s29, 2
    s_cselect_b32 s34, -1, s34
    s_cmp_lt_u32 s29, 8
    s_cselect_b32 s34, s29, s34
    s_lshl_b32 s40, s28, 1
    s_cmp_ge_u32 s34, 10
    s_addc_u32 s40, s40, 0
    s_sub_u32 s41, s34, 10
    s_cmp_ge_u32 s34, 10
    s_cselect_b32 s41, s41, s34
    s_mul_i32 s42, s28, 20
    s_add_u32 s42, s42, s34
    s_and_b32 s42, s42, 255
    s_lshl_b32 s42, s42, 9
    s_add_u32 s42, s42, 524288
    s_lshr_b32 s31, s28, 1
    s_mul_i32 s31, s31, 3
    s_lshr_b32 s3, s29, 3
    s_add_u32 s31, s31, s3
    s_sub_u32 s31, s31, 1
    s_and_b32 s32, s28, 1
    s_lshl_b32 s32, s32, 3
    s_and_b32 s3, s29, 7
    s_lshl_b32 s3, s3, 2
    s_lshr_b32 s3, 0x64317520, s3
    s_and_b32 s3, s3, 7
    s_add_u32 s32, s32, s3
    s_and_b32 s35, s29, 3
    s_and_b32 s3, s29, 4
    s_lshl_b32 s3, s3, 1
    s_add_u32 s35, s35, s3
    s_and_b32 s3, s28, 1
    s_lshl_b32 s3, s3, 2
    s_add_u32 s35, s35, s3
K_LOADER:
    s_mov_b32 s24, s8
    s_mov_b32 s25, s9
    s_mov_b32 s26, 0xc8000
    s_mov_b32 s27, 0x20000
    v_and_b32 v8, 15, v1
    v_lshrrev_b32 v9, 4, v1
    v_bfe_u32 v10, v1, 2, 2
    v_and_b32 v11, 3, v1
    s_add_u32 s20, s6, 0x100000
    s_addc_u32 s21, s7, 0
    s_mov_b32 s22, 0x280000
    s_mov_b32 s23, 0x20000
    s_lshr_b32 s53, s35, 2
    s_add_u32 s3, s53, s35
    s_lshl_b32 s3, s3, 12
    s_mul_i32 s33, s53, 19456
    s_lshl_b32 s53, s35, 8
    s_add_u32 s33, s33, s53
    s_add_u32 s33, s33, 16384
    s_mul_i32 s53, s31, 11
    s_add_u32 s54, s53, s43
    v_mov_b32 v3, s54
    v_lshrrev_b32 v2, 2, v3
    v_mul_u32_u24 v2, 76, v2
    v_add_lshl_u32 v2, v2, v3, 10
    v_lshl_add_u32 v2, v8, 4, v2
    v_add_u32 v220, s3, v2
    v_lshl_add_u32 v220, v9, 8, v220
    s_lshl_b32 s3, s43, 2
    v_add_u32 v4, s3, v9
    v_add_u32 v3, s53, v4
    v_lshrrev_b32 v2, 2, v3
    v_mul_u32_u24 v2, 76, v2
    v_add_lshl_u32 v2, v2, v3, 10
    v_lshl_add_u32 v2, v8, 4, v2
    v_add_u32 v221, s33, v2
    v_mov_b32 v5, 0x10000000
    v_cmp_gt_u32 vcc, 11, v4
    v_mov_b32 v224, -1
    v_mov_b32 v225, -1
    v_mov_b32 v226, -1
    v_mov_b32 v227, -1
    v_cndmask_b32 v221, v5, v221, vcc
    v_lshrrev_b32 v2, 3, v1
    v_mul_u32_u24 v2, 1280, v2
    v_lshrrev_b32 v3, 2, v1
    v_and_b32 v3, 4, v3
    v_and_b32 v4, 7, v1
    v_xor_b32 v3, v3, v4
    v_lshl_add_u32 v2, v3, 4, v2
    s_lshl_b32 s33, s41, 7
    v_add_u32 v222, s33, v2
    v_lshrrev_b32 v5, 5, v1
    v_mul_u32_u24 v5, 20480, v5
    v_add_u32 v5, v5, v222
    s_mov_b32 s30, s43
    s_waitcnt vmcnt(6)
    s_barrier
    s_add_u32 m0, s45, 3072
    s_add_u32 s52, s51, 30720
    buffer_load_dwordx4 v217, s[12:15], s52 offen lds
    s_add_u32 m0, s46, 3072
    s_add_u32 s52, s48, 46080
    buffer_load_dwordx4 v219, s[16:19], s52 offen lds
    s_add_u32 m0, s45, 4096
    s_add_u32 s52, s51, 40960
    buffer_load_dwordx4 v216, s[12:15], s52 offen lds
    s_add_u32 m0, s45, 5120
    s_add_u32 s52, s51, 51200
    buffer_load_dwordx4 v217, s[12:15], s52 offen lds
    s_lshl_b32 s47, s49, 7
    s_mul_i32 s48, s49, 245760
    s_add_u32 s51, s44, s47
    s_add_u32 s48, s48, s50
    s_add_u32 s49, s49, 1
    s_cmp_eq_u32 s49, 10
    s_cselect_b32 s49, 0, s49
    s_add_u32 m0, s46, 40960
    s_add_u32 s52, s48, 0
    buffer_load_dwordx4 v218, s[16:19], s52 offen lds
    s_add_u32 m0, s45, 40960
    s_max_i32 s52, s51, s47
    buffer_load_dwordx4 v216, s[12:15], s52 offen lds
    s_add_u32 m0, s46, 41984
    s_add_u32 s52, s48, 15360
    buffer_load_dwordx4 v218, s[16:19], s52 offen lds
    s_add_u32 m0, s45, 41984
    s_add_u32 s52, s51, 10240
    s_max_i32 s52, s52, s47
    buffer_load_dwordx4 v217, s[12:15], s52 offen lds
    s_add_u32 m0, s45, 43008
    s_add_u32 s52, s51, 20480
    buffer_load_dwordx4 v216, s[12:15], s52 offen lds
    s_add_u32 m0, s46, 43008
    s_add_u32 s52, s48, 30720
    buffer_load_dwordx4 v219, s[16:19], s52 offen lds
    s_waitcnt vmcnt(6)
    s_barrier
    s_add_u32 m0, s45, 44032
    s_add_u32 s52, s51, 30720
    buffer_load_dwordx4 v217, s[12:15], s52 offen lds
    s_add_u32 m0, s46, 44032
    s_add_u32 s52, s48, 46080
    buffer_load_dwordx4 v219, s[16:19], s52 offen lds
    s_add_u32 m0, s45, 45056
    s_add_u32 s52, s51, 40960
    buffer_load_dwordx4 v216, s[12:15], s52 offen lds
    s_add_u32 m0, s45, 46080
    s_add_u32 s52, s51, 51200
    buffer_load_dwordx4 v217, s[12:15], s52 offen lds
    s_lshl_b32 s47, s49, 7
    s_mul_i32 s48, s49, 245760
    s_add_u32 s51, s44, s47
    s_add_u32 s48, s48, s50
    s_add_u32 s49, s49, 1
    s_cmp_eq_u32 s49, 10
    s_cselect_b32 s49, 0, s49
    s_add_u32 m0, s46, 81920
    s_add_u32 s52, s48, 0
    buffer_load_dwordx4 v218, s[16:19], s52 offen lds
    s_add_u32 m0, s45, 81920
    s_max_i32 s52, s51, s47
    buffer_load_dwordx4 v216, s[12:15], s52 offen lds
    s_add_u32 m0, s46, 82944
    s_add_u32 s52, s48, 15360
    buffer_load_dwordx4 v218, s[16:19], s52 offen lds
    s_add_u32 m0, s45, 82944
    s_add_u32 s52, s51, 10240
    s_max_i32 s52, s52, s47
    buffer_load_dwordx4 v217, s[12:15], s52 offen lds
    s_add_u32 m0, s45, 83968
    s_add_u32 s52, s51, 20480
    buffer_load_dwordx4 v216, s[12:15], s52 offen lds
    s_add_u32 m0, s46, 83968
    s_add_u32 s52, s48, 30720
    buffer_load_dwordx4 v219, s[16:19], s52 offen lds
    s_waitcnt vmcnt(6)
    s_barrier
    s_add_u32 m0, s45, 84992
    s_add_u32 s52, s51, 30720
    buffer_load_dwordx4 v217, s[12:15], s52 offen lds
    s_add_u32 m0, s46, 84992
    s_add_u32 s52, s48, 46080
    buffer_load_dwordx4 v219, s[16:19], s52 offen lds
    s_add_u32 m0, s45, 86016
    s_add_u32 s52, s51, 40960
    buffer_load_dwordx4 v216, s[12:15], s52 offen lds
    s_add_u32 m0, s45, 87040
    s_add_u32 s52, s51, 51200
    buffer_load_dwordx4 v217, s[12:15], s52 offen lds
    s_lshl_b32 s47, s49, 7
    s_mul_i32 s48, s49, 245760
    s_add_u32 s51, s44, s47
    s_add_u32 s48, s48, s50
    s_add_u32 s49, s49, 1
    s_cmp_eq_u32 s49, 10
    s_cselect_b32 s49, 0, s49
    s_add_u32 m0, s46, 0
    s_add_u32 s52, s48, 0
    buffer_load_dwordx4 v218, s[16:19], s52 offen lds
    s_add_u32 m0, s45, 0
    s_max_i32 s52, s51, s47
    buffer_load_dwordx4 v216, s[12:15], s52 offen lds
    s_add_u32 m0, s46, 1024
    s_add_u32 s52, s48, 15360
    buffer_load_dwordx4 v218, s[16:19], s52 offen lds
    s_add_u32 m0, s45, 1024
    s_add_u32 s52, s51, 10240
    s_max_i32 s52, s52, s47
    buffer_load_dwordx4 v217, s[12:15], s52 offen lds
    s_add_u32 m0, s45, 2048
    s_add_u32 s52, s51, 20480
    buffer_load_dwordx4 v216, s[12:15], s52 offen lds
    s_add_u32 m0, s46, 2048
    s_add_u32 s52, s48, 30720
    buffer_load_dwordx4 v219, s[16:19], s52 offen lds
    s_waitcnt vmcnt(6)
    s_barrier
    s_add_u32 m0, s45, 3072
    s_add_u32 s52, s51, 30720
    buffer_load_dwordx4 v217, s[12:15], s52 offen lds
    s_add_u32 m0, s46, 3072
    s_add_u32 s52, s48, 46080
    buffer_load_dwordx4 v219, s[16:19], s52 offen lds
    s_add_u32 m0, s45, 4096
    s_add_u32 s52, s51, 40960
    buffer_load_dwordx4 v216, s[12:15], s52 offen lds
    s_add_u32 m0, s45, 5120
    s_add_u32 s52, s51, 51200
    buffer_load_dwordx4 v217, s[12:15], s52 offen lds
    s_lshl_b32 s47, s49, 7
    s_mul_i32 s48, s49, 245760
    s_add_u32 s51, s44, s47
    s_add_u32 s48, s48, s50
    s_add_u32 s49, s49, 1
    s_cmp_eq_u32 s49, 10
    s_cselect_b32 s49, 0, s49
    s_add_u32 m0, s46, 40960
    s_add_u32 s52, s48, 0
    buffer_load_dwordx4 v218, s[16:19], s52 offen lds
    s_add_u32 m0, s45, 40960
    s_max_i32 s52, s51, s47
    buffer_load_dwordx4 v216, s[12:15], s52 offen lds
    s_add_u32 m0, s46, 41984
    s_add_u32 s52, s48, 15360
    buffer_load_dwordx4 v218, s[16:19], s52 offen lds
    s_add_u32 m0, s45, 41984
    s_add_u32 s52, s51, 10240
    s_max_i32 s52, s52, s47
    buffer_load_dwordx4 v217, s[12:15], s52 offen lds
    s_add_u32 m0, s45, 43008
    s_add_u32 s52, s51, 20480
    buffer_load_dwordx4 v216, s[12:15], s52 offen lds
    s_add_u32 m0, s46, 43008
    s_add_u32 s52, s48, 30720
    buffer_load_dwordx4 v219, s[16:19], s52 offen lds
    s_waitcnt vmcnt(6)
    s_barrier
    s_add_u32 m0, s45, 44032
    s_add_u32 s52, s51, 30720
    buffer_load_dwordx4 v217, s[12:15], s52 offen lds
    s_add_u32 m0, s46, 44032
    s_add_u32 s52, s48, 46080
    buffer_load_dwordx4 v219, s[16:19], s52 offen lds
    s_add_u32 m0, s45, 45056
    s_add_u32 s52, s51, 40960
    buffer_load_dwordx4 v216, s[12:15], s52 offen lds
    s_add_u32 m0, s45, 46080
    s_add_u32 s52, s51, 51200
    buffer_load_dwordx4 v217, s[12:15], s52 offen lds
    s_lshl_b32 s47, s49, 7
    s_mul_i32 s48, s49, 245760
    s_add_u32 s51, s44, s47
    s_add_u32 s48, s48, s50
    s_add_u32 s49, s49, 1
    s_cmp_eq_u32 s49, 10
    s_cselect_b32 s49, 0, s49
    s_add_u32 m0, s46, 81920
    s_add_u32 s52, s48, 0
    buffer_load_dwordx4 v218, s[16:19], s52 offen lds
    s_add_u32 m0, s45, 81920
    s_max_i32 s52, s51, s47
    buffer_load_dwordx4 v216, s[12:15], s52 offen lds
    s_add_u32 m0, s46, 82944
    s_add_u32 s52, s48, 15360
    buffer_load_dwordx4 v218, s[16:19], s52 offen lds
    s_add_u32 m0, s45, 82944
    s_add_u32 s52, s51, 10240
    s_max_i32 s52, s52, s47
    buffer_load_dwordx4 v217, s[12:15], s52 offen lds
    s_add_u32 m0, s45, 83968
    s_add_u32 s52, s51, 20480
    buffer_load_dwordx4 v216, s[12:15], s52 offen lds
    s_add_u32 m0, s46, 83968
    s_add_u32 s52, s48, 30720
    buffer_load_dwordx4 v219, s[16:19], s52 offen lds
    s_waitcnt vmcnt(6)
    s_barrier
    s_add_u32 m0, s45, 84992
    s_add_u32 s52, s51, 30720
    buffer_load_dwordx4 v217, s[12:15], s52 offen lds
    s_add_u32 m0, s46, 84992
    s_add_u32 s52, s48, 46080
    buffer_load_dwordx4 v219, s[16:19], s52 offen lds
    s_add_u32 m0, s45, 86016
    s_add_u32 s52, s51, 40960
    buffer_load_dwordx4 v216, s[12:15], s52 offen lds
    s_add_u32 m0, s45, 87040
    s_add_u32 s52, s51, 51200
    buffer_load_dwordx4 v217, s[12:15], s52 offen lds
    s_lshl_b32 s47, s49, 7
    s_mul_i32 s48, s49, 245760
    s_add_u32 s51, s44, s47
    s_add_u32 s48, s48, s50
    s_add_u32 s49, s49, 1
    s_cmp_eq_u32 s49, 10
    s_cselect_b32 s49, 0, s49
    s_add_u32 m0, s46, 0
    s_add_u32 s52, s48, 0
    buffer_load_dwordx4 v218, s[16:19], s52 offen lds
    s_add_u32 m0, s45, 0
    s_max_i32 s52, s51, s47
    buffer_load_dwordx4 v216, s[12:15], s52 offen lds
    s_add_u32 m0, s46, 1024
    s_add_u32 s52, s48, 15360
    buffer_load_dwordx4 v218, s[16:19], s52 offen lds
    s_add_u32 m0, s45, 1024
    s_add_u32 s52, s51, 10240
    s_max_i32 s52, s52, s47
    buffer_load_dwordx4 v217, s[12:15], s52 offen lds
    s_add_u32 m0, s45, 2048
    s_add_u32 s52, s51, 20480
    buffer_load_dwordx4 v216, s[12:15], s52 offen lds
    s_add_u32 m0, s46, 2048
    s_add_u32 s52, s48, 30720
    buffer_load_dwordx4 v219, s[16:19], s52 offen lds
    s_waitcnt vmcnt(6)
    s_barrier
    s_add_u32 m0, s45, 3072
    s_add_u32 s52, s51, 30720
    s_branch K_PG0
.p2align 12
K_CHM0:
K_STM0:
    s_branch K_WRET_M
    s_nop 0
K_PG0:
    buffer_load_dwordx4 v217, s[12:15], s52 offen lds
    s_add_u32 m0, s46, 3072
    s_add_u32 s52, s48, 46080
    buffer_load_dwordx4 v219, s[16:19], s52 offen lds
    s_add_u32 m0, s45, 4096
    s_add_u32 s52, s51, 40960
    buffer_load_dwordx4 v216, s[12:15], s52 offen lds
    s_add_u32 m0, s45, 5120
    s_add_u32 s52, s51, 51200
    buffer_load_dwordx4 v217, s[12:15], s52 offen lds
    s_lshl_b32 s47, s49, 7
    s_mul_i32 s48, s49, 245760
    s_add_u32 s51, s44, s47
    s_add_u32 s48, s48, s50
    s_add_u32 s49, s49, 1
    s_cmp_eq_u32 s49, 10
    s_cselect_b32 s49, 0, s49
    s_add_u32 m0, s46, 40960
    s_add_u32 s52, s48, 0
    buffer_load_dwordx4 v218, s[16:19], s52 offen lds
    s_add_u32 m0, s45, 40960
    s_max_i32 s52, s51, s47
    buffer_load_dwordx4 v216, s[12:15], s52 offen lds
    s_add_u32 m0, s46, 41984
    s_add_u32 s52, s48, 15360
    buffer_load_dwordx4 v218, s[16:19], s52 offen lds
    s_add_u32 m0, s45, 41984
    s_add_u32 s52, s51, 10240
    s_max_i32 s52, s52, s47
    buffer_load_dwordx4 v217, s[12:15], s52 offen lds
    s_add_u32 m0, s45, 43008
    s_add_u32 s52, s51, 20480
    buffer_load_dwordx4 v216, s[12:15], s52 offen lds
    s_add_u32 m0, s46, 43008
    s_add_u32 s52, s48, 30720
    buffer_load_dwordx4 v219, s[16:19], s52 offen lds
    s_waitcnt vmcnt(6)
    s_barrier
    s_add_u32 m0, s45, 44032
    s_add_u32 s52, s51, 30720
    buffer_load_dwordx4 v217, s[12:15], s52 offen lds
    s_add_u32 m0, s46, 44032
    s_add_u32 s52, s48, 46080
    buffer_load_dwordx4 v219, s[16:19], s52 offen lds
    s_add_u32 m0, s45, 45056
    s_add_u32 s52, s51, 40960
    buffer_load_dwordx4 v216, s[12:15], s52 offen lds
    s_add_u32 m0, s45, 46080
    s_add_u32 s52, s51, 51200
    buffer_load_dwordx4 v217, s[12:15], s52 offen lds
    s_lshl_b32 s47, s49, 7
    s_mul_i32 s48, s49, 245760
    s_add_u32 s51, s44, s47
    s_add_u32 s48, s48, s50
    s_add_u32 s49, s49, 1
    s_cmp_eq_u32 s49, 10
    s_cselect_b32 s49, 0, s49
    s_add_u32 m0, s46, 81920
    s_add_u32 s52, s48, 0
    buffer_load_dwordx4 v218, s[16:19], s52 offen lds
    s_add_u32 m0, s45, 81920
    s_max_i32 s52, s51, s47
    buffer_load_dwordx4 v216, s[12:15], s52 offen lds
    s_add_u32 m0, s46, 82944
    s_add_u32 s52, s48, 15360
    buffer_load_dwordx4 v218, s[16:19], s52 offen lds
    s_add_u32 m0, s45, 82944
    s_add_u32 s52, s51, 10240
    s_max_i32 s52, s52, s47
    buffer_load_dwordx4 v217, s[12:15], s52 offen lds
    s_add_u32 m0, s45, 83968
    s_add_u32 s52, s51, 20480
    buffer_load_dwordx4 v216, s[12:15], s52 offen lds
    s_add_u32 m0, s46, 83968
    s_add_u32 s52, s48, 30720
    buffer_load_dwordx4 v219, s[16:19], s52 offen lds
    s_waitcnt vmcnt(6)
    s_barrier
    s_load_dword s54, s[4:5], 192
    s_add_u32 m0, s45, 84992
    s_add_u32 s52, s51, 30720
    buffer_load_dwordx4 v217, s[12:15], s52 offen lds
    s_add_u32 m0, s46, 84992
    s_add_u32 s52, s48, 46080
    buffer_load_dwordx4 v219, s[16:19], s52 offen lds
    s_add_u32 m0, s45, 86016
    s_add_u32 s52, s51, 40960
    buffer_load_dwordx4 v216, s[12:15], s52 offen lds
    s_add_u32 m0, s45, 87040
    s_add_u32 s52, s51, 51200
    buffer_load_dwordx4 v217, s[12:15], s52 offen lds
    s_waitcnt lgkmcnt(0)
    s_cmp_ge_u32 s54, 8
    s_cbranch_scc1 K_ZO0
    s_mov_b32 s3, 16384
K_ZB0:
    v_mov_b32 v4, 192
    global_load_dword v4, v4, s[4:5] sc1
    s_waitcnt vmcnt(0)
    v_readfirstlane_b32 s33, v4
    s_cmp_ge_u32 s33, 8
    s_cbranch_scc1 K_ZO0
    s_sleep 8
    s_sub_u32 s3, s3, 1
    s_cbranch_scc0 K_ZB0
K_ZO0:
    s_cmp_eq_u32 s34, -1
    s_cbranch_scc1 K_NOLT
    s_lshl_b32 s47, s43, 2
    s_lshr_b32 s47, 0x7520, s47
    s_and_b32 s47, s47, 7
    s_mul_i32 s47, s47, 51200
    s_lshl_b32 s48, s43, 12
    s_add_u32 s3, s47, 0
    s_add_u32 m0, s48, 0
    s_nop 0
    buffer_load_dwordx4 v222, s[24:27], s3 offen lds
    s_add_u32 s3, s47, 10240
    s_add_u32 m0, s48, 1024
    s_nop 0
    buffer_load_dwordx4 v222, s[24:27], s3 offen lds
    s_add_u32 s3, s47, 25600
    s_add_u32 m0, s48, 2048
    s_nop 0
    buffer_load_dwordx4 v222, s[24:27], s3 offen lds
    s_add_u32 s3, s47, 35840
    s_add_u32 m0, s48, 3072
    s_nop 0
    buffer_load_dwordx4 v222, s[24:27], s3 offen lds
    s_add_u32 s3, s47, 409600
    s_add_u32 m0, s48, 20480
    s_nop 0
    buffer_load_dwordx4 v222, s[24:27], s3 offen lds
    s_add_u32 s3, s47, 419840
    s_add_u32 m0, s48, 21504
    s_nop 0
    buffer_load_dwordx4 v222, s[24:27], s3 offen lds
    s_add_u32 s3, s47, 435200
    s_add_u32 m0, s48, 22528
    s_nop 0
    buffer_load_dwordx4 v222, s[24:27], s3 offen lds
    s_add_u32 s3, s47, 445440
    s_add_u32 m0, s48, 23552
    s_nop 0
    buffer_load_dwordx4 v222, s[24:27], s3 offen lds
    s_lshl_b32 s48, s43, 10
    s_add_u32 s3, s47, 20480
    s_add_u32 m0, s48, 16384
    s_nop 0
    buffer_load_dwordx4 v5, s[24:27], s3 offen lds
    s_add_u32 s3, s47, 430080
    s_add_u32 m0, s48, 36864
    s_nop 0
    buffer_load_dwordx4 v5, s[24:27], s3 offen lds
    s_waitcnt vmcnt(10)
    s_barrier
    s_mov_b32 s33, 81920
    s_cmp_eq_u32 s43, 3
    s_cselect_b32 s3, 0, 163840
    buffer_store_dwordx4 v[224:227], v220, s[20:23], 0 offen sc1
    buffer_store_dwordx4 v[224:227], v220, s[20:23], s33 offen sc1
    buffer_store_dwordx4 v[224:227], v220, s[20:23], s3 offen sc1
    buffer_store_dwordx4 v[224:227], v221, s[20:23], 0 offen sc1
    v_mov_b32 v2, 158720
    v_mov_b32 v3, 1
    s_waitcnt vmcnt(0)
    s_mov_b64 exec, 1
    ds_add_u32 v2, v3 offset:28
    ds_add_u32 v2, v3 offset:32
    s_mov_b64 exec, -1
    s_lshl_b32 s47, s43, 2
    s_lshr_b32 s47, 0x6431, s47
    s_and_b32 s47, s47, 7
    s_mul_i32 s47, s47, 51200
    s_lshl_b32 s48, s43, 12
    s_add_u32 s3, s47, 0
    s_add_u32 m0, s48, 40960
    s_nop 0
    buffer_load_dwordx4 v222, s[24:27], s3 offen lds
    s_add_u32 s3, s47, 10240
    s_add_u32 m0, s48, 41984
    s_nop 0
    buffer_load_dwordx4 v222, s[24:27], s3 offen lds
    s_add_u32 s3, s47, 25600
    s_add_u32 m0, s48, 43008
    s_nop 0
    buffer_load_dwordx4 v222, s[24:27], s3 offen lds
    s_add_u32 s3, s47, 35840
    s_add_u32 m0, s48, 44032
    s_nop 0
    buffer_load_dwordx4 v222, s[24:27], s3 offen lds
    s_add_u32 s3, s47, 409600
    s_add_u32 m0, s48, 61440
    s_nop 0
    buffer_load_dwordx4 v222, s[24:27], s3 offen lds
    s_add_u32 s3, s47, 419840
    s_add_u32 m0, s48, 62464
    s_nop 0
    buffer_load_dwordx4 v222, s[24:27], s3 offen lds
    s_add_u32 s3, s47, 435200
    s_add_u32 m0, s48, 63488
    s_nop 0
    buffer_load_dwordx4 v222, s[24:27], s3 offen lds
    s_add_u32 s3, s47, 445440
    s_add_u32 m0, s48, 64512
    s_nop 0
    buffer_load_dwordx4 v222, s[24:27], s3 offen lds
    s_lshl_b32 s48, s43, 10
    s_add_u32 s3, s47, 20480
    s_add_u32 m0, s48, 57344
    s_nop 0
    buffer_load_dwordx4 v5, s[24:27], s3 offen lds
    s_add_u32 s3, s47, 430080
    s_add_u32 m0, s48, 77824
    s_nop 0
    buffer_load_dwordx4 v5, s[24:27], s3 offen lds
    s_branch K_P2_GM
K_NOLT:
    s_waitcnt vmcnt(0)
    s_barrier
    s_mov_b32 s33, 81920
    s_cmp_eq_u32 s43, 3
    s_cselect_b32 s3, 0, 163840
    buffer_store_dwordx4 v[224:227], v220, s[20:23], 0 offen sc1
    buffer_store_dwordx4 v[224:227], v220, s[20:23], s33 offen sc1
    buffer_store_dwordx4 v[224:227], v220, s[20:23], s3 offen sc1
    buffer_store_dwordx4 v[224:227], v221, s[20:23], 0 offen sc1
    v_mov_b32 v2, 158720
    v_mov_b32 v3, 1
    s_waitcnt vmcnt(0)
    s_mov_b64 exec, 1
    ds_add_u32 v2, v3 offset:28
    ds_add_u32 v2, v3 offset:32
    s_mov_b64 exec, -1
    s_branch K_END
K_CONS:
    v_and_b32 v1, 63, v0
    v_and_b32 v8, 15, v1
    v_lshrrev_b32 v9, 4, v1
    v_bfe_u32 v10, v1, 2, 2
    v_and_b32 v11, 3, v1
    s_bfe_u32 s54, s30, 0x10001
    s_and_b32 s55, s30, 1
    v_lshrrev_b32 v2, 1, v8
    v_xor_b32 v2, v2, v9
    v_lshlrev_b32 v2, 4, v2
    v_lshl_add_u32 v2, v8, 7, v2
    s_mul_i32 s3, s54, 12288
    v_add_u32 v39, s3, v2
    v_xor_b32 v40, 64, v39
    v_add_u32 v41, 81920, v39
    v_add_u32 v42, 81920, v40
    v_and_b32 v2, 1, v9
    v_lshl_or_b32 v2, v2, 2, v10
    s_mul_i32 s3, s55, 40
    v_lshl_add_u32 v2, v2, 5, s3
    v_lshl_add_u32 v3, v9, 3, v10
    v_lshlrev_b32 v3, 8, v3
    v_add_u32 v3, 24576, v3
    v_lshl_add_u32 v5, v11, 3, v2
    s_mul_i32 s33, s55, 805306368
    s_sub_u32 s33, 0xf870c020, s33
    v_add_u32 v4, 0, v5
    v_and_b32 v4, 255, v4
    v_add_u32 v43, v4, v3
    v_add_u32 v47, 81920, v43
    v_add_u32 v4, 160, v5
    v_and_b32 v4, 255, v4
    v_add_u32 v44, v4, v3
    v_add_u32 v48, 81920, v44
    v_add_u32 v4, 80, v5
    v_and_b32 v4, 255, v4
    v_add_u32 v45, v4, v3
    v_add_u32 v49, 81920, v45
    v_lshlrev_b32 v4, 3, v11
    v_bfe_u32 v4, s33, v4, 8
    v_add_u32 v4, v4, v2
    v_and_b32 v4, 255, v4
    v_add_u32 v46, v4, v3
    v_add_u32 v50, 81920, v46
    v_and_b32 v1, 63, v0
    v_mov_b32 v7, 0
    s_and_b32 s28, s2, 7
    s_lshr_b32 s29, s2, 3
    s_xor_b32 s30, s30, 4
    s_lshr_b32 s34, s29, 3
    s_lshl_b32 s34, s34, 2
    s_and_b32 s3, s29, 3
    s_add_u32 s34, s34, s3
    s_add_u32 s34, s34, 4
    s_bitcmp1_b32 s29, 2
    s_cselect_b32 s34, -1, s34
    s_cmp_lt_u32 s29, 8
    s_cselect_b32 s34, s29, s34
    s_lshl_b32 s40, s28, 1
    s_cmp_ge_u32 s34, 10
    s_addc_u32 s40, s40, 0
    s_sub_u32 s41, s34, 10
    s_cmp_ge_u32 s34, 10
    s_cselect_b32 s41, s41, s34
    s_mul_i32 s42, s28, 20
    s_add_u32 s42, s42, s34
    s_and_b32 s42, s42, 255
    s_lshl_b32 s42, s42, 9
    s_add_u32 s42, s42, 524288
    v_mov_b32 v3, 158736
    ds_write2_b32 v3, v7, v7 offset0:0 offset1:1
    ds_write2_b32 v3, v7, v7 offset0:2 offset1:3
    ds_write2_b32 v3, v7, v7 offset0:4 offset1:5
    ds_write2_b32 v3, v7, v7 offset0:6 offset1:7
    ds_write2_b32 v3, v7, v7 offset0:8 offset1:9
    ds_write2_b32 v3, v7, v7 offset0:10 offset1:11
    s_lshr_b32 s31, s28, 1
    s_mul_i32 s31, s31, 3
    s_lshr_b32 s3, s29, 3
    s_add_u32 s31, s31, s3
    s_sub_u32 s31, s31, 1
    s_and_b32 s32, s28, 1
    s_lshl_b32 s32, s32, 3
    s_and_b32 s3, s29, 7
    s_lshl_b32 s3, s3, 2
    s_lshr_b32 s3, 0x64317520, s3
    s_and_b32 s3, s3, 7
    s_add_u32 s32, s32, s3
    s_and_b32 s35, s29, 3
    s_and_b32 s3, s29, 4
    s_lshl_b32 s3, s3, 1
    s_add_u32 s35, s35, s3
    s_and_b32 s3, s28, 1
    s_lshl_b32 s3, s3, 2
    s_add_u32 s35, s35, s3
    s_or_b32 s56, s31, s54
    v_mov_b32 v37, 0xf149f2ca
    v_lshlrev_b32 v2, 2, v9
    v_sub_u32 v2, v8, v2
    s_cmp_eq_u32 s56, 0
    s_cselect_b32 s3, 0xf149f2ca, 0
    v_subrev_u32 v3, 0, v2
    v_and_b32 v4, 0x80000001, v3
    v_cmp_eq_u32 vcc, 0, v4
    s_nop 1
    v_cndmask_b32 v16, v37, 0, vcc
    v_cmp_eq_u32 vcc, 0x80000000, v4
    s_nop 1
    v_cndmask_b32 v12, v37, 0, vcc
    v_add_f32 v20, s3, v12
    v_subrev_u32 v3, 1, v2
    v_and_b32 v4, 0x80000001, v3
    v_cmp_eq_u32 vcc, 0, v4
    s_nop 1
    v_cndmask_b32 v17, v37, 0, vcc
    v_cmp_eq_u32 vcc, 0x80000000, v4
    s_nop 1
    v_cndmask_b32 v13, v37, 0, vcc
    v_add_f32 v21, s3, v13
    v_subrev_u32 v3, 2, v2
    v_and_b32 v4, 0x80000001, v3
    v_cmp_eq_u32 vcc, 0, v4
    s_nop 1
    v_cndmask_b32 v18, v37, 0, vcc
    v_cmp_eq_u32 vcc, 0x80000000, v4
    s_nop 1
    v_cndmask_b32 v14, v37, 0, vcc
    v_add_f32 v22, s3, v14
    v_subrev_u32 v3, 3, v2
    v_and_b32 v4, 0x80000001, v3
    v_cmp_eq_u32 vcc, 0, v4
    s_nop 1
    v_cndmask_b32 v19, v37, 0, vcc
    v_cmp_eq_u32 vcc, 0x80000000, v4
    s_nop 1
    v_cndmask_b32 v15, v37, 0, vcc
    v_add_f32 v23, s3, v15
    v_mov_b32 v3, 0x0c0c0c0c
    v_mov_b32 v4, 0xc0c0100
    v_cmp_eq_u32 vcc, 0, v12
    v_mov_b32 v5, 0x1000c0c
    s_nop 0
    v_cndmask_b32 v3, v3, v4, vcc
    v_cmp_eq_u32 vcc, 0, v13
    s_nop 1
    v_cndmask_b32 v24, v3, v5, vcc
    v_mov_b32 v3, 0x0c0c0c0c
    v_mov_b32 v4, 0xc0c0302
    v_cmp_eq_u32 vcc, 0, v14
    v_mov_b32 v5, 0x3020c0c
    s_nop 0
    v_cndmask_b32 v3, v3, v4, vcc
    v_cmp_eq_u32 vcc, 0, v15
    s_nop 1
    v_cndmask_b32 v25, v3, v5, vcc
    v_mov_b32 v3, 0x0c0c0c0c
    v_mov_b32 v4, 0xc0c0100
    v_cmp_eq_u32 vcc, 0, v16
    v_mov_b32 v5, 0x1000c0c
    s_nop 0
    v_cndmask_b32 v3, v3, v4, vcc
    v_cmp_eq_u32 vcc, 0, v17
    s_nop 1
    v_cndmask_b32 v26, v3, v5, vcc
    v_mov_b32 v3, 0x0c0c0c0c
    v_mov_b32 v4, 0xc0c0302
    v_cmp_eq_u32 vcc, 0, v18
    v_mov_b32 v5, 0x3020c0c
    s_nop 0
    v_cndmask_b32 v3, v3, v4, vcc
    v_cmp_eq_u32 vcc, 0, v19
    s_nop 1
    v_cndmask_b32 v27, v3, v5, vcc
    s_mul_i32 s3, s55, 1664
    s_mul_i32 s33, s54, 768
    s_add_u32 s3, s3, s33
    s_add_u32 s3, s3, 125952
    v_lshl_add_u32 v2, v9, 2, v10
    v_lshl_add_u32 v33, v2, 3, s3
    v_lshl_add_u32 v2, v8, 3, s3
    v_lshlrev_b32 v3, 3, v1
    v_add_u32 v3, 129280, v3
    v_cmp_eq_u32 vcc, 2, v9
    s_mul_i32 s3, s55, 1536
    s_add_u32 s3, s3, 122880
    v_cndmask_b32 v32, v3, v2, vcc
    v_lshl_add_u32 v34, v1, 3, s3
    s_mul_i32 s3, s54, 1536
    s_add_u32 s3, s3, 131328
    s_lshl3_add_u32 s33, s55, s3
    v_lshl_add_u32 v35, v8, 4, s33
    v_cmp_eq_u32 vcc, 0, v9
    s_nop 1
    v_cndmask_b32 v35, v3, v35, vcc
    s_mul_i32 s33, s55, 768
    s_add_u32 s3, s3, s33
    v_lshl_add_u32 v36, v1, 4, s3
    v_mov_b32 v38, 158720
    s_waitcnt lgkmcnt(0)
    s_add_u32 s20, s6, 0x100000
    s_addc_u32 s21, s7, 0
    s_mov_b32 s22, 0x280000
    s_mov_b32 s23, 0x20000
    s_lshr_b32 s53, s35, 2
    s_add_u32 s58, s53, s35
    s_lshl_b32 s58, s58, 12
    s_mul_i32 s59, s53, 19456
    s_lshl_b32 s53, s35, 8
    s_add_u32 s59, s59, s53
    s_add_u32 s59, s59, 16384
    s_mul_i32 s53, s31, 11
    s_mul_i32 s3, s54, 6
    s_add_u32 s53, s53, s3
    s_add_u32 s53, s53, 3
    s_lshl_b32 s3, s55, 9
    s_add_u32 s58, s58, s3
    v_and_b32 v4, 1, v9
    v_lshrrev_b32 v5, 1, v9
    v_add_u32 v3, s53, v4
    v_lshrrev_b32 v2, 2, v3
    v_mul_u32_u24 v2, 76, v2
    v_add_lshl_u32 v2, v2, v3, 10
    v_lshl_add_u32 v2, v8, 4, v2
    v_add_u32 v30, s58, v2
    v_lshl_add_u32 v30, v5, 8, v30
    v_subrev_u32 v3, 2, v3
    v_lshrrev_b32 v2, 2, v3
    v_mul_u32_u24 v2, 76, v2
    v_add_lshl_u32 v2, v2, v3, 10
    v_lshl_add_u32 v2, v8, 4, v2
    v_add_u32 v29, s58, v2
    v_lshl_add_u32 v29, v5, 8, v29
    v_or_b32 v4, s54, v4
    v_cmp_eq_u32 vcc, 0, v4
    v_mov_b32 v5, 0x10000000
    v_subrev_u32 v28, 81920, v30
    v_cndmask_b32 v28, v28, v5, vcc
    s_mul_i32 s3, s55, 3
    s_add_u32 s53, s53, s3
    v_add_u32 v3, s53, v9
    v_lshrrev_b32 v2, 2, v3
    v_mul_u32_u24 v2, 76, v2
    v_add_lshl_u32 v2, v2, v3, 10
    v_lshl_add_u32 v2, v8, 4, v2
    v_add_u32 v31, s59, v2
    v_subrev_u32 v31, 81920, v31
    v_or_b32 v4, s30, v9
    v_cmp_eq_u32 vcc, 0, v4
    s_nop 1
    v_cndmask_b32 v31, v31, v5, vcc
    v_cmp_eq_u32 vcc, 3, v9
    s_nop 1
    v_cndmask_b32 v31, v31, v5, vcc
    s_mul_i32 s3, s31, 11
    s_add_u32 s33, s3, 10
    s_lshr_b32 s3, s3, 3
    s_lshr_b32 s33, s33, 3
    s_min_u32 s33, s33, 15
    s_sub_u32 s33, s33, s3
    s_add_u32 s33, s33, 1
    s_mul_i32 s33, s33, 10
    s_bfm_b32 s37, s33, 0
    v_mul_u32_u24 v2, 205, v1
    v_lshrrev_b32 v2, 11, v2
    v_add_u32 v2, s3, v2
    v_mul_u32_u24 v2, 1496, v2
    v_lshrrev_b32 v2, 11, v2
    v_sub_u32 v2, s31, v2
    v_and_b32 v2, 1, v2
    v_lshlrev_b32 v2, 2, v2
    v_lshl_add_u32 v2, v1, 9, v2
    s_mul_i32 s3, s3, 5120
    s_add_u32 s3, s3, 524288
    v_add_u32 v37, s3, v2
    s_lshr_b32 s36, s35, 2
    s_add_u32 s36, s36, s35
    s_lshl_b32 s36, 1, s36
    s_cmp_eq_u32 s30, 0
    s_cselect_b32 s36, s36, 0
    s_mov_b32 s58, 0x3fb8aa3b
    s_mov_b32 s59, s58
    s_mov_b32 s60, 0x3e64f92e
    s_mov_b32 s61, s60
    s_cmp_eq_u32 s30, 0
    s_cbranch_scc1 K_CHM0
    s_cmp_eq_u32 s30, 1
    s_cbranch_scc1 K_CHM1
    s_cmp_eq_u32 s30, 2
    s_cbranch_scc1 K_CHM2
    s_branch K_CHM3
K_WRET_M:
    s_setprio 2
    s_barrier
K_L0:
    ds_read_b64_tr_b16 v[196:197], v47 offset:0
    ds_read_b64_tr_b16 v[198:199], v47 offset:1024
    ds_read_b128 v[148:151], v41 offset:0
    ds_read_b64_tr_b16 v[200:201], v48 offset:0
    ds_read_b64_tr_b16 v[202:203], v48 offset:1024
    ds_read_b128 v[152:155], v41 offset:2048
    ds_read_b64_tr_b16 v[204:205], v49 offset:0
    ds_read_b64_tr_b16 v[206:207], v49 offset:1024
    ds_read_b128 v[156:159], v41 offset:4096
    ds_read_b64_tr_b16 v[208:209], v50 offset:0
    ds_read_b64_tr_b16 v[210:211], v50 offset:1024
    ds_read_b128 v[160:163], v41 offset:6144
    ds_read_b128 v[164:167], v41 offset:8192
    ds_read_b128 v[168:171], v41 offset:10240
    s_waitcnt lgkmcnt(0)
    v_mfma_f32_16x16x32_bf16 v[52:55], v[196:199], v[148:151], 0
    ds_read_b64_tr_b16 v[212:213], v47 offset:8192
    v_mfma_f32_16x16x32_bf16 v[56:59], v[200:203], v[148:151], 0
    ds_read_b64_tr_b16 v[214:215], v47 offset:9216
    v_mfma_f32_16x16x32_bf16 v[60:63], v[148:151], v[204:207], 0
    ds_read_b128 v[172:175], v42 offset:0
    v_mfma_f32_16x16x32_bf16 v[64:67], v[208:211], v[148:151], 0
    ds_read_b64_tr_b16 v[216:217], v48 offset:8192
    v_mfma_f32_16x16x32_bf16 v[80:83], v[208:211], v[152:155], 0
    ds_read_b64_tr_b16 v[218:219], v48 offset:9216
    v_mfma_f32_16x16x32_bf16 v[76:79], v[152:155], v[204:207], 0
    ds_read_b128 v[176:179], v42 offset:2048
    v_mfma_f32_16x16x32_bf16 v[72:75], v[200:203], v[152:155], 0
    ds_read_b64_tr_b16 v[220:221], v49 offset:8192
    v_mfma_f32_16x16x32_bf16 v[68:71], v[196:199], v[152:155], 0
    ds_read_b64_tr_b16 v[222:223], v49 offset:9216
    v_mfma_f32_16x16x32_bf16 v[84:87], v[196:199], v[156:159], 0
    ds_read_b128 v[180:183], v42 offset:4096
    v_mfma_f32_16x16x32_bf16 v[88:91], v[200:203], v[156:159], 0
    ds_read_b64_tr_b16 v[224:225], v50 offset:8192
    v_mfma_f32_16x16x32_bf16 v[92:95], v[156:159], v[204:207], 0
    ds_read_b64_tr_b16 v[226:227], v50 offset:9216
    v_mfma_f32_16x16x32_bf16 v[96:99], v[208:211], v[156:159], 0
    ds_read_b128 v[184:187], v42 offset:6144
    v_mfma_f32_16x16x32_bf16 v[112:115], v[208:211], v[160:163], 0
    ds_read_b128 v[188:191], v42 offset:8192
    v_mfma_f32_16x16x32_bf16 v[108:111], v[160:163], v[204:207], 0
    ds_read_b128 v[192:195], v42 offset:10240
    v_mfma_f32_16x16x32_bf16 v[104:107], v[200:203], v[160:163], 0
    v_mfma_f32_16x16x32_bf16 v[100:103], v[196:199], v[160:163], 0
    v_mfma_f32_16x16x32_bf16 v[116:119], v[196:199], v[164:167], 0
    v_mfma_f32_16x16x32_bf16 v[120:123], v[200:203], v[164:167], 0
    v_mfma_f32_16x16x32_bf16 v[124:127], v[164:167], v[204:207], 0
    v_mfma_f32_16x16x32_bf16 v[128:131], v[208:211], v[164:167], 0
    v_mfma_f32_16x16x32_bf16 v[144:147], v[208:211], v[168:171], 0
    v_mfma_f32_16x16x32_bf16 v[140:143], v[168:171], v[204:207], 0
    v_mfma_f32_16x16x32_bf16 v[136:139], v[200:203], v[168:171], 0
    v_mfma_f32_16x16x32_bf16 v[132:135], v[196:199], v[168:171], 0
    s_waitcnt lgkmcnt(0)
    s_barrier
    v_mfma_f32_16x16x32_bf16 v[52:55], v[212:215], v[172:175], v[52:55]
    ds_read_b64_tr_b16 v[196:197], v43 offset:0
    v_mfma_f32_16x16x32_bf16 v[56:59], v[216:219], v[172:175], v[56:59]
    ds_read_b64_tr_b16 v[198:199], v43 offset:1024
    v_mfma_f32_16x16x32_bf16 v[60:63], v[172:175], v[220:223], v[60:63]
    ds_read_b128 v[148:151], v39 offset:0
    v_mfma_f32_16x16x32_bf16 v[64:67], v[224:227], v[172:175], v[64:67]
    ds_read_b64_tr_b16 v[200:201], v44 offset:0
    v_mfma_f32_16x16x32_bf16 v[80:83], v[224:227], v[176:179], v[80:83]
    ds_read_b64_tr_b16 v[202:203], v44 offset:1024
    v_mfma_f32_16x16x32_bf16 v[76:79], v[176:179], v[220:223], v[76:79]
    ds_read_b128 v[152:155], v39 offset:2048
    v_mfma_f32_16x16x32_bf16 v[72:75], v[216:219], v[176:179], v[72:75]
    ds_read_b64_tr_b16 v[204:205], v45 offset:0
    v_mfma_f32_16x16x32_bf16 v[68:71], v[212:215], v[176:179], v[68:71]
    ds_read_b64_tr_b16 v[206:207], v45 offset:1024
    v_mfma_f32_16x16x32_bf16 v[84:87], v[212:215], v[180:183], v[84:87]
    ds_read_b128 v[156:159], v39 offset:4096
    v_mfma_f32_16x16x32_bf16 v[88:91], v[216:219], v[180:183], v[88:91]
    ds_read_b64_tr_b16 v[208:209], v46 offset:0
    v_mfma_f32_16x16x32_bf16 v[92:95], v[180:183], v[220:223], v[92:95]
    ds_read_b64_tr_b16 v[210:211], v46 offset:1024
    v_mfma_f32_16x16x32_bf16 v[96:99], v[224:227], v[180:183], v[96:99]
    ds_read_b128 v[160:163], v39 offset:6144
    v_mfma_f32_16x16x32_bf16 v[112:115], v[224:227], v[184:187], v[112:115]
    ds_read_b128 v[164:167], v39 offset:8192
    v_mfma_f32_16x16x32_bf16 v[108:111], v[184:187], v[220:223], v[108:111]
    ds_read_b128 v[168:171], v39 offset:10240
    v_mfma_f32_16x16x32_bf16 v[104:107], v[216:219], v[184:187], v[104:107]
    v_mfma_f32_16x16x32_bf16 v[100:103], v[212:215], v[184:187], v[100:103]
    v_mfma_f32_16x16x32_bf16 v[116:119], v[212:215], v[188:191], v[116:119]
    v_mfma_f32_16x16x32_bf16 v[120:123], v[216:219], v[188:191], v[120:123]
    v_mfma_f32_16x16x32_bf16 v[124:127], v[188:191], v[220:223], v[124:127]
    v_mfma_f32_16x16x32_bf16 v[128:131], v[224:227], v[188:191], v[128:131]
    v_mfma_f32_16x16x32_bf16 v[144:147], v[224:227], v[192:195], v[144:147]
    v_mfma_f32_16x16x32_bf16 v[140:143], v[192:195], v[220:223], v[140:143]
    v_mfma_f32_16x16x32_bf16 v[136:139], v[216:219], v[192:195], v[136:139]
    v_mfma_f32_16x16x32_bf16 v[132:135], v[212:215], v[192:195], v[132:135]
    s_waitcnt lgkmcnt(0)
    v_mfma_f32_16x16x32_bf16 v[52:55], v[196:199], v[148:151], v[52:55]
    ds_read_b64_tr_b16 v[212:213], v43 offset:8192
    v_mfma_f32_16x16x32_bf16 v[56:59], v[200:203], v[148:151], v[56:59]
    ds_read_b64_tr_b16 v[214:215], v43 offset:9216
    v_mfma_f32_16x16x32_bf16 v[60:63], v[148:151], v[204:207], v[60:63]
    ds_read_b128 v[172:175], v40 offset:0
    v_mfma_f32_16x16x32_bf16 v[64:67], v[208:211], v[148:151], v[64:67]
    ds_read_b64_tr_b16 v[216:217], v44 offset:8192
    v_mfma_f32_16x16x32_bf16 v[80:83], v[208:211], v[152:155], v[80:83]
    ds_read_b64_tr_b16 v[218:219], v44 offset:9216
    v_mfma_f32_16x16x32_bf16 v[76:79], v[152:155], v[204:207], v[76:79]
    ds_read_b128 v[176:179], v40 offset:2048
    v_mfma_f32_16x16x32_bf16 v[72:75], v[200:203], v[152:155], v[72:75]
    ds_read_b64_tr_b16 v[220:221], v45 offset:8192
    v_mfma_f32_16x16x32_bf16 v[68:71], v[196:199], v[152:155], v[68:71]
    ds_read_b64_tr_b16 v[222:223], v45 offset:9216
    v_mfma_f32_16x16x32_bf16 v[84:87], v[196:199], v[156:159], v[84:87]
    ds_read_b128 v[180:183], v40 offset:4096
    v_mfma_f32_16x16x32_bf16 v[88:91], v[200:203], v[156:159], v[88:91]
    ds_read_b64_tr_b16 v[224:225], v46 offset:8192
    v_mfma_f32_16x16x32_bf16 v[92:95], v[156:159], v[204:207], v[92:95]
    ds_read_b64_tr_b16 v[226:227], v46 offset:9216
    v_mfma_f32_16x16x32_bf16 v[96:99], v[208:211], v[156:159], v[96:99]
    ds_read_b128 v[184:187], v40 offset:6144
    v_mfma_f32_16x16x32_bf16 v[112:115], v[208:211], v[160:163], v[112:115]
    ds_read_b128 v[188:191], v40 offset:8192
    v_mfma_f32_16x16x32_bf16 v[108:111], v[160:163], v[204:207], v[108:111]
    ds_read_b128 v[192:195], v40 offset:10240
    s_branch K_PG1
.p2align 12
K_CHM1:
K_STM1:
    s_branch K_WRET_M
    s_nop 0
K_PG1:
    v_mfma_f32_16x16x32_bf16 v[104:107], v[200:203], v[160:163], v[104:107]
    v_mfma_f32_16x16x32_bf16 v[100:103], v[196:199], v[160:163], v[100:103]
    v_mfma_f32_16x16x32_bf16 v[116:119], v[196:199], v[164:167], v[116:119]
    v_mfma_f32_16x16x32_bf16 v[120:123], v[200:203], v[164:167], v[120:123]
    v_mfma_f32_16x16x32_bf16 v[124:127], v[164:167], v[204:207], v[124:127]
    v_mfma_f32_16x16x32_bf16 v[128:131], v[208:211], v[164:167], v[128:131]
    v_mfma_f32_16x16x32_bf16 v[144:147], v[208:211], v[168:171], v[144:147]
    v_mfma_f32_16x16x32_bf16 v[140:143], v[168:171], v[204:207], v[140:143]
    v_mfma_f32_16x16x32_bf16 v[136:139], v[200:203], v[168:171], v[136:139]
    v_mfma_f32_16x16x32_bf16 v[132:135], v[196:199], v[168:171], v[132:135]
    s_waitcnt lgkmcnt(0)
    s_barrier
    v_mfma_f32_16x16x32_bf16 v[52:55], v[212:215], v[172:175], v[52:55]
    ds_read_b64_tr_b16 v[196:197], v43 offset:40960
    v_mfma_f32_16x16x32_bf16 v[56:59], v[216:219], v[172:175], v[56:59]
    ds_read_b64_tr_b16 v[198:199], v43 offset:41984
    v_mfma_f32_16x16x32_bf16 v[60:63], v[172:175], v[220:223], v[60:63]
    ds_read_b128 v[148:151], v39 offset:40960
    v_mfma_f32_16x16x32_bf16 v[64:67], v[224:227], v[172:175], v[64:67]
    ds_read_b64_tr_b16 v[200:201], v44 offset:40960
    v_mfma_f32_16x16x32_bf16 v[80:83], v[224:227], v[176:179], v[80:83]
    ds_read_b64_tr_b16 v[202:203], v44 offset:41984
    v_mfma_f32_16x16x32_bf16 v[76:79], v[176:179], v[220:223], v[76:79]
    ds_read_b128 v[152:155], v39 offset:43008
    v_mfma_f32_16x16x32_bf16 v[72:75], v[216:219], v[176:179], v[72:75]
    ds_read_b64_tr_b16 v[204:205], v45 offset:40960
    v_mfma_f32_16x16x32_bf16 v[68:71], v[212:215], v[176:179], v[68:71]
    ds_read_b64_tr_b16 v[206:207], v45 offset:41984
    v_mfma_f32_16x16x32_bf16 v[84:87], v[212:215], v[180:183], v[84:87]
    ds_read_b128 v[156:159], v39 offset:45056
    v_mfma_f32_16x16x32_bf16 v[88:91], v[216:219], v[180:183], v[88:91]
    ds_read_b64_tr_b16 v[208:209], v46 offset:40960
    v_mfma_f32_16x16x32_bf16 v[92:95], v[180:183], v[220:223], v[92:95]
    ds_read_b64_tr_b16 v[210:211], v46 offset:41984
    v_mfma_f32_16x16x32_bf16 v[96:99], v[224:227], v[180:183], v[96:99]
    ds_read_b128 v[160:163], v39 offset:47104
    v_mfma_f32_16x16x32_bf16 v[112:115], v[224:227], v[184:187], v[112:115]
    ds_read_b128 v[164:167], v39 offset:49152
    v_mfma_f32_16x16x32_bf16 v[108:111], v[184:187], v[220:223], v[108:111]
    ds_read_b128 v[168:171], v39 offset:51200
    v_mfma_f32_16x16x32_bf16 v[104:107], v[216:219], v[184:187], v[104:107]
    v_mfma_f32_16x16x32_bf16 v[100:103], v[212:215], v[184:187], v[100:103]
    v_mfma_f32_16x16x32_bf16 v[116:119], v[212:215], v[188:191], v[116:119]
    v_mfma_f32_16x16x32_bf16 v[120:123], v[216:219], v[188:191], v[120:123]
    v_mfma_f32_16x16x32_bf16 v[124:127], v[188:191], v[220:223], v[124:127]
    v_mfma_f32_16x16x32_bf16 v[128:131], v[224:227], v[188:191], v[128:131]
    v_mfma_f32_16x16x32_bf16 v[144:147], v[224:227], v[192:195], v[144:147]
    v_mfma_f32_16x16x32_bf16 v[140:143], v[192:195], v[220:223], v[140:143]
    v_mfma_f32_16x16x32_bf16 v[136:139], v[216:219], v[192:195], v[136:139]
    v_mfma_f32_16x16x32_bf16 v[132:135], v[212:215], v[192:195], v[132:135]
    s_waitcnt lgkmcnt(0)
    v_mfma_f32_16x16x32_bf16 v[52:55], v[196:199], v[148:151], v[52:55]
    ds_read_b64_tr_b16 v[212:213], v43 offset:49152
    v_mfma_f32_16x16x32_bf16 v[56:59], v[200:203], v[148:151], v[56:59]
    ds_read_b64_tr_b16 v[214:215], v43 offset:50176
    v_mfma_f32_16x16x32_bf16 v[60:63], v[148:151], v[204:207], v[60:63]
    ds_read_b128 v[172:175], v40 offset:40960
    v_mfma_f32_16x16x32_bf16 v[64:67], v[208:211], v[148:151], v[64:67]
    ds_read_b64_tr_b16 v[216:217], v44 offset:49152
    v_mfma_f32_16x16x32_bf16 v[80:83], v[208:211], v[152:155], v[80:83]
    ds_read_b64_tr_b16 v[218:219], v44 offset:50176
    v_mfma_f32_16x16x32_bf16 v[76:79], v[152:155], v[204:207], v[76:79]
    ds_read_b128 v[176:179], v40 offset:43008
    v_mfma_f32_16x16x32_bf16 v[72:75], v[200:203], v[152:155], v[72:75]
    ds_read_b64_tr_b16 v[220:221], v45 offset:49152
    v_mfma_f32_16x16x32_bf16 v[68:71], v[196:199], v[152:155], v[68:71]
    ds_read_b64_tr_b16 v[222:223], v45 offset:50176
    v_mfma_f32_16x16x32_bf16 v[84:87], v[196:199], v[156:159], v[84:87]
    ds_read_b128 v[180:183], v40 offset:45056
    v_mfma_f32_16x16x32_bf16 v[88:91], v[200:203], v[156:159], v[88:91]
    ds_read_b64_tr_b16 v[224:225], v46 offset:49152
    v_mfma_f32_16x16x32_bf16 v[92:95], v[156:159], v[204:207], v[92:95]
    ds_read_b64_tr_b16 v[226:227], v46 offset:50176
    v_mfma_f32_16x16x32_bf16 v[96:99], v[208:211], v[156:159], v[96:99]
    ds_read_b128 v[184:187], v40 offset:47104
    v_mfma_f32_16x16x32_bf16 v[112:115], v[208:211], v[160:163], v[112:115]
    ds_read_b128 v[188:191], v40 offset:49152
    v_mfma_f32_16x16x32_bf16 v[108:111], v[160:163], v[204:207], v[108:111]
    ds_read_b128 v[192:195], v40 offset:51200
    v_mfma_f32_16x16x32_bf16 v[104:107], v[200:203], v[160:163], v[104:107]
    v_mfma_f32_16x16x32_bf16 v[100:103], v[196:199], v[160:163], v[100:103]
    v_mfma_f32_16x16x32_bf16 v[116:119], v[196:199], v[164:167], v[116:119]
    v_mfma_f32_16x16x32_bf16 v[120:123], v[200:203], v[164:167], v[120:123]
    v_mfma_f32_16x16x32_bf16 v[124:127], v[164:167], v[204:207], v[124:127]
    v_mfma_f32_16x16x32_bf16 v[128:131], v[208:211], v[164:167], v[128:131]
    v_mfma_f32_16x16x32_bf16 v[144:147], v[208:211], v[168:171], v[144:147]
    v_mfma_f32_16x16x32_bf16 v[140:143], v[168:171], v[204:207], v[140:143]
    v_mfma_f32_16x16x32_bf16 v[136:139], v[200:203], v[168:171], v[136:139]
    v_mfma_f32_16x16x32_bf16 v[132:135], v[196:199], v[168:171], v[132:135]
    s_waitcnt lgkmcnt(0)
    s_barrier
    v_mfma_f32_16x16x32_bf16 v[52:55], v[212:215], v[172:175], v[52:55]
    ds_read_b64_tr_b16 v[196:197], v47 offset:0
    v_mfma_f32_16x16x32_bf16 v[56:59], v[216:219], v[172:175], v[56:59]
    ds_read_b64_tr_b16 v[198:199], v47 offset:1024
    v_mfma_f32_16x16x32_bf16 v[60:63], v[172:175], v[220:223], v[60:63]
    ds_read_b128 v[148:151], v41 offset:0
    v_mfma_f32_16x16x32_bf16 v[64:67], v[224:227], v[172:175], v[64:67]
    ds_read_b64_tr_b16 v[200:201], v48 offset:0
    v_mfma_f32_16x16x32_bf16 v[80:83], v[224:227], v[176:179], v[80:83]
    ds_read_b64_tr_b16 v[202:203], v48 offset:1024
    v_mfma_f32_16x16x32_bf16 v[76:79], v[176:179], v[220:223], v[76:79]
    ds_read_b128 v[152:155], v41 offset:2048
    v_mfma_f32_16x16x32_bf16 v[72:75], v[216:219], v[176:179], v[72:75]
    ds_read_b64_tr_b16 v[204:205], v49 offset:0
    v_mfma_f32_16x16x32_bf16 v[68:71], v[212:215], v[176:179], v[68:71]
    ds_read_b64_tr_b16 v[206:207], v49 offset:1024
    v_mfma_f32_16x16x32_bf16 v[84:87], v[212:215], v[180:183], v[84:87]
    ds_read_b128 v[156:159], v41 offset:4096
    v_mfma_f32_16x16x32_bf16 v[88:91], v[216:219], v[180:183], v[88:91]
    ds_read_b64_tr_b16 v[208:209], v50 offset:0
    v_mfma_f32_16x16x32_bf16 v[92:95], v[180:183], v[220:223], v[92:95]
    ds_read_b64_tr_b16 v[210:211], v50 offset:1024
    v_mfma_f32_16x16x32_bf16 v[96:99], v[224:227], v[180:183], v[96:99]
    ds_read_b128 v[160:163], v41 offset:6144
    v_mfma_f32_16x16x32_bf16 v[112:115], v[224:227], v[184:187], v[112:115]
    ds_read_b128 v[164:167], v41 offset:8192
    v_mfma_f32_16x16x32_bf16 v[108:111], v[184:187], v[220:223], v[108:111]
    ds_read_b128 v[168:171], v41 offset:10240
    v_mfma_f32_16x16x32_bf16 v[104:107], v[216:219], v[184:187], v[104:107]
    v_mfma_f32_16x16x32_bf16 v[100:103], v[212:215], v[184:187], v[100:103]
    v_mfma_f32_16x16x32_bf16 v[116:119], v[212:215], v[188:191], v[116:119]
    v_mfma_f32_16x16x32_bf16 v[120:123], v[216:219], v[188:191], v[120:123]
    v_mfma_f32_16x16x32_bf16 v[124:127], v[188:191], v[220:223], v[124:127]
    v_mfma_f32_16x16x32_bf16 v[128:131], v[224:227], v[188:191], v[128:131]
    v_mfma_f32_16x16x32_bf16 v[144:147], v[224:227], v[192:195], v[144:147]
    v_mfma_f32_16x16x32_bf16 v[140:143], v[192:195], v[220:223], v[140:143]
    v_mfma_f32_16x16x32_bf16 v[136:139], v[216:219], v[192:195], v[136:139]
    v_mfma_f32_16x16x32_bf16 v[132:135], v[212:215], v[192:195], v[132:135]
    s_waitcnt lgkmcnt(0)
    v_mfma_f32_16x16x32_bf16 v[52:55], v[196:199], v[148:151], v[52:55]
    ds_read_b64_tr_b16 v[212:213], v47 offset:8192
    v_mfma_f32_16x16x32_bf16 v[56:59], v[200:203], v[148:151], v[56:59]
    ds_read_b64_tr_b16 v[214:215], v47 offset:9216
    v_mfma_f32_16x16x32_bf16 v[60:63], v[148:151], v[204:207], v[60:63]
    ds_read_b128 v[172:175], v42 offset:0
    v_mfma_f32_16x16x32_bf16 v[64:67], v[208:211], v[148:151], v[64:67]
    ds_read_b64_tr_b16 v[216:217], v48 offset:8192
    v_mfma_f32_16x16x32_bf16 v[80:83], v[208:211], v[152:155], v[80:83]
    ds_read_b64_tr_b16 v[218:219], v48 offset:9216
    v_mfma_f32_16x16x32_bf16 v[76:79], v[152:155], v[204:207], v[76:79]
    ds_read_b128 v[176:179], v42 offset:2048
    v_mfma_f32_16x16x32_bf16 v[72:75], v[200:203], v[152:155], v[72:75]
    ds_read_b64_tr_b16 v[220:221], v49 offset:8192
    v_mfma_f32_16x16x32_bf16 v[68:71], v[196:199], v[152:155], v[68:71]
    ds_read_b64_tr_b16 v[222:223], v49 offset:9216
    v_mfma_f32_16x16x32_bf16 v[84:87], v[196:199], v[156:159], v[84:87]
    ds_read_b128 v[180:183], v42 offset:4096
    v_mfma_f32_16x16x32_bf16 v[88:91], v[200:203], v[156:159], v[88:91]
    ds_read_b64_tr_b16 v[224:225], v50 offset:8192
    v_mfma_f32_16x16x32_bf16 v[92:95], v[156:159], v[204:207], v[92:95]
    ds_read_b64_tr_b16 v[226:227], v50 offset:9216
    v_mfma_f32_16x16x32_bf16 v[96:99], v[208:211], v[156:159], v[96:99]
    ds_read_b128 v[184:187], v42 offset:6144
    v_mfma_f32_16x16x32_bf16 v[112:115], v[208:211], v[160:163], v[112:115]
    ds_read_b128 v[188:191], v42 offset:8192
    v_mfma_f32_16x16x32_bf16 v[108:111], v[160:163], v[204:207], v[108:111]
    ds_read_b128 v[192:195], v42 offset:10240
    v_mfma_f32_16x16x32_bf16 v[104:107], v[200:203], v[160:163], v[104:107]
    v_mfma_f32_16x16x32_bf16 v[100:103], v[196:199], v[160:163], v[100:103]
    v_mfma_f32_16x16x32_bf16 v[116:119], v[196:199], v[164:167], v[116:119]
    v_mfma_f32_16x16x32_bf16 v[120:123], v[200:203], v[164:167], v[120:123]
    v_mfma_f32_16x16x32_bf16 v[124:127], v[164:167], v[204:207], v[124:127]
    v_mfma_f32_16x16x32_bf16 v[128:131], v[208:211], v[164:167], v[128:131]
    v_mfma_f32_16x16x32_bf16 v[144:147], v[208:211], v[168:171], v[144:147]
    v_mfma_f32_16x16x32_bf16 v[140:143], v[168:171], v[204:207], v[140:143]
    v_mfma_f32_16x16x32_bf16 v[136:139], v[200:203], v[168:171], v[136:139]
    v_mfma_f32_16x16x32_bf16 v[132:135], v[196:199], v[168:171], v[132:135]
    s_waitcnt lgkmcnt(0)
    s_barrier
    v_mfma_f32_16x16x32_bf16 v[52:55], v[212:215], v[172:175], v[52:55]
    ds_read_b64_tr_b16 v[196:197], v43 offset:0
    v_mfma_f32_16x16x32_bf16 v[56:59], v[216:219], v[172:175], v[56:59]
    ds_read_b64_tr_b16 v[198:199], v43 offset:1024
    v_mfma_f32_16x16x32_bf16 v[60:63], v[172:175], v[220:223], v[60:63]
    ds_read_b128 v[148:151], v39 offset:0
    v_mfma_f32_16x16x32_bf16 v[64:67], v[224:227], v[172:175], v[64:67]
    ds_read_b64_tr_b16 v[200:201], v44 offset:0
    v_mfma_f32_16x16x32_bf16 v[80:83], v[224:227], v[176:179], v[80:83]
    ds_read_b64_tr_b16 v[202:203], v44 offset:1024
    v_mfma_f32_16x16x32_bf16 v[76:79], v[176:179], v[220:223], v[76:79]
    ds_read_b128 v[152:155], v39 offset:2048
    v_mfma_f32_16x16x32_bf16 v[72:75], v[216:219], v[176:179], v[72:75]
    ds_read_b64_tr_b16 v[204:205], v45 offset:0
    v_mfma_f32_16x16x32_bf16 v[68:71], v[212:215], v[176:179], v[68:71]
    ds_read_b64_tr_b16 v[206:207], v45 offset:1024
    v_mfma_f32_16x16x32_bf16 v[84:87], v[212:215], v[180:183], v[84:87]
    ds_read_b128 v[156:159], v39 offset:4096
    v_mfma_f32_16x16x32_bf16 v[88:91], v[216:219], v[180:183], v[88:91]
    ds_read_b64_tr_b16 v[208:209], v46 offset:0
    v_mfma_f32_16x16x32_bf16 v[92:95], v[180:183], v[220:223], v[92:95]
    ds_read_b64_tr_b16 v[210:211], v46 offset:1024
    v_mfma_f32_16x16x32_bf16 v[96:99], v[224:227], v[180:183], v[96:99]
    ds_read_b128 v[160:163], v39 offset:6144
    v_mfma_f32_16x16x32_bf16 v[112:115], v[224:227], v[184:187], v[112:115]
    ds_read_b128 v[164:167], v39 offset:8192
    v_mfma_f32_16x16x32_bf16 v[108:111], v[184:187], v[220:223], v[108:111]
    ds_read_b128 v[168:171], v39 offset:10240
    v_mfma_f32_16x16x32_bf16 v[104:107], v[216:219], v[184:187], v[104:107]
    v_mfma_f32_16x16x32_bf16 v[100:103], v[212:215], v[184:187], v[100:103]
    v_mfma_f32_16x16x32_bf16 v[116:119], v[212:215], v[188:191], v[116:119]
    v_mfma_f32_16x16x32_bf16 v[120:123], v[216:219], v[188:191], v[120:123]
    v_mfma_f32_16x16x32_bf16 v[124:127], v[188:191], v[220:223], v[124:127]
    v_mfma_f32_16x16x32_bf16 v[128:131], v[224:227], v[188:191], v[128:131]
    v_mfma_f32_16x16x32_bf16 v[144:147], v[224:227], v[192:195], v[144:147]
    v_mfma_f32_16x16x32_bf16 v[140:143], v[192:195], v[220:223], v[140:143]
    v_mfma_f32_16x16x32_bf16 v[136:139], v[216:219], v[192:195], v[136:139]
    v_mfma_f32_16x16x32_bf16 v[132:135], v[212:215], v[192:195], v[132:135]
    s_waitcnt lgkmcnt(0)
    v_mfma_f32_16x16x32_bf16 v[52:55], v[196:199], v[148:151], v[52:55]
    ds_read_b64_tr_b16 v[212:213], v43 offset:8192
    v_mfma_f32_16x16x32_bf16 v[56:59], v[200:203], v[148:151], v[56:59]
    ds_read_b64_tr_b16 v[214:215], v43 offset:9216
    v_mfma_f32_16x16x32_bf16 v[60:63], v[148:151], v[204:207], v[60:63]
    ds_read_b128 v[172:175], v40 offset:0
    v_mfma_f32_16x16x32_bf16 v[64:67], v[208:211], v[148:151], v[64:67]
    ds_read_b64_tr_b16 v[216:217], v44 offset:8192
    v_mfma_f32_16x16x32_bf16 v[80:83], v[208:211], v[152:155], v[80:83]
    ds_read_b64_tr_b16 v[218:219], v44 offset:9216
    v_mfma_f32_16x16x32_bf16 v[76:79], v[152:155], v[204:207], v[76:79]
    ds_read_b128 v[176:179], v40 offset:2048
    v_mfma_f32_16x16x32_bf16 v[72:75], v[200:203], v[152:155], v[72:75]
    ds_read_b64_tr_b16 v[220:221], v45 offset:8192
    v_mfma_f32_16x16x32_bf16 v[68:71], v[196:199], v[152:155], v[68:71]
    ds_read_b64_tr_b16 v[222:223], v45 offset:9216
    v_mfma_f32_16x16x32_bf16 v[84:87], v[196:199], v[156:159], v[84:87]
    ds_read_b128 v[180:183], v40 offset:4096
    v_mfma_f32_16x16x32_bf16 v[88:91], v[200:203], v[156:159], v[88:91]
    ds_read_b64_tr_b16 v[224:225], v46 offset:8192
    v_mfma_f32_16x16x32_bf16 v[92:95], v[156:159], v[204:207], v[92:95]
    ds_read_b64_tr_b16 v[226:227], v46 offset:9216
    v_mfma_f32_16x16x32_bf16 v[96:99], v[208:211], v[156:159], v[96:99]
    ds_read_b128 v[184:187], v40 offset:6144
    v_mfma_f32_16x16x32_bf16 v[112:115], v[208:211], v[160:163], v[112:115]
    ds_read_b128 v[188:191], v40 offset:8192
    v_mfma_f32_16x16x32_bf16 v[108:111], v[160:163], v[204:207], v[108:111]
    ds_read_b128 v[192:195], v40 offset:10240
    v_mfma_f32_16x16x32_bf16 v[104:107], v[200:203], v[160:163], v[104:107]
    v_mfma_f32_16x16x32_bf16 v[100:103], v[196:199], v[160:163], v[100:103]
    v_mfma_f32_16x16x32_bf16 v[116:119], v[196:199], v[164:167], v[116:119]
    v_mfma_f32_16x16x32_bf16 v[120:123], v[200:203], v[164:167], v[120:123]
    v_mfma_f32_16x16x32_bf16 v[124:127], v[164:167], v[204:207], v[124:127]
    v_mfma_f32_16x16x32_bf16 v[128:131], v[208:211], v[164:167], v[128:131]
    v_mfma_f32_16x16x32_bf16 v[144:147], v[208:211], v[168:171], v[144:147]
    v_mfma_f32_16x16x32_bf16 v[140:143], v[168:171], v[204:207], v[140:143]
    v_mfma_f32_16x16x32_bf16 v[136:139], v[200:203], v[168:171], v[136:139]
    v_mfma_f32_16x16x32_bf16 v[132:135], v[196:199], v[168:171], v[132:135]
    s_waitcnt lgkmcnt(0)
    s_barrier
    v_mfma_f32_16x16x32_bf16 v[52:55], v[212:215], v[172:175], v[52:55]
    ds_read_b64_tr_b16 v[196:197], v43 offset:40960
    v_mfma_f32_16x16x32_bf16 v[56:59], v[216:219], v[172:175], v[56:59]
    ds_read_b64_tr_b16 v[198:199], v43 offset:41984
    v_mfma_f32_16x16x32_bf16 v[60:63], v[172:175], v[220:223], v[60:63]
    ds_read_b128 v[148:151], v39 offset:40960
    v_mfma_f32_16x16x32_bf16 v[64:67], v[224:227], v[172:175], v[64:67]
    ds_read_b64_tr_b16 v[200:201], v44 offset:40960
    v_mfma_f32_16x16x32_bf16 v[80:83], v[224:227], v[176:179], v[80:83]
    ds_read_b64_tr_b16 v[202:203], v44 offset:41984
    v_mfma_f32_16x16x32_bf16 v[76:79], v[176:179], v[220:223], v[76:79]
    ds_read_b128 v[152:155], v39 offset:43008
    v_mfma_f32_16x16x32_bf16 v[72:75], v[216:219], v[176:179], v[72:75]
    ds_read_b64_tr_b16 v[204:205], v45 offset:40960
    v_mfma_f32_16x16x32_bf16 v[68:71], v[212:215], v[176:179], v[68:71]
    ds_read_b64_tr_b16 v[206:207], v45 offset:41984
    v_mfma_f32_16x16x32_bf16 v[84:87], v[212:215], v[180:183], v[84:87]
    ds_read_b128 v[156:159], v39 offset:45056
    v_mfma_f32_16x16x32_bf16 v[88:91], v[216:219], v[180:183], v[88:91]
    ds_read_b64_tr_b16 v[208:209], v46 offset:40960
    v_mfma_f32_16x16x32_bf16 v[92:95], v[180:183], v[220:223], v[92:95]
    ds_read_b64_tr_b16 v[210:211], v46 offset:41984
    v_mfma_f32_16x16x32_bf16 v[96:99], v[224:227], v[180:183], v[96:99]
    ds_read_b128 v[160:163], v39 offset:47104
    v_mfma_f32_16x16x32_bf16 v[112:115], v[224:227], v[184:187], v[112:115]
    ds_read_b128 v[164:167], v39 offset:49152
    v_mfma_f32_16x16x32_bf16 v[108:111], v[184:187], v[220:223], v[108:111]
    ds_read_b128 v[168:171], v39 offset:51200
    v_mfma_f32_16x16x32_bf16 v[104:107], v[216:219], v[184:187], v[104:107]
    v_mfma_f32_16x16x32_bf16 v[100:103], v[212:215], v[184:187], v[100:103]
    v_mfma_f32_16x16x32_bf16 v[116:119], v[212:215], v[188:191], v[116:119]
    v_mfma_f32_16x16x32_bf16 v[120:123], v[216:219], v[188:191], v[120:123]
    v_mfma_f32_16x16x32_bf16 v[124:127], v[188:191], v[220:223], v[124:127]
    v_mfma_f32_16x16x32_bf16 v[128:131], v[224:227], v[188:191], v[128:131]
    v_mfma_f32_16x16x32_bf16 v[144:147], v[224:227], v[192:195], v[144:147]
    v_mfma_f32_16x16x32_bf16 v[140:143], v[192:195], v[220:223], v[140:143]
    v_mfma_f32_16x16x32_bf16 v[136:139], v[216:219], v[192:195], v[136:139]
    v_mfma_f32_16x16x32_bf16 v[132:135], v[212:215], v[192:195], v[132:135]
    s_waitcnt lgkmcnt(0)
    v_mfma_f32_16x16x32_bf16 v[52:55], v[196:199], v[148:151], v[52:55]
    ds_read_b64_tr_b16 v[212:213], v43 offset:49152
    v_mfma_f32_16x16x32_bf16 v[56:59], v[200:203], v[148:151], v[56:59]
    ds_read_b64_tr_b16 v[214:215], v43 offset:50176
    v_mfma_f32_16x16x32_bf16 v[60:63], v[148:151], v[204:207], v[60:63]
    ds_read_b128 v[172:175], v40 offset:40960
    v_mfma_f32_16x16x32_bf16 v[64:67], v[208:211], v[148:151], v[64:67]
    ds_read_b64_tr_b16 v[216:217], v44 offset:49152
    v_mfma_f32_16x16x32_bf16 v[80:83], v[208:211], v[152:155], v[80:83]
    ds_read_b64_tr_b16 v[218:219], v44 offset:50176
    v_mfma_f32_16x16x32_bf16 v[76:79], v[152:155], v[204:207], v[76:79]
    ds_read_b128 v[176:179], v40 offset:43008
    v_mfma_f32_16x16x32_bf16 v[72:75], v[200:203], v[152:155], v[72:75]
    ds_read_b64_tr_b16 v[220:221], v45 offset:49152
    v_mfma_f32_16x16x32_bf16 v[68:71], v[196:199], v[152:155], v[68:71]
    ds_read_b64_tr_b16 v[222:223], v45 offset:50176
    v_mfma_f32_16x16x32_bf16 v[84:87], v[196:199], v[156:159], v[84:87]
    ds_read_b128 v[180:183], v40 offset:45056
    v_mfma_f32_16x16x32_bf16 v[88:91], v[200:203], v[156:159], v[88:91]
    ds_read_b64_tr_b16 v[224:225], v46 offset:49152
    v_mfma_f32_16x16x32_bf16 v[92:95], v[156:159], v[204:207], v[92:95]
    ds_read_b64_tr_b16 v[226:227], v46 offset:50176
    v_mfma_f32_16x16x32_bf16 v[96:99], v[208:211], v[156:159], v[96:99]
    ds_read_b128 v[184:187], v40 offset:47104
    v_mfma_f32_16x16x32_bf16 v[112:115], v[208:211], v[160:163], v[112:115]
    ds_read_b128 v[188:191], v40 offset:49152
    v_mfma_f32_16x16x32_bf16 v[108:111], v[160:163], v[204:207], v[108:111]
    ds_read_b128 v[192:195], v40 offset:51200
    v_mfma_f32_16x16x32_bf16 v[104:107], v[200:203], v[160:163], v[104:107]
    v_mfma_f32_16x16x32_bf16 v[100:103], v[196:199], v[160:163], v[100:103]
    v_mfma_f32_16x16x32_bf16 v[116:119], v[196:199], v[164:167], v[116:119]
    v_mfma_f32_16x16x32_bf16 v[120:123], v[200:203], v[164:167], v[120:123]
    v_mfma_f32_16x16x32_bf16 v[124:127], v[164:167], v[204:207], v[124:127]
    v_mfma_f32_16x16x32_bf16 v[128:131], v[208:211], v[164:167], v[128:131]
    v_mfma_f32_16x16x32_bf16 v[144:147], v[208:211], v[168:171], v[144:147]
    v_mfma_f32_16x16x32_bf16 v[140:143], v[168:171], v[204:207], v[140:143]
    v_mfma_f32_16x16x32_bf16 v[136:139], v[200:203], v[168:171], v[136:139]
    v_mfma_f32_16x16x32_bf16 v[132:135], v[196:199], v[168:171], v[132:135]
    s_waitcnt lgkmcnt(0)
    s_barrier
    v_mfma_f32_16x16x32_bf16 v[52:55], v[212:215], v[172:175], v[52:55]
    ds_read_b64_tr_b16 v[196:197], v47 offset:0
    v_mfma_f32_16x16x32_bf16 v[56:59], v[216:219], v[172:175], v[56:59]
    ds_read_b64_tr_b16 v[198:199], v47 offset:1024
    v_mfma_f32_16x16x32_bf16 v[60:63], v[172:175], v[220:223], v[60:63]
    ds_read_b128 v[148:151], v41 offset:0
    v_mfma_f32_16x16x32_bf16 v[64:67], v[224:227], v[172:175], v[64:67]
    ds_read_b64_tr_b16 v[200:201], v48 offset:0
    v_mfma_f32_16x16x32_bf16 v[80:83], v[224:227], v[176:179], v[80:83]
    ds_read_b64_tr_b16 v[202:203], v48 offset:1024
    v_mfma_f32_16x16x32_bf16 v[76:79], v[176:179], v[220:223], v[76:79]
    ds_read_b128 v[152:155], v41 offset:2048
    v_mfma_f32_16x16x32_bf16 v[72:75], v[216:219], v[176:179], v[72:75]
    ds_read_b64_tr_b16 v[204:205], v49 offset:0
    v_mfma_f32_16x16x32_bf16 v[68:71], v[212:215], v[176:179], v[68:71]
    ds_read_b64_tr_b16 v[206:207], v49 offset:1024
    v_mfma_f32_16x16x32_bf16 v[84:87], v[212:215], v[180:183], v[84:87]
    ds_read_b128 v[156:159], v41 offset:4096
    v_mfma_f32_16x16x32_bf16 v[88:91], v[216:219], v[180:183], v[88:91]
    ds_read_b64_tr_b16 v[208:209], v50 offset:0
    v_mfma_f32_16x16x32_bf16 v[92:95], v[180:183], v[220:223], v[92:95]
    ds_read_b64_tr_b16 v[210:211], v50 offset:1024
    v_mfma_f32_16x16x32_bf16 v[96:99], v[224:227], v[180:183], v[96:99]
    ds_read_b128 v[160:163], v41 offset:6144
    v_mfma_f32_16x16x32_bf16 v[112:115], v[224:227], v[184:187], v[112:115]
    ds_read_b128 v[164:167], v41 offset:8192
    v_mfma_f32_16x16x32_bf16 v[108:111], v[184:187], v[220:223], v[108:111]
    ds_read_b128 v[168:171], v41 offset:10240
    v_mfma_f32_16x16x32_bf16 v[104:107], v[216:219], v[184:187], v[104:107]
    v_mfma_f32_16x16x32_bf16 v[100:103], v[212:215], v[184:187], v[100:103]
    v_mfma_f32_16x16x32_bf16 v[116:119], v[212:215], v[188:191], v[116:119]
    v_mfma_f32_16x16x32_bf16 v[120:123], v[216:219], v[188:191], v[120:123]
    v_mfma_f32_16x16x32_bf16 v[124:127], v[188:191], v[220:223], v[124:127]
    v_mfma_f32_16x16x32_bf16 v[128:131], v[224:227], v[188:191], v[128:131]
    v_mfma_f32_16x16x32_bf16 v[144:147], v[224:227], v[192:195], v[144:147]
    v_mfma_f32_16x16x32_bf16 v[140:143], v[192:195], v[220:223], v[140:143]
    v_mfma_f32_16x16x32_bf16 v[136:139], v[216:219], v[192:195], v[136:139]
    v_mfma_f32_16x16x32_bf16 v[132:135], v[212:215], v[192:195], v[132:135]
    s_waitcnt lgkmcnt(0)
    v_mfma_f32_16x16x32_bf16 v[52:55], v[196:199], v[148:151], v[52:55]
    ds_read_b64_tr_b16 v[212:213], v47 offset:8192
    v_mfma_f32_16x16x32_bf16 v[56:59], v[200:203], v[148:151], v[56:59]
    ds_read_b64_tr_b16 v[214:215], v47 offset:9216
    v_mfma_f32_16x16x32_bf16 v[60:63], v[148:151], v[204:207], v[60:63]
    ds_read_b128 v[172:175], v42 offset:0
    v_mfma_f32_16x16x32_bf16 v[64:67], v[208:211], v[148:151], v[64:67]
    ds_read_b64_tr_b16 v[216:217], v48 offset:8192
    v_mfma_f32_16x16x32_bf16 v[80:83], v[208:211], v[152:155], v[80:83]
    ds_read_b64_tr_b16 v[218:219], v48 offset:9216
    v_mfma_f32_16x16x32_bf16 v[76:79], v[152:155], v[204:207], v[76:79]
    ds_read_b128 v[176:179], v42 offset:2048
    v_mfma_f32_16x16x32_bf16 v[72:75], v[200:203], v[152:155], v[72:75]
    ds_read_b64_tr_b16 v[220:221], v49 offset:8192
    v_mfma_f32_16x16x32_bf16 v[68:71], v[196:199], v[152:155], v[68:71]
    ds_read_b64_tr_b16 v[222:223], v49 offset:9216
    v_mfma_f32_16x16x32_bf16 v[84:87], v[196:199], v[156:159], v[84:87]
    ds_read_b128 v[180:183], v42 offset:4096
    v_mfma_f32_16x16x32_bf16 v[88:91], v[200:203], v[156:159], v[88:91]
    ds_read_b64_tr_b16 v[224:225], v50 offset:8192
    v_mfma_f32_16x16x32_bf16 v[92:95], v[156:159], v[204:207], v[92:95]
    ds_read_b64_tr_b16 v[226:227], v50 offset:9216
    v_mfma_f32_16x16x32_bf16 v[96:99], v[208:211], v[156:159], v[96:99]
    ds_read_b128 v[184:187], v42 offset:6144
    v_mfma_f32_16x16x32_bf16 v[112:115], v[208:211], v[160:163], v[112:115]
    ds_read_b128 v[188:191], v42 offset:8192
    v_mfma_f32_16x16x32_bf16 v[108:111], v[160:163], v[204:207], v[108:111]
    ds_read_b128 v[192:195], v42 offset:10240
    v_mfma_f32_16x16x32_bf16 v[104:107], v[200:203], v[160:163], v[104:107]
    v_mfma_f32_16x16x32_bf16 v[100:103], v[196:199], v[160:163], v[100:103]
    v_mfma_f32_16x16x32_bf16 v[116:119], v[196:199], v[164:167], v[116:119]
    v_mfma_f32_16x16x32_bf16 v[120:123], v[200:203], v[164:167], v[120:123]
    v_mfma_f32_16x16x32_bf16 v[124:127], v[164:167], v[204:207], v[124:127]
    v_mfma_f32_16x16x32_bf16 v[128:131], v[208:211], v[164:167], v[128:131]
    v_mfma_f32_16x16x32_bf16 v[144:147], v[208:211], v[168:171], v[144:147]
    v_mfma_f32_16x16x32_bf16 v[140:143], v[168:171], v[204:207], v[140:143]
    v_mfma_f32_16x16x32_bf16 v[136:139], v[200:203], v[168:171], v[136:139]
    v_mfma_f32_16x16x32_bf16 v[132:135], v[196:199], v[168:171], v[132:135]
    s_waitcnt lgkmcnt(0)
    s_barrier
    v_mfma_f32_16x16x32_bf16 v[52:55], v[212:215], v[172:175], v[52:55]
    ds_read_b64_tr_b16 v[196:197], v43 offset:0
    v_mfma_f32_16x16x32_bf16 v[56:59], v[216:219], v[172:175], v[56:59]
    ds_read_b64_tr_b16 v[198:199], v43 offset:1024
    v_mfma_f32_16x16x32_bf16 v[60:63], v[172:175], v[220:223], v[60:63]
    ds_read_b128 v[148:151], v39 offset:0
    v_mfma_f32_16x16x32_bf16 v[64:67], v[224:227], v[172:175], v[64:67]
    ds_read_b64_tr_b16 v[200:201], v44 offset:0
    v_mfma_f32_16x16x32_bf16 v[80:83], v[224:227], v[176:179], v[80:83]
    ds_read_b64_tr_b16 v[202:203], v44 offset:1024
    v_mfma_f32_16x16x32_bf16 v[76:79], v[176:179], v[220:223], v[76:79]
    ds_read_b128 v[152:155], v39 offset:2048
    v_mfma_f32_16x16x32_bf16 v[72:75], v[216:219], v[176:179], v[72:75]
    ds_read_b64_tr_b16 v[204:205], v45 offset:0
    v_mfma_f32_16x16x32_bf16 v[68:71], v[212:215], v[176:179], v[68:71]
    ds_read_b64_tr_b16 v[206:207], v45 offset:1024
    v_mfma_f32_16x16x32_bf16 v[84:87], v[212:215], v[180:183], v[84:87]
    ds_read_b128 v[156:159], v39 offset:4096
    v_mfma_f32_16x16x32_bf16 v[88:91], v[216:219], v[180:183], v[88:91]
    ds_read_b64_tr_b16 v[208:209], v46 offset:0
    v_mfma_f32_16x16x32_bf16 v[92:95], v[180:183], v[220:223], v[92:95]
    ds_read_b64_tr_b16 v[210:211], v46 offset:1024
    v_mfma_f32_16x16x32_bf16 v[96:99], v[224:227], v[180:183], v[96:99]
    ds_read_b128 v[160:163], v39 offset:6144
    v_mfma_f32_16x16x32_bf16 v[112:115], v[224:227], v[184:187], v[112:115]
    ds_read_b128 v[164:167], v39 offset:8192
    v_mfma_f32_16x16x32_bf16 v[108:111], v[184:187], v[220:223], v[108:111]
    ds_read_b128 v[168:171], v39 offset:10240
    v_mfma_f32_16x16x32_bf16 v[104:107], v[216:219], v[184:187], v[104:107]
    v_mfma_f32_16x16x32_bf16 v[100:103], v[212:215], v[184:187], v[100:103]
    v_mfma_f32_16x16x32_bf16 v[116:119], v[212:215], v[188:191], v[116:119]
    v_mfma_f32_16x16x32_bf16 v[120:123], v[216:219], v[188:191], v[120:123]
    v_mfma_f32_16x16x32_bf16 v[124:127], v[188:191], v[220:223], v[124:127]
    v_mfma_f32_16x16x32_bf16 v[128:131], v[224:227], v[188:191], v[128:131]
    v_mfma_f32_16x16x32_bf16 v[144:147], v[224:227], v[192:195], v[144:147]
    v_mfma_f32_16x16x32_bf16 v[140:143], v[192:195], v[220:223], v[140:143]
    v_mfma_f32_16x16x32_bf16 v[136:139], v[216:219], v[192:195], v[136:139]
    v_mfma_f32_16x16x32_bf16 v[132:135], v[212:215], v[192:195], v[132:135]
    s_waitcnt lgkmcnt(0)
    v_mfma_f32_16x16x32_bf16 v[52:55], v[196:199], v[148:151], v[52:55]
    ds_read_b64_tr_b16 v[212:213], v43 offset:8192
    v_mfma_f32_16x16x32_bf16 v[56:59], v[200:203], v[148:151], v[56:59]
    ds_read_b64_tr_b16 v[214:215], v43 offset:9216
    v_mfma_f32_16x16x32_bf16 v[60:63], v[148:151], v[204:207], v[60:63]
    ds_read_b128 v[172:175], v40 offset:0
    v_mfma_f32_16x16x32_bf16 v[64:67], v[208:211], v[148:151], v[64:67]
    ds_read_b64_tr_b16 v[216:217], v44 offset:8192
    v_mfma_f32_16x16x32_bf16 v[80:83], v[208:211], v[152:155], v[80:83]
    ds_read_b64_tr_b16 v[218:219], v44 offset:9216
    v_mfma_f32_16x16x32_bf16 v[76:79], v[152:155], v[204:207], v[76:79]
    ds_read_b128 v[176:179], v40 offset:2048
    v_mfma_f32_16x16x32_bf16 v[72:75], v[200:203], v[152:155], v[72:75]
    ds_read_b64_tr_b16 v[220:221], v45 offset:8192
    v_mfma_f32_16x16x32_bf16 v[68:71], v[196:199], v[152:155], v[68:71]
    ds_read_b64_tr_b16 v[222:223], v45 offset:9216
    v_mfma_f32_16x16x32_bf16 v[84:87], v[196:199], v[156:159], v[84:87]
    ds_read_b128 v[180:183], v40 offset:4096
    v_mfma_f32_16x16x32_bf16 v[88:91], v[200:203], v[156:159], v[88:91]
    ds_read_b64_tr_b16 v[224:225], v46 offset:8192
    v_mfma_f32_16x16x32_bf16 v[92:95], v[156:159], v[204:207], v[92:95]
    ds_read_b64_tr_b16 v[226:227], v46 offset:9216
    v_mfma_f32_16x16x32_bf16 v[96:99], v[208:211], v[156:159], v[96:99]
    ds_read_b128 v[184:187], v40 offset:6144
    v_mfma_f32_16x16x32_bf16 v[112:115], v[208:211], v[160:163], v[112:115]
    ds_read_b128 v[188:191], v40 offset:8192
    v_mfma_f32_16x16x32_bf16 v[108:111], v[160:163], v[204:207], v[108:111]
    ds_read_b128 v[192:195], v40 offset:10240
    v_mfma_f32_16x16x32_bf16 v[104:107], v[200:203], v[160:163], v[104:107]
    v_mfma_f32_16x16x32_bf16 v[100:103], v[196:199], v[160:163], v[100:103]
    v_mfma_f32_16x16x32_bf16 v[116:119], v[196:199], v[164:167], v[116:119]
    v_mfma_f32_16x16x32_bf16 v[120:123], v[200:203], v[164:167], v[120:123]
    v_mfma_f32_16x16x32_bf16 v[124:127], v[164:167], v[204:207], v[124:127]
    v_mfma_f32_16x16x32_bf16 v[128:131], v[208:211], v[164:167], v[128:131]
    v_mfma_f32_16x16x32_bf16 v[144:147], v[208:211], v[168:171], v[144:147]
    v_mfma_f32_16x16x32_bf16 v[140:143], v[168:171], v[204:207], v[140:143]
    v_mfma_f32_16x16x32_bf16 v[136:139], v[200:203], v[168:171], v[136:139]
    v_mfma_f32_16x16x32_bf16 v[132:135], v[196:199], v[168:171], v[132:135]
    s_waitcnt lgkmcnt(0)
    s_barrier
    v_mfma_f32_16x16x32_bf16 v[52:55], v[212:215], v[172:175], v[52:55]
    ds_read_b64_tr_b16 v[196:197], v43 offset:40960
    v_mfma_f32_16x16x32_bf16 v[56:59], v[216:219], v[172:175], v[56:59]
    ds_read_b64_tr_b16 v[198:199], v43 offset:41984
    v_mfma_f32_16x16x32_bf16 v[60:63], v[172:175], v[220:223], v[60:63]
    ds_read_b128 v[148:151], v39 offset:40960
    v_mfma_f32_16x16x32_bf16 v[64:67], v[224:227], v[172:175], v[64:67]
    ds_read_b64_tr_b16 v[200:201], v44 offset:40960
    v_mfma_f32_16x16x32_bf16 v[80:83], v[224:227], v[176:179], v[80:83]
    ds_read_b64_tr_b16 v[202:203], v44 offset:41984
    v_mfma_f32_16x16x32_bf16 v[76:79], v[176:179], v[220:223], v[76:79]
    ds_read_b128 v[152:155], v39 offset:43008
    v_mfma_f32_16x16x32_bf16 v[72:75], v[216:219], v[176:179], v[72:75]
    ds_read_b64_tr_b16 v[204:205], v45 offset:40960
    v_mfma_f32_16x16x32_bf16 v[68:71], v[212:215], v[176:179], v[68:71]
    ds_read_b64_tr_b16 v[206:207], v45 offset:41984
    v_mfma_f32_16x16x32_bf16 v[84:87], v[212:215], v[180:183], v[84:87]
    ds_read_b128 v[156:159], v39 offset:45056
    v_mfma_f32_16x16x32_bf16 v[88:91], v[216:219], v[180:183], v[88:91]
    ds_read_b64_tr_b16 v[208:209], v46 offset:40960
    v_mfma_f32_16x16x32_bf16 v[92:95], v[180:183], v[220:223], v[92:95]
    ds_read_b64_tr_b16 v[210:211], v46 offset:41984
    v_mfma_f32_16x16x32_bf16 v[96:99], v[224:227], v[180:183], v[96:99]
    ds_read_b128 v[160:163], v39 offset:47104
    v_mfma_f32_16x16x32_bf16 v[112:115], v[224:227], v[184:187], v[112:115]
    ds_read_b128 v[164:167], v39 offset:49152
    v_mfma_f32_16x16x32_bf16 v[108:111], v[184:187], v[220:223], v[108:111]
    ds_read_b128 v[168:171], v39 offset:51200
    v_mfma_f32_16x16x32_bf16 v[104:107], v[216:219], v[184:187], v[104:107]
    v_mfma_f32_16x16x32_bf16 v[100:103], v[212:215], v[184:187], v[100:103]
    v_mfma_f32_16x16x32_bf16 v[116:119], v[212:215], v[188:191], v[116:119]
    v_mfma_f32_16x16x32_bf16 v[120:123], v[216:219], v[188:191], v[120:123]
    v_mfma_f32_16x16x32_bf16 v[124:127], v[188:191], v[220:223], v[124:127]
    v_mfma_f32_16x16x32_bf16 v[128:131], v[224:227], v[188:191], v[128:131]
    s_branch K_PG2
.p2align 12
K_CHM2:
K_STM2:
    s_branch K_WRET_M
    s_nop 0
K_PG2:
    v_mfma_f32_16x16x32_bf16 v[144:147], v[224:227], v[192:195], v[144:147]
    v_mfma_f32_16x16x32_bf16 v[140:143], v[192:195], v[220:223], v[140:143]
    v_mfma_f32_16x16x32_bf16 v[136:139], v[216:219], v[192:195], v[136:139]
    v_mfma_f32_16x16x32_bf16 v[132:135], v[212:215], v[192:195], v[132:135]
    s_waitcnt lgkmcnt(0)
    v_mfma_f32_16x16x32_bf16 v[52:55], v[196:199], v[148:151], v[52:55]
    ds_read_b64_tr_b16 v[212:213], v43 offset:49152
    v_mfma_f32_16x16x32_bf16 v[56:59], v[200:203], v[148:151], v[56:59]
    ds_read_b64_tr_b16 v[214:215], v43 offset:50176
    v_mfma_f32_16x16x32_bf16 v[60:63], v[148:151], v[204:207], v[60:63]
    ds_read_b128 v[172:175], v40 offset:40960
    v_mfma_f32_16x16x32_bf16 v[64:67], v[208:211], v[148:151], v[64:67]
    ds_read_b64_tr_b16 v[216:217], v44 offset:49152
    v_mfma_f32_16x16x32_bf16 v[80:83], v[208:211], v[152:155], v[80:83]
    ds_read_b64_tr_b16 v[218:219], v44 offset:50176
    v_mfma_f32_16x16x32_bf16 v[76:79], v[152:155], v[204:207], v[76:79]
    ds_read_b128 v[176:179], v40 offset:43008
    v_mfma_f32_16x16x32_bf16 v[72:75], v[200:203], v[152:155], v[72:75]
    ds_read_b64_tr_b16 v[220:221], v45 offset:49152
    v_mfma_f32_16x16x32_bf16 v[68:71], v[196:199], v[152:155], v[68:71]
    ds_read_b64_tr_b16 v[222:223], v45 offset:50176
    v_mfma_f32_16x16x32_bf16 v[84:87], v[196:199], v[156:159], v[84:87]
    ds_read_b128 v[180:183], v40 offset:45056
    v_mfma_f32_16x16x32_bf16 v[88:91], v[200:203], v[156:159], v[88:91]
    ds_read_b64_tr_b16 v[224:225], v46 offset:49152
    v_mfma_f32_16x16x32_bf16 v[92:95], v[156:159], v[204:207], v[92:95]
    ds_read_b64_tr_b16 v[226:227], v46 offset:50176
    v_mfma_f32_16x16x32_bf16 v[96:99], v[208:211], v[156:159], v[96:99]
    ds_read_b128 v[184:187], v40 offset:47104
    v_mfma_f32_16x16x32_bf16 v[112:115], v[208:211], v[160:163], v[112:115]
    ds_read_b128 v[188:191], v40 offset:49152
    v_mfma_f32_16x16x32_bf16 v[108:111], v[160:163], v[204:207], v[108:111]
    ds_read_b128 v[192:195], v40 offset:51200
    v_mfma_f32_16x16x32_bf16 v[104:107], v[200:203], v[160:163], v[104:107]
    v_mfma_f32_16x16x32_bf16 v[100:103], v[196:199], v[160:163], v[100:103]
    v_mfma_f32_16x16x32_bf16 v[116:119], v[196:199], v[164:167], v[116:119]
    v_mfma_f32_16x16x32_bf16 v[120:123], v[200:203], v[164:167], v[120:123]
    v_mfma_f32_16x16x32_bf16 v[124:127], v[164:167], v[204:207], v[124:127]
    v_mfma_f32_16x16x32_bf16 v[128:131], v[208:211], v[164:167], v[128:131]
    v_mfma_f32_16x16x32_bf16 v[144:147], v[208:211], v[168:171], v[144:147]
    v_mfma_f32_16x16x32_bf16 v[140:143], v[168:171], v[204:207], v[140:143]
    v_mfma_f32_16x16x32_bf16 v[136:139], v[200:203], v[168:171], v[136:139]
    v_mfma_f32_16x16x32_bf16 v[132:135], v[196:199], v[168:171], v[132:135]
    s_waitcnt lgkmcnt(0)
    s_barrier
    v_mfma_f32_16x16x32_bf16 v[52:55], v[212:215], v[172:175], v[52:55]
    ds_read_b64_tr_b16 v[196:197], v47 offset:0
    v_mfma_f32_16x16x32_bf16 v[56:59], v[216:219], v[172:175], v[56:59]
    ds_read_b64_tr_b16 v[198:199], v47 offset:1024
    v_mfma_f32_16x16x32_bf16 v[60:63], v[172:175], v[220:223], v[60:63]
    ds_read_b128 v[148:151], v41 offset:0
    v_mfma_f32_16x16x32_bf16 v[64:67], v[224:227], v[172:175], v[64:67]
    ds_read_b64_tr_b16 v[200:201], v48 offset:0
    v_mfma_f32_16x16x32_bf16 v[80:83], v[224:227], v[176:179], v[80:83]
    ds_read_b64_tr_b16 v[202:203], v48 offset:1024
    v_mfma_f32_16x16x32_bf16 v[76:79], v[176:179], v[220:223], v[76:79]
    ds_read_b128 v[152:155], v41 offset:2048
    v_mfma_f32_16x16x32_bf16 v[72:75], v[216:219], v[176:179], v[72:75]
    ds_read_b64_tr_b16 v[204:205], v49 offset:0
    v_mfma_f32_16x16x32_bf16 v[68:71], v[212:215], v[176:179], v[68:71]
    ds_read_b64_tr_b16 v[206:207], v49 offset:1024
    v_mfma_f32_16x16x32_bf16 v[84:87], v[212:215], v[180:183], v[84:87]
    ds_read_b128 v[156:159], v41 offset:4096
    v_mfma_f32_16x16x32_bf16 v[88:91], v[216:219], v[180:183], v[88:91]
    ds_read_b64_tr_b16 v[208:209], v50 offset:0
    v_mfma_f32_16x16x32_bf16 v[92:95], v[180:183], v[220:223], v[92:95]
    ds_read_b64_tr_b16 v[210:211], v50 offset:1024
    v_mfma_f32_16x16x32_bf16 v[96:99], v[224:227], v[180:183], v[96:99]
    ds_read_b128 v[160:163], v41 offset:6144
    v_mfma_f32_16x16x32_bf16 v[112:115], v[224:227], v[184:187], v[112:115]
    ds_read_b128 v[164:167], v41 offset:8192
    v_mfma_f32_16x16x32_bf16 v[108:111], v[184:187], v[220:223], v[108:111]
    ds_read_b128 v[168:171], v41 offset:10240
    v_mfma_f32_16x16x32_bf16 v[104:107], v[216:219], v[184:187], v[104:107]
    v_mfma_f32_16x16x32_bf16 v[100:103], v[212:215], v[184:187], v[100:103]
    v_mfma_f32_16x16x32_bf16 v[116:119], v[212:215], v[188:191], v[116:119]
    v_mfma_f32_16x16x32_bf16 v[120:123], v[216:219], v[188:191], v[120:123]
    v_mfma_f32_16x16x32_bf16 v[124:127], v[188:191], v[220:223], v[124:127]
    v_mfma_f32_16x16x32_bf16 v[128:131], v[224:227], v[188:191], v[128:131]
    v_mfma_f32_16x16x32_bf16 v[144:147], v[224:227], v[192:195], v[144:147]
    v_mfma_f32_16x16x32_bf16 v[140:143], v[192:195], v[220:223], v[140:143]
    v_mfma_f32_16x16x32_bf16 v[136:139], v[216:219], v[192:195], v[136:139]
    v_mfma_f32_16x16x32_bf16 v[132:135], v[212:215], v[192:195], v[132:135]
    s_waitcnt lgkmcnt(0)
    v_mfma_f32_16x16x32_bf16 v[132:135], v[196:199], v[168:171], v[132:135]
    ds_read_b64_tr_b16 v[212:213], v47 offset:8192
    ds_read_b64_tr_b16 v[214:215], v47 offset:9216
    v_mfma_f32_16x16x32_bf16 v[136:139], v[200:203], v[168:171], v[136:139]
    ds_read_b128 v[192:195], v42 offset:10240
    ds_read_b64_tr_b16 v[216:217], v48 offset:8192
    v_mfma_f32_16x16x32_bf16 v[140:143], v[168:171], v[204:207], v[140:143]
    ds_read_b64_tr_b16 v[218:219], v48 offset:9216
    ds_read_b64_tr_b16 v[220:221], v49 offset:8192
    v_mfma_f32_16x16x32_bf16 v[144:147], v[208:211], v[168:171], v[144:147]
    ds_read_b64_tr_b16 v[222:223], v49 offset:9216
    ds_read_b64_tr_b16 v[224:225], v50 offset:8192
    v_mfma_f32_16x16x32_bf16 v[116:119], v[196:199], v[164:167], v[116:119]
    ds_read_b64_tr_b16 v[226:227], v50 offset:9216
    ds_read_b128 v[188:191], v42 offset:8192
    v_mfma_f32_16x16x32_bf16 v[120:123], v[200:203], v[164:167], v[120:123]
    ds_read_b128 v[184:187], v42 offset:6144
    ds_read_b128 v[180:183], v42 offset:4096
    v_mfma_f32_16x16x32_bf16 v[124:127], v[164:167], v[204:207], v[124:127]
    ds_read_b128 v[176:179], v42 offset:2048
    ds_read_b128 v[172:175], v42 offset:0
    v_mfma_f32_16x16x32_bf16 v[128:131], v[208:211], v[164:167], v[128:131]
    s_waitcnt lgkmcnt(11)
    v_mfma_f32_16x16x32_bf16 v[132:135], v[212:215], v[192:195], v[132:135]
    s_waitcnt lgkmcnt(9)
    v_mfma_f32_16x16x32_bf16 v[136:139], v[216:219], v[192:195], v[136:139]
    s_waitcnt lgkmcnt(7)
    v_mfma_f32_16x16x32_bf16 v[140:143], v[192:195], v[220:223], v[140:143]
    s_waitcnt lgkmcnt(5)
    v_mfma_f32_16x16x32_bf16 v[144:147], v[224:227], v[192:195], v[144:147]
    s_waitcnt lgkmcnt(4)
    v_mfma_f32_16x16x32_bf16 v[116:119], v[212:215], v[188:191], v[116:119]
    v_cvt_pk_bf16_f32 v132, v132, v133
    v_cvt_pk_bf16_f32 v133, v134, v135
    v_mfma_f32_16x16x32_bf16 v[120:123], v[216:219], v[188:191], v[120:123]
    v_cvt_pk_bf16_f32 v136, v136, v137
    v_cvt_pk_bf16_f32 v137, v138, v139
    v_mfma_f32_16x16x32_bf16 v[124:127], v[188:191], v[220:223], v[124:127]
    v_mov_b32 v138, 0
    v_mov_b32 v139, 0
    v_mfma_f32_16x16x32_bf16 v[128:131], v[224:227], v[188:191], v[128:131]
    v_cvt_pk_bf16_f32 v134, v144, v145
    v_cvt_pk_bf16_f32 v135, v146, v147
    v_mfma_f32_16x16x32_bf16 v[100:103], v[196:199], v[160:163], v[100:103]
    v_cvt_pk_bf16_f32 v254, v140, v141
    v_cvt_pk_bf16_f32 v255, v142, v143
    v_mfma_f32_16x16x32_bf16 v[104:107], v[200:203], v[160:163], v[104:107]
    v_permlane16_swap_b32 v134, v138
    v_permlane16_swap_b32 v135, v139
    ds_write_b64 v32, v[134:135] offset:768
    v_mfma_f32_16x16x32_bf16 v[108:111], v[160:163], v[204:207], v[108:111]
    ds_read_b64_tr_b16 v[240:241], v33 offset:768
    s_cmp_lg_u32 s54, 0
    s_cbranch_scc1 K_NOX
    ds_write_b64 v34, v[132:133]
    ds_write_b64 v34, v[134:135] offset:512
    ds_write_b64 v34, v[254:255] offset:1024
    v_lshl_add_u32 v2, s55, 2, v38
    ds_write_b16 v2, v38 offset:30
K_NOX:
    v_mfma_f32_16x16x32_bf16 v[112:115], v[208:211], v[160:163], v[112:115]
    v_cvt_pk_bf16_f32 v116, v116, v117
    v_cvt_pk_bf16_f32 v117, v118, v119
    v_mfma_f32_16x16x32_bf16 v[192:195], v[132:135], v[136:139], v[16:19]
    v_cvt_pk_bf16_f32 v120, v120, v121
    v_cvt_pk_bf16_f32 v121, v122, v123
    s_waitcnt lgkmcnt(5)
    v_mfma_f32_16x16x32_bf16 v[100:103], v[212:215], v[184:187], v[100:103]
    v_mov_b32 v122, 0
    v_mov_b32 v123, 0
    v_mfma_f32_16x16x32_bf16 v[104:107], v[216:219], v[184:187], v[104:107]
    v_cvt_pk_bf16_f32 v118, v128, v129
    v_cvt_pk_bf16_f32 v119, v130, v131
    v_mfma_f32_16x16x32_bf16 v[108:111], v[184:187], v[220:223], v[108:111]
    v_cvt_pk_bf16_f32 v252, v124, v125
    v_cvt_pk_bf16_f32 v253, v126, v127
    v_mfma_f32_16x16x32_bf16 v[112:115], v[224:227], v[184:187], v[112:115]
    v_permlane16_swap_b32 v118, v122
    v_permlane16_swap_b32 v119, v123
    ds_write_b64 v32, v[118:119] offset:640
    v_mfma_f32_16x16x32_bf16 v[84:87], v[196:199], v[156:159], v[84:87]
    ds_read_b64_tr_b16 v[238:239], v33 offset:640
    v_cvt_pk_bf16_f32 v100, v100, v101
    v_mfma_f32_16x16x32_bf16 v[88:91], v[200:203], v[156:159], v[88:91]
    v_cvt_pk_bf16_f32 v101, v102, v103
    v_cvt_pk_bf16_f32 v104, v104, v105
    v_mfma_f32_16x16x32_bf16 v[168:171], v[116:119], v[136:139], v[12:15]
    v_cvt_pk_bf16_f32 v105, v106, v107
    v_mov_b32 v106, 0
    v_mfma_f32_16x16x32_bf16 v[92:95], v[156:159], v[204:207], v[92:95]
    v_mov_b32 v107, 0
    v_cvt_pk_bf16_f32 v102, v112, v113
    v_mfma_f32_16x16x32_bf16 v[188:191], v[116:119], v[120:123], v[16:19]
    v_cvt_pk_bf16_f32 v103, v114, v115
    v_cvt_pk_bf16_f32 v250, v108, v109
    v_mfma_f32_16x16x32_bf16 v[96:99], v[208:211], v[156:159], v[96:99]
    v_cvt_pk_bf16_f32 v251, v110, v111
    v_permlane16_swap_b32 v102, v106
    s_waitcnt lgkmcnt(6)
    v_mfma_f32_16x16x32_bf16 v[84:87], v[212:215], v[180:183], v[84:87]
    v_permlane16_swap_b32 v103, v107
    ds_write_b64 v32, v[102:103] offset:512
    v_mfma_f32_16x16x32_bf16 v[88:91], v[216:219], v[180:183], v[88:91]
    ds_read_b64_tr_b16 v[236:237], v33 offset:512
    v_max3_f32 v168, v168, v169, v192
    v_mfma_f32_16x16x32_bf16 v[92:95], v[180:183], v[220:223], v[92:95]
    v_max3_f32 v170, v170, v171, v194
    v_max_f32 v168, v168, v193
    v_mfma_f32_16x16x32_bf16 v[164:167], v[100:103], v[120:123], v[12:15]
    v_max_f32 v169, v170, v195
    v_cvt_pk_bf16_f32 v168, v168, v169
    v_mfma_f32_16x16x32_bf16 v[96:99], v[224:227], v[180:183], v[96:99]
    v_cvt_pk_bf16_f32 v84, v84, v85
    v_cvt_pk_bf16_f32 v85, v86, v87
    v_mfma_f32_16x16x32_bf16 v[184:187], v[100:103], v[104:107], v[16:19]
    v_cvt_pk_bf16_f32 v88, v88, v89
    v_cvt_pk_bf16_f32 v89, v90, v91
    v_mfma_f32_16x16x32_bf16 v[68:71], v[196:199], v[152:155], v[68:71]
    v_mov_b32 v90, 0
    v_mov_b32 v91, 0
    v_mfma_f32_16x16x32_bf16 v[72:75], v[200:203], v[152:155], v[72:75]
    v_max3_f32 v164, v164, v165, v188
    v_max3_f32 v166, v166, v167, v190
    v_mfma_f32_16x16x32_bf16 v[76:79], v[152:155], v[204:207], v[76:79]
    v_max_f32 v164, v164, v189
    v_max_f32 v165, v166, v191
    v_mfma_f32_16x16x32_bf16 v[80:83], v[208:211], v[152:155], v[80:83]
    v_cvt_pk_bf16_f32 v164, v164, v165
    v_cvt_pk_bf16_f32 v86, v96, v97
    s_waitcnt lgkmcnt(7)
    v_mfma_f32_16x16x32_bf16 v[68:71], v[212:215], v[176:179], v[68:71]
    v_cvt_pk_bf16_f32 v87, v98, v99
    v_cvt_pk_bf16_f32 v248, v92, v93
    v_mfma_f32_16x16x32_bf16 v[72:75], v[216:219], v[176:179], v[72:75]
    v_cvt_pk_bf16_f32 v249, v94, v95
    v_permlane16_swap_b32 v86, v90
    v_mfma_f32_16x16x32_bf16 v[76:79], v[176:179], v[220:223], v[76:79]
    v_permlane16_swap_b32 v87, v91
    ds_write_b64 v32, v[86:87] offset:384
    v_mfma_f32_16x16x32_bf16 v[80:83], v[224:227], v[176:179], v[80:83]
    ds_read_b64_tr_b16 v[234:235], v33 offset:384
    v_lshl_add_u32 v2, s55, 2, v38
    v_mfma_f32_16x16x32_bf16 v[52:55], v[196:199], v[148:151], v[52:55]
    ds_read_b32 v3, v2 offset:28
    ds_read_b64 v[144:145], v34
    v_mfma_f32_16x16x32_bf16 v[160:163], v[84:87], v[104:107], v[12:15]
    ds_read_b64 v[146:147], v34 offset:512
    ds_read_b64 v[242:243], v34 offset:1024
    v_mfma_f32_16x16x32_bf16 v[56:59], v[200:203], v[148:151], v[56:59]
    ds_read_b64_tr_b16 v[228:229], v33
    v_cvt_pk_bf16_f32 v68, v68, v69
    v_mfma_f32_16x16x32_bf16 v[180:183], v[84:87], v[88:91], v[16:19]
    v_cvt_pk_bf16_f32 v69, v70, v71
    v_cvt_pk_bf16_f32 v72, v72, v73
    v_mfma_f32_16x16x32_bf16 v[60:63], v[148:151], v[204:207], v[60:63]
    v_cvt_pk_bf16_f32 v73, v74, v75
    v_mov_b32 v74, 0
    v_mfma_f32_16x16x32_bf16 v[64:67], v[208:211], v[148:151], v[64:67]
    v_mov_b32 v75, 0
    v_cvt_pk_bf16_f32 v70, v80, v81
    s_waitcnt lgkmcnt(13)
    v_mfma_f32_16x16x32_bf16 v[52:55], v[212:215], v[172:175], v[52:55]
    v_cvt_pk_bf16_f32 v71, v82, v83
    v_cvt_pk_bf16_f32 v246, v76, v77
    v_mfma_f32_16x16x32_bf16 v[56:59], v[216:219], v[172:175], v[56:59]
    v_cvt_pk_bf16_f32 v247, v78, v79
    v_permlane16_swap_b32 v70, v74
    v_mfma_f32_16x16x32_bf16 v[60:63], v[172:175], v[220:223], v[60:63]
    v_permlane16_swap_b32 v71, v75
    ds_write_b64 v32, v[70:71] offset:256
    v_mfma_f32_16x16x32_bf16 v[64:67], v[224:227], v[172:175], v[64:67]
    ds_read_b64_tr_b16 v[232:233], v33 offset:256
    v_max3_f32 v160, v160, v161, v184
    v_max3_f32 v162, v162, v163, v186
    v_max_f32 v160, v160, v185
    v_max_f32 v161, v162, v187
    v_mfma_f32_16x16x32_bf16 v[156:159], v[68:71], v[88:91], v[12:15]
    v_cvt_pk_bf16_f32 v160, v160, v161
    v_cvt_pk_bf16_f32 v52, v52, v53
    v_cvt_pk_bf16_f32 v53, v54, v55
    v_mfma_f32_16x16x32_bf16 v[176:179], v[68:71], v[72:75], v[16:19]
    v_cvt_pk_bf16_f32 v56, v56, v57
    v_cvt_pk_bf16_f32 v57, v58, v59
    v_mov_b32 v58, 0
    v_mov_b32 v59, 0
    v_cvt_pk_bf16_f32 v54, v64, v65
    v_cvt_pk_bf16_f32 v55, v66, v67
    v_cvt_pk_bf16_f32 v244, v60, v61
    v_cvt_pk_bf16_f32 v245, v62, v63
    v_permlane16_swap_b32 v54, v58
    v_permlane16_swap_b32 v55, v59
    ds_write_b64 v32, v[54:55] offset:128
    ds_read_b64_tr_b16 v[230:231], v33 offset:128
    v_max3_f32 v156, v156, v157, v180
    v_max3_f32 v158, v158, v159, v182
    v_max_f32 v156, v156, v181
    v_mfma_f32_16x16x32_bf16 v[152:155], v[52:55], v[72:75], v[20:23]
    v_max_f32 v157, v158, v183
    v_cvt_pk_bf16_f32 v156, v156, v157
    v_mfma_f32_16x16x32_bf16 v[172:175], v[52:55], v[56:59], v[16:19]
    s_waitcnt lgkmcnt(4)
    v_readfirstlane_b32 s33, v3
    s_cmp_lt_u32 s33, 1811939328
    s_cbranch_scc1 K_XW
K_XR:
    v_mfma_f32_16x16x32_bf16 v[148:151], v[144:147], v[56:59], v[12:15]
    v_max3_f32 v152, v152, v153, v176
    v_max3_f32 v154, v154, v155, v178
    v_max_f32 v152, v152, v177
    v_max_f32 v153, v154, v179
    v_cvt_pk_bf16_f32 v152, v152, v153
    v_permlane16_swap_b32 v164, v168
    v_permlane16_swap_b32 v156, v160
    s_nop 1
    v_max3_f32 v148, v148, v149, v172
    v_max3_f32 v150, v150, v151, v174
    v_max_f32 v148, v148, v173
    v_max_f32 v149, v150, v175
    v_cvt_pk_bf16_f32 v148, v148, v149
    v_permlane32_swap_b32 v156, v164
    v_permlane32_swap_b32 v160, v168
    v_lshlrev_b32 v220, 16, v156
    v_and_b32 v221, 0xffff0000, v156
    v_lshlrev_b32 v224, 16, v164
    v_and_b32 v225, 0xffff0000, v164
    v_lshlrev_b32 v222, 16, v160
    v_and_b32 v223, 0xffff0000, v160
    v_lshlrev_b32 v226, 16, v168
    v_and_b32 v227, 0xffff0000, v168
    v_permlane16_swap_b32 v148, v152
    v_lshlrev_b32 v216, 16, v148
    v_and_b32 v217, 0xffff0000, v148
    v_lshlrev_b32 v218, 16, v152
    v_and_b32 v219, 0xffff0000, v152
    v_pk_mul_f32 v[220:221], v[220:221], s[60:61]
    v_pk_mul_f32 v[224:225], v[224:225], s[60:61]
    v_pk_mul_f32 v[222:223], v[222:223], s[60:61]
    v_pk_mul_f32 v[226:227], v[226:227], s[60:61]
    v_pk_mul_f32 v[216:217], v[216:217], s[60:61]
    v_pk_mul_f32 v[218:219], v[218:219], s[60:61]
    v_cvt_pk_bf16_f32 v156, v220, v221
    v_cvt_pk_bf16_f32 v164, v224, v225
    v_cvt_pk_bf16_f32 v160, v222, v223
    v_cvt_pk_bf16_f32 v168, v226, v227
    v_cvt_pk_bf16_f32 v148, v216, v217
    v_cvt_pk_bf16_f32 v152, v218, v219
    v_lshlrev_b32 v218, 16, v152
    v_and_b32 v219, 0xffff0000, v152
    v_lshlrev_b32 v216, 16, v148
    v_and_b32 v217, 0xffff0000, v148
    v_lshlrev_b32 v226, 16, v168
    v_and_b32 v227, 0xffff0000, v168
    v_lshlrev_b32 v222, 16, v160
    v_and_b32 v223, 0xffff0000, v160
    v_lshlrev_b32 v224, 16, v164
    v_and_b32 v225, 0xffff0000, v164
    v_lshlrev_b32 v220, 16, v156
    v_and_b32 v221, 0xffff0000, v156
    v_max3_f32 v174, v216, v217, v218
    v_max3_f32 v172, v220, v221, v224
    v_max_f32 v174, v174, v219
    v_max3_f32 v172, v172, v225, v222
    v_mov_b32 v176, v174
    v_max3_f32 v172, v172, v223, v226
    v_max_f32 v172, v172, v227
    v_permlane32_swap_b32 v174, v176
    v_mul_f32 v172, s58, v172
    v_max_f32 v174, v174, v176
    v_mul_f32 v174, s58, v174
    v_pk_fma_f32 v[220:221], v[220:221], s[58:59], v[172:173] op_sel_hi:[1,1,0] neg_lo:[0,0,1] neg_hi:[0,0,1]
    v_pk_fma_f32 v[222:223], v[222:223], s[58:59], v[172:173] op_sel_hi:[1,1,0] neg_lo:[0,0,1] neg_hi:[0,0,1]
    v_pk_fma_f32 v[224:225], v[224:225], s[58:59], v[172:173] op_sel_hi:[1,1,0] neg_lo:[0,0,1] neg_hi:[0,0,1]
    v_pk_fma_f32 v[226:227], v[226:227], s[58:59], v[172:173] op_sel_hi:[1,1,0] neg_lo:[0,0,1] neg_hi:[0,0,1]
    v_pk_fma_f32 v[216:217], v[216:217], s[58:59], v[174:175] op_sel_hi:[1,1,0] neg_lo:[0,0,1] neg_hi:[0,0,1]
    v_pk_fma_f32 v[218:219], v[218:219], s[58:59], v[174:175] op_sel_hi:[1,1,0] neg_lo:[0,0,1] neg_hi:[0,0,1]
    v_exp_f32 v216, v216
    v_exp_f32 v217, v217
    v_exp_f32 v218, v218
    v_exp_f32 v219, v219
    v_exp_f32 v220, v220
    v_exp_f32 v221, v221
    v_exp_f32 v222, v222
    v_exp_f32 v223, v223
    v_exp_f32 v224, v224
    v_exp_f32 v225, v225
    v_exp_f32 v226, v226
    v_exp_f32 v227, v227
    ds_read_b32 v3, v2 offset:28
    v_pk_add_f32 v[174:175], v[216:217], v[218:219]
    v_pk_add_f32 v[172:173], v[220:221], v[222:223]
    v_add_f32 v174, v174, v175
    v_pk_add_f32 v[178:179], v[224:225], v[226:227]
    v_mov_b32 v176, v174
    v_pk_add_f32 v[172:173], v[172:173], v[178:179]
    v_add_f32 v172, v172, v173
    v_permlane32_swap_b32 v174, v176
    v_rcp_f32 v172, v172
    v_add_f32 v174, v174, v176
    v_rcp_f32 v174, v174
    v_pk_mul_f32 v[220:221], v[220:221], v[172:173] op_sel_hi:[1,0]
    v_pk_mul_f32 v[222:223], v[222:223], v[172:173] op_sel_hi:[1,0]
    v_pk_mul_f32 v[224:225], v[224:225], v[172:173] op_sel_hi:[1,0]
    v_pk_mul_f32 v[226:227], v[226:227], v[172:173] op_sel_hi:[1,0]
    v_pk_mul_f32 v[216:217], v[216:217], v[174:175] op_sel_hi:[1,0]
    v_pk_mul_f32 v[218:219], v[218:219], v[174:175] op_sel_hi:[1,0]
    v_cvt_pk_bf16_f32 v156, v220, v221
    v_cvt_pk_bf16_f32 v164, v224, v225
    v_cvt_pk_bf16_f32 v160, v222, v223
    v_cvt_pk_bf16_f32 v168, v226, v227
    v_cvt_pk_bf16_f32 v148, v216, v217
    v_cvt_pk_bf16_f32 v152, v218, v219
    v_permlane32_swap_b32 v156, v164
    v_permlane32_swap_b32 v160, v168
    v_permlane16_swap_b32 v148, v152
    s_waitcnt lgkmcnt(0)
    v_permlane16_swap_b32 v156, v160
    v_permlane16_swap_b32 v164, v168
    v_readfirstlane_b32 s33, v3
    s_cmp_lt_u32 s33, 1811939332
    s_cbranch_scc1 K_PW
K_PR:
    s_and_b32 s3, s36, 0xffc00
    s_cbranch_scc0 K_NOHa3
    v_mov_b32 v4, s36
    s_mov_b32 exec_lo, s37
    s_mov_b32 exec_hi, 0
    global_atomic_add v37, v4, s[6:7] sc1
    s_mov_b64 exec, -1
K_NOHa3:
    v_perm_b32 v56, v148, v148, v24
    v_perm_b32 v57, v148, v148, v25
    v_perm_b32 v58, v148, v148, v26
    v_perm_b32 v59, v148, v148, v27
    v_perm_b32 v72, v152, v152, v24
    v_perm_b32 v73, v152, v152, v25
    v_mfma_f32_16x16x32_bf16 v[64:67], v[228:231], v[56:59], 0
    v_perm_b32 v74, v152, v152, v26
    v_perm_b32 v75, v152, v152, v27
    v_mfma_f32_16x16x32_bf16 v[60:63], v[242:245], v[56:59], 0
    v_perm_b32 v88, v156, v156, v24
    v_perm_b32 v89, v156, v156, v25
    v_mfma_f32_16x16x32_bf16 v[80:83], v[230:233], v[72:75], 0
    v_perm_b32 v90, v156, v156, v26
    v_perm_b32 v91, v156, v156, v27
    v_mfma_f32_16x16x32_bf16 v[76:79], v[244:247], v[72:75], 0
    v_perm_b32 v104, v160, v160, v24
    v_perm_b32 v105, v160, v160, v25
    v_mfma_f32_16x16x32_bf16 v[96:99], v[232:235], v[88:91], 0
    v_perm_b32 v106, v160, v160, v26
    v_perm_b32 v107, v160, v160, v27
    v_mfma_f32_16x16x32_bf16 v[92:95], v[246:249], v[88:91], 0
    v_cvt_pk_bf16_f32 v68, v64, v65
    v_cvt_pk_bf16_f32 v69, v66, v67
    ds_write_b64 v35, v[68:69] offset:0
    v_perm_b32 v120, v164, v164, v24
    v_perm_b32 v121, v164, v164, v25
    v_mfma_f32_16x16x32_bf16 v[112:115], v[234:237], v[104:107], 0
    v_perm_b32 v122, v164, v164, v26
    v_perm_b32 v123, v164, v164, v27
    v_mfma_f32_16x16x32_bf16 v[108:111], v[248:251], v[104:107], 0
    v_cvt_pk_bf16_f32 v70, v80, v81
    v_cvt_pk_bf16_f32 v71, v82, v83
    ds_write_b64 v35, v[70:71] offset:256
    v_perm_b32 v136, v168, v168, v24
    v_perm_b32 v137, v168, v168, v25
    v_mfma_f32_16x16x32_bf16 v[128:131], v[236:239], v[120:123], 0
    v_perm_b32 v138, v168, v168, v26
    v_perm_b32 v139, v168, v168, v27
    v_mfma_f32_16x16x32_bf16 v[124:127], v[250:253], v[120:123], 0
    v_cvt_pk_bf16_f32 v100, v96, v97
    v_cvt_pk_bf16_f32 v101, v98, v99
    ds_write_b64 v35, v[100:101] offset:512
    v_mov_b32 v3, 1
    v_mfma_f32_16x16x32_bf16 v[144:147], v[238:241], v[136:139], 0
    s_and_b32 s3, s36, 0x3ff
    s_cbranch_scc0 K_NOHa4
    v_mov_b32 v4, s36
    s_mov_b32 exec_lo, s37
    s_mov_b32 exec_hi, 0
    global_atomic_add v37, v4, s[6:7] sc1
    s_mov_b64 exec, -1
K_NOHa4:
    v_lshl_add_u32 v2, s54, 2, v38
    v_cvt_pk_bf16_f32 v102, v112, v113
    v_cvt_pk_bf16_f32 v103, v114, v115
    ds_write_b64 v35, v[102:103] offset:768
    v_mfma_f32_16x16x32_bf16 v[140:143], v[252:255], v[136:139], 0
    v_cvt_pk_bf16_f32 v132, v128, v129
    v_cvt_pk_bf16_f32 v133, v130, v131
    ds_write_b64 v35, v[132:133] offset:1024
    v_cvt_pk_bf16_f32 v134, v144, v145
    v_cvt_pk_bf16_f32 v135, v146, v147
    ds_write_b64 v35, v[134:135] offset:1280
    s_mov_b64 exec, 1
    ds_add_u32 v2, v3 offset:48
    s_mov_b64 exec, -1
    v_cvt_pk_bf16_f32 v52, v60, v61
    v_cvt_pk_bf16_f32 v54, v76, v77
    v_cvt_pk_bf16_f32 v53, v62, v63
    v_cvt_pk_bf16_f32 v55, v78, v79
    s_nop 0
    v_permlane16_swap_b32 v52, v54
    v_permlane16_swap_b32 v53, v55
    v_min_u32 v52, -2, v52
    buffer_store_dwordx4 v[52:55], v28, s[20:23], 0 offen sc1
    v_cvt_pk_bf16_f32 v84, v92, v93
    v_cvt_pk_bf16_f32 v86, v108, v109
    v_cvt_pk_bf16_f32 v85, v94, v95
    v_cvt_pk_bf16_f32 v87, v110, v111
    s_nop 0
    v_permlane16_swap_b32 v84, v86
    v_permlane16_swap_b32 v85, v87
    v_min_u32 v84, -2, v84
    buffer_store_dwordx4 v[84:87], v29, s[20:23], 0 offen sc1
    ds_read_b32 v3, v2 offset:48
    ds_read_b128 v[196:199], v36
    v_cvt_pk_bf16_f32 v116, v124, v125
    v_cvt_pk_bf16_f32 v118, v140, v141
    v_cvt_pk_bf16_f32 v117, v126, v127
    v_cvt_pk_bf16_f32 v119, v142, v143
    s_nop 0
    v_permlane16_swap_b32 v116, v118
    v_permlane16_swap_b32 v117, v119
    v_min_u32 v116, -2, v116
    buffer_store_dwordx4 v[116:119], v30, s[20:23], 0 offen sc1
    s_waitcnt lgkmcnt(0)
    v_readfirstlane_b32 s33, v3
    s_cmp_lt_u32 s33, 2
    s_cbranch_scc1 K_TW
K_TR:
    v_min_u32 v196, -2, v196
    buffer_store_dwordx4 v[196:199], v31, s[20:23], 0 offen sc1
    s_cmp_eq_u32 s34, -1
    s_cbranch_scc1 K_END
    s_add_u32 s30, s30, 4
    s_branch K_P2_HELP
K_CHM3:
K_STM3:
    s_branch K_WRET_M
    s_nop 0
K_XW:
    s_mov_b32 s3, 1048576
K_CGX:
    ds_read_b32 v3, v2 offset:28
    s_sub_u32 s3, s3, 1
    s_waitcnt lgkmcnt(0)
    v_readfirstlane_b32 s33, v3
    s_cselect_b32 s33, 1811939328, s33
    s_cmp_lt_u32 s33, 1811939328
    s_cbranch_scc1 K_CGX
    ds_read_b64 v[144:145], v34
    ds_read_b64 v[146:147], v34 offset:512
    ds_read_b64 v[242:243], v34 offset:1024
    ds_read_b64_tr_b16 v[228:229], v33
    s_waitcnt lgkmcnt(0)
    s_branch K_XR
K_PW:
    s_mov_b32 s3, 1048576
K_CGP:
    ds_read_b32 v3, v2 offset:28
    s_sub_u32 s3, s3, 1
    s_waitcnt lgkmcnt(0)
    v_readfirstlane_b32 s33, v3
    s_cselect_b32 s33, 1811939332, s33
    s_cmp_lt_u32 s33, 1811939332
    s_cbranch_scc1 K_CGP
    s_branch K_PR
K_TW:
    s_mov_b32 s3, 1048576
K_CGT:
    ds_read_b32 v3, v2 offset:48
    s_sub_u32 s3, s3, 1
    s_waitcnt lgkmcnt(0)
    v_readfirstlane_b32 s33, v3
    s_cselect_b32 s33, 2, s33
    s_cmp_lt_u32 s33, 2
    s_cbranch_scc1 K_CGT
    ds_read_b128 v[196:199], v36
    s_waitcnt lgkmcnt(0)
    s_branch K_TR
K_P2_EARLY:
    s_lshl_b32 s62, s40, 7
    v_lshrrev_b32 v8, 3, v1
    v_lshrrev_b32 v9, 4, v1
    v_mov_b32 v15, 158720
    s_lshl_b32 s61, s40, 3
    s_add_u32 s61, s61, s30
    s_mul_i32 s3, s61, 20480
    s_lshl_b32 s33, s41, 7
    s_add_u32 s3, s3, s33
    v_and_b32 v2, 7, v1
    v_lshlrev_b32 v2, 4, v2
    v_mul_u32_u24 v4, 1280, v8
    v_add3_u32 v10, v2, v4, s3
    s_lshl_b32 s3, s30, 7
    s_add_u32 s3, s3, 159744
    v_lshl_add_u32 v11, v8, 3, s3
    s_mov_b32 s63, 10240
    s_add_u32 s20, s6, 0x100000
    s_addc_u32 s21, s7, 0
    s_mov_b32 s22, 0x280000
    s_mov_b32 s23, 0x20000
    s_mov_b32 s56, s10
    s_mov_b32 s57, s11
    s_mov_b32 s58, 0x280000
    s_mov_b32 s59, 0x20000
    v_mul_u32_u24 v3, 144, v8
    v_add_u32 v3, v2, v3
    s_mul_i32 s3, s30, 2304
    s_add_u32 s3, s3, 140288
    v_add_u32 v14, s3, v3
    buffer_load_dwordx4 v[16:19], v10, s[12:15], 0 offen
    buffer_load_dwordx4 v[20:23], v10, s[12:15], s63 offen
    v_bfe_u32 v48, v1, 2, 2
    v_and_b32 v49, 3, v1
    s_add_u32 s3, s61, s30
    s_lshr_b32 s33, s3, 2
    s_mul_i32 s33, s33, 76
    s_add_u32 s3, s3, s33
    s_lshl_b32 s3, s3, 10
    v_and_b32 v2, 15, v1
    v_lshl_add_u32 v2, v2, 4, s3
    v_lshrrev_b32 v3, 5, v1
    v_lshl_add_u32 v2, v3, 8, v2
    v_and_b32 v4, 1, v9
    v_lshl_add_u32 v52, v4, 10, v2
    v_mov_b32 v53, 0x1f000
    v_lshl_add_u32 v2, v3, 3, v48
    v_lshlrev_b32 v2, 7, v2
    v_lshl_add_u32 v2, v49, 3, v2
    v_lshl_add_u32 v2, v4, 5, v2
    v_lshrrev_b32 v4, 1, v48
    v_lshl_add_u32 v54, v4, 6, v2
    v_xor_b32 v55, 64, v54
    v_mov_b32 v56, v54
    v_mov_b32 v57, v54
    s_branch K_PG3
.p2align 12
K_CHA0:
K_STA4:
    s_branch K_STA8
K_CHB0:
K_STB4:
    s_branch K_STB8
K_PG3:
    v_and_b32 v2, 31, v1
    v_mul_u32_u24 v2, 144, v2
    v_lshl_add_u32 v2, v3, 3, v2
    s_mul_i32 s3, s30, 4608
    s_add_u32 s3, s3, 140288
    v_add_u32 v50, s3, v2
    s_lshl_b32 s3, s40, 3
    s_mul_i32 s33, s3, 187
    s_lshr_b32 s33, s33, 11
    s_add_u32 s33, s33, 1
    s_mul_i32 s33, s33, 11
    s_add_u32 s3, s61, s30
    s_add_u32 s3, s3, 1
    s_cmp_ge_u32 s3, s33
    s_cselect_b32 s60, 24, 16
    s_cmp_gt_u32 s3, s33
    s_cselect_b32 s60, 20, s60
    v_add_u32 v58, s60, v15
    s_mov_b32 s64, -1
    s_mov_b32 s65, -1
    s_mov_b32 s66, -1
    s_mov_b32 s67, -1
    s_mov_b32 s68, -1
    s_mov_b32 s69, -1
    s_mov_b32 s70, 0xfffff
    s_mov_b32 s71, 131072
    v_mov_b32 v108, 0
    v_mov_b32 v109, 0
    v_mov_b32 v110, 0
    v_mov_b32 v111, 0
    v_mov_b32 v112, 0
    v_mov_b32 v113, 0
    v_mov_b32 v114, 0
    v_mov_b32 v115, 0
    v_mov_b32 v116, 0
    v_mov_b32 v117, 0
    v_mov_b32 v118, 0
    v_mov_b32 v119, 0
    v_mov_b32 v120, 0
    v_mov_b32 v121, 0
    v_mov_b32 v122, 0
    v_mov_b32 v123, 0
    v_mov_b32 v124, 0
    v_mov_b32 v125, 0
    v_mov_b32 v126, 0
    v_mov_b32 v127, 0
    v_mov_b32 v128, 0
    v_mov_b32 v129, 0
    v_mov_b32 v130, 0
    v_mov_b32 v131, 0
    v_mov_b32 v132, 0
    v_mov_b32 v133, 0
    v_mov_b32 v134, 0
    v_mov_b32 v135, 0
    v_mov_b32 v136, 0
    v_mov_b32 v137, 0
    v_mov_b32 v138, 0
    v_mov_b32 v139, 0
    s_barrier
    s_branch K_P2_AUXW
K_P2_GM:
    s_lshl_b32 s62, s40, 7
    v_lshrrev_b32 v8, 3, v1
    v_lshrrev_b32 v9, 4, v1
    v_mov_b32 v15, 158720
    s_lshl_b32 s61, s40, 3
    s_add_u32 s61, s61, s30
    s_mul_i32 s3, s61, 20480
    s_lshl_b32 s33, s41, 7
    s_add_u32 s3, s3, s33
    v_and_b32 v2, 7, v1
    v_lshlrev_b32 v2, 4, v2
    v_mul_u32_u24 v4, 1280, v8
    v_add3_u32 v10, v2, v4, s3
    s_lshl_b32 s3, s30, 7
    s_add_u32 s3, s3, 159744
    v_lshl_add_u32 v11, v8, 3, s3
    s_mov_b32 s63, 10240
    s_add_u32 s20, s6, 0x100000
    s_addc_u32 s21, s7, 0
    s_mov_b32 s22, 0x280000
    s_mov_b32 s23, 0x20000
    s_mov_b32 s56, s10
    s_mov_b32 s57, s11
    s_mov_b32 s58, 0x280000
    s_mov_b32 s59, 0x20000
    v_mul_u32_u24 v3, 144, v8
    v_add_u32 v3, v2, v3
    s_mul_i32 s3, s30, 2304
    s_add_u32 s3, s3, 140288
    v_add_u32 v14, s3, v3
    v_bfe_u32 v48, v1, 2, 2
    v_and_b32 v49, 3, v1
    s_add_u32 s3, s61, s30
    s_lshr_b32 s33, s3, 2
    s_mul_i32 s33, s33, 76
    s_add_u32 s3, s3, s33
    s_lshl_b32 s3, s3, 10
    v_and_b32 v2, 15, v1
    v_lshl_add_u32 v2, v2, 4, s3
    v_lshrrev_b32 v3, 5, v1
    v_lshl_add_u32 v2, v3, 8, v2
    v_and_b32 v4, 1, v9
    v_lshl_add_u32 v52, v4, 10, v2
    v_mov_b32 v53, 0x1f000
    v_lshl_add_u32 v2, v3, 3, v48
    v_lshlrev_b32 v2, 7, v2
    v_lshl_add_u32 v2, v49, 3, v2
    v_lshl_add_u32 v2, v4, 5, v2
    v_lshrrev_b32 v4, 1, v48
    v_lshl_add_u32 v54, v4, 6, v2
    v_xor_b32 v55, 64, v54
    v_mov_b32 v56, v54
    v_mov_b32 v57, v54
    v_and_b32 v2, 31, v1
    v_mul_u32_u24 v2, 144, v2
    v_lshl_add_u32 v2, v3, 3, v2
    s_mul_i32 s3, s30, 4608
    s_add_u32 s3, s3, 140288
    v_add_u32 v50, s3, v2
    s_lshl_b32 s3, s40, 3
    s_mul_i32 s33, s3, 187
    s_lshr_b32 s33, s33, 11
    s_add_u32 s33, s33, 1
    s_mul_i32 s33, s33, 11
    s_add_u32 s3, s61, s30
    s_add_u32 s3, s3, 1
    s_cmp_ge_u32 s3, s33
    s_cselect_b32 s60, 24, 16
    s_cmp_gt_u32 s3, s33
    s_cselect_b32 s60, 20, s60
    v_add_u32 v58, s60, v15
    s_mov_b32 s64, -1
    s_mov_b32 s65, -1
    s_mov_b32 s66, -1
    s_mov_b32 s67, -1
    s_mov_b32 s68, -1
    s_mov_b32 s69, -1
    s_mov_b32 s70, 0xfffff
    s_mov_b32 s71, 131072
    v_mov_b32 v108, 0
    v_mov_b32 v109, 0
    v_mov_b32 v110, 0
    v_mov_b32 v111, 0
    v_mov_b32 v112, 0
    v_mov_b32 v113, 0
    v_mov_b32 v114, 0
    v_mov_b32 v115, 0
    v_mov_b32 v116, 0
    v_mov_b32 v117, 0
    v_mov_b32 v118, 0
    v_mov_b32 v119, 0
    v_mov_b32 v120, 0
    v_mov_b32 v121, 0
    v_mov_b32 v122, 0
    v_mov_b32 v123, 0
    v_mov_b32 v124, 0
    v_mov_b32 v125, 0
    v_mov_b32 v126, 0
    v_mov_b32 v127, 0
    v_mov_b32 v128, 0
    v_mov_b32 v129, 0
    v_mov_b32 v130, 0
    v_mov_b32 v131, 0
    v_mov_b32 v132, 0
    v_mov_b32 v133, 0
    v_mov_b32 v134, 0
    v_mov_b32 v135, 0
    v_mov_b32 v136, 0
    v_mov_b32 v137, 0
    v_mov_b32 v138, 0
    v_mov_b32 v139, 0
    buffer_load_dwordx4 v[16:19], v10, s[12:15], 0 offen
    buffer_load_dwordx4 v[20:23], v10, s[12:15], s63 offen
    s_cmp_eq_u32 s30, 0
    s_cbranch_scc1 K_CHB0
    s_cmp_eq_u32 s30, 1
    s_cbranch_scc1 K_CHB1
    s_cmp_eq_u32 s30, 2
    s_cbranch_scc1 K_CHB2
    s_branch K_CHB3
K_WRET_B:
    v_mov_b32 v3, 1
    s_waitcnt vmcnt(2)
    s_mov_b64 exec, 1
    ds_add_u32 v15, v3 offset:44
    s_mov_b64 exec, -1
    s_mov_b32 s3, 1048576
K_P2_GWM:
    ds_read_b32 v2, v15 offset:44
    s_sleep 1
    s_sub_u32 s3, s3, 1
    s_waitcnt lgkmcnt(0)
    v_readfirstlane_b32 s33, v2
    s_nop 3
    s_cselect_b32 s33, 4, s33
    s_cmp_lt_u32 s33, 4
    s_cbranch_scc1 K_P2_GWM
    ds_write_b32 v15, v15 offset:56
K_P2_GEMM:
    s_setprio 1
    s_mul_i32 s52, s40, 1496
    s_add_u32 s53, s52, 1309
    s_lshr_b32 s52, s52, 11
    s_lshr_b32 s53, s53, 11
    s_sub_u32 s53, s53, s52
    s_mov_b32 s46, 0x84210
    s_mov_b32 s47, s46
    s_waitcnt vmcnt(0)
    v_lshlrev_b32 v32, 16, v16
    v_and_b32 v33, 0xffff0000, v16
    v_lshlrev_b32 v34, 16, v17
    v_and_b32 v35, 0xffff0000, v17
    v_lshlrev_b32 v36, 16, v18
    v_and_b32 v37, 0xffff0000, v18
    v_lshlrev_b32 v38, 16, v19
    v_and_b32 v39, 0xffff0000, v19
    v_lshlrev_b32 v40, 16, v20
    v_and_b32 v41, 0xffff0000, v20
    v_lshlrev_b32 v42, 16, v21
    v_and_b32 v43, 0xffff0000, v21
    v_lshlrev_b32 v44, 16, v22
    v_and_b32 v45, 0xffff0000, v22
    v_lshlrev_b32 v46, 16, v23
    v_and_b32 v47, 0xffff0000, v23
    s_branch K_SPL
K_IT0:
    v_mfma_f32_32x32x16_bf16 v[108:123], v[156:159], v[68:71], v[108:123]
    ds_read_b64_tr_b16 v[140:141], v56 offset:0
    ds_read_b64_tr_b16 v[142:143], v56 offset:512
    s_and_b32 s33, s50, s70
    s_cbranch_scc0 K_RF0
K_RB0:
    s_ff1_i32_b32 s51, s33
    ds_read_b64_tr_b16 v[144:145], v56 offset:2048
    v_mfma_f32_32x32x16_bf16 v[124:139], v[164:167], v[68:71], v[124:139]
    s_bitset0_b32 s70, s51
    s_lshl_b32 s64, s51, 12
    buffer_load_dwordx4 v[60:63], v52, s[20:23], s64 offen offset:0 sc1
    ds_read_b64_tr_b16 v[146:147], v56 offset:2560
    ds_read_b64_tr_b16 v[148:149], v57 offset:0
    v_mfma_f32_32x32x16_bf16 v[108:123], v[160:163], v[72:75], v[108:123]
    buffer_load_dwordx4 v[64:67], v52, s[20:23], s64 offen offset:512 sc1
    ds_read_b64_tr_b16 v[150:151], v57 offset:512
    ds_read_b64_tr_b16 v[152:153], v57 offset:2048
    ds_read_b64_tr_b16 v[154:155], v57 offset:2560
    v_mfma_f32_32x32x16_bf16 v[124:139], v[168:171], v[72:75], v[124:139]
K_TL0:
    s_waitcnt vmcnt(8) lgkmcnt(8)
    v_cmp_u_f32 vcc, v76, v80
    v_and_or_b32 v56, s68, v53, v54
    v_and_or_b32 v57, s68, v53, v55
    s_cbranch_vccnz K_FX1
K_IT1:
    v_mfma_f32_32x32x16_bf16 v[108:123], v[172:175], v[76:79], v[108:123]
    ds_read_b64_tr_b16 v[156:157], v56 offset:0
    ds_read_b64_tr_b16 v[158:159], v56 offset:512
    s_and_b32 s33, s50, s70
    s_cbranch_scc0 K_RF1
K_RB1:
    s_ff1_i32_b32 s51, s33
    ds_read_b64_tr_b16 v[160:161], v56 offset:2048
    v_mfma_f32_32x32x16_bf16 v[124:139], v[180:183], v[76:79], v[124:139]
    s_bitset0_b32 s70, s51
    s_lshl_b32 s65, s51, 12
    buffer_load_dwordx4 v[68:71], v52, s[20:23], s65 offen offset:0 sc1
    ds_read_b64_tr_b16 v[162:163], v56 offset:2560
    ds_read_b64_tr_b16 v[164:165], v57 offset:0
    v_mfma_f32_32x32x16_bf16 v[108:123], v[176:179], v[80:83], v[108:123]
    buffer_load_dwordx4 v[72:75], v52, s[20:23], s65 offen offset:512 sc1
    ds_read_b64_tr_b16 v[166:167], v57 offset:512
    ds_read_b64_tr_b16 v[168:169], v57 offset:2048
    ds_read_b64_tr_b16 v[170:171], v57 offset:2560
    v_mfma_f32_32x32x16_bf16 v[124:139], v[184:187], v[80:83], v[124:139]
K_TL1:
    s_waitcnt vmcnt(8) lgkmcnt(8)
    v_cmp_u_f32 vcc, v84, v88
    v_and_or_b32 v56, s69, v53, v54
    v_and_or_b32 v57, s69, v53, v55
    s_cbranch_vccnz K_FX2
K_IT2:
    v_mfma_f32_32x32x16_bf16 v[108:123], v[140:143], v[84:87], v[108:123]
    ds_read_b64_tr_b16 v[172:173], v56 offset:0
    ds_read_b64_tr_b16 v[174:175], v56 offset:512
    s_and_b32 s33, s50, s70
    s_cbranch_scc0 K_RF2
K_RB2:
    s_ff1_i32_b32 s51, s33
    ds_read_b64_tr_b16 v[176:177], v56 offset:2048
    v_mfma_f32_32x32x16_bf16 v[124:139], v[148:151], v[84:87], v[124:139]
    s_bitset0_b32 s70, s51
    s_lshl_b32 s66, s51, 12
    buffer_load_dwordx4 v[76:79], v52, s[20:23], s66 offen offset:0 sc1
    ds_read_b64_tr_b16 v[178:179], v56 offset:2560
    ds_read_b64_tr_b16 v[180:181], v57 offset:0
    v_mfma_f32_32x32x16_bf16 v[108:123], v[144:147], v[88:91], v[108:123]
    buffer_load_dwordx4 v[80:83], v52, s[20:23], s66 offen offset:512 sc1
    ds_read_b64_tr_b16 v[182:183], v57 offset:512
    ds_read_b64_tr_b16 v[184:185], v57 offset:2048
    ds_read_b64_tr_b16 v[186:187], v57 offset:2560
    v_mfma_f32_32x32x16_bf16 v[124:139], v[152:155], v[88:91], v[124:139]
K_TL2:
    s_waitcnt vmcnt(8) lgkmcnt(8)
    v_cmp_u_f32 vcc, v92, v96
    v_and_or_b32 v56, s64, v53, v54
    v_and_or_b32 v57, s64, v53, v55
    s_cbranch_vccnz K_FX3
K_IT3:
    v_mfma_f32_32x32x16_bf16 v[108:123], v[156:159], v[92:95], v[108:123]
    ds_read_b64_tr_b16 v[140:141], v56 offset:0
    ds_read_b64_tr_b16 v[142:143], v56 offset:512
    s_and_b32 s33, s50, s70
    s_cbranch_scc0 K_RF3
K_RB3:
    s_ff1_i32_b32 s51, s33
    ds_read_b64_tr_b16 v[144:145], v56 offset:2048
    v_mfma_f32_32x32x16_bf16 v[124:139], v[164:167], v[92:95], v[124:139]
    s_bitset0_b32 s70, s51
    s_lshl_b32 s67, s51, 12
    buffer_load_dwordx4 v[84:87], v52, s[20:23], s67 offen offset:0 sc1
    ds_read_b64_tr_b16 v[146:147], v56 offset:2560
    ds_read_b64_tr_b16 v[148:149], v57 offset:0
    v_mfma_f32_32x32x16_bf16 v[108:123], v[160:163], v[96:99], v[108:123]
    buffer_load_dwordx4 v[88:91], v52, s[20:23], s67 offen offset:512 sc1
    ds_read_b64_tr_b16 v[150:151], v57 offset:512
    ds_read_b64_tr_b16 v[152:153], v57 offset:2048
    ds_read_b64_tr_b16 v[154:155], v57 offset:2560
    v_mfma_f32_32x32x16_bf16 v[124:139], v[168:171], v[96:99], v[124:139]
K_TL3:
    s_waitcnt vmcnt(8) lgkmcnt(8)
    v_cmp_u_f32 vcc, v100, v104
    v_and_or_b32 v56, s65, v53, v54
    v_and_or_b32 v57, s65, v53, v55
    s_cbranch_vccnz K_FX4
K_IT4:
    v_mfma_f32_32x32x16_bf16 v[108:123], v[172:175], v[100:103], v[108:123]
    ds_read_b64_tr_b16 v[156:157], v56 offset:0
    ds_read_b64_tr_b16 v[158:159], v56 offset:512
    s_and_b32 s33, s50, s70
    s_cbranch_scc0 K_RF4
K_RB4:
    s_ff1_i32_b32 s51, s33
    ds_read_b64_tr_b16 v[160:161], v56 offset:2048
    v_mfma_f32_32x32x16_bf16 v[124:139], v[180:183], v[100:103], v[124:139]
    s_bitset0_b32 s70, s51
    s_lshl_b32 s68, s51, 12
    buffer_load_dwordx4 v[92:95], v52, s[20:23], s68 offen offset:0 sc1
    ds_read_b64_tr_b16 v[162:163], v56 offset:2560
    ds_read_b64_tr_b16 v[164:165], v57 offset:0
    v_mfma_f32_32x32x16_bf16 v[108:123], v[176:179], v[104:107], v[108:123]
    buffer_load_dwordx4 v[96:99], v52, s[20:23], s68 offen offset:512 sc1
    ds_read_b64_tr_b16 v[166:167], v57 offset:512
    ds_read_b64_tr_b16 v[168:169], v57 offset:2048
    ds_read_b64_tr_b16 v[170:171], v57 offset:2560
    v_mfma_f32_32x32x16_bf16 v[124:139], v[184:187], v[104:107], v[124:139]
K_TL4:
    s_waitcnt vmcnt(8) lgkmcnt(8)
    v_cmp_u_f32 vcc, v60, v64
    v_and_or_b32 v56, s66, v53, v54
    v_and_or_b32 v57, s66, v53, v55
    s_cbranch_vccnz K_FX5
K_IT5:
    v_mfma_f32_32x32x16_bf16 v[108:123], v[140:143], v[60:63], v[108:123]
    ds_read_b64_tr_b16 v[172:173], v56 offset:0
    ds_read_b64_tr_b16 v[174:175], v56 offset:512
    s_and_b32 s33, s50, s70
    s_cbranch_scc0 K_RF5
K_RB5:
    s_ff1_i32_b32 s51, s33
    ds_read_b64_tr_b16 v[176:177], v56 offset:2048
    v_mfma_f32_32x32x16_bf16 v[124:139], v[148:151], v[60:63], v[124:139]
    s_bitset0_b32 s70, s51
    s_lshl_b32 s69, s51, 12
    buffer_load_dwordx4 v[100:103], v52, s[20:23], s69 offen offset:0 sc1
    ds_read_b64_tr_b16 v[178:179], v56 offset:2560
    ds_read_b64_tr_b16 v[180:181], v57 offset:0
    v_mfma_f32_32x32x16_bf16 v[108:123], v[144:147], v[64:67], v[108:123]
    buffer_load_dwordx4 v[104:107], v52, s[20:23], s69 offen offset:512 sc1
    ds_read_b64_tr_b16 v[182:183], v57 offset:512
    ds_read_b64_tr_b16 v[184:185], v57 offset:2048
    ds_read_b64_tr_b16 v[186:187], v57 offset:2560
    v_mfma_f32_32x32x16_bf16 v[124:139], v[152:155], v[64:67], v[124:139]
K_TL5:
    s_waitcnt vmcnt(8) lgkmcnt(8)
    v_cmp_u_f32 vcc, v68, v72
    v_and_or_b32 v56, s67, v53, v54
    v_and_or_b32 v57, s67, v53, v55
    s_cbranch_vccnz K_FX0
    s_branch K_IT0
K_DR0:
    v_mfma_f32_32x32x16_bf16 v[108:123], v[156:159], v[68:71], v[108:123]
    ds_read_b64_tr_b16 v[140:141], v56 offset:0
    ds_read_b64_tr_b16 v[142:143], v56 offset:512
K_DM0:
    ds_read_b64_tr_b16 v[144:145], v56 offset:2048
    s_mov_b32 s64, -1
    v_mfma_f32_32x32x16_bf16 v[124:139], v[164:167], v[68:71], v[124:139]
    buffer_load_dword v3, v52, s[20:23], s64 offen
    ds_read_b64_tr_b16 v[146:147], v56 offset:2560
    ds_read_b64_tr_b16 v[148:149], v57 offset:0
    v_mfma_f32_32x32x16_bf16 v[108:123], v[160:163], v[72:75], v[108:123]
    buffer_load_dword v3, v52, s[20:23], s64 offen
    ds_read_b64_tr_b16 v[150:151], v57 offset:512
    ds_read_b64_tr_b16 v[152:153], v57 offset:2048
    ds_read_b64_tr_b16 v[154:155], v57 offset:2560
    v_mfma_f32_32x32x16_bf16 v[124:139], v[168:171], v[72:75], v[124:139]
    s_waitcnt vmcnt(8) lgkmcnt(8)
    v_cmp_u_f32 vcc, v76, v80
    v_and_or_b32 v56, s68, v53, v54
    v_and_or_b32 v57, s68, v53, v55
    v_mov_b32 v60, -1
    s_cbranch_vccnz K_FX1
K_DR1:
    v_mfma_f32_32x32x16_bf16 v[108:123], v[172:175], v[76:79], v[108:123]
    ds_read_b64_tr_b16 v[156:157], v56 offset:0
    ds_read_b64_tr_b16 v[158:159], v56 offset:512
K_DM1:
    ds_read_b64_tr_b16 v[160:161], v56 offset:2048
    s_mov_b32 s65, -1
    v_mfma_f32_32x32x16_bf16 v[124:139], v[180:183], v[76:79], v[124:139]
    buffer_load_dword v3, v52, s[20:23], s65 offen
    ds_read_b64_tr_b16 v[162:163], v56 offset:2560
    ds_read_b64_tr_b16 v[164:165], v57 offset:0
    v_mfma_f32_32x32x16_bf16 v[108:123], v[176:179], v[80:83], v[108:123]
    buffer_load_dword v3, v52, s[20:23], s65 offen
    ds_read_b64_tr_b16 v[166:167], v57 offset:512
    ds_read_b64_tr_b16 v[168:169], v57 offset:2048
    ds_read_b64_tr_b16 v[170:171], v57 offset:2560
    v_mfma_f32_32x32x16_bf16 v[124:139], v[184:187], v[80:83], v[124:139]
    s_waitcnt vmcnt(8) lgkmcnt(8)
    v_cmp_u_f32 vcc, v84, v88
    v_and_or_b32 v56, s69, v53, v54
    v_and_or_b32 v57, s69, v53, v55
    v_mov_b32 v68, -1
    s_cbranch_vccnz K_FX2
K_DR2:
    v_mfma_f32_32x32x16_bf16 v[108:123], v[140:143], v[84:87], v[108:123]
    ds_read_b64_tr_b16 v[172:173], v56 offset:0
    ds_read_b64_tr_b16 v[174:175], v56 offset:512
K_DM2:
    ds_read_b64_tr_b16 v[176:177], v56 offset:2048
    s_mov_b32 s66, -1
    v_mfma_f32_32x32x16_bf16 v[124:139], v[148:151], v[84:87], v[124:139]
    buffer_load_dword v3, v52, s[20:23], s66 offen
    ds_read_b64_tr_b16 v[178:179], v56 offset:2560
    ds_read_b64_tr_b16 v[180:181], v57 offset:0
    v_mfma_f32_32x32x16_bf16 v[108:123], v[144:147], v[88:91], v[108:123]
    buffer_load_dword v3, v52, s[20:23], s66 offen
    ds_read_b64_tr_b16 v[182:183], v57 offset:512
    ds_read_b64_tr_b16 v[184:185], v57 offset:2048
    ds_read_b64_tr_b16 v[186:187], v57 offset:2560
    v_mfma_f32_32x32x16_bf16 v[124:139], v[152:155], v[88:91], v[124:139]
    s_waitcnt vmcnt(8) lgkmcnt(8)
    v_cmp_u_f32 vcc, v92, v96
    v_and_or_b32 v56, s64, v53, v54
    v_and_or_b32 v57, s64, v53, v55
    v_mov_b32 v76, -1
    s_cbranch_vccnz K_FX3
K_DR3:
    v_mfma_f32_32x32x16_bf16 v[108:123], v[156:159], v[92:95], v[108:123]
    ds_read_b64_tr_b16 v[140:141], v56 offset:0
    ds_read_b64_tr_b16 v[142:143], v56 offset:512
K_DM3:
    ds_read_b64_tr_b16 v[144:145], v56 offset:2048
    s_mov_b32 s67, -1
    v_mfma_f32_32x32x16_bf16 v[124:139], v[164:167], v[92:95], v[124:139]
    buffer_load_dword v3, v52, s[20:23], s67 offen
    ds_read_b64_tr_b16 v[146:147], v56 offset:2560
    ds_read_b64_tr_b16 v[148:149], v57 offset:0
    v_mfma_f32_32x32x16_bf16 v[108:123], v[160:163], v[96:99], v[108:123]
    buffer_load_dword v3, v52, s[20:23], s67 offen
    ds_read_b64_tr_b16 v[150:151], v57 offset:512
    ds_read_b64_tr_b16 v[152:153], v57 offset:2048
    ds_read_b64_tr_b16 v[154:155], v57 offset:2560
    v_mfma_f32_32x32x16_bf16 v[124:139], v[168:171], v[96:99], v[124:139]
    s_waitcnt vmcnt(8) lgkmcnt(8)
    v_cmp_u_f32 vcc, v100, v104
    v_and_or_b32 v56, s65, v53, v54
    v_and_or_b32 v57, s65, v53, v55
    v_mov_b32 v84, -1
    s_cbranch_vccnz K_FX4
K_DR4:
    v_mfma_f32_32x32x16_bf16 v[108:123], v[172:175], v[100:103], v[108:123]
    ds_read_b64_tr_b16 v[156:157], v56 offset:0
    ds_read_b64_tr_b16 v[158:159], v56 offset:512
K_DM4:
    ds_read_b64_tr_b16 v[160:161], v56 offset:2048
    s_mov_b32 s68, -1
    v_mfma_f32_32x32x16_bf16 v[124:139], v[180:183], v[100:103], v[124:139]
    buffer_load_dword v3, v52, s[20:23], s68 offen
    ds_read_b64_tr_b16 v[162:163], v56 offset:2560
    ds_read_b64_tr_b16 v[164:165], v57 offset:0
    v_mfma_f32_32x32x16_bf16 v[108:123], v[176:179], v[104:107], v[108:123]
    buffer_load_dword v3, v52, s[20:23], s68 offen
    ds_read_b64_tr_b16 v[166:167], v57 offset:512
    ds_read_b64_tr_b16 v[168:169], v57 offset:2048
    ds_read_b64_tr_b16 v[170:171], v57 offset:2560
    v_mfma_f32_32x32x16_bf16 v[124:139], v[184:187], v[104:107], v[124:139]
    s_waitcnt vmcnt(8) lgkmcnt(8)
    v_cmp_u_f32 vcc, v60, v64
    v_and_or_b32 v56, s66, v53, v54
    v_and_or_b32 v57, s66, v53, v55
    v_mov_b32 v92, -1
    s_cbranch_vccnz K_FX5
K_DR5:
    v_mfma_f32_32x32x16_bf16 v[108:123], v[140:143], v[60:63], v[108:123]
    ds_read_b64_tr_b16 v[172:173], v56 offset:0
    ds_read_b64_tr_b16 v[174:175], v56 offset:512
K_DM5:
    ds_read_b64_tr_b16 v[176:177], v56 offset:2048
    s_mov_b32 s69, -1
    v_mfma_f32_32x32x16_bf16 v[124:139], v[148:151], v[60:63], v[124:139]
    buffer_load_dword v3, v52, s[20:23], s69 offen
    ds_read_b64_tr_b16 v[178:179], v56 offset:2560
    ds_read_b64_tr_b16 v[180:181], v57 offset:0
    v_mfma_f32_32x32x16_bf16 v[108:123], v[144:147], v[64:67], v[108:123]
    buffer_load_dword v3, v52, s[20:23], s69 offen
    ds_read_b64_tr_b16 v[182:183], v57 offset:512
    ds_read_b64_tr_b16 v[184:185], v57 offset:2048
    ds_read_b64_tr_b16 v[186:187], v57 offset:2560
    v_mfma_f32_32x32x16_bf16 v[124:139], v[152:155], v[64:67], v[124:139]
    s_waitcnt vmcnt(8) lgkmcnt(8)
    v_cmp_u_f32 vcc, v68, v72
    v_and_or_b32 v56, s67, v53, v54
    v_and_or_b32 v57, s67, v53, v55
    v_mov_b32 v100, -1
    s_cbranch_vccnz K_FX0
    s_branch K_DR0
K_CHA1:
K_STA5:
    s_branch K_STA9
K_CHB1:
K_STB5:
    s_branch K_STB9
K_RF0:
    s_cmp_eq_u32 s70, 0
    s_cbranch_scc1 K_DM0
    ds_read_b32 v59, v58
    s_waitcnt lgkmcnt(0)
    v_readfirstlane_b32 s50, v59
    s_and_b32 s33, s50, s70
    s_cbranch_scc1 K_RB0
K_NV0:
    ds_read_b64_tr_b16 v[144:145], v56 offset:2048
    v_mfma_f32_32x32x16_bf16 v[124:139], v[164:167], v[68:71], v[124:139]
    s_mov_b32 s64, -1
    v_mov_b32 v60, -1
    buffer_load_dword v3, v52, s[20:23], s64 offen
    ds_read_b64_tr_b16 v[146:147], v56 offset:2560
    ds_read_b64_tr_b16 v[148:149], v57 offset:0
    v_mfma_f32_32x32x16_bf16 v[108:123], v[160:163], v[72:75], v[108:123]
    buffer_load_dword v3, v52, s[20:23], s64 offen
    ds_read_b64_tr_b16 v[150:151], v57 offset:512
    ds_read_b64_tr_b16 v[152:153], v57 offset:2048
    ds_read_b64_tr_b16 v[154:155], v57 offset:2560
    v_mfma_f32_32x32x16_bf16 v[124:139], v[168:171], v[72:75], v[124:139]
    s_branch K_TL0
K_FX0:
    s_cmp_lt_i32 s65, 0
    s_cbranch_scc1 K_SK0
    v_max_u32 v2, v68, v72
    v_cmp_eq_u32 vcc, -1, v2
    s_cbranch_vccz K_IT0
    s_sub_u32 s71, s71, 1
    s_cbranch_scc1 K_IT0
    s_lshr_b32 s51, s65, 12
    s_bitset1_b32 s70, s51
K_SK0:
    s_and_b32 s33, s50, s70
    s_cbranch_scc0 K_NUL0
K_BK0:
    s_ff1_i32_b32 s51, s33
    s_lshl_b32 s64, s51, 12
    buffer_load_dwordx4 v[60:63], v52, s[20:23], s64 offen offset:0 sc1
    buffer_load_dwordx4 v[64:67], v52, s[20:23], s64 offen offset:512 sc1
    s_bitset0_b32 s70, s51
K_RD0:
    ds_read_b64_tr_b16 v[140:141], v56 offset:0
    ds_read_b64_tr_b16 v[142:143], v56 offset:512
    ds_read_b64_tr_b16 v[144:145], v56 offset:2048
    ds_read_b64_tr_b16 v[146:147], v56 offset:2560
    ds_read_b64_tr_b16 v[148:149], v57 offset:0
    ds_read_b64_tr_b16 v[150:151], v57 offset:512
    ds_read_b64_tr_b16 v[152:153], v57 offset:2048
    ds_read_b64_tr_b16 v[154:155], v57 offset:2560
    s_cmp_lt_i32 s66, 0
    s_cbranch_scc0 K_TL0
    v_and_or_b32 v56, s68, v53, v54
    v_and_or_b32 v57, s68, v53, v55
    s_branch K_SK1
K_NUL0:
    s_and_b32 s51, s66, s67
    s_and_b32 s51, s51, s68
    s_and_b32 s51, s51, s69
    s_cmp_lt_i32 s51, 0
    s_cbranch_scc0 K_PC0
    s_cmp_eq_u32 s70, 0
    s_cbranch_scc1 K_P2_MM
    s_branch K_SPN
K_PC0:
    s_cmp_eq_u32 s70, 0
    s_cbranch_scc1 K_NI0
    ds_read_b32 v59, v58
    s_waitcnt lgkmcnt(0)
    v_readfirstlane_b32 s50, v59
    s_and_b32 s33, s50, s70
    s_cbranch_scc1 K_BK0
    ds_read_b32 v59, v58
    s_waitcnt lgkmcnt(0)
    v_readfirstlane_b32 s50, v59
    s_and_b32 s33, s50, s70
    s_cbranch_scc1 K_BK0
K_NI0:
    s_mov_b32 s64, -1
    v_mov_b32 v60, -1
    buffer_load_dword v3, v52, s[20:23], s64 offen
    buffer_load_dword v3, v52, s[20:23], s64 offen
    s_branch K_RD0
K_RF1:
    s_cmp_eq_u32 s70, 0
    s_cbranch_scc1 K_DM1
    ds_read_b32 v59, v58
    s_waitcnt lgkmcnt(0)
    v_readfirstlane_b32 s50, v59
    s_and_b32 s33, s50, s70
    s_cbranch_scc1 K_RB1
K_NV1:
    ds_read_b64_tr_b16 v[160:161], v56 offset:2048
    v_mfma_f32_32x32x16_bf16 v[124:139], v[180:183], v[76:79], v[124:139]
    s_mov_b32 s65, -1
    v_mov_b32 v68, -1
    buffer_load_dword v3, v52, s[20:23], s65 offen
    ds_read_b64_tr_b16 v[162:163], v56 offset:2560
    ds_read_b64_tr_b16 v[164:165], v57 offset:0
    v_mfma_f32_32x32x16_bf16 v[108:123], v[176:179], v[80:83], v[108:123]
    buffer_load_dword v3, v52, s[20:23], s65 offen
    ds_read_b64_tr_b16 v[166:167], v57 offset:512
    ds_read_b64_tr_b16 v[168:169], v57 offset:2048
    ds_read_b64_tr_b16 v[170:171], v57 offset:2560
    v_mfma_f32_32x32x16_bf16 v[124:139], v[184:187], v[80:83], v[124:139]
    s_branch K_TL1
K_CHA2:
K_STA6:
    s_branch K_STA10
K_CHB2:
K_STB6:
    s_branch K_STB10
K_FX1:
    s_cmp_lt_i32 s66, 0
    s_cbranch_scc1 K_SK1
    v_max_u32 v2, v76, v80
    v_cmp_eq_u32 vcc, -1, v2
    s_cbranch_vccz K_IT1
    s_sub_u32 s71, s71, 1
    s_cbranch_scc1 K_IT1
    s_lshr_b32 s51, s66, 12
    s_bitset1_b32 s70, s51
K_SK1:
    s_and_b32 s33, s50, s70
    s_cbranch_scc0 K_NUL1
K_BK1:
    s_ff1_i32_b32 s51, s33
    s_lshl_b32 s65, s51, 12
    buffer_load_dwordx4 v[68:71], v52, s[20:23], s65 offen offset:0 sc1
    buffer_load_dwordx4 v[72:75], v52, s[20:23], s65 offen offset:512 sc1
    s_bitset0_b32 s70, s51
K_RD1:
    ds_read_b64_tr_b16 v[156:157], v56 offset:0
    ds_read_b64_tr_b16 v[158:159], v56 offset:512
    ds_read_b64_tr_b16 v[160:161], v56 offset:2048
    ds_read_b64_tr_b16 v[162:163], v56 offset:2560
    ds_read_b64_tr_b16 v[164:165], v57 offset:0
    ds_read_b64_tr_b16 v[166:167], v57 offset:512
    ds_read_b64_tr_b16 v[168:169], v57 offset:2048
    ds_read_b64_tr_b16 v[170:171], v57 offset:2560
    s_cmp_lt_i32 s67, 0
    s_cbranch_scc0 K_TL1
    v_and_or_b32 v56, s69, v53, v54
    v_and_or_b32 v57, s69, v53, v55
    s_branch K_SK2
K_NUL1:
    s_and_b32 s51, s64, s67
    s_and_b32 s51, s51, s68
    s_and_b32 s51, s51, s69
    s_cmp_lt_i32 s51, 0
    s_cbranch_scc0 K_PC1
    s_cmp_eq_u32 s70, 0
    s_cbranch_scc1 K_P2_MM
    s_branch K_SPN
K_PC1:
    s_cmp_eq_u32 s70, 0
    s_cbranch_scc1 K_NI1
    ds_read_b32 v59, v58
    s_waitcnt lgkmcnt(0)
    v_readfirstlane_b32 s50, v59
    s_and_b32 s33, s50, s70
    s_cbranch_scc1 K_BK1
    ds_read_b32 v59, v58
    s_waitcnt lgkmcnt(0)
    v_readfirstlane_b32 s50, v59
    s_and_b32 s33, s50, s70
    s_cbranch_scc1 K_BK1
K_NI1:
    s_mov_b32 s65, -1
    v_mov_b32 v68, -1
    buffer_load_dword v3, v52, s[20:23], s65 offen
    buffer_load_dword v3, v52, s[20:23], s65 offen
    s_branch K_RD1
K_RF2:
    s_cmp_eq_u32 s70, 0
    s_cbranch_scc1 K_DM2
    ds_read_b32 v59, v58
    s_waitcnt lgkmcnt(0)
    v_readfirstlane_b32 s50, v59
    s_and_b32 s33, s50, s70
    s_cbranch_scc1 K_RB2
K_NV2:
    ds_read_b64_tr_b16 v[176:177], v56 offset:2048
    v_mfma_f32_32x32x16_bf16 v[124:139], v[148:151], v[84:87], v[124:139]
    s_mov_b32 s66, -1
    v_mov_b32 v76, -1
    buffer_load_dword v3, v52, s[20:23], s66 offen
    ds_read_b64_tr_b16 v[178:179], v56 offset:2560
    ds_read_b64_tr_b16 v[180:181], v57 offset:0
    v_mfma_f32_32x32x16_bf16 v[108:123], v[144:147], v[88:91], v[108:123]
    buffer_load_dword v3, v52, s[20:23], s66 offen
    ds_read_b64_tr_b16 v[182:183], v57 offset:512
    ds_read_b64_tr_b16 v[184:185], v57 offset:2048
    ds_read_b64_tr_b16 v[186:187], v57 offset:2560
    v_mfma_f32_32x32x16_bf16 v[124:139], v[152:155], v[88:91], v[124:139]
    s_branch K_TL2
K_FX2:
    s_cmp_lt_i32 s67, 0
    s_cbranch_scc1 K_SK2
    v_max_u32 v2, v84, v88
    v_cmp_eq_u32 vcc, -1, v2
    s_cbranch_vccz K_IT2
    s_sub_u32 s71, s71, 1
    s_cbranch_scc1 K_IT2
    s_lshr_b32 s51, s67, 12
    s_bitset1_b32 s70, s51
K_SK2:
    s_and_b32 s33, s50, s70
    s_cbranch_scc0 K_NUL2
K_BK2:
    s_ff1_i32_b32 s51, s33
    s_lshl_b32 s66, s51, 12
    buffer_load_dwordx4 v[76:79], v52, s[20:23], s66 offen offset:0 sc1
    buffer_load_dwordx4 v[80:83], v52, s[20:23], s66 offen offset:512 sc1
    s_bitset0_b32 s70, s51
K_RD2:
    ds_read_b64_tr_b16 v[172:173], v56 offset:0
    ds_read_b64_tr_b16 v[174:175], v56 offset:512
    ds_read_b64_tr_b16 v[176:177], v56 offset:2048
    ds_read_b64_tr_b16 v[178:179], v56 offset:2560
    ds_read_b64_tr_b16 v[180:181], v57 offset:0
    ds_read_b64_tr_b16 v[182:183], v57 offset:512
    ds_read_b64_tr_b16 v[184:185], v57 offset:2048
    ds_read_b64_tr_b16 v[186:187], v57 offset:2560
    s_cmp_lt_i32 s68, 0
    s_cbranch_scc0 K_TL2
    s_branch K_PG4
.p2align 12
K_CHA3:
K_STA7:
    s_branch K_STA11
K_CHB3:
K_STB7:
    s_branch K_STB11
K_PG4:
    v_and_or_b32 v56, s64, v53, v54
    v_and_or_b32 v57, s64, v53, v55
    s_branch K_SK3
K_NUL2:
    s_and_b32 s51, s64, s65
    s_and_b32 s51, s51, s68
    s_and_b32 s51, s51, s69
    s_cmp_lt_i32 s51, 0
    s_cbranch_scc0 K_PC2
    s_cmp_eq_u32 s70, 0
    s_cbranch_scc1 K_P2_MM
    s_branch K_SPN
K_PC2:
    s_cmp_eq_u32 s70, 0
    s_cbranch_scc1 K_NI2
    ds_read_b32 v59, v58
    s_waitcnt lgkmcnt(0)
    v_readfirstlane_b32 s50, v59
    s_and_b32 s33, s50, s70
    s_cbranch_scc1 K_BK2
    ds_read_b32 v59, v58
    s_waitcnt lgkmcnt(0)
    v_readfirstlane_b32 s50, v59
    s_and_b32 s33, s50, s70
    s_cbranch_scc1 K_BK2
K_NI2:
    s_mov_b32 s66, -1
    v_mov_b32 v76, -1
    buffer_load_dword v3, v52, s[20:23], s66 offen
    buffer_load_dword v3, v52, s[20:23], s66 offen
    s_branch K_RD2
K_RF3:
    s_cmp_eq_u32 s70, 0
    s_cbranch_scc1 K_DM3
    ds_read_b32 v59, v58
    s_waitcnt lgkmcnt(0)
    v_readfirstlane_b32 s50, v59
    s_and_b32 s33, s50, s70
    s_cbranch_scc1 K_RB3
K_NV3:
    ds_read_b64_tr_b16 v[144:145], v56 offset:2048
    v_mfma_f32_32x32x16_bf16 v[124:139], v[164:167], v[92:95], v[124:139]
    s_mov_b32 s67, -1
    v_mov_b32 v84, -1
    buffer_load_dword v3, v52, s[20:23], s67 offen
    ds_read_b64_tr_b16 v[146:147], v56 offset:2560
    ds_read_b64_tr_b16 v[148:149], v57 offset:0
    v_mfma_f32_32x32x16_bf16 v[108:123], v[160:163], v[96:99], v[108:123]
    buffer_load_dword v3, v52, s[20:23], s67 offen
    ds_read_b64_tr_b16 v[150:151], v57 offset:512
    ds_read_b64_tr_b16 v[152:153], v57 offset:2048
    ds_read_b64_tr_b16 v[154:155], v57 offset:2560
    v_mfma_f32_32x32x16_bf16 v[124:139], v[168:171], v[96:99], v[124:139]
    s_branch K_TL3
K_FX3:
    s_cmp_lt_i32 s68, 0
    s_cbranch_scc1 K_SK3
    v_max_u32 v2, v92, v96
    v_cmp_eq_u32 vcc, -1, v2
    s_cbranch_vccz K_IT3
    s_sub_u32 s71, s71, 1
    s_cbranch_scc1 K_IT3
    s_lshr_b32 s51, s68, 12
    s_bitset1_b32 s70, s51
K_SK3:
    s_and_b32 s33, s50, s70
    s_cbranch_scc0 K_NUL3
K_BK3:
    s_ff1_i32_b32 s51, s33
    s_lshl_b32 s67, s51, 12
    buffer_load_dwordx4 v[84:87], v52, s[20:23], s67 offen offset:0 sc1
    buffer_load_dwordx4 v[88:91], v52, s[20:23], s67 offen offset:512 sc1
    s_bitset0_b32 s70, s51
K_RD3:
    ds_read_b64_tr_b16 v[140:141], v56 offset:0
    ds_read_b64_tr_b16 v[142:143], v56 offset:512
    ds_read_b64_tr_b16 v[144:145], v56 offset:2048
    ds_read_b64_tr_b16 v[146:147], v56 offset:2560
    ds_read_b64_tr_b16 v[148:149], v57 offset:0
    ds_read_b64_tr_b16 v[150:151], v57 offset:512
    ds_read_b64_tr_b16 v[152:153], v57 offset:2048
    ds_read_b64_tr_b16 v[154:155], v57 offset:2560
    s_cmp_lt_i32 s69, 0
    s_cbranch_scc0 K_TL3
    v_and_or_b32 v56, s65, v53, v54
    v_and_or_b32 v57, s65, v53, v55
    s_branch K_SK4
K_NUL3:
    s_and_b32 s51, s64, s65
    s_and_b32 s51, s51, s66
    s_and_b32 s51, s51, s69
    s_cmp_lt_i32 s51, 0
    s_cbranch_scc0 K_PC3
    s_cmp_eq_u32 s70, 0
    s_cbranch_scc1 K_P2_MM
    s_branch K_SPN
K_PC3:
    s_cmp_eq_u32 s70, 0
    s_cbranch_scc1 K_NI3
    ds_read_b32 v59, v58
    s_waitcnt lgkmcnt(0)
    v_readfirstlane_b32 s50, v59
    s_and_b32 s33, s50, s70
    s_cbranch_scc1 K_BK3
    ds_read_b32 v59, v58
    s_waitcnt lgkmcnt(0)
    v_readfirstlane_b32 s50, v59
    s_and_b32 s33, s50, s70
    s_cbranch_scc1 K_BK3
K_NI3:
    s_mov_b32 s67, -1
    v_mov_b32 v84, -1
    buffer_load_dword v3, v52, s[20:23], s67 offen
    buffer_load_dword v3, v52, s[20:23], s67 offen
    s_branch K_RD3
K_STA8:
    s_branch K_STA12
K_STB8:
    s_branch K_STB12
K_RF4:
    s_cmp_eq_u32 s70, 0
    s_cbranch_scc1 K_DM4
    ds_read_b32 v59, v58
    s_waitcnt lgkmcnt(0)
    v_readfirstlane_b32 s50, v59
    s_and_b32 s33, s50, s70
    s_cbranch_scc1 K_RB4
K_NV4:
    ds_read_b64_tr_b16 v[160:161], v56 offset:2048
    v_mfma_f32_32x32x16_bf16 v[124:139], v[180:183], v[100:103], v[124:139]
    s_mov_b32 s68, -1
    v_mov_b32 v92, -1
    buffer_load_dword v3, v52, s[20:23], s68 offen
    ds_read_b64_tr_b16 v[162:163], v56 offset:2560
    ds_read_b64_tr_b16 v[164:165], v57 offset:0
    v_mfma_f32_32x32x16_bf16 v[108:123], v[176:179], v[104:107], v[108:123]
    buffer_load_dword v3, v52, s[20:23], s68 offen
    ds_read_b64_tr_b16 v[166:167], v57 offset:512
    ds_read_b64_tr_b16 v[168:169], v57 offset:2048
    ds_read_b64_tr_b16 v[170:171], v57 offset:2560
    v_mfma_f32_32x32x16_bf16 v[124:139], v[184:187], v[104:107], v[124:139]
    s_branch K_TL4
K_FX4:
    s_cmp_lt_i32 s69, 0
    s_cbranch_scc1 K_SK4
    v_max_u32 v2, v100, v104
    v_cmp_eq_u32 vcc, -1, v2
    s_cbranch_vccz K_IT4
    s_sub_u32 s71, s71, 1
    s_cbranch_scc1 K_IT4
    s_lshr_b32 s51, s69, 12
    s_bitset1_b32 s70, s51
K_SK4:
    s_and_b32 s33, s50, s70
    s_cbranch_scc0 K_NUL4
K_BK4:
    s_ff1_i32_b32 s51, s33
    s_lshl_b32 s68, s51, 12
    buffer_load_dwordx4 v[92:95], v52, s[20:23], s68 offen offset:0 sc1
    buffer_load_dwordx4 v[96:99], v52, s[20:23], s68 offen offset:512 sc1
    s_bitset0_b32 s70, s51
K_RD4:
    ds_read_b64_tr_b16 v[156:157], v56 offset:0
    ds_read_b64_tr_b16 v[158:159], v56 offset:512
    ds_read_b64_tr_b16 v[160:161], v56 offset:2048
    ds_read_b64_tr_b16 v[162:163], v56 offset:2560
    ds_read_b64_tr_b16 v[164:165], v57 offset:0
    ds_read_b64_tr_b16 v[166:167], v57 offset:512
    ds_read_b64_tr_b16 v[168:169], v57 offset:2048
    ds_read_b64_tr_b16 v[170:171], v57 offset:2560
    s_cmp_lt_i32 s64, 0
    s_cbranch_scc0 K_TL4
    v_and_or_b32 v56, s66, v53, v54
    v_and_or_b32 v57, s66, v53, v55
    s_branch K_SK5
K_NUL4:
    s_and_b32 s51, s64, s65
    s_and_b32 s51, s51, s66
    s_and_b32 s51, s51, s67
    s_cmp_lt_i32 s51, 0
    s_cbranch_scc0 K_PC4
    s_cmp_eq_u32 s70, 0
    s_cbranch_scc1 K_P2_MM
    s_branch K_SPN
K_PC4:
    s_cmp_eq_u32 s70, 0
    s_cbranch_scc1 K_NI4
    ds_read_b32 v59, v58
    s_waitcnt lgkmcnt(0)
    v_readfirstlane_b32 s50, v59
    s_and_b32 s33, s50, s70
    s_cbranch_scc1 K_BK4
    ds_read_b32 v59, v58
    s_waitcnt lgkmcnt(0)
    v_readfirstlane_b32 s50, v59
    s_and_b32 s33, s50, s70
    s_cbranch_scc1 K_BK4
K_NI4:
    s_mov_b32 s68, -1
    v_mov_b32 v92, -1
    buffer_load_dword v3, v52, s[20:23], s68 offen
    buffer_load_dword v3, v52, s[20:23], s68 offen
    s_branch K_RD4
K_RF5:
    s_cmp_eq_u32 s70, 0
    s_cbranch_scc1 K_DM5
    ds_read_b32 v59, v58
    s_waitcnt lgkmcnt(0)
    v_readfirstlane_b32 s50, v59
    s_and_b32 s33, s50, s70
    s_cbranch_scc1 K_RB5
K_NV5:
    ds_read_b64_tr_b16 v[176:177], v56 offset:2048
    v_mfma_f32_32x32x16_bf16 v[124:139], v[148:151], v[60:63], v[124:139]
    s_mov_b32 s69, -1
    v_mov_b32 v100, -1
    buffer_load_dword v3, v52, s[20:23], s69 offen
    ds_read_b64_tr_b16 v[178:179], v56 offset:2560
    ds_read_b64_tr_b16 v[180:181], v57 offset:0
    v_mfma_f32_32x32x16_bf16 v[108:123], v[144:147], v[64:67], v[108:123]
    buffer_load_dword v3, v52, s[20:23], s69 offen
    ds_read_b64_tr_b16 v[182:183], v57 offset:512
    ds_read_b64_tr_b16 v[184:185], v57 offset:2048
    ds_read_b64_tr_b16 v[186:187], v57 offset:2560
    v_mfma_f32_32x32x16_bf16 v[124:139], v[152:155], v[64:67], v[124:139]
    s_branch K_TL5
K_STA9:
    s_branch K_STA13
K_STB9:
    s_branch K_STB13
K_FX5:
    s_cmp_lt_i32 s64, 0
    s_cbranch_scc1 K_SK5
    v_max_u32 v2, v60, v64
    v_cmp_eq_u32 vcc, -1, v2
    s_cbranch_vccz K_IT5
    s_sub_u32 s71, s71, 1
    s_cbranch_scc1 K_IT5
    s_lshr_b32 s51, s64, 12
    s_bitset1_b32 s70, s51
K_SK5:
    s_and_b32 s33, s50, s70
    s_cbranch_scc0 K_NUL5
K_BK5:
    s_ff1_i32_b32 s51, s33
    s_lshl_b32 s69, s51, 12
    buffer_load_dwordx4 v[100:103], v52, s[20:23], s69 offen offset:0 sc1
    buffer_load_dwordx4 v[104:107], v52, s[20:23], s69 offen offset:512 sc1
    s_bitset0_b32 s70, s51
K_RD5:
    ds_read_b64_tr_b16 v[172:173], v56 offset:0
    ds_read_b64_tr_b16 v[174:175], v56 offset:512
    ds_read_b64_tr_b16 v[176:177], v56 offset:2048
    ds_read_b64_tr_b16 v[178:179], v56 offset:2560
    ds_read_b64_tr_b16 v[180:181], v57 offset:0
    ds_read_b64_tr_b16 v[182:183], v57 offset:512
    ds_read_b64_tr_b16 v[184:185], v57 offset:2048
    ds_read_b64_tr_b16 v[186:187], v57 offset:2560
    s_cmp_lt_i32 s65, 0
    s_cbranch_scc0 K_TL5
    v_and_or_b32 v56, s67, v53, v54
    v_and_or_b32 v57, s67, v53, v55
    s_branch K_SK0
K_NUL5:
    s_and_b32 s51, s65, s66
    s_and_b32 s51, s51, s67
    s_and_b32 s51, s51, s68
    s_cmp_lt_i32 s51, 0
    s_cbranch_scc0 K_PC5
    s_cmp_eq_u32 s70, 0
    s_cbranch_scc1 K_P2_MM
    s_branch K_SPN
K_PC5:
    s_cmp_eq_u32 s70, 0
    s_cbranch_scc1 K_NI5
    ds_read_b32 v59, v58
    s_waitcnt lgkmcnt(0)
    v_readfirstlane_b32 s50, v59
    s_and_b32 s33, s50, s70
    s_cbranch_scc1 K_BK5
    ds_read_b32 v59, v58
    s_waitcnt lgkmcnt(0)
    v_readfirstlane_b32 s50, v59
    s_and_b32 s33, s50, s70
    s_cbranch_scc1 K_BK5
K_NI5:
    s_mov_b32 s69, -1
    v_mov_b32 v100, -1
    buffer_load_dword v3, v52, s[20:23], s69 offen
    buffer_load_dword v3, v52, s[20:23], s69 offen
    s_branch K_RD5
K_P2_MM:
    v_cvt_pk_bf16_f32 v188, v108, v109
    v_cvt_pk_bf16_f32 v189, v110, v111
    ds_write_b64 v50, v[188:189] offset:0
    v_cvt_pk_bf16_f32 v190, v112, v113
    v_cvt_pk_bf16_f32 v191, v114, v115
    ds_write_b64 v50, v[190:191] offset:16
    v_cvt_pk_bf16_f32 v192, v116, v117
    v_cvt_pk_bf16_f32 v193, v118, v119
    ds_write_b64 v50, v[192:193] offset:32
    v_cvt_pk_bf16_f32 v194, v120, v121
    v_cvt_pk_bf16_f32 v195, v122, v123
    ds_write_b64 v50, v[194:195] offset:48
    v_cvt_pk_bf16_f32 v188, v124, v125
    v_cvt_pk_bf16_f32 v189, v126, v127
    ds_write_b64 v50, v[188:189] offset:64
    v_cvt_pk_bf16_f32 v190, v128, v129
    v_cvt_pk_bf16_f32 v191, v130, v131
    ds_write_b64 v50, v[190:191] offset:80
    v_cvt_pk_bf16_f32 v192, v132, v133
    v_cvt_pk_bf16_f32 v193, v134, v135
    ds_write_b64 v50, v[192:193] offset:96
    v_cvt_pk_bf16_f32 v194, v136, v137
    v_cvt_pk_bf16_f32 v195, v138, v139
    ds_write_b64 v50, v[194:195] offset:112
K_P2_E2:
    s_waitcnt vmcnt(0) lgkmcnt(0)
    s_lshl_b32 s72, s61, 4
    s_barrier
    ds_read_b64 v[28:29], v15
    ds_read_b64 v[24:25], v11
    ds_read_b128 v[48:51], v14
    ds_read_b64 v[26:27], v11 offset:64
    ds_read_b128 v[52:55], v14 offset:1152
    s_waitcnt lgkmcnt(4)
    v_readfirstlane_b32 s48, v28
    v_readfirstlane_b32 s49, v29
    s_sub_u32 s3, s48, s72
    s_cmp_lt_u32 s3, 16
    s_cbranch_scc1 K_YROW0
K_NOY0:
    s_sub_u32 s3, s49, s72
    s_cmp_lt_u32 s3, 16
    s_cbranch_scc1 K_YROW1
K_NOY1:
    s_waitcnt lgkmcnt(3)
    v_pk_mul_f32 v[32:33], v[32:33], v[24:25] op_sel:[0,1] op_sel_hi:[1,1]
    v_pk_mul_f32 v[34:35], v[34:35], v[24:25] op_sel:[0,1] op_sel_hi:[1,1]
    v_pk_mul_f32 v[36:37], v[36:37], v[24:25] op_sel:[0,1] op_sel_hi:[1,1]
    v_pk_mul_f32 v[38:39], v[38:39], v[24:25] op_sel:[0,1] op_sel_hi:[1,1]
    s_waitcnt lgkmcnt(2)
    v_lshlrev_b32 v68, 16, v48
    v_and_b32 v69, 0xffff0000, v48
    v_pk_fma_f32 v[68:69], v[68:69], v[24:25], v[32:33] op_sel_hi:[1,0,1]
    v_cvt_pk_bf16_f32 v48, v68, v69
    v_lshlrev_b32 v70, 16, v49
    v_and_b32 v71, 0xffff0000, v49
    v_pk_fma_f32 v[70:71], v[70:71], v[24:25], v[34:35] op_sel_hi:[1,0,1]
    v_cvt_pk_bf16_f32 v49, v70, v71
    v_lshlrev_b32 v68, 16, v50
    v_and_b32 v69, 0xffff0000, v50
    v_pk_fma_f32 v[68:69], v[68:69], v[24:25], v[36:37] op_sel_hi:[1,0,1]
    v_cvt_pk_bf16_f32 v50, v68, v69
    v_lshlrev_b32 v70, 16, v51
    v_and_b32 v71, 0xffff0000, v51
    v_pk_fma_f32 v[70:71], v[70:71], v[24:25], v[38:39] op_sel_hi:[1,0,1]
    v_cvt_pk_bf16_f32 v51, v70, v71
    buffer_store_dwordx4 v[48:51], v10, s[56:59], 0 offen sc1
    s_waitcnt lgkmcnt(1)
    v_pk_mul_f32 v[40:41], v[40:41], v[26:27] op_sel:[0,1] op_sel_hi:[1,1]
    v_pk_mul_f32 v[42:43], v[42:43], v[26:27] op_sel:[0,1] op_sel_hi:[1,1]
    v_pk_mul_f32 v[44:45], v[44:45], v[26:27] op_sel:[0,1] op_sel_hi:[1,1]
    v_pk_mul_f32 v[46:47], v[46:47], v[26:27] op_sel:[0,1] op_sel_hi:[1,1]
    s_waitcnt lgkmcnt(0)
    v_lshlrev_b32 v68, 16, v52
    v_and_b32 v69, 0xffff0000, v52
    v_pk_fma_f32 v[68:69], v[68:69], v[26:27], v[40:41] op_sel_hi:[1,0,1]
    v_cvt_pk_bf16_f32 v52, v68, v69
    v_lshlrev_b32 v70, 16, v53
    v_and_b32 v71, 0xffff0000, v53
    v_pk_fma_f32 v[70:71], v[70:71], v[26:27], v[42:43] op_sel_hi:[1,0,1]
    v_cvt_pk_bf16_f32 v53, v70, v71
    v_lshlrev_b32 v68, 16, v54
    v_and_b32 v69, 0xffff0000, v54
    v_pk_fma_f32 v[68:69], v[68:69], v[26:27], v[44:45] op_sel_hi:[1,0,1]
    v_cvt_pk_bf16_f32 v54, v68, v69
    v_lshlrev_b32 v70, 16, v55
    v_and_b32 v71, 0xffff0000, v55
    v_pk_fma_f32 v[70:71], v[70:71], v[26:27], v[46:47] op_sel_hi:[1,0,1]
    v_cvt_pk_bf16_f32 v55, v70, v71
    buffer_store_dwordx4 v[52:55], v10, s[56:59], s63 offen sc1
K_END:
K_EXIT:
    s_endpgm
K_YROW0:
    v_and_b32 v2, 7, v1
    v_lshlrev_b32 v2, 5, v2
    v_add_u32 v2, 158976, v2
    ds_read_b128 v[56:59], v2
    ds_read_b128 v[60:63], v2 offset:16
    s_and_b32 s33, s3, 7
    v_cmp_eq_u32 vcc, s33, v8
    s_cmp_ge_u32 s3, 8
    s_cbranch_scc1 K_YR1_0
    s_waitcnt lgkmcnt(0)
    v_add_f32 v64, v32, v56
    v_cvt_pk_bf16_f32 v64, v64, v64
    v_lshlrev_b32 v64, 16, v64
    v_cndmask_b32 v32, v32, v64, vcc
    v_add_f32 v65, v33, v57
    v_cvt_pk_bf16_f32 v65, v65, v65
    v_lshlrev_b32 v65, 16, v65
    v_cndmask_b32 v33, v33, v65, vcc
    v_add_f32 v66, v34, v58
    v_cvt_pk_bf16_f32 v66, v66, v66
    v_lshlrev_b32 v66, 16, v66
    v_cndmask_b32 v34, v34, v66, vcc
    v_add_f32 v67, v35, v59
    v_cvt_pk_bf16_f32 v67, v67, v67
    v_lshlrev_b32 v67, 16, v67
    v_cndmask_b32 v35, v35, v67, vcc
    v_add_f32 v64, v36, v60
    v_cvt_pk_bf16_f32 v64, v64, v64
    v_lshlrev_b32 v64, 16, v64
    v_cndmask_b32 v36, v36, v64, vcc
    v_add_f32 v65, v37, v61
    v_cvt_pk_bf16_f32 v65, v65, v65
    v_lshlrev_b32 v65, 16, v65
    v_cndmask_b32 v37, v37, v65, vcc
    v_add_f32 v66, v38, v62
    v_cvt_pk_bf16_f32 v66, v66, v66
    v_lshlrev_b32 v66, 16, v66
    v_cndmask_b32 v38, v38, v66, vcc
    v_add_f32 v67, v39, v63
    v_cvt_pk_bf16_f32 v67, v67, v67
    v_lshlrev_b32 v67, 16, v67
    v_cndmask_b32 v39, v39, v67, vcc
    s_branch K_NOY0
K_YR1_0:
    s_waitcnt lgkmcnt(0)
    v_add_f32 v64, v40, v56
    v_cvt_pk_bf16_f32 v64, v64, v64
    v_lshlrev_b32 v64, 16, v64
    v_cndmask_b32 v40, v40, v64, vcc
    v_add_f32 v65, v41, v57
    v_cvt_pk_bf16_f32 v65, v65, v65
    v_lshlrev_b32 v65, 16, v65
    v_cndmask_b32 v41, v41, v65, vcc
    v_add_f32 v66, v42, v58
    v_cvt_pk_bf16_f32 v66, v66, v66
    v_lshlrev_b32 v66, 16, v66
    v_cndmask_b32 v42, v42, v66, vcc
    v_add_f32 v67, v43, v59
    v_cvt_pk_bf16_f32 v67, v67, v67
    v_lshlrev_b32 v67, 16, v67
    v_cndmask_b32 v43, v43, v67, vcc
    v_add_f32 v64, v44, v60
    v_cvt_pk_bf16_f32 v64, v64, v64
    v_lshlrev_b32 v64, 16, v64
    v_cndmask_b32 v44, v44, v64, vcc
    v_add_f32 v65, v45, v61
    v_cvt_pk_bf16_f32 v65, v65, v65
    v_lshlrev_b32 v65, 16, v65
    v_cndmask_b32 v45, v45, v65, vcc
    v_add_f32 v66, v46, v62
    v_cvt_pk_bf16_f32 v66, v66, v66
    v_lshlrev_b32 v66, 16, v66
    v_cndmask_b32 v46, v46, v66, vcc
    v_add_f32 v67, v47, v63
    v_cvt_pk_bf16_f32 v67, v67, v67
    v_lshlrev_b32 v67, 16, v67
    v_cndmask_b32 v47, v47, v67, vcc
    s_branch K_NOY0
K_YROW1:
    v_and_b32 v2, 7, v1
    v_lshlrev_b32 v2, 5, v2
    v_add_u32 v2, 159232, v2
    ds_read_b128 v[56:59], v2
    ds_read_b128 v[60:63], v2 offset:16
    s_and_b32 s33, s3, 7
    v_cmp_eq_u32 vcc, s33, v8
    s_cmp_ge_u32 s3, 8
    s_cbranch_scc1 K_YR1_1
    s_waitcnt lgkmcnt(0)
    v_add_f32 v64, v32, v56
    v_cvt_pk_bf16_f32 v64, v64, v64
    v_lshlrev_b32 v64, 16, v64
    v_cndmask_b32 v32, v32, v64, vcc
    v_add_f32 v65, v33, v57
    v_cvt_pk_bf16_f32 v65, v65, v65
    v_lshlrev_b32 v65, 16, v65
    v_cndmask_b32 v33, v33, v65, vcc
    v_add_f32 v66, v34, v58
    v_cvt_pk_bf16_f32 v66, v66, v66
    v_lshlrev_b32 v66, 16, v66
    v_cndmask_b32 v34, v34, v66, vcc
    v_add_f32 v67, v35, v59
    v_cvt_pk_bf16_f32 v67, v67, v67
    v_lshlrev_b32 v67, 16, v67
    v_cndmask_b32 v35, v35, v67, vcc
    v_add_f32 v64, v36, v60
    v_cvt_pk_bf16_f32 v64, v64, v64
    v_lshlrev_b32 v64, 16, v64
    v_cndmask_b32 v36, v36, v64, vcc
    v_add_f32 v65, v37, v61
    v_cvt_pk_bf16_f32 v65, v65, v65
    v_lshlrev_b32 v65, 16, v65
    v_cndmask_b32 v37, v37, v65, vcc
    v_add_f32 v66, v38, v62
    v_cvt_pk_bf16_f32 v66, v66, v66
    v_lshlrev_b32 v66, 16, v66
    v_cndmask_b32 v38, v38, v66, vcc
    v_add_f32 v67, v39, v63
    v_cvt_pk_bf16_f32 v67, v67, v67
    v_lshlrev_b32 v67, 16, v67
    v_cndmask_b32 v39, v39, v67, vcc
    s_branch K_NOY1
K_YR1_1:
    s_waitcnt lgkmcnt(0)
    v_add_f32 v64, v40, v56
    v_cvt_pk_bf16_f32 v64, v64, v64
    v_lshlrev_b32 v64, 16, v64
    v_cndmask_b32 v40, v40, v64, vcc
    v_add_f32 v65, v41, v57
    v_cvt_pk_bf16_f32 v65, v65, v65
    v_lshlrev_b32 v65, 16, v65
    v_cndmask_b32 v41, v41, v65, vcc
    v_add_f32 v66, v42, v58
    v_cvt_pk_bf16_f32 v66, v66, v66
    v_lshlrev_b32 v66, 16, v66
    v_cndmask_b32 v42, v42, v66, vcc
    v_add_f32 v67, v43, v59
    v_cvt_pk_bf16_f32 v67, v67, v67
    v_lshlrev_b32 v67, 16, v67
    v_cndmask_b32 v43, v43, v67, vcc
    v_add_f32 v64, v44, v60
    v_cvt_pk_bf16_f32 v64, v64, v64
    v_lshlrev_b32 v64, 16, v64
    v_cndmask_b32 v44, v44, v64, vcc
    v_add_f32 v65, v45, v61
    v_cvt_pk_bf16_f32 v65, v65, v65
    v_lshlrev_b32 v65, 16, v65
    v_cndmask_b32 v45, v45, v65, vcc
    v_add_f32 v66, v46, v62
    v_cvt_pk_bf16_f32 v66, v66, v66
    v_lshlrev_b32 v66, 16, v66
    v_cndmask_b32 v46, v46, v66, vcc
    v_add_f32 v67, v47, v63
    v_cvt_pk_bf16_f32 v67, v67, v67
    v_lshlrev_b32 v67, 16, v67
    v_cndmask_b32 v47, v47, v67, vcc
    s_branch K_NOY1
K_STA10:
    s_branch K_STA14
K_STB10:
    s_branch K_STB14
K_P2:
    s_cmp_ge_u32 s30, 4
    s_cbranch_scc1 K_P2_HELP
    s_lshl_b32 s62, s40, 7
    v_lshrrev_b32 v8, 3, v1
    v_lshrrev_b32 v9, 4, v1
    v_mov_b32 v15, 158720
    s_lshl_b32 s61, s40, 3
    s_add_u32 s61, s61, s30
    s_mul_i32 s3, s61, 20480
    s_lshl_b32 s33, s41, 7
    s_add_u32 s3, s3, s33
    v_and_b32 v2, 7, v1
    v_lshlrev_b32 v2, 4, v2
    v_mul_u32_u24 v4, 1280, v8
    v_add3_u32 v10, v2, v4, s3
    s_lshl_b32 s3, s30, 7
    s_add_u32 s3, s3, 159744
    v_lshl_add_u32 v11, v8, 3, s3
    s_mov_b32 s63, 10240
    s_add_u32 s20, s6, 0x100000
    s_addc_u32 s21, s7, 0
    s_mov_b32 s22, 0x280000
    s_mov_b32 s23, 0x20000
    s_mov_b32 s56, s10
    s_mov_b32 s57, s11
    s_mov_b32 s58, 0x280000
    s_mov_b32 s59, 0x20000
    v_mul_u32_u24 v3, 144, v8
    v_add_u32 v3, v2, v3
    s_mul_i32 s3, s30, 2304
    s_add_u32 s3, s3, 140288
    v_add_u32 v14, s3, v3
    buffer_load_dwordx4 v[16:19], v10, s[12:15], 0 offen
    buffer_load_dwordx4 v[20:23], v10, s[12:15], s63 offen
    v_bfe_u32 v48, v1, 2, 2
    v_and_b32 v49, 3, v1
    s_add_u32 s3, s61, s30
    s_lshr_b32 s33, s3, 2
    s_mul_i32 s33, s33, 76
    s_add_u32 s3, s3, s33
    s_lshl_b32 s3, s3, 10
    v_and_b32 v2, 15, v1
    v_lshl_add_u32 v2, v2, 4, s3
    v_lshrrev_b32 v3, 5, v1
    v_lshl_add_u32 v2, v3, 8, v2
    v_and_b32 v4, 1, v9
    v_lshl_add_u32 v52, v4, 10, v2
    v_mov_b32 v53, 0x1f000
    v_lshl_add_u32 v2, v3, 3, v48
    v_lshlrev_b32 v2, 7, v2
    v_lshl_add_u32 v2, v49, 3, v2
    v_lshl_add_u32 v2, v4, 5, v2
    v_lshrrev_b32 v4, 1, v48
    v_lshl_add_u32 v54, v4, 6, v2
    v_xor_b32 v55, 64, v54
    v_mov_b32 v56, v54
    v_mov_b32 v57, v54
    v_and_b32 v2, 31, v1
    v_mul_u32_u24 v2, 144, v2
    v_lshl_add_u32 v2, v3, 3, v2
    s_mul_i32 s3, s30, 4608
    s_add_u32 s3, s3, 140288
    v_add_u32 v50, s3, v2
    s_lshl_b32 s3, s40, 3
    s_mul_i32 s33, s3, 187
    s_lshr_b32 s33, s33, 11
    s_add_u32 s33, s33, 1
    s_mul_i32 s33, s33, 11
    s_add_u32 s3, s61, s30
    s_add_u32 s3, s3, 1
    s_cmp_ge_u32 s3, s33
    s_cselect_b32 s60, 24, 16
    s_cmp_gt_u32 s3, s33
    s_cselect_b32 s60, 20, s60
    v_add_u32 v58, s60, v15
    s_mov_b32 s64, -1
    s_mov_b32 s65, -1
    s_mov_b32 s66, -1
    s_mov_b32 s67, -1
    s_mov_b32 s68, -1
    s_mov_b32 s69, -1
    s_mov_b32 s70, 0xfffff
    s_mov_b32 s71, 131072
    v_mov_b32 v108, 0
    v_mov_b32 v109, 0
    v_mov_b32 v110, 0
    v_mov_b32 v111, 0
    v_mov_b32 v112, 0
    v_mov_b32 v113, 0
    v_mov_b32 v114, 0
    v_mov_b32 v115, 0
    v_mov_b32 v116, 0
    v_mov_b32 v117, 0
    v_mov_b32 v118, 0
    v_mov_b32 v119, 0
    v_mov_b32 v120, 0
    v_mov_b32 v121, 0
    v_mov_b32 v122, 0
    v_mov_b32 v123, 0
    v_mov_b32 v124, 0
    v_mov_b32 v125, 0
    v_mov_b32 v126, 0
    v_mov_b32 v127, 0
    v_mov_b32 v128, 0
    v_mov_b32 v129, 0
    v_mov_b32 v130, 0
    v_mov_b32 v131, 0
    v_mov_b32 v132, 0
    v_mov_b32 v133, 0
    v_mov_b32 v134, 0
    v_mov_b32 v135, 0
    v_mov_b32 v136, 0
    v_mov_b32 v137, 0
    v_mov_b32 v138, 0
    v_mov_b32 v139, 0
K_P2_AUXW:
    v_lshrrev_b32 v2, 3, v1
    v_mul_u32_u24 v2, 1280, v2
    v_lshrrev_b32 v3, 2, v1
    v_and_b32 v3, 4, v3
    v_and_b32 v4, 7, v1
    v_xor_b32 v3, v3, v4
    v_lshl_add_u32 v2, v3, 4, v2
    s_lshl_b32 s33, s41, 7
    v_add_u32 v51, s33, v2
    v_lshrrev_b32 v5, 5, v1
    v_mul_u32_u24 v5, 20480, v5
    v_add_u32 v5, v5, v51
    s_lshl_b32 s52, s30, 2
    s_lshr_b32 s52, 0x7520, s52
    s_and_b32 s52, s52, 7
    s_mul_i32 s52, s52, 51200
    s_lshl_b32 s53, s30, 12
    s_add_u32 s60, s52, 0
    s_add_u32 m0, s53, 0
    s_waitcnt vmcnt(5)
    buffer_load_dwordx4 v51, s[24:27], s60 offen lds
    s_add_u32 s60, s52, 10240
    s_add_u32 m0, s53, 1024
    s_waitcnt vmcnt(5)
    buffer_load_dwordx4 v51, s[24:27], s60 offen lds
    s_add_u32 s60, s52, 25600
    s_add_u32 m0, s53, 2048
    s_waitcnt vmcnt(5)
    buffer_load_dwordx4 v51, s[24:27], s60 offen lds
    s_add_u32 s60, s52, 35840
    s_add_u32 m0, s53, 3072
    s_waitcnt vmcnt(5)
    buffer_load_dwordx4 v51, s[24:27], s60 offen lds
    s_add_u32 s60, s52, 409600
    s_add_u32 m0, s53, 20480
    s_waitcnt vmcnt(5)
    buffer_load_dwordx4 v51, s[24:27], s60 offen lds
    s_add_u32 s60, s52, 419840
    s_add_u32 m0, s53, 21504
    s_waitcnt vmcnt(5)
    buffer_load_dwordx4 v51, s[24:27], s60 offen lds
    v_mov_b32 v3, 1
    s_mov_b64 exec, 1
    ds_add_u32 v15, v3 offset:52
    s_mov_b64 exec, -1
    s_add_u32 s60, s52, 435200
    s_add_u32 m0, s53, 22528
    s_waitcnt vmcnt(5)
    buffer_load_dwordx4 v51, s[24:27], s60 offen lds
    s_add_u32 s60, s52, 445440
    s_add_u32 m0, s53, 23552
    s_waitcnt vmcnt(5)
    buffer_load_dwordx4 v51, s[24:27], s60 offen lds
    s_lshl_b32 s53, s30, 10
    s_add_u32 s60, s52, 20480
    s_add_u32 m0, s53, 16384
    s_waitcnt vmcnt(5)
    buffer_load_dwordx4 v5, s[24:27], s60 offen lds
    s_add_u32 s60, s52, 430080
    s_add_u32 m0, s53, 36864
    s_waitcnt vmcnt(5)
    buffer_load_dwordx4 v5, s[24:27], s60 offen lds
    s_cmp_eq_u32 s30, 0
    s_cbranch_scc1 K_CHA0
    s_cmp_eq_u32 s30, 1
    s_cbranch_scc1 K_CHA1
    s_cmp_eq_u32 s30, 2
    s_cbranch_scc1 K_CHA2
    s_branch K_CHA3
K_WRET_A:
    v_mov_b32 v3, 1
    s_waitcnt vmcnt(0)
    s_mov_b64 exec, 1
    ds_add_u32 v15, v3 offset:44
    s_mov_b64 exec, -1
    s_mov_b32 s3, 1048576
K_P2_GWA:
    ds_read_b32 v2, v15 offset:44
    s_sub_u32 s3, s3, 1
    s_waitcnt lgkmcnt(0)
    v_readfirstlane_b32 s33, v2
    s_nop 3
    s_cselect_b32 s33, 4, s33
    s_cmp_lt_u32 s33, 4
    s_cbranch_scc1 K_P2_GWA
    s_branch K_P2_GEMM
K_STA11:
    s_branch K_STA15
K_STB11:
    s_branch K_STB15
K_P2_HELP:
    s_setprio 3
    s_cmp_eq_u32 s30, 7
    s_cbranch_scc1 K_P2_W7
    s_cmp_eq_u32 s30, 4
    s_cbranch_scc1 K_P2_NL
    s_cmp_ge_u32 s29, 8
    s_cbranch_scc1 K_P2_NL
    s_mov_b32 s24, s8
    s_mov_b32 s25, s9
    s_mov_b32 s26, 0xc8000
    s_mov_b32 s27, 0x20000
    v_lshrrev_b32 v2, 3, v1
    v_mul_u32_u24 v2, 1280, v2
    v_lshrrev_b32 v3, 2, v1
    v_and_b32 v3, 4, v3
    v_and_b32 v4, 7, v1
    v_xor_b32 v3, v3, v4
    v_lshl_add_u32 v2, v3, 4, v2
    s_lshl_b32 s33, s41, 7
    v_add_u32 v12, s33, v2
    v_lshrrev_b32 v5, 5, v1
    v_mul_u32_u24 v5, 20480, v5
    v_add_u32 v5, v5, v12
    s_sub_u32 s61, s30, 5
    s_lshl_b32 s52, s61, 2
    s_lshr_b32 s52, 0x6431, s52
    s_and_b32 s52, s52, 7
    s_mul_i32 s52, s52, 51200
    s_lshl_b32 s53, s61, 12
    s_add_u32 s60, s52, 0
    s_add_u32 m0, s53, 40960
    s_nop 0
    buffer_load_dwordx4 v12, s[24:27], s60 offen lds
    s_add_u32 s60, s52, 10240
    s_add_u32 m0, s53, 41984
    s_nop 0
    buffer_load_dwordx4 v12, s[24:27], s60 offen lds
    s_add_u32 s60, s52, 25600
    s_add_u32 m0, s53, 43008
    s_nop 0
    buffer_load_dwordx4 v12, s[24:27], s60 offen lds
    s_branch K_PG5
.p2align 12
K_STA12:
    s_branch K_WRET_A
K_STB12:
    s_branch K_WRET_B
K_PG5:
    s_add_u32 s60, s52, 35840
    s_add_u32 m0, s53, 44032
    s_nop 0
    buffer_load_dwordx4 v12, s[24:27], s60 offen lds
    s_add_u32 s60, s52, 409600
    s_add_u32 m0, s53, 61440
    s_nop 0
    buffer_load_dwordx4 v12, s[24:27], s60 offen lds
    s_add_u32 s60, s52, 419840
    s_add_u32 m0, s53, 62464
    s_nop 0
    buffer_load_dwordx4 v12, s[24:27], s60 offen lds
    s_add_u32 s60, s52, 435200
    s_add_u32 m0, s53, 63488
    s_nop 0
    buffer_load_dwordx4 v12, s[24:27], s60 offen lds
    s_add_u32 s60, s52, 445440
    s_add_u32 m0, s53, 64512
    s_nop 0
    buffer_load_dwordx4 v12, s[24:27], s60 offen lds
    s_lshl_b32 s53, s61, 10
    s_add_u32 s60, s52, 20480
    s_add_u32 m0, s53, 57344
    s_nop 0
    buffer_load_dwordx4 v5, s[24:27], s60 offen lds
    s_add_u32 s60, s52, 430080
    s_add_u32 m0, s53, 77824
    s_nop 0
    buffer_load_dwordx4 v5, s[24:27], s60 offen lds
    s_add_u32 s61, s61, 2
    s_lshl_b32 s52, s61, 2
    s_lshr_b32 s52, 0x6431, s52
    s_and_b32 s52, s52, 7
    s_mul_i32 s52, s52, 51200
    s_lshl_b32 s53, s61, 12
    s_add_u32 s60, s52, 0
    s_add_u32 m0, s53, 40960
    s_nop 0
    buffer_load_dwordx4 v12, s[24:27], s60 offen lds
    s_add_u32 s60, s52, 10240
    s_add_u32 m0, s53, 41984
    s_nop 0
    buffer_load_dwordx4 v12, s[24:27], s60 offen lds
    s_add_u32 s60, s52, 25600
    s_add_u32 m0, s53, 43008
    s_nop 0
    buffer_load_dwordx4 v12, s[24:27], s60 offen lds
    s_add_u32 s60, s52, 35840
    s_add_u32 m0, s53, 44032
    s_nop 0
    buffer_load_dwordx4 v12, s[24:27], s60 offen lds
    s_add_u32 s60, s52, 409600
    s_add_u32 m0, s53, 61440
    s_nop 0
    buffer_load_dwordx4 v12, s[24:27], s60 offen lds
    s_add_u32 s60, s52, 419840
    s_add_u32 m0, s53, 62464
    s_nop 0
    buffer_load_dwordx4 v12, s[24:27], s60 offen lds
    s_add_u32 s60, s52, 435200
    s_add_u32 m0, s53, 63488
    s_nop 0
    buffer_load_dwordx4 v12, s[24:27], s60 offen lds
    s_add_u32 s60, s52, 445440
    s_add_u32 m0, s53, 64512
    s_nop 0
    buffer_load_dwordx4 v12, s[24:27], s60 offen lds
    s_lshl_b32 s53, s61, 10
    s_add_u32 s60, s52, 20480
    s_add_u32 m0, s53, 57344
    s_nop 0
    buffer_load_dwordx4 v5, s[24:27], s60 offen lds
    s_add_u32 s60, s52, 430080
    s_add_u32 m0, s53, 77824
    s_nop 0
    buffer_load_dwordx4 v5, s[24:27], s60 offen lds
    v_mov_b32 v2, 158720
    v_mov_b32 v3, 1
    s_waitcnt vmcnt(0)
    s_mov_b64 exec, 1
    ds_add_u32 v2, v3 offset:56
    s_mov_b64 exec, -1
K_P2_NL:
    s_lshl_b32 s62, s40, 7
    v_lshrrev_b32 v8, 3, v1
    v_lshrrev_b32 v9, 4, v1
    v_mov_b32 v15, 158720
    s_lshl_b32 s61, s40, 3
    s_add_u32 s61, s61, s30
    s_mul_i32 s3, s61, 20480
    s_lshl_b32 s33, s41, 7
    s_add_u32 s3, s3, s33
    v_and_b32 v2, 7, v1
    v_lshlrev_b32 v2, 4, v2
    v_mul_u32_u24 v4, 1280, v8
    v_add3_u32 v10, v2, v4, s3
    s_lshl_b32 s3, s30, 7
    s_add_u32 s3, s3, 159744
    v_lshl_add_u32 v11, v8, 3, s3
    s_mov_b32 s63, 10240
    s_add_u32 s20, s6, 0x100000
    s_addc_u32 s21, s7, 0
    s_mov_b32 s22, 0x280000
    s_mov_b32 s23, 0x20000
    s_mov_b32 s56, s10
    s_mov_b32 s57, s11
    s_mov_b32 s58, 0x280000
    s_mov_b32 s59, 0x20000
    v_mul_u32_u24 v3, 144, v8
    v_add_u32 v3, v2, v3
    s_mul_i32 s3, s30, 2304
    s_add_u32 s3, s3, 140288
    v_add_u32 v14, s3, v3
    s_add_u32 s44, s6, 0x10000
    s_addc_u32 s45, s7, 0
    s_mov_b32 s46, 0x43800
    s_mov_b32 s47, 0x20000
    v_mov_b32 v108, 1
    buffer_load_dwordx4 v[16:19], v10, s[12:15], 0 offen
    buffer_load_dwordx4 v[20:23], v10, s[12:15], s63 offen
    s_cmp_lg_u32 s30, 6
    s_cbranch_scc1 K_P2_HW
    s_mov_b32 s3, 131072
    s_waitcnt vmcnt(2)
K_P2_DPOLL:
    v_min_u32 v2, v7, v6
    v_cmp_eq_u32 vcc, 0, v2
    s_cbranch_vccz K_P2_DOK
    s_cmp_eq_u32 s3, 131072
    s_cbranch_scc1 K_P2_DNS
    s_sleep 12
K_P2_DNS:
    v_lshl_add_u32 v13, v1, 2, s42
    global_load_dword v7, v13, s[6:7] offset:256 sc1
    v_and_b32 v13, 0xfffffe04, v13
    global_load_dword v6, v13, s[6:7] offset:128 sc1
    s_sub_u32 s3, s3, 1
    s_waitcnt vmcnt(0)
    s_cmp_lg_u32 s3, 0
    s_cbranch_scc1 K_P2_DPOLL
K_P2_DOK:
    v_readlane_b32 s52, v6, 0
    v_readlane_b32 s53, v6, 1
    s_nop 1
    s_and_b32 s3, s52, 0x7ff
    s_sub_u32 s3, 2047, s3
    v_mov_b32 v48, s3
    v_mov_b32 v4, s52
    v_and_b32 v4, 0xffff0000, v4
    v_ashrrev_i32 v5, 31, v4
    v_not_b32 v5, v5
    v_or_b32 v5, 0x80000000, v5
    v_xor_b32 v4, v4, v5
    v_and_b32 v4, 0xffff0000, v4
    v_mul_f32 v5, 0xbfb8aa3b, v4
    v_exp_f32 v5, v5
    s_nop 0
    v_add_f32 v5, 1.0, v5
    v_rcp_f32 v4, v5
    s_nop 0
    v_cvt_pk_bf16_f32 v50, v4, v4
    v_lshlrev_b32 v50, 16, v50
    s_and_b32 s3, s53, 0x7ff
    s_sub_u32 s3, 2047, s3
    v_mov_b32 v49, s3
    v_mov_b32 v4, s53
    v_and_b32 v4, 0xffff0000, v4
    v_ashrrev_i32 v5, 31, v4
    v_not_b32 v5, v5
    v_or_b32 v5, 0x80000000, v5
    v_xor_b32 v4, v4, v5
    v_and_b32 v4, 0xffff0000, v4
    v_mul_f32 v5, 0xbfb8aa3b, v4
    v_exp_f32 v5, v5
    s_nop 0
    v_add_f32 v5, 1.0, v5
    v_rcp_f32 v4, v5
    s_nop 0
    v_cvt_pk_bf16_f32 v51, v4, v4
    v_lshlrev_b32 v51, 16, v51
    ds_write_b128 v15, v[48:51]
    ds_write_b32 v15, v108 offset:40
    v_lshl_add_u32 v13, v1, 4, v15
    v_lshlrev_b32 v52, 16, v7
    v_and_b32 v52, 0x7fff0000, v52
    v_and_b32 v54, 0x7fff0000, v7
    v_sub_f32 v53, 1.0, v52
    v_cvt_pk_bf16_f32 v53, v53, v53
    v_lshlrev_b32 v53, 16, v53
    v_sub_f32 v55, 1.0, v54
    v_cvt_pk_bf16_f32 v55, v55, v55
    v_lshlrev_b32 v55, 16, v55
    ds_write_b128 v13, v[52:55] offset:1024
    s_branch K_P2_E
K_STA13:
    s_branch K_WRET_A
K_STB13:
    s_branch K_WRET_B
K_P2_HW:
    s_mov_b32 s3, 1048576
K_P2_GS2:
    ds_read_b32 v2, v15 offset:40
    s_sleep 1
    s_sub_u32 s3, s3, 1
    s_waitcnt lgkmcnt(0)
    v_readfirstlane_b32 s33, v2
    s_nop 3
    s_cselect_b32 s33, 1, s33
    s_cmp_lt_u32 s33, 1
    s_cbranch_scc1 K_P2_GS2
    ds_read_b128 v[28:31], v15
    s_waitcnt lgkmcnt(0)
    s_cmp_eq_u32 s30, 4
    s_cselect_b64 vcc, -1, 0
    s_nop 1
    v_cndmask_b32 v2, v29, v28, vcc
    v_cndmask_b32 v5, v31, v30, vcc
    s_nop 0
    v_readfirstlane_b32 s52, v2
    s_nop 3
    s_sub_u32 s3, s52, s62
    s_cmp_lt_u32 s3, 128
    s_cbranch_scc0 K_P2_E
    s_mov_b32 s3, 131072
K_P2_YPOLL:
    s_load_dword s33, s[6:7], s42 offset:136 glc
    s_waitcnt lgkmcnt(0)
    s_cmp_lg_u32 s33, 0
    s_cbranch_scc1 K_P2_YGO
    s_sleep 4
    s_sub_u32 s3, s3, 1
    s_cbranch_scc0 K_P2_YPOLL
K_P2_YGO:
    v_and_b32 v2, 15, v1
    v_lshlrev_b32 v2, 4, v2
    v_mul_u32_u24 v4, 5120, v9
    s_sub_u32 s53, s30, 4
    s_mul_i32 s33, s53, 2560
    s_lshl_b32 s3, s41, 8
    s_add_u32 s3, s3, s33
    v_add3_u32 v3, v2, v4, s3
    s_mov_b32 s60, 0
    buffer_load_dwordx4 v[52:55], v3, s[44:47], s60 offen sc1
    s_mov_b32 s60, 20480
    buffer_load_dwordx4 v[56:59], v3, s[44:47], s60 offen sc1
    s_mov_b32 s60, 40960
    buffer_load_dwordx4 v[60:63], v3, s[44:47], s60 offen sc1
    s_mov_b32 s60, 61440
    buffer_load_dwordx4 v[64:67], v3, s[44:47], s60 offen sc1
    s_mov_b32 s60, 81920
    buffer_load_dwordx4 v[68:71], v3, s[44:47], s60 offen sc1
    s_mov_b32 s60, 102400
    buffer_load_dwordx4 v[72:75], v3, s[44:47], s60 offen sc1
    s_mov_b32 s60, 122880
    buffer_load_dwordx4 v[76:79], v3, s[44:47], s60 offen sc1
    s_mov_b32 s60, 143360
    buffer_load_dwordx4 v[80:83], v3, s[44:47], s60 offen sc1
    s_mov_b32 s60, 163840
    buffer_load_dwordx4 v[84:87], v3, s[44:47], s60 offen sc1
    s_mov_b32 s60, 184320
    buffer_load_dwordx4 v[88:91], v3, s[44:47], s60 offen sc1
    s_mov_b32 s60, 204800
    buffer_load_dwordx4 v[92:95], v3, s[44:47], s60 offen sc1
    s_mov_b32 s60, 225280
    buffer_load_dwordx4 v[96:99], v3, s[44:47], s60 offen sc1
    s_mov_b32 s60, 245760
    buffer_load_dwordx4 v[100:103], v3, s[44:47], s60 offen sc1
    s_mov_b32 s60, 266240
    buffer_load_dwordx4 v[104:107], v3, s[44:47], s60 offen sc1
    s_waitcnt vmcnt(12)
    v_add_f32 v48, v52, v56
    v_add_f32 v49, v53, v57
    v_add_f32 v50, v54, v58
    v_add_f32 v51, v55, v59
    s_waitcnt vmcnt(11)
    v_add_f32 v48, v48, v60
    v_add_f32 v49, v49, v61
    v_add_f32 v50, v50, v62
    v_add_f32 v51, v51, v63
    s_waitcnt vmcnt(10)
    v_add_f32 v48, v48, v64
    v_add_f32 v49, v49, v65
    v_add_f32 v50, v50, v66
    v_add_f32 v51, v51, v67
    s_waitcnt vmcnt(9)
    v_add_f32 v48, v48, v68
    v_add_f32 v49, v49, v69
    v_add_f32 v50, v50, v70
    v_add_f32 v51, v51, v71
    s_waitcnt vmcnt(8)
    v_add_f32 v48, v48, v72
    v_add_f32 v49, v49, v73
    v_add_f32 v50, v50, v74
    v_add_f32 v51, v51, v75
    s_waitcnt vmcnt(7)
    v_add_f32 v48, v48, v76
    v_add_f32 v49, v49, v77
    v_add_f32 v50, v50, v78
    v_add_f32 v51, v51, v79
    s_waitcnt vmcnt(6)
    v_add_f32 v48, v48, v80
    v_add_f32 v49, v49, v81
    v_add_f32 v50, v50, v82
    v_add_f32 v51, v51, v83
    s_waitcnt vmcnt(5)
    v_add_f32 v48, v48, v84
    v_add_f32 v49, v49, v85
    v_add_f32 v50, v50, v86
    v_add_f32 v51, v51, v87
    s_waitcnt vmcnt(4)
    v_add_f32 v48, v48, v88
    v_add_f32 v49, v49, v89
    v_add_f32 v50, v50, v90
    v_add_f32 v51, v51, v91
    s_waitcnt vmcnt(3)
    v_add_f32 v48, v48, v92
    v_add_f32 v49, v49, v93
    v_add_f32 v50, v50, v94
    v_add_f32 v51, v51, v95
    s_waitcnt vmcnt(2)
    v_add_f32 v48, v48, v96
    v_add_f32 v49, v49, v97
    v_add_f32 v50, v50, v98
    v_add_f32 v51, v51, v99
    s_waitcnt vmcnt(1)
    v_add_f32 v48, v48, v100
    v_add_f32 v49, v49, v101
    v_add_f32 v50, v50, v102
    v_add_f32 v51, v51, v103
    s_waitcnt vmcnt(0)
    v_add_f32 v48, v48, v104
    v_add_f32 v49, v49, v105
    v_add_f32 v50, v50, v106
    v_add_f32 v51, v51, v107
    v_mov_b32 v52, v48
    v_mov_b32 v53, v49
    v_mov_b32 v54, v50
    v_mov_b32 v55, v51
    s_nop 0
    v_permlane16_swap_b32 v48, v52
    v_permlane16_swap_b32 v49, v53
    v_permlane16_swap_b32 v50, v54
    v_permlane16_swap_b32 v51, v55
    v_add_f32 v48, v48, v52
    v_add_f32 v49, v49, v53
    v_add_f32 v50, v50, v54
    v_add_f32 v51, v51, v55
    v_mov_b32 v52, v48
    v_mov_b32 v53, v49
    v_mov_b32 v54, v50
    v_mov_b32 v55, v51
    s_nop 0
    v_permlane32_swap_b32 v48, v52
    v_permlane32_swap_b32 v49, v53
    v_permlane32_swap_b32 v50, v54
    v_permlane32_swap_b32 v51, v55
    v_add_f32 v48, v48, v52
    v_add_f32 v49, v49, v53
    v_add_f32 v50, v50, v54
    v_add_f32 v51, v51, v55
    v_cvt_pk_bf16_f32 v48, v48, v48
    v_lshlrev_b32 v48, 16, v48
    v_mul_f32 v48, v5, v48
    v_cvt_pk_bf16_f32 v48, v48, v48
    v_lshlrev_b32 v48, 16, v48
    v_cvt_pk_bf16_f32 v49, v49, v49
    v_lshlrev_b32 v49, 16, v49
    v_mul_f32 v49, v5, v49
    v_cvt_pk_bf16_f32 v49, v49, v49
    v_lshlrev_b32 v49, 16, v49
    v_cvt_pk_bf16_f32 v50, v50, v50
    v_lshlrev_b32 v50, 16, v50
    v_mul_f32 v50, v5, v50
    v_cvt_pk_bf16_f32 v50, v50, v50
    v_lshlrev_b32 v50, 16, v50
    v_cvt_pk_bf16_f32 v51, v51, v51
    v_lshlrev_b32 v51, 16, v51
    v_mul_f32 v51, v5, v51
    v_cvt_pk_bf16_f32 v51, v51, v51
    v_lshlrev_b32 v51, 16, v51
    s_lshl_b32 s3, s53, 8
    s_add_u32 s3, s3, 158976
    v_add_u32 v2, s3, v2
    ds_write_b128 v2, v[48:51]
    s_branch K_P2_E
K_STA14:
    s_branch K_WRET_A
K_STB14:
    s_branch K_WRET_B
K_P2_W7:
    s_mov_b32 s37, s42
    s_waitcnt lgkmcnt(0)
    s_load_dwordx2 s[48:49], s[6:7], s37 glc
    s_mul_i32 s52, s40, 1496
    s_add_u32 s53, s52, 1309
    s_lshr_b32 s52, s52, 11
    s_lshr_b32 s53, s53, 11
    s_sub_u32 s53, s53, s52
    s_mov_b32 s46, 0x84210
    s_mov_b32 s47, s46
    v_mov_b32 v15, 158720
    v_mov_b32 v5, 0
    v_mov_b32 v48, 0x80000000
    s_mov_b64 exec, 1
    ds_or_b32 v15, v48 offset:16
    ds_or_b32 v15, v48 offset:20
    ds_or_b32 v15, v48 offset:24
    s_waitcnt lgkmcnt(0)
    s_cmp_eq_u32 s53, 0
    s_cselect_b32 s49, s48, s49
    s_lshl_b64 s[50:51], s[48:49], 1
    s_and_b64 s[50:51], s[50:51], s[48:49]
    s_lshl_b64 vcc, s[50:51], 2
    s_and_b64 s[50:51], s[50:51], vcc
    s_lshl_b64 s[50:51], s[50:51], 1
    s_and_b64 s[50:51], s[50:51], s[46:47]
    s_or_b64 s[48:49], s[48:49], s[50:51]
    v_readfirstlane_b32 s52, v5
    s_cmp_ge_u32 s52, 2
    s_cselect_b32 s52, -1, 0x3ff
    s_and_b32 s48, s48, s52
    s_and_b32 s49, s49, s52
    s_and_b32 s52, s48, s49
    v_mov_b32 v48, s48
    v_mov_b32 v49, s49
    v_mov_b32 v50, s52
    s_mov_b64 exec, 1
    ds_or_b64 v15, v[48:49] offset:16
    ds_or_b32 v15, v50 offset:24
    s_mov_b64 exec, -1
    s_load_dwordx2 s[48:49], s[6:7], s37 glc
    s_lshl_b32 s62, s40, 7
    v_lshrrev_b32 v8, 3, v1
    v_lshrrev_b32 v9, 4, v1
    v_mov_b32 v15, 158720
    s_lshl_b32 s61, s40, 3
    s_add_u32 s61, s61, s30
    s_mul_i32 s3, s61, 20480
    s_lshl_b32 s33, s41, 7
    s_add_u32 s3, s3, s33
    v_and_b32 v2, 7, v1
    v_lshlrev_b32 v2, 4, v2
    v_mul_u32_u24 v4, 1280, v8
    v_add3_u32 v10, v2, v4, s3
    s_lshl_b32 s3, s30, 7
    s_add_u32 s3, s3, 159744
    v_lshl_add_u32 v11, v8, 3, s3
    s_mov_b32 s63, 10240
    s_add_u32 s20, s6, 0x100000
    s_addc_u32 s21, s7, 0
    s_mov_b32 s22, 0x280000
    s_mov_b32 s23, 0x20000
    s_mov_b32 s56, s10
    s_mov_b32 s57, s11
    s_mov_b32 s58, 0x280000
    s_mov_b32 s59, 0x20000
    v_mul_u32_u24 v3, 144, v8
    v_add_u32 v3, v2, v3
    s_mul_i32 s3, s30, 2304
    s_add_u32 s3, s3, 140288
    v_add_u32 v14, s3, v3
    buffer_load_dwordx4 v[16:19], v10, s[12:15], 0 offen
    buffer_load_dwordx4 v[20:23], v10, s[12:15], s63 offen
    s_mov_b32 s3, 131072
    s_waitcnt lgkmcnt(0)
K_P2_FCHK:
    s_cmp_eq_u32 s53, 0
    s_cselect_b32 s49, s48, s49
    s_lshl_b64 s[50:51], s[48:49], 1
    s_and_b64 s[50:51], s[50:51], s[48:49]
    s_lshl_b64 vcc, s[50:51], 2
    s_and_b64 s[50:51], s[50:51], vcc
    s_lshl_b64 s[50:51], s[50:51], 1
    s_and_b64 s[50:51], s[50:51], s[46:47]
    s_or_b64 s[48:49], s[48:49], s[50:51]
    v_readfirstlane_b32 s52, v5
    s_cmp_ge_u32 s52, 2
    s_cselect_b32 s52, -1, 0x3ff
    s_and_b32 s48, s48, s52
    s_and_b32 s49, s49, s52
    s_and_b32 s52, s48, s49
    v_mov_b32 v48, s48
    v_mov_b32 v49, s49
    v_mov_b32 v50, s52
    s_mov_b64 exec, 1
    ds_or_b64 v15, v[48:49] offset:16
    ds_or_b32 v15, v50 offset:24
    s_mov_b64 exec, -1
    s_cmp_eq_u32 s52, 0xfffff
    s_cbranch_scc1 K_P2_FGO
    s_cmp_lg_u64 s[48:49], 0
    s_cbranch_scc1 K_P2_FS
    s_sleep 8
K_P2_FS:
    s_sleep 2
    s_load_dwordx2 s[48:49], s[6:7], s37 glc
    ds_read_b32 v5, v15 offset:56
    s_sub_u32 s3, s3, 1
    s_waitcnt lgkmcnt(0)
    s_cbranch_scc0 K_P2_FCHK
    v_mov_b32 v48, -1
    v_mov_b32 v49, -1
    v_mov_b32 v50, -1
    ds_write_b96 v15, v[48:50] offset:16
K_P2_FGO:
K_P2_E:
    s_setprio 0
    s_waitcnt vmcnt(0)
    v_lshlrev_b32 v32, 16, v16
    v_and_b32 v33, 0xffff0000, v16
    v_lshlrev_b32 v34, 16, v17
    v_and_b32 v35, 0xffff0000, v17
    v_lshlrev_b32 v36, 16, v18
    v_and_b32 v37, 0xffff0000, v18
    v_lshlrev_b32 v38, 16, v19
    v_and_b32 v39, 0xffff0000, v19
    v_lshlrev_b32 v40, 16, v20
    v_and_b32 v41, 0xffff0000, v20
    v_lshlrev_b32 v42, 16, v21
    v_and_b32 v43, 0xffff0000, v21
    v_lshlrev_b32 v44, 16, v22
    v_and_b32 v45, 0xffff0000, v22
    v_lshlrev_b32 v46, 16, v23
    v_and_b32 v47, 0xffff0000, v23
    s_branch K_P2_E2
K_STA15:
    s_branch K_WRET_A
K_STB15:
    s_branch K_WRET_B
K_SPN:
    s_mov_b32 s64, -1
    s_mov_b32 s65, -1
    s_mov_b32 s66, -1
    s_mov_b32 s67, -1
    s_mov_b32 s68, -1
    s_mov_b32 s69, -1
K_SPL:
    ds_read_b32 v59, v58
    s_waitcnt lgkmcnt(0)
    v_readfirstlane_b32 s50, v59
    s_and_b32 s33, s50, s70
    s_cbranch_scc1 K_BK0
    s_cmp_lt_i32 s50, 0
    s_cbranch_scc0 K_SPG
    s_sleep 1
    s_branch K_SPL
K_SPG:
    s_load_dwordx2 s[48:49], s[6:7], s42 glc
    ds_read_b32 v5, v15 offset:56
    s_waitcnt lgkmcnt(0)
    s_cmp_eq_u32 s53, 0
    s_cselect_b32 s49, s48, s49
    s_lshl_b64 s[50:51], s[48:49], 1
    s_and_b64 s[50:51], s[50:51], s[48:49]
    s_lshl_b64 vcc, s[50:51], 2
    s_and_b64 s[50:51], s[50:51], vcc
    s_lshl_b64 s[50:51], s[50:51], 1
    s_and_b64 s[50:51], s[50:51], s[46:47]
    s_or_b64 s[48:49], s[48:49], s[50:51]
    v_readfirstlane_b32 s52, v5
    s_cmp_ge_u32 s52, 2
    s_cselect_b32 s52, -1, 0x3ff
    s_and_b32 s48, s48, s52
    s_and_b32 s49, s49, s52
    s_and_b32 s52, s48, s49
    v_mov_b32 v188, s48
    v_mov_b32 v189, s49
    v_mov_b32 v190, s52
    s_mov_b64 exec, 1
    ds_or_b64 v15, v[188:189] offset:16
    ds_or_b32 v15, v190 offset:24
    s_mov_b64 exec, -1
    ds_read_b32 v59, v58
    s_waitcnt lgkmcnt(0)
    v_readfirstlane_b32 s50, v59
    s_and_b32 s33, s50, s70
    s_cbranch_scc1 K_BK0
    s_sleep 2
    ds_read_b32 v59, v58
    s_waitcnt lgkmcnt(0)
    v_readfirstlane_b32 s50, v59
    s_and_b32 s33, s50, s70
    s_cbranch_scc1 K_BK0
    s_sleep 2
    ds_read_b32 v59, v58
    s_waitcnt lgkmcnt(0)
    v_readfirstlane_b32 s50, v59
    s_and_b32 s33, s50, s70
    s_cbranch_scc1 K_BK0
    s_sleep 2
    ds_read_b32 v59, v58
    s_waitcnt lgkmcnt(0)
    v_readfirstlane_b32 s50, v59
    s_and_b32 s33, s50, s70
    s_cbranch_scc1 K_BK0
    s_branch K_SPL
K_CHEND:
K_AUX:
    s_cmp_ge_u32 s30, 4
    s_cbranch_scc1 K_AUX_L
    s_and_b32 s3, s2, 7
    s_lshr_b32 s70, s2, 3
    s_lshl3_add_u32 s3, s3, s70
    s_lshl_b32 s3, s3, 5
    s_lshl3_add_u32 s3, s30, s3
    v_bfe_u32 v8, v0, 4, 2
    v_add_u32 v8, s3, v8
    v_and_b32 v10, 15, v0
    v_lshlrev_b32 v10, 4, v10
    v_mul_u32_u24 v9, 1280, v8
    v_add_u32 v9, v9, v10
    v_and_b32 v2, 63, v0
    v_lshlrev_b32 v2, 4, v2
    s_lshl_b32 s71, s30, 12
    s_add_u32 s71, s71, 126016
    s_mov_b32 s70, 5120
    s_mov_b32 m0, s71
    s_waitcnt lgkmcnt(0)
    s_mov_b32 s16, s44
    s_mov_b32 s17, s45
    s_mov_b32 s18, 0x500
    s_mov_b32 s19, 0x20000
    s_mov_b32 s20, s52
    s_mov_b32 s21, s53
    s_mov_b32 s22, 0x500
    s_mov_b32 s23, 0x20000
    buffer_load_dwordx4 v2, s[16:19], 0 offen lds
    buffer_load_dwordx4 v2, s[16:19], 0 offen offset:1024 lds
    s_add_u32 m0, s71, 2048
    v_add_u32 v10, s71, v10
    buffer_load_dwordx4 v2, s[20:23], 0 offen lds
    buffer_load_dwordx4 v2, s[20:23], 0 offen offset:1024 lds
    buffer_load_dwordx4 v[16:19], v9, s[12:15], 0 offen offset:0
    buffer_load_dwordx4 v[20:23], v9, s[12:15], s70 offen offset:0
    buffer_load_dwordx4 v[24:27], v9, s[12:15], 0 offen offset:256
    buffer_load_dwordx4 v[28:31], v9, s[12:15], s70 offen offset:256
    buffer_load_dwordx4 v[32:35], v9, s[12:15], 0 offen offset:512
    buffer_load_dwordx4 v[36:39], v9, s[12:15], s70 offen offset:512
    buffer_load_dwordx4 v[40:43], v9, s[12:15], 0 offen offset:768
    buffer_load_dwordx4 v[44:47], v9, s[12:15], s70 offen offset:768
    buffer_load_dwordx4 v[48:51], v9, s[12:15], 0 offen offset:1024
    buffer_load_dwordx4 v[52:55], v9, s[12:15], s70 offen offset:1024
    s_barrier
    v_and_b32 v1, 63, v0
    v_mov_b32 v7, 0
    s_and_b32 s28, s2, 7
    s_lshr_b32 s29, s2, 3
    s_xor_b32 s30, s30, 4
    s_lshr_b32 s34, s29, 3
    s_lshl_b32 s34, s34, 2
    s_and_b32 s3, s29, 3
    s_add_u32 s34, s34, s3
    s_add_u32 s34, s34, 4
    s_bitcmp1_b32 s29, 2
    s_cselect_b32 s34, -1, s34
    s_cmp_lt_u32 s29, 8
    s_cselect_b32 s34, s29, s34
    s_lshl_b32 s40, s28, 1
    s_cmp_ge_u32 s34, 10
    s_addc_u32 s40, s40, 0
    s_sub_u32 s41, s34, 10
    s_cmp_ge_u32 s34, 10
    s_cselect_b32 s41, s41, s34
    s_mul_i32 s42, s28, 20
    s_add_u32 s42, s42, s34
    s_and_b32 s42, s42, 255
    s_lshl_b32 s42, s42, 9
    s_add_u32 s42, s42, 524288
    s_mul_i32 s43, s28, 7
    s_add_u32 s43, s43, s29
    s_sub_u32 s43, s43, 1
    s_cmp_lt_u32 s43, 54
    s_cselect_b32 s43, s43, 63
    s_cmp_eq_u32 s29, 0
    s_cselect_b32 s43, 63, s43
    s_mov_b32 s24, s8
    s_mov_b32 s25, s9
    s_mov_b32 s26, 0xc8000
    s_mov_b32 s27, 0x20000
    s_add_u32 s64, s6, 0x80000
    s_addc_u32 s65, s7, 0
    s_mov_b32 s66, 0x14400
    s_mov_b32 s67, 0x20000
    s_add_u32 s60, s6, 0x10000
    s_addc_u32 s61, s7, 0
    s_mov_b32 s62, 0x43800
    s_mov_b32 s63, 0x20000
    v_mov_b32 v96, 0
    v_mov_b32 v97, 0
    v_mov_b32 v98, 0
    v_mov_b32 v99, 0
    v_mov_b32 v13, 158720
    s_waitcnt vmcnt(10)
    ds_read_b128 v[56:59], v10 offset:0
    ds_read_b128 v[76:79], v10 offset:2048
    ds_read_b128 v[60:63], v10 offset:256
    ds_read_b128 v[80:83], v10 offset:2304
    ds_read_b128 v[64:67], v10 offset:512
    ds_read_b128 v[84:87], v10 offset:2560
    ds_read_b128 v[68:71], v10 offset:768
    ds_read_b128 v[88:91], v10 offset:2816
    ds_read_b128 v[72:75], v10 offset:1024
    ds_read_b128 v[92:95], v10 offset:3072
    s_waitcnt vmcnt(8) lgkmcnt(8)
    v_dot2c_f32_bf16 v96, v16, v56
    v_dot2c_f32_bf16 v98, v16, v76
    v_dot2c_f32_bf16 v97, v20, v56
    v_dot2c_f32_bf16 v99, v20, v76
    v_dot2c_f32_bf16 v96, v17, v57
    v_dot2c_f32_bf16 v98, v17, v77
    v_dot2c_f32_bf16 v97, v21, v57
    v_dot2c_f32_bf16 v99, v21, v77
    v_dot2c_f32_bf16 v96, v18, v58
    v_dot2c_f32_bf16 v98, v18, v78
    v_dot2c_f32_bf16 v97, v22, v58
    v_dot2c_f32_bf16 v99, v22, v78
    v_dot2c_f32_bf16 v96, v19, v59
    v_dot2c_f32_bf16 v98, v19, v79
    v_dot2c_f32_bf16 v97, v23, v59
    v_dot2c_f32_bf16 v99, v23, v79
    s_waitcnt vmcnt(6) lgkmcnt(6)
    v_dot2c_f32_bf16 v96, v24, v60
    v_dot2c_f32_bf16 v98, v24, v80
    v_dot2c_f32_bf16 v97, v28, v60
    v_dot2c_f32_bf16 v99, v28, v80
    v_dot2c_f32_bf16 v96, v25, v61
    v_dot2c_f32_bf16 v98, v25, v81
    v_dot2c_f32_bf16 v97, v29, v61
    v_dot2c_f32_bf16 v99, v29, v81
    v_dot2c_f32_bf16 v96, v26, v62
    v_dot2c_f32_bf16 v98, v26, v82
    v_dot2c_f32_bf16 v97, v30, v62
    v_dot2c_f32_bf16 v99, v30, v82
    v_dot2c_f32_bf16 v96, v27, v63
    v_dot2c_f32_bf16 v98, v27, v83
    v_dot2c_f32_bf16 v97, v31, v63
    v_dot2c_f32_bf16 v99, v31, v83
    s_waitcnt vmcnt(4) lgkmcnt(4)
    v_dot2c_f32_bf16 v96, v32, v64
    v_dot2c_f32_bf16 v98, v32, v84
    v_dot2c_f32_bf16 v97, v36, v64
    v_dot2c_f32_bf16 v99, v36, v84
    v_dot2c_f32_bf16 v96, v33, v65
    v_dot2c_f32_bf16 v98, v33, v85
    v_dot2c_f32_bf16 v97, v37, v65
    v_dot2c_f32_bf16 v99, v37, v85
    v_dot2c_f32_bf16 v96, v34, v66
    v_dot2c_f32_bf16 v98, v34, v86
    v_dot2c_f32_bf16 v97, v38, v66
    v_dot2c_f32_bf16 v99, v38, v86
    v_dot2c_f32_bf16 v96, v35, v67
    v_dot2c_f32_bf16 v98, v35, v87
    v_dot2c_f32_bf16 v97, v39, v67
    v_dot2c_f32_bf16 v99, v39, v87
    s_waitcnt vmcnt(2) lgkmcnt(2)
    v_dot2c_f32_bf16 v96, v40, v68
    v_dot2c_f32_bf16 v98, v40, v88
    v_dot2c_f32_bf16 v97, v44, v68
    v_dot2c_f32_bf16 v99, v44, v88
    v_dot2c_f32_bf16 v96, v41, v69
    v_dot2c_f32_bf16 v98, v41, v89
    v_dot2c_f32_bf16 v97, v45, v69
    v_dot2c_f32_bf16 v99, v45, v89
    v_dot2c_f32_bf16 v96, v42, v70
    v_dot2c_f32_bf16 v98, v42, v90
    v_dot2c_f32_bf16 v97, v46, v70
    v_dot2c_f32_bf16 v99, v46, v90
    v_dot2c_f32_bf16 v96, v43, v71
    v_dot2c_f32_bf16 v98, v43, v91
    v_dot2c_f32_bf16 v97, v47, v71
    v_dot2c_f32_bf16 v99, v47, v91
    s_waitcnt vmcnt(0) lgkmcnt(0)
    v_dot2c_f32_bf16 v96, v48, v72
    v_dot2c_f32_bf16 v98, v48, v92
    v_dot2c_f32_bf16 v97, v52, v72
    v_dot2c_f32_bf16 v99, v52, v92
    v_dot2c_f32_bf16 v96, v49, v73
    v_dot2c_f32_bf16 v98, v49, v93
    v_dot2c_f32_bf16 v97, v53, v73
    v_dot2c_f32_bf16 v99, v53, v93
    v_dot2c_f32_bf16 v96, v50, v74
    v_dot2c_f32_bf16 v98, v50, v94
    v_dot2c_f32_bf16 v97, v54, v74
    v_dot2c_f32_bf16 v99, v54, v94
    v_dot2c_f32_bf16 v96, v51, v75
    v_dot2c_f32_bf16 v98, v51, v95
    v_dot2c_f32_bf16 v97, v55, v75
    v_dot2c_f32_bf16 v99, v55, v95
    s_nop 2
    v_add_f32_dpp v96, v96, v96 quad_perm:[1,0,3,2] row_mask:0xf bank_mask:0xf
    v_add_f32_dpp v97, v97, v97 quad_perm:[1,0,3,2] row_mask:0xf bank_mask:0xf
    v_add_f32_dpp v98, v98, v98 quad_perm:[1,0,3,2] row_mask:0xf bank_mask:0xf
    s_branch K_PG6
.p2align 12
K_PG6:
    v_add_f32_dpp v99, v99, v99 quad_perm:[1,0,3,2] row_mask:0xf bank_mask:0xf
    v_add_f32_dpp v96, v96, v96 quad_perm:[2,3,0,1] row_mask:0xf bank_mask:0xf
    v_add_f32_dpp v97, v97, v97 quad_perm:[2,3,0,1] row_mask:0xf bank_mask:0xf
    v_add_f32_dpp v98, v98, v98 quad_perm:[2,3,0,1] row_mask:0xf bank_mask:0xf
    v_add_f32_dpp v99, v99, v99 quad_perm:[2,3,0,1] row_mask:0xf bank_mask:0xf
    v_add_f32_dpp v96, v96, v96 row_half_mirror row_mask:0xf bank_mask:0xf
    v_add_f32_dpp v97, v97, v97 row_half_mirror row_mask:0xf bank_mask:0xf
    v_add_f32_dpp v98, v98, v98 row_half_mirror row_mask:0xf bank_mask:0xf
    v_add_f32_dpp v99, v99, v99 row_half_mirror row_mask:0xf bank_mask:0xf
    v_add_f32_dpp v96, v96, v96 row_mirror row_mask:0xf bank_mask:0xf
    v_add_f32_dpp v97, v97, v97 row_mirror row_mask:0xf bank_mask:0xf
    v_add_f32_dpp v98, v98, v98 row_mirror row_mask:0xf bank_mask:0xf
    v_add_f32_dpp v99, v99, v99 row_mirror row_mask:0xf bank_mask:0xf
    v_and_b32 v4, 31, v8
    v_lshlrev_b32 v11, 2, v4
    v_add_u32 v11, 122880, v11
    v_lshlrev_b32 v12, 1, v4
    v_add_u32 v12, 123008, v12
    v_cvt_pk_bf16_f32 v2, v96, v96
    v_lshlrev_b32 v2, 16, v2
    v_ashrrev_i32 v3, 31, v2
    v_or_b32 v3, 0x80000000, v3
    v_xor_b32 v2, v2, v3
    v_and_b32 v2, 0xffff0000, v2
    v_sub_u32 v3, 0x87ff, v8
    v_or_b32 v96, v2, v3
    ds_write_b32 v11, v96 offset:0
    v_cvt_pk_bf16_f32 v98, v98, v98
    v_lshlrev_b32 v98, 16, v98
    v_mul_f32 v5, 0xbfb8aa3b, v98
    v_exp_f32 v5, v5
    s_nop 0
    v_add_f32 v5, 1.0, v5
    v_rcp_f32 v98, v5
    s_nop 0
    v_cvt_pk_bf16_f32 v98, v98, v98
    v_or_b32 v98, 0x8000, v98
    ds_write_b16 v12, v98 offset:0
    v_cvt_pk_bf16_f32 v2, v97, v97
    v_lshlrev_b32 v2, 16, v2
    v_ashrrev_i32 v3, 31, v2
    v_or_b32 v3, 0x80000000, v3
    v_xor_b32 v2, v2, v3
    v_and_b32 v2, 0xffff0000, v2
    v_sub_u32 v3, 0x87fb, v8
    v_or_b32 v97, v2, v3
    ds_write_b32 v11, v97 offset:16
    v_cvt_pk_bf16_f32 v99, v99, v99
    v_lshlrev_b32 v99, 16, v99
    v_mul_f32 v5, 0xbfb8aa3b, v99
    v_exp_f32 v5, v5
    s_nop 0
    v_add_f32 v5, 1.0, v5
    v_rcp_f32 v99, v5
    s_nop 0
    v_cvt_pk_bf16_f32 v99, v99, v99
    v_or_b32 v99, 0x8000, v99
    ds_write_b16 v12, v99 offset:8
    v_mov_b32 v3, 1
    s_mov_b64 exec, 1
    ds_add_u32 v13, v3 offset:48
    s_mov_b64 exec, -1
    s_cmp_ge_u32 s30, 6
    s_cbranch_scc1 K_AUX_G1
    s_mov_b32 s3, 1048576
K_FGR:
    ds_read_b32 v2, v13 offset:48
    s_sleep 1
    s_sub_u32 s3, s3, 1
    s_waitcnt lgkmcnt(0)
    v_readfirstlane_b32 s33, v2
    s_nop 3
    s_cselect_b32 s33, 4, s33
    s_cmp_lt_u32 s33, 4
    s_cbranch_scc1 K_FGR
    s_cmp_lg_u32 s30, 4
    s_cbranch_scc1 K_AUX_G0
    v_and_b32 v3, 31, v1
    v_lshlrev_b32 v3, 2, v3
    v_add_u32 v3, 122880, v3
    ds_read_b32 v2, v3
    s_waitcnt lgkmcnt(0)
    s_nop 1
    v_max_u32_dpp v3, v2, v2 quad_perm:[1,0,3,2] row_mask:0xf bank_mask:0xf
    s_nop 1
    v_max_u32_dpp v3, v3, v3 quad_perm:[2,3,0,1] row_mask:0xf bank_mask:0xf
    s_nop 1
    v_max_u32_dpp v3, v3, v3 row_half_mirror row_mask:0xf bank_mask:0xf
    s_nop 1
    v_max_u32_dpp v3, v3, v3 row_mirror row_mask:0xf bank_mask:0xf
    s_nop 1
    v_readlane_b32 s68, v3, 0
    v_readlane_b32 s76, v3, 16
    v_readlane_b32 s77, v3, 32
    v_readlane_b32 s78, v3, 48
    s_nop 3
    s_max_u32 s68, s68, s76
    s_max_u32 s77, s77, s78
    s_max_u32 s68, s68, s77
    v_cmp_ne_u32 vcc, s68, v2
    s_nop 1
    v_cndmask_b32 v2, 0, v2, vcc
    s_nop 1
    v_max_u32_dpp v3, v2, v2 quad_perm:[1,0,3,2] row_mask:0xf bank_mask:0xf
    s_nop 1
    v_max_u32_dpp v3, v3, v3 quad_perm:[2,3,0,1] row_mask:0xf bank_mask:0xf
    s_nop 1
    v_max_u32_dpp v3, v3, v3 row_half_mirror row_mask:0xf bank_mask:0xf
    s_nop 1
    v_max_u32_dpp v3, v3, v3 row_mirror row_mask:0xf bank_mask:0xf
    s_nop 1
    v_readlane_b32 s69, v3, 0
    v_readlane_b32 s76, v3, 16
    v_readlane_b32 s77, v3, 32
    v_readlane_b32 s78, v3, 48
    s_nop 3
    s_max_u32 s69, s69, s76
    s_max_u32 s77, s77, s78
    s_max_u32 s69, s69, s77
    s_load_dword s33, s[4:5], 0
    s_waitcnt lgkmcnt(0)
    s_cmp_ge_u32 s33, 1
    s_cbranch_scc1 K_ZO3
    s_sleep 8
    s_load_dword s33, s[4:5], 64
    s_waitcnt lgkmcnt(0)
    s_cmp_ge_u32 s33, 1
    s_cbranch_scc1 K_ZO3
    s_sleep 8
    s_mov_b32 s3, 16384
K_ZB3:
    v_mov_b32 v4, 0
    global_load_dword v4, v4, s[4:5] sc1
    s_waitcnt vmcnt(0)
    v_readfirstlane_b32 s33, v4
    s_cmp_ge_u32 s33, 1
    s_cbranch_scc1 K_ZO3
    s_sleep 8
    s_sub_u32 s3, s3, 1
    s_cbranch_scc0 K_ZB3
K_ZO3:
    s_lshl_b32 s3, s2, 3
    s_add_u32 s3, s3, 606208
    s_atomic_add_x2 s[68:69], s[6:7], s3
    s_cmp_lg_u32 s2, 63
    s_cbranch_scc1 K_AUX_G1
    s_mov_b32 s70, 81920
    v_lshlrev_b32 v3, 3, v1
    s_mov_b32 s3, 131072
K_AUX_POLL:
    buffer_load_dwordx2 v[176:177], v3, s[64:67], s70 offen sc1
    s_waitcnt vmcnt(0)
    v_min_u32 v2, v176, v177
    v_cmp_eq_u32 vcc, 0, v2
    s_cbranch_vccz K_AUX_GOT
    s_sleep 2
    s_sub_u32 s3, s3, 1
    s_cmp_lg_u32 s3, 0
    s_cbranch_scc1 K_AUX_POLL
K_AUX_GOT:
    s_waitcnt lgkmcnt(0)
    s_nop 1
    v_max_u32_dpp v3, v176, v176 quad_perm:[1,0,3,2] row_mask:0xf bank_mask:0xf
    s_nop 1
    v_max_u32_dpp v3, v3, v3 quad_perm:[2,3,0,1] row_mask:0xf bank_mask:0xf
    s_nop 1
    v_max_u32_dpp v3, v3, v3 row_half_mirror row_mask:0xf bank_mask:0xf
    s_nop 1
    v_max_u32_dpp v3, v3, v3 row_mirror row_mask:0xf bank_mask:0xf
    s_nop 1
    v_readlane_b32 s68, v3, 0
    v_readlane_b32 s76, v3, 16
    v_readlane_b32 s77, v3, 32
    v_readlane_b32 s78, v3, 48
    s_nop 3
    s_max_u32 s68, s68, s76
    s_max_u32 s77, s77, s78
    s_max_u32 s68, s68, s77
    v_cmp_ne_u32 vcc, s68, v176
    s_nop 1
    v_cndmask_b32 v2, v177, v176, vcc
    s_nop 1
    v_max_u32_dpp v3, v2, v2 quad_perm:[1,0,3,2] row_mask:0xf bank_mask:0xf
    s_nop 1
    v_max_u32_dpp v3, v3, v3 quad_perm:[2,3,0,1] row_mask:0xf bank_mask:0xf
    s_nop 1
    v_max_u32_dpp v3, v3, v3 row_half_mirror row_mask:0xf bank_mask:0xf
    s_nop 1
    v_max_u32_dpp v3, v3, v3 row_mirror row_mask:0xf bank_mask:0xf
    s_nop 1
    v_readlane_b32 s69, v3, 0
    v_readlane_b32 s76, v3, 16
    v_readlane_b32 s77, v3, 32
    v_readlane_b32 s78, v3, 48
    s_nop 3
    s_max_u32 s69, s69, s76
    s_max_u32 s77, s77, s78
    s_max_u32 s69, s69, s77
    v_mov_b32 v176, s68
    v_mov_b32 v177, s69
    s_mov_b32 s3, 1048576
K_FGZ:
    ds_read_b32 v2, v13 offset:36
    s_sleep 1
    s_sub_u32 s3, s3, 1
    s_waitcnt lgkmcnt(0)
    v_readfirstlane_b32 s33, v2
    s_nop 3
    s_cselect_b32 s33, 1, s33
    s_cmp_lt_u32 s33, 1
    s_cbranch_scc1 K_FGZ
    v_lshlrev_b32 v3, 9, v1
    s_mov_b32 s66, 81920
    s_mov_b32 s70, 0
    buffer_store_dwordx2 v[176:177], v3, s[64:67], s70 offen offset:128 sc1
    s_mov_b32 s70, 32768
    buffer_store_dwordx2 v[176:177], v3, s[64:67], s70 offen offset:128 sc1
    s_mov_b32 s70, 65536
    buffer_store_dwordx2 v[176:177], v3, s[64:67], s70 offen offset:128 sc1
    v_mov_b32 v3, 16
    ds_write_b32 v13, v3 offset:48
    s_branch K_AUX_G1
K_AUX_G0:
    v_and_b32 v3, 3, v1
    v_lshlrev_b32 v3, 4, v3
    v_add_u32 v2, 123008, v3
    ds_read_b128 v[176:179], v2
    v_lshrrev_b32 v2, 2, v1
    v_lshl_add_u32 v3, v2, 9, v3
    s_sleep 12
    s_load_dword s33, s[4:5], 128
    s_waitcnt lgkmcnt(0)
    s_cmp_ge_u32 s33, 8
    s_cbranch_scc1 K_ZO4
    s_sleep 8
    s_mov_b32 s3, 16384
K_ZB4:
    v_mov_b32 v4, 128
    global_load_dword v4, v4, s[4:5] sc1
    s_waitcnt vmcnt(0)
    v_readfirstlane_b32 s33, v4
    s_cmp_ge_u32 s33, 8
    s_cbranch_scc1 K_ZO4
    s_sleep 8
    s_sub_u32 s3, s3, 1
    s_cbranch_scc0 K_ZB4
K_ZO4:
    v_mov_b32 v2, 1
    ds_write_b32 v13, v2 offset:36
    s_lshr_b32 s3, s29, 2
    s_lshl1_add_u32 s3, s28, s3
    s_mul_i32 s3, s3, 5120
    s_and_b32 s70, s29, 3
    s_lshl_b32 s70, s70, 6
    s_add_u32 s3, s3, s70
    s_mov_b32 exec_hi, 0xff
    s_waitcnt lgkmcnt(0)
    buffer_store_dwordx4 v[176:179], v3, s[64:67], s3 offen offset:256 sc1
    s_mov_b64 exec, -1
K_AUX_G1:
    s_cmp_lg_u32 s43, 63
    s_cbranch_scc1 K_FFN_C
    s_cmp_lg_u32 s29, 0
    s_cbranch_scc1 K_AUX_NT
    s_lshl2_add_u32 s3, s28, s30
    s_sub_u32 s3, s3, 4
    s_mul_i32 s3, s3, 25600
    v_lshlrev_b32 v2, 7, v1
    buffer_load_dword v5, v2, s[24:27], s3 offen
    s_add_u32 s3, s3, 8192
    buffer_load_dword v5, v2, s[24:27], s3 offen
    s_add_u32 s3, s3, 8192
    buffer_load_dword v5, v2, s[24:27], s3 offen
    s_add_u32 s3, s3, 8192
    s_mov_b64 exec, 0xff
    buffer_load_dword v5, v2, s[24:27], s3 offen
    s_add_u32 s3, s3, 8192
    s_mov_b64 exec, -1
    s_mul_i32 s3, s30, 160
    s_sub_u32 s3, s3, 640
    v_lshrrev_b32 v2, 1, v1
    v_add_u32 v2, s3, v2
    v_mul_u32_u24 v2, 1280, v2
    v_and_b32 v3, 1, v1
    v_lshl_add_u32 v2, v3, 7, v2
    s_mov_b32 s70, 0
    buffer_load_dword v5, v2, s[24:27], s70 offen offset:1024
    s_mov_b32 s70, 40960
    buffer_load_dword v5, v2, s[24:27], s70 offen offset:1024
    s_mov_b32 s70, 81920
    buffer_load_dword v5, v2, s[24:27], s70 offen offset:1024
    s_mov_b32 s70, 122880
    buffer_load_dword v5, v2, s[24:27], s70 offen offset:1024
    s_mov_b32 s70, 163840
    buffer_load_dword v5, v2, s[24:27], s70 offen offset:1024
K_AUX_NT:
    s_mov_b32 s3, 1048576
K_FGZ2:
    ds_read_b32 v2, v13 offset:36
    s_sleep 1
    s_sub_u32 s3, s3, 1
    s_waitcnt lgkmcnt(0)
    v_readfirstlane_b32 s33, v2
    s_nop 3
    s_cselect_b32 s33, 1, s33
    s_cmp_lt_u32 s33, 1
    s_cbranch_scc1 K_FGZ2
    s_waitcnt vmcnt(0)
    s_branch K_P2
K_AUX_L:
    v_and_b32 v1, 63, v0
    v_mov_b32 v7, 0
    s_and_b32 s28, s2, 7
    s_lshr_b32 s29, s2, 3
    s_xor_b32 s30, s30, 4
    s_lshr_b32 s34, s29, 3
    s_lshl_b32 s34, s34, 2
    s_and_b32 s3, s29, 3
    s_add_u32 s34, s34, s3
    s_add_u32 s34, s34, 4
    s_bitcmp1_b32 s29, 2
    s_cselect_b32 s34, -1, s34
    s_cmp_lt_u32 s29, 8
    s_cselect_b32 s34, s29, s34
    s_lshl_b32 s40, s28, 1
    s_cmp_ge_u32 s34, 10
    s_addc_u32 s40, s40, 0
    s_sub_u32 s41, s34, 10
    s_cmp_ge_u32 s34, 10
    s_cselect_b32 s41, s41, s34
    s_mul_i32 s42, s28, 20
    s_add_u32 s42, s42, s34
    s_and_b32 s42, s42, 255
    s_lshl_b32 s42, s42, 9
    s_add_u32 s42, s42, 524288
    s_mul_i32 s43, s28, 7
    s_add_u32 s43, s43, s29
    s_sub_u32 s43, s43, 1
    s_cmp_lt_u32 s43, 54
    s_cselect_b32 s43, s43, 63
    s_cmp_eq_u32 s29, 0
    s_cselect_b32 s43, 63, s43
    v_mov_b32 v3, 158736
    ds_write2_b32 v3, v7, v7 offset0:0 offset1:1
    ds_write2_b32 v3, v7, v7 offset0:2 offset1:3
    ds_write2_b32 v3, v7, v7 offset0:4 offset1:5
    ds_write2_b32 v3, v7, v7 offset0:6 offset1:7
    ds_write2_b32 v3, v7, v7 offset0:8 offset1:9
    ds_write2_b32 v3, v7, v7 offset0:10 offset1:11
    v_lshrrev_b32 v3, 2, v1
    v_mul_u32_u24 v11, 3456, v3
    v_lshrrev_b32 v3, 4, v1
    v_and_b32 v3, 2, v3
    v_xor_b32 v3, v3, v1
    v_and_b32 v3, 3, v3
    v_lshl_add_u32 v11, v3, 4, v11
    s_mul_i32 s3, s30, 552960
    s_lshl_b32 s70, s43, 6
    s_add_u32 s3, s3, s70
    v_add_u32 v11, s3, v11
    s_mul_i32 s68, s30, 10240
    s_add_u32 s72, s68, 40960
    s_bitcmp1_b32 s43, 0
    s_cselect_b32 s71, s72, s68
    s_cselect_b32 s72, s68, s72
    v_lshlrev_b32 v8, 4, v1
    s_waitcnt lgkmcnt(0)
    s_barrier
    s_mov_b32 s24, s8
    s_mov_b32 s25, s9
    s_mov_b32 s26, 0xc8000
    s_mov_b32 s27, 0x20000
    s_cmp_lg_u32 s43, 63
    s_cbranch_scc1 K_AUX_FFN1
    s_cmp_lg_u32 s30, 0
    s_cbranch_scc1 K_AUX_NR
    s_cmp_eq_u32 s2, 55
    s_cbranch_scc1 K_AUX_NR
    s_cmp_eq_u32 s2, 63
    s_cselect_b32 s70, 0, 128
    s_mov_b32 s3, 1
    s_waitcnt vmcnt(0)
    s_atomic_add s3, s[4:5], s70
    s_atomic_add s3, s[4:5], s70 offset:64
    s_waitcnt lgkmcnt(0)
K_AUX_NR:
    v_mov_b32 v13, 158720
    s_mov_b32 s3, 1048576
K_FGZ3:
    ds_read_b32 v2, v13 offset:36
    s_sleep 1
    s_sub_u32 s3, s3, 1
    s_waitcnt lgkmcnt(0)
    v_readfirstlane_b32 s33, v2
    s_nop 3
    s_cselect_b32 s33, 1, s33
    s_cmp_lt_u32 s33, 1
    s_cbranch_scc1 K_FGZ3
    s_cmp_lg_u32 s2, 63
    s_cbranch_scc1 K_AUX_NH
    s_mov_b32 s3, 1048576
K_FGH:
    ds_read_b32 v2, v13 offset:48
    s_sleep 1
    s_sub_u32 s3, s3, 1
    s_waitcnt lgkmcnt(0)
    v_readfirstlane_b32 s33, v2
    s_nop 3
    s_cselect_b32 s33, 16, s33
    s_cmp_lt_u32 s33, 16
    s_cbranch_scc1 K_FGH
K_AUX_NH:
    s_branch K_P2
K_AUX_FFN1:
    s_bitcmp1_b32 s43, 0
    s_cselect_b64 s[56:57], s[48:49], s[46:47]
    s_cselect_b64 s[60:61], s[46:47], s[48:49]
    s_mov_b32 s58, 2211840
    s_mov_b32 s59, 0x20000
    s_mov_b32 s62, 2211840
    s_mov_b32 s63, 0x20000
    s_add_u32 m0, s71, 0
    s_mov_b32 s70, 0
    buffer_load_dwordx4 v11, s[56:59], s70 offen  lds
    s_add_u32 m0, s71, 1024
    s_mov_b32 s70, 55296
    buffer_load_dwordx4 v11, s[56:59], s70 offen  lds
    s_add_u32 m0, s71, 2048
    s_mov_b32 s70, 110592
    buffer_load_dwordx4 v11, s[56:59], s70 offen  lds
    s_add_u32 m0, s71, 3072
    s_mov_b32 s70, 165888
    buffer_load_dwordx4 v11, s[56:59], s70 offen  lds
    s_add_u32 m0, s71, 4096
    s_mov_b32 s70, 221184
    buffer_load_dwordx4 v11, s[56:59], s70 offen  lds
    s_add_u32 m0, s71, 5120
    s_mov_b32 s70, 276480
    buffer_load_dwordx4 v11, s[56:59], s70 offen  lds
    s_add_u32 m0, s71, 6144
    s_mov_b32 s70, 331776
    buffer_load_dwordx4 v11, s[56:59], s70 offen  lds
    s_add_u32 m0, s71, 7168
    s_mov_b32 s70, 387072
    buffer_load_dwordx4 v11, s[56:59], s70 offen  lds
    s_add_u32 m0, s71, 8192
    s_mov_b32 s70, 442368
    buffer_load_dwordx4 v11, s[56:59], s70 offen  lds
    s_add_u32 m0, s71, 9216
    s_mov_b32 s70, 497664
    buffer_load_dwordx4 v11, s[56:59], s70 offen  lds
    s_add_u32 m0, s72, 0
    s_mov_b32 s70, 0
    buffer_load_dwordx4 v11, s[60:63], s70 offen  lds
    s_add_u32 m0, s72, 1024
    s_mov_b32 s70, 55296
    buffer_load_dwordx4 v11, s[60:63], s70 offen  lds
    s_add_u32 m0, s72, 2048
    s_mov_b32 s70, 110592
    buffer_load_dwordx4 v11, s[60:63], s70 offen  lds
    s_add_u32 m0, s72, 3072
    s_mov_b32 s70, 165888
    buffer_load_dwordx4 v11, s[60:63], s70 offen  lds
    s_add_u32 m0, s72, 4096
    s_mov_b32 s70, 221184
    buffer_load_dwordx4 v11, s[60:63], s70 offen  lds
    s_add_u32 m0, s72, 5120
    s_mov_b32 s70, 276480
    buffer_load_dwordx4 v11, s[60:63], s70 offen  lds
    s_add_u32 m0, s72, 6144
    s_mov_b32 s70, 331776
    buffer_load_dwordx4 v11, s[60:63], s70 offen  lds
    s_add_u32 m0, s72, 7168
    s_mov_b32 s70, 387072
    buffer_load_dwordx4 v11, s[60:63], s70 offen  lds
    s_add_u32 m0, s72, 8192
    s_mov_b32 s70, 442368
    buffer_load_dwordx4 v11, s[60:63], s70 offen  lds
    s_add_u32 m0, s72, 9216
    s_mov_b32 s70, 497664
    buffer_load_dwordx4 v11, s[60:63], s70 offen  lds
    s_mov_b32 s64, s50
    s_mov_b32 s65, s51
    s_mov_b32 s66, 0x21c000
    s_mov_b32 s67, 0x20000
    s_mul_i32 s3, s43, 40960
    s_add_u32 s3, s3, s68
    v_lshrrev_b32 v2, 3, v1
    v_and_b32 v3, 2, v2
    s_lshl_b32 s70, s30, 2
    v_xor_b32 v3, s70, v3
    v_xor_b32 v3, v3, v1
    v_and_b32 v3, 7, v3
    v_mul_u32_u24 v2, 1280, v2
    v_lshl_add_u32 v2, v3, 4, v2
    v_add_u32 v12, s3, v2
    s_add_u32 m0, s68, 81920
    s_mov_b32 s70, 0
    buffer_load_dwordx4 v12, s[64:67], s70 offen  lds
    s_add_u32 m0, s68, 82944
    s_mov_b32 s70, 128
    buffer_load_dwordx4 v12, s[64:67], s70 offen  lds
    s_add_u32 m0, s68, 83968
    s_mov_b32 s70, 256
    buffer_load_dwordx4 v12, s[64:67], s70 offen  lds
    s_add_u32 m0, s68, 84992
    s_mov_b32 s70, 384
    buffer_load_dwordx4 v12, s[64:67], s70 offen  lds
    s_add_u32 m0, s68, 86016
    s_mov_b32 s70, 512
    buffer_load_dwordx4 v12, s[64:67], s70 offen  lds
    s_add_u32 m0, s68, 87040
    s_mov_b32 s70, 640
    buffer_load_dwordx4 v12, s[64:67], s70 offen  lds
    s_add_u32 m0, s68, 88064
    s_mov_b32 s70, 768
    buffer_load_dwordx4 v12, s[64:67], s70 offen  lds
    s_add_u32 m0, s68, 89088
    s_mov_b32 s70, 896
    buffer_load_dwordx4 v12, s[64:67], s70 offen  lds
    s_add_u32 m0, s68, 90112
    s_mov_b32 s70, 1024
    buffer_load_dwordx4 v12, s[64:67], s70 offen  lds
    s_add_u32 m0, s68, 91136
    s_mov_b32 s70, 1152
    buffer_load_dwordx4 v12, s[64:67], s70 offen  lds
    s_waitcnt vmcnt(10)
    s_barrier
    s_branch K_P2_EARLY
K_FFN_C:
    v_lshrrev_b32 v180, 4, v1
    v_bfe_u32 v2, v1, 2, 2
    v_lshl_add_u32 v2, v180, 3, v2
    v_and_b32 v3, 3, v1
    v_lshlrev_b32 v3, 3, v3
    v_lshl_add_u32 v181, v2, 6, v3
    s_bfe_u32 s3, s30, 0x10001
    s_mul_i32 s3, s3, 40960
    v_xor_b32 v4, s30, v180
    v_and_b32 v4, 1, v4
    v_lshl_add_u32 v181, v4, 5, v181
    v_add_u32 v181, s3, v181
    v_bfe_u32 v4, v1, 3, 2
    v_xor_b32 v4, s30, v4
    v_and_b32 v4, 3, v4
    v_lshl_add_u32 v3, v4, 5, v3
    v_and_b32 v2, 3, v2
    v_lshl_add_u32 v3, v2, 7, v3
    v_mul_u32_u24 v182, 10240, v180
    s_mov_b32 s3, 81920
    v_add3_u32 v182, v182, v3, s3
    v_mov_b32 v183, 123904
    s_cmp_lg_u32 s30, 5
    s_cbranch_scc1 K_KW
    s_mov_b32 s3, 131072
K_KPOLL:
    s_load_dwordx2 s[68:69], s[6:7], s42 offset:128 glc
    s_waitcnt lgkmcnt(0)
    s_min_u32 s33, s68, s69
    s_cmp_lg_u32 s33, 0
    s_cbranch_scc1 K_KGOT
    s_sleep 2
    s_sub_u32 s3, s3, 1
    s_cbranch_scc0 K_KPOLL
K_KGOT:
    v_mov_b32 v176, s68
    v_mov_b32 v177, s69
    ds_write_b64 v183, v[176:177]
    v_lshlrev_b32 v2, 4, v1
    s_and_b32 s70, s68, 0x7ff
    s_sub_u32 s70, 2047, s70
    s_mul_i32 s70, s70, 1280
    s_mov_b32 m0, 134208
    s_mov_b64 exec, -1
    buffer_load_dwordx4 v2, s[12:15], s70 offen lds
    s_mov_b64 exec, 0xffff
    buffer_load_dwordx4 v2, s[12:15], s70 offen offset:1024 lds
    s_and_b32 s70, s69, 0x7ff
    s_sub_u32 s70, 2047, s70
    s_mul_i32 s70, s70, 1280
    s_mov_b32 m0, 135552
    s_mov_b64 exec, -1
    buffer_load_dwordx4 v2, s[12:15], s70 offen lds
    s_mov_b64 exec, 0xffff
    buffer_load_dwordx4 v2, s[12:15], s70 offen offset:1024 lds
    s_mov_b64 exec, -1
    v_mov_b32 v3, 16
    s_waitcnt vmcnt(0)
    ds_write_b32 v13, v3 offset:48
    s_branch K_KW2
K_KW:
    s_cmp_lt_u32 s30, 6
    s_cbranch_scc1 K_KW2
    s_cmp_eq_u32 s30, 6
    s_cbranch_scc1 K_CHF0
    s_branch K_CHF1
K_WRET_F:
K_KW2:
    s_branch K_J7d44
K_CHF0:
K_STF16:
    s_branch K_STF18
    s_nop 0
K_J7d44:
    v_and_b32 v2, 1, v1
    v_mul_u32_u24 v9, 1344, v2
    v_lshl_add_u32 v9, v180, 4, v9
    v_add_u32 v9, 134208, v9
    v_and_b32 v2, 1, v1
    v_lshlrev_b32 v192, 6, v2
    v_lshl_add_u32 v192, v180, 4, v192
    s_and_b32 s3, s30, 3
    s_lshl_b32 s3, s3, 7
    v_add3_u32 v193, v192, s3, v183
    v_add_u32 v192, 64, v193
    v_add_u32 v193, 1088, v193
    v_lshrrev_b32 v2, 5, v1
    v_bfe_u32 v3, v1, 4, 1
    v_lshl_add_u32 v3, v3, 1, v2
    v_lshlrev_b32 v3, 6, v3
    v_and_b32 v4, 15, v1
    v_lshl_add_u32 v3, v4, 2, v3
    v_add_u32 v194, 123968, v3
    v_lshlrev_b32 v4, 1, v1
    s_add_u32 s3, s3, 124992
    v_add_u32 v195, s3, v4
    v_and_b32 v2, 1, v1
    v_mul_u32_u24 v2, 2560, v2
    v_lshl_add_u32 v196, v180, 4, v2
    s_lshl_b32 s70, s30, 6
    s_add_u32 s70, s70, 125760
    v_add_u32 v196, s70, v196
    v_mov_b32 v3, 1
    s_mov_b32 s3, 1048576
K_FGK:
    ds_read_b32 v2, v13 offset:48
    s_sleep 1
    s_sub_u32 s3, s3, 1
    s_waitcnt lgkmcnt(0)
    v_readfirstlane_b32 s33, v2
    s_nop 3
    s_cselect_b32 s33, 16, s33
    s_cmp_lt_u32 s33, 16
    s_cbranch_scc1 K_FGK
    ds_read_b128 v[96:99], v9 offset:0
    ds_read_b128 v[100:103], v9 offset:64
    ds_read_b128 v[104:107], v9 offset:128
    ds_read_b128 v[108:111], v9 offset:192
    ds_read_b128 v[112:115], v9 offset:256
    ds_read_b128 v[116:119], v9 offset:320
    ds_read_b128 v[120:123], v9 offset:384
    ds_read_b128 v[124:127], v9 offset:448
    ds_read_b128 v[128:131], v9 offset:512
    ds_read_b128 v[132:135], v9 offset:576
    ds_read_b128 v[136:139], v9 offset:640
    ds_read_b128 v[140:143], v9 offset:704
    ds_read_b128 v[144:147], v9 offset:768
    ds_read_b128 v[148:151], v9 offset:832
    ds_read_b128 v[152:155], v9 offset:896
    ds_read_b128 v[156:159], v9 offset:960
    ds_read_b128 v[160:163], v9 offset:1024
    ds_read_b128 v[164:167], v9 offset:1088
    ds_read_b128 v[168:171], v9 offset:1152
    ds_read_b128 v[172:175], v9 offset:1216
    s_setprio 3
    s_barrier
    ds_read_b64_tr_b16 v[16:17], v181 offset:0
    ds_read_b64_tr_b16 v[18:19], v181 offset:256
    ds_read_b64_tr_b16 v[20:21], v181 offset:2048
    ds_read_b64_tr_b16 v[22:23], v181 offset:2304
    ds_read_b64_tr_b16 v[24:25], v181 offset:4096
    ds_read_b64_tr_b16 v[26:27], v181 offset:4352
    ds_read_b64_tr_b16 v[28:29], v181 offset:6144
    ds_read_b64_tr_b16 v[30:31], v181 offset:6400
    ds_read_b64_tr_b16 v[32:33], v181 offset:8192
    ds_read_b64_tr_b16 v[34:35], v181 offset:8448
    ds_read_b64_tr_b16 v[36:37], v181 offset:10240
    ds_read_b64_tr_b16 v[38:39], v181 offset:10496
    ds_read_b64_tr_b16 v[40:41], v181 offset:12288
    ds_read_b64_tr_b16 v[42:43], v181 offset:12544
    ds_read_b64_tr_b16 v[44:45], v181 offset:14336
    ds_read_b64_tr_b16 v[46:47], v181 offset:14592
    ds_read_b64_tr_b16 v[48:49], v181 offset:16384
    ds_read_b64_tr_b16 v[50:51], v181 offset:16640
    ds_read_b64_tr_b16 v[52:53], v181 offset:18432
    ds_read_b64_tr_b16 v[54:55], v181 offset:18688
    ds_read_b64_tr_b16 v[56:57], v181 offset:20480
    ds_read_b64_tr_b16 v[58:59], v181 offset:20736
    ds_read_b64_tr_b16 v[60:61], v181 offset:22528
    ds_read_b64_tr_b16 v[62:63], v181 offset:22784
    ds_read_b64_tr_b16 v[64:65], v181 offset:24576
    ds_read_b64_tr_b16 v[66:67], v181 offset:24832
    ds_read_b64_tr_b16 v[68:69], v181 offset:26624
    ds_read_b64_tr_b16 v[70:71], v181 offset:26880
    ds_read_b64_tr_b16 v[72:73], v181 offset:28672
    ds_read_b64_tr_b16 v[74:75], v181 offset:28928
    ds_read_b64_tr_b16 v[76:77], v181 offset:30720
    ds_read_b64_tr_b16 v[78:79], v181 offset:30976
    ds_read_b64_tr_b16 v[80:81], v181 offset:32768
    ds_read_b64_tr_b16 v[82:83], v181 offset:33024
    ds_read_b64_tr_b16 v[84:85], v181 offset:34816
    ds_read_b64_tr_b16 v[86:87], v181 offset:35072
    ds_read_b64_tr_b16 v[88:89], v181 offset:36864
    s_branch K_PG7
.p2align 12
K_CHF1:
K_STF17:
    s_branch K_WRET_F
    s_nop 0
K_PG7:
    ds_read_b64_tr_b16 v[90:91], v181 offset:37120
    ds_read_b64_tr_b16 v[92:93], v181 offset:38912
    ds_read_b64_tr_b16 v[94:95], v181 offset:39168
    s_waitcnt lgkmcnt(0)
    s_barrier
    v_mfma_f32_16x16x32_bf16 v[184:187], v[16:19], v[96:99], 0
    v_mfma_f32_16x16x32_bf16 v[188:191], v[20:23], v[100:103], 0
    v_mfma_f32_16x16x32_bf16 v[184:187], v[24:27], v[104:107], v[184:187]
    v_mfma_f32_16x16x32_bf16 v[188:191], v[28:31], v[108:111], v[188:191]
    v_mfma_f32_16x16x32_bf16 v[184:187], v[32:35], v[112:115], v[184:187]
    v_mfma_f32_16x16x32_bf16 v[188:191], v[36:39], v[116:119], v[188:191]
    v_mfma_f32_16x16x32_bf16 v[184:187], v[40:43], v[120:123], v[184:187]
    v_mfma_f32_16x16x32_bf16 v[188:191], v[44:47], v[124:127], v[188:191]
    v_mfma_f32_16x16x32_bf16 v[184:187], v[48:51], v[128:131], v[184:187]
    v_mfma_f32_16x16x32_bf16 v[188:191], v[52:55], v[132:135], v[188:191]
    v_mfma_f32_16x16x32_bf16 v[184:187], v[56:59], v[136:139], v[184:187]
    v_mfma_f32_16x16x32_bf16 v[188:191], v[60:63], v[140:143], v[188:191]
    v_mfma_f32_16x16x32_bf16 v[184:187], v[64:67], v[144:147], v[184:187]
    v_mfma_f32_16x16x32_bf16 v[188:191], v[68:71], v[148:151], v[188:191]
    v_mfma_f32_16x16x32_bf16 v[184:187], v[72:75], v[152:155], v[184:187]
    v_mfma_f32_16x16x32_bf16 v[188:191], v[76:79], v[156:159], v[188:191]
    v_mfma_f32_16x16x32_bf16 v[184:187], v[80:83], v[160:163], v[184:187]
    v_mfma_f32_16x16x32_bf16 v[188:191], v[84:87], v[164:167], v[188:191]
    v_mfma_f32_16x16x32_bf16 v[184:187], v[88:91], v[168:171], v[184:187]
    v_mfma_f32_16x16x32_bf16 v[188:191], v[92:95], v[172:175], v[188:191]
    s_nop 7
    v_add_f32 v184, v184, v188
    v_add_f32 v185, v185, v189
    v_add_f32 v186, v186, v190
    v_add_f32 v187, v187, v191
    s_mov_b32 exec_lo, 0x00030003
    s_mov_b32 exec_hi, 0x00030003
    ds_write_b128 v192, v[184:187]
    s_mov_b64 exec, 1
    ds_add_u32 v13, v3 offset:52
    s_mov_b64 exec, -1
    s_cmp_lg_u32 s30, 6
    s_cbranch_scc1 K_NOS6B
    v_lshl_add_u32 v4, v1, 2, s42
    global_load_dword v7, v4, s[6:7] offset:256 sc1
    v_and_b32 v4, 0xfffffe04, v4
    global_load_dword v6, v4, s[6:7] offset:128 sc1
K_NOS6B:
    s_mov_b32 s3, 1048576
K_FGP:
    ds_read_b32 v2, v13 offset:52
    s_sleep 1
    s_sub_u32 s3, s3, 1
    s_waitcnt lgkmcnt(0)
    v_readfirstlane_b32 s33, v2
    s_nop 3
    s_cselect_b32 s33, 8, s33
    s_cmp_lt_u32 s33, 8
    s_cbranch_scc1 K_FGP
    ds_read_b32 v200, v194
    ds_read_b32 v202, v194 offset:256
    ds_read_b64_tr_b16 v[16:17], v182 offset:0
    ds_read_b64_tr_b16 v[18:19], v182 offset:512
    ds_read_b64_tr_b16 v[20:21], v182 offset:1024
    ds_read_b64_tr_b16 v[22:23], v182 offset:1536
    ds_read_b64_tr_b16 v[24:25], v182 offset:2048
    ds_read_b64_tr_b16 v[26:27], v182 offset:2560
    ds_read_b64_tr_b16 v[28:29], v182 offset:3072
    ds_read_b64_tr_b16 v[30:31], v182 offset:3584
    ds_read_b64_tr_b16 v[32:33], v182 offset:4096
    ds_read_b64_tr_b16 v[34:35], v182 offset:4608
    ds_read_b64_tr_b16 v[36:37], v182 offset:5120
    ds_read_b64_tr_b16 v[38:39], v182 offset:5632
    ds_read_b64_tr_b16 v[40:41], v182 offset:6144
    ds_read_b64_tr_b16 v[42:43], v182 offset:6656
    s_waitcnt lgkmcnt(14)
    v_cvt_pk_bf16_f32 v200, v200, v200
    v_lshlrev_b32 v200, 16, v200
    v_cvt_pk_bf16_f32 v202, v202, v202
    v_lshlrev_b32 v202, 16, v202
    v_mul_f32 v201, 0xbfb8aa3b, v200
    v_exp_f32 v201, v201
    s_nop 0
    v_add_f32 v201, 1.0, v201
    v_rcp_f32 v201, v201
    s_nop 0
    v_mul_f32 v200, v200, v201
    v_cvt_pk_bf16_f32 v200, v200, v200
    v_lshlrev_b32 v200, 16, v200
    v_mul_f32 v200, v200, v202
    v_cvt_pk_bf16_f32 v200, v200, v200
    ds_write_b16 v195, v200
    s_waitcnt lgkmcnt(0)
    ds_read_b128 v[200:203], v193
    ds_read_b64_tr_b16 v[44:45], v182 offset:7168
    ds_read_b64_tr_b16 v[46:47], v182 offset:7680
    ds_read_b64_tr_b16 v[48:49], v182 offset:8192
    ds_read_b64_tr_b16 v[50:51], v182 offset:8704
    ds_read_b64_tr_b16 v[52:53], v182 offset:9216
    ds_read_b64_tr_b16 v[54:55], v182 offset:9728
    s_waitcnt lgkmcnt(6)
    v_mfma_f32_16x16x32_bf16 v[96:99], v[16:19], v[200:203], 0
    v_mfma_f32_16x16x32_bf16 v[100:103], v[20:23], v[200:203], 0
    v_mfma_f32_16x16x32_bf16 v[104:107], v[24:27], v[200:203], 0
    v_mfma_f32_16x16x32_bf16 v[108:111], v[28:31], v[200:203], 0
    v_mfma_f32_16x16x32_bf16 v[112:115], v[32:35], v[200:203], 0
    v_mfma_f32_16x16x32_bf16 v[116:119], v[36:39], v[200:203], 0
    v_mfma_f32_16x16x32_bf16 v[120:123], v[40:43], v[200:203], 0
    s_waitcnt lgkmcnt(4)
    v_mfma_f32_16x16x32_bf16 v[124:127], v[44:47], v[200:203], 0
    s_waitcnt lgkmcnt(2)
    v_mfma_f32_16x16x32_bf16 v[128:131], v[48:51], v[200:203], 0
    s_waitcnt lgkmcnt(0)
    v_mfma_f32_16x16x32_bf16 v[132:135], v[52:55], v[200:203], 0
    s_mov_b32 exec_lo, 0x00030003
    s_mov_b32 exec_hi, 0x00030003
    ds_write_b128 v196, v[96:99] offset:0
    ds_write_b128 v196, v[100:103] offset:256
    ds_write_b128 v196, v[104:107] offset:512
    ds_write_b128 v196, v[108:111] offset:768
    ds_write_b128 v196, v[112:115] offset:1024
    ds_write_b128 v196, v[116:119] offset:1280
    ds_write_b128 v196, v[120:123] offset:1536
    ds_write_b128 v196, v[124:127] offset:1792
    ds_write_b128 v196, v[128:131] offset:2048
    ds_write_b128 v196, v[132:135] offset:2304
    v_mov_b32 v3, 1
    s_mov_b64 exec, 1
    ds_add_u32 v13, v3 offset:52
    s_mov_b64 exec, -1
    s_cmp_lg_u32 s30, 4
    s_cbranch_scc1 K_P2
    v_lshlrev_b32 v3, 4, v1
    v_add_u32 v4, 126016, v3
    s_mul_i32 s70, s43, 5120
    s_add_u32 s71, s70, 4096
    s_mov_b32 s3, 1048576
K_FGQ:
    ds_read_b32 v2, v13 offset:52
    s_sleep 1
    s_sub_u32 s3, s3, 1
    s_waitcnt lgkmcnt(0)
    v_readfirstlane_b32 s33, v2
    s_nop 3
    s_cselect_b32 s33, 12, s33
    s_cmp_lt_u32 s33, 12
    s_cbranch_scc1 K_FGQ
    ds_read_b128 v[16:19], v4 offset:0
    ds_read_b128 v[20:23], v4 offset:1024
    ds_read_b128 v[24:27], v4 offset:2048
    ds_read_b128 v[28:31], v4 offset:3072
    ds_read_b128 v[32:35], v4 offset:4096
    s_waitcnt lgkmcnt(4)
    s_branch K_J83c8
K_STF18:
    s_branch K_WRET_F
    s_nop 0
K_J83c8:
    buffer_store_dwordx4 v[16:19], v3, s[60:63], s70 offen offset:0 sc1
    s_waitcnt lgkmcnt(3)
    buffer_store_dwordx4 v[20:23], v3, s[60:63], s70 offen offset:1024 sc1
    s_waitcnt lgkmcnt(2)
    buffer_store_dwordx4 v[24:27], v3, s[60:63], s70 offen offset:2048 sc1
    s_waitcnt lgkmcnt(1)
    buffer_store_dwordx4 v[28:31], v3, s[60:63], s70 offen offset:3072 sc1
    s_waitcnt lgkmcnt(0)
    buffer_store_dwordx4 v[32:35], v3, s[60:63], s71 offen offset:0 sc1
    s_mov_b32 s3, 1
    s_waitcnt vmcnt(0)
    s_atomic_add s3, s[6:7], 606720 glc
    ds_read_b64 v[176:177], v183
    s_waitcnt lgkmcnt(0)
    s_cmp_lg_u32 s3, 53
    s_cbranch_scc1 K_P2
    v_readfirstlane_b32 s70, v176
    s_and_b32 s70, s70, 0x7ff
    s_sub_u32 s70, 2047, s70
    s_lshr_b32 s70, s70, 7
    s_mul_i32 s70, s70, 5120
    s_atomic_add s3, s[6:7], s70 offset:524424
    s_atomic_add s3, s[6:7], s70 offset:524936
    s_atomic_add s3, s[6:7], s70 offset:525448
    s_atomic_add s3, s[6:7], s70 offset:525960
    s_atomic_add s3, s[6:7], s70 offset:526472
    s_atomic_add s3, s[6:7], s70 offset:526984
    s_atomic_add s3, s[6:7], s70 offset:527496
    s_atomic_add s3, s[6:7], s70 offset:528008
    s_atomic_add s3, s[6:7], s70 offset:528520
    s_atomic_add s3, s[6:7], s70 offset:529032
    v_readfirstlane_b32 s70, v177
    s_and_b32 s70, s70, 0x7ff
    s_sub_u32 s70, 2047, s70
    s_lshr_b32 s70, s70, 7
    s_mul_i32 s70, s70, 5120
    s_atomic_add s3, s[6:7], s70 offset:524424
    s_atomic_add s3, s[6:7], s70 offset:524936
    s_atomic_add s3, s[6:7], s70 offset:525448
    s_atomic_add s3, s[6:7], s70 offset:525960
    s_atomic_add s3, s[6:7], s70 offset:526472
    s_atomic_add s3, s[6:7], s70 offset:526984
    s_atomic_add s3, s[6:7], s70 offset:527496
    s_atomic_add s3, s[6:7], s70 offset:528008
    s_atomic_add s3, s[6:7], s70 offset:528520
    s_atomic_add s3, s[6:7], s70 offset:529032
    s_waitcnt lgkmcnt(0)
    s_branch K_P2
K_CODE_END:
.section .rodata,"a"
.p2align 6
.amdhsa_kernel gated_mix__sliding_local_dilated__moe_arch_mod__prompt_kernel
  .amdhsa_next_free_vgpr 256
  .amdhsa_next_free_sgpr 79
  .amdhsa_accum_offset 256
  .amdhsa_group_segment_fixed_size 0
  .amdhsa_kernarg_size 96
  .amdhsa_user_sgpr_count 2
  .amdhsa_user_sgpr_kernarg_segment_ptr 1
  .amdhsa_system_sgpr_workgroup_id_x 1
.end_amdhsa_kernel
```

```asm
; @launch grid=(256,1,1) block=(512,1,1) lds=163840
.amdgcn_target "amdgcn-amd-amdhsa--gfx950"
.text
K_CPL = 33
.p2align 12
.p2align 8
.globl gated_mix__sliding_local_dilated__moe_arch_mod__prompt_kernel
.type gated_mix__sliding_local_dilated__moe_arch_mod__prompt_kernel,@function
gated_mix__sliding_local_dilated__moe_arch_mod__prompt_kernel:
    s_cmp_ge_u32 s2, 256
    s_cbranch_scc1 K_EXIT
    s_load_dwordx2 s[12:13], s[0:1], 0
    s_load_dwordx2 s[16:17], s[0:1], 8
    s_load_dwordx4 s[4:7], s[0:1], 80
    s_load_dwordx2 s[8:9], s[0:1], 16
    s_load_dwordx2 s[10:11], s[0:1], 72
    v_readfirstlane_b32 s30, v0
    s_mov_b32 s14, 0x280000
    s_mov_b32 s15, 0x20000
    s_lshr_b32 s30, s30, 6
    s_cmp_ge_u32 s2, 64
    s_cbranch_scc1 K_MAIN
    s_load_dwordx8 s[44:51], s[0:1], 32
    s_load_dwordx2 s[52:53], s[0:1], 64
    s_getpc_b64 s[38:39]
K_PC:
    s_lshr_b32 s3, s2, 3
    s_mul_i32 s3, s3, K_CPL
    v_add_u32 v2, s3, v0
    v_lshlrev_b32 v2, 7, v2
    v_min_u32 v2, K_CODE_END-K_PC-4, v2
    v_cmp_gt_u32 vcc, K_CPL, v0
    s_and_saveexec_b64 s[20:21], vcc
    s_cbranch_execz K_NOPF
    global_load_dword v6, v2, s[38:39]
K_NOPF:
    s_mov_b64 exec, -1
    s_cmp_lg_u32 s30, 4
    s_cbranch_scc1 K_AUX
    s_min_u32 s3, s2, 8
    s_mul_i32 s3, s3, 10240
    s_add_u32 s33, s3, 10240
    s_cmp_lt_u32 s2, 8
    s_cbranch_scc1 K_ZS
    s_cmp_lg_u32 s2, 63
    s_cbranch_scc1 K_AUX
    s_mov_b32 s33, 0
K_ZS:
    v_lshlrev_b32 v2, 4, v0
    v_mov_b32 v8, 0
    v_mov_b32 v9, 0
    v_mov_b32 v10, 0
    v_mov_b32 v11, 0
    s_waitcnt lgkmcnt(0)
    s_add_u32 s20, s6, 0x7f000
    s_addc_u32 s21, s7, 0
    s_mov_b32 s22, 0x15400
    s_mov_b32 s23, 0x20000
K_ZL:
    buffer_store_dwordx4 v[8:11], v2, s[20:23], s3 offen sc1
    s_add_u32 s3, s3, 1024
    s_cmp_lt_u32 s3, s33
    s_cbranch_scc1 K_ZL
    s_branch K_AUX
K_MAIN:
    s_cmp_ge_u32 s30, 4
    s_cbranch_scc1 K_CONS
    s_bfe_u32 s3, s2, 0x20001
    s_mul_i32 s44, s3, 675840
    s_lshr_b32 s33, s2, 6
    s_mul_i32 s3, s33, 225280
    s_add_u32 s44, s44, s3
    s_mul_i32 s3, s30, 61440
    s_add_u32 s44, s44, s3
    s_sub_u32 s44, s44, 245760
    v_bfe_u32 v3, v0, 4, 2
    s_lshr_b32 s3, s2, 1
    s_and_b32 s3, s3, 28
    s_or_b32 s3, s3, 0x40000
    v_lshlrev_b32 v2, 1, v3
    v_sub_u32 v2, v0, v2
    s_and_b32 s50, s2, 0xc1
    s_mov_b32 s49, 0x225510
    s_cmpk_eq_u32 s50, 128
    s_cselect_b32 s49, 0x75275525, s49
    s_cmpk_eq_u32 s50, 192
    s_cselect_b32 s49, 0x37765750, s49
    s_cmpk_eq_u32 s50, 65
    s_cselect_b32 s49, 0x225510, s49
    s_cmpk_eq_u32 s50, 129
    s_cselect_b32 s49, 0x75275525, s49
    s_cmpk_eq_u32 s50, 193
    s_cselect_b32 s49, 0x37765750, s49
    s_bfe_u32 s49, s49, s3
    s_bfe_u32 s32, 0x64317520, s3
    v_and_b32 v2, 15, v2
    v_mul_u32_u24 v5, 3840, v3
    s_lshl_b32 s3, s2, 2
    s_lshr_b32 s3, 0x44032335, s3
    s_and_b32 s3, s3, 15
    s_add_u32 s49, s49, s3
    s_mov_b32 s33, 0x00a55a
    v_subrev_u32 v5, 160, v5
    s_sub_u32 s3, s49, 10
    s_cselect_b32 s49, s49, s3
    v_mul_u32_u24 v4, 52, v2
    v_lshrrev_b32 v4, 5, v4
    v_and_b32 v4, 24, v4
    v_bfe_u32 v4, s33, v4, 8
    v_add_u32 v4, v4, v2
    v_lshl_add_u32 v218, v4, 4, v5
    v_add_u32 v4, 1, v2
    v_lshrrev_b32 v4, 4, v4
    v_lshl_add_u32 v218, v4, 28, v218
    v_xor_b32 v2, 8, v2
    v_mul_u32_u24 v4, 52, v2
    v_lshrrev_b32 v4, 5, v4
    v_and_b32 v4, 24, v4
    v_bfe_u32 v4, s33, v4, 8
    v_add_u32 v4, v4, v2
    v_lshl_add_u32 v219, v4, 4, v5
    v_add_u32 v4, 1, v2
    v_lshrrev_b32 v4, 4, v4
    v_lshl_add_u32 v219, v4, 28, v219
    s_bitcmp1_b32 s2, 0
    s_cselect_b32 s3, 8, 0
    s_add_u32 s32, s32, s3
    s_mul_i32 s50, s32, 80
    s_mul_i32 s3, s30, 61440
    s_add_u32 s50, s50, s3
    s_lshl_b32 s46, s30, 12
    s_add_u32 s46, s46, 24576
    s_mul_i32 s45, s30, 6144
    s_mov_b32 s18, 0x258000
    s_mov_b32 s19, 0x20000
    v_xor_b32 v3, v3, v0
    v_and_b32 v3, 7, v3
    v_bfe_u32 v2, v0, 3, 3
    v_mul_u32_u24 v2, 1280, v2
    v_lshl_add_u32 v216, v3, 4, v2
    v_xor_b32 v217, 64, v216
    s_lshl_b32 s47, s49, 7
    s_mul_i32 s48, s49, 245760
    s_add_u32 s51, s44, s47
    s_add_u32 s48, s48, s50
    s_add_u32 s49, s49, 1
    s_cmp_eq_u32 s49, 10
    s_cselect_b32 s49, 0, s49
    s_waitcnt lgkmcnt(0)
    s_add_u32 m0, s46, 81920
    s_add_u32 s52, s48, 0
    buffer_load_dwordx4 v218, s[16:19], s52 offen lds
    s_add_u32 m0, s45, 81920
    s_max_i32 s52, s51, s47
    buffer_load_dwordx4 v216, s[12:15], s52 offen lds
    s_add_u32 m0, s46, 82944
    s_add_u32 s52, s48, 15360
    buffer_load_dwordx4 v218, s[16:19], s52 offen lds
    s_add_u32 m0, s45, 82944
    s_add_u32 s52, s51, 10240
    s_max_i32 s52, s52, s47
    buffer_load_dwordx4 v217, s[12:15], s52 offen lds
    s_add_u32 m0, s45, 83968
    s_add_u32 s52, s51, 20480
    buffer_load_dwordx4 v216, s[12:15], s52 offen lds
    s_add_u32 m0, s46, 83968
    s_add_u32 s52, s48, 30720
    buffer_load_dwordx4 v219, s[16:19], s52 offen lds
    s_add_u32 m0, s45, 84992
    s_add_u32 s52, s51, 30720
    buffer_load_dwordx4 v217, s[12:15], s52 offen lds
    s_add_u32 m0, s46, 84992
    s_add_u32 s52, s48, 46080
    buffer_load_dwordx4 v219, s[16:19], s52 offen lds
    s_add_u32 m0, s45, 86016
    s_add_u32 s52, s51, 40960
    buffer_load_dwordx4 v216, s[12:15], s52 offen lds
    s_add_u32 m0, s45, 87040
    s_add_u32 s52, s51, 51200
    buffer_load_dwordx4 v217, s[12:15], s52 offen lds
    s_lshl_b32 s47, s49, 7
    s_mul_i32 s48, s49, 245760
    s_add_u32 s51, s44, s47
    s_add_u32 s48, s48, s50
    s_add_u32 s49, s49, 1
    s_cmp_eq_u32 s49, 10
    s_cselect_b32 s49, 0, s49
    s_add_u32 m0, s46, 0
    s_add_u32 s52, s48, 0
    buffer_load_dwordx4 v218, s[16:19], s52 offen lds
    s_add_u32 m0, s45, 0
    s_max_i32 s52, s51, s47
    buffer_load_dwordx4 v216, s[12:15], s52 offen lds
    s_add_u32 m0, s46, 1024
    s_add_u32 s52, s48, 15360
    buffer_load_dwordx4 v218, s[16:19], s52 offen lds
    s_add_u32 m0, s45, 1024
    s_add_u32 s52, s51, 10240
    s_max_i32 s52, s52, s47
    buffer_load_dwordx4 v217, s[12:15], s52 offen lds
    s_add_u32 m0, s45, 2048
    s_add_u32 s52, s51, 20480
    buffer_load_dwordx4 v216, s[12:15], s52 offen lds
    s_add_u32 m0, s46, 2048
    s_add_u32 s52, s48, 30720
    buffer_load_dwordx4 v219, s[16:19], s52 offen lds
    s_mov_b32 s43, s30
    v_and_b32 v1, 63, v0
    v_mov_b32 v7, 0
    s_and_b32 s28, s2, 7
    s_lshr_b32 s29, s2, 3
    s_xor_b32 s30, s30, 4
    s_lshr_b32 s34, s29, 3
    s_lshl_b32 s34, s34, 2
    s_and_b32 s3, s29, 3
    s_add_u32 s34, s34, s3
    s_add_u32 s34, s34, 4
    s_bitcmp1_b32 s29, 2
    s_cselect_b32 s34, -1, s34
    s_cmp_lt_u32 s29, 8
    s_cselect_b32 s34, s29, s34
    s_lshl_b32 s40, s28, 1
    s_cmp_ge_u32 s34, 10
    s_addc_u32 s40, s40, 0
    s_sub_u32 s41, s34, 10
    s_cmp_ge_u32 s34, 10
    s_cselect_b32 s41, s41, s34
    s_mul_i32 s42, s28, 20
    s_add_u32 s42, s42, s34
    s_and_b32 s42, s42, 255
    s_lshl_b32 s42, s42, 9
    s_add_u32 s42, s42, 524288
    s_lshr_b32 s31, s28, 1
    s_mul_i32 s31, s31, 3
    s_lshr_b32 s3, s29, 3
    s_add_u32 s31, s31, s3
    s_sub_u32 s31, s31, 1
    s_and_b32 s32, s28, 1
    s_lshl_b32 s32, s32, 3
    s_and_b32 s3, s29, 7
    s_lshl_b32 s3, s3, 2
    s_lshr_b32 s3, 0x64317520, s3
    s_and_b32 s3, s3, 7
    s_add_u32 s32, s32, s3
    s_and_b32 s35, s29, 3
    s_and_b32 s3, s29, 4
    s_lshl_b32 s3, s3, 1
    s_add_u32 s35, s35, s3
    s_and_b32 s3, s28, 1
    s_lshl_b32 s3, s3, 2
    s_add_u32 s35, s35, s3
K_LOADER:
    s_mov_b32 s24, s8
    s_mov_b32 s25, s9
    s_mov_b32 s26, 0xc8000
    s_mov_b32 s27, 0x20000
    v_and_b32 v8, 15, v1
    v_lshrrev_b32 v9, 4, v1
    v_bfe_u32 v10, v1, 2, 2
    v_and_b32 v11, 3, v1
    s_add_u32 s20, s6, 0x100000
    s_addc_u32 s21, s7, 0
    s_mov_b32 s22, 0x280000
    s_mov_b32 s23, 0x20000
    s_lshr_b32 s53, s35, 2
    s_add_u32 s3, s53, s35
    s_lshl_b32 s3, s3, 12
    s_mul_i32 s33, s53, 19456
    s_lshl_b32 s53, s35, 8
    s_add_u32 s33, s33, s53
    s_add_u32 s33, s33, 16384
    s_mul_i32 s53, s31, 11
    s_add_u32 s54, s53, s43
    v_mov_b32 v3, s54
    v_lshrrev_b32 v2, 2, v3
    v_mul_u32_u24 v2, 76, v2
    v_add_lshl_u32 v2, v2, v3, 10
    v_lshl_add_u32 v2, v8, 4, v2
    v_add_u32 v220, s3, v2
    v_lshl_add_u32 v220, v9, 8, v220
    s_lshl_b32 s3, s43, 2
    v_add_u32 v4, s3, v9
    v_add_u32 v3, s53, v4
    v_lshrrev_b32 v2, 2, v3
    v_mul_u32_u24 v2, 76, v2
    v_add_lshl_u32 v2, v2, v3, 10
    v_lshl_add_u32 v2, v8, 4, v2
    v_add_u32 v221, s33, v2
    v_mov_b32 v5, 0x10000000
    v_cmp_gt_u32 vcc, 11, v4
    v_mov_b32 v224, -1
    v_mov_b32 v225, -1
    v_mov_b32 v226, -1
    v_mov_b32 v227, -1
    v_cndmask_b32 v221, v5, v221, vcc
    v_lshrrev_b32 v2, 3, v1
    v_mul_u32_u24 v2, 1280, v2
    v_lshrrev_b32 v3, 2, v1
    v_and_b32 v3, 4, v3
    v_and_b32 v4, 7, v1
    v_xor_b32 v3, v3, v4
    v_lshl_add_u32 v2, v3, 4, v2
    s_lshl_b32 s33, s41, 7
    v_add_u32 v222, s33, v2
    v_lshrrev_b32 v5, 5, v1
    v_mul_u32_u24 v5, 20480, v5
    v_add_u32 v5, v5, v222
    s_mov_b32 s30, s43
    s_waitcnt vmcnt(6)
    s_barrier
    s_add_u32 m0, s45, 3072
    s_add_u32 s52, s51, 30720
    buffer_load_dwordx4 v217, s[12:15], s52 offen lds
    s_add_u32 m0, s46, 3072
    s_add_u32 s52, s48, 46080
    buffer_load_dwordx4 v219, s[16:19], s52 offen lds
    s_add_u32 m0, s45, 4096
    s_add_u32 s52, s51, 40960
    buffer_load_dwordx4 v216, s[12:15], s52 offen lds
    s_add_u32 m0, s45, 5120
    s_add_u32 s52, s51, 51200
    buffer_load_dwordx4 v217, s[12:15], s52 offen lds
    s_lshl_b32 s47, s49, 7
    s_mul_i32 s48, s49, 245760
    s_add_u32 s51, s44, s47
    s_add_u32 s48, s48, s50
    s_add_u32 s49, s49, 1
    s_cmp_eq_u32 s49, 10
    s_cselect_b32 s49, 0, s49
    s_add_u32 m0, s46, 40960
    s_add_u32 s52, s48, 0
    buffer_load_dwordx4 v218, s[16:19], s52 offen lds
    s_add_u32 m0, s45, 40960
    s_max_i32 s52, s51, s47
    buffer_load_dwordx4 v216, s[12:15], s52 offen lds
    s_add_u32 m0, s46, 41984
    s_add_u32 s52, s48, 15360
    buffer_load_dwordx4 v218, s[16:19], s52 offen lds
    s_add_u32 m0, s45, 41984
    s_add_u32 s52, s51, 10240
    s_max_i32 s52, s52, s47
    buffer_load_dwordx4 v217, s[12:15], s52 offen lds
    s_add_u32 m0, s45, 43008
    s_add_u32 s52, s51, 20480
    buffer_load_dwordx4 v216, s[12:15], s52 offen lds
    s_add_u32 m0, s46, 43008
    s_add_u32 s52, s48, 30720
    buffer_load_dwordx4 v219, s[16:19], s52 offen lds
    s_waitcnt vmcnt(6)
    s_barrier
    s_add_u32 m0, s45, 44032
    s_add_u32 s52, s51, 30720
    buffer_load_dwordx4 v217, s[12:15], s52 offen lds
    s_add_u32 m0, s46, 44032
    s_add_u32 s52, s48, 46080
    buffer_load_dwordx4 v219, s[16:19], s52 offen lds
    s_add_u32 m0, s45, 45056
    s_add_u32 s52, s51, 40960
    buffer_load_dwordx4 v216, s[12:15], s52 offen lds
    s_add_u32 m0, s45, 46080
    s_add_u32 s52, s51, 51200
    buffer_load_dwordx4 v217, s[12:15], s52 offen lds
    s_lshl_b32 s47, s49, 7
    s_mul_i32 s48, s49, 245760
    s_add_u32 s51, s44, s47
    s_add_u32 s48, s48, s50
    s_add_u32 s49, s49, 1
    s_cmp_eq_u32 s49, 10
    s_cselect_b32 s49, 0, s49
    s_add_u32 m0, s46, 81920
    s_add_u32 s52, s48, 0
    buffer_load_dwordx4 v218, s[16:19], s52 offen lds
    s_add_u32 m0, s45, 81920
    s_max_i32 s52, s51, s47
    buffer_load_dwordx4 v216, s[12:15], s52 offen lds
    s_add_u32 m0, s46, 82944
    s_add_u32 s52, s48, 15360
    buffer_load_dwordx4 v218, s[16:19], s52 offen lds
    s_add_u32 m0, s45, 82944
    s_add_u32 s52, s51, 10240
    s_max_i32 s52, s52, s47
    buffer_load_dwordx4 v217, s[12:15], s52 offen lds
    s_add_u32 m0, s45, 83968
    s_add_u32 s52, s51, 20480
    buffer_load_dwordx4 v216, s[12:15], s52 offen lds
    s_add_u32 m0, s46, 83968
    s_add_u32 s52, s48, 30720
    buffer_load_dwordx4 v219, s[16:19], s52 offen lds
    s_waitcnt vmcnt(6)
    s_barrier
    s_add_u32 m0, s45, 84992
    s_add_u32 s52, s51, 30720
    buffer_load_dwordx4 v217, s[12:15], s52 offen lds
    s_add_u32 m0, s46, 84992
    s_add_u32 s52, s48, 46080
    buffer_load_dwordx4 v219, s[16:19], s52 offen lds
    s_add_u32 m0, s45, 86016
    s_add_u32 s52, s51, 40960
    buffer_load_dwordx4 v216, s[12:15], s52 offen lds
    s_add_u32 m0, s45, 87040
    s_add_u32 s52, s51, 51200
    buffer_load_dwordx4 v217, s[12:15], s52 offen lds
    s_lshl_b32 s47, s49, 7
    s_mul_i32 s48, s49, 245760
    s_add_u32 s51, s44, s47
    s_add_u32 s48, s48, s50
    s_add_u32 s49, s49, 1
    s_cmp_eq_u32 s49, 10
    s_cselect_b32 s49, 0, s49
    s_add_u32 m0, s46, 0
    s_add_u32 s52, s48, 0
    buffer_load_dwordx4 v218, s[16:19], s52 offen lds
    s_add_u32 m0, s45, 0
    s_max_i32 s52, s51, s47
    buffer_load_dwordx4 v216, s[12:15], s52 offen lds
    s_add_u32 m0, s46, 1024
    s_add_u32 s52, s48, 15360
    buffer_load_dwordx4 v218, s[16:19], s52 offen lds
    s_add_u32 m0, s45, 1024
    s_add_u32 s52, s51, 10240
    s_max_i32 s52, s52, s47
    buffer_load_dwordx4 v217, s[12:15], s52 offen lds
    s_add_u32 m0, s45, 2048
    s_add_u32 s52, s51, 20480
    buffer_load_dwordx4 v216, s[12:15], s52 offen lds
    s_add_u32 m0, s46, 2048
    s_add_u32 s52, s48, 30720
    buffer_load_dwordx4 v219, s[16:19], s52 offen lds
    s_waitcnt vmcnt(6)
    s_barrier
    s_add_u32 m0, s45, 3072
    s_add_u32 s52, s51, 30720
    buffer_load_dwordx4 v217, s[12:15], s52 offen lds
    s_add_u32 m0, s46, 3072
    s_add_u32 s52, s48, 46080
    buffer_load_dwordx4 v219, s[16:19], s52 offen lds
    s_add_u32 m0, s45, 4096
    s_add_u32 s52, s51, 40960
    buffer_load_dwordx4 v216, s[12:15], s52 offen lds
    s_add_u32 m0, s45, 5120
    s_add_u32 s52, s51, 51200
    buffer_load_dwordx4 v217, s[12:15], s52 offen lds
    s_lshl_b32 s47, s49, 7
    s_mul_i32 s48, s49, 245760
    s_add_u32 s51, s44, s47
    s_add_u32 s48, s48, s50
    s_add_u32 s49, s49, 1
    s_cmp_eq_u32 s49, 10
    s_cselect_b32 s49, 0, s49
    s_add_u32 m0, s46, 40960
    s_add_u32 s52, s48, 0
    buffer_load_dwordx4 v218, s[16:19], s52 offen lds
    s_add_u32 m0, s45, 40960
    s_max_i32 s52, s51, s47
    buffer_load_dwordx4 v216, s[12:15], s52 offen lds
    s_add_u32 m0, s46, 41984
    s_add_u32 s52, s48, 15360
    buffer_load_dwordx4 v218, s[16:19], s52 offen lds
    s_add_u32 m0, s45, 41984
    s_add_u32 s52, s51, 10240
    s_max_i32 s52, s52, s47
    buffer_load_dwordx4 v217, s[12:15], s52 offen lds
    s_add_u32 m0, s45, 43008
    s_add_u32 s52, s51, 20480
    buffer_load_dwordx4 v216, s[12:15], s52 offen lds
    s_add_u32 m0, s46, 43008
    s_add_u32 s52, s48, 30720
    buffer_load_dwordx4 v219, s[16:19], s52 offen lds
    s_waitcnt vmcnt(6)
    s_barrier
    s_add_u32 m0, s45, 44032
    s_add_u32 s52, s51, 30720
    buffer_load_dwordx4 v217, s[12:15], s52 offen lds
    s_add_u32 m0, s46, 44032
    s_add_u32 s52, s48, 46080
    buffer_load_dwordx4 v219, s[16:19], s52 offen lds
    s_add_u32 m0, s45, 45056
    s_add_u32 s52, s51, 40960
    buffer_load_dwordx4 v216, s[12:15], s52 offen lds
    s_add_u32 m0, s45, 46080
    s_add_u32 s52, s51, 51200
    buffer_load_dwordx4 v217, s[12:15], s52 offen lds
    s_lshl_b32 s47, s49, 7
    s_mul_i32 s48, s49, 245760
    s_add_u32 s51, s44, s47
    s_add_u32 s48, s48, s50
    s_add_u32 s49, s49, 1
    s_cmp_eq_u32 s49, 10
    s_cselect_b32 s49, 0, s49
    s_add_u32 m0, s46, 81920
    s_add_u32 s52, s48, 0
    buffer_load_dwordx4 v218, s[16:19], s52 offen lds
    s_add_u32 m0, s45, 81920
    s_max_i32 s52, s51, s47
    buffer_load_dwordx4 v216, s[12:15], s52 offen lds
    s_add_u32 m0, s46, 82944
    s_add_u32 s52, s48, 15360
    buffer_load_dwordx4 v218, s[16:19], s52 offen lds
    s_add_u32 m0, s45, 82944
    s_add_u32 s52, s51, 10240
    s_max_i32 s52, s52, s47
    buffer_load_dwordx4 v217, s[12:15], s52 offen lds
    s_add_u32 m0, s45, 83968
    s_add_u32 s52, s51, 20480
    buffer_load_dwordx4 v216, s[12:15], s52 offen lds
    s_add_u32 m0, s46, 83968
    s_add_u32 s52, s48, 30720
    buffer_load_dwordx4 v219, s[16:19], s52 offen lds
    s_waitcnt vmcnt(6)
    s_barrier
    s_add_u32 m0, s45, 84992
    s_add_u32 s52, s51, 30720
    buffer_load_dwordx4 v217, s[12:15], s52 offen lds
    s_add_u32 m0, s46, 84992
    s_add_u32 s52, s48, 46080
    buffer_load_dwordx4 v219, s[16:19], s52 offen lds
    s_add_u32 m0, s45, 86016
    s_add_u32 s52, s51, 40960
    buffer_load_dwordx4 v216, s[12:15], s52 offen lds
    s_add_u32 m0, s45, 87040
    s_add_u32 s52, s51, 51200
    buffer_load_dwordx4 v217, s[12:15], s52 offen lds
    s_lshl_b32 s47, s49, 7
    s_mul_i32 s48, s49, 245760
    s_add_u32 s51, s44, s47
    s_add_u32 s48, s48, s50
    s_add_u32 s49, s49, 1
    s_cmp_eq_u32 s49, 10
    s_cselect_b32 s49, 0, s49
    s_add_u32 m0, s46, 0
    s_add_u32 s52, s48, 0
    buffer_load_dwordx4 v218, s[16:19], s52 offen lds
    s_add_u32 m0, s45, 0
    s_max_i32 s52, s51, s47
    buffer_load_dwordx4 v216, s[12:15], s52 offen lds
    s_add_u32 m0, s46, 1024
    s_add_u32 s52, s48, 15360
    buffer_load_dwordx4 v218, s[16:19], s52 offen lds
    s_add_u32 m0, s45, 1024
    s_add_u32 s52, s51, 10240
    s_max_i32 s52, s52, s47
    buffer_load_dwordx4 v217, s[12:15], s52 offen lds
    s_add_u32 m0, s45, 2048
    s_add_u32 s52, s51, 20480
    buffer_load_dwordx4 v216, s[12:15], s52 offen lds
    s_add_u32 m0, s46, 2048
    s_add_u32 s52, s48, 30720
    buffer_load_dwordx4 v219, s[16:19], s52 offen lds
    s_waitcnt vmcnt(6)
    s_barrier
    s_add_u32 m0, s45, 3072
    s_add_u32 s52, s51, 30720
    s_branch K_PG0
.p2align 12
K_CHM0:
K_STM0:
    s_branch K_WRET_M
    s_nop 0
K_PG0:
    buffer_load_dwordx4 v217, s[12:15], s52 offen lds
    s_add_u32 m0, s46, 3072
    s_add_u32 s52, s48, 46080
    buffer_load_dwordx4 v219, s[16:19], s52 offen lds
    s_add_u32 m0, s45, 4096
    s_add_u32 s52, s51, 40960
    buffer_load_dwordx4 v216, s[12:15], s52 offen lds
    s_add_u32 m0, s45, 5120
    s_add_u32 s52, s51, 51200
    buffer_load_dwordx4 v217, s[12:15], s52 offen lds
    s_lshl_b32 s47, s49, 7
    s_mul_i32 s48, s49, 245760
    s_add_u32 s51, s44, s47
    s_add_u32 s48, s48, s50
    s_add_u32 s49, s49, 1
    s_cmp_eq_u32 s49, 10
    s_cselect_b32 s49, 0, s49
    s_add_u32 m0, s46, 40960
    s_add_u32 s52, s48, 0
    buffer_load_dwordx4 v218, s[16:19], s52 offen lds
    s_add_u32 m0, s45, 40960
    s_max_i32 s52, s51, s47
    buffer_load_dwordx4 v216, s[12:15], s52 offen lds
    s_add_u32 m0, s46, 41984
    s_add_u32 s52, s48, 15360
    buffer_load_dwordx4 v218, s[16:19], s52 offen lds
    s_add_u32 m0, s45, 41984
    s_add_u32 s52, s51, 10240
    s_max_i32 s52, s52, s47
    buffer_load_dwordx4 v217, s[12:15], s52 offen lds
    s_add_u32 m0, s45, 43008
    s_add_u32 s52, s51, 20480
    buffer_load_dwordx4 v216, s[12:15], s52 offen lds
    s_add_u32 m0, s46, 43008
    s_add_u32 s52, s48, 30720
    buffer_load_dwordx4 v219, s[16:19], s52 offen lds
    s_waitcnt vmcnt(6)
    s_barrier
    s_add_u32 m0, s45, 44032
    s_add_u32 s52, s51, 30720
    buffer_load_dwordx4 v217, s[12:15], s52 offen lds
    s_add_u32 m0, s46, 44032
    s_add_u32 s52, s48, 46080
    buffer_load_dwordx4 v219, s[16:19], s52 offen lds
    s_add_u32 m0, s45, 45056
    s_add_u32 s52, s51, 40960
    buffer_load_dwordx4 v216, s[12:15], s52 offen lds
    s_add_u32 m0, s45, 46080
    s_add_u32 s52, s51, 51200
    buffer_load_dwordx4 v217, s[12:15], s52 offen lds
    s_lshl_b32 s47, s49, 7
    s_mul_i32 s48, s49, 245760
    s_add_u32 s51, s44, s47
    s_add_u32 s48, s48, s50
    s_add_u32 s49, s49, 1
    s_cmp_eq_u32 s49, 10
    s_cselect_b32 s49, 0, s49
    s_add_u32 m0, s46, 81920
    s_add_u32 s52, s48, 0
    buffer_load_dwordx4 v218, s[16:19], s52 offen lds
    s_add_u32 m0, s45, 81920
    s_max_i32 s52, s51, s47
    buffer_load_dwordx4 v216, s[12:15], s52 offen lds
    s_add_u32 m0, s46, 82944
    s_add_u32 s52, s48, 15360
    buffer_load_dwordx4 v218, s[16:19], s52 offen lds
    s_add_u32 m0, s45, 82944
    s_add_u32 s52, s51, 10240
    s_max_i32 s52, s52, s47
    buffer_load_dwordx4 v217, s[12:15], s52 offen lds
    s_add_u32 m0, s45, 83968
    s_add_u32 s52, s51, 20480
    buffer_load_dwordx4 v216, s[12:15], s52 offen lds
    s_add_u32 m0, s46, 83968
    s_add_u32 s52, s48, 30720
    buffer_load_dwordx4 v219, s[16:19], s52 offen lds
    s_waitcnt vmcnt(6)
    s_barrier
    s_load_dword s54, s[4:5], 192
    s_add_u32 m0, s45, 84992
    s_add_u32 s52, s51, 30720
    buffer_load_dwordx4 v217, s[12:15], s52 offen lds
    s_add_u32 m0, s46, 84992
    s_add_u32 s52, s48, 46080
    buffer_load_dwordx4 v219, s[16:19], s52 offen lds
    s_add_u32 m0, s45, 86016
    s_add_u32 s52, s51, 40960
    buffer_load_dwordx4 v216, s[12:15], s52 offen lds
    s_add_u32 m0, s45, 87040
    s_add_u32 s52, s51, 51200
    buffer_load_dwordx4 v217, s[12:15], s52 offen lds
    s_waitcnt lgkmcnt(0)
    s_cmp_ge_u32 s54, 8
    s_cbranch_scc1 K_ZO0
    s_mov_b32 s3, 16384
K_ZB0:
    v_mov_b32 v4, 192
    global_load_dword v4, v4, s[4:5] sc1
    s_waitcnt vmcnt(0)
    v_readfirstlane_b32 s33, v4
    s_cmp_ge_u32 s33, 8
    s_cbranch_scc1 K_ZO0
    s_sleep 8
    s_sub_u32 s3, s3, 1
    s_cbranch_scc0 K_ZB0
K_ZO0:
    s_cmp_eq_u32 s34, -1
    s_cbranch_scc1 K_NOLT
    s_lshl_b32 s47, s43, 2
    s_lshr_b32 s47, 0x7520, s47
    s_and_b32 s47, s47, 7
    s_mul_i32 s47, s47, 51200
    s_lshl_b32 s48, s43, 12
    s_add_u32 s3, s47, 0
    s_add_u32 m0, s48, 0
    s_nop 0
    buffer_load_dwordx4 v222, s[24:27], s3 offen lds
    s_add_u32 s3, s47, 10240
    s_add_u32 m0, s48, 1024
    s_nop 0
    buffer_load_dwordx4 v222, s[24:27], s3 offen lds
    s_add_u32 s3, s47, 25600
    s_add_u32 m0, s48, 2048
    s_nop 0
    buffer_load_dwordx4 v222, s[24:27], s3 offen lds
    s_add_u32 s3, s47, 35840
    s_add_u32 m0, s48, 3072
    s_nop 0
    buffer_load_dwordx4 v222, s[24:27], s3 offen lds
    s_add_u32 s3, s47, 409600
    s_add_u32 m0, s48, 20480
    s_nop 0
    buffer_load_dwordx4 v222, s[24:27], s3 offen lds
    s_add_u32 s3, s47, 419840
    s_add_u32 m0, s48, 21504
    s_nop 0
    buffer_load_dwordx4 v222, s[24:27], s3 offen lds
    s_add_u32 s3, s47, 435200
    s_add_u32 m0, s48, 22528
    s_nop 0
    buffer_load_dwordx4 v222, s[24:27], s3 offen lds
    s_add_u32 s3, s47, 445440
    s_add_u32 m0, s48, 23552
    s_nop 0
    buffer_load_dwordx4 v222, s[24:27], s3 offen lds
    s_lshl_b32 s48, s43, 10
    s_add_u32 s3, s47, 20480
    s_add_u32 m0, s48, 16384
    s_nop 0
    buffer_load_dwordx4 v5, s[24:27], s3 offen lds
    s_add_u32 s3, s47, 430080
    s_add_u32 m0, s48, 36864
    s_nop 0
    buffer_load_dwordx4 v5, s[24:27], s3 offen lds
    s_waitcnt vmcnt(10)
    s_barrier
    s_mov_b32 s33, 81920
    s_cmp_eq_u32 s43, 3
    s_cselect_b32 s3, 0, 163840
    buffer_store_dwordx4 v[224:227], v220, s[20:23], 0 offen sc1
    buffer_store_dwordx4 v[224:227], v220, s[20:23], s33 offen sc1
    buffer_store_dwordx4 v[224:227], v220, s[20:23], s3 offen sc1
    buffer_store_dwordx4 v[224:227], v221, s[20:23], 0 offen sc1
    v_mov_b32 v2, 158720
    v_mov_b32 v3, 1
    s_waitcnt vmcnt(0)
    s_mov_b64 exec, 1
    ds_add_u32 v2, v3 offset:28
    ds_add_u32 v2, v3 offset:32
    s_mov_b64 exec, -1
    s_lshl_b32 s47, s43, 2
    s_lshr_b32 s47, 0x6431, s47
    s_and_b32 s47, s47, 7
    s_mul_i32 s47, s47, 51200
    s_lshl_b32 s48, s43, 12
    s_add_u32 s3, s47, 0
    s_add_u32 m0, s48, 40960
    s_nop 0
    buffer_load_dwordx4 v222, s[24:27], s3 offen lds
    s_add_u32 s3, s47, 10240
    s_add_u32 m0, s48, 41984
    s_nop 0
    buffer_load_dwordx4 v222, s[24:27], s3 offen lds
    s_add_u32 s3, s47, 25600
    s_add_u32 m0, s48, 43008
    s_nop 0
    buffer_load_dwordx4 v222, s[24:27], s3 offen lds
    s_add_u32 s3, s47, 35840
    s_add_u32 m0, s48, 44032
    s_nop 0
    buffer_load_dwordx4 v222, s[24:27], s3 offen lds
    s_add_u32 s3, s47, 409600
    s_add_u32 m0, s48, 61440
    s_nop 0
    buffer_load_dwordx4 v222, s[24:27], s3 offen lds
    s_add_u32 s3, s47, 419840
    s_add_u32 m0, s48, 62464
    s_nop 0
    buffer_load_dwordx4 v222, s[24:27], s3 offen lds
    s_add_u32 s3, s47, 435200
    s_add_u32 m0, s48, 63488
    s_nop 0
    buffer_load_dwordx4 v222, s[24:27], s3 offen lds
    s_add_u32 s3, s47, 445440
    s_add_u32 m0, s48, 64512
    s_nop 0
    buffer_load_dwordx4 v222, s[24:27], s3 offen lds
    s_lshl_b32 s48, s43, 10
    s_add_u32 s3, s47, 20480
    s_add_u32 m0, s48, 57344
    s_nop 0
    buffer_load_dwordx4 v5, s[24:27], s3 offen lds
    s_add_u32 s3, s47, 430080
    s_add_u32 m0, s48, 77824
    s_nop 0
    buffer_load_dwordx4 v5, s[24:27], s3 offen lds
    s_branch K_P2_GM
K_NOLT:
    s_waitcnt vmcnt(0)
    s_barrier
    s_mov_b32 s33, 81920
    s_cmp_eq_u32 s43, 3
    s_cselect_b32 s3, 0, 163840
    buffer_store_dwordx4 v[224:227], v220, s[20:23], 0 offen sc1
    buffer_store_dwordx4 v[224:227], v220, s[20:23], s33 offen sc1
    buffer_store_dwordx4 v[224:227], v220, s[20:23], s3 offen sc1
    buffer_store_dwordx4 v[224:227], v221, s[20:23], 0 offen sc1
    v_mov_b32 v2, 158720
    v_mov_b32 v3, 1
    s_waitcnt vmcnt(0)
    s_mov_b64 exec, 1
    ds_add_u32 v2, v3 offset:28
    ds_add_u32 v2, v3 offset:32
    s_mov_b64 exec, -1
    s_branch K_END
K_CONS:
    v_and_b32 v1, 63, v0
    v_and_b32 v8, 15, v1
    v_lshrrev_b32 v9, 4, v1
    v_bfe_u32 v10, v1, 2, 2
    v_and_b32 v11, 3, v1
    s_bfe_u32 s54, s30, 0x10001
    s_and_b32 s55, s30, 1
    v_lshrrev_b32 v2, 1, v8
    v_xor_b32 v2, v2, v9
    v_lshlrev_b32 v2, 4, v2
    v_lshl_add_u32 v2, v8, 7, v2
    s_mul_i32 s3, s54, 12288
    v_add_u32 v39, s3, v2
    v_xor_b32 v40, 64, v39
    v_add_u32 v41, 81920, v39
    v_add_u32 v42, 81920, v40
    v_and_b32 v2, 1, v9
    v_lshl_or_b32 v2, v2, 2, v10
    s_mul_i32 s3, s55, 40
    v_lshl_add_u32 v2, v2, 5, s3
    v_lshl_add_u32 v3, v9, 3, v10
    v_lshlrev_b32 v3, 8, v3
    v_add_u32 v3, 24576, v3
    v_lshl_add_u32 v5, v11, 3, v2
    s_mul_i32 s33, s55, 805306368
    s_sub_u32 s33, 0xf870c020, s33
    v_add_u32 v4, 0, v5
    v_and_b32 v4, 255, v4
    v_add_u32 v43, v4, v3
    v_add_u32 v47, 81920, v43
    v_add_u32 v4, 160, v5
    v_and_b32 v4, 255, v4
    v_add_u32 v44, v4, v3
    v_add_u32 v48, 81920, v44
    v_add_u32 v4, 80, v5
    v_and_b32 v4, 255, v4
    v_add_u32 v45, v4, v3
    v_add_u32 v49, 81920, v45
    v_lshlrev_b32 v4, 3, v11
    v_bfe_u32 v4, s33, v4, 8
    v_add_u32 v4, v4, v2
    v_and_b32 v4, 255, v4
    v_add_u32 v46, v4, v3
    v_add_u32 v50, 81920, v46
    v_and_b32 v1, 63, v0
    v_mov_b32 v7, 0
    s_and_b32 s28, s2, 7
    s_lshr_b32 s29, s2, 3
    s_xor_b32 s30, s30, 4
    s_lshr_b32 s34, s29, 3
    s_lshl_b32 s34, s34, 2
    s_and_b32 s3, s29, 3
    s_add_u32 s34, s34, s3
    s_add_u32 s34, s34, 4
    s_bitcmp1_b32 s29, 2
    s_cselect_b32 s34, -1, s34
    s_cmp_lt_u32 s29, 8
    s_cselect_b32 s34, s29, s34
    s_lshl_b32 s40, s28, 1
    s_cmp_ge_u32 s34, 10
    s_addc_u32 s40, s40, 0
    s_sub_u32 s41, s34, 10
    s_cmp_ge_u32 s34, 10
    s_cselect_b32 s41, s41, s34
    s_mul_i32 s42, s28, 20
    s_add_u32 s42, s42, s34
    s_and_b32 s42, s42, 255
    s_lshl_b32 s42, s42, 9
    s_add_u32 s42, s42, 524288
    v_mov_b32 v3, 158736
    ds_write2_b32 v3, v7, v7 offset0:0 offset1:1
    ds_write2_b32 v3, v7, v7 offset0:2 offset1:3
    ds_write2_b32 v3, v7, v7 offset0:4 offset1:5
    ds_write2_b32 v3, v7, v7 offset0:6 offset1:7
    ds_write2_b32 v3, v7, v7 offset0:8 offset1:9
    ds_write2_b32 v3, v7, v7 offset0:10 offset1:11
    s_lshr_b32 s31, s28, 1
    s_mul_i32 s31, s31, 3
    s_lshr_b32 s3, s29, 3
    s_add_u32 s31, s31, s3
    s_sub_u32 s31, s31, 1
    s_and_b32 s32, s28, 1
    s_lshl_b32 s32, s32, 3
    s_and_b32 s3, s29, 7
    s_lshl_b32 s3, s3, 2
    s_lshr_b32 s3, 0x64317520, s3
    s_and_b32 s3, s3, 7
    s_add_u32 s32, s32, s3
    s_and_b32 s35, s29, 3
    s_and_b32 s3, s29, 4
    s_lshl_b32 s3, s3, 1
    s_add_u32 s35, s35, s3
    s_and_b32 s3, s28, 1
    s_lshl_b32 s3, s3, 2
    s_add_u32 s35, s35, s3
    s_or_b32 s56, s31, s54
    v_mov_b32 v37, 0xf149f2ca
    v_lshlrev_b32 v2, 2, v9
    v_sub_u32 v2, v8, v2
    s_cmp_eq_u32 s56, 0
    s_cselect_b32 s3, 0xf149f2ca, 0
    v_subrev_u32 v3, 0, v2
    v_and_b32 v4, 0x80000001, v3
    v_cmp_eq_u32 vcc, 0, v4
    s_nop 1
    v_cndmask_b32 v16, v37, 0, vcc
    v_cmp_eq_u32 vcc, 0x80000000, v4
    s_nop 1
    v_cndmask_b32 v12, v37, 0, vcc
    v_add_f32 v20, s3, v12
    v_subrev_u32 v3, 1, v2
    v_and_b32 v4, 0x80000001, v3
    v_cmp_eq_u32 vcc, 0, v4
    s_nop 1
    v_cndmask_b32 v17, v37, 0, vcc
    v_cmp_eq_u32 vcc, 0x80000000, v4
    s_nop 1
    v_cndmask_b32 v13, v37, 0, vcc
    v_add_f32 v21, s3, v13
    v_subrev_u32 v3, 2, v2
    v_and_b32 v4, 0x80000001, v3
    v_cmp_eq_u32 vcc, 0, v4
    s_nop 1
    v_cndmask_b32 v18, v37, 0, vcc
    v_cmp_eq_u32 vcc, 0x80000000, v4
    s_nop 1
    v_cndmask_b32 v14, v37, 0, vcc
    v_add_f32 v22, s3, v14
    v_subrev_u32 v3, 3, v2
    v_and_b32 v4, 0x80000001, v3
    v_cmp_eq_u32 vcc, 0, v4
    s_nop 1
    v_cndmask_b32 v19, v37, 0, vcc
    v_cmp_eq_u32 vcc, 0x80000000, v4
    s_nop 1
    v_cndmask_b32 v15, v37, 0, vcc
    v_add_f32 v23, s3, v15
    v_mov_b32 v3, 0x0c0c0c0c
    v_mov_b32 v4, 0xc0c0100
    v_cmp_eq_u32 vcc, 0, v12
    v_mov_b32 v5, 0x1000c0c
    s_nop 0
    v_cndmask_b32 v3, v3, v4, vcc
    v_cmp_eq_u32 vcc, 0, v13
    s_nop 1
    v_cndmask_b32 v24, v3, v5, vcc
    v_mov_b32 v3, 0x0c0c0c0c
    v_mov_b32 v4, 0xc0c0302
    v_cmp_eq_u32 vcc, 0, v14
    v_mov_b32 v5, 0x3020c0c
    s_nop 0
    v_cndmask_b32 v3, v3, v4, vcc
    v_cmp_eq_u32 vcc, 0, v15
    s_nop 1
    v_cndmask_b32 v25, v3, v5, vcc
    v_mov_b32 v3, 0x0c0c0c0c
    v_mov_b32 v4, 0xc0c0100
    v_cmp_eq_u32 vcc, 0, v16
    v_mov_b32 v5, 0x1000c0c
    s_nop 0
    v_cndmask_b32 v3, v3, v4, vcc
    v_cmp_eq_u32 vcc, 0, v17
    s_nop 1
    v_cndmask_b32 v26, v3, v5, vcc
    v_mov_b32 v3, 0x0c0c0c0c
    v_mov_b32 v4, 0xc0c0302
    v_cmp_eq_u32 vcc, 0, v18
    v_mov_b32 v5, 0x3020c0c
    s_nop 0
    v_cndmask_b32 v3, v3, v4, vcc
    v_cmp_eq_u32 vcc, 0, v19
    s_nop 1
    v_cndmask_b32 v27, v3, v5, vcc
    s_mul_i32 s3, s55, 1664
    s_mul_i32 s33, s54, 768
    s_add_u32 s3, s3, s33
    s_add_u32 s3, s3, 125952
    v_lshl_add_u32 v2, v9, 2, v10
    v_lshl_add_u32 v33, v2, 3, s3
    v_lshl_add_u32 v2, v8, 3, s3
    v_lshlrev_b32 v3, 3, v1
    v_add_u32 v3, 129280, v3
    v_cmp_eq_u32 vcc, 2, v9
    s_mul_i32 s3, s55, 1536
    s_add_u32 s3, s3, 122880
    v_cndmask_b32 v32, v3, v2, vcc
    v_lshl_add_u32 v34, v1, 3, s3
    s_mul_i32 s3, s54, 1536
    s_add_u32 s3, s3, 131328
    s_lshl3_add_u32 s33, s55, s3
    v_lshl_add_u32 v35, v8, 4, s33
    v_cmp_eq_u32 vcc, 0, v9
    s_nop 1
    v_cndmask_b32 v35, v3, v35, vcc
    s_mul_i32 s33, s55, 768
    s_add_u32 s3, s3, s33
    v_lshl_add_u32 v36, v1, 4, s3
    v_mov_b32 v38, 158720
    s_waitcnt lgkmcnt(0)
    s_add_u32 s20, s6, 0x100000
    s_addc_u32 s21, s7, 0
    s_mov_b32 s22, 0x280000
    s_mov_b32 s23, 0x20000
    s_lshr_b32 s53, s35, 2
    s_add_u32 s58, s53, s35
    s_lshl_b32 s58, s58, 12
    s_mul_i32 s59, s53, 19456
    s_lshl_b32 s53, s35, 8
    s_add_u32 s59, s59, s53
    s_add_u32 s59, s59, 16384
    s_mul_i32 s53, s31, 11
    s_mul_i32 s3, s54, 6
    s_add_u32 s53, s53, s3
    s_add_u32 s53, s53, 3
    s_lshl_b32 s3, s55, 9
    s_add_u32 s58, s58, s3
    v_and_b32 v4, 1, v9
    v_lshrrev_b32 v5, 1, v9
    v_add_u32 v3, s53, v4
    v_lshrrev_b32 v2, 2, v3
    v_mul_u32_u24 v2, 76, v2
    v_add_lshl_u32 v2, v2, v3, 10
    v_lshl_add_u32 v2, v8, 4, v2
    v_add_u32 v30, s58, v2
    v_lshl_add_u32 v30, v5, 8, v30
    v_subrev_u32 v3, 2, v3
    v_lshrrev_b32 v2, 2, v3
    v_mul_u32_u24 v2, 76, v2
    v_add_lshl_u32 v2, v2, v3, 10
    v_lshl_add_u32 v2, v8, 4, v2
    v_add_u32 v29, s58, v2
    v_lshl_add_u32 v29, v5, 8, v29
    v_or_b32 v4, s54, v4
    v_cmp_eq_u32 vcc, 0, v4
    v_mov_b32 v5, 0x10000000
    v_subrev_u32 v28, 81920, v30
    v_cndmask_b32 v28, v28, v5, vcc
    s_mul_i32 s3, s55, 3
    s_add_u32 s53, s53, s3
    v_add_u32 v3, s53, v9
    v_lshrrev_b32 v2, 2, v3
    v_mul_u32_u24 v2, 76, v2
    v_add_lshl_u32 v2, v2, v3, 10
    v_lshl_add_u32 v2, v8, 4, v2
    v_add_u32 v31, s59, v2
    v_subrev_u32 v31, 81920, v31
    v_or_b32 v4, s30, v9
    v_cmp_eq_u32 vcc, 0, v4
    s_nop 1
    v_cndmask_b32 v31, v31, v5, vcc
    v_cmp_eq_u32 vcc, 3, v9
    s_nop 1
    v_cndmask_b32 v31, v31, v5, vcc
    s_mul_i32 s3, s31, 11
    s_add_u32 s33, s3, 10
    s_lshr_b32 s3, s3, 3
    s_lshr_b32 s33, s33, 3
    s_min_u32 s33, s33, 15
    s_sub_u32 s33, s33, s3
    s_add_u32 s33, s33, 1
    s_mul_i32 s33, s33, 10
    s_bfm_b32 s37, s33, 0
    v_mul_u32_u24 v2, 205, v1
    v_lshrrev_b32 v2, 11, v2
    v_add_u32 v2, s3, v2
    v_mul_u32_u24 v2, 1496, v2
    v_lshrrev_b32 v2, 11, v2
    v_sub_u32 v2, s31, v2
    v_and_b32 v2, 1, v2
    v_lshlrev_b32 v2, 2, v2
    v_lshl_add_u32 v2, v1, 9, v2
    s_mul_i32 s3, s3, 5120
    s_add_u32 s3, s3, 524288
    v_add_u32 v37, s3, v2
    s_lshr_b32 s36, s35, 2
    s_add_u32 s36, s36, s35
    s_lshl_b32 s36, 1, s36
    s_cmp_eq_u32 s30, 0
    s_cselect_b32 s36, s36, 0
    s_mov_b32 s58, 0x3fb8aa3b
    s_mov_b32 s59, s58
    s_mov_b32 s60, 0x3e64f92e
    s_mov_b32 s61, s60
    s_cmp_eq_u32 s30, 0
    s_cbranch_scc1 K_CHM0
    s_cmp_eq_u32 s30, 1
    s_cbranch_scc1 K_CHM1
    s_cmp_eq_u32 s30, 2
    s_cbranch_scc1 K_CHM2
    s_branch K_CHM3
K_WRET_M:
    s_setprio 2
    s_barrier
K_L0:
    ds_read_b64_tr_b16 v[196:197], v47 offset:0
    ds_read_b64_tr_b16 v[198:199], v47 offset:1024
    ds_read_b128 v[148:151], v41 offset:0
    ds_read_b64_tr_b16 v[200:201], v48 offset:0
    ds_read_b64_tr_b16 v[202:203], v48 offset:1024
    ds_read_b128 v[152:155], v41 offset:2048
    ds_read_b64_tr_b16 v[204:205], v49 offset:0
    ds_read_b64_tr_b16 v[206:207], v49 offset:1024
    ds_read_b128 v[156:159], v41 offset:4096
    ds_read_b64_tr_b16 v[208:209], v50 offset:0
    ds_read_b64_tr_b16 v[210:211], v50 offset:1024
    ds_read_b128 v[160:163], v41 offset:6144
    ds_read_b128 v[164:167], v41 offset:8192
    ds_read_b128 v[168:171], v41 offset:10240
    s_waitcnt lgkmcnt(0)
    v_mfma_f32_16x16x32_bf16 v[52:55], v[196:199], v[148:151], 0
    ds_read_b64_tr_b16 v[212:213], v47 offset:8192
    v_mfma_f32_16x16x32_bf16 v[56:59], v[200:203], v[148:151], 0
    ds_read_b64_tr_b16 v[214:215], v47 offset:9216
    v_mfma_f32_16x16x32_bf16 v[60:63], v[148:151], v[204:207], 0
    ds_read_b128 v[172:175], v42 offset:0
    v_mfma_f32_16x16x32_bf16 v[64:67], v[208:211], v[148:151], 0
    ds_read_b64_tr_b16 v[216:217], v48 offset:8192
    v_mfma_f32_16x16x32_bf16 v[80:83], v[208:211], v[152:155], 0
    ds_read_b64_tr_b16 v[218:219], v48 offset:9216
    v_mfma_f32_16x16x32_bf16 v[76:79], v[152:155], v[204:207], 0
    ds_read_b128 v[176:179], v42 offset:2048
    v_mfma_f32_16x16x32_bf16 v[72:75], v[200:203], v[152:155], 0
    ds_read_b64_tr_b16 v[220:221], v49 offset:8192
    v_mfma_f32_16x16x32_bf16 v[68:71], v[196:199], v[152:155], 0
    ds_read_b64_tr_b16 v[222:223], v49 offset:9216
    v_mfma_f32_16x16x32_bf16 v[84:87], v[196:199], v[156:159], 0
    ds_read_b128 v[180:183], v42 offset:4096
    v_mfma_f32_16x16x32_bf16 v[88:91], v[200:203], v[156:159], 0
    ds_read_b64_tr_b16 v[224:225], v50 offset:8192
    v_mfma_f32_16x16x32_bf16 v[92:95], v[156:159], v[204:207], 0
    ds_read_b64_tr_b16 v[226:227], v50 offset:9216
    v_mfma_f32_16x16x32_bf16 v[96:99], v[208:211], v[156:159], 0
    ds_read_b128 v[184:187], v42 offset:6144
    v_mfma_f32_16x16x32_bf16 v[112:115], v[208:211], v[160:163], 0
    ds_read_b128 v[188:191], v42 offset:8192
    v_mfma_f32_16x16x32_bf16 v[108:111], v[160:163], v[204:207], 0
    ds_read_b128 v[192:195], v42 offset:10240
    v_mfma_f32_16x16x32_bf16 v[104:107], v[200:203], v[160:163], 0
    v_mfma_f32_16x16x32_bf16 v[100:103], v[196:199], v[160:163], 0
    v_mfma_f32_16x16x32_bf16 v[116:119], v[196:199], v[164:167], 0
    v_mfma_f32_16x16x32_bf16 v[120:123], v[200:203], v[164:167], 0
    v_mfma_f32_16x16x32_bf16 v[124:127], v[164:167], v[204:207], 0
    v_mfma_f32_16x16x32_bf16 v[128:131], v[208:211], v[164:167], 0
    v_mfma_f32_16x16x32_bf16 v[144:147], v[208:211], v[168:171], 0
    v_mfma_f32_16x16x32_bf16 v[140:143], v[168:171], v[204:207], 0
    v_mfma_f32_16x16x32_bf16 v[136:139], v[200:203], v[168:171], 0
    v_mfma_f32_16x16x32_bf16 v[132:135], v[196:199], v[168:171], 0
    s_waitcnt lgkmcnt(0)
    s_barrier
    v_mfma_f32_16x16x32_bf16 v[52:55], v[212:215], v[172:175], v[52:55]
    ds_read_b64_tr_b16 v[196:197], v43 offset:0
    v_mfma_f32_16x16x32_bf16 v[56:59], v[216:219], v[172:175], v[56:59]
    ds_read_b64_tr_b16 v[198:199], v43 offset:1024
    v_mfma_f32_16x16x32_bf16 v[60:63], v[172:175], v[220:223], v[60:63]
    ds_read_b128 v[148:151], v39 offset:0
    v_mfma_f32_16x16x32_bf16 v[64:67], v[224:227], v[172:175], v[64:67]
    ds_read_b64_tr_b16 v[200:201], v44 offset:0
    v_mfma_f32_16x16x32_bf16 v[80:83], v[224:227], v[176:179], v[80:83]
    ds_read_b64_tr_b16 v[202:203], v44 offset:1024
    v_mfma_f32_16x16x32_bf16 v[76:79], v[176:179], v[220:223], v[76:79]
    ds_read_b128 v[152:155], v39 offset:2048
    v_mfma_f32_16x16x32_bf16 v[72:75], v[216:219], v[176:179], v[72:75]
    ds_read_b64_tr_b16 v[204:205], v45 offset:0
    v_mfma_f32_16x16x32_bf16 v[68:71], v[212:215], v[176:179], v[68:71]
    ds_read_b64_tr_b16 v[206:207], v45 offset:1024
    v_mfma_f32_16x16x32_bf16 v[84:87], v[212:215], v[180:183], v[84:87]
    ds_read_b128 v[156:159], v39 offset:4096
    v_mfma_f32_16x16x32_bf16 v[88:91], v[216:219], v[180:183], v[88:91]
    ds_read_b64_tr_b16 v[208:209], v46 offset:0
    v_mfma_f32_16x16x32_bf16 v[92:95], v[180:183], v[220:223], v[92:95]
    ds_read_b64_tr_b16 v[210:211], v46 offset:1024
    v_mfma_f32_16x16x32_bf16 v[96:99], v[224:227], v[180:183], v[96:99]
    ds_read_b128 v[160:163], v39 offset:6144
    v_mfma_f32_16x16x32_bf16 v[112:115], v[224:227], v[184:187], v[112:115]
    ds_read_b128 v[164:167], v39 offset:8192
    v_mfma_f32_16x16x32_bf16 v[108:111], v[184:187], v[220:223], v[108:111]
    ds_read_b128 v[168:171], v39 offset:10240
    v_mfma_f32_16x16x32_bf16 v[104:107], v[216:219], v[184:187], v[104:107]
    v_mfma_f32_16x16x32_bf16 v[100:103], v[212:215], v[184:187], v[100:103]
    v_mfma_f32_16x16x32_bf16 v[116:119], v[212:215], v[188:191], v[116:119]
    v_mfma_f32_16x16x32_bf16 v[120:123], v[216:219], v[188:191], v[120:123]
    v_mfma_f32_16x16x32_bf16 v[124:127], v[188:191], v[220:223], v[124:127]
    v_mfma_f32_16x16x32_bf16 v[128:131], v[224:227], v[188:191], v[128:131]
    v_mfma_f32_16x16x32_bf16 v[144:147], v[224:227], v[192:195], v[144:147]
    v_mfma_f32_16x16x32_bf16 v[140:143], v[192:195], v[220:223], v[140:143]
    v_mfma_f32_16x16x32_bf16 v[136:139], v[216:219], v[192:195], v[136:139]
    v_mfma_f32_16x16x32_bf16 v[132:135], v[212:215], v[192:195], v[132:135]
    s_waitcnt lgkmcnt(0)
    v_mfma_f32_16x16x32_bf16 v[52:55], v[196:199], v[148:151], v[52:55]
    ds_read_b64_tr_b16 v[212:213], v43 offset:8192
    v_mfma_f32_16x16x32_bf16 v[56:59], v[200:203], v[148:151], v[56:59]
    ds_read_b64_tr_b16 v[214:215], v43 offset:9216
    v_mfma_f32_16x16x32_bf16 v[60:63], v[148:151], v[204:207], v[60:63]
    ds_read_b128 v[172:175], v40 offset:0
    v_mfma_f32_16x16x32_bf16 v[64:67], v[208:211], v[148:151], v[64:67]
    ds_read_b64_tr_b16 v[216:217], v44 offset:8192
    v_mfma_f32_16x16x32_bf16 v[80:83], v[208:211], v[152:155], v[80:83]
    ds_read_b64_tr_b16 v[218:219], v44 offset:9216
    v_mfma_f32_16x16x32_bf16 v[76:79], v[152:155], v[204:207], v[76:79]
    ds_read_b128 v[176:179], v40 offset:2048
    v_mfma_f32_16x16x32_bf16 v[72:75], v[200:203], v[152:155], v[72:75]
    ds_read_b64_tr_b16 v[220:221], v45 offset:8192
    v_mfma_f32_16x16x32_bf16 v[68:71], v[196:199], v[152:155], v[68:71]
    ds_read_b64_tr_b16 v[222:223], v45 offset:9216
    v_mfma_f32_16x16x32_bf16 v[84:87], v[196:199], v[156:159], v[84:87]
    ds_read_b128 v[180:183], v40 offset:4096
    v_mfma_f32_16x16x32_bf16 v[88:91], v[200:203], v[156:159], v[88:91]
    ds_read_b64_tr_b16 v[224:225], v46 offset:8192
    v_mfma_f32_16x16x32_bf16 v[92:95], v[156:159], v[204:207], v[92:95]
    ds_read_b64_tr_b16 v[226:227], v46 offset:9216
    v_mfma_f32_16x16x32_bf16 v[96:99], v[208:211], v[156:159], v[96:99]
    ds_read_b128 v[184:187], v40 offset:6144
    v_mfma_f32_16x16x32_bf16 v[112:115], v[208:211], v[160:163], v[112:115]
    ds_read_b128 v[188:191], v40 offset:8192
    v_mfma_f32_16x16x32_bf16 v[108:111], v[160:163], v[204:207], v[108:111]
    ds_read_b128 v[192:195], v40 offset:10240
    s_branch K_PG1
.p2align 12
K_CHM1:
K_STM1:
    s_branch K_WRET_M
    s_nop 0
K_PG1:
    v_mfma_f32_16x16x32_bf16 v[104:107], v[200:203], v[160:163], v[104:107]
    v_mfma_f32_16x16x32_bf16 v[100:103], v[196:199], v[160:163], v[100:103]
    v_mfma_f32_16x16x32_bf16 v[116:119], v[196:199], v[164:167], v[116:119]
    v_mfma_f32_16x16x32_bf16 v[120:123], v[200:203], v[164:167], v[120:123]
    v_mfma_f32_16x16x32_bf16 v[124:127], v[164:167], v[204:207], v[124:127]
    v_mfma_f32_16x16x32_bf16 v[128:131], v[208:211], v[164:167], v[128:131]
    v_mfma_f32_16x16x32_bf16 v[144:147], v[208:211], v[168:171], v[144:147]
    v_mfma_f32_16x16x32_bf16 v[140:143], v[168:171], v[204:207], v[140:143]
    v_mfma_f32_16x16x32_bf16 v[136:139], v[200:203], v[168:171], v[136:139]
    v_mfma_f32_16x16x32_bf16 v[132:135], v[196:199], v[168:171], v[132:135]
    s_waitcnt lgkmcnt(0)
    s_barrier
    v_mfma_f32_16x16x32_bf16 v[52:55], v[212:215], v[172:175], v[52:55]
    ds_read_b64_tr_b16 v[196:197], v43 offset:40960
    v_mfma_f32_16x16x32_bf16 v[56:59], v[216:219], v[172:175], v[56:59]
    ds_read_b64_tr_b16 v[198:199], v43 offset:41984
    v_mfma_f32_16x16x32_bf16 v[60:63], v[172:175], v[220:223], v[60:63]
    ds_read_b128 v[148:151], v39 offset:40960
    v_mfma_f32_16x16x32_bf16 v[64:67], v[224:227], v[172:175], v[64:67]
    ds_read_b64_tr_b16 v[200:201], v44 offset:40960
    v_mfma_f32_16x16x32_bf16 v[80:83], v[224:227], v[176:179], v[80:83]
    ds_read_b64_tr_b16 v[202:203], v44 offset:41984
    v_mfma_f32_16x16x32_bf16 v[76:79], v[176:179], v[220:223], v[76:79]
    ds_read_b128 v[152:155], v39 offset:43008
    v_mfma_f32_16x16x32_bf16 v[72:75], v[216:219], v[176:179], v[72:75]
    ds_read_b64_tr_b16 v[204:205], v45 offset:40960
    v_mfma_f32_16x16x32_bf16 v[68:71], v[212:215], v[176:179], v[68:71]
    ds_read_b64_tr_b16 v[206:207], v45 offset:41984
    v_mfma_f32_16x16x32_bf16 v[84:87], v[212:215], v[180:183], v[84:87]
    ds_read_b128 v[156:159], v39 offset:45056
    v_mfma_f32_16x16x32_bf16 v[88:91], v[216:219], v[180:183], v[88:91]
    ds_read_b64_tr_b16 v[208:209], v46 offset:40960
    v_mfma_f32_16x16x32_bf16 v[92:95], v[180:183], v[220:223], v[92:95]
    ds_read_b64_tr_b16 v[210:211], v46 offset:41984
    v_mfma_f32_16x16x32_bf16 v[96:99], v[224:227], v[180:183], v[96:99]
    ds_read_b128 v[160:163], v39 offset:47104
    v_mfma_f32_16x16x32_bf16 v[112:115], v[224:227], v[184:187], v[112:115]
    ds_read_b128 v[164:167], v39 offset:49152
    v_mfma_f32_16x16x32_bf16 v[108:111], v[184:187], v[220:223], v[108:111]
    ds_read_b128 v[168:171], v39 offset:51200
    v_mfma_f32_16x16x32_bf16 v[104:107], v[216:219], v[184:187], v[104:107]
    v_mfma_f32_16x16x32_bf16 v[100:103], v[212:215], v[184:187], v[100:103]
    v_mfma_f32_16x16x32_bf16 v[116:119], v[212:215], v[188:191], v[116:119]
    v_mfma_f32_16x16x32_bf16 v[120:123], v[216:219], v[188:191], v[120:123]
    v_mfma_f32_16x16x32_bf16 v[124:127], v[188:191], v[220:223], v[124:127]
    v_mfma_f32_16x16x32_bf16 v[128:131], v[224:227], v[188:191], v[128:131]
    v_mfma_f32_16x16x32_bf16 v[144:147], v[224:227], v[192:195], v[144:147]
    v_mfma_f32_16x16x32_bf16 v[140:143], v[192:195], v[220:223], v[140:143]
    v_mfma_f32_16x16x32_bf16 v[136:139], v[216:219], v[192:195], v[136:139]
    v_mfma_f32_16x16x32_bf16 v[132:135], v[212:215], v[192:195], v[132:135]
    s_waitcnt lgkmcnt(0)
    v_mfma_f32_16x16x32_bf16 v[52:55], v[196:199], v[148:151], v[52:55]
    ds_read_b64_tr_b16 v[212:213], v43 offset:49152
    v_mfma_f32_16x16x32_bf16 v[56:59], v[200:203], v[148:151], v[56:59]
    ds_read_b64_tr_b16 v[214:215], v43 offset:50176
    v_mfma_f32_16x16x32_bf16 v[60:63], v[148:151], v[204:207], v[60:63]
    ds_read_b128 v[172:175], v40 offset:40960
    v_mfma_f32_16x16x32_bf16 v[64:67], v[208:211], v[148:151], v[64:67]
    ds_read_b64_tr_b16 v[216:217], v44 offset:49152
    v_mfma_f32_16x16x32_bf16 v[80:83], v[208:211], v[152:155], v[80:83]
    ds_read_b64_tr_b16 v[218:219], v44 offset:50176
    v_mfma_f32_16x16x32_bf16 v[76:79], v[152:155], v[204:207], v[76:79]
    ds_read_b128 v[176:179], v40 offset:43008
    v_mfma_f32_16x16x32_bf16 v[72:75], v[200:203], v[152:155], v[72:75]
    ds_read_b64_tr_b16 v[220:221], v45 offset:49152
    v_mfma_f32_16x16x32_bf16 v[68:71], v[196:199], v[152:155], v[68:71]
    ds_read_b64_tr_b16 v[222:223], v45 offset:50176
    v_mfma_f32_16x16x32_bf16 v[84:87], v[196:199], v[156:159], v[84:87]
    ds_read_b128 v[180:183], v40 offset:45056
    v_mfma_f32_16x16x32_bf16 v[88:91], v[200:203], v[156:159], v[88:91]
    ds_read_b64_tr_b16 v[224:225], v46 offset:49152
    v_mfma_f32_16x16x32_bf16 v[92:95], v[156:159], v[204:207], v[92:95]
    ds_read_b64_tr_b16 v[226:227], v46 offset:50176
    v_mfma_f32_16x16x32_bf16 v[96:99], v[208:211], v[156:159], v[96:99]
    ds_read_b128 v[184:187], v40 offset:47104
    v_mfma_f32_16x16x32_bf16 v[112:115], v[208:211], v[160:163], v[112:115]
    ds_read_b128 v[188:191], v40 offset:49152
    v_mfma_f32_16x16x32_bf16 v[108:111], v[160:163], v[204:207], v[108:111]
    ds_read_b128 v[192:195], v40 offset:51200
    v_mfma_f32_16x16x32_bf16 v[104:107], v[200:203], v[160:163], v[104:107]
    v_mfma_f32_16x16x32_bf16 v[100:103], v[196:199], v[160:163], v[100:103]
    v_mfma_f32_16x16x32_bf16 v[116:119], v[196:199], v[164:167], v[116:119]
    v_mfma_f32_16x16x32_bf16 v[120:123], v[200:203], v[164:167], v[120:123]
    v_mfma_f32_16x16x32_bf16 v[124:127], v[164:167], v[204:207], v[124:127]
    v_mfma_f32_16x16x32_bf16 v[128:131], v[208:211], v[164:167], v[128:131]
    v_mfma_f32_16x16x32_bf16 v[144:147], v[208:211], v[168:171], v[144:147]
    v_mfma_f32_16x16x32_bf16 v[140:143], v[168:171], v[204:207], v[140:143]
    v_mfma_f32_16x16x32_bf16 v[136:139], v[200:203], v[168:171], v[136:139]
    v_mfma_f32_16x16x32_bf16 v[132:135], v[196:199], v[168:171], v[132:135]
    s_waitcnt lgkmcnt(0)
    s_barrier
    v_mfma_f32_16x16x32_bf16 v[52:55], v[212:215], v[172:175], v[52:55]
    ds_read_b64_tr_b16 v[196:197], v47 offset:0
    v_mfma_f32_16x16x32_bf16 v[56:59], v[216:219], v[172:175], v[56:59]
    ds_read_b64_tr_b16 v[198:199], v47 offset:1024
    v_mfma_f32_16x16x32_bf16 v[60:63], v[172:175], v[220:223], v[60:63]
    ds_read_b128 v[148:151], v41 offset:0
    v_mfma_f32_16x16x32_bf16 v[64:67], v[224:227], v[172:175], v[64:67]
    ds_read_b64_tr_b16 v[200:201], v48 offset:0
    v_mfma_f32_16x16x32_bf16 v[80:83], v[224:227], v[176:179], v[80:83]
    ds_read_b64_tr_b16 v[202:203], v48 offset:1024
    v_mfma_f32_16x16x32_bf16 v[76:79], v[176:179], v[220:223], v[76:79]
    ds_read_b128 v[152:155], v41 offset:2048
    v_mfma_f32_16x16x32_bf16 v[72:75], v[216:219], v[176:179], v[72:75]
    ds_read_b64_tr_b16 v[204:205], v49 offset:0
    v_mfma_f32_16x16x32_bf16 v[68:71], v[212:215], v[176:179], v[68:71]
    ds_read_b64_tr_b16 v[206:207], v49 offset:1024
    v_mfma_f32_16x16x32_bf16 v[84:87], v[212:215], v[180:183], v[84:87]
    ds_read_b128 v[156:159], v41 offset:4096
    v_mfma_f32_16x16x32_bf16 v[88:91], v[216:219], v[180:183], v[88:91]
    ds_read_b64_tr_b16 v[208:209], v50 offset:0
    v_mfma_f32_16x16x32_bf16 v[92:95], v[180:183], v[220:223], v[92:95]
    ds_read_b64_tr_b16 v[210:211], v50 offset:1024
    v_mfma_f32_16x16x32_bf16 v[96:99], v[224:227], v[180:183], v[96:99]
    ds_read_b128 v[160:163], v41 offset:6144
    v_mfma_f32_16x16x32_bf16 v[112:115], v[224:227], v[184:187], v[112:115]
    ds_read_b128 v[164:167], v41 offset:8192
    v_mfma_f32_16x16x32_bf16 v[108:111], v[184:187], v[220:223], v[108:111]
    ds_read_b128 v[168:171], v41 offset:10240
    v_mfma_f32_16x16x32_bf16 v[104:107], v[216:219], v[184:187], v[104:107]
    v_mfma_f32_16x16x32_bf16 v[100:103], v[212:215], v[184:187], v[100:103]
    v_mfma_f32_16x16x32_bf16 v[116:119], v[212:215], v[188:191], v[116:119]
    v_mfma_f32_16x16x32_bf16 v[120:123], v[216:219], v[188:191], v[120:123]
    v_mfma_f32_16x16x32_bf16 v[124:127], v[188:191], v[220:223], v[124:127]
    v_mfma_f32_16x16x32_bf16 v[128:131], v[224:227], v[188:191], v[128:131]
    v_mfma_f32_16x16x32_bf16 v[144:147], v[224:227], v[192:195], v[144:147]
    v_mfma_f32_16x16x32_bf16 v[140:143], v[192:195], v[220:223], v[140:143]
    v_mfma_f32_16x16x32_bf16 v[136:139], v[216:219], v[192:195], v[136:139]
    v_mfma_f32_16x16x32_bf16 v[132:135], v[212:215], v[192:195], v[132:135]
    s_waitcnt lgkmcnt(0)
    v_mfma_f32_16x16x32_bf16 v[52:55], v[196:199], v[148:151], v[52:55]
    ds_read_b64_tr_b16 v[212:213], v47 offset:8192
    v_mfma_f32_16x16x32_bf16 v[56:59], v[200:203], v[148:151], v[56:59]
    ds_read_b64_tr_b16 v[214:215], v47 offset:9216
    v_mfma_f32_16x16x32_bf16 v[60:63], v[148:151], v[204:207], v[60:63]
    ds_read_b128 v[172:175], v42 offset:0
    v_mfma_f32_16x16x32_bf16 v[64:67], v[208:211], v[148:151], v[64:67]
    ds_read_b64_tr_b16 v[216:217], v48 offset:8192
    v_mfma_f32_16x16x32_bf16 v[80:83], v[208:211], v[152:155], v[80:83]
    ds_read_b64_tr_b16 v[218:219], v48 offset:9216
    v_mfma_f32_16x16x32_bf16 v[76:79], v[152:155], v[204:207], v[76:79]
    ds_read_b128 v[176:179], v42 offset:2048
    v_mfma_f32_16x16x32_bf16 v[72:75], v[200:203], v[152:155], v[72:75]
    ds_read_b64_tr_b16 v[220:221], v49 offset:8192
    v_mfma_f32_16x16x32_bf16 v[68:71], v[196:199], v[152:155], v[68:71]
    ds_read_b64_tr_b16 v[222:223], v49 offset:9216
    v_mfma_f32_16x16x32_bf16 v[84:87], v[196:199], v[156:159], v[84:87]
    ds_read_b128 v[180:183], v42 offset:4096
    v_mfma_f32_16x16x32_bf16 v[88:91], v[200:203], v[156:159], v[88:91]
    ds_read_b64_tr_b16 v[224:225], v50 offset:8192
    v_mfma_f32_16x16x32_bf16 v[92:95], v[156:159], v[204:207], v[92:95]
    ds_read_b64_tr_b16 v[226:227], v50 offset:9216
    v_mfma_f32_16x16x32_bf16 v[96:99], v[208:211], v[156:159], v[96:99]
    ds_read_b128 v[184:187], v42 offset:6144
    v_mfma_f32_16x16x32_bf16 v[112:115], v[208:211], v[160:163], v[112:115]
    ds_read_b128 v[188:191], v42 offset:8192
    v_mfma_f32_16x16x32_bf16 v[108:111], v[160:163], v[204:207], v[108:111]
    ds_read_b128 v[192:195], v42 offset:10240
    v_mfma_f32_16x16x32_bf16 v[104:107], v[200:203], v[160:163], v[104:107]
    v_mfma_f32_16x16x32_bf16 v[100:103], v[196:199], v[160:163], v[100:103]
    v_mfma_f32_16x16x32_bf16 v[116:119], v[196:199], v[164:167], v[116:119]
    v_mfma_f32_16x16x32_bf16 v[120:123], v[200:203], v[164:167], v[120:123]
    v_mfma_f32_16x16x32_bf16 v[124:127], v[164:167], v[204:207], v[124:127]
    v_mfma_f32_16x16x32_bf16 v[128:131], v[208:211], v[164:167], v[128:131]
    v_mfma_f32_16x16x32_bf16 v[144:147], v[208:211], v[168:171], v[144:147]
    v_mfma_f32_16x16x32_bf16 v[140:143], v[168:171], v[204:207], v[140:143]
    v_mfma_f32_16x16x32_bf16 v[136:139], v[200:203], v[168:171], v[136:139]
    v_mfma_f32_16x16x32_bf16 v[132:135], v[196:199], v[168:171], v[132:135]
    s_waitcnt lgkmcnt(0)
    s_barrier
    v_mfma_f32_16x16x32_bf16 v[52:55], v[212:215], v[172:175], v[52:55]
    ds_read_b64_tr_b16 v[196:197], v43 offset:0
    v_mfma_f32_16x16x32_bf16 v[56:59], v[216:219], v[172:175], v[56:59]
    ds_read_b64_tr_b16 v[198:199], v43 offset:1024
    v_mfma_f32_16x16x32_bf16 v[60:63], v[172:175], v[220:223], v[60:63]
    ds_read_b128 v[148:151], v39 offset:0
    v_mfma_f32_16x16x32_bf16 v[64:67], v[224:227], v[172:175], v[64:67]
    ds_read_b64_tr_b16 v[200:201], v44 offset:0
    v_mfma_f32_16x16x32_bf16 v[80:83], v[224:227], v[176:179], v[80:83]
    ds_read_b64_tr_b16 v[202:203], v44 offset:1024
    v_mfma_f32_16x16x32_bf16 v[76:79], v[176:179], v[220:223], v[76:79]
    ds_read_b128 v[152:155], v39 offset:2048
    v_mfma_f32_16x16x32_bf16 v[72:75], v[216:219], v[176:179], v[72:75]
    ds_read_b64_tr_b16 v[204:205], v45 offset:0
    v_mfma_f32_16x16x32_bf16 v[68:71], v[212:215], v[176:179], v[68:71]
    ds_read_b64_tr_b16 v[206:207], v45 offset:1024
    v_mfma_f32_16x16x32_bf16 v[84:87], v[212:215], v[180:183], v[84:87]
    ds_read_b128 v[156:159], v39 offset:4096
    v_mfma_f32_16x16x32_bf16 v[88:91], v[216:219], v[180:183], v[88:91]
    ds_read_b64_tr_b16 v[208:209], v46 offset:0
    v_mfma_f32_16x16x32_bf16 v[92:95], v[180:183], v[220:223], v[92:95]
    ds_read_b64_tr_b16 v[210:211], v46 offset:1024
    v_mfma_f32_16x16x32_bf16 v[96:99], v[224:227], v[180:183], v[96:99]
    ds_read_b128 v[160:163], v39 offset:6144
    v_mfma_f32_16x16x32_bf16 v[112:115], v[224:227], v[184:187], v[112:115]
    ds_read_b128 v[164:167], v39 offset:8192
    v_mfma_f32_16x16x32_bf16 v[108:111], v[184:187], v[220:223], v[108:111]
    ds_read_b128 v[168:171], v39 offset:10240
    v_mfma_f32_16x16x32_bf16 v[104:107], v[216:219], v[184:187], v[104:107]
    v_mfma_f32_16x16x32_bf16 v[100:103], v[212:215], v[184:187], v[100:103]
    v_mfma_f32_16x16x32_bf16 v[116:119], v[212:215], v[188:191], v[116:119]
    v_mfma_f32_16x16x32_bf16 v[120:123], v[216:219], v[188:191], v[120:123]
    v_mfma_f32_16x16x32_bf16 v[124:127], v[188:191], v[220:223], v[124:127]
    v_mfma_f32_16x16x32_bf16 v[128:131], v[224:227], v[188:191], v[128:131]
    v_mfma_f32_16x16x32_bf16 v[144:147], v[224:227], v[192:195], v[144:147]
    v_mfma_f32_16x16x32_bf16 v[140:143], v[192:195], v[220:223], v[140:143]
    v_mfma_f32_16x16x32_bf16 v[136:139], v[216:219], v[192:195], v[136:139]
    v_mfma_f32_16x16x32_bf16 v[132:135], v[212:215], v[192:195], v[132:135]
    s_waitcnt lgkmcnt(0)
    v_mfma_f32_16x16x32_bf16 v[52:55], v[196:199], v[148:151], v[52:55]
    ds_read_b64_tr_b16 v[212:213], v43 offset:8192
    v_mfma_f32_16x16x32_bf16 v[56:59], v[200:203], v[148:151], v[56:59]
    ds_read_b64_tr_b16 v[214:215], v43 offset:9216
    v_mfma_f32_16x16x32_bf16 v[60:63], v[148:151], v[204:207], v[60:63]
    ds_read_b128 v[172:175], v40 offset:0
    v_mfma_f32_16x16x32_bf16 v[64:67], v[208:211], v[148:151], v[64:67]
    ds_read_b64_tr_b16 v[216:217], v44 offset:8192
    v_mfma_f32_16x16x32_bf16 v[80:83], v[208:211], v[152:155], v[80:83]
    ds_read_b64_tr_b16 v[218:219], v44 offset:9216
    v_mfma_f32_16x16x32_bf16 v[76:79], v[152:155], v[204:207], v[76:79]
    ds_read_b128 v[176:179], v40 offset:2048
    v_mfma_f32_16x16x32_bf16 v[72:75], v[200:203], v[152:155], v[72:75]
    ds_read_b64_tr_b16 v[220:221], v45 offset:8192
    v_mfma_f32_16x16x32_bf16 v[68:71], v[196:199], v[152:155], v[68:71]
    ds_read_b64_tr_b16 v[222:223], v45 offset:9216
    v_mfma_f32_16x16x32_bf16 v[84:87], v[196:199], v[156:159], v[84:87]
    ds_read_b128 v[180:183], v40 offset:4096
    v_mfma_f32_16x16x32_bf16 v[88:91], v[200:203], v[156:159], v[88:91]
    ds_read_b64_tr_b16 v[224:225], v46 offset:8192
    v_mfma_f32_16x16x32_bf16 v[92:95], v[156:159], v[204:207], v[92:95]
    ds_read_b64_tr_b16 v[226:227], v46 offset:9216
    v_mfma_f32_16x16x32_bf16 v[96:99], v[208:211], v[156:159], v[96:99]
    ds_read_b128 v[184:187], v40 offset:6144
    v_mfma_f32_16x16x32_bf16 v[112:115], v[208:211], v[160:163], v[112:115]
    ds_read_b128 v[188:191], v40 offset:8192
    v_mfma_f32_16x16x32_bf16 v[108:111], v[160:163], v[204:207], v[108:111]
    ds_read_b128 v[192:195], v40 offset:10240
    v_mfma_f32_16x16x32_bf16 v[104:107], v[200:203], v[160:163], v[104:107]
    v_mfma_f32_16x16x32_bf16 v[100:103], v[196:199], v[160:163], v[100:103]
    v_mfma_f32_16x16x32_bf16 v[116:119], v[196:199], v[164:167], v[116:119]
    v_mfma_f32_16x16x32_bf16 v[120:123], v[200:203], v[164:167], v[120:123]
    v_mfma_f32_16x16x32_bf16 v[124:127], v[164:167], v[204:207], v[124:127]
    v_mfma_f32_16x16x32_bf16 v[128:131], v[208:211], v[164:167], v[128:131]
    v_mfma_f32_16x16x32_bf16 v[144:147], v[208:211], v[168:171], v[144:147]
    v_mfma_f32_16x16x32_bf16 v[140:143], v[168:171], v[204:207], v[140:143]
    v_mfma_f32_16x16x32_bf16 v[136:139], v[200:203], v[168:171], v[136:139]
    v_mfma_f32_16x16x32_bf16 v[132:135], v[196:199], v[168:171], v[132:135]
    s_waitcnt lgkmcnt(0)
    s_barrier
    v_mfma_f32_16x16x32_bf16 v[52:55], v[212:215], v[172:175], v[52:55]
    ds_read_b64_tr_b16 v[196:197], v43 offset:40960
    v_mfma_f32_16x16x32_bf16 v[56:59], v[216:219], v[172:175], v[56:59]
    ds_read_b64_tr_b16 v[198:199], v43 offset:41984
    v_mfma_f32_16x16x32_bf16 v[60:63], v[172:175], v[220:223], v[60:63]
    ds_read_b128 v[148:151], v39 offset:40960
    v_mfma_f32_16x16x32_bf16 v[64:67], v[224:227], v[172:175], v[64:67]
    ds_read_b64_tr_b16 v[200:201], v44 offset:40960
    v_mfma_f32_16x16x32_bf16 v[80:83], v[224:227], v[176:179], v[80:83]
    ds_read_b64_tr_b16 v[202:203], v44 offset:41984
    v_mfma_f32_16x16x32_bf16 v[76:79], v[176:179], v[220:223], v[76:79]
    ds_read_b128 v[152:155], v39 offset:43008
    v_mfma_f32_16x16x32_bf16 v[72:75], v[216:219], v[176:179], v[72:75]
    ds_read_b64_tr_b16 v[204:205], v45 offset:40960
    v_mfma_f32_16x16x32_bf16 v[68:71], v[212:215], v[176:179], v[68:71]
    ds_read_b64_tr_b16 v[206:207], v45 offset:41984
    v_mfma_f32_16x16x32_bf16 v[84:87], v[212:215], v[180:183], v[84:87]
    ds_read_b128 v[156:159], v39 offset:45056
    v_mfma_f32_16x16x32_bf16 v[88:91], v[216:219], v[180:183], v[88:91]
    ds_read_b64_tr_b16 v[208:209], v46 offset:40960
    v_mfma_f32_16x16x32_bf16 v[92:95], v[180:183], v[220:223], v[92:95]
    ds_read_b64_tr_b16 v[210:211], v46 offset:41984
    v_mfma_f32_16x16x32_bf16 v[96:99], v[224:227], v[180:183], v[96:99]
    ds_read_b128 v[160:163], v39 offset:47104
    v_mfma_f32_16x16x32_bf16 v[112:115], v[224:227], v[184:187], v[112:115]
    ds_read_b128 v[164:167], v39 offset:49152
    v_mfma_f32_16x16x32_bf16 v[108:111], v[184:187], v[220:223], v[108:111]
    ds_read_b128 v[168:171], v39 offset:51200
    v_mfma_f32_16x16x32_bf16 v[104:107], v[216:219], v[184:187], v[104:107]
    v_mfma_f32_16x16x32_bf16 v[100:103], v[212:215], v[184:187], v[100:103]
    v_mfma_f32_16x16x32_bf16 v[116:119], v[212:215], v[188:191], v[116:119]
    v_mfma_f32_16x16x32_bf16 v[120:123], v[216:219], v[188:191], v[120:123]
    v_mfma_f32_16x16x32_bf16 v[124:127], v[188:191], v[220:223], v[124:127]
    v_mfma_f32_16x16x32_bf16 v[128:131], v[224:227], v[188:191], v[128:131]
    v_mfma_f32_16x16x32_bf16 v[144:147], v[224:227], v[192:195], v[144:147]
    v_mfma_f32_16x16x32_bf16 v[140:143], v[192:195], v[220:223], v[140:143]
    v_mfma_f32_16x16x32_bf16 v[136:139], v[216:219], v[192:195], v[136:139]
    v_mfma_f32_16x16x32_bf16 v[132:135], v[212:215], v[192:195], v[132:135]
    s_waitcnt lgkmcnt(0)
    v_mfma_f32_16x16x32_bf16 v[52:55], v[196:199], v[148:151], v[52:55]
    ds_read_b64_tr_b16 v[212:213], v43 offset:49152
    v_mfma_f32_16x16x32_bf16 v[56:59], v[200:203], v[148:151], v[56:59]
    ds_read_b64_tr_b16 v[214:215], v43 offset:50176
    v_mfma_f32_16x16x32_bf16 v[60:63], v[148:151], v[204:207], v[60:63]
    ds_read_b128 v[172:175], v40 offset:40960
    v_mfma_f32_16x16x32_bf16 v[64:67], v[208:211], v[148:151], v[64:67]
    ds_read_b64_tr_b16 v[216:217], v44 offset:49152
    v_mfma_f32_16x16x32_bf16 v[80:83], v[208:211], v[152:155], v[80:83]
    ds_read_b64_tr_b16 v[218:219], v44 offset:50176
    v_mfma_f32_16x16x32_bf16 v[76:79], v[152:155], v[204:207], v[76:79]
    ds_read_b128 v[176:179], v40 offset:43008
    v_mfma_f32_16x16x32_bf16 v[72:75], v[200:203], v[152:155], v[72:75]
    ds_read_b64_tr_b16 v[220:221], v45 offset:49152
    v_mfma_f32_16x16x32_bf16 v[68:71], v[196:199], v[152:155], v[68:71]
    ds_read_b64_tr_b16 v[222:223], v45 offset:50176
    v_mfma_f32_16x16x32_bf16 v[84:87], v[196:199], v[156:159], v[84:87]
    ds_read_b128 v[180:183], v40 offset:45056
    v_mfma_f32_16x16x32_bf16 v[88:91], v[200:203], v[156:159], v[88:91]
    ds_read_b64_tr_b16 v[224:225], v46 offset:49152
    v_mfma_f32_16x16x32_bf16 v[92:95], v[156:159], v[204:207], v[92:95]
    ds_read_b64_tr_b16 v[226:227], v46 offset:50176
    v_mfma_f32_16x16x32_bf16 v[96:99], v[208:211], v[156:159], v[96:99]
    ds_read_b128 v[184:187], v40 offset:47104
    v_mfma_f32_16x16x32_bf16 v[112:115], v[208:211], v[160:163], v[112:115]
    ds_read_b128 v[188:191], v40 offset:49152
    v_mfma_f32_16x16x32_bf16 v[108:111], v[160:163], v[204:207], v[108:111]
    ds_read_b128 v[192:195], v40 offset:51200
    v_mfma_f32_16x16x32_bf16 v[104:107], v[200:203], v[160:163], v[104:107]
    v_mfma_f32_16x16x32_bf16 v[100:103], v[196:199], v[160:163], v[100:103]
    v_mfma_f32_16x16x32_bf16 v[116:119], v[196:199], v[164:167], v[116:119]
    v_mfma_f32_16x16x32_bf16 v[120:123], v[200:203], v[164:167], v[120:123]
    v_mfma_f32_16x16x32_bf16 v[124:127], v[164:167], v[204:207], v[124:127]
    v_mfma_f32_16x16x32_bf16 v[128:131], v[208:211], v[164:167], v[128:131]
    v_mfma_f32_16x16x32_bf16 v[144:147], v[208:211], v[168:171], v[144:147]
    v_mfma_f32_16x16x32_bf16 v[140:143], v[168:171], v[204:207], v[140:143]
    v_mfma_f32_16x16x32_bf16 v[136:139], v[200:203], v[168:171], v[136:139]
    v_mfma_f32_16x16x32_bf16 v[132:135], v[196:199], v[168:171], v[132:135]
    s_waitcnt lgkmcnt(0)
    s_barrier
    v_mfma_f32_16x16x32_bf16 v[52:55], v[212:215], v[172:175], v[52:55]
    ds_read_b64_tr_b16 v[196:197], v47 offset:0
    v_mfma_f32_16x16x32_bf16 v[56:59], v[216:219], v[172:175], v[56:59]
    ds_read_b64_tr_b16 v[198:199], v47 offset:1024
    v_mfma_f32_16x16x32_bf16 v[60:63], v[172:175], v[220:223], v[60:63]
    ds_read_b128 v[148:151], v41 offset:0
    v_mfma_f32_16x16x32_bf16 v[64:67], v[224:227], v[172:175], v[64:67]
    ds_read_b64_tr_b16 v[200:201], v48 offset:0
    v_mfma_f32_16x16x32_bf16 v[80:83], v[224:227], v[176:179], v[80:83]
    ds_read_b64_tr_b16 v[202:203], v48 offset:1024
    v_mfma_f32_16x16x32_bf16 v[76:79], v[176:179], v[220:223], v[76:79]
    ds_read_b128 v[152:155], v41 offset:2048
    v_mfma_f32_16x16x32_bf16 v[72:75], v[216:219], v[176:179], v[72:75]
    ds_read_b64_tr_b16 v[204:205], v49 offset:0
    v_mfma_f32_16x16x32_bf16 v[68:71], v[212:215], v[176:179], v[68:71]
    ds_read_b64_tr_b16 v[206:207], v49 offset:1024
    v_mfma_f32_16x16x32_bf16 v[84:87], v[212:215], v[180:183], v[84:87]
    ds_read_b128 v[156:159], v41 offset:4096
    v_mfma_f32_16x16x32_bf16 v[88:91], v[216:219], v[180:183], v[88:91]
    ds_read_b64_tr_b16 v[208:209], v50 offset:0
    v_mfma_f32_16x16x32_bf16 v[92:95], v[180:183], v[220:223], v[92:95]
    ds_read_b64_tr_b16 v[210:211], v50 offset:1024
    v_mfma_f32_16x16x32_bf16 v[96:99], v[224:227], v[180:183], v[96:99]
    ds_read_b128 v[160:163], v41 offset:6144
    v_mfma_f32_16x16x32_bf16 v[112:115], v[224:227], v[184:187], v[112:115]
    ds_read_b128 v[164:167], v41 offset:8192
    v_mfma_f32_16x16x32_bf16 v[108:111], v[184:187], v[220:223], v[108:111]
    ds_read_b128 v[168:171], v41 offset:10240
    v_mfma_f32_16x16x32_bf16 v[104:107], v[216:219], v[184:187], v[104:107]
    v_mfma_f32_16x16x32_bf16 v[100:103], v[212:215], v[184:187], v[100:103]
    v_mfma_f32_16x16x32_bf16 v[116:119], v[212:215], v[188:191], v[116:119]
    v_mfma_f32_16x16x32_bf16 v[120:123], v[216:219], v[188:191], v[120:123]
    v_mfma_f32_16x16x32_bf16 v[124:127], v[188:191], v[220:223], v[124:127]
    v_mfma_f32_16x16x32_bf16 v[128:131], v[224:227], v[188:191], v[128:131]
    v_mfma_f32_16x16x32_bf16 v[144:147], v[224:227], v[192:195], v[144:147]
    v_mfma_f32_16x16x32_bf16 v[140:143], v[192:195], v[220:223], v[140:143]
    v_mfma_f32_16x16x32_bf16 v[136:139], v[216:219], v[192:195], v[136:139]
    v_mfma_f32_16x16x32_bf16 v[132:135], v[212:215], v[192:195], v[132:135]
    s_waitcnt lgkmcnt(0)
    v_mfma_f32_16x16x32_bf16 v[52:55], v[196:199], v[148:151], v[52:55]
    ds_read_b64_tr_b16 v[212:213], v47 offset:8192
    v_mfma_f32_16x16x32_bf16 v[56:59], v[200:203], v[148:151], v[56:59]
    ds_read_b64_tr_b16 v[214:215], v47 offset:9216
    v_mfma_f32_16x16x32_bf16 v[60:63], v[148:151], v[204:207], v[60:63]
    ds_read_b128 v[172:175], v42 offset:0
    v_mfma_f32_16x16x32_bf16 v[64:67], v[208:211], v[148:151], v[64:67]
    ds_read_b64_tr_b16 v[216:217], v48 offset:8192
    v_mfma_f32_16x16x32_bf16 v[80:83], v[208:211], v[152:155], v[80:83]
    ds_read_b64_tr_b16 v[218:219], v48 offset:9216
    v_mfma_f32_16x16x32_bf16 v[76:79], v[152:155], v[204:207], v[76:79]
    ds_read_b128 v[176:179], v42 offset:2048
    v_mfma_f32_16x16x32_bf16 v[72:75], v[200:203], v[152:155], v[72:75]
    ds_read_b64_tr_b16 v[220:221], v49 offset:8192
    v_mfma_f32_16x16x32_bf16 v[68:71], v[196:199], v[152:155], v[68:71]
    ds_read_b64_tr_b16 v[222:223], v49 offset:9216
    v_mfma_f32_16x16x32_bf16 v[84:87], v[196:199], v[156:159], v[84:87]
    ds_read_b128 v[180:183], v42 offset:4096
    v_mfma_f32_16x16x32_bf16 v[88:91], v[200:203], v[156:159], v[88:91]
    ds_read_b64_tr_b16 v[224:225], v50 offset:8192
    v_mfma_f32_16x16x32_bf16 v[92:95], v[156:159], v[204:207], v[92:95]
    ds_read_b64_tr_b16 v[226:227], v50 offset:9216
    v_mfma_f32_16x16x32_bf16 v[96:99], v[208:211], v[156:159], v[96:99]
    ds_read_b128 v[184:187], v42 offset:6144
    v_mfma_f32_16x16x32_bf16 v[112:115], v[208:211], v[160:163], v[112:115]
    ds_read_b128 v[188:191], v42 offset:8192
    v_mfma_f32_16x16x32_bf16 v[108:111], v[160:163], v[204:207], v[108:111]
    ds_read_b128 v[192:195], v42 offset:10240
    v_mfma_f32_16x16x32_bf16 v[104:107], v[200:203], v[160:163], v[104:107]
    v_mfma_f32_16x16x32_bf16 v[100:103], v[196:199], v[160:163], v[100:103]
    v_mfma_f32_16x16x32_bf16 v[116:119], v[196:199], v[164:167], v[116:119]
    v_mfma_f32_16x16x32_bf16 v[120:123], v[200:203], v[164:167], v[120:123]
    v_mfma_f32_16x16x32_bf16 v[124:127], v[164:167], v[204:207], v[124:127]
    v_mfma_f32_16x16x32_bf16 v[128:131], v[208:211], v[164:167], v[128:131]
    v_mfma_f32_16x16x32_bf16 v[144:147], v[208:211], v[168:171], v[144:147]
    v_mfma_f32_16x16x32_bf16 v[140:143], v[168:171], v[204:207], v[140:143]
    v_mfma_f32_16x16x32_bf16 v[136:139], v[200:203], v[168:171], v[136:139]
    v_mfma_f32_16x16x32_bf16 v[132:135], v[196:199], v[168:171], v[132:135]
    s_waitcnt lgkmcnt(0)
    s_barrier
    v_mfma_f32_16x16x32_bf16 v[52:55], v[212:215], v[172:175], v[52:55]
    ds_read_b64_tr_b16 v[196:197], v43 offset:0
    v_mfma_f32_16x16x32_bf16 v[56:59], v[216:219], v[172:175], v[56:59]
    ds_read_b64_tr_b16 v[198:199], v43 offset:1024
    v_mfma_f32_16x16x32_bf16 v[60:63], v[172:175], v[220:223], v[60:63]
    ds_read_b128 v[148:151], v39 offset:0
    v_mfma_f32_16x16x32_bf16 v[64:67], v[224:227], v[172:175], v[64:67]
    ds_read_b64_tr_b16 v[200:201], v44 offset:0
    v_mfma_f32_16x16x32_bf16 v[80:83], v[224:227], v[176:179], v[80:83]
    ds_read_b64_tr_b16 v[202:203], v44 offset:1024
    v_mfma_f32_16x16x32_bf16 v[76:79], v[176:179], v[220:223], v[76:79]
    ds_read_b128 v[152:155], v39 offset:2048
    v_mfma_f32_16x16x32_bf16 v[72:75], v[216:219], v[176:179], v[72:75]
    ds_read_b64_tr_b16 v[204:205], v45 offset:0
    v_mfma_f32_16x16x32_bf16 v[68:71], v[212:215], v[176:179], v[68:71]
    ds_read_b64_tr_b16 v[206:207], v45 offset:1024
    v_mfma_f32_16x16x32_bf16 v[84:87], v[212:215], v[180:183], v[84:87]
    ds_read_b128 v[156:159], v39 offset:4096
    v_mfma_f32_16x16x32_bf16 v[88:91], v[216:219], v[180:183], v[88:91]
    ds_read_b64_tr_b16 v[208:209], v46 offset:0
    v_mfma_f32_16x16x32_bf16 v[92:95], v[180:183], v[220:223], v[92:95]
    ds_read_b64_tr_b16 v[210:211], v46 offset:1024
    v_mfma_f32_16x16x32_bf16 v[96:99], v[224:227], v[180:183], v[96:99]
    ds_read_b128 v[160:163], v39 offset:6144
    v_mfma_f32_16x16x32_bf16 v[112:115], v[224:227], v[184:187], v[112:115]
    ds_read_b128 v[164:167], v39 offset:8192
    v_mfma_f32_16x16x32_bf16 v[108:111], v[184:187], v[220:223], v[108:111]
    ds_read_b128 v[168:171], v39 offset:10240
    v_mfma_f32_16x16x32_bf16 v[104:107], v[216:219], v[184:187], v[104:107]
    v_mfma_f32_16x16x32_bf16 v[100:103], v[212:215], v[184:187], v[100:103]
    v_mfma_f32_16x16x32_bf16 v[116:119], v[212:215], v[188:191], v[116:119]
    v_mfma_f32_16x16x32_bf16 v[120:123], v[216:219], v[188:191], v[120:123]
    v_mfma_f32_16x16x32_bf16 v[124:127], v[188:191], v[220:223], v[124:127]
    v_mfma_f32_16x16x32_bf16 v[128:131], v[224:227], v[188:191], v[128:131]
    v_mfma_f32_16x16x32_bf16 v[144:147], v[224:227], v[192:195], v[144:147]
    v_mfma_f32_16x16x32_bf16 v[140:143], v[192:195], v[220:223], v[140:143]
    v_mfma_f32_16x16x32_bf16 v[136:139], v[216:219], v[192:195], v[136:139]
    v_mfma_f32_16x16x32_bf16 v[132:135], v[212:215], v[192:195], v[132:135]
    s_waitcnt lgkmcnt(0)
    v_mfma_f32_16x16x32_bf16 v[52:55], v[196:199], v[148:151], v[52:55]
    ds_read_b64_tr_b16 v[212:213], v43 offset:8192
    v_mfma_f32_16x16x32_bf16 v[56:59], v[200:203], v[148:151], v[56:59]
    ds_read_b64_tr_b16 v[214:215], v43 offset:9216
    v_mfma_f32_16x16x32_bf16 v[60:63], v[148:151], v[204:207], v[60:63]
    ds_read_b128 v[172:175], v40 offset:0
    v_mfma_f32_16x16x32_bf16 v[64:67], v[208:211], v[148:151], v[64:67]
    ds_read_b64_tr_b16 v[216:217], v44 offset:8192
    v_mfma_f32_16x16x32_bf16 v[80:83], v[208:211], v[152:155], v[80:83]
    ds_read_b64_tr_b16 v[218:219], v44 offset:9216
    v_mfma_f32_16x16x32_bf16 v[76:79], v[152:155], v[204:207], v[76:79]
    ds_read_b128 v[176:179], v40 offset:2048
    v_mfma_f32_16x16x32_bf16 v[72:75], v[200:203], v[152:155], v[72:75]
    ds_read_b64_tr_b16 v[220:221], v45 offset:8192
    v_mfma_f32_16x16x32_bf16 v[68:71], v[196:199], v[152:155], v[68:71]
    ds_read_b64_tr_b16 v[222:223], v45 offset:9216
    v_mfma_f32_16x16x32_bf16 v[84:87], v[196:199], v[156:159], v[84:87]
    ds_read_b128 v[180:183], v40 offset:4096
    v_mfma_f32_16x16x32_bf16 v[88:91], v[200:203], v[156:159], v[88:91]
    ds_read_b64_tr_b16 v[224:225], v46 offset:8192
    v_mfma_f32_16x16x32_bf16 v[92:95], v[156:159], v[204:207], v[92:95]
    ds_read_b64_tr_b16 v[226:227], v46 offset:9216
    v_mfma_f32_16x16x32_bf16 v[96:99], v[208:211], v[156:159], v[96:99]
    ds_read_b128 v[184:187], v40 offset:6144
    v_mfma_f32_16x16x32_bf16 v[112:115], v[208:211], v[160:163], v[112:115]
    ds_read_b128 v[188:191], v40 offset:8192
    v_mfma_f32_16x16x32_bf16 v[108:111], v[160:163], v[204:207], v[108:111]
    ds_read_b128 v[192:195], v40 offset:10240
    v_mfma_f32_16x16x32_bf16 v[104:107], v[200:203], v[160:163], v[104:107]
    v_mfma_f32_16x16x32_bf16 v[100:103], v[196:199], v[160:163], v[100:103]
    v_mfma_f32_16x16x32_bf16 v[116:119], v[196:199], v[164:167], v[116:119]
    v_mfma_f32_16x16x32_bf16 v[120:123], v[200:203], v[164:167], v[120:123]
    v_mfma_f32_16x16x32_bf16 v[124:127], v[164:167], v[204:207], v[124:127]
    v_mfma_f32_16x16x32_bf16 v[128:131], v[208:211], v[164:167], v[128:131]
    v_mfma_f32_16x16x32_bf16 v[144:147], v[208:211], v[168:171], v[144:147]
    v_mfma_f32_16x16x32_bf16 v[140:143], v[168:171], v[204:207], v[140:143]
    v_mfma_f32_16x16x32_bf16 v[136:139], v[200:203], v[168:171], v[136:139]
    v_mfma_f32_16x16x32_bf16 v[132:135], v[196:199], v[168:171], v[132:135]
    s_waitcnt lgkmcnt(0)
    s_barrier
    v_mfma_f32_16x16x32_bf16 v[52:55], v[212:215], v[172:175], v[52:55]
    ds_read_b64_tr_b16 v[196:197], v43 offset:40960
    v_mfma_f32_16x16x32_bf16 v[56:59], v[216:219], v[172:175], v[56:59]
    ds_read_b64_tr_b16 v[198:199], v43 offset:41984
    v_mfma_f32_16x16x32_bf16 v[60:63], v[172:175], v[220:223], v[60:63]
    ds_read_b128 v[148:151], v39 offset:40960
    v_mfma_f32_16x16x32_bf16 v[64:67], v[224:227], v[172:175], v[64:67]
    ds_read_b64_tr_b16 v[200:201], v44 offset:40960
    v_mfma_f32_16x16x32_bf16 v[80:83], v[224:227], v[176:179], v[80:83]
    ds_read_b64_tr_b16 v[202:203], v44 offset:41984
    v_mfma_f32_16x16x32_bf16 v[76:79], v[176:179], v[220:223], v[76:79]
    ds_read_b128 v[152:155], v39 offset:43008
    v_mfma_f32_16x16x32_bf16 v[72:75], v[216:219], v[176:179], v[72:75]
    ds_read_b64_tr_b16 v[204:205], v45 offset:40960
    v_mfma_f32_16x16x32_bf16 v[68:71], v[212:215], v[176:179], v[68:71]
    ds_read_b64_tr_b16 v[206:207], v45 offset:41984
    v_mfma_f32_16x16x32_bf16 v[84:87], v[212:215], v[180:183], v[84:87]
    ds_read_b128 v[156:159], v39 offset:45056
    v_mfma_f32_16x16x32_bf16 v[88:91], v[216:219], v[180:183], v[88:91]
    ds_read_b64_tr_b16 v[208:209], v46 offset:40960
    v_mfma_f32_16x16x32_bf16 v[92:95], v[180:183], v[220:223], v[92:95]
    ds_read_b64_tr_b16 v[210:211], v46 offset:41984
    v_mfma_f32_16x16x32_bf16 v[96:99], v[224:227], v[180:183], v[96:99]
    ds_read_b128 v[160:163], v39 offset:47104
    v_mfma_f32_16x16x32_bf16 v[112:115], v[224:227], v[184:187], v[112:115]
    ds_read_b128 v[164:167], v39 offset:49152
    v_mfma_f32_16x16x32_bf16 v[108:111], v[184:187], v[220:223], v[108:111]
    ds_read_b128 v[168:171], v39 offset:51200
    v_mfma_f32_16x16x32_bf16 v[104:107], v[216:219], v[184:187], v[104:107]
    v_mfma_f32_16x16x32_bf16 v[100:103], v[212:215], v[184:187], v[100:103]
    v_mfma_f32_16x16x32_bf16 v[116:119], v[212:215], v[188:191], v[116:119]
    v_mfma_f32_16x16x32_bf16 v[120:123], v[216:219], v[188:191], v[120:123]
    v_mfma_f32_16x16x32_bf16 v[124:127], v[188:191], v[220:223], v[124:127]
    v_mfma_f32_16x16x32_bf16 v[128:131], v[224:227], v[188:191], v[128:131]
    s_branch K_PG2
.p2align 12
K_CHM2:
K_STM2:
    s_branch K_WRET_M
    s_nop 0
K_PG2:
    v_mfma_f32_16x16x32_bf16 v[144:147], v[224:227], v[192:195], v[144:147]
    v_mfma_f32_16x16x32_bf16 v[140:143], v[192:195], v[220:223], v[140:143]
    v_mfma_f32_16x16x32_bf16 v[136:139], v[216:219], v[192:195], v[136:139]
    v_mfma_f32_16x16x32_bf16 v[132:135], v[212:215], v[192:195], v[132:135]
    s_waitcnt lgkmcnt(0)
    v_mfma_f32_16x16x32_bf16 v[52:55], v[196:199], v[148:151], v[52:55]
    ds_read_b64_tr_b16 v[212:213], v43 offset:49152
    v_mfma_f32_16x16x32_bf16 v[56:59], v[200:203], v[148:151], v[56:59]
    ds_read_b64_tr_b16 v[214:215], v43 offset:50176
    v_mfma_f32_16x16x32_bf16 v[60:63], v[148:151], v[204:207], v[60:63]
    ds_read_b128 v[172:175], v40 offset:40960
    v_mfma_f32_16x16x32_bf16 v[64:67], v[208:211], v[148:151], v[64:67]
    ds_read_b64_tr_b16 v[216:217], v44 offset:49152
    v_mfma_f32_16x16x32_bf16 v[80:83], v[208:211], v[152:155], v[80:83]
    ds_read_b64_tr_b16 v[218:219], v44 offset:50176
    v_mfma_f32_16x16x32_bf16 v[76:79], v[152:155], v[204:207], v[76:79]
    ds_read_b128 v[176:179], v40 offset:43008
    v_mfma_f32_16x16x32_bf16 v[72:75], v[200:203], v[152:155], v[72:75]
    ds_read_b64_tr_b16 v[220:221], v45 offset:49152
    v_mfma_f32_16x16x32_bf16 v[68:71], v[196:199], v[152:155], v[68:71]
    ds_read_b64_tr_b16 v[222:223], v45 offset:50176
    v_mfma_f32_16x16x32_bf16 v[84:87], v[196:199], v[156:159], v[84:87]
    ds_read_b128 v[180:183], v40 offset:45056
    v_mfma_f32_16x16x32_bf16 v[88:91], v[200:203], v[156:159], v[88:91]
    ds_read_b64_tr_b16 v[224:225], v46 offset:49152
    v_mfma_f32_16x16x32_bf16 v[92:95], v[156:159], v[204:207], v[92:95]
    ds_read_b64_tr_b16 v[226:227], v46 offset:50176
    v_mfma_f32_16x16x32_bf16 v[96:99], v[208:211], v[156:159], v[96:99]
    ds_read_b128 v[184:187], v40 offset:47104
    v_mfma_f32_16x16x32_bf16 v[112:115], v[208:211], v[160:163], v[112:115]
    ds_read_b128 v[188:191], v40 offset:49152
    v_mfma_f32_16x16x32_bf16 v[108:111], v[160:163], v[204:207], v[108:111]
    ds_read_b128 v[192:195], v40 offset:51200
    v_mfma_f32_16x16x32_bf16 v[104:107], v[200:203], v[160:163], v[104:107]
    v_mfma_f32_16x16x32_bf16 v[100:103], v[196:199], v[160:163], v[100:103]
    v_mfma_f32_16x16x32_bf16 v[116:119], v[196:199], v[164:167], v[116:119]
    v_mfma_f32_16x16x32_bf16 v[120:123], v[200:203], v[164:167], v[120:123]
    v_mfma_f32_16x16x32_bf16 v[124:127], v[164:167], v[204:207], v[124:127]
    v_mfma_f32_16x16x32_bf16 v[128:131], v[208:211], v[164:167], v[128:131]
    v_mfma_f32_16x16x32_bf16 v[144:147], v[208:211], v[168:171], v[144:147]
    v_mfma_f32_16x16x32_bf16 v[140:143], v[168:171], v[204:207], v[140:143]
    v_mfma_f32_16x16x32_bf16 v[136:139], v[200:203], v[168:171], v[136:139]
    v_mfma_f32_16x16x32_bf16 v[132:135], v[196:199], v[168:171], v[132:135]
    s_waitcnt lgkmcnt(0)
    s_barrier
    v_mfma_f32_16x16x32_bf16 v[52:55], v[212:215], v[172:175], v[52:55]
    ds_read_b64_tr_b16 v[196:197], v47 offset:0
    v_mfma_f32_16x16x32_bf16 v[56:59], v[216:219], v[172:175], v[56:59]
    ds_read_b64_tr_b16 v[198:199], v47 offset:1024
    v_mfma_f32_16x16x32_bf16 v[60:63], v[172:175], v[220:223], v[60:63]
    ds_read_b128 v[148:151], v41 offset:0
    v_mfma_f32_16x16x32_bf16 v[64:67], v[224:227], v[172:175], v[64:67]
    ds_read_b64_tr_b16 v[200:201], v48 offset:0
    v_mfma_f32_16x16x32_bf16 v[80:83], v[224:227], v[176:179], v[80:83]
    ds_read_b64_tr_b16 v[202:203], v48 offset:1024
    v_mfma_f32_16x16x32_bf16 v[76:79], v[176:179], v[220:223], v[76:79]
    ds_read_b128 v[152:155], v41 offset:2048
    v_mfma_f32_16x16x32_bf16 v[72:75], v[216:219], v[176:179], v[72:75]
    ds_read_b64_tr_b16 v[204:205], v49 offset:0
    v_mfma_f32_16x16x32_bf16 v[68:71], v[212:215], v[176:179], v[68:71]
    ds_read_b64_tr_b16 v[206:207], v49 offset:1024
    v_mfma_f32_16x16x32_bf16 v[84:87], v[212:215], v[180:183], v[84:87]
    ds_read_b128 v[156:159], v41 offset:4096
    v_mfma_f32_16x16x32_bf16 v[88:91], v[216:219], v[180:183], v[88:91]
    ds_read_b64_tr_b16 v[208:209], v50 offset:0
    v_mfma_f32_16x16x32_bf16 v[92:95], v[180:183], v[220:223], v[92:95]
    ds_read_b64_tr_b16 v[210:211], v50 offset:1024
    v_mfma_f32_16x16x32_bf16 v[96:99], v[224:227], v[180:183], v[96:99]
    ds_read_b128 v[160:163], v41 offset:6144
    v_mfma_f32_16x16x32_bf16 v[112:115], v[224:227], v[184:187], v[112:115]
    ds_read_b128 v[164:167], v41 offset:8192
    v_mfma_f32_16x16x32_bf16 v[108:111], v[184:187], v[220:223], v[108:111]
    ds_read_b128 v[168:171], v41 offset:10240
    v_mfma_f32_16x16x32_bf16 v[104:107], v[216:219], v[184:187], v[104:107]
    v_mfma_f32_16x16x32_bf16 v[100:103], v[212:215], v[184:187], v[100:103]
    v_mfma_f32_16x16x32_bf16 v[116:119], v[212:215], v[188:191], v[116:119]
    v_mfma_f32_16x16x32_bf16 v[120:123], v[216:219], v[188:191], v[120:123]
    v_mfma_f32_16x16x32_bf16 v[124:127], v[188:191], v[220:223], v[124:127]
    v_mfma_f32_16x16x32_bf16 v[128:131], v[224:227], v[188:191], v[128:131]
    v_mfma_f32_16x16x32_bf16 v[144:147], v[224:227], v[192:195], v[144:147]
    v_mfma_f32_16x16x32_bf16 v[140:143], v[192:195], v[220:223], v[140:143]
    v_mfma_f32_16x16x32_bf16 v[136:139], v[216:219], v[192:195], v[136:139]
    v_mfma_f32_16x16x32_bf16 v[132:135], v[212:215], v[192:195], v[132:135]
    s_waitcnt lgkmcnt(0)
    v_mfma_f32_16x16x32_bf16 v[132:135], v[196:199], v[168:171], v[132:135]
    ds_read_b64_tr_b16 v[212:213], v47 offset:8192
    ds_read_b64_tr_b16 v[214:215], v47 offset:9216
    v_mfma_f32_16x16x32_bf16 v[136:139], v[200:203], v[168:171], v[136:139]
    ds_read_b128 v[192:195], v42 offset:10240
    ds_read_b64_tr_b16 v[216:217], v48 offset:8192
    v_mfma_f32_16x16x32_bf16 v[140:143], v[168:171], v[204:207], v[140:143]
    ds_read_b64_tr_b16 v[218:219], v48 offset:9216
    ds_read_b64_tr_b16 v[220:221], v49 offset:8192
    v_mfma_f32_16x16x32_bf16 v[144:147], v[208:211], v[168:171], v[144:147]
    ds_read_b64_tr_b16 v[222:223], v49 offset:9216
    ds_read_b64_tr_b16 v[224:225], v50 offset:8192
    v_mfma_f32_16x16x32_bf16 v[116:119], v[196:199], v[164:167], v[116:119]
    ds_read_b64_tr_b16 v[226:227], v50 offset:9216
    ds_read_b128 v[188:191], v42 offset:8192
    v_mfma_f32_16x16x32_bf16 v[120:123], v[200:203], v[164:167], v[120:123]
    ds_read_b128 v[184:187], v42 offset:6144
    ds_read_b128 v[180:183], v42 offset:4096
    v_mfma_f32_16x16x32_bf16 v[124:127], v[164:167], v[204:207], v[124:127]
    ds_read_b128 v[176:179], v42 offset:2048
    ds_read_b128 v[172:175], v42 offset:0
    v_mfma_f32_16x16x32_bf16 v[128:131], v[208:211], v[164:167], v[128:131]
    s_waitcnt lgkmcnt(11)
    v_mfma_f32_16x16x32_bf16 v[132:135], v[212:215], v[192:195], v[132:135]
    s_waitcnt lgkmcnt(9)
    v_mfma_f32_16x16x32_bf16 v[136:139], v[216:219], v[192:195], v[136:139]
    s_waitcnt lgkmcnt(7)
    v_mfma_f32_16x16x32_bf16 v[140:143], v[192:195], v[220:223], v[140:143]
    s_waitcnt lgkmcnt(5)
    v_mfma_f32_16x16x32_bf16 v[144:147], v[224:227], v[192:195], v[144:147]
    s_waitcnt lgkmcnt(4)
    v_mfma_f32_16x16x32_bf16 v[116:119], v[212:215], v[188:191], v[116:119]
    v_cvt_pk_bf16_f32 v132, v132, v133
    v_cvt_pk_bf16_f32 v133, v134, v135
    v_mfma_f32_16x16x32_bf16 v[120:123], v[216:219], v[188:191], v[120:123]
    v_cvt_pk_bf16_f32 v136, v136, v137
    v_cvt_pk_bf16_f32 v137, v138, v139
    v_mfma_f32_16x16x32_bf16 v[124:127], v[188:191], v[220:223], v[124:127]
    v_mov_b32 v138, 0
    v_mov_b32 v139, 0
    v_mfma_f32_16x16x32_bf16 v[128:131], v[224:227], v[188:191], v[128:131]
    v_cvt_pk_bf16_f32 v134, v144, v145
    v_cvt_pk_bf16_f32 v135, v146, v147
    v_mfma_f32_16x16x32_bf16 v[100:103], v[196:199], v[160:163], v[100:103]
    v_cvt_pk_bf16_f32 v254, v140, v141
    v_cvt_pk_bf16_f32 v255, v142, v143
    v_mfma_f32_16x16x32_bf16 v[104:107], v[200:203], v[160:163], v[104:107]
    v_permlane16_swap_b32 v134, v138
    v_permlane16_swap_b32 v135, v139
    ds_write_b64 v32, v[134:135] offset:768
    v_mfma_f32_16x16x32_bf16 v[108:111], v[160:163], v[204:207], v[108:111]
    ds_read_b64_tr_b16 v[240:241], v33 offset:768
    s_cmp_lg_u32 s54, 0
    s_cbranch_scc1 K_NOX
    ds_write_b64 v34, v[132:133]
    ds_write_b64 v34, v[134:135] offset:512
    ds_write_b64 v34, v[254:255] offset:1024
    v_lshl_add_u32 v2, s55, 2, v38
    ds_write_b16 v2, v38 offset:30
K_NOX:
    v_mfma_f32_16x16x32_bf16 v[112:115], v[208:211], v[160:163], v[112:115]
    v_cvt_pk_bf16_f32 v116, v116, v117
    v_cvt_pk_bf16_f32 v117, v118, v119
    v_mfma_f32_16x16x32_bf16 v[192:195], v[132:135], v[136:139], v[16:19]
    v_cvt_pk_bf16_f32 v120, v120, v121
    v_cvt_pk_bf16_f32 v121, v122, v123
    s_waitcnt lgkmcnt(5)
    v_mfma_f32_16x16x32_bf16 v[100:103], v[212:215], v[184:187], v[100:103]
    v_mov_b32 v122, 0
    v_mov_b32 v123, 0
    v_mfma_f32_16x16x32_bf16 v[104:107], v[216:219], v[184:187], v[104:107]
    v_cvt_pk_bf16_f32 v118, v128, v129
    v_cvt_pk_bf16_f32 v119, v130, v131
    v_mfma_f32_16x16x32_bf16 v[108:111], v[184:187], v[220:223], v[108:111]
    v_cvt_pk_bf16_f32 v252, v124, v125
    v_cvt_pk_bf16_f32 v253, v126, v127
    v_mfma_f32_16x16x32_bf16 v[112:115], v[224:227], v[184:187], v[112:115]
    v_permlane16_swap_b32 v118, v122
    v_permlane16_swap_b32 v119, v123
    ds_write_b64 v32, v[118:119] offset:640
    v_mfma_f32_16x16x32_bf16 v[84:87], v[196:199], v[156:159], v[84:87]
    ds_read_b64_tr_b16 v[238:239], v33 offset:640
    v_cvt_pk_bf16_f32 v100, v100, v101
    v_mfma_f32_16x16x32_bf16 v[88:91], v[200:203], v[156:159], v[88:91]
    v_cvt_pk_bf16_f32 v101, v102, v103
    v_cvt_pk_bf16_f32 v104, v104, v105
    v_mfma_f32_16x16x32_bf16 v[168:171], v[116:119], v[136:139], v[12:15]
    v_cvt_pk_bf16_f32 v105, v106, v107
    v_mov_b32 v106, 0
    v_mfma_f32_16x16x32_bf16 v[92:95], v[156:159], v[204:207], v[92:95]
    v_mov_b32 v107, 0
    v_cvt_pk_bf16_f32 v102, v112, v113
    v_mfma_f32_16x16x32_bf16 v[188:191], v[116:119], v[120:123], v[16:19]
    v_cvt_pk_bf16_f32 v103, v114, v115
    v_cvt_pk_bf16_f32 v250, v108, v109
    v_mfma_f32_16x16x32_bf16 v[96:99], v[208:211], v[156:159], v[96:99]
    v_cvt_pk_bf16_f32 v251, v110, v111
    v_permlane16_swap_b32 v102, v106
    s_waitcnt lgkmcnt(6)
    v_mfma_f32_16x16x32_bf16 v[84:87], v[212:215], v[180:183], v[84:87]
    v_permlane16_swap_b32 v103, v107
    ds_write_b64 v32, v[102:103] offset:512
    v_mfma_f32_16x16x32_bf16 v[88:91], v[216:219], v[180:183], v[88:91]
    ds_read_b64_tr_b16 v[236:237], v33 offset:512
    v_max3_f32 v168, v168, v169, v192
    v_mfma_f32_16x16x32_bf16 v[92:95], v[180:183], v[220:223], v[92:95]
    v_max3_f32 v170, v170, v171, v194
    v_max_f32 v168, v168, v193
    v_mfma_f32_16x16x32_bf16 v[164:167], v[100:103], v[120:123], v[12:15]
    v_max_f32 v169, v170, v195
    v_cvt_pk_bf16_f32 v168, v168, v169
    v_mfma_f32_16x16x32_bf16 v[96:99], v[224:227], v[180:183], v[96:99]
    v_cvt_pk_bf16_f32 v84, v84, v85
    v_cvt_pk_bf16_f32 v85, v86, v87
    v_mfma_f32_16x16x32_bf16 v[184:187], v[100:103], v[104:107], v[16:19]
    v_cvt_pk_bf16_f32 v88, v88, v89
    v_cvt_pk_bf16_f32 v89, v90, v91
    v_mfma_f32_16x16x32_bf16 v[68:71], v[196:199], v[152:155], v[68:71]
    v_mov_b32 v90, 0
    v_mov_b32 v91, 0
    v_mfma_f32_16x16x32_bf16 v[72:75], v[200:203], v[152:155], v[72:75]
    v_max3_f32 v164, v164, v165, v188
    v_max3_f32 v166, v166, v167, v190
    v_mfma_f32_16x16x32_bf16 v[76:79], v[152:155], v[204:207], v[76:79]
    v_max_f32 v164, v164, v189
    v_max_f32 v165, v166, v191
    v_mfma_f32_16x16x32_bf16 v[80:83], v[208:211], v[152:155], v[80:83]
    v_cvt_pk_bf16_f32 v164, v164, v165
    v_cvt_pk_bf16_f32 v86, v96, v97
    s_waitcnt lgkmcnt(7)
    v_mfma_f32_16x16x32_bf16 v[68:71], v[212:215], v[176:179], v[68:71]
    v_cvt_pk_bf16_f32 v87, v98, v99
    v_cvt_pk_bf16_f32 v248, v92, v93
    v_mfma_f32_16x16x32_bf16 v[72:75], v[216:219], v[176:179], v[72:75]
    v_cvt_pk_bf16_f32 v249, v94, v95
    v_permlane16_swap_b32 v86, v90
    v_mfma_f32_16x16x32_bf16 v[76:79], v[176:179], v[220:223], v[76:79]
    v_permlane16_swap_b32 v87, v91
    ds_write_b64 v32, v[86:87] offset:384
    v_mfma_f32_16x16x32_bf16 v[80:83], v[224:227], v[176:179], v[80:83]
    ds_read_b64_tr_b16 v[234:235], v33 offset:384
    v_lshl_add_u32 v2, s55, 2, v38
    v_mfma_f32_16x16x32_bf16 v[52:55], v[196:199], v[148:151], v[52:55]
    ds_read_b32 v3, v2 offset:28
    ds_read_b64 v[144:145], v34
    v_mfma_f32_16x16x32_bf16 v[160:163], v[84:87], v[104:107], v[12:15]
    ds_read_b64 v[146:147], v34 offset:512
    ds_read_b64 v[242:243], v34 offset:1024
    v_mfma_f32_16x16x32_bf16 v[56:59], v[200:203], v[148:151], v[56:59]
    ds_read_b64_tr_b16 v[228:229], v33
    v_cvt_pk_bf16_f32 v68, v68, v69
    v_mfma_f32_16x16x32_bf16 v[180:183], v[84:87], v[88:91], v[16:19]
    v_cvt_pk_bf16_f32 v69, v70, v71
    v_cvt_pk_bf16_f32 v72, v72, v73
    v_mfma_f32_16x16x32_bf16 v[60:63], v[148:151], v[204:207], v[60:63]
    v_cvt_pk_bf16_f32 v73, v74, v75
    v_mov_b32 v74, 0
    v_mfma_f32_16x16x32_bf16 v[64:67], v[208:211], v[148:151], v[64:67]
    v_mov_b32 v75, 0
    v_cvt_pk_bf16_f32 v70, v80, v81
    s_waitcnt lgkmcnt(13)
    v_mfma_f32_16x16x32_bf16 v[52:55], v[212:215], v[172:175], v[52:55]
    v_cvt_pk_bf16_f32 v71, v82, v83
    v_cvt_pk_bf16_f32 v246, v76, v77
    v_mfma_f32_16x16x32_bf16 v[56:59], v[216:219], v[172:175], v[56:59]
    v_cvt_pk_bf16_f32 v247, v78, v79
    v_permlane16_swap_b32 v70, v74
    v_mfma_f32_16x16x32_bf16 v[60:63], v[172:175], v[220:223], v[60:63]
    v_permlane16_swap_b32 v71, v75
    ds_write_b64 v32, v[70:71] offset:256
    v_mfma_f32_16x16x32_bf16 v[64:67], v[224:227], v[172:175], v[64:67]
    ds_read_b64_tr_b16 v[232:233], v33 offset:256
    v_max3_f32 v160, v160, v161, v184
    v_max3_f32 v162, v162, v163, v186
    v_max_f32 v160, v160, v185
    v_max_f32 v161, v162, v187
    v_mfma_f32_16x16x32_bf16 v[156:159], v[68:71], v[88:91], v[12:15]
    v_cvt_pk_bf16_f32 v160, v160, v161
    v_cvt_pk_bf16_f32 v52, v52, v53
    v_cvt_pk_bf16_f32 v53, v54, v55
    v_mfma_f32_16x16x32_bf16 v[176:179], v[68:71], v[72:75], v[16:19]
    v_cvt_pk_bf16_f32 v56, v56, v57
    v_cvt_pk_bf16_f32 v57, v58, v59
    v_mov_b32 v58, 0
    v_mov_b32 v59, 0
    v_cvt_pk_bf16_f32 v54, v64, v65
    v_cvt_pk_bf16_f32 v55, v66, v67
    v_cvt_pk_bf16_f32 v244, v60, v61
    v_cvt_pk_bf16_f32 v245, v62, v63
    v_permlane16_swap_b32 v54, v58
    v_permlane16_swap_b32 v55, v59
    ds_write_b64 v32, v[54:55] offset:128
    ds_read_b64_tr_b16 v[230:231], v33 offset:128
    v_max3_f32 v156, v156, v157, v180
    v_max3_f32 v158, v158, v159, v182
    v_max_f32 v156, v156, v181
    v_mfma_f32_16x16x32_bf16 v[152:155], v[52:55], v[72:75], v[20:23]
    v_max_f32 v157, v158, v183
    v_cvt_pk_bf16_f32 v156, v156, v157
    v_mfma_f32_16x16x32_bf16 v[172:175], v[52:55], v[56:59], v[16:19]
    s_waitcnt lgkmcnt(4)
    v_readfirstlane_b32 s33, v3
    s_cmp_lt_u32 s33, 1811939328
    s_cbranch_scc1 K_XW
K_XR:
    v_mfma_f32_16x16x32_bf16 v[148:151], v[144:147], v[56:59], v[12:15]
    v_max3_f32 v152, v152, v153, v176
    v_max3_f32 v154, v154, v155, v178
    v_max_f32 v152, v152, v177
    v_max_f32 v153, v154, v179
    v_cvt_pk_bf16_f32 v152, v152, v153
    v_permlane16_swap_b32 v164, v168
    v_permlane16_swap_b32 v156, v160
    s_nop 1
    v_max3_f32 v148, v148, v149, v172
    v_max3_f32 v150, v150, v151, v174
    v_max_f32 v148, v148, v173
    v_max_f32 v149, v150, v175
    v_cvt_pk_bf16_f32 v148, v148, v149
    v_permlane32_swap_b32 v156, v164
    v_permlane32_swap_b32 v160, v168
    v_lshlrev_b32 v220, 16, v156
    v_and_b32 v221, 0xffff0000, v156
    v_lshlrev_b32 v224, 16, v164
    v_and_b32 v225, 0xffff0000, v164
    v_lshlrev_b32 v222, 16, v160
    v_and_b32 v223, 0xffff0000, v160
    v_lshlrev_b32 v226, 16, v168
    v_and_b32 v227, 0xffff0000, v168
    v_permlane16_swap_b32 v148, v152
    v_lshlrev_b32 v216, 16, v148
    v_and_b32 v217, 0xffff0000, v148
    v_lshlrev_b32 v218, 16, v152
    v_and_b32 v219, 0xffff0000, v152
    v_pk_mul_f32 v[220:221], v[220:221], s[60:61]
    v_pk_mul_f32 v[224:225], v[224:225], s[60:61]
    v_pk_mul_f32 v[222:223], v[222:223], s[60:61]
    v_pk_mul_f32 v[226:227], v[226:227], s[60:61]
    v_pk_mul_f32 v[216:217], v[216:217], s[60:61]
    v_pk_mul_f32 v[218:219], v[218:219], s[60:61]
    v_cvt_pk_bf16_f32 v156, v220, v221
    v_cvt_pk_bf16_f32 v164, v224, v225
    v_cvt_pk_bf16_f32 v160, v222, v223
    v_cvt_pk_bf16_f32 v168, v226, v227
    v_cvt_pk_bf16_f32 v148, v216, v217
    v_cvt_pk_bf16_f32 v152, v218, v219
    v_lshlrev_b32 v218, 16, v152
    v_and_b32 v219, 0xffff0000, v152
    v_lshlrev_b32 v216, 16, v148
    v_and_b32 v217, 0xffff0000, v148
    v_lshlrev_b32 v226, 16, v168
    v_and_b32 v227, 0xffff0000, v168
    v_lshlrev_b32 v222, 16, v160
    v_and_b32 v223, 0xffff0000, v160
    v_lshlrev_b32 v224, 16, v164
    v_and_b32 v225, 0xffff0000, v164
    v_lshlrev_b32 v220, 16, v156
    v_and_b32 v221, 0xffff0000, v156
    v_max3_f32 v174, v216, v217, v218
    v_max3_f32 v172, v220, v221, v224
    v_max_f32 v174, v174, v219
    v_max3_f32 v172, v172, v225, v222
    v_mov_b32 v176, v174
    v_max3_f32 v172, v172, v223, v226
    v_max_f32 v172, v172, v227
    v_permlane32_swap_b32 v174, v176
    v_mul_f32 v172, s58, v172
    v_max_f32 v174, v174, v176
    v_mul_f32 v174, s58, v174
    v_pk_fma_f32 v[220:221], v[220:221], s[58:59], v[172:173] op_sel_hi:[1,1,0] neg_lo:[0,0,1] neg_hi:[0,0,1]
    v_pk_fma_f32 v[222:223], v[222:223], s[58:59], v[172:173] op_sel_hi:[1,1,0] neg_lo:[0,0,1] neg_hi:[0,0,1]
    v_pk_fma_f32 v[224:225], v[224:225], s[58:59], v[172:173] op_sel_hi:[1,1,0] neg_lo:[0,0,1] neg_hi:[0,0,1]
    v_pk_fma_f32 v[226:227], v[226:227], s[58:59], v[172:173] op_sel_hi:[1,1,0] neg_lo:[0,0,1] neg_hi:[0,0,1]
    v_pk_fma_f32 v[216:217], v[216:217], s[58:59], v[174:175] op_sel_hi:[1,1,0] neg_lo:[0,0,1] neg_hi:[0,0,1]
    v_pk_fma_f32 v[218:219], v[218:219], s[58:59], v[174:175] op_sel_hi:[1,1,0] neg_lo:[0,0,1] neg_hi:[0,0,1]
    v_exp_f32 v216, v216
    v_exp_f32 v217, v217
    v_exp_f32 v218, v218
    v_exp_f32 v219, v219
    v_exp_f32 v220, v220
    v_exp_f32 v221, v221
    v_exp_f32 v222, v222
    v_exp_f32 v223, v223
    v_exp_f32 v224, v224
    v_exp_f32 v225, v225
    v_exp_f32 v226, v226
    v_exp_f32 v227, v227
    ds_read_b32 v3, v2 offset:28
    v_pk_add_f32 v[174:175], v[216:217], v[218:219]
    v_pk_add_f32 v[172:173], v[220:221], v[222:223]
    v_add_f32 v174, v174, v175
    v_pk_add_f32 v[178:179], v[224:225], v[226:227]
    v_mov_b32 v176, v174
    v_pk_add_f32 v[172:173], v[172:173], v[178:179]
    v_add_f32 v172, v172, v173
    v_permlane32_swap_b32 v174, v176
    v_rcp_f32 v172, v172
    v_add_f32 v174, v174, v176
    v_rcp_f32 v174, v174
    v_pk_mul_f32 v[220:221], v[220:221], v[172:173] op_sel_hi:[1,0]
    v_pk_mul_f32 v[222:223], v[222:223], v[172:173] op_sel_hi:[1,0]
    v_pk_mul_f32 v[224:225], v[224:225], v[172:173] op_sel_hi:[1,0]
    v_pk_mul_f32 v[226:227], v[226:227], v[172:173] op_sel_hi:[1,0]
    v_pk_mul_f32 v[216:217], v[216:217], v[174:175] op_sel_hi:[1,0]
    v_pk_mul_f32 v[218:219], v[218:219], v[174:175] op_sel_hi:[1,0]
    v_cvt_pk_bf16_f32 v156, v220, v221
    v_cvt_pk_bf16_f32 v164, v224, v225
    v_cvt_pk_bf16_f32 v160, v222, v223
    v_cvt_pk_bf16_f32 v168, v226, v227
    v_cvt_pk_bf16_f32 v148, v216, v217
    v_cvt_pk_bf16_f32 v152, v218, v219
    v_permlane32_swap_b32 v156, v164
    v_permlane32_swap_b32 v160, v168
    v_permlane16_swap_b32 v148, v152
    s_waitcnt lgkmcnt(0)
    v_permlane16_swap_b32 v156, v160
    v_permlane16_swap_b32 v164, v168
    v_readfirstlane_b32 s33, v3
    s_cmp_lt_u32 s33, 1811939332
    s_cbranch_scc1 K_PW
K_PR:
    s_and_b32 s3, s36, 0xffc00
    s_cbranch_scc0 K_NOHa3
    v_mov_b32 v4, s36
    s_mov_b32 exec_lo, s37
    s_mov_b32 exec_hi, 0
    global_atomic_add v37, v4, s[6:7] sc1
    s_mov_b64 exec, -1
K_NOHa3:
    v_perm_b32 v56, v148, v148, v24
    v_perm_b32 v57, v148, v148, v25
    v_perm_b32 v58, v148, v148, v26
    v_perm_b32 v59, v148, v148, v27
    v_perm_b32 v72, v152, v152, v24
    v_perm_b32 v73, v152, v152, v25
    v_mfma_f32_16x16x32_bf16 v[64:67], v[228:231], v[56:59], 0
    v_perm_b32 v74, v152, v152, v26
    v_perm_b32 v75, v152, v152, v27
    v_mfma_f32_16x16x32_bf16 v[60:63], v[242:245], v[56:59], 0
    v_perm_b32 v88, v156, v156, v24
    v_perm_b32 v89, v156, v156, v25
    v_mfma_f32_16x16x32_bf16 v[80:83], v[230:233], v[72:75], 0
    v_perm_b32 v90, v156, v156, v26
    v_perm_b32 v91, v156, v156, v27
    v_mfma_f32_16x16x32_bf16 v[76:79], v[244:247], v[72:75], 0
    v_perm_b32 v104, v160, v160, v24
    v_perm_b32 v105, v160, v160, v25
    v_mfma_f32_16x16x32_bf16 v[96:99], v[232:235], v[88:91], 0
    v_perm_b32 v106, v160, v160, v26
    v_perm_b32 v107, v160, v160, v27
    v_mfma_f32_16x16x32_bf16 v[92:95], v[246:249], v[88:91], 0
    v_cvt_pk_bf16_f32 v68, v64, v65
    v_cvt_pk_bf16_f32 v69, v66, v67
    ds_write_b64 v35, v[68:69] offset:0
    v_perm_b32 v120, v164, v164, v24
    v_perm_b32 v121, v164, v164, v25
    v_mfma_f32_16x16x32_bf16 v[112:115], v[234:237], v[104:107], 0
    v_perm_b32 v122, v164, v164, v26
    v_perm_b32 v123, v164, v164, v27
    v_mfma_f32_16x16x32_bf16 v[108:111], v[248:251], v[104:107], 0
    v_cvt_pk_bf16_f32 v70, v80, v81
    v_cvt_pk_bf16_f32 v71, v82, v83
    ds_write_b64 v35, v[70:71] offset:256
    v_perm_b32 v136, v168, v168, v24
    v_perm_b32 v137, v168, v168, v25
    v_mfma_f32_16x16x32_bf16 v[128:131], v[236:239], v[120:123], 0
    v_perm_b32 v138, v168, v168, v26
    v_perm_b32 v139, v168, v168, v27
    v_mfma_f32_16x16x32_bf16 v[124:127], v[250:253], v[120:123], 0
    v_cvt_pk_bf16_f32 v100, v96, v97
    v_cvt_pk_bf16_f32 v101, v98, v99
    ds_write_b64 v35, v[100:101] offset:512
    v_mov_b32 v3, 1
    v_mfma_f32_16x16x32_bf16 v[144:147], v[238:241], v[136:139], 0
    s_and_b32 s3, s36, 0x3ff
    s_cbranch_scc0 K_NOHa4
    v_mov_b32 v4, s36
    s_mov_b32 exec_lo, s37
    s_mov_b32 exec_hi, 0
    global_atomic_add v37, v4, s[6:7] sc1
    s_mov_b64 exec, -1
K_NOHa4:
    v_lshl_add_u32 v2, s54, 2, v38
    v_cvt_pk_bf16_f32 v102, v112, v113
    v_cvt_pk_bf16_f32 v103, v114, v115
    ds_write_b64 v35, v[102:103] offset:768
    v_mfma_f32_16x16x32_bf16 v[140:143], v[252:255], v[136:139], 0
    v_cvt_pk_bf16_f32 v132, v128, v129
    v_cvt_pk_bf16_f32 v133, v130, v131
    ds_write_b64 v35, v[132:133] offset:1024
    v_cvt_pk_bf16_f32 v134, v144, v145
    v_cvt_pk_bf16_f32 v135, v146, v147
    ds_write_b64 v35, v[134:135] offset:1280
    s_mov_b64 exec, 1
    ds_add_u32 v2, v3 offset:48
    s_mov_b64 exec, -1
    v_cvt_pk_bf16_f32 v52, v60, v61
    v_cvt_pk_bf16_f32 v54, v76, v77
    v_cvt_pk_bf16_f32 v53, v62, v63
    v_cvt_pk_bf16_f32 v55, v78, v79
    s_nop 0
    v_permlane16_swap_b32 v52, v54
    v_permlane16_swap_b32 v53, v55
    v_min_u32 v52, -2, v52
    buffer_store_dwordx4 v[52:55], v28, s[20:23], 0 offen sc1
    v_cvt_pk_bf16_f32 v84, v92, v93
    v_cvt_pk_bf16_f32 v86, v108, v109
    v_cvt_pk_bf16_f32 v85, v94, v95
    v_cvt_pk_bf16_f32 v87, v110, v111
    s_nop 0
    v_permlane16_swap_b32 v84, v86
    v_permlane16_swap_b32 v85, v87
    v_min_u32 v84, -2, v84
    buffer_store_dwordx4 v[84:87], v29, s[20:23], 0 offen sc1
    ds_read_b32 v3, v2 offset:48
    ds_read_b128 v[196:199], v36
    v_cvt_pk_bf16_f32 v116, v124, v125
    v_cvt_pk_bf16_f32 v118, v140, v141
    v_cvt_pk_bf16_f32 v117, v126, v127
    v_cvt_pk_bf16_f32 v119, v142, v143
    s_nop 0
    v_permlane16_swap_b32 v116, v118
    v_permlane16_swap_b32 v117, v119
    v_min_u32 v116, -2, v116
    buffer_store_dwordx4 v[116:119], v30, s[20:23], 0 offen sc1
    s_waitcnt lgkmcnt(0)
    v_readfirstlane_b32 s33, v3
    s_cmp_lt_u32 s33, 2
    s_cbranch_scc1 K_TW
K_TR:
    v_min_u32 v196, -2, v196
    buffer_store_dwordx4 v[196:199], v31, s[20:23], 0 offen sc1
    s_cmp_eq_u32 s34, -1
    s_cbranch_scc1 K_END
    s_add_u32 s30, s30, 4
    s_branch K_P2_HELP
K_CHM3:
K_STM3:
    s_branch K_WRET_M
    s_nop 0
K_XW:
    s_mov_b32 s3, 1048576
K_CGX:
    ds_read_b32 v3, v2 offset:28
    s_sub_u32 s3, s3, 1
    s_waitcnt lgkmcnt(0)
    v_readfirstlane_b32 s33, v3
    s_cselect_b32 s33, 1811939328, s33
    s_cmp_lt_u32 s33, 1811939328
    s_cbranch_scc1 K_CGX
    ds_read_b64 v[144:145], v34
    ds_read_b64 v[146:147], v34 offset:512
    ds_read_b64 v[242:243], v34 offset:1024
    ds_read_b64_tr_b16 v[228:229], v33
    s_waitcnt lgkmcnt(0)
    s_branch K_XR
K_PW:
    s_mov_b32 s3, 1048576
K_CGP:
    ds_read_b32 v3, v2 offset:28
    s_sub_u32 s3, s3, 1
    s_waitcnt lgkmcnt(0)
    v_readfirstlane_b32 s33, v3
    s_cselect_b32 s33, 1811939332, s33
    s_cmp_lt_u32 s33, 1811939332
    s_cbranch_scc1 K_CGP
    s_branch K_PR
K_TW:
    s_mov_b32 s3, 1048576
K_CGT:
    ds_read_b32 v3, v2 offset:48
    s_sub_u32 s3, s3, 1
    s_waitcnt lgkmcnt(0)
    v_readfirstlane_b32 s33, v3
    s_cselect_b32 s33, 2, s33
    s_cmp_lt_u32 s33, 2
    s_cbranch_scc1 K_CGT
    ds_read_b128 v[196:199], v36
    s_waitcnt lgkmcnt(0)
    s_branch K_TR
K_P2_EARLY:
    s_lshl_b32 s62, s40, 7
    v_lshrrev_b32 v8, 3, v1
    v_lshrrev_b32 v9, 4, v1
    v_mov_b32 v15, 158720
    s_lshl_b32 s61, s40, 3
    s_add_u32 s61, s61, s30
    s_mul_i32 s3, s61, 20480
    s_lshl_b32 s33, s41, 7
    s_add_u32 s3, s3, s33
    v_and_b32 v2, 7, v1
    v_lshlrev_b32 v2, 4, v2
    v_mul_u32_u24 v4, 1280, v8
    v_add3_u32 v10, v2, v4, s3
    s_lshl_b32 s3, s30, 7
    s_add_u32 s3, s3, 159744
    v_lshl_add_u32 v11, v8, 3, s3
    s_mov_b32 s63, 10240
    s_add_u32 s20, s6, 0x100000
    s_addc_u32 s21, s7, 0
    s_mov_b32 s22, 0x280000
    s_mov_b32 s23, 0x20000
    s_mov_b32 s56, s10
    s_mov_b32 s57, s11
    s_mov_b32 s58, 0x280000
    s_mov_b32 s59, 0x20000
    v_mul_u32_u24 v3, 144, v8
    v_add_u32 v3, v2, v3
    s_mul_i32 s3, s30, 2304
    s_add_u32 s3, s3, 140288
    v_add_u32 v14, s3, v3
    buffer_load_dwordx4 v[16:19], v10, s[12:15], 0 offen
    buffer_load_dwordx4 v[20:23], v10, s[12:15], s63 offen
    v_bfe_u32 v48, v1, 2, 2
    v_and_b32 v49, 3, v1
    s_add_u32 s3, s61, s30
    s_lshr_b32 s33, s3, 2
    s_mul_i32 s33, s33, 76
    s_add_u32 s3, s3, s33
    s_lshl_b32 s3, s3, 10
    v_and_b32 v2, 15, v1
    v_lshl_add_u32 v2, v2, 4, s3
    v_lshrrev_b32 v3, 5, v1
    v_lshl_add_u32 v2, v3, 8, v2
    v_and_b32 v4, 1, v9
    v_lshl_add_u32 v52, v4, 10, v2
    v_mov_b32 v53, 0x1f000
    v_lshl_add_u32 v2, v3, 3, v48
    v_lshlrev_b32 v2, 7, v2
    v_lshl_add_u32 v2, v49, 3, v2
    v_lshl_add_u32 v2, v4, 5, v2
    v_lshrrev_b32 v4, 1, v48
    v_lshl_add_u32 v54, v4, 6, v2
    v_xor_b32 v55, 64, v54
    v_mov_b32 v56, v54
    v_mov_b32 v57, v54
    s_branch K_PG3
.p2align 12
K_CHA0:
K_STA4:
    s_branch K_STA8
K_CHB0:
K_STB4:
    s_branch K_STB8
K_PG3:
    v_and_b32 v2, 31, v1
    v_mul_u32_u24 v2, 144, v2
    v_lshl_add_u32 v2, v3, 3, v2
    s_mul_i32 s3, s30, 4608
    s_add_u32 s3, s3, 140288
    v_add_u32 v50, s3, v2
    s_lshl_b32 s3, s40, 3
    s_mul_i32 s33, s3, 187
    s_lshr_b32 s33, s33, 11
    s_add_u32 s33, s33, 1
    s_mul_i32 s33, s33, 11
    s_add_u32 s3, s61, s30
    s_add_u32 s3, s3, 1
    s_cmp_ge_u32 s3, s33
    s_cselect_b32 s60, 24, 16
    s_cmp_gt_u32 s3, s33
    s_cselect_b32 s60, 20, s60
    v_add_u32 v58, s60, v15
    s_mov_b32 s64, -1
    s_mov_b32 s65, -1
    s_mov_b32 s66, -1
    s_mov_b32 s67, -1
    s_mov_b32 s68, -1
    s_mov_b32 s69, -1
    s_mov_b32 s70, 0xfffff
    s_mov_b32 s71, 131072
    v_mov_b32 v108, 0
    v_mov_b32 v109, 0
    v_mov_b32 v110, 0
    v_mov_b32 v111, 0
    v_mov_b32 v112, 0
    v_mov_b32 v113, 0
    v_mov_b32 v114, 0
    v_mov_b32 v115, 0
    v_mov_b32 v116, 0
    v_mov_b32 v117, 0
    v_mov_b32 v118, 0
    v_mov_b32 v119, 0
    v_mov_b32 v120, 0
    v_mov_b32 v121, 0
    v_mov_b32 v122, 0
    v_mov_b32 v123, 0
    v_mov_b32 v124, 0
    v_mov_b32 v125, 0
    v_mov_b32 v126, 0
    v_mov_b32 v127, 0
    v_mov_b32 v128, 0
    v_mov_b32 v129, 0
    v_mov_b32 v130, 0
    v_mov_b32 v131, 0
    v_mov_b32 v132, 0
    v_mov_b32 v133, 0
    v_mov_b32 v134, 0
    v_mov_b32 v135, 0
    v_mov_b32 v136, 0
    v_mov_b32 v137, 0
    v_mov_b32 v138, 0
    v_mov_b32 v139, 0
    s_barrier
    s_branch K_P2_AUXW
K_P2_GM:
    s_lshl_b32 s62, s40, 7
    v_lshrrev_b32 v8, 3, v1
    v_lshrrev_b32 v9, 4, v1
    v_mov_b32 v15, 158720
    s_lshl_b32 s61, s40, 3
    s_add_u32 s61, s61, s30
    s_mul_i32 s3, s61, 20480
    s_lshl_b32 s33, s41, 7
    s_add_u32 s3, s3, s33
    v_and_b32 v2, 7, v1
    v_lshlrev_b32 v2, 4, v2
    v_mul_u32_u24 v4, 1280, v8
    v_add3_u32 v10, v2, v4, s3
    s_lshl_b32 s3, s30, 7
    s_add_u32 s3, s3, 159744
    v_lshl_add_u32 v11, v8, 3, s3
    s_mov_b32 s63, 10240
    s_add_u32 s20, s6, 0x100000
    s_addc_u32 s21, s7, 0
    s_mov_b32 s22, 0x280000
    s_mov_b32 s23, 0x20000
    s_mov_b32 s56, s10
    s_mov_b32 s57, s11
    s_mov_b32 s58, 0x280000
    s_mov_b32 s59, 0x20000
    v_mul_u32_u24 v3, 144, v8
    v_add_u32 v3, v2, v3
    s_mul_i32 s3, s30, 2304
    s_add_u32 s3, s3, 140288
    v_add_u32 v14, s3, v3
    v_bfe_u32 v48, v1, 2, 2
    v_and_b32 v49, 3, v1
    s_add_u32 s3, s61, s30
    s_lshr_b32 s33, s3, 2
    s_mul_i32 s33, s33, 76
    s_add_u32 s3, s3, s33
    s_lshl_b32 s3, s3, 10
    v_and_b32 v2, 15, v1
    v_lshl_add_u32 v2, v2, 4, s3
    v_lshrrev_b32 v3, 5, v1
    v_lshl_add_u32 v2, v3, 8, v2
    v_and_b32 v4, 1, v9
    v_lshl_add_u32 v52, v4, 10, v2
    v_mov_b32 v53, 0x1f000
    v_lshl_add_u32 v2, v3, 3, v48
    v_lshlrev_b32 v2, 7, v2
    v_lshl_add_u32 v2, v49, 3, v2
    v_lshl_add_u32 v2, v4, 5, v2
    v_lshrrev_b32 v4, 1, v48
    v_lshl_add_u32 v54, v4, 6, v2
    v_xor_b32 v55, 64, v54
    v_mov_b32 v56, v54
    v_mov_b32 v57, v54
    v_and_b32 v2, 31, v1
    v_mul_u32_u24 v2, 144, v2
    v_lshl_add_u32 v2, v3, 3, v2
    s_mul_i32 s3, s30, 4608
    s_add_u32 s3, s3, 140288
    v_add_u32 v50, s3, v2
    s_lshl_b32 s3, s40, 3
    s_mul_i32 s33, s3, 187
    s_lshr_b32 s33, s33, 11
    s_add_u32 s33, s33, 1
    s_mul_i32 s33, s33, 11
    s_add_u32 s3, s61, s30
    s_add_u32 s3, s3, 1
    s_cmp_ge_u32 s3, s33
    s_cselect_b32 s60, 24, 16
    s_cmp_gt_u32 s3, s33
    s_cselect_b32 s60, 20, s60
    v_add_u32 v58, s60, v15
    s_mov_b32 s64, -1
    s_mov_b32 s65, -1
    s_mov_b32 s66, -1
    s_mov_b32 s67, -1
    s_mov_b32 s68, -1
    s_mov_b32 s69, -1
    s_mov_b32 s70, 0xfffff
    s_mov_b32 s71, 131072
    v_mov_b32 v108, 0
    v_mov_b32 v109, 0
    v_mov_b32 v110, 0
    v_mov_b32 v111, 0
    v_mov_b32 v112, 0
    v_mov_b32 v113, 0
    v_mov_b32 v114, 0
    v_mov_b32 v115, 0
    v_mov_b32 v116, 0
    v_mov_b32 v117, 0
    v_mov_b32 v118, 0
    v_mov_b32 v119, 0
    v_mov_b32 v120, 0
    v_mov_b32 v121, 0
    v_mov_b32 v122, 0
    v_mov_b32 v123, 0
    v_mov_b32 v124, 0
    v_mov_b32 v125, 0
    v_mov_b32 v126, 0
    v_mov_b32 v127, 0
    v_mov_b32 v128, 0
    v_mov_b32 v129, 0
    v_mov_b32 v130, 0
    v_mov_b32 v131, 0
    v_mov_b32 v132, 0
    v_mov_b32 v133, 0
    v_mov_b32 v134, 0
    v_mov_b32 v135, 0
    v_mov_b32 v136, 0
    v_mov_b32 v137, 0
    v_mov_b32 v138, 0
    v_mov_b32 v139, 0
    buffer_load_dwordx4 v[16:19], v10, s[12:15], 0 offen
    buffer_load_dwordx4 v[20:23], v10, s[12:15], s63 offen
    s_cmp_eq_u32 s30, 0
    s_cbranch_scc1 K_CHB0
    s_cmp_eq_u32 s30, 1
    s_cbranch_scc1 K_CHB1
    s_cmp_eq_u32 s30, 2
    s_cbranch_scc1 K_CHB2
    s_branch K_CHB3
K_WRET_B:
    v_mov_b32 v3, 1
    s_waitcnt vmcnt(2)
    s_mov_b64 exec, 1
    ds_add_u32 v15, v3 offset:44
    s_mov_b64 exec, -1
    s_mov_b32 s3, 1048576
K_P2_GWM:
    ds_read_b32 v2, v15 offset:44
    s_sleep 1
    s_sub_u32 s3, s3, 1
    s_waitcnt lgkmcnt(0)
    v_readfirstlane_b32 s33, v2
    s_nop 3
    s_cselect_b32 s33, 4, s33
    s_cmp_lt_u32 s33, 4
    s_cbranch_scc1 K_P2_GWM
    ds_write_b32 v15, v15 offset:56
K_P2_GEMM:
    s_setprio 1
    s_mul_i32 s52, s40, 1496
    s_add_u32 s53, s52, 1309
    s_lshr_b32 s52, s52, 11
    s_lshr_b32 s53, s53, 11
    s_sub_u32 s53, s53, s52
    s_mov_b32 s46, 0x84210
    s_mov_b32 s47, s46
    s_waitcnt vmcnt(0)
    v_lshlrev_b32 v32, 16, v16
    v_and_b32 v33, 0xffff0000, v16
    v_lshlrev_b32 v34, 16, v17
    v_and_b32 v35, 0xffff0000, v17
    v_lshlrev_b32 v36, 16, v18
    v_and_b32 v37, 0xffff0000, v18
    v_lshlrev_b32 v38, 16, v19
    v_and_b32 v39, 0xffff0000, v19
    v_lshlrev_b32 v40, 16, v20
    v_and_b32 v41, 0xffff0000, v20
    v_lshlrev_b32 v42, 16, v21
    v_and_b32 v43, 0xffff0000, v21
    v_lshlrev_b32 v44, 16, v22
    v_and_b32 v45, 0xffff0000, v22
    v_lshlrev_b32 v46, 16, v23
    v_and_b32 v47, 0xffff0000, v23
    s_branch K_SPL
K_IT0:
    v_mfma_f32_32x32x16_bf16 v[108:123], v[156:159], v[68:71], v[108:123]
    ds_read_b64_tr_b16 v[140:141], v56 offset:0
    ds_read_b64_tr_b16 v[142:143], v56 offset:512
    s_and_b32 s33, s50, s70
    s_cbranch_scc0 K_RF0
K_RB0:
    s_ff1_i32_b32 s51, s33
    ds_read_b64_tr_b16 v[144:145], v56 offset:2048
    v_mfma_f32_32x32x16_bf16 v[124:139], v[164:167], v[68:71], v[124:139]
    s_bitset0_b32 s70, s51
    s_lshl_b32 s64, s51, 12
    buffer_load_dwordx4 v[60:63], v52, s[20:23], s64 offen offset:0 sc1
    ds_read_b64_tr_b16 v[146:147], v56 offset:2560
    ds_read_b64_tr_b16 v[148:149], v57 offset:0
    v_mfma_f32_32x32x16_bf16 v[108:123], v[160:163], v[72:75], v[108:123]
    buffer_load_dwordx4 v[64:67], v52, s[20:23], s64 offen offset:512 sc1
    ds_read_b64_tr_b16 v[150:151], v57 offset:512
    ds_read_b64_tr_b16 v[152:153], v57 offset:2048
    ds_read_b64_tr_b16 v[154:155], v57 offset:2560
    v_mfma_f32_32x32x16_bf16 v[124:139], v[168:171], v[72:75], v[124:139]
K_TL0:
    s_waitcnt vmcnt(8) lgkmcnt(8)
    v_cmp_u_f32 vcc, v76, v80
    v_and_or_b32 v56, s68, v53, v54
    v_and_or_b32 v57, s68, v53, v55
    s_cbranch_vccnz K_FX1
K_IT1:
    v_mfma_f32_32x32x16_bf16 v[108:123], v[172:175], v[76:79], v[108:123]
    ds_read_b64_tr_b16 v[156:157], v56 offset:0
    ds_read_b64_tr_b16 v[158:159], v56 offset:512
    s_and_b32 s33, s50, s70
    s_cbranch_scc0 K_RF1
K_RB1:
    s_ff1_i32_b32 s51, s33
    ds_read_b64_tr_b16 v[160:161], v56 offset:2048
    v_mfma_f32_32x32x16_bf16 v[124:139], v[180:183], v[76:79], v[124:139]
    s_bitset0_b32 s70, s51
    s_lshl_b32 s65, s51, 12
    buffer_load_dwordx4 v[68:71], v52, s[20:23], s65 offen offset:0 sc1
    ds_read_b64_tr_b16 v[162:163], v56 offset:2560
    ds_read_b64_tr_b16 v[164:165], v57 offset:0
    v_mfma_f32_32x32x16_bf16 v[108:123], v[176:179], v[80:83], v[108:123]
    buffer_load_dwordx4 v[72:75], v52, s[20:23], s65 offen offset:512 sc1
    ds_read_b64_tr_b16 v[166:167], v57 offset:512
    ds_read_b64_tr_b16 v[168:169], v57 offset:2048
    ds_read_b64_tr_b16 v[170:171], v57 offset:2560
    v_mfma_f32_32x32x16_bf16 v[124:139], v[184:187], v[80:83], v[124:139]
K_TL1:
    s_waitcnt vmcnt(8) lgkmcnt(8)
    v_cmp_u_f32 vcc, v84, v88
    v_and_or_b32 v56, s69, v53, v54
    v_and_or_b32 v57, s69, v53, v55
    s_cbranch_vccnz K_FX2
K_IT2:
    v_mfma_f32_32x32x16_bf16 v[108:123], v[140:143], v[84:87], v[108:123]
    ds_read_b64_tr_b16 v[172:173], v56 offset:0
    ds_read_b64_tr_b16 v[174:175], v56 offset:512
    s_and_b32 s33, s50, s70
    s_cbranch_scc0 K_RF2
K_RB2:
    s_ff1_i32_b32 s51, s33
    ds_read_b64_tr_b16 v[176:177], v56 offset:2048
    v_mfma_f32_32x32x16_bf16 v[124:139], v[148:151], v[84:87], v[124:139]
    s_bitset0_b32 s70, s51
    s_lshl_b32 s66, s51, 12
    buffer_load_dwordx4 v[76:79], v52, s[20:23], s66 offen offset:0 sc1
    ds_read_b64_tr_b16 v[178:179], v56 offset:2560
    ds_read_b64_tr_b16 v[180:181], v57 offset:0
    v_mfma_f32_32x32x16_bf16 v[108:123], v[144:147], v[88:91], v[108:123]
    buffer_load_dwordx4 v[80:83], v52, s[20:23], s66 offen offset:512 sc1
    ds_read_b64_tr_b16 v[182:183], v57 offset:512
    ds_read_b64_tr_b16 v[184:185], v57 offset:2048
    ds_read_b64_tr_b16 v[186:187], v57 offset:2560
    v_mfma_f32_32x32x16_bf16 v[124:139], v[152:155], v[88:91], v[124:139]
K_TL2:
    s_waitcnt vmcnt(8) lgkmcnt(8)
    v_cmp_u_f32 vcc, v92, v96
    v_and_or_b32 v56, s64, v53, v54
    v_and_or_b32 v57, s64, v53, v55
    s_cbranch_vccnz K_FX3
K_IT3:
    v_mfma_f32_32x32x16_bf16 v[108:123], v[156:159], v[92:95], v[108:123]
    ds_read_b64_tr_b16 v[140:141], v56 offset:0
    ds_read_b64_tr_b16 v[142:143], v56 offset:512
    s_and_b32 s33, s50, s70
    s_cbranch_scc0 K_RF3
K_RB3:
    s_ff1_i32_b32 s51, s33
    ds_read_b64_tr_b16 v[144:145], v56 offset:2048
    v_mfma_f32_32x32x16_bf16 v[124:139], v[164:167], v[92:95], v[124:139]
    s_bitset0_b32 s70, s51
    s_lshl_b32 s67, s51, 12
    buffer_load_dwordx4 v[84:87], v52, s[20:23], s67 offen offset:0 sc1
    ds_read_b64_tr_b16 v[146:147], v56 offset:2560
    ds_read_b64_tr_b16 v[148:149], v57 offset:0
    v_mfma_f32_32x32x16_bf16 v[108:123], v[160:163], v[96:99], v[108:123]
    buffer_load_dwordx4 v[88:91], v52, s[20:23], s67 offen offset:512 sc1
    ds_read_b64_tr_b16 v[150:151], v57 offset:512
    ds_read_b64_tr_b16 v[152:153], v57 offset:2048
    ds_read_b64_tr_b16 v[154:155], v57 offset:2560
    v_mfma_f32_32x32x16_bf16 v[124:139], v[168:171], v[96:99], v[124:139]
K_TL3:
    s_waitcnt vmcnt(8) lgkmcnt(8)
    v_cmp_u_f32 vcc, v100, v104
    v_and_or_b32 v56, s65, v53, v54
    v_and_or_b32 v57, s65, v53, v55
    s_cbranch_vccnz K_FX4
K_IT4:
    v_mfma_f32_32x32x16_bf16 v[108:123], v[172:175], v[100:103], v[108:123]
    ds_read_b64_tr_b16 v[156:157], v56 offset:0
    ds_read_b64_tr_b16 v[158:159], v56 offset:512
    s_and_b32 s33, s50, s70
    s_cbranch_scc0 K_RF4
K_RB4:
    s_ff1_i32_b32 s51, s33
    ds_read_b64_tr_b16 v[160:161], v56 offset:2048
    v_mfma_f32_32x32x16_bf16 v[124:139], v[180:183], v[100:103], v[124:139]
    s_bitset0_b32 s70, s51
    s_lshl_b32 s68, s51, 12
    buffer_load_dwordx4 v[92:95], v52, s[20:23], s68 offen offset:0 sc1
    ds_read_b64_tr_b16 v[162:163], v56 offset:2560
    ds_read_b64_tr_b16 v[164:165], v57 offset:0
    v_mfma_f32_32x32x16_bf16 v[108:123], v[176:179], v[104:107], v[108:123]
    buffer_load_dwordx4 v[96:99], v52, s[20:23], s68 offen offset:512 sc1
    ds_read_b64_tr_b16 v[166:167], v57 offset:512
    ds_read_b64_tr_b16 v[168:169], v57 offset:2048
    ds_read_b64_tr_b16 v[170:171], v57 offset:2560
    v_mfma_f32_32x32x16_bf16 v[124:139], v[184:187], v[104:107], v[124:139]
K_TL4:
    s_waitcnt vmcnt(8) lgkmcnt(8)
    v_cmp_u_f32 vcc, v60, v64
    v_and_or_b32 v56, s66, v53, v54
    v_and_or_b32 v57, s66, v53, v55
    s_cbranch_vccnz K_FX5
K_IT5:
    v_mfma_f32_32x32x16_bf16 v[108:123], v[140:143], v[60:63], v[108:123]
    ds_read_b64_tr_b16 v[172:173], v56 offset:0
    ds_read_b64_tr_b16 v[174:175], v56 offset:512
    s_and_b32 s33, s50, s70
    s_cbranch_scc0 K_RF5
K_RB5:
    s_ff1_i32_b32 s51, s33
    ds_read_b64_tr_b16 v[176:177], v56 offset:2048
    v_mfma_f32_32x32x16_bf16 v[124:139], v[148:151], v[60:63], v[124:139]
    s_bitset0_b32 s70, s51
    s_lshl_b32 s69, s51, 12
    buffer_load_dwordx4 v[100:103], v52, s[20:23], s69 offen offset:0 sc1
    ds_read_b64_tr_b16 v[178:179], v56 offset:2560
    ds_read_b64_tr_b16 v[180:181], v57 offset:0
    v_mfma_f32_32x32x16_bf16 v[108:123], v[144:147], v[64:67], v[108:123]
    buffer_load_dwordx4 v[104:107], v52, s[20:23], s69 offen offset:512 sc1
    ds_read_b64_tr_b16 v[182:183], v57 offset:512
    ds_read_b64_tr_b16 v[184:185], v57 offset:2048
    ds_read_b64_tr_b16 v[186:187], v57 offset:2560
    v_mfma_f32_32x32x16_bf16 v[124:139], v[152:155], v[64:67], v[124:139]
K_TL5:
    s_waitcnt vmcnt(8) lgkmcnt(8)
    v_cmp_u_f32 vcc, v68, v72
    v_and_or_b32 v56, s67, v53, v54
    v_and_or_b32 v57, s67, v53, v55
    s_cbranch_vccnz K_FX0
    s_branch K_IT0
K_DR0:
    v_mfma_f32_32x32x16_bf16 v[108:123], v[156:159], v[68:71], v[108:123]
    ds_read_b64_tr_b16 v[140:141], v56 offset:0
    ds_read_b64_tr_b16 v[142:143], v56 offset:512
K_DM0:
    ds_read_b64_tr_b16 v[144:145], v56 offset:2048
    s_mov_b32 s64, -1
    v_mfma_f32_32x32x16_bf16 v[124:139], v[164:167], v[68:71], v[124:139]
    buffer_load_dword v3, v52, s[20:23], s64 offen
    ds_read_b64_tr_b16 v[146:147], v56 offset:2560
    ds_read_b64_tr_b16 v[148:149], v57 offset:0
    v_mfma_f32_32x32x16_bf16 v[108:123], v[160:163], v[72:75], v[108:123]
    buffer_load_dword v3, v52, s[20:23], s64 offen
    ds_read_b64_tr_b16 v[150:151], v57 offset:512
    ds_read_b64_tr_b16 v[152:153], v57 offset:2048
    ds_read_b64_tr_b16 v[154:155], v57 offset:2560
    v_mfma_f32_32x32x16_bf16 v[124:139], v[168:171], v[72:75], v[124:139]
    s_waitcnt vmcnt(8) lgkmcnt(8)
    v_cmp_u_f32 vcc, v76, v80
    v_and_or_b32 v56, s68, v53, v54
    v_and_or_b32 v57, s68, v53, v55
    v_mov_b32 v60, -1
    s_cbranch_vccnz K_FX1
K_DR1:
    v_mfma_f32_32x32x16_bf16 v[108:123], v[172:175], v[76:79], v[108:123]
    ds_read_b64_tr_b16 v[156:157], v56 offset:0
    ds_read_b64_tr_b16 v[158:159], v56 offset:512
K_DM1:
    ds_read_b64_tr_b16 v[160:161], v56 offset:2048
    s_mov_b32 s65, -1
    v_mfma_f32_32x32x16_bf16 v[124:139], v[180:183], v[76:79], v[124:139]
    buffer_load_dword v3, v52, s[20:23], s65 offen
    ds_read_b64_tr_b16 v[162:163], v56 offset:2560
    ds_read_b64_tr_b16 v[164:165], v57 offset:0
    v_mfma_f32_32x32x16_bf16 v[108:123], v[176:179], v[80:83], v[108:123]
    buffer_load_dword v3, v52, s[20:23], s65 offen
    ds_read_b64_tr_b16 v[166:167], v57 offset:512
    ds_read_b64_tr_b16 v[168:169], v57 offset:2048
    ds_read_b64_tr_b16 v[170:171], v57 offset:2560
    v_mfma_f32_32x32x16_bf16 v[124:139], v[184:187], v[80:83], v[124:139]
    s_waitcnt vmcnt(8) lgkmcnt(8)
    v_cmp_u_f32 vcc, v84, v88
    v_and_or_b32 v56, s69, v53, v54
    v_and_or_b32 v57, s69, v53, v55
    v_mov_b32 v68, -1
    s_cbranch_vccnz K_FX2
K_DR2:
    v_mfma_f32_32x32x16_bf16 v[108:123], v[140:143], v[84:87], v[108:123]
    ds_read_b64_tr_b16 v[172:173], v56 offset:0
    ds_read_b64_tr_b16 v[174:175], v56 offset:512
K_DM2:
    ds_read_b64_tr_b16 v[176:177], v56 offset:2048
    s_mov_b32 s66, -1
    v_mfma_f32_32x32x16_bf16 v[124:139], v[148:151], v[84:87], v[124:139]
    buffer_load_dword v3, v52, s[20:23], s66 offen
    ds_read_b64_tr_b16 v[178:179], v56 offset:2560
    ds_read_b64_tr_b16 v[180:181], v57 offset:0
    v_mfma_f32_32x32x16_bf16 v[108:123], v[144:147], v[88:91], v[108:123]
    buffer_load_dword v3, v52, s[20:23], s66 offen
    ds_read_b64_tr_b16 v[182:183], v57 offset:512
    ds_read_b64_tr_b16 v[184:185], v57 offset:2048
    ds_read_b64_tr_b16 v[186:187], v57 offset:2560
    v_mfma_f32_32x32x16_bf16 v[124:139], v[152:155], v[88:91], v[124:139]
    s_waitcnt vmcnt(8) lgkmcnt(8)
    v_cmp_u_f32 vcc, v92, v96
    v_and_or_b32 v56, s64, v53, v54
    v_and_or_b32 v57, s64, v53, v55
    v_mov_b32 v76, -1
    s_cbranch_vccnz K_FX3
K_DR3:
    v_mfma_f32_32x32x16_bf16 v[108:123], v[156:159], v[92:95], v[108:123]
    ds_read_b64_tr_b16 v[140:141], v56 offset:0
    ds_read_b64_tr_b16 v[142:143], v56 offset:512
K_DM3:
    ds_read_b64_tr_b16 v[144:145], v56 offset:2048
    s_mov_b32 s67, -1
    v_mfma_f32_32x32x16_bf16 v[124:139], v[164:167], v[92:95], v[124:139]
    buffer_load_dword v3, v52, s[20:23], s67 offen
    ds_read_b64_tr_b16 v[146:147], v56 offset:2560
    ds_read_b64_tr_b16 v[148:149], v57 offset:0
    v_mfma_f32_32x32x16_bf16 v[108:123], v[160:163], v[96:99], v[108:123]
    buffer_load_dword v3, v52, s[20:23], s67 offen
    ds_read_b64_tr_b16 v[150:151], v57 offset:512
    ds_read_b64_tr_b16 v[152:153], v57 offset:2048
    ds_read_b64_tr_b16 v[154:155], v57 offset:2560
    v_mfma_f32_32x32x16_bf16 v[124:139], v[168:171], v[96:99], v[124:139]
    s_waitcnt vmcnt(8) lgkmcnt(8)
    v_cmp_u_f32 vcc, v100, v104
    v_and_or_b32 v56, s65, v53, v54
    v_and_or_b32 v57, s65, v53, v55
    v_mov_b32 v84, -1
    s_cbranch_vccnz K_FX4
K_DR4:
    v_mfma_f32_32x32x16_bf16 v[108:123], v[172:175], v[100:103], v[108:123]
    ds_read_b64_tr_b16 v[156:157], v56 offset:0
    ds_read_b64_tr_b16 v[158:159], v56 offset:512
K_DM4:
    ds_read_b64_tr_b16 v[160:161], v56 offset:2048
    s_mov_b32 s68, -1
    v_mfma_f32_32x32x16_bf16 v[124:139], v[180:183], v[100:103], v[124:139]
    buffer_load_dword v3, v52, s[20:23], s68 offen
    ds_read_b64_tr_b16 v[162:163], v56 offset:2560
    ds_read_b64_tr_b16 v[164:165], v57 offset:0
    v_mfma_f32_32x32x16_bf16 v[108:123], v[176:179], v[104:107], v[108:123]
    buffer_load_dword v3, v52, s[20:23], s68 offen
    ds_read_b64_tr_b16 v[166:167], v57 offset:512
    ds_read_b64_tr_b16 v[168:169], v57 offset:2048
    ds_read_b64_tr_b16 v[170:171], v57 offset:2560
    v_mfma_f32_32x32x16_bf16 v[124:139], v[184:187], v[104:107], v[124:139]
    s_waitcnt vmcnt(8) lgkmcnt(8)
    v_cmp_u_f32 vcc, v60, v64
    v_and_or_b32 v56, s66, v53, v54
    v_and_or_b32 v57, s66, v53, v55
    v_mov_b32 v92, -1
    s_cbranch_vccnz K_FX5
K_DR5:
    v_mfma_f32_32x32x16_bf16 v[108:123], v[140:143], v[60:63], v[108:123]
    ds_read_b64_tr_b16 v[172:173], v56 offset:0
    ds_read_b64_tr_b16 v[174:175], v56 offset:512
K_DM5:
    ds_read_b64_tr_b16 v[176:177], v56 offset:2048
    s_mov_b32 s69, -1
    v_mfma_f32_32x32x16_bf16 v[124:139], v[148:151], v[60:63], v[124:139]
    buffer_load_dword v3, v52, s[20:23], s69 offen
    ds_read_b64_tr_b16 v[178:179], v56 offset:2560
    ds_read_b64_tr_b16 v[180:181], v57 offset:0
    v_mfma_f32_32x32x16_bf16 v[108:123], v[144:147], v[64:67], v[108:123]
    buffer_load_dword v3, v52, s[20:23], s69 offen
    ds_read_b64_tr_b16 v[182:183], v57 offset:512
    ds_read_b64_tr_b16 v[184:185], v57 offset:2048
    ds_read_b64_tr_b16 v[186:187], v57 offset:2560
    v_mfma_f32_32x32x16_bf16 v[124:139], v[152:155], v[64:67], v[124:139]
    s_waitcnt vmcnt(8) lgkmcnt(8)
    v_cmp_u_f32 vcc, v68, v72
    v_and_or_b32 v56, s67, v53, v54
    v_and_or_b32 v57, s67, v53, v55
    v_mov_b32 v100, -1
    s_cbranch_vccnz K_FX0
    s_branch K_DR0
K_CHA1:
K_STA5:
    s_branch K_STA9
K_CHB1:
K_STB5:
    s_branch K_STB9
K_RF0:
    s_cmp_eq_u32 s70, 0
    s_cbranch_scc1 K_DM0
    ds_read_b32 v59, v58
    s_waitcnt lgkmcnt(0)
    v_readfirstlane_b32 s50, v59
    s_and_b32 s33, s50, s70
    s_cbranch_scc1 K_RB0
K_NV0:
    ds_read_b64_tr_b16 v[144:145], v56 offset:2048
    v_mfma_f32_32x32x16_bf16 v[124:139], v[164:167], v[68:71], v[124:139]
    s_mov_b32 s64, -1
    v_mov_b32 v60, -1
    buffer_load_dword v3, v52, s[20:23], s64 offen
    ds_read_b64_tr_b16 v[146:147], v56 offset:2560
    ds_read_b64_tr_b16 v[148:149], v57 offset:0
    v_mfma_f32_32x32x16_bf16 v[108:123], v[160:163], v[72:75], v[108:123]
    buffer_load_dword v3, v52, s[20:23], s64 offen
    ds_read_b64_tr_b16 v[150:151], v57 offset:512
    ds_read_b64_tr_b16 v[152:153], v57 offset:2048
    ds_read_b64_tr_b16 v[154:155], v57 offset:2560
    v_mfma_f32_32x32x16_bf16 v[124:139], v[168:171], v[72:75], v[124:139]
    s_branch K_TL0
K_FX0:
    s_cmp_lt_i32 s65, 0
    s_cbranch_scc1 K_SK0
    v_max_u32 v2, v68, v72
    v_cmp_eq_u32 vcc, -1, v2
    s_cbranch_vccz K_IT0
    s_sub_u32 s71, s71, 1
    s_cbranch_scc1 K_IT0
    s_lshr_b32 s51, s65, 12
    s_bitset1_b32 s70, s51
K_SK0:
    s_and_b32 s33, s50, s70
    s_cbranch_scc0 K_NUL0
K_BK0:
    s_ff1_i32_b32 s51, s33
    s_lshl_b32 s64, s51, 12
    buffer_load_dwordx4 v[60:63], v52, s[20:23], s64 offen offset:0 sc1
    buffer_load_dwordx4 v[64:67], v52, s[20:23], s64 offen offset:512 sc1
    s_bitset0_b32 s70, s51
K_RD0:
    ds_read_b64_tr_b16 v[140:141], v56 offset:0
    ds_read_b64_tr_b16 v[142:143], v56 offset:512
    ds_read_b64_tr_b16 v[144:145], v56 offset:2048
    ds_read_b64_tr_b16 v[146:147], v56 offset:2560
    ds_read_b64_tr_b16 v[148:149], v57 offset:0
    ds_read_b64_tr_b16 v[150:151], v57 offset:512
    ds_read_b64_tr_b16 v[152:153], v57 offset:2048
    ds_read_b64_tr_b16 v[154:155], v57 offset:2560
    s_cmp_lt_i32 s66, 0
    s_cbranch_scc0 K_TL0
    v_and_or_b32 v56, s68, v53, v54
    v_and_or_b32 v57, s68, v53, v55
    s_branch K_SK1
K_NUL0:
    s_and_b32 s51, s66, s67
    s_and_b32 s51, s51, s68
    s_and_b32 s51, s51, s69
    s_cmp_lt_i32 s51, 0
    s_cbranch_scc0 K_PC0
    s_cmp_eq_u32 s70, 0
    s_cbranch_scc1 K_P2_MM
    s_branch K_SPN
K_PC0:
    s_cmp_eq_u32 s70, 0
    s_cbranch_scc1 K_NI0
    ds_read_b32 v59, v58
    s_waitcnt lgkmcnt(0)
    v_readfirstlane_b32 s50, v59
    s_and_b32 s33, s50, s70
    s_cbranch_scc1 K_BK0
    ds_read_b32 v59, v58
    s_waitcnt lgkmcnt(0)
    v_readfirstlane_b32 s50, v59
    s_and_b32 s33, s50, s70
    s_cbranch_scc1 K_BK0
K_NI0:
    s_mov_b32 s64, -1
    v_mov_b32 v60, -1
    buffer_load_dword v3, v52, s[20:23], s64 offen
    buffer_load_dword v3, v52, s[20:23], s64 offen
    s_branch K_RD0
K_RF1:
    s_cmp_eq_u32 s70, 0
    s_cbranch_scc1 K_DM1
    ds_read_b32 v59, v58
    s_waitcnt lgkmcnt(0)
    v_readfirstlane_b32 s50, v59
    s_and_b32 s33, s50, s70
    s_cbranch_scc1 K_RB1
K_NV1:
    ds_read_b64_tr_b16 v[160:161], v56 offset:2048
    v_mfma_f32_32x32x16_bf16 v[124:139], v[180:183], v[76:79], v[124:139]
    s_mov_b32 s65, -1
    v_mov_b32 v68, -1
    buffer_load_dword v3, v52, s[20:23], s65 offen
    ds_read_b64_tr_b16 v[162:163], v56 offset:2560
    ds_read_b64_tr_b16 v[164:165], v57 offset:0
    v_mfma_f32_32x32x16_bf16 v[108:123], v[176:179], v[80:83], v[108:123]
    buffer_load_dword v3, v52, s[20:23], s65 offen
    ds_read_b64_tr_b16 v[166:167], v57 offset:512
    ds_read_b64_tr_b16 v[168:169], v57 offset:2048
    ds_read_b64_tr_b16 v[170:171], v57 offset:2560
    v_mfma_f32_32x32x16_bf16 v[124:139], v[184:187], v[80:83], v[124:139]
    s_branch K_TL1
K_CHA2:
K_STA6:
    s_branch K_STA10
K_CHB2:
K_STB6:
    s_branch K_STB10
K_FX1:
    s_cmp_lt_i32 s66, 0
    s_cbranch_scc1 K_SK1
    v_max_u32 v2, v76, v80
    v_cmp_eq_u32 vcc, -1, v2
    s_cbranch_vccz K_IT1
    s_sub_u32 s71, s71, 1
    s_cbranch_scc1 K_IT1
    s_lshr_b32 s51, s66, 12
    s_bitset1_b32 s70, s51
K_SK1:
    s_and_b32 s33, s50, s70
    s_cbranch_scc0 K_NUL1
K_BK1:
    s_ff1_i32_b32 s51, s33
    s_lshl_b32 s65, s51, 12
    buffer_load_dwordx4 v[68:71], v52, s[20:23], s65 offen offset:0 sc1
    buffer_load_dwordx4 v[72:75], v52, s[20:23], s65 offen offset:512 sc1
    s_bitset0_b32 s70, s51
K_RD1:
    ds_read_b64_tr_b16 v[156:157], v56 offset:0
    ds_read_b64_tr_b16 v[158:159], v56 offset:512
    ds_read_b64_tr_b16 v[160:161], v56 offset:2048
    ds_read_b64_tr_b16 v[162:163], v56 offset:2560
    ds_read_b64_tr_b16 v[164:165], v57 offset:0
    ds_read_b64_tr_b16 v[166:167], v57 offset:512
    ds_read_b64_tr_b16 v[168:169], v57 offset:2048
    ds_read_b64_tr_b16 v[170:171], v57 offset:2560
    s_cmp_lt_i32 s67, 0
    s_cbranch_scc0 K_TL1
    v_and_or_b32 v56, s69, v53, v54
    v_and_or_b32 v57, s69, v53, v55
    s_branch K_SK2
K_NUL1:
    s_and_b32 s51, s64, s67
    s_and_b32 s51, s51, s68
    s_and_b32 s51, s51, s69
    s_cmp_lt_i32 s51, 0
    s_cbranch_scc0 K_PC1
    s_cmp_eq_u32 s70, 0
    s_cbranch_scc1 K_P2_MM
    s_branch K_SPN
K_PC1:
    s_cmp_eq_u32 s70, 0
    s_cbranch_scc1 K_NI1
    ds_read_b32 v59, v58
    s_waitcnt lgkmcnt(0)
    v_readfirstlane_b32 s50, v59
    s_and_b32 s33, s50, s70
    s_cbranch_scc1 K_BK1
    ds_read_b32 v59, v58
    s_waitcnt lgkmcnt(0)
    v_readfirstlane_b32 s50, v59
    s_and_b32 s33, s50, s70
    s_cbranch_scc1 K_BK1
K_NI1:
    s_mov_b32 s65, -1
    v_mov_b32 v68, -1
    buffer_load_dword v3, v52, s[20:23], s65 offen
    buffer_load_dword v3, v52, s[20:23], s65 offen
    s_branch K_RD1
K_RF2:
    s_cmp_eq_u32 s70, 0
    s_cbranch_scc1 K_DM2
    ds_read_b32 v59, v58
    s_waitcnt lgkmcnt(0)
    v_readfirstlane_b32 s50, v59
    s_and_b32 s33, s50, s70
    s_cbranch_scc1 K_RB2
K_NV2:
    ds_read_b64_tr_b16 v[176:177], v56 offset:2048
    v_mfma_f32_32x32x16_bf16 v[124:139], v[148:151], v[84:87], v[124:139]
    s_mov_b32 s66, -1
    v_mov_b32 v76, -1
    buffer_load_dword v3, v52, s[20:23], s66 offen
    ds_read_b64_tr_b16 v[178:179], v56 offset:2560
    ds_read_b64_tr_b16 v[180:181], v57 offset:0
    v_mfma_f32_32x32x16_bf16 v[108:123], v[144:147], v[88:91], v[108:123]
    buffer_load_dword v3, v52, s[20:23], s66 offen
    ds_read_b64_tr_b16 v[182:183], v57 offset:512
    ds_read_b64_tr_b16 v[184:185], v57 offset:2048
    ds_read_b64_tr_b16 v[186:187], v57 offset:2560
    v_mfma_f32_32x32x16_bf16 v[124:139], v[152:155], v[88:91], v[124:139]
    s_branch K_TL2
K_FX2:
    s_cmp_lt_i32 s67, 0
    s_cbranch_scc1 K_SK2
    v_max_u32 v2, v84, v88
    v_cmp_eq_u32 vcc, -1, v2
    s_cbranch_vccz K_IT2
    s_sub_u32 s71, s71, 1
    s_cbranch_scc1 K_IT2
    s_lshr_b32 s51, s67, 12
    s_bitset1_b32 s70, s51
K_SK2:
    s_and_b32 s33, s50, s70
    s_cbranch_scc0 K_NUL2
K_BK2:
    s_ff1_i32_b32 s51, s33
    s_lshl_b32 s66, s51, 12
    buffer_load_dwordx4 v[76:79], v52, s[20:23], s66 offen offset:0 sc1
    buffer_load_dwordx4 v[80:83], v52, s[20:23], s66 offen offset:512 sc1
    s_bitset0_b32 s70, s51
K_RD2:
    ds_read_b64_tr_b16 v[172:173], v56 offset:0
    ds_read_b64_tr_b16 v[174:175], v56 offset:512
    ds_read_b64_tr_b16 v[176:177], v56 offset:2048
    ds_read_b64_tr_b16 v[178:179], v56 offset:2560
    ds_read_b64_tr_b16 v[180:181], v57 offset:0
    ds_read_b64_tr_b16 v[182:183], v57 offset:512
    ds_read_b64_tr_b16 v[184:185], v57 offset:2048
    ds_read_b64_tr_b16 v[186:187], v57 offset:2560
    s_cmp_lt_i32 s68, 0
    s_cbranch_scc0 K_TL2
    s_branch K_PG4
.p2align 12
K_CHA3:
K_STA7:
    s_branch K_STA11
K_CHB3:
K_STB7:
    s_branch K_STB11
K_PG4:
    v_and_or_b32 v56, s64, v53, v54
    v_and_or_b32 v57, s64, v53, v55
    s_branch K_SK3
K_NUL2:
    s_and_b32 s51, s64, s65
    s_and_b32 s51, s51, s68
    s_and_b32 s51, s51, s69
    s_cmp_lt_i32 s51, 0
    s_cbranch_scc0 K_PC2
    s_cmp_eq_u32 s70, 0
    s_cbranch_scc1 K_P2_MM
    s_branch K_SPN
K_PC2:
    s_cmp_eq_u32 s70, 0
    s_cbranch_scc1 K_NI2
    ds_read_b32 v59, v58
    s_waitcnt lgkmcnt(0)
    v_readfirstlane_b32 s50, v59
    s_and_b32 s33, s50, s70
    s_cbranch_scc1 K_BK2
    ds_read_b32 v59, v58
    s_waitcnt lgkmcnt(0)
    v_readfirstlane_b32 s50, v59
    s_and_b32 s33, s50, s70
    s_cbranch_scc1 K_BK2
K_NI2:
    s_mov_b32 s66, -1
    v_mov_b32 v76, -1
    buffer_load_dword v3, v52, s[20:23], s66 offen
    buffer_load_dword v3, v52, s[20:23], s66 offen
    s_branch K_RD2
K_RF3:
    s_cmp_eq_u32 s70, 0
    s_cbranch_scc1 K_DM3
    ds_read_b32 v59, v58
    s_waitcnt lgkmcnt(0)
    v_readfirstlane_b32 s50, v59
    s_and_b32 s33, s50, s70
    s_cbranch_scc1 K_RB3
K_NV3:
    ds_read_b64_tr_b16 v[144:145], v56 offset:2048
    v_mfma_f32_32x32x16_bf16 v[124:139], v[164:167], v[92:95], v[124:139]
    s_mov_b32 s67, -1
    v_mov_b32 v84, -1
    buffer_load_dword v3, v52, s[20:23], s67 offen
    ds_read_b64_tr_b16 v[146:147], v56 offset:2560
    ds_read_b64_tr_b16 v[148:149], v57 offset:0
    v_mfma_f32_32x32x16_bf16 v[108:123], v[160:163], v[96:99], v[108:123]
    buffer_load_dword v3, v52, s[20:23], s67 offen
    ds_read_b64_tr_b16 v[150:151], v57 offset:512
    ds_read_b64_tr_b16 v[152:153], v57 offset:2048
    ds_read_b64_tr_b16 v[154:155], v57 offset:2560
    v_mfma_f32_32x32x16_bf16 v[124:139], v[168:171], v[96:99], v[124:139]
    s_branch K_TL3
K_FX3:
    s_cmp_lt_i32 s68, 0
    s_cbranch_scc1 K_SK3
    v_max_u32 v2, v92, v96
    v_cmp_eq_u32 vcc, -1, v2
    s_cbranch_vccz K_IT3
    s_sub_u32 s71, s71, 1
    s_cbranch_scc1 K_IT3
    s_lshr_b32 s51, s68, 12
    s_bitset1_b32 s70, s51
K_SK3:
    s_and_b32 s33, s50, s70
    s_cbranch_scc0 K_NUL3
K_BK3:
    s_ff1_i32_b32 s51, s33
    s_lshl_b32 s67, s51, 12
    buffer_load_dwordx4 v[84:87], v52, s[20:23], s67 offen offset:0 sc1
    buffer_load_dwordx4 v[88:91], v52, s[20:23], s67 offen offset:512 sc1
    s_bitset0_b32 s70, s51
K_RD3:
    ds_read_b64_tr_b16 v[140:141], v56 offset:0
    ds_read_b64_tr_b16 v[142:143], v56 offset:512
    ds_read_b64_tr_b16 v[144:145], v56 offset:2048
    ds_read_b64_tr_b16 v[146:147], v56 offset:2560
    ds_read_b64_tr_b16 v[148:149], v57 offset:0
    ds_read_b64_tr_b16 v[150:151], v57 offset:512
    ds_read_b64_tr_b16 v[152:153], v57 offset:2048
    ds_read_b64_tr_b16 v[154:155], v57 offset:2560
    s_cmp_lt_i32 s69, 0
    s_cbranch_scc0 K_TL3
    v_and_or_b32 v56, s65, v53, v54
    v_and_or_b32 v57, s65, v53, v55
    s_branch K_SK4
K_NUL3:
    s_and_b32 s51, s64, s65
    s_and_b32 s51, s51, s66
    s_and_b32 s51, s51, s69
    s_cmp_lt_i32 s51, 0
    s_cbranch_scc0 K_PC3
    s_cmp_eq_u32 s70, 0
    s_cbranch_scc1 K_P2_MM
    s_branch K_SPN
K_PC3:
    s_cmp_eq_u32 s70, 0
    s_cbranch_scc1 K_NI3
    ds_read_b32 v59, v58
    s_waitcnt lgkmcnt(0)
    v_readfirstlane_b32 s50, v59
    s_and_b32 s33, s50, s70
    s_cbranch_scc1 K_BK3
    ds_read_b32 v59, v58
    s_waitcnt lgkmcnt(0)
    v_readfirstlane_b32 s50, v59
    s_and_b32 s33, s50, s70
    s_cbranch_scc1 K_BK3
K_NI3:
    s_mov_b32 s67, -1
    v_mov_b32 v84, -1
    buffer_load_dword v3, v52, s[20:23], s67 offen
    buffer_load_dword v3, v52, s[20:23], s67 offen
    s_branch K_RD3
K_STA8:
    s_branch K_STA12
K_STB8:
    s_branch K_STB12
K_RF4:
    s_cmp_eq_u32 s70, 0
    s_cbranch_scc1 K_DM4
    ds_read_b32 v59, v58
    s_waitcnt lgkmcnt(0)
    v_readfirstlane_b32 s50, v59
    s_and_b32 s33, s50, s70
    s_cbranch_scc1 K_RB4
K_NV4:
    ds_read_b64_tr_b16 v[160:161], v56 offset:2048
    v_mfma_f32_32x32x16_bf16 v[124:139], v[180:183], v[100:103], v[124:139]
    s_mov_b32 s68, -1
    v_mov_b32 v92, -1
    buffer_load_dword v3, v52, s[20:23], s68 offen
    ds_read_b64_tr_b16 v[162:163], v56 offset:2560
    ds_read_b64_tr_b16 v[164:165], v57 offset:0
    v_mfma_f32_32x32x16_bf16 v[108:123], v[176:179], v[104:107], v[108:123]
    buffer_load_dword v3, v52, s[20:23], s68 offen
    ds_read_b64_tr_b16 v[166:167], v57 offset:512
    ds_read_b64_tr_b16 v[168:169], v57 offset:2048
    ds_read_b64_tr_b16 v[170:171], v57 offset:2560
    v_mfma_f32_32x32x16_bf16 v[124:139], v[184:187], v[104:107], v[124:139]
    s_branch K_TL4
K_FX4:
    s_cmp_lt_i32 s69, 0
    s_cbranch_scc1 K_SK4
    v_max_u32 v2, v100, v104
    v_cmp_eq_u32 vcc, -1, v2
    s_cbranch_vccz K_IT4
    s_sub_u32 s71, s71, 1
    s_cbranch_scc1 K_IT4
    s_lshr_b32 s51, s69, 12
    s_bitset1_b32 s70, s51
K_SK4:
    s_and_b32 s33, s50, s70
    s_cbranch_scc0 K_NUL4
K_BK4:
    s_ff1_i32_b32 s51, s33
    s_lshl_b32 s68, s51, 12
    buffer_load_dwordx4 v[92:95], v52, s[20:23], s68 offen offset:0 sc1
    buffer_load_dwordx4 v[96:99], v52, s[20:23], s68 offen offset:512 sc1
    s_bitset0_b32 s70, s51
K_RD4:
    ds_read_b64_tr_b16 v[156:157], v56 offset:0
    ds_read_b64_tr_b16 v[158:159], v56 offset:512
    ds_read_b64_tr_b16 v[160:161], v56 offset:2048
    ds_read_b64_tr_b16 v[162:163], v56 offset:2560
    ds_read_b64_tr_b16 v[164:165], v57 offset:0
    ds_read_b64_tr_b16 v[166:167], v57 offset:512
    ds_read_b64_tr_b16 v[168:169], v57 offset:2048
    ds_read_b64_tr_b16 v[170:171], v57 offset:2560
    s_cmp_lt_i32 s64, 0
    s_cbranch_scc0 K_TL4
    v_and_or_b32 v56, s66, v53, v54
    v_and_or_b32 v57, s66, v53, v55
    s_branch K_SK5
K_NUL4:
    s_and_b32 s51, s64, s65
    s_and_b32 s51, s51, s66
    s_and_b32 s51, s51, s67
    s_cmp_lt_i32 s51, 0
    s_cbranch_scc0 K_PC4
    s_cmp_eq_u32 s70, 0
    s_cbranch_scc1 K_P2_MM
    s_branch K_SPN
K_PC4:
    s_cmp_eq_u32 s70, 0
    s_cbranch_scc1 K_NI4
    ds_read_b32 v59, v58
    s_waitcnt lgkmcnt(0)
    v_readfirstlane_b32 s50, v59
    s_and_b32 s33, s50, s70
    s_cbranch_scc1 K_BK4
    ds_read_b32 v59, v58
    s_waitcnt lgkmcnt(0)
    v_readfirstlane_b32 s50, v59
    s_and_b32 s33, s50, s70
    s_cbranch_scc1 K_BK4
K_NI4:
    s_mov_b32 s68, -1
    v_mov_b32 v92, -1
    buffer_load_dword v3, v52, s[20:23], s68 offen
    buffer_load_dword v3, v52, s[20:23], s68 offen
    s_branch K_RD4
K_RF5:
    s_cmp_eq_u32 s70, 0
    s_cbranch_scc1 K_DM5
    ds_read_b32 v59, v58
    s_waitcnt lgkmcnt(0)
    v_readfirstlane_b32 s50, v59
    s_and_b32 s33, s50, s70
    s_cbranch_scc1 K_RB5
K_NV5:
    ds_read_b64_tr_b16 v[176:177], v56 offset:2048
    v_mfma_f32_32x32x16_bf16 v[124:139], v[148:151], v[60:63], v[124:139]
    s_mov_b32 s69, -1
    v_mov_b32 v100, -1
    buffer_load_dword v3, v52, s[20:23], s69 offen
    ds_read_b64_tr_b16 v[178:179], v56 offset:2560
    ds_read_b64_tr_b16 v[180:181], v57 offset:0
    v_mfma_f32_32x32x16_bf16 v[108:123], v[144:147], v[64:67], v[108:123]
    buffer_load_dword v3, v52, s[20:23], s69 offen
    ds_read_b64_tr_b16 v[182:183], v57 offset:512
    ds_read_b64_tr_b16 v[184:185], v57 offset:2048
    ds_read_b64_tr_b16 v[186:187], v57 offset:2560
    v_mfma_f32_32x32x16_bf16 v[124:139], v[152:155], v[64:67], v[124:139]
    s_branch K_TL5
K_STA9:
    s_branch K_STA13
K_STB9:
    s_branch K_STB13
K_FX5:
    s_cmp_lt_i32 s64, 0
    s_cbranch_scc1 K_SK5
    v_max_u32 v2, v60, v64
    v_cmp_eq_u32 vcc, -1, v2
    s_cbranch_vccz K_IT5
    s_sub_u32 s71, s71, 1
    s_cbranch_scc1 K_IT5
    s_lshr_b32 s51, s64, 12
    s_bitset1_b32 s70, s51
K_SK5:
    s_and_b32 s33, s50, s70
    s_cbranch_scc0 K_NUL5
K_BK5:
    s_ff1_i32_b32 s51, s33
    s_lshl_b32 s69, s51, 12
    buffer_load_dwordx4 v[100:103], v52, s[20:23], s69 offen offset:0 sc1
    buffer_load_dwordx4 v[104:107], v52, s[20:23], s69 offen offset:512 sc1
    s_bitset0_b32 s70, s51
K_RD5:
    ds_read_b64_tr_b16 v[172:173], v56 offset:0
    ds_read_b64_tr_b16 v[174:175], v56 offset:512
    ds_read_b64_tr_b16 v[176:177], v56 offset:2048
    ds_read_b64_tr_b16 v[178:179], v56 offset:2560
    ds_read_b64_tr_b16 v[180:181], v57 offset:0
    ds_read_b64_tr_b16 v[182:183], v57 offset:512
    ds_read_b64_tr_b16 v[184:185], v57 offset:2048
    ds_read_b64_tr_b16 v[186:187], v57 offset:2560
    s_cmp_lt_i32 s65, 0
    s_cbranch_scc0 K_TL5
    v_and_or_b32 v56, s67, v53, v54
    v_and_or_b32 v57, s67, v53, v55
    s_branch K_SK0
K_NUL5:
    s_and_b32 s51, s65, s66
    s_and_b32 s51, s51, s67
    s_and_b32 s51, s51, s68
    s_cmp_lt_i32 s51, 0
    s_cbranch_scc0 K_PC5
    s_cmp_eq_u32 s70, 0
    s_cbranch_scc1 K_P2_MM
    s_branch K_SPN
K_PC5:
    s_cmp_eq_u32 s70, 0
    s_cbranch_scc1 K_NI5
    ds_read_b32 v59, v58
    s_waitcnt lgkmcnt(0)
    v_readfirstlane_b32 s50, v59
    s_and_b32 s33, s50, s70
    s_cbranch_scc1 K_BK5
    ds_read_b32 v59, v58
    s_waitcnt lgkmcnt(0)
    v_readfirstlane_b32 s50, v59
    s_and_b32 s33, s50, s70
    s_cbranch_scc1 K_BK5
K_NI5:
    s_mov_b32 s69, -1
    v_mov_b32 v100, -1
    buffer_load_dword v3, v52, s[20:23], s69 offen
    buffer_load_dword v3, v52, s[20:23], s69 offen
    s_branch K_RD5
K_P2_MM:
    v_cvt_pk_bf16_f32 v188, v108, v109
    v_cvt_pk_bf16_f32 v189, v110, v111
    ds_write_b64 v50, v[188:189] offset:0
    v_cvt_pk_bf16_f32 v190, v112, v113
    v_cvt_pk_bf16_f32 v191, v114, v115
    ds_write_b64 v50, v[190:191] offset:16
    v_cvt_pk_bf16_f32 v192, v116, v117
    v_cvt_pk_bf16_f32 v193, v118, v119
    ds_write_b64 v50, v[192:193] offset:32
    v_cvt_pk_bf16_f32 v194, v120, v121
    v_cvt_pk_bf16_f32 v195, v122, v123
    ds_write_b64 v50, v[194:195] offset:48
    v_cvt_pk_bf16_f32 v188, v124, v125
    v_cvt_pk_bf16_f32 v189, v126, v127
    ds_write_b64 v50, v[188:189] offset:64
    v_cvt_pk_bf16_f32 v190, v128, v129
    v_cvt_pk_bf16_f32 v191, v130, v131
    ds_write_b64 v50, v[190:191] offset:80
    v_cvt_pk_bf16_f32 v192, v132, v133
    v_cvt_pk_bf16_f32 v193, v134, v135
    ds_write_b64 v50, v[192:193] offset:96
    v_cvt_pk_bf16_f32 v194, v136, v137
    v_cvt_pk_bf16_f32 v195, v138, v139
    ds_write_b64 v50, v[194:195] offset:112
K_P2_E2:
    s_waitcnt vmcnt(0) lgkmcnt(0)
    s_lshl_b32 s72, s61, 4
    s_barrier
    ds_read_b64 v[28:29], v15
    ds_read_b64 v[24:25], v11
    ds_read_b128 v[48:51], v14
    ds_read_b64 v[26:27], v11 offset:64
    ds_read_b128 v[52:55], v14 offset:1152
    s_waitcnt lgkmcnt(4)
    v_readfirstlane_b32 s48, v28
    v_readfirstlane_b32 s49, v29
    s_sub_u32 s3, s48, s72
    s_cmp_lt_u32 s3, 16
    s_cbranch_scc1 K_YROW0
K_NOY0:
    s_sub_u32 s3, s49, s72
    s_cmp_lt_u32 s3, 16
    s_cbranch_scc1 K_YROW1
K_NOY1:
    s_waitcnt lgkmcnt(3)
    v_pk_mul_f32 v[32:33], v[32:33], v[24:25] op_sel:[0,1] op_sel_hi:[1,1]
    v_pk_mul_f32 v[34:35], v[34:35], v[24:25] op_sel:[0,1] op_sel_hi:[1,1]
    v_pk_mul_f32 v[36:37], v[36:37], v[24:25] op_sel:[0,1] op_sel_hi:[1,1]
    v_pk_mul_f32 v[38:39], v[38:39], v[24:25] op_sel:[0,1] op_sel_hi:[1,1]
    s_waitcnt lgkmcnt(2)
    v_lshlrev_b32 v68, 16, v48
    v_and_b32 v69, 0xffff0000, v48
    v_pk_fma_f32 v[68:69], v[68:69], v[24:25], v[32:33] op_sel_hi:[1,0,1]
    v_cvt_pk_bf16_f32 v48, v68, v69
    v_lshlrev_b32 v70, 16, v49
    v_and_b32 v71, 0xffff0000, v49
    v_pk_fma_f32 v[70:71], v[70:71], v[24:25], v[34:35] op_sel_hi:[1,0,1]
    v_cvt_pk_bf16_f32 v49, v70, v71
    v_lshlrev_b32 v68, 16, v50
    v_and_b32 v69, 0xffff0000, v50
    v_pk_fma_f32 v[68:69], v[68:69], v[24:25], v[36:37] op_sel_hi:[1,0,1]
    v_cvt_pk_bf16_f32 v50, v68, v69
    v_lshlrev_b32 v70, 16, v51
    v_and_b32 v71, 0xffff0000, v51
    v_pk_fma_f32 v[70:71], v[70:71], v[24:25], v[38:39] op_sel_hi:[1,0,1]
    v_cvt_pk_bf16_f32 v51, v70, v71
    buffer_store_dwordx4 v[48:51], v10, s[56:59], 0 offen sc1
    s_waitcnt lgkmcnt(1)
    v_pk_mul_f32 v[40:41], v[40:41], v[26:27] op_sel:[0,1] op_sel_hi:[1,1]
    v_pk_mul_f32 v[42:43], v[42:43], v[26:27] op_sel:[0,1] op_sel_hi:[1,1]
    v_pk_mul_f32 v[44:45], v[44:45], v[26:27] op_sel:[0,1] op_sel_hi:[1,1]
    v_pk_mul_f32 v[46:47], v[46:47], v[26:27] op_sel:[0,1] op_sel_hi:[1,1]
    s_waitcnt lgkmcnt(0)
    v_lshlrev_b32 v68, 16, v52
    v_and_b32 v69, 0xffff0000, v52
    v_pk_fma_f32 v[68:69], v[68:69], v[26:27], v[40:41] op_sel_hi:[1,0,1]
    v_cvt_pk_bf16_f32 v52, v68, v69
    v_lshlrev_b32 v70, 16, v53
    v_and_b32 v71, 0xffff0000, v53
    v_pk_fma_f32 v[70:71], v[70:71], v[26:27], v[42:43] op_sel_hi:[1,0,1]
    v_cvt_pk_bf16_f32 v53, v70, v71
    v_lshlrev_b32 v68, 16, v54
    v_and_b32 v69, 0xffff0000, v54
    v_pk_fma_f32 v[68:69], v[68:69], v[26:27], v[44:45] op_sel_hi:[1,0,1]
    v_cvt_pk_bf16_f32 v54, v68, v69
    v_lshlrev_b32 v70, 16, v55
    v_and_b32 v71, 0xffff0000, v55
    v_pk_fma_f32 v[70:71], v[70:71], v[26:27], v[46:47] op_sel_hi:[1,0,1]
    v_cvt_pk_bf16_f32 v55, v70, v71
    buffer_store_dwordx4 v[52:55], v10, s[56:59], s63 offen sc1
K_END:
K_EXIT:
    s_endpgm
K_YROW0:
    v_and_b32 v2, 7, v1
    v_lshlrev_b32 v2, 5, v2
    v_add_u32 v2, 158976, v2
    ds_read_b128 v[56:59], v2
    ds_read_b128 v[60:63], v2 offset:16
    s_and_b32 s33, s3, 7
    v_cmp_eq_u32 vcc, s33, v8
    s_cmp_ge_u32 s3, 8
    s_cbranch_scc1 K_YR1_0
    s_waitcnt lgkmcnt(0)
    v_add_f32 v64, v32, v56
    v_cvt_pk_bf16_f32 v64, v64, v64
    v_lshlrev_b32 v64, 16, v64
    v_cndmask_b32 v32, v32, v64, vcc
    v_add_f32 v65, v33, v57
    v_cvt_pk_bf16_f32 v65, v65, v65
    v_lshlrev_b32 v65, 16, v65
    v_cndmask_b32 v33, v33, v65, vcc
    v_add_f32 v66, v34, v58
    v_cvt_pk_bf16_f32 v66, v66, v66
    v_lshlrev_b32 v66, 16, v66
    v_cndmask_b32 v34, v34, v66, vcc
    v_add_f32 v67, v35, v59
    v_cvt_pk_bf16_f32 v67, v67, v67
    v_lshlrev_b32 v67, 16, v67
    v_cndmask_b32 v35, v35, v67, vcc
    v_add_f32 v64, v36, v60
    v_cvt_pk_bf16_f32 v64, v64, v64
    v_lshlrev_b32 v64, 16, v64
    v_cndmask_b32 v36, v36, v64, vcc
    v_add_f32 v65, v37, v61
    v_cvt_pk_bf16_f32 v65, v65, v65
    v_lshlrev_b32 v65, 16, v65
    v_cndmask_b32 v37, v37, v65, vcc
    v_add_f32 v66, v38, v62
    v_cvt_pk_bf16_f32 v66, v66, v66
    v_lshlrev_b32 v66, 16, v66
    v_cndmask_b32 v38, v38, v66, vcc
    v_add_f32 v67, v39, v63
    v_cvt_pk_bf16_f32 v67, v67, v67
    v_lshlrev_b32 v67, 16, v67
    v_cndmask_b32 v39, v39, v67, vcc
    s_branch K_NOY0
K_YR1_0:
    s_waitcnt lgkmcnt(0)
    v_add_f32 v64, v40, v56
    v_cvt_pk_bf16_f32 v64, v64, v64
    v_lshlrev_b32 v64, 16, v64
    v_cndmask_b32 v40, v40, v64, vcc
    v_add_f32 v65, v41, v57
    v_cvt_pk_bf16_f32 v65, v65, v65
    v_lshlrev_b32 v65, 16, v65
    v_cndmask_b32 v41, v41, v65, vcc
    v_add_f32 v66, v42, v58
    v_cvt_pk_bf16_f32 v66, v66, v66
    v_lshlrev_b32 v66, 16, v66
    v_cndmask_b32 v42, v42, v66, vcc
    v_add_f32 v67, v43, v59
    v_cvt_pk_bf16_f32 v67, v67, v67
    v_lshlrev_b32 v67, 16, v67
    v_cndmask_b32 v43, v43, v67, vcc
    v_add_f32 v64, v44, v60
    v_cvt_pk_bf16_f32 v64, v64, v64
    v_lshlrev_b32 v64, 16, v64
    v_cndmask_b32 v44, v44, v64, vcc
    v_add_f32 v65, v45, v61
    v_cvt_pk_bf16_f32 v65, v65, v65
    v_lshlrev_b32 v65, 16, v65
    v_cndmask_b32 v45, v45, v65, vcc
    v_add_f32 v66, v46, v62
    v_cvt_pk_bf16_f32 v66, v66, v66
    v_lshlrev_b32 v66, 16, v66
    v_cndmask_b32 v46, v46, v66, vcc
    v_add_f32 v67, v47, v63
    v_cvt_pk_bf16_f32 v67, v67, v67
    v_lshlrev_b32 v67, 16, v67
    v_cndmask_b32 v47, v47, v67, vcc
    s_branch K_NOY0
K_YROW1:
    v_and_b32 v2, 7, v1
    v_lshlrev_b32 v2, 5, v2
    v_add_u32 v2, 159232, v2
    ds_read_b128 v[56:59], v2
    ds_read_b128 v[60:63], v2 offset:16
    s_and_b32 s33, s3, 7
    v_cmp_eq_u32 vcc, s33, v8
    s_cmp_ge_u32 s3, 8
    s_cbranch_scc1 K_YR1_1
    s_waitcnt lgkmcnt(0)
    v_add_f32 v64, v32, v56
    v_cvt_pk_bf16_f32 v64, v64, v64
    v_lshlrev_b32 v64, 16, v64
    v_cndmask_b32 v32, v32, v64, vcc
    v_add_f32 v65, v33, v57
    v_cvt_pk_bf16_f32 v65, v65, v65
    v_lshlrev_b32 v65, 16, v65
    v_cndmask_b32 v33, v33, v65, vcc
    v_add_f32 v66, v34, v58
    v_cvt_pk_bf16_f32 v66, v66, v66
    v_lshlrev_b32 v66, 16, v66
    v_cndmask_b32 v34, v34, v66, vcc
    v_add_f32 v67, v35, v59
    v_cvt_pk_bf16_f32 v67, v67, v67
    v_lshlrev_b32 v67, 16, v67
    v_cndmask_b32 v35, v35, v67, vcc
    v_add_f32 v64, v36, v60
    v_cvt_pk_bf16_f32 v64, v64, v64
    v_lshlrev_b32 v64, 16, v64
    v_cndmask_b32 v36, v36, v64, vcc
    v_add_f32 v65, v37, v61
    v_cvt_pk_bf16_f32 v65, v65, v65
    v_lshlrev_b32 v65, 16, v65
    v_cndmask_b32 v37, v37, v65, vcc
    v_add_f32 v66, v38, v62
    v_cvt_pk_bf16_f32 v66, v66, v66
    v_lshlrev_b32 v66, 16, v66
    v_cndmask_b32 v38, v38, v66, vcc
    v_add_f32 v67, v39, v63
    v_cvt_pk_bf16_f32 v67, v67, v67
    v_lshlrev_b32 v67, 16, v67
    v_cndmask_b32 v39, v39, v67, vcc
    s_branch K_NOY1
K_YR1_1:
    s_waitcnt lgkmcnt(0)
    v_add_f32 v64, v40, v56
    v_cvt_pk_bf16_f32 v64, v64, v64
    v_lshlrev_b32 v64, 16, v64
    v_cndmask_b32 v40, v40, v64, vcc
    v_add_f32 v65, v41, v57
    v_cvt_pk_bf16_f32 v65, v65, v65
    v_lshlrev_b32 v65, 16, v65
    v_cndmask_b32 v41, v41, v65, vcc
    v_add_f32 v66, v42, v58
    v_cvt_pk_bf16_f32 v66, v66, v66
    v_lshlrev_b32 v66, 16, v66
    v_cndmask_b32 v42, v42, v66, vcc
    v_add_f32 v67, v43, v59
    v_cvt_pk_bf16_f32 v67, v67, v67
    v_lshlrev_b32 v67, 16, v67
    v_cndmask_b32 v43, v43, v67, vcc
    v_add_f32 v64, v44, v60
    v_cvt_pk_bf16_f32 v64, v64, v64
    v_lshlrev_b32 v64, 16, v64
    v_cndmask_b32 v44, v44, v64, vcc
    v_add_f32 v65, v45, v61
    v_cvt_pk_bf16_f32 v65, v65, v65
    v_lshlrev_b32 v65, 16, v65
    v_cndmask_b32 v45, v45, v65, vcc
    v_add_f32 v66, v46, v62
    v_cvt_pk_bf16_f32 v66, v66, v66
    v_lshlrev_b32 v66, 16, v66
    v_cndmask_b32 v46, v46, v66, vcc
    v_add_f32 v67, v47, v63
    v_cvt_pk_bf16_f32 v67, v67, v67
    v_lshlrev_b32 v67, 16, v67
    v_cndmask_b32 v47, v47, v67, vcc
    s_branch K_NOY1
K_STA10:
    s_branch K_STA14
K_STB10:
    s_branch K_STB14
K_P2:
    s_cmp_ge_u32 s30, 4
    s_cbranch_scc1 K_P2_HELP
    s_lshl_b32 s62, s40, 7
    v_lshrrev_b32 v8, 3, v1
    v_lshrrev_b32 v9, 4, v1
    v_mov_b32 v15, 158720
    s_lshl_b32 s61, s40, 3
    s_add_u32 s61, s61, s30
    s_mul_i32 s3, s61, 20480
    s_lshl_b32 s33, s41, 7
    s_add_u32 s3, s3, s33
    v_and_b32 v2, 7, v1
    v_lshlrev_b32 v2, 4, v2
    v_mul_u32_u24 v4, 1280, v8
    v_add3_u32 v10, v2, v4, s3
    s_lshl_b32 s3, s30, 7
    s_add_u32 s3, s3, 159744
    v_lshl_add_u32 v11, v8, 3, s3
    s_mov_b32 s63, 10240
    s_add_u32 s20, s6, 0x100000
    s_addc_u32 s21, s7, 0
    s_mov_b32 s22, 0x280000
    s_mov_b32 s23, 0x20000
    s_mov_b32 s56, s10
    s_mov_b32 s57, s11
    s_mov_b32 s58, 0x280000
    s_mov_b32 s59, 0x20000
    v_mul_u32_u24 v3, 144, v8
    v_add_u32 v3, v2, v3
    s_mul_i32 s3, s30, 2304
    s_add_u32 s3, s3, 140288
    v_add_u32 v14, s3, v3
    buffer_load_dwordx4 v[16:19], v10, s[12:15], 0 offen
    buffer_load_dwordx4 v[20:23], v10, s[12:15], s63 offen
    v_bfe_u32 v48, v1, 2, 2
    v_and_b32 v49, 3, v1
    s_add_u32 s3, s61, s30
    s_lshr_b32 s33, s3, 2
    s_mul_i32 s33, s33, 76
    s_add_u32 s3, s3, s33
    s_lshl_b32 s3, s3, 10
    v_and_b32 v2, 15, v1
    v_lshl_add_u32 v2, v2, 4, s3
    v_lshrrev_b32 v3, 5, v1
    v_lshl_add_u32 v2, v3, 8, v2
    v_and_b32 v4, 1, v9
    v_lshl_add_u32 v52, v4, 10, v2
    v_mov_b32 v53, 0x1f000
    v_lshl_add_u32 v2, v3, 3, v48
    v_lshlrev_b32 v2, 7, v2
    v_lshl_add_u32 v2, v49, 3, v2
    v_lshl_add_u32 v2, v4, 5, v2
    v_lshrrev_b32 v4, 1, v48
    v_lshl_add_u32 v54, v4, 6, v2
    v_xor_b32 v55, 64, v54
    v_mov_b32 v56, v54
    v_mov_b32 v57, v54
    v_and_b32 v2, 31, v1
    v_mul_u32_u24 v2, 144, v2
    v_lshl_add_u32 v2, v3, 3, v2
    s_mul_i32 s3, s30, 4608
    s_add_u32 s3, s3, 140288
    v_add_u32 v50, s3, v2
    s_lshl_b32 s3, s40, 3
    s_mul_i32 s33, s3, 187
    s_lshr_b32 s33, s33, 11
    s_add_u32 s33, s33, 1
    s_mul_i32 s33, s33, 11
    s_add_u32 s3, s61, s30
    s_add_u32 s3, s3, 1
    s_cmp_ge_u32 s3, s33
    s_cselect_b32 s60, 24, 16
    s_cmp_gt_u32 s3, s33
    s_cselect_b32 s60, 20, s60
    v_add_u32 v58, s60, v15
    s_mov_b32 s64, -1
    s_mov_b32 s65, -1
    s_mov_b32 s66, -1
    s_mov_b32 s67, -1
    s_mov_b32 s68, -1
    s_mov_b32 s69, -1
    s_mov_b32 s70, 0xfffff
    s_mov_b32 s71, 131072
    v_mov_b32 v108, 0
    v_mov_b32 v109, 0
    v_mov_b32 v110, 0
    v_mov_b32 v111, 0
    v_mov_b32 v112, 0
    v_mov_b32 v113, 0
    v_mov_b32 v114, 0
    v_mov_b32 v115, 0
    v_mov_b32 v116, 0
    v_mov_b32 v117, 0
    v_mov_b32 v118, 0
    v_mov_b32 v119, 0
    v_mov_b32 v120, 0
    v_mov_b32 v121, 0
    v_mov_b32 v122, 0
    v_mov_b32 v123, 0
    v_mov_b32 v124, 0
    v_mov_b32 v125, 0
    v_mov_b32 v126, 0
    v_mov_b32 v127, 0
    v_mov_b32 v128, 0
    v_mov_b32 v129, 0
    v_mov_b32 v130, 0
    v_mov_b32 v131, 0
    v_mov_b32 v132, 0
    v_mov_b32 v133, 0
    v_mov_b32 v134, 0
    v_mov_b32 v135, 0
    v_mov_b32 v136, 0
    v_mov_b32 v137, 0
    v_mov_b32 v138, 0
    v_mov_b32 v139, 0
K_P2_AUXW:
    v_lshrrev_b32 v2, 3, v1
    v_mul_u32_u24 v2, 1280, v2
    v_lshrrev_b32 v3, 2, v1
    v_and_b32 v3, 4, v3
    v_and_b32 v4, 7, v1
    v_xor_b32 v3, v3, v4
    v_lshl_add_u32 v2, v3, 4, v2
    s_lshl_b32 s33, s41, 7
    v_add_u32 v51, s33, v2
    v_lshrrev_b32 v5, 5, v1
    v_mul_u32_u24 v5, 20480, v5
    v_add_u32 v5, v5, v51
    s_lshl_b32 s52, s30, 2
    s_lshr_b32 s52, 0x7520, s52
    s_and_b32 s52, s52, 7
    s_mul_i32 s52, s52, 51200
    s_lshl_b32 s53, s30, 12
    s_add_u32 s60, s52, 0
    s_add_u32 m0, s53, 0
    s_waitcnt vmcnt(5)
    buffer_load_dwordx4 v51, s[24:27], s60 offen lds
    s_add_u32 s60, s52, 10240
    s_add_u32 m0, s53, 1024
    s_waitcnt vmcnt(5)
    buffer_load_dwordx4 v51, s[24:27], s60 offen lds
    s_add_u32 s60, s52, 25600
    s_add_u32 m0, s53, 2048
    s_waitcnt vmcnt(5)
    buffer_load_dwordx4 v51, s[24:27], s60 offen lds
    s_add_u32 s60, s52, 35840
    s_add_u32 m0, s53, 3072
    s_waitcnt vmcnt(5)
    buffer_load_dwordx4 v51, s[24:27], s60 offen lds
    s_add_u32 s60, s52, 409600
    s_add_u32 m0, s53, 20480
    s_waitcnt vmcnt(5)
    buffer_load_dwordx4 v51, s[24:27], s60 offen lds
    s_add_u32 s60, s52, 419840
    s_add_u32 m0, s53, 21504
    s_waitcnt vmcnt(5)
    buffer_load_dwordx4 v51, s[24:27], s60 offen lds
    v_mov_b32 v3, 1
    s_mov_b64 exec, 1
    ds_add_u32 v15, v3 offset:52
    s_mov_b64 exec, -1
    s_add_u32 s60, s52, 435200
    s_add_u32 m0, s53, 22528
    s_waitcnt vmcnt(5)
    buffer_load_dwordx4 v51, s[24:27], s60 offen lds
    s_add_u32 s60, s52, 445440
    s_add_u32 m0, s53, 23552
    s_waitcnt vmcnt(5)
    buffer_load_dwordx4 v51, s[24:27], s60 offen lds
    s_lshl_b32 s53, s30, 10
    s_add_u32 s60, s52, 20480
    s_add_u32 m0, s53, 16384
    s_waitcnt vmcnt(5)
    buffer_load_dwordx4 v5, s[24:27], s60 offen lds
    s_add_u32 s60, s52, 430080
    s_add_u32 m0, s53, 36864
    s_waitcnt vmcnt(5)
    buffer_load_dwordx4 v5, s[24:27], s60 offen lds
    s_cmp_eq_u32 s30, 0
    s_cbranch_scc1 K_CHA0
    s_cmp_eq_u32 s30, 1
    s_cbranch_scc1 K_CHA1
    s_cmp_eq_u32 s30, 2
    s_cbranch_scc1 K_CHA2
    s_branch K_CHA3
K_WRET_A:
    v_mov_b32 v3, 1
    s_waitcnt vmcnt(0)
    s_mov_b64 exec, 1
    ds_add_u32 v15, v3 offset:44
    s_mov_b64 exec, -1
    s_mov_b32 s3, 1048576
K_P2_GWA:
    ds_read_b32 v2, v15 offset:44
    s_sub_u32 s3, s3, 1
    s_waitcnt lgkmcnt(0)
    v_readfirstlane_b32 s33, v2
    s_nop 3
    s_cselect_b32 s33, 4, s33
    s_cmp_lt_u32 s33, 4
    s_cbranch_scc1 K_P2_GWA
    s_branch K_P2_GEMM
K_STA11:
    s_branch K_STA15
K_STB11:
    s_branch K_STB15
K_P2_HELP:
    s_setprio 3
    s_cmp_eq_u32 s30, 7
    s_cbranch_scc1 K_P2_W7
    s_cmp_eq_u32 s30, 4
    s_cbranch_scc1 K_P2_NL
    s_cmp_ge_u32 s29, 8
    s_cbranch_scc1 K_P2_NL
    s_mov_b32 s24, s8
    s_mov_b32 s25, s9
    s_mov_b32 s26, 0xc8000
    s_mov_b32 s27, 0x20000
    v_lshrrev_b32 v2, 3, v1
    v_mul_u32_u24 v2, 1280, v2
    v_lshrrev_b32 v3, 2, v1
    v_and_b32 v3, 4, v3
    v_and_b32 v4, 7, v1
    v_xor_b32 v3, v3, v4
    v_lshl_add_u32 v2, v3, 4, v2
    s_lshl_b32 s33, s41, 7
    v_add_u32 v12, s33, v2
    v_lshrrev_b32 v5, 5, v1
    v_mul_u32_u24 v5, 20480, v5
    v_add_u32 v5, v5, v12
    s_sub_u32 s61, s30, 5
    s_lshl_b32 s52, s61, 2
    s_lshr_b32 s52, 0x6431, s52
    s_and_b32 s52, s52, 7
    s_mul_i32 s52, s52, 51200
    s_lshl_b32 s53, s61, 12
    s_add_u32 s60, s52, 0
    s_add_u32 m0, s53, 40960
    s_nop 0
    buffer_load_dwordx4 v12, s[24:27], s60 offen lds
    s_add_u32 s60, s52, 10240
    s_add_u32 m0, s53, 41984
    s_nop 0
    buffer_load_dwordx4 v12, s[24:27], s60 offen lds
    s_add_u32 s60, s52, 25600
    s_add_u32 m0, s53, 43008
    s_nop 0
    buffer_load_dwordx4 v12, s[24:27], s60 offen lds
    s_branch K_PG5
.p2align 12
K_STA12:
    s_branch K_WRET_A
K_STB12:
    s_branch K_WRET_B
K_PG5:
    s_add_u32 s60, s52, 35840
    s_add_u32 m0, s53, 44032
    s_nop 0
    buffer_load_dwordx4 v12, s[24:27], s60 offen lds
    s_add_u32 s60, s52, 409600
    s_add_u32 m0, s53, 61440
    s_nop 0
    buffer_load_dwordx4 v12, s[24:27], s60 offen lds
    s_add_u32 s60, s52, 419840
    s_add_u32 m0, s53, 62464
    s_nop 0
    buffer_load_dwordx4 v12, s[24:27], s60 offen lds
    s_add_u32 s60, s52, 435200
    s_add_u32 m0, s53, 63488
    s_nop 0
    buffer_load_dwordx4 v12, s[24:27], s60 offen lds
    s_add_u32 s60, s52, 445440
    s_add_u32 m0, s53, 64512
    s_nop 0
    buffer_load_dwordx4 v12, s[24:27], s60 offen lds
    s_lshl_b32 s53, s61, 10
    s_add_u32 s60, s52, 20480
    s_add_u32 m0, s53, 57344
    s_nop 0
    buffer_load_dwordx4 v5, s[24:27], s60 offen lds
    s_add_u32 s60, s52, 430080
    s_add_u32 m0, s53, 77824
    s_nop 0
    buffer_load_dwordx4 v5, s[24:27], s60 offen lds
    s_add_u32 s61, s61, 2
    s_lshl_b32 s52, s61, 2
    s_lshr_b32 s52, 0x6431, s52
    s_and_b32 s52, s52, 7
    s_mul_i32 s52, s52, 51200
    s_lshl_b32 s53, s61, 12
    s_add_u32 s60, s52, 0
    s_add_u32 m0, s53, 40960
    s_nop 0
    buffer_load_dwordx4 v12, s[24:27], s60 offen lds
    s_add_u32 s60, s52, 10240
    s_add_u32 m0, s53, 41984
    s_nop 0
    buffer_load_dwordx4 v12, s[24:27], s60 offen lds
    s_add_u32 s60, s52, 25600
    s_add_u32 m0, s53, 43008
    s_nop 0
    buffer_load_dwordx4 v12, s[24:27], s60 offen lds
    s_add_u32 s60, s52, 35840
    s_add_u32 m0, s53, 44032
    s_nop 0
    buffer_load_dwordx4 v12, s[24:27], s60 offen lds
    s_add_u32 s60, s52, 409600
    s_add_u32 m0, s53, 61440
    s_nop 0
    buffer_load_dwordx4 v12, s[24:27], s60 offen lds
    s_add_u32 s60, s52, 419840
    s_add_u32 m0, s53, 62464
    s_nop 0
    buffer_load_dwordx4 v12, s[24:27], s60 offen lds
    s_add_u32 s60, s52, 435200
    s_add_u32 m0, s53, 63488
    s_nop 0
    buffer_load_dwordx4 v12, s[24:27], s60 offen lds
    s_add_u32 s60, s52, 445440
    s_add_u32 m0, s53, 64512
    s_nop 0
    buffer_load_dwordx4 v12, s[24:27], s60 offen lds
    s_lshl_b32 s53, s61, 10
    s_add_u32 s60, s52, 20480
    s_add_u32 m0, s53, 57344
    s_nop 0
    buffer_load_dwordx4 v5, s[24:27], s60 offen lds
    s_add_u32 s60, s52, 430080
    s_add_u32 m0, s53, 77824
    s_nop 0
    buffer_load_dwordx4 v5, s[24:27], s60 offen lds
    v_mov_b32 v2, 158720
    v_mov_b32 v3, 1
    s_waitcnt vmcnt(0)
    s_mov_b64 exec, 1
    ds_add_u32 v2, v3 offset:56
    s_mov_b64 exec, -1
K_P2_NL:
    s_lshl_b32 s62, s40, 7
    v_lshrrev_b32 v8, 3, v1
    v_lshrrev_b32 v9, 4, v1
    v_mov_b32 v15, 158720
    s_lshl_b32 s61, s40, 3
    s_add_u32 s61, s61, s30
    s_mul_i32 s3, s61, 20480
    s_lshl_b32 s33, s41, 7
    s_add_u32 s3, s3, s33
    v_and_b32 v2, 7, v1
    v_lshlrev_b32 v2, 4, v2
    v_mul_u32_u24 v4, 1280, v8
    v_add3_u32 v10, v2, v4, s3
    s_lshl_b32 s3, s30, 7
    s_add_u32 s3, s3, 159744
    v_lshl_add_u32 v11, v8, 3, s3
    s_mov_b32 s63, 10240
    s_add_u32 s20, s6, 0x100000
    s_addc_u32 s21, s7, 0
    s_mov_b32 s22, 0x280000
    s_mov_b32 s23, 0x20000
    s_mov_b32 s56, s10
    s_mov_b32 s57, s11
    s_mov_b32 s58, 0x280000
    s_mov_b32 s59, 0x20000
    v_mul_u32_u24 v3, 144, v8
    v_add_u32 v3, v2, v3
    s_mul_i32 s3, s30, 2304
    s_add_u32 s3, s3, 140288
    v_add_u32 v14, s3, v3
    s_add_u32 s44, s6, 0x10000
    s_addc_u32 s45, s7, 0
    s_mov_b32 s46, 0x43800
    s_mov_b32 s47, 0x20000
    v_mov_b32 v108, 1
    buffer_load_dwordx4 v[16:19], v10, s[12:15], 0 offen
    buffer_load_dwordx4 v[20:23], v10, s[12:15], s63 offen
    s_cmp_lg_u32 s30, 6
    s_cbranch_scc1 K_P2_HW
    s_mov_b32 s3, 131072
    s_waitcnt vmcnt(2)
K_P2_DPOLL:
    v_min_u32 v2, v7, v6
    v_cmp_eq_u32 vcc, 0, v2
    s_cbranch_vccz K_P2_DOK
    s_cmp_eq_u32 s3, 131072
    s_cbranch_scc1 K_P2_DNS
    s_sleep 12
K_P2_DNS:
    v_lshl_add_u32 v13, v1, 2, s42
    global_load_dword v7, v13, s[6:7] offset:256 sc1
    v_and_b32 v13, 0xfffffe04, v13
    global_load_dword v6, v13, s[6:7] offset:128 sc1
    s_sub_u32 s3, s3, 1
    s_waitcnt vmcnt(0)
    s_cmp_lg_u32 s3, 0
    s_cbranch_scc1 K_P2_DPOLL
K_P2_DOK:
    v_readlane_b32 s52, v6, 0
    v_readlane_b32 s53, v6, 1
    s_nop 1
    s_and_b32 s3, s52, 0x7ff
    s_sub_u32 s3, 2047, s3
    v_mov_b32 v48, s3
    v_mov_b32 v4, s52
    v_and_b32 v4, 0xffff0000, v4
    v_ashrrev_i32 v5, 31, v4
    v_not_b32 v5, v5
    v_or_b32 v5, 0x80000000, v5
    v_xor_b32 v4, v4, v5
    v_and_b32 v4, 0xffff0000, v4
    v_mul_f32 v5, 0xbfb8aa3b, v4
    v_exp_f32 v5, v5
    s_nop 0
    v_add_f32 v5, 1.0, v5
    v_rcp_f32 v4, v5
    s_nop 0
    v_cvt_pk_bf16_f32 v50, v4, v4
    v_lshlrev_b32 v50, 16, v50
    s_and_b32 s3, s53, 0x7ff
    s_sub_u32 s3, 2047, s3
    v_mov_b32 v49, s3
    v_mov_b32 v4, s53
    v_and_b32 v4, 0xffff0000, v4
    v_ashrrev_i32 v5, 31, v4
    v_not_b32 v5, v5
    v_or_b32 v5, 0x80000000, v5
    v_xor_b32 v4, v4, v5
    v_and_b32 v4, 0xffff0000, v4
    v_mul_f32 v5, 0xbfb8aa3b, v4
    v_exp_f32 v5, v5
    s_nop 0
    v_add_f32 v5, 1.0, v5
    v_rcp_f32 v4, v5
    s_nop 0
    v_cvt_pk_bf16_f32 v51, v4, v4
    v_lshlrev_b32 v51, 16, v51
    ds_write_b128 v15, v[48:51]
    ds_write_b32 v15, v108 offset:40
    v_lshl_add_u32 v13, v1, 4, v15
    v_lshlrev_b32 v52, 16, v7
    v_and_b32 v52, 0x7fff0000, v52
    v_and_b32 v54, 0x7fff0000, v7
    v_sub_f32 v53, 1.0, v52
    v_cvt_pk_bf16_f32 v53, v53, v53
    v_lshlrev_b32 v53, 16, v53
    v_sub_f32 v55, 1.0, v54
    v_cvt_pk_bf16_f32 v55, v55, v55
    v_lshlrev_b32 v55, 16, v55
    ds_write_b128 v13, v[52:55] offset:1024
    s_branch K_P2_E
K_STA13:
    s_branch K_WRET_A
K_STB13:
    s_branch K_WRET_B
K_P2_HW:
    s_mov_b32 s3, 1048576
K_P2_GS2:
    ds_read_b32 v2, v15 offset:40
    s_sleep 1
    s_sub_u32 s3, s3, 1
    s_waitcnt lgkmcnt(0)
    v_readfirstlane_b32 s33, v2
    s_nop 3
    s_cselect_b32 s33, 1, s33
    s_cmp_lt_u32 s33, 1
    s_cbranch_scc1 K_P2_GS2
    ds_read_b128 v[28:31], v15
    s_waitcnt lgkmcnt(0)
    s_cmp_eq_u32 s30, 4
    s_cselect_b64 vcc, -1, 0
    s_nop 1
    v_cndmask_b32 v2, v29, v28, vcc
    v_cndmask_b32 v5, v31, v30, vcc
    s_nop 0
    v_readfirstlane_b32 s52, v2
    s_nop 3
    s_sub_u32 s3, s52, s62
    s_cmp_lt_u32 s3, 128
    s_cbranch_scc0 K_P2_E
    s_mov_b32 s3, 131072
K_P2_YPOLL:
    s_load_dword s33, s[6:7], s42 offset:136 glc
    s_waitcnt lgkmcnt(0)
    s_cmp_lg_u32 s33, 0
    s_cbranch_scc1 K_P2_YGO
    s_sleep 4
    s_sub_u32 s3, s3, 1
    s_cbranch_scc0 K_P2_YPOLL
K_P2_YGO:
    v_and_b32 v2, 15, v1
    v_lshlrev_b32 v2, 4, v2
    v_mul_u32_u24 v4, 5120, v9
    s_sub_u32 s53, s30, 4
    s_mul_i32 s33, s53, 2560
    s_lshl_b32 s3, s41, 8
    s_add_u32 s3, s3, s33
    v_add3_u32 v3, v2, v4, s3
    s_mov_b32 s60, 0
    buffer_load_dwordx4 v[52:55], v3, s[44:47], s60 offen sc1
    s_mov_b32 s60, 20480
    buffer_load_dwordx4 v[56:59], v3, s[44:47], s60 offen sc1
    s_mov_b32 s60, 40960
    buffer_load_dwordx4 v[60:63], v3, s[44:47], s60 offen sc1
    s_mov_b32 s60, 61440
    buffer_load_dwordx4 v[64:67], v3, s[44:47], s60 offen sc1
    s_mov_b32 s60, 81920
    buffer_load_dwordx4 v[68:71], v3, s[44:47], s60 offen sc1
    s_mov_b32 s60, 102400
    buffer_load_dwordx4 v[72:75], v3, s[44:47], s60 offen sc1
    s_mov_b32 s60, 122880
    buffer_load_dwordx4 v[76:79], v3, s[44:47], s60 offen sc1
    s_mov_b32 s60, 143360
    buffer_load_dwordx4 v[80:83], v3, s[44:47], s60 offen sc1
    s_mov_b32 s60, 163840
    buffer_load_dwordx4 v[84:87], v3, s[44:47], s60 offen sc1
    s_mov_b32 s60, 184320
    buffer_load_dwordx4 v[88:91], v3, s[44:47], s60 offen sc1
    s_mov_b32 s60, 204800
    buffer_load_dwordx4 v[92:95], v3, s[44:47], s60 offen sc1
    s_mov_b32 s60, 225280
    buffer_load_dwordx4 v[96:99], v3, s[44:47], s60 offen sc1
    s_mov_b32 s60, 245760
    buffer_load_dwordx4 v[100:103], v3, s[44:47], s60 offen sc1
    s_mov_b32 s60, 266240
    buffer_load_dwordx4 v[104:107], v3, s[44:47], s60 offen sc1
    s_waitcnt vmcnt(12)
    v_add_f32 v48, v52, v56
    v_add_f32 v49, v53, v57
    v_add_f32 v50, v54, v58
    v_add_f32 v51, v55, v59
    s_waitcnt vmcnt(11)
    v_add_f32 v48, v48, v60
    v_add_f32 v49, v49, v61
    v_add_f32 v50, v50, v62
    v_add_f32 v51, v51, v63
    s_waitcnt vmcnt(10)
    v_add_f32 v48, v48, v64
    v_add_f32 v49, v49, v65
    v_add_f32 v50, v50, v66
    v_add_f32 v51, v51, v67
    s_waitcnt vmcnt(9)
    v_add_f32 v48, v48, v68
    v_add_f32 v49, v49, v69
    v_add_f32 v50, v50, v70
    v_add_f32 v51, v51, v71
    s_waitcnt vmcnt(8)
    v_add_f32 v48, v48, v72
    v_add_f32 v49, v49, v73
    v_add_f32 v50, v50, v74
    v_add_f32 v51, v51, v75
    s_waitcnt vmcnt(7)
    v_add_f32 v48, v48, v76
    v_add_f32 v49, v49, v77
    v_add_f32 v50, v50, v78
    v_add_f32 v51, v51, v79
    s_waitcnt vmcnt(6)
    v_add_f32 v48, v48, v80
    v_add_f32 v49, v49, v81
    v_add_f32 v50, v50, v82
    v_add_f32 v51, v51, v83
    s_waitcnt vmcnt(5)
    v_add_f32 v48, v48, v84
    v_add_f32 v49, v49, v85
    v_add_f32 v50, v50, v86
    v_add_f32 v51, v51, v87
    s_waitcnt vmcnt(4)
    v_add_f32 v48, v48, v88
    v_add_f32 v49, v49, v89
    v_add_f32 v50, v50, v90
    v_add_f32 v51, v51, v91
    s_waitcnt vmcnt(3)
    v_add_f32 v48, v48, v92
    v_add_f32 v49, v49, v93
    v_add_f32 v50, v50, v94
    v_add_f32 v51, v51, v95
    s_waitcnt vmcnt(2)
    v_add_f32 v48, v48, v96
    v_add_f32 v49, v49, v97
    v_add_f32 v50, v50, v98
    v_add_f32 v51, v51, v99
    s_waitcnt vmcnt(1)
    v_add_f32 v48, v48, v100
    v_add_f32 v49, v49, v101
    v_add_f32 v50, v50, v102
    v_add_f32 v51, v51, v103
    s_waitcnt vmcnt(0)
    v_add_f32 v48, v48, v104
    v_add_f32 v49, v49, v105
    v_add_f32 v50, v50, v106
    v_add_f32 v51, v51, v107
    v_mov_b32 v52, v48
    v_mov_b32 v53, v49
    v_mov_b32 v54, v50
    v_mov_b32 v55, v51
    s_nop 0
    v_permlane16_swap_b32 v48, v52
    v_permlane16_swap_b32 v49, v53
    v_permlane16_swap_b32 v50, v54
    v_permlane16_swap_b32 v51, v55
    v_add_f32 v48, v48, v52
    v_add_f32 v49, v49, v53
    v_add_f32 v50, v50, v54
    v_add_f32 v51, v51, v55
    v_mov_b32 v52, v48
    v_mov_b32 v53, v49
    v_mov_b32 v54, v50
    v_mov_b32 v55, v51
    s_nop 0
    v_permlane32_swap_b32 v48, v52
    v_permlane32_swap_b32 v49, v53
    v_permlane32_swap_b32 v50, v54
    v_permlane32_swap_b32 v51, v55
    v_add_f32 v48, v48, v52
    v_add_f32 v49, v49, v53
    v_add_f32 v50, v50, v54
    v_add_f32 v51, v51, v55
    v_cvt_pk_bf16_f32 v48, v48, v48
    v_lshlrev_b32 v48, 16, v48
    v_mul_f32 v48, v5, v48
    v_cvt_pk_bf16_f32 v48, v48, v48
    v_lshlrev_b32 v48, 16, v48
    v_cvt_pk_bf16_f32 v49, v49, v49
    v_lshlrev_b32 v49, 16, v49
    v_mul_f32 v49, v5, v49
    v_cvt_pk_bf16_f32 v49, v49, v49
    v_lshlrev_b32 v49, 16, v49
    v_cvt_pk_bf16_f32 v50, v50, v50
    v_lshlrev_b32 v50, 16, v50
    v_mul_f32 v50, v5, v50
    v_cvt_pk_bf16_f32 v50, v50, v50
    v_lshlrev_b32 v50, 16, v50
    v_cvt_pk_bf16_f32 v51, v51, v51
    v_lshlrev_b32 v51, 16, v51
    v_mul_f32 v51, v5, v51
    v_cvt_pk_bf16_f32 v51, v51, v51
    v_lshlrev_b32 v51, 16, v51
    s_lshl_b32 s3, s53, 8
    s_add_u32 s3, s3, 158976
    v_add_u32 v2, s3, v2
    ds_write_b128 v2, v[48:51]
    s_branch K_P2_E
K_STA14:
    s_branch K_WRET_A
K_STB14:
    s_branch K_WRET_B
K_P2_W7:
    s_mov_b32 s37, s42
    s_waitcnt lgkmcnt(0)
    s_load_dwordx2 s[48:49], s[6:7], s37 glc
    s_mul_i32 s52, s40, 1496
    s_add_u32 s53, s52, 1309
    s_lshr_b32 s52, s52, 11
    s_lshr_b32 s53, s53, 11
    s_sub_u32 s53, s53, s52
    s_mov_b32 s46, 0x84210
    s_mov_b32 s47, s46
    v_mov_b32 v15, 158720
    v_mov_b32 v5, 0
    v_mov_b32 v48, 0x80000000
    s_mov_b64 exec, 1
    ds_or_b32 v15, v48 offset:16
    ds_or_b32 v15, v48 offset:20
    ds_or_b32 v15, v48 offset:24
    s_waitcnt lgkmcnt(0)
    s_cmp_eq_u32 s53, 0
    s_cselect_b32 s49, s48, s49
    s_lshl_b64 s[50:51], s[48:49], 1
    s_and_b64 s[50:51], s[50:51], s[48:49]
    s_lshl_b64 vcc, s[50:51], 2
    s_and_b64 s[50:51], s[50:51], vcc
    s_lshl_b64 s[50:51], s[50:51], 1
    s_and_b64 s[50:51], s[50:51], s[46:47]
    s_or_b64 s[48:49], s[48:49], s[50:51]
    v_readfirstlane_b32 s52, v5
    s_cmp_ge_u32 s52, 2
    s_cselect_b32 s52, -1, 0x3ff
    s_and_b32 s48, s48, s52
    s_and_b32 s49, s49, s52
    s_and_b32 s52, s48, s49
    v_mov_b32 v48, s48
    v_mov_b32 v49, s49
    v_mov_b32 v50, s52
    s_mov_b64 exec, 1
    ds_or_b64 v15, v[48:49] offset:16
    ds_or_b32 v15, v50 offset:24
    s_mov_b64 exec, -1
    s_load_dwordx2 s[48:49], s[6:7], s37 glc
    s_lshl_b32 s62, s40, 7
    v_lshrrev_b32 v8, 3, v1
    v_lshrrev_b32 v9, 4, v1
    v_mov_b32 v15, 158720
    s_lshl_b32 s61, s40, 3
    s_add_u32 s61, s61, s30
    s_mul_i32 s3, s61, 20480
    s_lshl_b32 s33, s41, 7
    s_add_u32 s3, s3, s33
    v_and_b32 v2, 7, v1
    v_lshlrev_b32 v2, 4, v2
    v_mul_u32_u24 v4, 1280, v8
    v_add3_u32 v10, v2, v4, s3
    s_lshl_b32 s3, s30, 7
    s_add_u32 s3, s3, 159744
    v_lshl_add_u32 v11, v8, 3, s3
    s_mov_b32 s63, 10240
    s_add_u32 s20, s6, 0x100000
    s_addc_u32 s21, s7, 0
    s_mov_b32 s22, 0x280000
    s_mov_b32 s23, 0x20000
    s_mov_b32 s56, s10
    s_mov_b32 s57, s11
    s_mov_b32 s58, 0x280000
    s_mov_b32 s59, 0x20000
    v_mul_u32_u24 v3, 144, v8
    v_add_u32 v3, v2, v3
    s_mul_i32 s3, s30, 2304
    s_add_u32 s3, s3, 140288
    v_add_u32 v14, s3, v3
    buffer_load_dwordx4 v[16:19], v10, s[12:15], 0 offen
    buffer_load_dwordx4 v[20:23], v10, s[12:15], s63 offen
    s_mov_b32 s3, 131072
    s_waitcnt lgkmcnt(0)
K_P2_FCHK:
    s_cmp_eq_u32 s53, 0
    s_cselect_b32 s49, s48, s49
    s_lshl_b64 s[50:51], s[48:49], 1
    s_and_b64 s[50:51], s[50:51], s[48:49]
    s_lshl_b64 vcc, s[50:51], 2
    s_and_b64 s[50:51], s[50:51], vcc
    s_lshl_b64 s[50:51], s[50:51], 1
    s_and_b64 s[50:51], s[50:51], s[46:47]
    s_or_b64 s[48:49], s[48:49], s[50:51]
    v_readfirstlane_b32 s52, v5
    s_cmp_ge_u32 s52, 2
    s_cselect_b32 s52, -1, 0x3ff
    s_and_b32 s48, s48, s52
    s_and_b32 s49, s49, s52
    s_and_b32 s52, s48, s49
    v_mov_b32 v48, s48
    v_mov_b32 v49, s49
    v_mov_b32 v50, s52
    s_mov_b64 exec, 1
    ds_or_b64 v15, v[48:49] offset:16
    ds_or_b32 v15, v50 offset:24
    s_mov_b64 exec, -1
    s_cmp_eq_u32 s52, 0xfffff
    s_cbranch_scc1 K_P2_FGO
    s_cmp_lg_u64 s[48:49], 0
    s_cbranch_scc1 K_P2_FS
    s_sleep 8
K_P2_FS:
    s_sleep 2
    s_load_dwordx2 s[48:49], s[6:7], s37 glc
    ds_read_b32 v5, v15 offset:56
    s_sub_u32 s3, s3, 1
    s_waitcnt lgkmcnt(0)
    s_cbranch_scc0 K_P2_FCHK
    v_mov_b32 v48, -1
    v_mov_b32 v49, -1
    v_mov_b32 v50, -1
    ds_write_b96 v15, v[48:50] offset:16
K_P2_FGO:
K_P2_E:
    s_setprio 0
    s_waitcnt vmcnt(0)
    v_lshlrev_b32 v32, 16, v16
    v_and_b32 v33, 0xffff0000, v16
    v_lshlrev_b32 v34, 16, v17
    v_and_b32 v35, 0xffff0000, v17
    v_lshlrev_b32 v36, 16, v18
    v_and_b32 v37, 0xffff0000, v18
    v_lshlrev_b32 v38, 16, v19
    v_and_b32 v39, 0xffff0000, v19
    v_lshlrev_b32 v40, 16, v20
    v_and_b32 v41, 0xffff0000, v20
    v_lshlrev_b32 v42, 16, v21
    v_and_b32 v43, 0xffff0000, v21
    v_lshlrev_b32 v44, 16, v22
    v_and_b32 v45, 0xffff0000, v22
    v_lshlrev_b32 v46, 16, v23
    v_and_b32 v47, 0xffff0000, v23
    s_branch K_P2_E2
K_STA15:
    s_branch K_WRET_A
K_STB15:
    s_branch K_WRET_B
K_SPN:
    s_mov_b32 s64, -1
    s_mov_b32 s65, -1
    s_mov_b32 s66, -1
    s_mov_b32 s67, -1
    s_mov_b32 s68, -1
    s_mov_b32 s69, -1
K_SPL:
    ds_read_b32 v59, v58
    s_waitcnt lgkmcnt(0)
    v_readfirstlane_b32 s50, v59
    s_and_b32 s33, s50, s70
    s_cbranch_scc1 K_BK0
    s_cmp_lt_i32 s50, 0
    s_cbranch_scc0 K_SPG
    s_sleep 1
    s_branch K_SPL
K_SPG:
    s_load_dwordx2 s[48:49], s[6:7], s42 glc
    ds_read_b32 v5, v15 offset:56
    s_waitcnt lgkmcnt(0)
    s_cmp_eq_u32 s53, 0
    s_cselect_b32 s49, s48, s49
    s_lshl_b64 s[50:51], s[48:49], 1
    s_and_b64 s[50:51], s[50:51], s[48:49]
    s_lshl_b64 vcc, s[50:51], 2
    s_and_b64 s[50:51], s[50:51], vcc
    s_lshl_b64 s[50:51], s[50:51], 1
    s_and_b64 s[50:51], s[50:51], s[46:47]
    s_or_b64 s[48:49], s[48:49], s[50:51]
    v_readfirstlane_b32 s52, v5
    s_cmp_ge_u32 s52, 2
    s_cselect_b32 s52, -1, 0x3ff
    s_and_b32 s48, s48, s52
    s_and_b32 s49, s49, s52
    s_and_b32 s52, s48, s49
    v_mov_b32 v188, s48
    v_mov_b32 v189, s49
    v_mov_b32 v190, s52
    s_mov_b64 exec, 1
    ds_or_b64 v15, v[188:189] offset:16
    ds_or_b32 v15, v190 offset:24
    s_mov_b64 exec, -1
    ds_read_b32 v59, v58
    s_waitcnt lgkmcnt(0)
    v_readfirstlane_b32 s50, v59
    s_and_b32 s33, s50, s70
    s_cbranch_scc1 K_BK0
    s_sleep 2
    ds_read_b32 v59, v58
    s_waitcnt lgkmcnt(0)
    v_readfirstlane_b32 s50, v59
    s_and_b32 s33, s50, s70
    s_cbranch_scc1 K_BK0
    s_sleep 2
    ds_read_b32 v59, v58
    s_waitcnt lgkmcnt(0)
    v_readfirstlane_b32 s50, v59
    s_and_b32 s33, s50, s70
    s_cbranch_scc1 K_BK0
    s_sleep 2
    ds_read_b32 v59, v58
    s_waitcnt lgkmcnt(0)
    v_readfirstlane_b32 s50, v59
    s_and_b32 s33, s50, s70
    s_cbranch_scc1 K_BK0
    s_branch K_SPL
K_CHEND:
K_AUX:
    s_cmp_ge_u32 s30, 4
    s_cbranch_scc1 K_AUX_L
    s_and_b32 s3, s2, 7
    s_lshr_b32 s70, s2, 3
    s_lshl3_add_u32 s3, s3, s70
    s_lshl_b32 s3, s3, 5
    s_lshl3_add_u32 s3, s30, s3
    v_bfe_u32 v8, v0, 4, 2
    v_add_u32 v8, s3, v8
    v_and_b32 v10, 15, v0
    v_lshlrev_b32 v10, 4, v10
    v_mul_u32_u24 v9, 1280, v8
    v_add_u32 v9, v9, v10
    v_and_b32 v2, 63, v0
    v_lshlrev_b32 v2, 4, v2
    s_lshl_b32 s71, s30, 12
    s_add_u32 s71, s71, 126016
    s_mov_b32 s70, 5120
    s_mov_b32 m0, s71
    s_waitcnt lgkmcnt(0)
    s_mov_b32 s16, s44
    s_mov_b32 s17, s45
    s_mov_b32 s18, 0x500
    s_mov_b32 s19, 0x20000
    s_mov_b32 s20, s52
    s_mov_b32 s21, s53
    s_mov_b32 s22, 0x500
    s_mov_b32 s23, 0x20000
    buffer_load_dwordx4 v2, s[16:19], 0 offen lds
    buffer_load_dwordx4 v2, s[16:19], 0 offen offset:1024 lds
    s_add_u32 m0, s71, 2048
    v_add_u32 v10, s71, v10
    buffer_load_dwordx4 v2, s[20:23], 0 offen lds
    buffer_load_dwordx4 v2, s[20:23], 0 offen offset:1024 lds
    buffer_load_dwordx4 v[16:19], v9, s[12:15], 0 offen offset:0
    buffer_load_dwordx4 v[20:23], v9, s[12:15], s70 offen offset:0
    buffer_load_dwordx4 v[24:27], v9, s[12:15], 0 offen offset:256
    buffer_load_dwordx4 v[28:31], v9, s[12:15], s70 offen offset:256
    buffer_load_dwordx4 v[32:35], v9, s[12:15], 0 offen offset:512
    buffer_load_dwordx4 v[36:39], v9, s[12:15], s70 offen offset:512
    buffer_load_dwordx4 v[40:43], v9, s[12:15], 0 offen offset:768
    buffer_load_dwordx4 v[44:47], v9, s[12:15], s70 offen offset:768
    buffer_load_dwordx4 v[48:51], v9, s[12:15], 0 offen offset:1024
    buffer_load_dwordx4 v[52:55], v9, s[12:15], s70 offen offset:1024
    s_barrier
    v_and_b32 v1, 63, v0
    v_mov_b32 v7, 0
    s_and_b32 s28, s2, 7
    s_lshr_b32 s29, s2, 3
    s_xor_b32 s30, s30, 4
    s_lshr_b32 s34, s29, 3
    s_lshl_b32 s34, s34, 2
    s_and_b32 s3, s29, 3
    s_add_u32 s34, s34, s3
    s_add_u32 s34, s34, 4
    s_bitcmp1_b32 s29, 2
    s_cselect_b32 s34, -1, s34
    s_cmp_lt_u32 s29, 8
    s_cselect_b32 s34, s29, s34
    s_lshl_b32 s40, s28, 1
    s_cmp_ge_u32 s34, 10
    s_addc_u32 s40, s40, 0
    s_sub_u32 s41, s34, 10
    s_cmp_ge_u32 s34, 10
    s_cselect_b32 s41, s41, s34
    s_mul_i32 s42, s28, 20
    s_add_u32 s42, s42, s34
    s_and_b32 s42, s42, 255
    s_lshl_b32 s42, s42, 9
    s_add_u32 s42, s42, 524288
    s_mul_i32 s43, s28, 7
    s_add_u32 s43, s43, s29
    s_sub_u32 s43, s43, 1
    s_cmp_lt_u32 s43, 54
    s_cselect_b32 s43, s43, 63
    s_cmp_eq_u32 s29, 0
    s_cselect_b32 s43, 63, s43
    s_mov_b32 s24, s8
    s_mov_b32 s25, s9
    s_mov_b32 s26, 0xc8000
    s_mov_b32 s27, 0x20000
    s_add_u32 s64, s6, 0x80000
    s_addc_u32 s65, s7, 0
    s_mov_b32 s66, 0x14400
    s_mov_b32 s67, 0x20000
    s_add_u32 s60, s6, 0x10000
    s_addc_u32 s61, s7, 0
    s_mov_b32 s62, 0x43800
    s_mov_b32 s63, 0x20000
    v_mov_b32 v96, 0
    v_mov_b32 v97, 0
    v_mov_b32 v98, 0
    v_mov_b32 v99, 0
    v_mov_b32 v13, 158720
    s_waitcnt vmcnt(10)
    ds_read_b128 v[56:59], v10 offset:0
    ds_read_b128 v[76:79], v10 offset:2048
    ds_read_b128 v[60:63], v10 offset:256
    ds_read_b128 v[80:83], v10 offset:2304
    ds_read_b128 v[64:67], v10 offset:512
    ds_read_b128 v[84:87], v10 offset:2560
    ds_read_b128 v[68:71], v10 offset:768
    ds_read_b128 v[88:91], v10 offset:2816
    ds_read_b128 v[72:75], v10 offset:1024
    ds_read_b128 v[92:95], v10 offset:3072
    s_waitcnt vmcnt(8) lgkmcnt(8)
    v_dot2c_f32_bf16 v96, v16, v56
    v_dot2c_f32_bf16 v98, v16, v76
    v_dot2c_f32_bf16 v97, v20, v56
    v_dot2c_f32_bf16 v99, v20, v76
    v_dot2c_f32_bf16 v96, v17, v57
    v_dot2c_f32_bf16 v98, v17, v77
    v_dot2c_f32_bf16 v97, v21, v57
    v_dot2c_f32_bf16 v99, v21, v77
    v_dot2c_f32_bf16 v96, v18, v58
    v_dot2c_f32_bf16 v98, v18, v78
    v_dot2c_f32_bf16 v97, v22, v58
    v_dot2c_f32_bf16 v99, v22, v78
    v_dot2c_f32_bf16 v96, v19, v59
    v_dot2c_f32_bf16 v98, v19, v79
    v_dot2c_f32_bf16 v97, v23, v59
    v_dot2c_f32_bf16 v99, v23, v79
    s_waitcnt vmcnt(6) lgkmcnt(6)
    v_dot2c_f32_bf16 v96, v24, v60
    v_dot2c_f32_bf16 v98, v24, v80
    v_dot2c_f32_bf16 v97, v28, v60
    v_dot2c_f32_bf16 v99, v28, v80
    v_dot2c_f32_bf16 v96, v25, v61
    v_dot2c_f32_bf16 v98, v25, v81
    v_dot2c_f32_bf16 v97, v29, v61
    v_dot2c_f32_bf16 v99, v29, v81
    v_dot2c_f32_bf16 v96, v26, v62
    v_dot2c_f32_bf16 v98, v26, v82
    v_dot2c_f32_bf16 v97, v30, v62
    v_dot2c_f32_bf16 v99, v30, v82
    v_dot2c_f32_bf16 v96, v27, v63
    v_dot2c_f32_bf16 v98, v27, v83
    v_dot2c_f32_bf16 v97, v31, v63
    v_dot2c_f32_bf16 v99, v31, v83
    s_waitcnt vmcnt(4) lgkmcnt(4)
    v_dot2c_f32_bf16 v96, v32, v64
    v_dot2c_f32_bf16 v98, v32, v84
    v_dot2c_f32_bf16 v97, v36, v64
    v_dot2c_f32_bf16 v99, v36, v84
    v_dot2c_f32_bf16 v96, v33, v65
    v_dot2c_f32_bf16 v98, v33, v85
    v_dot2c_f32_bf16 v97, v37, v65
    v_dot2c_f32_bf16 v99, v37, v85
    v_dot2c_f32_bf16 v96, v34, v66
    v_dot2c_f32_bf16 v98, v34, v86
    v_dot2c_f32_bf16 v97, v38, v66
    v_dot2c_f32_bf16 v99, v38, v86
    v_dot2c_f32_bf16 v96, v35, v67
    v_dot2c_f32_bf16 v98, v35, v87
    v_dot2c_f32_bf16 v97, v39, v67
    v_dot2c_f32_bf16 v99, v39, v87
    s_waitcnt vmcnt(2) lgkmcnt(2)
    v_dot2c_f32_bf16 v96, v40, v68
    v_dot2c_f32_bf16 v98, v40, v88
    v_dot2c_f32_bf16 v97, v44, v68
    v_dot2c_f32_bf16 v99, v44, v88
    v_dot2c_f32_bf16 v96, v41, v69
    v_dot2c_f32_bf16 v98, v41, v89
    v_dot2c_f32_bf16 v97, v45, v69
    v_dot2c_f32_bf16 v99, v45, v89
    v_dot2c_f32_bf16 v96, v42, v70
    v_dot2c_f32_bf16 v98, v42, v90
    v_dot2c_f32_bf16 v97, v46, v70
    v_dot2c_f32_bf16 v99, v46, v90
    v_dot2c_f32_bf16 v96, v43, v71
    v_dot2c_f32_bf16 v98, v43, v91
    v_dot2c_f32_bf16 v97, v47, v71
    v_dot2c_f32_bf16 v99, v47, v91
    s_waitcnt vmcnt(0) lgkmcnt(0)
    v_dot2c_f32_bf16 v96, v48, v72
    v_dot2c_f32_bf16 v98, v48, v92
    v_dot2c_f32_bf16 v97, v52, v72
    v_dot2c_f32_bf16 v99, v52, v92
    v_dot2c_f32_bf16 v96, v49, v73
    v_dot2c_f32_bf16 v98, v49, v93
    v_dot2c_f32_bf16 v97, v53, v73
    v_dot2c_f32_bf16 v99, v53, v93
    v_dot2c_f32_bf16 v96, v50, v74
    v_dot2c_f32_bf16 v98, v50, v94
    v_dot2c_f32_bf16 v97, v54, v74
    v_dot2c_f32_bf16 v99, v54, v94
    v_dot2c_f32_bf16 v96, v51, v75
    v_dot2c_f32_bf16 v98, v51, v95
    v_dot2c_f32_bf16 v97, v55, v75
    v_dot2c_f32_bf16 v99, v55, v95
    s_nop 2
    v_add_f32_dpp v96, v96, v96 quad_perm:[1,0,3,2] row_mask:0xf bank_mask:0xf
    v_add_f32_dpp v97, v97, v97 quad_perm:[1,0,3,2] row_mask:0xf bank_mask:0xf
    v_add_f32_dpp v98, v98, v98 quad_perm:[1,0,3,2] row_mask:0xf bank_mask:0xf
    s_branch K_PG6
.p2align 12
K_PG6:
    v_add_f32_dpp v99, v99, v99 quad_perm:[1,0,3,2] row_mask:0xf bank_mask:0xf
    v_add_f32_dpp v96, v96, v96 quad_perm:[2,3,0,1] row_mask:0xf bank_mask:0xf
    v_add_f32_dpp v97, v97, v97 quad_perm:[2,3,0,1] row_mask:0xf bank_mask:0xf
    v_add_f32_dpp v98, v98, v98 quad_perm:[2,3,0,1] row_mask:0xf bank_mask:0xf
    v_add_f32_dpp v99, v99, v99 quad_perm:[2,3,0,1] row_mask:0xf bank_mask:0xf
    v_add_f32_dpp v96, v96, v96 row_half_mirror row_mask:0xf bank_mask:0xf
    v_add_f32_dpp v97, v97, v97 row_half_mirror row_mask:0xf bank_mask:0xf
    v_add_f32_dpp v98, v98, v98 row_half_mirror row_mask:0xf bank_mask:0xf
    v_add_f32_dpp v99, v99, v99 row_half_mirror row_mask:0xf bank_mask:0xf
    v_add_f32_dpp v96, v96, v96 row_mirror row_mask:0xf bank_mask:0xf
    v_add_f32_dpp v97, v97, v97 row_mirror row_mask:0xf bank_mask:0xf
    v_add_f32_dpp v98, v98, v98 row_mirror row_mask:0xf bank_mask:0xf
    v_add_f32_dpp v99, v99, v99 row_mirror row_mask:0xf bank_mask:0xf
    v_and_b32 v4, 31, v8
    v_lshlrev_b32 v11, 2, v4
    v_add_u32 v11, 122880, v11
    v_lshlrev_b32 v12, 1, v4
    v_add_u32 v12, 123008, v12
    v_cvt_pk_bf16_f32 v2, v96, v96
    v_lshlrev_b32 v2, 16, v2
    v_ashrrev_i32 v3, 31, v2
    v_or_b32 v3, 0x80000000, v3
    v_xor_b32 v2, v2, v3
    v_and_b32 v2, 0xffff0000, v2
    v_sub_u32 v3, 0x87ff, v8
    v_or_b32 v96, v2, v3
    ds_write_b32 v11, v96 offset:0
    v_cvt_pk_bf16_f32 v98, v98, v98
    v_lshlrev_b32 v98, 16, v98
    v_mul_f32 v5, 0xbfb8aa3b, v98
    v_exp_f32 v5, v5
    s_nop 0
    v_add_f32 v5, 1.0, v5
    v_rcp_f32 v98, v5
    s_nop 0
    v_cvt_pk_bf16_f32 v98, v98, v98
    v_or_b32 v98, 0x8000, v98
    ds_write_b16 v12, v98 offset:0
    v_cvt_pk_bf16_f32 v2, v97, v97
    v_lshlrev_b32 v2, 16, v2
    v_ashrrev_i32 v3, 31, v2
    v_or_b32 v3, 0x80000000, v3
    v_xor_b32 v2, v2, v3
    v_and_b32 v2, 0xffff0000, v2
    v_sub_u32 v3, 0x87fb, v8
    v_or_b32 v97, v2, v3
    ds_write_b32 v11, v97 offset:16
    v_cvt_pk_bf16_f32 v99, v99, v99
    v_lshlrev_b32 v99, 16, v99
    v_mul_f32 v5, 0xbfb8aa3b, v99
    v_exp_f32 v5, v5
    s_nop 0
    v_add_f32 v5, 1.0, v5
    v_rcp_f32 v99, v5
    s_nop 0
    v_cvt_pk_bf16_f32 v99, v99, v99
    v_or_b32 v99, 0x8000, v99
    ds_write_b16 v12, v99 offset:8
    v_mov_b32 v3, 1
    s_mov_b64 exec, 1
    ds_add_u32 v13, v3 offset:48
    s_mov_b64 exec, -1
    s_cmp_ge_u32 s30, 6
    s_cbranch_scc1 K_AUX_G1
    s_mov_b32 s3, 1048576
K_FGR:
    ds_read_b32 v2, v13 offset:48
    s_sleep 1
    s_sub_u32 s3, s3, 1
    s_waitcnt lgkmcnt(0)
    v_readfirstlane_b32 s33, v2
    s_nop 3
    s_cselect_b32 s33, 4, s33
    s_cmp_lt_u32 s33, 4
    s_cbranch_scc1 K_FGR
    s_cmp_lg_u32 s30, 4
    s_cbranch_scc1 K_AUX_G0
    v_and_b32 v3, 31, v1
    v_lshlrev_b32 v3, 2, v3
    v_add_u32 v3, 122880, v3
    ds_read_b32 v2, v3
    s_waitcnt lgkmcnt(0)
    s_nop 1
    v_max_u32_dpp v3, v2, v2 quad_perm:[1,0,3,2] row_mask:0xf bank_mask:0xf
    s_nop 1
    v_max_u32_dpp v3, v3, v3 quad_perm:[2,3,0,1] row_mask:0xf bank_mask:0xf
    s_nop 1
    v_max_u32_dpp v3, v3, v3 row_half_mirror row_mask:0xf bank_mask:0xf
    s_nop 1
    v_max_u32_dpp v3, v3, v3 row_mirror row_mask:0xf bank_mask:0xf
    s_nop 1
    v_readlane_b32 s68, v3, 0
    v_readlane_b32 s76, v3, 16
    v_readlane_b32 s77, v3, 32
    v_readlane_b32 s78, v3, 48
    s_nop 3
    s_max_u32 s68, s68, s76
    s_max_u32 s77, s77, s78
    s_max_u32 s68, s68, s77
    v_cmp_ne_u32 vcc, s68, v2
    s_nop 1
    v_cndmask_b32 v2, 0, v2, vcc
    s_nop 1
    v_max_u32_dpp v3, v2, v2 quad_perm:[1,0,3,2] row_mask:0xf bank_mask:0xf
    s_nop 1
    v_max_u32_dpp v3, v3, v3 quad_perm:[2,3,0,1] row_mask:0xf bank_mask:0xf
    s_nop 1
    v_max_u32_dpp v3, v3, v3 row_half_mirror row_mask:0xf bank_mask:0xf
    s_nop 1
    v_max_u32_dpp v3, v3, v3 row_mirror row_mask:0xf bank_mask:0xf
    s_nop 1
    v_readlane_b32 s69, v3, 0
    v_readlane_b32 s76, v3, 16
    v_readlane_b32 s77, v3, 32
    v_readlane_b32 s78, v3, 48
    s_nop 3
    s_max_u32 s69, s69, s76
    s_max_u32 s77, s77, s78
    s_max_u32 s69, s69, s77
    s_load_dword s33, s[4:5], 0
    s_waitcnt lgkmcnt(0)
    s_cmp_ge_u32 s33, 1
    s_cbranch_scc1 K_ZO3
    s_sleep 8
    s_load_dword s33, s[4:5], 64
    s_waitcnt lgkmcnt(0)
    s_cmp_ge_u32 s33, 1
    s_cbranch_scc1 K_ZO3
    s_sleep 8
    s_mov_b32 s3, 16384
K_ZB3:
    v_mov_b32 v4, 0
    global_load_dword v4, v4, s[4:5] sc1
    s_waitcnt vmcnt(0)
    v_readfirstlane_b32 s33, v4
    s_cmp_ge_u32 s33, 1
    s_cbranch_scc1 K_ZO3
    s_sleep 8
    s_sub_u32 s3, s3, 1
    s_cbranch_scc0 K_ZB3
K_ZO3:
    s_lshl_b32 s3, s2, 3
    s_add_u32 s3, s3, 606208
    s_atomic_add_x2 s[68:69], s[6:7], s3
    s_cmp_lg_u32 s2, 63
    s_cbranch_scc1 K_AUX_G1
    s_mov_b32 s70, 81920
    v_lshlrev_b32 v3, 3, v1
    s_mov_b32 s3, 131072
K_AUX_POLL:
    buffer_load_dwordx2 v[176:177], v3, s[64:67], s70 offen sc1
    s_waitcnt vmcnt(0)
    v_min_u32 v2, v176, v177
    v_cmp_eq_u32 vcc, 0, v2
    s_cbranch_vccz K_AUX_GOT
    s_sleep 2
    s_sub_u32 s3, s3, 1
    s_cmp_lg_u32 s3, 0
    s_cbranch_scc1 K_AUX_POLL
K_AUX_GOT:
    s_waitcnt lgkmcnt(0)
    s_nop 1
    v_max_u32_dpp v3, v176, v176 quad_perm:[1,0,3,2] row_mask:0xf bank_mask:0xf
    s_nop 1
    v_max_u32_dpp v3, v3, v3 quad_perm:[2,3,0,1] row_mask:0xf bank_mask:0xf
    s_nop 1
    v_max_u32_dpp v3, v3, v3 row_half_mirror row_mask:0xf bank_mask:0xf
    s_nop 1
    v_max_u32_dpp v3, v3, v3 row_mirror row_mask:0xf bank_mask:0xf
    s_nop 1
    v_readlane_b32 s68, v3, 0
    v_readlane_b32 s76, v3, 16
    v_readlane_b32 s77, v3, 32
    v_readlane_b32 s78, v3, 48
    s_nop 3
    s_max_u32 s68, s68, s76
    s_max_u32 s77, s77, s78
    s_max_u32 s68, s68, s77
    v_cmp_ne_u32 vcc, s68, v176
    s_nop 1
    v_cndmask_b32 v2, v177, v176, vcc
    s_nop 1
    v_max_u32_dpp v3, v2, v2 quad_perm:[1,0,3,2] row_mask:0xf bank_mask:0xf
    s_nop 1
    v_max_u32_dpp v3, v3, v3 quad_perm:[2,3,0,1] row_mask:0xf bank_mask:0xf
    s_nop 1
    v_max_u32_dpp v3, v3, v3 row_half_mirror row_mask:0xf bank_mask:0xf
    s_nop 1
    v_max_u32_dpp v3, v3, v3 row_mirror row_mask:0xf bank_mask:0xf
    s_nop 1
    v_readlane_b32 s69, v3, 0
    v_readlane_b32 s76, v3, 16
    v_readlane_b32 s77, v3, 32
    v_readlane_b32 s78, v3, 48
    s_nop 3
    s_max_u32 s69, s69, s76
    s_max_u32 s77, s77, s78
    s_max_u32 s69, s69, s77
    v_mov_b32 v176, s68
    v_mov_b32 v177, s69
    s_mov_b32 s3, 1048576
K_FGZ:
    ds_read_b32 v2, v13 offset:36
    s_sleep 1
    s_sub_u32 s3, s3, 1
    s_waitcnt lgkmcnt(0)
    v_readfirstlane_b32 s33, v2
    s_nop 3
    s_cselect_b32 s33, 1, s33
    s_cmp_lt_u32 s33, 1
    s_cbranch_scc1 K_FGZ
    v_lshlrev_b32 v3, 9, v1
    s_mov_b32 s66, 81920
    s_mov_b32 s70, 0
    buffer_store_dwordx2 v[176:177], v3, s[64:67], s70 offen offset:128 sc1
    s_mov_b32 s70, 32768
    buffer_store_dwordx2 v[176:177], v3, s[64:67], s70 offen offset:128 sc1
    s_mov_b32 s70, 65536
    buffer_store_dwordx2 v[176:177], v3, s[64:67], s70 offen offset:128 sc1
    v_mov_b32 v3, 16
    ds_write_b32 v13, v3 offset:48
    s_branch K_AUX_G1
K_AUX_G0:
    v_and_b32 v3, 3, v1
    v_lshlrev_b32 v3, 4, v3
    v_add_u32 v2, 123008, v3
    ds_read_b128 v[176:179], v2
    v_lshrrev_b32 v2, 2, v1
    v_lshl_add_u32 v3, v2, 9, v3
    s_sleep 12
    s_load_dword s33, s[4:5], 128
    s_waitcnt lgkmcnt(0)
    s_cmp_ge_u32 s33, 8
    s_cbranch_scc1 K_ZO4
    s_sleep 8
    s_mov_b32 s3, 16384
K_ZB4:
    v_mov_b32 v4, 128
    global_load_dword v4, v4, s[4:5] sc1
    s_waitcnt vmcnt(0)
    v_readfirstlane_b32 s33, v4
    s_cmp_ge_u32 s33, 8
    s_cbranch_scc1 K_ZO4
    s_sleep 8
    s_sub_u32 s3, s3, 1
    s_cbranch_scc0 K_ZB4
K_ZO4:
    v_mov_b32 v2, 1
    ds_write_b32 v13, v2 offset:36
    s_lshr_b32 s3, s29, 2
    s_lshl1_add_u32 s3, s28, s3
    s_mul_i32 s3, s3, 5120
    s_and_b32 s70, s29, 3
    s_lshl_b32 s70, s70, 6
    s_add_u32 s3, s3, s70
    s_mov_b32 exec_hi, 0xff
    s_waitcnt lgkmcnt(0)
    buffer_store_dwordx4 v[176:179], v3, s[64:67], s3 offen offset:256 sc1
    s_mov_b64 exec, -1
K_AUX_G1:
    s_cmp_lg_u32 s43, 63
    s_cbranch_scc1 K_FFN_C
    s_cmp_lg_u32 s29, 0
    s_cbranch_scc1 K_AUX_NT
    s_lshl2_add_u32 s3, s28, s30
    s_sub_u32 s3, s3, 4
    s_mul_i32 s3, s3, 25600
    v_lshlrev_b32 v2, 7, v1
    buffer_load_dword v5, v2, s[24:27], s3 offen
    s_add_u32 s3, s3, 8192
    buffer_load_dword v5, v2, s[24:27], s3 offen
    s_add_u32 s3, s3, 8192
    buffer_load_dword v5, v2, s[24:27], s3 offen
    s_add_u32 s3, s3, 8192
    s_mov_b64 exec, 0xff
    buffer_load_dword v5, v2, s[24:27], s3 offen
    s_add_u32 s3, s3, 8192
    s_mov_b64 exec, -1
K_AUX_NT:
    s_mov_b32 s3, 1048576
K_FGZ2:
    ds_read_b32 v2, v13 offset:36
    s_sleep 1
    s_sub_u32 s3, s3, 1
    s_waitcnt lgkmcnt(0)
    v_readfirstlane_b32 s33, v2
    s_nop 3
    s_cselect_b32 s33, 1, s33
    s_cmp_lt_u32 s33, 1
    s_cbranch_scc1 K_FGZ2
    s_waitcnt vmcnt(0)
    s_branch K_P2
K_AUX_L:
    v_and_b32 v1, 63, v0
    v_mov_b32 v7, 0
    s_and_b32 s28, s2, 7
    s_lshr_b32 s29, s2, 3
    s_xor_b32 s30, s30, 4
    s_lshr_b32 s34, s29, 3
    s_lshl_b32 s34, s34, 2
    s_and_b32 s3, s29, 3
    s_add_u32 s34, s34, s3
    s_add_u32 s34, s34, 4
    s_bitcmp1_b32 s29, 2
    s_cselect_b32 s34, -1, s34
    s_cmp_lt_u32 s29, 8
    s_cselect_b32 s34, s29, s34
    s_lshl_b32 s40, s28, 1
    s_cmp_ge_u32 s34, 10
    s_addc_u32 s40, s40, 0
    s_sub_u32 s41, s34, 10
    s_cmp_ge_u32 s34, 10
    s_cselect_b32 s41, s41, s34
    s_mul_i32 s42, s28, 20
    s_add_u32 s42, s42, s34
    s_and_b32 s42, s42, 255
    s_lshl_b32 s42, s42, 9
    s_add_u32 s42, s42, 524288
    s_mul_i32 s43, s28, 7
    s_add_u32 s43, s43, s29
    s_sub_u32 s43, s43, 1
    s_cmp_lt_u32 s43, 54
    s_cselect_b32 s43, s43, 63
    s_cmp_eq_u32 s29, 0
    s_cselect_b32 s43, 63, s43
    v_mov_b32 v3, 158736
    ds_write2_b32 v3, v7, v7 offset0:0 offset1:1
    ds_write2_b32 v3, v7, v7 offset0:2 offset1:3
    ds_write2_b32 v3, v7, v7 offset0:4 offset1:5
    ds_write2_b32 v3, v7, v7 offset0:6 offset1:7
    ds_write2_b32 v3, v7, v7 offset0:8 offset1:9
    ds_write2_b32 v3, v7, v7 offset0:10 offset1:11
    v_lshrrev_b32 v3, 2, v1
    v_mul_u32_u24 v11, 3456, v3
    v_lshrrev_b32 v3, 4, v1
    v_and_b32 v3, 2, v3
    v_xor_b32 v3, v3, v1
    v_and_b32 v3, 3, v3
    v_lshl_add_u32 v11, v3, 4, v11
    s_mul_i32 s3, s30, 552960
    s_lshl_b32 s70, s43, 6
    s_add_u32 s3, s3, s70
    v_add_u32 v11, s3, v11
    s_mul_i32 s68, s30, 10240
    s_add_u32 s72, s68, 40960
    s_bitcmp1_b32 s43, 0
    s_cselect_b32 s71, s72, s68
    s_cselect_b32 s72, s68, s72
    v_lshlrev_b32 v8, 4, v1
    s_waitcnt lgkmcnt(0)
    s_barrier
    s_mov_b32 s24, s8
    s_mov_b32 s25, s9
    s_mov_b32 s26, 0xc8000
    s_mov_b32 s27, 0x20000
    s_cmp_lg_u32 s43, 63
    s_cbranch_scc1 K_AUX_FFN1
    s_cmp_lg_u32 s30, 0
    s_cbranch_scc1 K_AUX_NR
    s_cmp_eq_u32 s2, 55
    s_cbranch_scc1 K_AUX_NR
    s_cmp_eq_u32 s2, 63
    s_cselect_b32 s70, 0, 128
    s_mov_b32 s3, 1
    s_waitcnt vmcnt(0)
    s_atomic_add s3, s[4:5], s70
    s_atomic_add s3, s[4:5], s70 offset:64
    s_waitcnt lgkmcnt(0)
K_AUX_NR:
    v_mov_b32 v13, 158720
    s_mov_b32 s3, 1048576
K_FGZ3:
    ds_read_b32 v2, v13 offset:36
    s_sleep 1
    s_sub_u32 s3, s3, 1
    s_waitcnt lgkmcnt(0)
    v_readfirstlane_b32 s33, v2
    s_nop 3
    s_cselect_b32 s33, 1, s33
    s_cmp_lt_u32 s33, 1
    s_cbranch_scc1 K_FGZ3
    s_cmp_lg_u32 s2, 63
    s_cbranch_scc1 K_AUX_NH
    s_mov_b32 s3, 1048576
K_FGH:
    ds_read_b32 v2, v13 offset:48
    s_sleep 1
    s_sub_u32 s3, s3, 1
    s_waitcnt lgkmcnt(0)
    v_readfirstlane_b32 s33, v2
    s_nop 3
    s_cselect_b32 s33, 16, s33
    s_cmp_lt_u32 s33, 16
    s_cbranch_scc1 K_FGH
K_AUX_NH:
    s_branch K_P2
K_AUX_FFN1:
    s_bitcmp1_b32 s43, 0
    s_cselect_b64 s[56:57], s[48:49], s[46:47]
    s_cselect_b64 s[60:61], s[46:47], s[48:49]
    s_mov_b32 s58, 2211840
    s_mov_b32 s59, 0x20000
    s_mov_b32 s62, 2211840
    s_mov_b32 s63, 0x20000
    s_add_u32 m0, s71, 0
    s_mov_b32 s70, 0
    buffer_load_dwordx4 v11, s[56:59], s70 offen  lds
    s_add_u32 m0, s71, 1024
    s_mov_b32 s70, 55296
    buffer_load_dwordx4 v11, s[56:59], s70 offen  lds
    s_add_u32 m0, s71, 2048
    s_mov_b32 s70, 110592
    buffer_load_dwordx4 v11, s[56:59], s70 offen  lds
    s_add_u32 m0, s71, 3072
    s_mov_b32 s70, 165888
    buffer_load_dwordx4 v11, s[56:59], s70 offen  lds
    s_add_u32 m0, s71, 4096
    s_mov_b32 s70, 221184
    buffer_load_dwordx4 v11, s[56:59], s70 offen  lds
    s_add_u32 m0, s71, 5120
    s_mov_b32 s70, 276480
    buffer_load_dwordx4 v11, s[56:59], s70 offen  lds
    s_add_u32 m0, s71, 6144
    s_mov_b32 s70, 331776
    buffer_load_dwordx4 v11, s[56:59], s70 offen  lds
    s_add_u32 m0, s71, 7168
    s_mov_b32 s70, 387072
    buffer_load_dwordx4 v11, s[56:59], s70 offen  lds
    s_add_u32 m0, s71, 8192
    s_mov_b32 s70, 442368
    buffer_load_dwordx4 v11, s[56:59], s70 offen  lds
    s_add_u32 m0, s71, 9216
    s_mov_b32 s70, 497664
    buffer_load_dwordx4 v11, s[56:59], s70 offen  lds
    s_add_u32 m0, s72, 0
    s_mov_b32 s70, 0
    buffer_load_dwordx4 v11, s[60:63], s70 offen  lds
    s_add_u32 m0, s72, 1024
    s_mov_b32 s70, 55296
    buffer_load_dwordx4 v11, s[60:63], s70 offen  lds
    s_add_u32 m0, s72, 2048
    s_mov_b32 s70, 110592
    buffer_load_dwordx4 v11, s[60:63], s70 offen  lds
    s_add_u32 m0, s72, 3072
    s_mov_b32 s70, 165888
    buffer_load_dwordx4 v11, s[60:63], s70 offen  lds
    s_add_u32 m0, s72, 4096
    s_mov_b32 s70, 221184
    buffer_load_dwordx4 v11, s[60:63], s70 offen  lds
    s_add_u32 m0, s72, 5120
    s_mov_b32 s70, 276480
    buffer_load_dwordx4 v11, s[60:63], s70 offen  lds
    s_add_u32 m0, s72, 6144
    s_mov_b32 s70, 331776
    buffer_load_dwordx4 v11, s[60:63], s70 offen  lds
    s_add_u32 m0, s72, 7168
    s_mov_b32 s70, 387072
    buffer_load_dwordx4 v11, s[60:63], s70 offen  lds
    s_add_u32 m0, s72, 8192
    s_mov_b32 s70, 442368
    buffer_load_dwordx4 v11, s[60:63], s70 offen  lds
    s_add_u32 m0, s72, 9216
    s_mov_b32 s70, 497664
    buffer_load_dwordx4 v11, s[60:63], s70 offen  lds
    s_mov_b32 s64, s50
    s_mov_b32 s65, s51
    s_mov_b32 s66, 0x21c000
    s_mov_b32 s67, 0x20000
    s_mul_i32 s3, s43, 40960
    s_add_u32 s3, s3, s68
    v_lshrrev_b32 v2, 3, v1
    v_and_b32 v3, 2, v2
    s_lshl_b32 s70, s30, 2
    v_xor_b32 v3, s70, v3
    v_xor_b32 v3, v3, v1
    v_and_b32 v3, 7, v3
    v_mul_u32_u24 v2, 1280, v2
    v_lshl_add_u32 v2, v3, 4, v2
    v_add_u32 v12, s3, v2
    s_add_u32 m0, s68, 81920
    s_mov_b32 s70, 0
    buffer_load_dwordx4 v12, s[64:67], s70 offen  lds
    s_add_u32 m0, s68, 82944
    s_mov_b32 s70, 128
    buffer_load_dwordx4 v12, s[64:67], s70 offen  lds
    s_add_u32 m0, s68, 83968
    s_mov_b32 s70, 256
    buffer_load_dwordx4 v12, s[64:67], s70 offen  lds
    s_add_u32 m0, s68, 84992
    s_mov_b32 s70, 384
    buffer_load_dwordx4 v12, s[64:67], s70 offen  lds
    s_add_u32 m0, s68, 86016
    s_mov_b32 s70, 512
    buffer_load_dwordx4 v12, s[64:67], s70 offen  lds
    s_add_u32 m0, s68, 87040
    s_mov_b32 s70, 640
    buffer_load_dwordx4 v12, s[64:67], s70 offen  lds
    s_add_u32 m0, s68, 88064
    s_mov_b32 s70, 768
    buffer_load_dwordx4 v12, s[64:67], s70 offen  lds
    s_add_u32 m0, s68, 89088
    s_mov_b32 s70, 896
    buffer_load_dwordx4 v12, s[64:67], s70 offen  lds
    s_add_u32 m0, s68, 90112
    s_mov_b32 s70, 1024
    buffer_load_dwordx4 v12, s[64:67], s70 offen  lds
    s_add_u32 m0, s68, 91136
    s_mov_b32 s70, 1152
    buffer_load_dwordx4 v12, s[64:67], s70 offen  lds
    s_waitcnt vmcnt(10)
    s_barrier
    s_branch K_P2_EARLY
K_FFN_C:
    v_lshrrev_b32 v180, 4, v1
    v_bfe_u32 v2, v1, 2, 2
    v_lshl_add_u32 v2, v180, 3, v2
    v_and_b32 v3, 3, v1
    v_lshlrev_b32 v3, 3, v3
    v_lshl_add_u32 v181, v2, 6, v3
    s_bfe_u32 s3, s30, 0x10001
    s_mul_i32 s3, s3, 40960
    v_xor_b32 v4, s30, v180
    v_and_b32 v4, 1, v4
    v_lshl_add_u32 v181, v4, 5, v181
    v_add_u32 v181, s3, v181
    v_bfe_u32 v4, v1, 3, 2
    v_xor_b32 v4, s30, v4
    v_and_b32 v4, 3, v4
    v_lshl_add_u32 v3, v4, 5, v3
    v_and_b32 v2, 3, v2
    v_lshl_add_u32 v3, v2, 7, v3
    v_mul_u32_u24 v182, 10240, v180
    s_mov_b32 s3, 81920
    v_add3_u32 v182, v182, v3, s3
    v_mov_b32 v183, 123904
    s_cmp_lg_u32 s30, 5
    s_cbranch_scc1 K_KW
    s_mov_b32 s3, 131072
K_KPOLL:
    s_load_dwordx2 s[68:69], s[6:7], s42 offset:128 glc
    s_waitcnt lgkmcnt(0)
    s_min_u32 s33, s68, s69
    s_cmp_lg_u32 s33, 0
    s_cbranch_scc1 K_KGOT
    s_sleep 2
    s_sub_u32 s3, s3, 1
    s_cbranch_scc0 K_KPOLL
K_KGOT:
    v_mov_b32 v176, s68
    v_mov_b32 v177, s69
    ds_write_b64 v183, v[176:177]
    v_lshlrev_b32 v2, 4, v1
    s_and_b32 s70, s68, 0x7ff
    s_sub_u32 s70, 2047, s70
    s_mul_i32 s70, s70, 1280
    s_mov_b32 m0, 134208
    s_mov_b64 exec, -1
    buffer_load_dwordx4 v2, s[12:15], s70 offen lds
    s_mov_b64 exec, 0xffff
    buffer_load_dwordx4 v2, s[12:15], s70 offen offset:1024 lds
    s_and_b32 s70, s69, 0x7ff
    s_sub_u32 s70, 2047, s70
    s_mul_i32 s70, s70, 1280
    s_mov_b32 m0, 135552
    s_mov_b64 exec, -1
    buffer_load_dwordx4 v2, s[12:15], s70 offen lds
    s_mov_b64 exec, 0xffff
    buffer_load_dwordx4 v2, s[12:15], s70 offen offset:1024 lds
    s_mov_b64 exec, -1
    v_mov_b32 v3, 16
    s_waitcnt vmcnt(0)
    ds_write_b32 v13, v3 offset:48
    s_branch K_KW2
K_KW:
    s_cmp_lt_u32 s30, 6
    s_cbranch_scc1 K_KW2
    s_cmp_eq_u32 s30, 6
    s_cbranch_scc1 K_CHF0
    s_branch K_CHF1
K_WRET_F:
K_KW2:
    s_branch K_J7ccc
K_CHF0:
K_STF16:
    s_branch K_STF18
    s_nop 0
K_J7ccc:
    v_and_b32 v2, 1, v1
    v_mul_u32_u24 v9, 1344, v2
    v_lshl_add_u32 v9, v180, 4, v9
    v_add_u32 v9, 134208, v9
    v_and_b32 v2, 1, v1
    v_lshlrev_b32 v192, 6, v2
    v_lshl_add_u32 v192, v180, 4, v192
    s_and_b32 s3, s30, 3
    s_lshl_b32 s3, s3, 7
    v_add3_u32 v193, v192, s3, v183
    v_add_u32 v192, 64, v193
    v_add_u32 v193, 1088, v193
    v_lshrrev_b32 v2, 5, v1
    v_bfe_u32 v3, v1, 4, 1
    v_lshl_add_u32 v3, v3, 1, v2
    v_lshlrev_b32 v3, 6, v3
    v_and_b32 v4, 15, v1
    v_lshl_add_u32 v3, v4, 2, v3
    v_add_u32 v194, 123968, v3
    v_lshlrev_b32 v4, 1, v1
    s_add_u32 s3, s3, 124992
    v_add_u32 v195, s3, v4
    v_and_b32 v2, 1, v1
    v_mul_u32_u24 v2, 2560, v2
    v_lshl_add_u32 v196, v180, 4, v2
    s_lshl_b32 s70, s30, 6
    s_add_u32 s70, s70, 125760
    v_add_u32 v196, s70, v196
    v_mov_b32 v3, 1
    s_mov_b32 s3, 1048576
K_FGK:
    ds_read_b32 v2, v13 offset:48
    s_sleep 1
    s_sub_u32 s3, s3, 1
    s_waitcnt lgkmcnt(0)
    v_readfirstlane_b32 s33, v2
    s_nop 3
    s_cselect_b32 s33, 16, s33
    s_cmp_lt_u32 s33, 16
    s_cbranch_scc1 K_FGK
    ds_read_b128 v[96:99], v9 offset:0
    ds_read_b128 v[100:103], v9 offset:64
    ds_read_b128 v[104:107], v9 offset:128
    ds_read_b128 v[108:111], v9 offset:192
    ds_read_b128 v[112:115], v9 offset:256
    ds_read_b128 v[116:119], v9 offset:320
    ds_read_b128 v[120:123], v9 offset:384
    ds_read_b128 v[124:127], v9 offset:448
    ds_read_b128 v[128:131], v9 offset:512
    ds_read_b128 v[132:135], v9 offset:576
    ds_read_b128 v[136:139], v9 offset:640
    ds_read_b128 v[140:143], v9 offset:704
    ds_read_b128 v[144:147], v9 offset:768
    ds_read_b128 v[148:151], v9 offset:832
    ds_read_b128 v[152:155], v9 offset:896
    ds_read_b128 v[156:159], v9 offset:960
    ds_read_b128 v[160:163], v9 offset:1024
    ds_read_b128 v[164:167], v9 offset:1088
    ds_read_b128 v[168:171], v9 offset:1152
    ds_read_b128 v[172:175], v9 offset:1216
    s_setprio 3
    s_barrier
    ds_read_b64_tr_b16 v[16:17], v181 offset:0
    ds_read_b64_tr_b16 v[18:19], v181 offset:256
    ds_read_b64_tr_b16 v[20:21], v181 offset:2048
    ds_read_b64_tr_b16 v[22:23], v181 offset:2304
    ds_read_b64_tr_b16 v[24:25], v181 offset:4096
    ds_read_b64_tr_b16 v[26:27], v181 offset:4352
    ds_read_b64_tr_b16 v[28:29], v181 offset:6144
    ds_read_b64_tr_b16 v[30:31], v181 offset:6400
    ds_read_b64_tr_b16 v[32:33], v181 offset:8192
    ds_read_b64_tr_b16 v[34:35], v181 offset:8448
    ds_read_b64_tr_b16 v[36:37], v181 offset:10240
    ds_read_b64_tr_b16 v[38:39], v181 offset:10496
    ds_read_b64_tr_b16 v[40:41], v181 offset:12288
    ds_read_b64_tr_b16 v[42:43], v181 offset:12544
    ds_read_b64_tr_b16 v[44:45], v181 offset:14336
    ds_read_b64_tr_b16 v[46:47], v181 offset:14592
    ds_read_b64_tr_b16 v[48:49], v181 offset:16384
    ds_read_b64_tr_b16 v[50:51], v181 offset:16640
    ds_read_b64_tr_b16 v[52:53], v181 offset:18432
    ds_read_b64_tr_b16 v[54:55], v181 offset:18688
    ds_read_b64_tr_b16 v[56:57], v181 offset:20480
    ds_read_b64_tr_b16 v[58:59], v181 offset:20736
    ds_read_b64_tr_b16 v[60:61], v181 offset:22528
    ds_read_b64_tr_b16 v[62:63], v181 offset:22784
    ds_read_b64_tr_b16 v[64:65], v181 offset:24576
    ds_read_b64_tr_b16 v[66:67], v181 offset:24832
    ds_read_b64_tr_b16 v[68:69], v181 offset:26624
    ds_read_b64_tr_b16 v[70:71], v181 offset:26880
    ds_read_b64_tr_b16 v[72:73], v181 offset:28672
    ds_read_b64_tr_b16 v[74:75], v181 offset:28928
    ds_read_b64_tr_b16 v[76:77], v181 offset:30720
    ds_read_b64_tr_b16 v[78:79], v181 offset:30976
    ds_read_b64_tr_b16 v[80:81], v181 offset:32768
    ds_read_b64_tr_b16 v[82:83], v181 offset:33024
    ds_read_b64_tr_b16 v[84:85], v181 offset:34816
    ds_read_b64_tr_b16 v[86:87], v181 offset:35072
    ds_read_b64_tr_b16 v[88:89], v181 offset:36864
    ds_read_b64_tr_b16 v[90:91], v181 offset:37120
    ds_read_b64_tr_b16 v[92:93], v181 offset:38912
    ds_read_b64_tr_b16 v[94:95], v181 offset:39168
    s_waitcnt lgkmcnt(0)
    s_barrier
    v_mfma_f32_16x16x32_bf16 v[184:187], v[16:19], v[96:99], 0
    v_mfma_f32_16x16x32_bf16 v[188:191], v[20:23], v[100:103], 0
    v_mfma_f32_16x16x32_bf16 v[184:187], v[24:27], v[104:107], v[184:187]
    v_mfma_f32_16x16x32_bf16 v[188:191], v[28:31], v[108:111], v[188:191]
    v_mfma_f32_16x16x32_bf16 v[184:187], v[32:35], v[112:115], v[184:187]
    v_mfma_f32_16x16x32_bf16 v[188:191], v[36:39], v[116:119], v[188:191]
    v_mfma_f32_16x16x32_bf16 v[184:187], v[40:43], v[120:123], v[184:187]
    v_mfma_f32_16x16x32_bf16 v[188:191], v[44:47], v[124:127], v[188:191]
    v_mfma_f32_16x16x32_bf16 v[184:187], v[48:51], v[128:131], v[184:187]
    v_mfma_f32_16x16x32_bf16 v[188:191], v[52:55], v[132:135], v[188:191]
    v_mfma_f32_16x16x32_bf16 v[184:187], v[56:59], v[136:139], v[184:187]
    s_branch K_PG7
.p2align 12
K_CHF1:
K_STF17:
    s_branch K_WRET_F
    s_nop 0
K_PG7:
    v_mfma_f32_16x16x32_bf16 v[188:191], v[60:63], v[140:143], v[188:191]
    v_mfma_f32_16x16x32_bf16 v[184:187], v[64:67], v[144:147], v[184:187]
    v_mfma_f32_16x16x32_bf16 v[188:191], v[68:71], v[148:151], v[188:191]
    v_mfma_f32_16x16x32_bf16 v[184:187], v[72:75], v[152:155], v[184:187]
    v_mfma_f32_16x16x32_bf16 v[188:191], v[76:79], v[156:159], v[188:191]
    v_mfma_f32_16x16x32_bf16 v[184:187], v[80:83], v[160:163], v[184:187]
    v_mfma_f32_16x16x32_bf16 v[188:191], v[84:87], v[164:167], v[188:191]
    v_mfma_f32_16x16x32_bf16 v[184:187], v[88:91], v[168:171], v[184:187]
    v_mfma_f32_16x16x32_bf16 v[188:191], v[92:95], v[172:175], v[188:191]
    s_nop 7
    v_add_f32 v184, v184, v188
    v_add_f32 v185, v185, v189
    v_add_f32 v186, v186, v190
    v_add_f32 v187, v187, v191
    s_mov_b32 exec_lo, 0x00030003
    s_mov_b32 exec_hi, 0x00030003
    ds_write_b128 v192, v[184:187]
    s_mov_b64 exec, 1
    ds_add_u32 v13, v3 offset:52
    s_mov_b64 exec, -1
    s_cmp_lg_u32 s30, 6
    s_cbranch_scc1 K_NOS6B
    v_lshl_add_u32 v4, v1, 2, s42
    global_load_dword v7, v4, s[6:7] offset:256 sc1
    v_and_b32 v4, 0xfffffe04, v4
    global_load_dword v6, v4, s[6:7] offset:128 sc1
K_NOS6B:
    s_mov_b32 s3, 1048576
K_FGP:
    ds_read_b32 v2, v13 offset:52
    s_sleep 1
    s_sub_u32 s3, s3, 1
    s_waitcnt lgkmcnt(0)
    v_readfirstlane_b32 s33, v2
    s_nop 3
    s_cselect_b32 s33, 8, s33
    s_cmp_lt_u32 s33, 8
    s_cbranch_scc1 K_FGP
    ds_read_b32 v200, v194
    ds_read_b32 v202, v194 offset:256
    ds_read_b64_tr_b16 v[16:17], v182 offset:0
    ds_read_b64_tr_b16 v[18:19], v182 offset:512
    ds_read_b64_tr_b16 v[20:21], v182 offset:1024
    ds_read_b64_tr_b16 v[22:23], v182 offset:1536
    ds_read_b64_tr_b16 v[24:25], v182 offset:2048
    ds_read_b64_tr_b16 v[26:27], v182 offset:2560
    ds_read_b64_tr_b16 v[28:29], v182 offset:3072
    ds_read_b64_tr_b16 v[30:31], v182 offset:3584
    ds_read_b64_tr_b16 v[32:33], v182 offset:4096
    ds_read_b64_tr_b16 v[34:35], v182 offset:4608
    ds_read_b64_tr_b16 v[36:37], v182 offset:5120
    ds_read_b64_tr_b16 v[38:39], v182 offset:5632
    ds_read_b64_tr_b16 v[40:41], v182 offset:6144
    ds_read_b64_tr_b16 v[42:43], v182 offset:6656
    s_waitcnt lgkmcnt(14)
    v_cvt_pk_bf16_f32 v200, v200, v200
    v_lshlrev_b32 v200, 16, v200
    v_cvt_pk_bf16_f32 v202, v202, v202
    v_lshlrev_b32 v202, 16, v202
    v_mul_f32 v201, 0xbfb8aa3b, v200
    v_exp_f32 v201, v201
    s_nop 0
    v_add_f32 v201, 1.0, v201
    v_rcp_f32 v201, v201
    s_nop 0
    v_mul_f32 v200, v200, v201
    v_cvt_pk_bf16_f32 v200, v200, v200
    v_lshlrev_b32 v200, 16, v200
    v_mul_f32 v200, v200, v202
    v_cvt_pk_bf16_f32 v200, v200, v200
    ds_write_b16 v195, v200
    s_waitcnt lgkmcnt(0)
    ds_read_b128 v[200:203], v193
    ds_read_b64_tr_b16 v[44:45], v182 offset:7168
    ds_read_b64_tr_b16 v[46:47], v182 offset:7680
    ds_read_b64_tr_b16 v[48:49], v182 offset:8192
    ds_read_b64_tr_b16 v[50:51], v182 offset:8704
    ds_read_b64_tr_b16 v[52:53], v182 offset:9216
    ds_read_b64_tr_b16 v[54:55], v182 offset:9728
    s_waitcnt lgkmcnt(6)
    v_mfma_f32_16x16x32_bf16 v[96:99], v[16:19], v[200:203], 0
    v_mfma_f32_16x16x32_bf16 v[100:103], v[20:23], v[200:203], 0
    v_mfma_f32_16x16x32_bf16 v[104:107], v[24:27], v[200:203], 0
    v_mfma_f32_16x16x32_bf16 v[108:111], v[28:31], v[200:203], 0
    v_mfma_f32_16x16x32_bf16 v[112:115], v[32:35], v[200:203], 0
    v_mfma_f32_16x16x32_bf16 v[116:119], v[36:39], v[200:203], 0
    v_mfma_f32_16x16x32_bf16 v[120:123], v[40:43], v[200:203], 0
    s_waitcnt lgkmcnt(4)
    v_mfma_f32_16x16x32_bf16 v[124:127], v[44:47], v[200:203], 0
    s_waitcnt lgkmcnt(2)
    v_mfma_f32_16x16x32_bf16 v[128:131], v[48:51], v[200:203], 0
    s_waitcnt lgkmcnt(0)
    v_mfma_f32_16x16x32_bf16 v[132:135], v[52:55], v[200:203], 0
    s_mov_b32 exec_lo, 0x00030003
    s_mov_b32 exec_hi, 0x00030003
    ds_write_b128 v196, v[96:99] offset:0
    ds_write_b128 v196, v[100:103] offset:256
    ds_write_b128 v196, v[104:107] offset:512
    ds_write_b128 v196, v[108:111] offset:768
    ds_write_b128 v196, v[112:115] offset:1024
    ds_write_b128 v196, v[116:119] offset:1280
    ds_write_b128 v196, v[120:123] offset:1536
    ds_write_b128 v196, v[124:127] offset:1792
    ds_write_b128 v196, v[128:131] offset:2048
    ds_write_b128 v196, v[132:135] offset:2304
    v_mov_b32 v3, 1
    s_mov_b64 exec, 1
    ds_add_u32 v13, v3 offset:52
    s_mov_b64 exec, -1
    s_cmp_lg_u32 s30, 4
    s_cbranch_scc1 K_P2
    v_lshlrev_b32 v3, 4, v1
    v_add_u32 v4, 126016, v3
    s_mul_i32 s70, s43, 5120
    s_add_u32 s71, s70, 4096
    s_mov_b32 s3, 1048576
K_FGQ:
    ds_read_b32 v2, v13 offset:52
    s_sleep 1
    s_sub_u32 s3, s3, 1
    s_waitcnt lgkmcnt(0)
    v_readfirstlane_b32 s33, v2
    s_nop 3
    s_cselect_b32 s33, 12, s33
    s_cmp_lt_u32 s33, 12
    s_cbranch_scc1 K_FGQ
    ds_read_b128 v[16:19], v4 offset:0
    ds_read_b128 v[20:23], v4 offset:1024
    ds_read_b128 v[24:27], v4 offset:2048
    ds_read_b128 v[28:31], v4 offset:3072
    ds_read_b128 v[32:35], v4 offset:4096
    s_waitcnt lgkmcnt(4)
    buffer_store_dwordx4 v[16:19], v3, s[60:63], s70 offen offset:0 sc1
    s_waitcnt lgkmcnt(3)
    buffer_store_dwordx4 v[20:23], v3, s[60:63], s70 offen offset:1024 sc1
    s_waitcnt lgkmcnt(2)
    buffer_store_dwordx4 v[24:27], v3, s[60:63], s70 offen offset:2048 sc1
    s_waitcnt lgkmcnt(1)
    buffer_store_dwordx4 v[28:31], v3, s[60:63], s70 offen offset:3072 sc1
    s_waitcnt lgkmcnt(0)
    buffer_store_dwordx4 v[32:35], v3, s[60:63], s71 offen offset:0 sc1
    s_mov_b32 s3, 1
    s_waitcnt vmcnt(0)
    s_atomic_add s3, s[6:7], 606720 glc
    ds_read_b64 v[176:177], v183
    s_waitcnt lgkmcnt(0)
    s_cmp_lg_u32 s3, 53
    s_cbranch_scc1 K_P2
    v_readfirstlane_b32 s70, v176
    s_and_b32 s70, s70, 0x7ff
    s_sub_u32 s70, 2047, s70
    s_lshr_b32 s70, s70, 7
    s_mul_i32 s70, s70, 5120
    s_branch K_J83cc
K_STF18:
    s_branch K_WRET_F
    s_nop 0
K_J83cc:
    s_atomic_add s3, s[6:7], s70 offset:524424
    s_atomic_add s3, s[6:7], s70 offset:524936
    s_atomic_add s3, s[6:7], s70 offset:525448
    s_atomic_add s3, s[6:7], s70 offset:525960
    s_atomic_add s3, s[6:7], s70 offset:526472
    s_atomic_add s3, s[6:7], s70 offset:526984
    s_atomic_add s3, s[6:7], s70 offset:527496
    s_atomic_add s3, s[6:7], s70 offset:528008
    s_atomic_add s3, s[6:7], s70 offset:528520
    s_atomic_add s3, s[6:7], s70 offset:529032
    v_readfirstlane_b32 s70, v177
    s_and_b32 s70, s70, 0x7ff
    s_sub_u32 s70, 2047, s70
    s_lshr_b32 s70, s70, 7
    s_mul_i32 s70, s70, 5120
    s_atomic_add s3, s[6:7], s70 offset:524424
    s_atomic_add s3, s[6:7], s70 offset:524936
    s_atomic_add s3, s[6:7], s70 offset:525448
    s_atomic_add s3, s[6:7], s70 offset:525960
    s_atomic_add s3, s[6:7], s70 offset:526472
    s_atomic_add s3, s[6:7], s70 offset:526984
    s_atomic_add s3, s[6:7], s70 offset:527496
    s_atomic_add s3, s[6:7], s70 offset:528008
    s_atomic_add s3, s[6:7], s70 offset:528520
    s_atomic_add s3, s[6:7], s70 offset:529032
    s_waitcnt lgkmcnt(0)
    s_branch K_P2
K_CODE_END:
.section .rodata,"a"
.p2align 6
.amdhsa_kernel gated_mix__sliding_local_dilated__moe_arch_mod__prompt_kernel
  .amdhsa_next_free_vgpr 256
  .amdhsa_next_free_sgpr 79
  .amdhsa_accum_offset 256
  .amdhsa_group_segment_fixed_size 0
  .amdhsa_kernarg_size 96
  .amdhsa_user_sgpr_count 2
  .amdhsa_user_sgpr_kernarg_segment_ptr 1
  .amdhsa_system_sgpr_workgroup_id_x 1
.end_amdhsa_kernel
```

```asm
; @launch grid=(256,1,1) block=(512,1,1) lds=163840
.amdgcn_target "amdgcn-amd-amdhsa--gfx950"
.text
K_CPL = 33
.p2align 12
.p2align 8
.globl gated_mix__sliding_local_dilated__moe_arch_mod__prompt_kernel
.type gated_mix__sliding_local_dilated__moe_arch_mod__prompt_kernel,@function
gated_mix__sliding_local_dilated__moe_arch_mod__prompt_kernel:
    s_cmp_ge_u32 s2, 256
    s_cbranch_scc1 K_EXIT
    s_load_dwordx2 s[12:13], s[0:1], 0
    s_load_dwordx2 s[16:17], s[0:1], 8
    s_load_dwordx4 s[4:7], s[0:1], 80
    s_load_dwordx2 s[8:9], s[0:1], 16
    s_load_dwordx2 s[10:11], s[0:1], 72
    v_readfirstlane_b32 s30, v0
    s_mov_b32 s14, 0x280000
    s_mov_b32 s15, 0x20000
    s_lshr_b32 s30, s30, 6
    s_cmp_ge_u32 s2, 64
    s_cbranch_scc1 K_MAIN
    s_load_dwordx8 s[44:51], s[0:1], 32
    s_load_dwordx2 s[52:53], s[0:1], 64
    s_getpc_b64 s[38:39]
K_PC:
    s_lshr_b32 s3, s2, 3
    s_mul_i32 s3, s3, K_CPL
    v_add_u32 v2, s3, v0
    v_lshlrev_b32 v2, 7, v2
    v_min_u32 v2, K_CODE_END-K_PC-4, v2
    v_cmp_gt_u32 vcc, K_CPL, v0
    s_and_saveexec_b64 s[20:21], vcc
    s_cbranch_execz K_NOPF
    global_load_dword v6, v2, s[38:39]
K_NOPF:
    s_mov_b64 exec, -1
    s_cmp_lg_u32 s30, 4
    s_cbranch_scc1 K_AUX
    s_min_u32 s3, s2, 8
    s_mul_i32 s3, s3, 10240
    s_add_u32 s33, s3, 10240
    s_cmp_lt_u32 s2, 8
    s_cbranch_scc1 K_ZS
    s_cmp_lg_u32 s2, 63
    s_cbranch_scc1 K_AUX
    s_mov_b32 s33, 0
K_ZS:
    v_lshlrev_b32 v2, 4, v0
    v_mov_b32 v8, 0
    v_mov_b32 v9, 0
    v_mov_b32 v10, 0
    v_mov_b32 v11, 0
    s_waitcnt lgkmcnt(0)
    s_add_u32 s20, s6, 0x7f000
    s_addc_u32 s21, s7, 0
    s_mov_b32 s22, 0x15400
    s_mov_b32 s23, 0x20000
K_ZL:
    buffer_store_dwordx4 v[8:11], v2, s[20:23], s3 offen sc1
    s_add_u32 s3, s3, 1024
    s_cmp_lt_u32 s3, s33
    s_cbranch_scc1 K_ZL
    s_branch K_AUX
K_MAIN:
    s_cmp_ge_u32 s30, 4
    s_cbranch_scc1 K_CONS
    s_bfe_u32 s3, s2, 0x20001
    s_mul_i32 s44, s3, 675840
    s_lshr_b32 s33, s2, 6
    s_mul_i32 s3, s33, 225280
    s_add_u32 s44, s44, s3
    s_mul_i32 s3, s30, 61440
    s_add_u32 s44, s44, s3
    s_sub_u32 s44, s44, 245760
    v_bfe_u32 v3, v0, 4, 2
    s_lshr_b32 s3, s2, 1
    s_and_b32 s3, s3, 28
    s_or_b32 s3, s3, 0x40000
    v_lshlrev_b32 v2, 1, v3
    v_sub_u32 v2, v0, v2
    s_and_b32 s50, s2, 0xc1
    s_mov_b32 s49, 0x225510
    s_cmpk_eq_u32 s50, 128
    s_cselect_b32 s49, 0x75275525, s49
    s_cmpk_eq_u32 s50, 192
    s_cselect_b32 s49, 0x37765750, s49
    s_cmpk_eq_u32 s50, 65
    s_cselect_b32 s49, 0x225510, s49
    s_cmpk_eq_u32 s50, 129
    s_cselect_b32 s49, 0x75275525, s49
    s_cmpk_eq_u32 s50, 193
    s_cselect_b32 s49, 0x37765750, s49
    s_bfe_u32 s49, s49, s3
    s_bfe_u32 s32, 0x64317520, s3
    v_and_b32 v2, 15, v2
    v_mul_u32_u24 v5, 3840, v3
    s_lshl_b32 s3, s2, 2
    s_lshr_b32 s3, 0x44032335, s3
    s_and_b32 s3, s3, 15
    s_add_u32 s49, s49, s3
    s_mov_b32 s33, 0x00a55a
    v_subrev_u32 v5, 160, v5
    s_sub_u32 s3, s49, 10
    s_cselect_b32 s49, s49, s3
    v_mul_u32_u24 v4, 52, v2
    v_lshrrev_b32 v4, 5, v4
    v_and_b32 v4, 24, v4
    v_bfe_u32 v4, s33, v4, 8
    v_add_u32 v4, v4, v2
    v_lshl_add_u32 v218, v4, 4, v5
    v_add_u32 v4, 1, v2
    v_lshrrev_b32 v4, 4, v4
    v_lshl_add_u32 v218, v4, 28, v218
    v_xor_b32 v2, 8, v2
    v_mul_u32_u24 v4, 52, v2
    v_lshrrev_b32 v4, 5, v4
    v_and_b32 v4, 24, v4
    v_bfe_u32 v4, s33, v4, 8
    v_add_u32 v4, v4, v2
    v_lshl_add_u32 v219, v4, 4, v5
    v_add_u32 v4, 1, v2
    v_lshrrev_b32 v4, 4, v4
    v_lshl_add_u32 v219, v4, 28, v219
    s_bitcmp1_b32 s2, 0
    s_cselect_b32 s3, 8, 0
    s_add_u32 s32, s32, s3
    s_mul_i32 s50, s32, 80
    s_mul_i32 s3, s30, 61440
    s_add_u32 s50, s50, s3
    s_lshl_b32 s46, s30, 12
    s_add_u32 s46, s46, 24576
    s_mul_i32 s45, s30, 6144
    s_mov_b32 s18, 0x258000
    s_mov_b32 s19, 0x20000
    v_xor_b32 v3, v3, v0
    v_and_b32 v3, 7, v3
    v_bfe_u32 v2, v0, 3, 3
    v_mul_u32_u24 v2, 1280, v2
    v_lshl_add_u32 v216, v3, 4, v2
    v_xor_b32 v217, 64, v216
    s_lshl_b32 s47, s49, 7
    s_mul_i32 s48, s49, 245760
    s_add_u32 s51, s44, s47
    s_add_u32 s48, s48, s50
    s_add_u32 s49, s49, 1
    s_cmp_eq_u32 s49, 10
    s_cselect_b32 s49, 0, s49
    s_waitcnt lgkmcnt(0)
    s_add_u32 m0, s46, 81920
    s_add_u32 s52, s48, 0
    buffer_load_dwordx4 v218, s[16:19], s52 offen lds
    s_add_u32 m0, s45, 81920
    s_max_i32 s52, s51, s47
    buffer_load_dwordx4 v216, s[12:15], s52 offen lds
    s_add_u32 m0, s46, 82944
    s_add_u32 s52, s48, 15360
    buffer_load_dwordx4 v218, s[16:19], s52 offen lds
    s_add_u32 m0, s45, 82944
    s_add_u32 s52, s51, 10240
    s_max_i32 s52, s52, s47
    buffer_load_dwordx4 v217, s[12:15], s52 offen lds
    s_add_u32 m0, s45, 83968
    s_add_u32 s52, s51, 20480
    buffer_load_dwordx4 v216, s[12:15], s52 offen lds
    s_add_u32 m0, s46, 83968
    s_add_u32 s52, s48, 30720
    buffer_load_dwordx4 v219, s[16:19], s52 offen lds
    s_add_u32 m0, s45, 84992
    s_add_u32 s52, s51, 30720
    buffer_load_dwordx4 v217, s[12:15], s52 offen lds
    s_add_u32 m0, s46, 84992
    s_add_u32 s52, s48, 46080
    buffer_load_dwordx4 v219, s[16:19], s52 offen lds
    s_add_u32 m0, s45, 86016
    s_add_u32 s52, s51, 40960
    buffer_load_dwordx4 v216, s[12:15], s52 offen lds
    s_add_u32 m0, s45, 87040
    s_add_u32 s52, s51, 51200
    buffer_load_dwordx4 v217, s[12:15], s52 offen lds
    s_lshl_b32 s47, s49, 7
    s_mul_i32 s48, s49, 245760
    s_add_u32 s51, s44, s47
    s_add_u32 s48, s48, s50
    s_add_u32 s49, s49, 1
    s_cmp_eq_u32 s49, 10
    s_cselect_b32 s49, 0, s49
    s_add_u32 m0, s46, 0
    s_add_u32 s52, s48, 0
    buffer_load_dwordx4 v218, s[16:19], s52 offen lds
    s_add_u32 m0, s45, 0
    s_max_i32 s52, s51, s47
    buffer_load_dwordx4 v216, s[12:15], s52 offen lds
    s_add_u32 m0, s46, 1024
    s_add_u32 s52, s48, 15360
    buffer_load_dwordx4 v218, s[16:19], s52 offen lds
    s_add_u32 m0, s45, 1024
    s_add_u32 s52, s51, 10240
    s_max_i32 s52, s52, s47
    buffer_load_dwordx4 v217, s[12:15], s52 offen lds
    s_add_u32 m0, s45, 2048
    s_add_u32 s52, s51, 20480
    buffer_load_dwordx4 v216, s[12:15], s52 offen lds
    s_add_u32 m0, s46, 2048
    s_add_u32 s52, s48, 30720
    buffer_load_dwordx4 v219, s[16:19], s52 offen lds
    s_mov_b32 s43, s30
    v_and_b32 v1, 63, v0
    v_mov_b32 v7, 0
    s_and_b32 s28, s2, 7
    s_lshr_b32 s29, s2, 3
    s_xor_b32 s30, s30, 4
    s_lshr_b32 s34, s29, 3
    s_lshl_b32 s34, s34, 2
    s_and_b32 s3, s29, 3
    s_add_u32 s34, s34, s3
    s_add_u32 s34, s34, 4
    s_bitcmp1_b32 s29, 2
    s_cselect_b32 s34, -1, s34
    s_cmp_lt_u32 s29, 8
    s_cselect_b32 s34, s29, s34
    s_lshl_b32 s40, s28, 1
    s_cmp_ge_u32 s34, 10
    s_addc_u32 s40, s40, 0
    s_sub_u32 s41, s34, 10
    s_cmp_ge_u32 s34, 10
    s_cselect_b32 s41, s41, s34
    s_mul_i32 s42, s28, 20
    s_add_u32 s42, s42, s34
    s_and_b32 s42, s42, 255
    s_lshl_b32 s42, s42, 9
    s_add_u32 s42, s42, 524288
    s_lshr_b32 s31, s28, 1
    s_mul_i32 s31, s31, 3
    s_lshr_b32 s3, s29, 3
    s_add_u32 s31, s31, s3
    s_sub_u32 s31, s31, 1
    s_and_b32 s32, s28, 1
    s_lshl_b32 s32, s32, 3
    s_and_b32 s3, s29, 7
    s_lshl_b32 s3, s3, 2
    s_lshr_b32 s3, 0x64317520, s3
    s_and_b32 s3, s3, 7
    s_add_u32 s32, s32, s3
    s_and_b32 s35, s29, 3
    s_and_b32 s3, s29, 4
    s_lshl_b32 s3, s3, 1
    s_add_u32 s35, s35, s3
    s_and_b32 s3, s28, 1
    s_lshl_b32 s3, s3, 2
    s_add_u32 s35, s35, s3
K_LOADER:
    s_mov_b32 s24, s8
    s_mov_b32 s25, s9
    s_mov_b32 s26, 0xc8000
    s_mov_b32 s27, 0x20000
    v_and_b32 v8, 15, v1
    v_lshrrev_b32 v9, 4, v1
    v_bfe_u32 v10, v1, 2, 2
    v_and_b32 v11, 3, v1
    s_add_u32 s20, s6, 0x100000
    s_addc_u32 s21, s7, 0
    s_mov_b32 s22, 0x280000
    s_mov_b32 s23, 0x20000
    s_lshr_b32 s53, s35, 2
    s_add_u32 s3, s53, s35
    s_lshl_b32 s3, s3, 12
    s_mul_i32 s33, s53, 19456
    s_lshl_b32 s53, s35, 8
    s_add_u32 s33, s33, s53
    s_add_u32 s33, s33, 16384
    s_mul_i32 s53, s31, 11
    s_add_u32 s54, s53, s43
    v_mov_b32 v3, s54
    v_lshrrev_b32 v2, 2, v3
    v_mul_u32_u24 v2, 76, v2
    v_add_lshl_u32 v2, v2, v3, 10
    v_lshl_add_u32 v2, v8, 4, v2
    v_add_u32 v220, s3, v2
    v_lshl_add_u32 v220, v9, 8, v220
    s_lshl_b32 s3, s43, 2
    v_add_u32 v4, s3, v9
    v_add_u32 v3, s53, v4
    v_lshrrev_b32 v2, 2, v3
    v_mul_u32_u24 v2, 76, v2
    v_add_lshl_u32 v2, v2, v3, 10
    v_lshl_add_u32 v2, v8, 4, v2
    v_add_u32 v221, s33, v2
    v_mov_b32 v5, 0x10000000
    v_cmp_gt_u32 vcc, 11, v4
    v_mov_b32 v224, -1
    v_mov_b32 v225, -1
    v_mov_b32 v226, -1
    v_mov_b32 v227, -1
    v_cndmask_b32 v221, v5, v221, vcc
    v_lshrrev_b32 v2, 3, v1
    v_mul_u32_u24 v2, 1280, v2
    v_lshrrev_b32 v3, 2, v1
    v_and_b32 v3, 4, v3
    v_and_b32 v4, 7, v1
    v_xor_b32 v3, v3, v4
    v_lshl_add_u32 v2, v3, 4, v2
    s_lshl_b32 s33, s41, 7
    v_add_u32 v222, s33, v2
    v_lshrrev_b32 v5, 5, v1
    v_mul_u32_u24 v5, 20480, v5
    v_add_u32 v5, v5, v222
    s_mov_b32 s30, s43
    s_waitcnt vmcnt(6)
    s_barrier
    s_add_u32 m0, s45, 3072
    s_add_u32 s52, s51, 30720
    buffer_load_dwordx4 v217, s[12:15], s52 offen lds
    s_add_u32 m0, s46, 3072
    s_add_u32 s52, s48, 46080
    buffer_load_dwordx4 v219, s[16:19], s52 offen lds
    s_add_u32 m0, s45, 4096
    s_add_u32 s52, s51, 40960
    buffer_load_dwordx4 v216, s[12:15], s52 offen lds
    s_add_u32 m0, s45, 5120
    s_add_u32 s52, s51, 51200
    buffer_load_dwordx4 v217, s[12:15], s52 offen lds
    s_lshl_b32 s47, s49, 7
    s_mul_i32 s48, s49, 245760
    s_add_u32 s51, s44, s47
    s_add_u32 s48, s48, s50
    s_add_u32 s49, s49, 1
    s_cmp_eq_u32 s49, 10
    s_cselect_b32 s49, 0, s49
    s_add_u32 m0, s46, 40960
    s_add_u32 s52, s48, 0
    buffer_load_dwordx4 v218, s[16:19], s52 offen lds
    s_add_u32 m0, s45, 40960
    s_max_i32 s52, s51, s47
    buffer_load_dwordx4 v216, s[12:15], s52 offen lds
    s_add_u32 m0, s46, 41984
    s_add_u32 s52, s48, 15360
    buffer_load_dwordx4 v218, s[16:19], s52 offen lds
    s_add_u32 m0, s45, 41984
    s_add_u32 s52, s51, 10240
    s_max_i32 s52, s52, s47
    buffer_load_dwordx4 v217, s[12:15], s52 offen lds
    s_add_u32 m0, s45, 43008
    s_add_u32 s52, s51, 20480
    buffer_load_dwordx4 v216, s[12:15], s52 offen lds
    s_add_u32 m0, s46, 43008
    s_add_u32 s52, s48, 30720
    buffer_load_dwordx4 v219, s[16:19], s52 offen lds
    s_waitcnt vmcnt(6)
    s_barrier
    s_add_u32 m0, s45, 44032
    s_add_u32 s52, s51, 30720
    buffer_load_dwordx4 v217, s[12:15], s52 offen lds
    s_add_u32 m0, s46, 44032
    s_add_u32 s52, s48, 46080
    buffer_load_dwordx4 v219, s[16:19], s52 offen lds
    s_add_u32 m0, s45, 45056
    s_add_u32 s52, s51, 40960
    buffer_load_dwordx4 v216, s[12:15], s52 offen lds
    s_add_u32 m0, s45, 46080
    s_add_u32 s52, s51, 51200
    buffer_load_dwordx4 v217, s[12:15], s52 offen lds
    s_lshl_b32 s47, s49, 7
    s_mul_i32 s48, s49, 245760
    s_add_u32 s51, s44, s47
    s_add_u32 s48, s48, s50
    s_add_u32 s49, s49, 1
    s_cmp_eq_u32 s49, 10
    s_cselect_b32 s49, 0, s49
    s_add_u32 m0, s46, 81920
    s_add_u32 s52, s48, 0
    buffer_load_dwordx4 v218, s[16:19], s52 offen lds
    s_add_u32 m0, s45, 81920
    s_max_i32 s52, s51, s47
    buffer_load_dwordx4 v216, s[12:15], s52 offen lds
    s_add_u32 m0, s46, 82944
    s_add_u32 s52, s48, 15360
    buffer_load_dwordx4 v218, s[16:19], s52 offen lds
    s_add_u32 m0, s45, 82944
    s_add_u32 s52, s51, 10240
    s_max_i32 s52, s52, s47
    buffer_load_dwordx4 v217, s[12:15], s52 offen lds
    s_add_u32 m0, s45, 83968
    s_add_u32 s52, s51, 20480
    buffer_load_dwordx4 v216, s[12:15], s52 offen lds
    s_add_u32 m0, s46, 83968
    s_add_u32 s52, s48, 30720
    buffer_load_dwordx4 v219, s[16:19], s52 offen lds
    s_waitcnt vmcnt(6)
    s_barrier
    s_add_u32 m0, s45, 84992
    s_add_u32 s52, s51, 30720
    buffer_load_dwordx4 v217, s[12:15], s52 offen lds
    s_add_u32 m0, s46, 84992
    s_add_u32 s52, s48, 46080
    buffer_load_dwordx4 v219, s[16:19], s52 offen lds
    s_add_u32 m0, s45, 86016
    s_add_u32 s52, s51, 40960
    buffer_load_dwordx4 v216, s[12:15], s52 offen lds
    s_add_u32 m0, s45, 87040
    s_add_u32 s52, s51, 51200
    buffer_load_dwordx4 v217, s[12:15], s52 offen lds
    s_lshl_b32 s47, s49, 7
    s_mul_i32 s48, s49, 245760
    s_add_u32 s51, s44, s47
    s_add_u32 s48, s48, s50
    s_add_u32 s49, s49, 1
    s_cmp_eq_u32 s49, 10
    s_cselect_b32 s49, 0, s49
    s_add_u32 m0, s46, 0
    s_add_u32 s52, s48, 0
    buffer_load_dwordx4 v218, s[16:19], s52 offen lds
    s_add_u32 m0, s45, 0
    s_max_i32 s52, s51, s47
    buffer_load_dwordx4 v216, s[12:15], s52 offen lds
    s_add_u32 m0, s46, 1024
    s_add_u32 s52, s48, 15360
    buffer_load_dwordx4 v218, s[16:19], s52 offen lds
    s_add_u32 m0, s45, 1024
    s_add_u32 s52, s51, 10240
    s_max_i32 s52, s52, s47
    buffer_load_dwordx4 v217, s[12:15], s52 offen lds
    s_add_u32 m0, s45, 2048
    s_add_u32 s52, s51, 20480
    buffer_load_dwordx4 v216, s[12:15], s52 offen lds
    s_add_u32 m0, s46, 2048
    s_add_u32 s52, s48, 30720
    buffer_load_dwordx4 v219, s[16:19], s52 offen lds
    s_waitcnt vmcnt(6)
    s_barrier
    s_add_u32 m0, s45, 3072
    s_add_u32 s52, s51, 30720
    buffer_load_dwordx4 v217, s[12:15], s52 offen lds
    s_add_u32 m0, s46, 3072
    s_add_u32 s52, s48, 46080
    buffer_load_dwordx4 v219, s[16:19], s52 offen lds
    s_add_u32 m0, s45, 4096
    s_add_u32 s52, s51, 40960
    buffer_load_dwordx4 v216, s[12:15], s52 offen lds
    s_add_u32 m0, s45, 5120
    s_add_u32 s52, s51, 51200
    buffer_load_dwordx4 v217, s[12:15], s52 offen lds
    s_lshl_b32 s47, s49, 7
    s_mul_i32 s48, s49, 245760
    s_add_u32 s51, s44, s47
    s_add_u32 s48, s48, s50
    s_add_u32 s49, s49, 1
    s_cmp_eq_u32 s49, 10
    s_cselect_b32 s49, 0, s49
    s_add_u32 m0, s46, 40960
    s_add_u32 s52, s48, 0
    buffer_load_dwordx4 v218, s[16:19], s52 offen lds
    s_add_u32 m0, s45, 40960
    s_max_i32 s52, s51, s47
    buffer_load_dwordx4 v216, s[12:15], s52 offen lds
    s_add_u32 m0, s46, 41984
    s_add_u32 s52, s48, 15360
    buffer_load_dwordx4 v218, s[16:19], s52 offen lds
    s_add_u32 m0, s45, 41984
    s_add_u32 s52, s51, 10240
    s_max_i32 s52, s52, s47
    buffer_load_dwordx4 v217, s[12:15], s52 offen lds
    s_add_u32 m0, s45, 43008
    s_add_u32 s52, s51, 20480
    buffer_load_dwordx4 v216, s[12:15], s52 offen lds
    s_add_u32 m0, s46, 43008
    s_add_u32 s52, s48, 30720
    buffer_load_dwordx4 v219, s[16:19], s52 offen lds
    s_waitcnt vmcnt(6)
    s_barrier
    s_add_u32 m0, s45, 44032
    s_add_u32 s52, s51, 30720
    buffer_load_dwordx4 v217, s[12:15], s52 offen lds
    s_add_u32 m0, s46, 44032
    s_add_u32 s52, s48, 46080
    buffer_load_dwordx4 v219, s[16:19], s52 offen lds
    s_add_u32 m0, s45, 45056
    s_add_u32 s52, s51, 40960
    buffer_load_dwordx4 v216, s[12:15], s52 offen lds
    s_add_u32 m0, s45, 46080
    s_add_u32 s52, s51, 51200
    buffer_load_dwordx4 v217, s[12:15], s52 offen lds
    s_lshl_b32 s47, s49, 7
    s_mul_i32 s48, s49, 245760
    s_add_u32 s51, s44, s47
    s_add_u32 s48, s48, s50
    s_add_u32 s49, s49, 1
    s_cmp_eq_u32 s49, 10
    s_cselect_b32 s49, 0, s49
    s_add_u32 m0, s46, 81920
    s_add_u32 s52, s48, 0
    buffer_load_dwordx4 v218, s[16:19], s52 offen lds
    s_add_u32 m0, s45, 81920
    s_max_i32 s52, s51, s47
    buffer_load_dwordx4 v216, s[12:15], s52 offen lds
    s_add_u32 m0, s46, 82944
    s_add_u32 s52, s48, 15360
    buffer_load_dwordx4 v218, s[16:19], s52 offen lds
    s_add_u32 m0, s45, 82944
    s_add_u32 s52, s51, 10240
    s_max_i32 s52, s52, s47
    buffer_load_dwordx4 v217, s[12:15], s52 offen lds
    s_add_u32 m0, s45, 83968
    s_add_u32 s52, s51, 20480
    buffer_load_dwordx4 v216, s[12:15], s52 offen lds
    s_add_u32 m0, s46, 83968
    s_add_u32 s52, s48, 30720
    buffer_load_dwordx4 v219, s[16:19], s52 offen lds
    s_waitcnt vmcnt(6)
    s_barrier
    s_add_u32 m0, s45, 84992
    s_add_u32 s52, s51, 30720
    buffer_load_dwordx4 v217, s[12:15], s52 offen lds
    s_add_u32 m0, s46, 84992
    s_add_u32 s52, s48, 46080
    buffer_load_dwordx4 v219, s[16:19], s52 offen lds
    s_add_u32 m0, s45, 86016
    s_add_u32 s52, s51, 40960
    buffer_load_dwordx4 v216, s[12:15], s52 offen lds
    s_add_u32 m0, s45, 87040
    s_add_u32 s52, s51, 51200
    buffer_load_dwordx4 v217, s[12:15], s52 offen lds
    s_lshl_b32 s47, s49, 7
    s_mul_i32 s48, s49, 245760
    s_add_u32 s51, s44, s47
    s_add_u32 s48, s48, s50
    s_add_u32 s49, s49, 1
    s_cmp_eq_u32 s49, 10
    s_cselect_b32 s49, 0, s49
    s_add_u32 m0, s46, 0
    s_add_u32 s52, s48, 0
    buffer_load_dwordx4 v218, s[16:19], s52 offen lds
    s_add_u32 m0, s45, 0
    s_max_i32 s52, s51, s47
    buffer_load_dwordx4 v216, s[12:15], s52 offen lds
    s_add_u32 m0, s46, 1024
    s_add_u32 s52, s48, 15360
    buffer_load_dwordx4 v218, s[16:19], s52 offen lds
    s_add_u32 m0, s45, 1024
    s_add_u32 s52, s51, 10240
    s_max_i32 s52, s52, s47
    buffer_load_dwordx4 v217, s[12:15], s52 offen lds
    s_add_u32 m0, s45, 2048
    s_add_u32 s52, s51, 20480
    buffer_load_dwordx4 v216, s[12:15], s52 offen lds
    s_add_u32 m0, s46, 2048
    s_add_u32 s52, s48, 30720
    buffer_load_dwordx4 v219, s[16:19], s52 offen lds
    s_waitcnt vmcnt(6)
    s_barrier
    s_add_u32 m0, s45, 3072
    s_add_u32 s52, s51, 30720
    s_branch K_PG0
.p2align 12
K_CHM0:
K_STM0:
    s_branch K_WRET_M
    s_nop 0
K_PG0:
    buffer_load_dwordx4 v217, s[12:15], s52 offen lds
    s_add_u32 m0, s46, 3072
    s_add_u32 s52, s48, 46080
    buffer_load_dwordx4 v219, s[16:19], s52 offen lds
    s_add_u32 m0, s45, 4096
    s_add_u32 s52, s51, 40960
    buffer_load_dwordx4 v216, s[12:15], s52 offen lds
    s_add_u32 m0, s45, 5120
    s_add_u32 s52, s51, 51200
    buffer_load_dwordx4 v217, s[12:15], s52 offen lds
    s_lshl_b32 s47, s49, 7
    s_mul_i32 s48, s49, 245760
    s_add_u32 s51, s44, s47
    s_add_u32 s48, s48, s50
    s_add_u32 s49, s49, 1
    s_cmp_eq_u32 s49, 10
    s_cselect_b32 s49, 0, s49
    s_add_u32 m0, s46, 40960
    s_add_u32 s52, s48, 0
    buffer_load_dwordx4 v218, s[16:19], s52 offen lds
    s_add_u32 m0, s45, 40960
    s_max_i32 s52, s51, s47
    buffer_load_dwordx4 v216, s[12:15], s52 offen lds
    s_add_u32 m0, s46, 41984
    s_add_u32 s52, s48, 15360
    buffer_load_dwordx4 v218, s[16:19], s52 offen lds
    s_add_u32 m0, s45, 41984
    s_add_u32 s52, s51, 10240
    s_max_i32 s52, s52, s47
    buffer_load_dwordx4 v217, s[12:15], s52 offen lds
    s_add_u32 m0, s45, 43008
    s_add_u32 s52, s51, 20480
    buffer_load_dwordx4 v216, s[12:15], s52 offen lds
    s_add_u32 m0, s46, 43008
    s_add_u32 s52, s48, 30720
    buffer_load_dwordx4 v219, s[16:19], s52 offen lds
    s_waitcnt vmcnt(6)
    s_barrier
    s_add_u32 m0, s45, 44032
    s_add_u32 s52, s51, 30720
    buffer_load_dwordx4 v217, s[12:15], s52 offen lds
    s_add_u32 m0, s46, 44032
    s_add_u32 s52, s48, 46080
    buffer_load_dwordx4 v219, s[16:19], s52 offen lds
    s_add_u32 m0, s45, 45056
    s_add_u32 s52, s51, 40960
    buffer_load_dwordx4 v216, s[12:15], s52 offen lds
    s_add_u32 m0, s45, 46080
    s_add_u32 s52, s51, 51200
    buffer_load_dwordx4 v217, s[12:15], s52 offen lds
    s_lshl_b32 s47, s49, 7
    s_mul_i32 s48, s49, 245760
    s_add_u32 s51, s44, s47
    s_add_u32 s48, s48, s50
    s_add_u32 s49, s49, 1
    s_cmp_eq_u32 s49, 10
    s_cselect_b32 s49, 0, s49
    s_add_u32 m0, s46, 81920
    s_add_u32 s52, s48, 0
    buffer_load_dwordx4 v218, s[16:19], s52 offen lds
    s_add_u32 m0, s45, 81920
    s_max_i32 s52, s51, s47
    buffer_load_dwordx4 v216, s[12:15], s52 offen lds
    s_add_u32 m0, s46, 82944
    s_add_u32 s52, s48, 15360
    buffer_load_dwordx4 v218, s[16:19], s52 offen lds
    s_add_u32 m0, s45, 82944
    s_add_u32 s52, s51, 10240
    s_max_i32 s52, s52, s47
    buffer_load_dwordx4 v217, s[12:15], s52 offen lds
    s_add_u32 m0, s45, 83968
    s_add_u32 s52, s51, 20480
    buffer_load_dwordx4 v216, s[12:15], s52 offen lds
    s_add_u32 m0, s46, 83968
    s_add_u32 s52, s48, 30720
    buffer_load_dwordx4 v219, s[16:19], s52 offen lds
    s_waitcnt vmcnt(6)
    s_barrier
    s_load_dword s54, s[4:5], 192
    s_add_u32 m0, s45, 84992
    s_add_u32 s52, s51, 30720
    buffer_load_dwordx4 v217, s[12:15], s52 offen lds
    s_add_u32 m0, s46, 84992
    s_add_u32 s52, s48, 46080
    buffer_load_dwordx4 v219, s[16:19], s52 offen lds
    s_add_u32 m0, s45, 86016
    s_add_u32 s52, s51, 40960
    buffer_load_dwordx4 v216, s[12:15], s52 offen lds
    s_add_u32 m0, s45, 87040
    s_add_u32 s52, s51, 51200
    buffer_load_dwordx4 v217, s[12:15], s52 offen lds
    s_waitcnt lgkmcnt(0)
    s_cmp_ge_u32 s54, 8
    s_cbranch_scc1 K_ZO0
    s_mov_b32 s3, 16384
K_ZB0:
    v_mov_b32 v4, 192
    global_load_dword v4, v4, s[4:5] sc1
    s_waitcnt vmcnt(0)
    v_readfirstlane_b32 s33, v4
    s_cmp_ge_u32 s33, 8
    s_cbranch_scc1 K_ZO0
    s_sleep 8
    s_sub_u32 s3, s3, 1
    s_cbranch_scc0 K_ZB0
K_ZO0:
    s_cmp_eq_u32 s34, -1
    s_cbranch_scc1 K_NOLT
    s_lshl_b32 s47, s43, 2
    s_lshr_b32 s47, 0x7520, s47
    s_and_b32 s47, s47, 7
    s_mul_i32 s47, s47, 51200
    s_lshl_b32 s48, s43, 12
    s_add_u32 s3, s47, 0
    s_add_u32 m0, s48, 0
    s_nop 0
    buffer_load_dwordx4 v222, s[24:27], s3 offen lds
    s_add_u32 s3, s47, 10240
    s_add_u32 m0, s48, 1024
    s_nop 0
    buffer_load_dwordx4 v222, s[24:27], s3 offen lds
    s_add_u32 s3, s47, 25600
    s_add_u32 m0, s48, 2048
    s_nop 0
    buffer_load_dwordx4 v222, s[24:27], s3 offen lds
    s_add_u32 s3, s47, 35840
    s_add_u32 m0, s48, 3072
    s_nop 0
    buffer_load_dwordx4 v222, s[24:27], s3 offen lds
    s_add_u32 s3, s47, 409600
    s_add_u32 m0, s48, 20480
    s_nop 0
    buffer_load_dwordx4 v222, s[24:27], s3 offen lds
    s_add_u32 s3, s47, 419840
    s_add_u32 m0, s48, 21504
    s_nop 0
    buffer_load_dwordx4 v222, s[24:27], s3 offen lds
    s_add_u32 s3, s47, 435200
    s_add_u32 m0, s48, 22528
    s_nop 0
    buffer_load_dwordx4 v222, s[24:27], s3 offen lds
    s_add_u32 s3, s47, 445440
    s_add_u32 m0, s48, 23552
    s_nop 0
    buffer_load_dwordx4 v222, s[24:27], s3 offen lds
    s_lshl_b32 s48, s43, 10
    s_add_u32 s3, s47, 20480
    s_add_u32 m0, s48, 16384
    s_nop 0
    buffer_load_dwordx4 v5, s[24:27], s3 offen lds
    s_add_u32 s3, s47, 430080
    s_add_u32 m0, s48, 36864
    s_nop 0
    buffer_load_dwordx4 v5, s[24:27], s3 offen lds
    s_waitcnt vmcnt(10)
    s_barrier
    s_mov_b32 s33, 81920
    s_cmp_eq_u32 s43, 3
    s_cselect_b32 s3, 0, 163840
    buffer_store_dwordx4 v[224:227], v220, s[20:23], 0 offen sc1
    buffer_store_dwordx4 v[224:227], v220, s[20:23], s33 offen sc1
    buffer_store_dwordx4 v[224:227], v220, s[20:23], s3 offen sc1
    buffer_store_dwordx4 v[224:227], v221, s[20:23], 0 offen sc1
    v_mov_b32 v2, 158720
    v_mov_b32 v3, 1
    s_waitcnt vmcnt(0)
    s_mov_b64 exec, 1
    ds_add_u32 v2, v3 offset:28
    ds_add_u32 v2, v3 offset:32
    s_mov_b64 exec, -1
    s_lshl_b32 s47, s43, 2
    s_lshr_b32 s47, 0x6431, s47
    s_and_b32 s47, s47, 7
    s_mul_i32 s47, s47, 51200
    s_lshl_b32 s48, s43, 12
    s_add_u32 s3, s47, 0
    s_add_u32 m0, s48, 40960
    s_nop 0
    buffer_load_dwordx4 v222, s[24:27], s3 offen lds
    s_add_u32 s3, s47, 10240
    s_add_u32 m0, s48, 41984
    s_nop 0
    buffer_load_dwordx4 v222, s[24:27], s3 offen lds
    s_add_u32 s3, s47, 25600
    s_add_u32 m0, s48, 43008
    s_nop 0
    buffer_load_dwordx4 v222, s[24:27], s3 offen lds
    s_add_u32 s3, s47, 35840
    s_add_u32 m0, s48, 44032
    s_nop 0
    buffer_load_dwordx4 v222, s[24:27], s3 offen lds
    s_add_u32 s3, s47, 409600
    s_add_u32 m0, s48, 61440
    s_nop 0
    buffer_load_dwordx4 v222, s[24:27], s3 offen lds
    s_add_u32 s3, s47, 419840
    s_add_u32 m0, s48, 62464
    s_nop 0
    buffer_load_dwordx4 v222, s[24:27], s3 offen lds
    s_add_u32 s3, s47, 435200
    s_add_u32 m0, s48, 63488
    s_nop 0
    buffer_load_dwordx4 v222, s[24:27], s3 offen lds
    s_add_u32 s3, s47, 445440
    s_add_u32 m0, s48, 64512
    s_nop 0
    buffer_load_dwordx4 v222, s[24:27], s3 offen lds
    s_lshl_b32 s48, s43, 10
    s_add_u32 s3, s47, 20480
    s_add_u32 m0, s48, 57344
    s_nop 0
    buffer_load_dwordx4 v5, s[24:27], s3 offen lds
    s_add_u32 s3, s47, 430080
    s_add_u32 m0, s48, 77824
    s_nop 0
    buffer_load_dwordx4 v5, s[24:27], s3 offen lds
    s_branch K_P2_GM
K_NOLT:
    s_waitcnt vmcnt(0)
    s_barrier
    s_mov_b32 s33, 81920
    s_cmp_eq_u32 s43, 3
    s_cselect_b32 s3, 0, 163840
    buffer_store_dwordx4 v[224:227], v220, s[20:23], 0 offen sc1
    buffer_store_dwordx4 v[224:227], v220, s[20:23], s33 offen sc1
    buffer_store_dwordx4 v[224:227], v220, s[20:23], s3 offen sc1
    buffer_store_dwordx4 v[224:227], v221, s[20:23], 0 offen sc1
    v_mov_b32 v2, 158720
    v_mov_b32 v3, 1
    s_waitcnt vmcnt(0)
    s_mov_b64 exec, 1
    ds_add_u32 v2, v3 offset:28
    ds_add_u32 v2, v3 offset:32
    s_mov_b64 exec, -1
    s_branch K_END
K_CONS:
    v_and_b32 v1, 63, v0
    v_and_b32 v8, 15, v1
    v_lshrrev_b32 v9, 4, v1
    v_bfe_u32 v10, v1, 2, 2
    v_and_b32 v11, 3, v1
    s_bfe_u32 s54, s30, 0x10001
    s_and_b32 s55, s30, 1
    v_lshrrev_b32 v2, 1, v8
    v_xor_b32 v2, v2, v9
    v_lshlrev_b32 v2, 4, v2
    v_lshl_add_u32 v2, v8, 7, v2
    s_mul_i32 s3, s54, 12288
    v_add_u32 v39, s3, v2
    v_xor_b32 v40, 64, v39
    v_add_u32 v41, 81920, v39
    v_add_u32 v42, 81920, v40
    v_and_b32 v2, 1, v9
    v_lshl_or_b32 v2, v2, 2, v10
    s_mul_i32 s3, s55, 40
    v_lshl_add_u32 v2, v2, 5, s3
    v_lshl_add_u32 v3, v9, 3, v10
    v_lshlrev_b32 v3, 8, v3
    v_add_u32 v3, 24576, v3
    v_lshl_add_u32 v5, v11, 3, v2
    s_mul_i32 s33, s55, 805306368
    s_sub_u32 s33, 0xf870c020, s33
    v_add_u32 v4, 0, v5
    v_and_b32 v4, 255, v4
    v_add_u32 v43, v4, v3
    v_add_u32 v47, 81920, v43
    v_add_u32 v4, 160, v5
    v_and_b32 v4, 255, v4
    v_add_u32 v44, v4, v3
    v_add_u32 v48, 81920, v44
    v_add_u32 v4, 80, v5
    v_and_b32 v4, 255, v4
    v_add_u32 v45, v4, v3
    v_add_u32 v49, 81920, v45
    v_lshlrev_b32 v4, 3, v11
    v_bfe_u32 v4, s33, v4, 8
    v_add_u32 v4, v4, v2
    v_and_b32 v4, 255, v4
    v_add_u32 v46, v4, v3
    v_add_u32 v50, 81920, v46
    v_and_b32 v1, 63, v0
    v_mov_b32 v7, 0
    s_and_b32 s28, s2, 7
    s_lshr_b32 s29, s2, 3
    s_xor_b32 s30, s30, 4
    s_lshr_b32 s34, s29, 3
    s_lshl_b32 s34, s34, 2
    s_and_b32 s3, s29, 3
    s_add_u32 s34, s34, s3
    s_add_u32 s34, s34, 4
    s_bitcmp1_b32 s29, 2
    s_cselect_b32 s34, -1, s34
    s_cmp_lt_u32 s29, 8
    s_cselect_b32 s34, s29, s34
    s_lshl_b32 s40, s28, 1
    s_cmp_ge_u32 s34, 10
    s_addc_u32 s40, s40, 0
    s_sub_u32 s41, s34, 10
    s_cmp_ge_u32 s34, 10
    s_cselect_b32 s41, s41, s34
    s_mul_i32 s42, s28, 20
    s_add_u32 s42, s42, s34
    s_and_b32 s42, s42, 255
    s_lshl_b32 s42, s42, 9
    s_add_u32 s42, s42, 524288
    v_mov_b32 v3, 158736
    ds_write2_b32 v3, v7, v7 offset0:0 offset1:1
    ds_write2_b32 v3, v7, v7 offset0:2 offset1:3
    ds_write2_b32 v3, v7, v7 offset0:4 offset1:5
    ds_write2_b32 v3, v7, v7 offset0:6 offset1:7
    ds_write2_b32 v3, v7, v7 offset0:8 offset1:9
    ds_write2_b32 v3, v7, v7 offset0:10 offset1:11
    s_lshr_b32 s31, s28, 1
    s_mul_i32 s31, s31, 3
    s_lshr_b32 s3, s29, 3
    s_add_u32 s31, s31, s3
    s_sub_u32 s31, s31, 1
    s_and_b32 s32, s28, 1
    s_lshl_b32 s32, s32, 3
    s_and_b32 s3, s29, 7
    s_lshl_b32 s3, s3, 2
    s_lshr_b32 s3, 0x64317520, s3
    s_and_b32 s3, s3, 7
    s_add_u32 s32, s32, s3
    s_and_b32 s35, s29, 3
    s_and_b32 s3, s29, 4
    s_lshl_b32 s3, s3, 1
    s_add_u32 s35, s35, s3
    s_and_b32 s3, s28, 1
    s_lshl_b32 s3, s3, 2
    s_add_u32 s35, s35, s3
    s_or_b32 s56, s31, s54
    v_mov_b32 v37, 0xf149f2ca
    v_lshlrev_b32 v2, 2, v9
    v_sub_u32 v2, v8, v2
    s_cmp_eq_u32 s56, 0
    s_cselect_b32 s3, 0xf149f2ca, 0
    v_subrev_u32 v3, 0, v2
    v_and_b32 v4, 0x80000001, v3
    v_cmp_eq_u32 vcc, 0, v4
    s_nop 1
    v_cndmask_b32 v16, v37, 0, vcc
    v_cmp_eq_u32 vcc, 0x80000000, v4
    s_nop 1
    v_cndmask_b32 v12, v37, 0, vcc
    v_add_f32 v20, s3, v12
    v_subrev_u32 v3, 1, v2
    v_and_b32 v4, 0x80000001, v3
    v_cmp_eq_u32 vcc, 0, v4
    s_nop 1
    v_cndmask_b32 v17, v37, 0, vcc
    v_cmp_eq_u32 vcc, 0x80000000, v4
    s_nop 1
    v_cndmask_b32 v13, v37, 0, vcc
    v_add_f32 v21, s3, v13
    v_subrev_u32 v3, 2, v2
    v_and_b32 v4, 0x80000001, v3
    v_cmp_eq_u32 vcc, 0, v4
    s_nop 1
    v_cndmask_b32 v18, v37, 0, vcc
    v_cmp_eq_u32 vcc, 0x80000000, v4
    s_nop 1
    v_cndmask_b32 v14, v37, 0, vcc
    v_add_f32 v22, s3, v14
    v_subrev_u32 v3, 3, v2
    v_and_b32 v4, 0x80000001, v3
    v_cmp_eq_u32 vcc, 0, v4
    s_nop 1
    v_cndmask_b32 v19, v37, 0, vcc
    v_cmp_eq_u32 vcc, 0x80000000, v4
    s_nop 1
    v_cndmask_b32 v15, v37, 0, vcc
    v_add_f32 v23, s3, v15
    v_mov_b32 v3, 0x0c0c0c0c
    v_mov_b32 v4, 0xc0c0100
    v_cmp_eq_u32 vcc, 0, v12
    v_mov_b32 v5, 0x1000c0c
    s_nop 0
    v_cndmask_b32 v3, v3, v4, vcc
    v_cmp_eq_u32 vcc, 0, v13
    s_nop 1
    v_cndmask_b32 v24, v3, v5, vcc
    v_mov_b32 v3, 0x0c0c0c0c
    v_mov_b32 v4, 0xc0c0302
    v_cmp_eq_u32 vcc, 0, v14
    v_mov_b32 v5, 0x3020c0c
    s_nop 0
    v_cndmask_b32 v3, v3, v4, vcc
    v_cmp_eq_u32 vcc, 0, v15
    s_nop 1
    v_cndmask_b32 v25, v3, v5, vcc
    v_mov_b32 v3, 0x0c0c0c0c
    v_mov_b32 v4, 0xc0c0100
    v_cmp_eq_u32 vcc, 0, v16
    v_mov_b32 v5, 0x1000c0c
    s_nop 0
    v_cndmask_b32 v3, v3, v4, vcc
    v_cmp_eq_u32 vcc, 0, v17
    s_nop 1
    v_cndmask_b32 v26, v3, v5, vcc
    v_mov_b32 v3, 0x0c0c0c0c
    v_mov_b32 v4, 0xc0c0302
    v_cmp_eq_u32 vcc, 0, v18
    v_mov_b32 v5, 0x3020c0c
    s_nop 0
    v_cndmask_b32 v3, v3, v4, vcc
    v_cmp_eq_u32 vcc, 0, v19
    s_nop 1
    v_cndmask_b32 v27, v3, v5, vcc
    s_mul_i32 s3, s55, 1664
    s_mul_i32 s33, s54, 768
    s_add_u32 s3, s3, s33
    s_add_u32 s3, s3, 125952
    v_lshl_add_u32 v2, v9, 2, v10
    v_lshl_add_u32 v33, v2, 3, s3
    v_lshl_add_u32 v2, v8, 3, s3
    v_lshlrev_b32 v3, 3, v1
    v_add_u32 v3, 129280, v3
    v_cmp_eq_u32 vcc, 2, v9
    s_mul_i32 s3, s55, 1536
    s_add_u32 s3, s3, 122880
    v_cndmask_b32 v32, v3, v2, vcc
    v_lshl_add_u32 v34, v1, 3, s3
    s_mul_i32 s3, s54, 1536
    s_add_u32 s3, s3, 131328
    s_lshl3_add_u32 s33, s55, s3
    v_lshl_add_u32 v35, v8, 4, s33
    v_cmp_eq_u32 vcc, 0, v9
    s_nop 1
    v_cndmask_b32 v35, v3, v35, vcc
    s_mul_i32 s33, s55, 768
    s_add_u32 s3, s3, s33
    v_lshl_add_u32 v36, v1, 4, s3
    v_mov_b32 v38, 158720
    s_waitcnt lgkmcnt(0)
    s_add_u32 s20, s6, 0x100000
    s_addc_u32 s21, s7, 0
    s_mov_b32 s22, 0x280000
    s_mov_b32 s23, 0x20000
    s_lshr_b32 s53, s35, 2
    s_add_u32 s58, s53, s35
    s_lshl_b32 s58, s58, 12
    s_mul_i32 s59, s53, 19456
    s_lshl_b32 s53, s35, 8
    s_add_u32 s59, s59, s53
    s_add_u32 s59, s59, 16384
    s_mul_i32 s53, s31, 11
    s_mul_i32 s3, s54, 6
    s_add_u32 s53, s53, s3
    s_add_u32 s53, s53, 3
    s_lshl_b32 s3, s55, 9
    s_add_u32 s58, s58, s3
    v_and_b32 v4, 1, v9
    v_lshrrev_b32 v5, 1, v9
    v_add_u32 v3, s53, v4
    v_lshrrev_b32 v2, 2, v3
    v_mul_u32_u24 v2, 76, v2
    v_add_lshl_u32 v2, v2, v3, 10
    v_lshl_add_u32 v2, v8, 4, v2
    v_add_u32 v30, s58, v2
    v_lshl_add_u32 v30, v5, 8, v30
    v_subrev_u32 v3, 2, v3
    v_lshrrev_b32 v2, 2, v3
    v_mul_u32_u24 v2, 76, v2
    v_add_lshl_u32 v2, v2, v3, 10
    v_lshl_add_u32 v2, v8, 4, v2
    v_add_u32 v29, s58, v2
    v_lshl_add_u32 v29, v5, 8, v29
    v_or_b32 v4, s54, v4
    v_cmp_eq_u32 vcc, 0, v4
    v_mov_b32 v5, 0x10000000
    v_subrev_u32 v28, 81920, v30
    v_cndmask_b32 v28, v28, v5, vcc
    s_mul_i32 s3, s55, 3
    s_add_u32 s53, s53, s3
    v_add_u32 v3, s53, v9
    v_lshrrev_b32 v2, 2, v3
    v_mul_u32_u24 v2, 76, v2
    v_add_lshl_u32 v2, v2, v3, 10
    v_lshl_add_u32 v2, v8, 4, v2
    v_add_u32 v31, s59, v2
    v_subrev_u32 v31, 81920, v31
    v_or_b32 v4, s30, v9
    v_cmp_eq_u32 vcc, 0, v4
    s_nop 1
    v_cndmask_b32 v31, v31, v5, vcc
    v_cmp_eq_u32 vcc, 3, v9
    s_nop 1
    v_cndmask_b32 v31, v31, v5, vcc
    s_mul_i32 s3, s31, 11
    s_add_u32 s33, s3, 10
    s_lshr_b32 s3, s3, 3
    s_lshr_b32 s33, s33, 3
    s_min_u32 s33, s33, 15
    s_sub_u32 s33, s33, s3
    s_add_u32 s33, s33, 1
    s_mul_i32 s33, s33, 10
    s_bfm_b32 s37, s33, 0
    v_mul_u32_u24 v2, 205, v1
    v_lshrrev_b32 v2, 11, v2
    v_add_u32 v2, s3, v2
    v_mul_u32_u24 v2, 1496, v2
    v_lshrrev_b32 v2, 11, v2
    v_sub_u32 v2, s31, v2
    v_and_b32 v2, 1, v2
    v_lshlrev_b32 v2, 2, v2
    v_lshl_add_u32 v2, v1, 9, v2
    s_mul_i32 s3, s3, 5120
    s_add_u32 s3, s3, 524288
    v_add_u32 v37, s3, v2
    s_lshr_b32 s36, s35, 2
    s_add_u32 s36, s36, s35
    s_lshl_b32 s36, 1, s36
    s_cmp_eq_u32 s30, 0
    s_cselect_b32 s36, s36, 0
    s_mov_b32 s58, 0x3fb8aa3b
    s_mov_b32 s59, s58
    s_mov_b32 s60, 0x3e64f92e
    s_mov_b32 s61, s60
    s_cmp_eq_u32 s30, 0
    s_cbranch_scc1 K_CHM0
    s_cmp_eq_u32 s30, 1
    s_cbranch_scc1 K_CHM1
    s_cmp_eq_u32 s30, 2
    s_cbranch_scc1 K_CHM2
    s_branch K_CHM3
K_WRET_M:
    s_setprio 2
    s_barrier
K_L0:
    ds_read_b64_tr_b16 v[196:197], v47 offset:0
    ds_read_b64_tr_b16 v[198:199], v47 offset:1024
    ds_read_b128 v[148:151], v41 offset:0
    ds_read_b64_tr_b16 v[200:201], v48 offset:0
    ds_read_b64_tr_b16 v[202:203], v48 offset:1024
    ds_read_b128 v[152:155], v41 offset:2048
    ds_read_b64_tr_b16 v[204:205], v49 offset:0
    ds_read_b64_tr_b16 v[206:207], v49 offset:1024
    ds_read_b128 v[156:159], v41 offset:4096
    ds_read_b64_tr_b16 v[208:209], v50 offset:0
    ds_read_b64_tr_b16 v[210:211], v50 offset:1024
    ds_read_b128 v[160:163], v41 offset:6144
    ds_read_b128 v[164:167], v41 offset:8192
    ds_read_b128 v[168:171], v41 offset:10240
    s_waitcnt lgkmcnt(0)
    v_mfma_f32_16x16x32_bf16 v[52:55], v[196:199], v[148:151], 0
    ds_read_b64_tr_b16 v[212:213], v47 offset:8192
    v_mfma_f32_16x16x32_bf16 v[56:59], v[200:203], v[148:151], 0
    ds_read_b64_tr_b16 v[214:215], v47 offset:9216
    v_mfma_f32_16x16x32_bf16 v[60:63], v[148:151], v[204:207], 0
    ds_read_b128 v[172:175], v42 offset:0
    v_mfma_f32_16x16x32_bf16 v[64:67], v[208:211], v[148:151], 0
    ds_read_b64_tr_b16 v[216:217], v48 offset:8192
    v_mfma_f32_16x16x32_bf16 v[80:83], v[208:211], v[152:155], 0
    ds_read_b64_tr_b16 v[218:219], v48 offset:9216
    v_mfma_f32_16x16x32_bf16 v[76:79], v[152:155], v[204:207], 0
    ds_read_b128 v[176:179], v42 offset:2048
    v_mfma_f32_16x16x32_bf16 v[72:75], v[200:203], v[152:155], 0
    ds_read_b64_tr_b16 v[220:221], v49 offset:8192
    v_mfma_f32_16x16x32_bf16 v[68:71], v[196:199], v[152:155], 0
    ds_read_b64_tr_b16 v[222:223], v49 offset:9216
    v_mfma_f32_16x16x32_bf16 v[84:87], v[196:199], v[156:159], 0
    ds_read_b128 v[180:183], v42 offset:4096
    v_mfma_f32_16x16x32_bf16 v[88:91], v[200:203], v[156:159], 0
    ds_read_b64_tr_b16 v[224:225], v50 offset:8192
    v_mfma_f32_16x16x32_bf16 v[92:95], v[156:159], v[204:207], 0
    ds_read_b64_tr_b16 v[226:227], v50 offset:9216
    v_mfma_f32_16x16x32_bf16 v[96:99], v[208:211], v[156:159], 0
    ds_read_b128 v[184:187], v42 offset:6144
    v_mfma_f32_16x16x32_bf16 v[112:115], v[208:211], v[160:163], 0
    ds_read_b128 v[188:191], v42 offset:8192
    v_mfma_f32_16x16x32_bf16 v[108:111], v[160:163], v[204:207], 0
    ds_read_b128 v[192:195], v42 offset:10240
    v_mfma_f32_16x16x32_bf16 v[104:107], v[200:203], v[160:163], 0
    v_mfma_f32_16x16x32_bf16 v[100:103], v[196:199], v[160:163], 0
    v_mfma_f32_16x16x32_bf16 v[116:119], v[196:199], v[164:167], 0
    v_mfma_f32_16x16x32_bf16 v[120:123], v[200:203], v[164:167], 0
    v_mfma_f32_16x16x32_bf16 v[124:127], v[164:167], v[204:207], 0
    v_mfma_f32_16x16x32_bf16 v[128:131], v[208:211], v[164:167], 0
    v_mfma_f32_16x16x32_bf16 v[144:147], v[208:211], v[168:171], 0
    v_mfma_f32_16x16x32_bf16 v[140:143], v[168:171], v[204:207], 0
    v_mfma_f32_16x16x32_bf16 v[136:139], v[200:203], v[168:171], 0
    v_mfma_f32_16x16x32_bf16 v[132:135], v[196:199], v[168:171], 0
    s_waitcnt lgkmcnt(0)
    s_barrier
    v_mfma_f32_16x16x32_bf16 v[52:55], v[212:215], v[172:175], v[52:55]
    ds_read_b64_tr_b16 v[196:197], v43 offset:0
    v_mfma_f32_16x16x32_bf16 v[56:59], v[216:219], v[172:175], v[56:59]
    ds_read_b64_tr_b16 v[198:199], v43 offset:1024
    v_mfma_f32_16x16x32_bf16 v[60:63], v[172:175], v[220:223], v[60:63]
    ds_read_b128 v[148:151], v39 offset:0
    v_mfma_f32_16x16x32_bf16 v[64:67], v[224:227], v[172:175], v[64:67]
    ds_read_b64_tr_b16 v[200:201], v44 offset:0
    v_mfma_f32_16x16x32_bf16 v[80:83], v[224:227], v[176:179], v[80:83]
    ds_read_b64_tr_b16 v[202:203], v44 offset:1024
    v_mfma_f32_16x16x32_bf16 v[76:79], v[176:179], v[220:223], v[76:79]
    ds_read_b128 v[152:155], v39 offset:2048
    v_mfma_f32_16x16x32_bf16 v[72:75], v[216:219], v[176:179], v[72:75]
    ds_read_b64_tr_b16 v[204:205], v45 offset:0
    v_mfma_f32_16x16x32_bf16 v[68:71], v[212:215], v[176:179], v[68:71]
    ds_read_b64_tr_b16 v[206:207], v45 offset:1024
    v_mfma_f32_16x16x32_bf16 v[84:87], v[212:215], v[180:183], v[84:87]
    ds_read_b128 v[156:159], v39 offset:4096
    v_mfma_f32_16x16x32_bf16 v[88:91], v[216:219], v[180:183], v[88:91]
    ds_read_b64_tr_b16 v[208:209], v46 offset:0
    v_mfma_f32_16x16x32_bf16 v[92:95], v[180:183], v[220:223], v[92:95]
    ds_read_b64_tr_b16 v[210:211], v46 offset:1024
    v_mfma_f32_16x16x32_bf16 v[96:99], v[224:227], v[180:183], v[96:99]
    ds_read_b128 v[160:163], v39 offset:6144
    v_mfma_f32_16x16x32_bf16 v[112:115], v[224:227], v[184:187], v[112:115]
    ds_read_b128 v[164:167], v39 offset:8192
    v_mfma_f32_16x16x32_bf16 v[108:111], v[184:187], v[220:223], v[108:111]
    ds_read_b128 v[168:171], v39 offset:10240
    v_mfma_f32_16x16x32_bf16 v[104:107], v[216:219], v[184:187], v[104:107]
    v_mfma_f32_16x16x32_bf16 v[100:103], v[212:215], v[184:187], v[100:103]
    v_mfma_f32_16x16x32_bf16 v[116:119], v[212:215], v[188:191], v[116:119]
    v_mfma_f32_16x16x32_bf16 v[120:123], v[216:219], v[188:191], v[120:123]
    v_mfma_f32_16x16x32_bf16 v[124:127], v[188:191], v[220:223], v[124:127]
    v_mfma_f32_16x16x32_bf16 v[128:131], v[224:227], v[188:191], v[128:131]
    v_mfma_f32_16x16x32_bf16 v[144:147], v[224:227], v[192:195], v[144:147]
    v_mfma_f32_16x16x32_bf16 v[140:143], v[192:195], v[220:223], v[140:143]
    v_mfma_f32_16x16x32_bf16 v[136:139], v[216:219], v[192:195], v[136:139]
    v_mfma_f32_16x16x32_bf16 v[132:135], v[212:215], v[192:195], v[132:135]
    s_waitcnt lgkmcnt(0)
    v_mfma_f32_16x16x32_bf16 v[52:55], v[196:199], v[148:151], v[52:55]
    ds_read_b64_tr_b16 v[212:213], v43 offset:8192
    v_mfma_f32_16x16x32_bf16 v[56:59], v[200:203], v[148:151], v[56:59]
    ds_read_b64_tr_b16 v[214:215], v43 offset:9216
    v_mfma_f32_16x16x32_bf16 v[60:63], v[148:151], v[204:207], v[60:63]
    ds_read_b128 v[172:175], v40 offset:0
    v_mfma_f32_16x16x32_bf16 v[64:67], v[208:211], v[148:151], v[64:67]
    ds_read_b64_tr_b16 v[216:217], v44 offset:8192
    v_mfma_f32_16x16x32_bf16 v[80:83], v[208:211], v[152:155], v[80:83]
    ds_read_b64_tr_b16 v[218:219], v44 offset:9216
    v_mfma_f32_16x16x32_bf16 v[76:79], v[152:155], v[204:207], v[76:79]
    ds_read_b128 v[176:179], v40 offset:2048
    v_mfma_f32_16x16x32_bf16 v[72:75], v[200:203], v[152:155], v[72:75]
    ds_read_b64_tr_b16 v[220:221], v45 offset:8192
    v_mfma_f32_16x16x32_bf16 v[68:71], v[196:199], v[152:155], v[68:71]
    ds_read_b64_tr_b16 v[222:223], v45 offset:9216
    v_mfma_f32_16x16x32_bf16 v[84:87], v[196:199], v[156:159], v[84:87]
    ds_read_b128 v[180:183], v40 offset:4096
    v_mfma_f32_16x16x32_bf16 v[88:91], v[200:203], v[156:159], v[88:91]
    ds_read_b64_tr_b16 v[224:225], v46 offset:8192
    v_mfma_f32_16x16x32_bf16 v[92:95], v[156:159], v[204:207], v[92:95]
    ds_read_b64_tr_b16 v[226:227], v46 offset:9216
    v_mfma_f32_16x16x32_bf16 v[96:99], v[208:211], v[156:159], v[96:99]
    ds_read_b128 v[184:187], v40 offset:6144
    v_mfma_f32_16x16x32_bf16 v[112:115], v[208:211], v[160:163], v[112:115]
    ds_read_b128 v[188:191], v40 offset:8192
    v_mfma_f32_16x16x32_bf16 v[108:111], v[160:163], v[204:207], v[108:111]
    ds_read_b128 v[192:195], v40 offset:10240
    s_branch K_PG1
.p2align 12
K_CHM1:
K_STM1:
    s_branch K_WRET_M
    s_nop 0
K_PG1:
    v_mfma_f32_16x16x32_bf16 v[104:107], v[200:203], v[160:163], v[104:107]
    v_mfma_f32_16x16x32_bf16 v[100:103], v[196:199], v[160:163], v[100:103]
    v_mfma_f32_16x16x32_bf16 v[116:119], v[196:199], v[164:167], v[116:119]
    v_mfma_f32_16x16x32_bf16 v[120:123], v[200:203], v[164:167], v[120:123]
    v_mfma_f32_16x16x32_bf16 v[124:127], v[164:167], v[204:207], v[124:127]
    v_mfma_f32_16x16x32_bf16 v[128:131], v[208:211], v[164:167], v[128:131]
    v_mfma_f32_16x16x32_bf16 v[144:147], v[208:211], v[168:171], v[144:147]
    v_mfma_f32_16x16x32_bf16 v[140:143], v[168:171], v[204:207], v[140:143]
    v_mfma_f32_16x16x32_bf16 v[136:139], v[200:203], v[168:171], v[136:139]
    v_mfma_f32_16x16x32_bf16 v[132:135], v[196:199], v[168:171], v[132:135]
    s_waitcnt lgkmcnt(0)
    s_barrier
    v_mfma_f32_16x16x32_bf16 v[52:55], v[212:215], v[172:175], v[52:55]
    ds_read_b64_tr_b16 v[196:197], v43 offset:40960
    v_mfma_f32_16x16x32_bf16 v[56:59], v[216:219], v[172:175], v[56:59]
    ds_read_b64_tr_b16 v[198:199], v43 offset:41984
    v_mfma_f32_16x16x32_bf16 v[60:63], v[172:175], v[220:223], v[60:63]
    ds_read_b128 v[148:151], v39 offset:40960
    v_mfma_f32_16x16x32_bf16 v[64:67], v[224:227], v[172:175], v[64:67]
    ds_read_b64_tr_b16 v[200:201], v44 offset:40960
    v_mfma_f32_16x16x32_bf16 v[80:83], v[224:227], v[176:179], v[80:83]
    ds_read_b64_tr_b16 v[202:203], v44 offset:41984
    v_mfma_f32_16x16x32_bf16 v[76:79], v[176:179], v[220:223], v[76:79]
    ds_read_b128 v[152:155], v39 offset:43008
    v_mfma_f32_16x16x32_bf16 v[72:75], v[216:219], v[176:179], v[72:75]
    ds_read_b64_tr_b16 v[204:205], v45 offset:40960
    v_mfma_f32_16x16x32_bf16 v[68:71], v[212:215], v[176:179], v[68:71]
    ds_read_b64_tr_b16 v[206:207], v45 offset:41984
    v_mfma_f32_16x16x32_bf16 v[84:87], v[212:215], v[180:183], v[84:87]
    ds_read_b128 v[156:159], v39 offset:45056
    v_mfma_f32_16x16x32_bf16 v[88:91], v[216:219], v[180:183], v[88:91]
    ds_read_b64_tr_b16 v[208:209], v46 offset:40960
    v_mfma_f32_16x16x32_bf16 v[92:95], v[180:183], v[220:223], v[92:95]
    ds_read_b64_tr_b16 v[210:211], v46 offset:41984
    v_mfma_f32_16x16x32_bf16 v[96:99], v[224:227], v[180:183], v[96:99]
    ds_read_b128 v[160:163], v39 offset:47104
    v_mfma_f32_16x16x32_bf16 v[112:115], v[224:227], v[184:187], v[112:115]
    ds_read_b128 v[164:167], v39 offset:49152
    v_mfma_f32_16x16x32_bf16 v[108:111], v[184:187], v[220:223], v[108:111]
    ds_read_b128 v[168:171], v39 offset:51200
    v_mfma_f32_16x16x32_bf16 v[104:107], v[216:219], v[184:187], v[104:107]
    v_mfma_f32_16x16x32_bf16 v[100:103], v[212:215], v[184:187], v[100:103]
    v_mfma_f32_16x16x32_bf16 v[116:119], v[212:215], v[188:191], v[116:119]
    v_mfma_f32_16x16x32_bf16 v[120:123], v[216:219], v[188:191], v[120:123]
    v_mfma_f32_16x16x32_bf16 v[124:127], v[188:191], v[220:223], v[124:127]
    v_mfma_f32_16x16x32_bf16 v[128:131], v[224:227], v[188:191], v[128:131]
    v_mfma_f32_16x16x32_bf16 v[144:147], v[224:227], v[192:195], v[144:147]
    v_mfma_f32_16x16x32_bf16 v[140:143], v[192:195], v[220:223], v[140:143]
    v_mfma_f32_16x16x32_bf16 v[136:139], v[216:219], v[192:195], v[136:139]
    v_mfma_f32_16x16x32_bf16 v[132:135], v[212:215], v[192:195], v[132:135]
    s_waitcnt lgkmcnt(0)
    v_mfma_f32_16x16x32_bf16 v[52:55], v[196:199], v[148:151], v[52:55]
    ds_read_b64_tr_b16 v[212:213], v43 offset:49152
    v_mfma_f32_16x16x32_bf16 v[56:59], v[200:203], v[148:151], v[56:59]
    ds_read_b64_tr_b16 v[214:215], v43 offset:50176
    v_mfma_f32_16x16x32_bf16 v[60:63], v[148:151], v[204:207], v[60:63]
    ds_read_b128 v[172:175], v40 offset:40960
    v_mfma_f32_16x16x32_bf16 v[64:67], v[208:211], v[148:151], v[64:67]
    ds_read_b64_tr_b16 v[216:217], v44 offset:49152
    v_mfma_f32_16x16x32_bf16 v[80:83], v[208:211], v[152:155], v[80:83]
    ds_read_b64_tr_b16 v[218:219], v44 offset:50176
    v_mfma_f32_16x16x32_bf16 v[76:79], v[152:155], v[204:207], v[76:79]
    ds_read_b128 v[176:179], v40 offset:43008
    v_mfma_f32_16x16x32_bf16 v[72:75], v[200:203], v[152:155], v[72:75]
    ds_read_b64_tr_b16 v[220:221], v45 offset:49152
    v_mfma_f32_16x16x32_bf16 v[68:71], v[196:199], v[152:155], v[68:71]
    ds_read_b64_tr_b16 v[222:223], v45 offset:50176
    v_mfma_f32_16x16x32_bf16 v[84:87], v[196:199], v[156:159], v[84:87]
    ds_read_b128 v[180:183], v40 offset:45056
    v_mfma_f32_16x16x32_bf16 v[88:91], v[200:203], v[156:159], v[88:91]
    ds_read_b64_tr_b16 v[224:225], v46 offset:49152
    v_mfma_f32_16x16x32_bf16 v[92:95], v[156:159], v[204:207], v[92:95]
    ds_read_b64_tr_b16 v[226:227], v46 offset:50176
    v_mfma_f32_16x16x32_bf16 v[96:99], v[208:211], v[156:159], v[96:99]
    ds_read_b128 v[184:187], v40 offset:47104
    v_mfma_f32_16x16x32_bf16 v[112:115], v[208:211], v[160:163], v[112:115]
    ds_read_b128 v[188:191], v40 offset:49152
    v_mfma_f32_16x16x32_bf16 v[108:111], v[160:163], v[204:207], v[108:111]
    ds_read_b128 v[192:195], v40 offset:51200
    v_mfma_f32_16x16x32_bf16 v[104:107], v[200:203], v[160:163], v[104:107]
    v_mfma_f32_16x16x32_bf16 v[100:103], v[196:199], v[160:163], v[100:103]
    v_mfma_f32_16x16x32_bf16 v[116:119], v[196:199], v[164:167], v[116:119]
    v_mfma_f32_16x16x32_bf16 v[120:123], v[200:203], v[164:167], v[120:123]
    v_mfma_f32_16x16x32_bf16 v[124:127], v[164:167], v[204:207], v[124:127]
    v_mfma_f32_16x16x32_bf16 v[128:131], v[208:211], v[164:167], v[128:131]
    v_mfma_f32_16x16x32_bf16 v[144:147], v[208:211], v[168:171], v[144:147]
    v_mfma_f32_16x16x32_bf16 v[140:143], v[168:171], v[204:207], v[140:143]
    v_mfma_f32_16x16x32_bf16 v[136:139], v[200:203], v[168:171], v[136:139]
    v_mfma_f32_16x16x32_bf16 v[132:135], v[196:199], v[168:171], v[132:135]
    s_waitcnt lgkmcnt(0)
    s_barrier
    v_mfma_f32_16x16x32_bf16 v[52:55], v[212:215], v[172:175], v[52:55]
    ds_read_b64_tr_b16 v[196:197], v47 offset:0
    v_mfma_f32_16x16x32_bf16 v[56:59], v[216:219], v[172:175], v[56:59]
    ds_read_b64_tr_b16 v[198:199], v47 offset:1024
    v_mfma_f32_16x16x32_bf16 v[60:63], v[172:175], v[220:223], v[60:63]
    ds_read_b128 v[148:151], v41 offset:0
    v_mfma_f32_16x16x32_bf16 v[64:67], v[224:227], v[172:175], v[64:67]
    ds_read_b64_tr_b16 v[200:201], v48 offset:0
    v_mfma_f32_16x16x32_bf16 v[80:83], v[224:227], v[176:179], v[80:83]
    ds_read_b64_tr_b16 v[202:203], v48 offset:1024
    v_mfma_f32_16x16x32_bf16 v[76:79], v[176:179], v[220:223], v[76:79]
    ds_read_b128 v[152:155], v41 offset:2048
    v_mfma_f32_16x16x32_bf16 v[72:75], v[216:219], v[176:179], v[72:75]
    ds_read_b64_tr_b16 v[204:205], v49 offset:0
    v_mfma_f32_16x16x32_bf16 v[68:71], v[212:215], v[176:179], v[68:71]
    ds_read_b64_tr_b16 v[206:207], v49 offset:1024
    v_mfma_f32_16x16x32_bf16 v[84:87], v[212:215], v[180:183], v[84:87]
    ds_read_b128 v[156:159], v41 offset:4096
    v_mfma_f32_16x16x32_bf16 v[88:91], v[216:219], v[180:183], v[88:91]
    ds_read_b64_tr_b16 v[208:209], v50 offset:0
    v_mfma_f32_16x16x32_bf16 v[92:95], v[180:183], v[220:223], v[92:95]
    ds_read_b64_tr_b16 v[210:211], v50 offset:1024
    v_mfma_f32_16x16x32_bf16 v[96:99], v[224:227], v[180:183], v[96:99]
    ds_read_b128 v[160:163], v41 offset:6144
    v_mfma_f32_16x16x32_bf16 v[112:115], v[224:227], v[184:187], v[112:115]
    ds_read_b128 v[164:167], v41 offset:8192
    v_mfma_f32_16x16x32_bf16 v[108:111], v[184:187], v[220:223], v[108:111]
    ds_read_b128 v[168:171], v41 offset:10240
    v_mfma_f32_16x16x32_bf16 v[104:107], v[216:219], v[184:187], v[104:107]
    v_mfma_f32_16x16x32_bf16 v[100:103], v[212:215], v[184:187], v[100:103]
    v_mfma_f32_16x16x32_bf16 v[116:119], v[212:215], v[188:191], v[116:119]
    v_mfma_f32_16x16x32_bf16 v[120:123], v[216:219], v[188:191], v[120:123]
    v_mfma_f32_16x16x32_bf16 v[124:127], v[188:191], v[220:223], v[124:127]
    v_mfma_f32_16x16x32_bf16 v[128:131], v[224:227], v[188:191], v[128:131]
    v_mfma_f32_16x16x32_bf16 v[144:147], v[224:227], v[192:195], v[144:147]
    v_mfma_f32_16x16x32_bf16 v[140:143], v[192:195], v[220:223], v[140:143]
    v_mfma_f32_16x16x32_bf16 v[136:139], v[216:219], v[192:195], v[136:139]
    v_mfma_f32_16x16x32_bf16 v[132:135], v[212:215], v[192:195], v[132:135]
    s_waitcnt lgkmcnt(0)
    v_mfma_f32_16x16x32_bf16 v[52:55], v[196:199], v[148:151], v[52:55]
    ds_read_b64_tr_b16 v[212:213], v47 offset:8192
    v_mfma_f32_16x16x32_bf16 v[56:59], v[200:203], v[148:151], v[56:59]
    ds_read_b64_tr_b16 v[214:215], v47 offset:9216
    v_mfma_f32_16x16x32_bf16 v[60:63], v[148:151], v[204:207], v[60:63]
    ds_read_b128 v[172:175], v42 offset:0
    v_mfma_f32_16x16x32_bf16 v[64:67], v[208:211], v[148:151], v[64:67]
    ds_read_b64_tr_b16 v[216:217], v48 offset:8192
    v_mfma_f32_16x16x32_bf16 v[80:83], v[208:211], v[152:155], v[80:83]
    ds_read_b64_tr_b16 v[218:219], v48 offset:9216
    v_mfma_f32_16x16x32_bf16 v[76:79], v[152:155], v[204:207], v[76:79]
    ds_read_b128 v[176:179], v42 offset:2048
    v_mfma_f32_16x16x32_bf16 v[72:75], v[200:203], v[152:155], v[72:75]
    ds_read_b64_tr_b16 v[220:221], v49 offset:8192
    v_mfma_f32_16x16x32_bf16 v[68:71], v[196:199], v[152:155], v[68:71]
    ds_read_b64_tr_b16 v[222:223], v49 offset:9216
    v_mfma_f32_16x16x32_bf16 v[84:87], v[196:199], v[156:159], v[84:87]
    ds_read_b128 v[180:183], v42 offset:4096
    v_mfma_f32_16x16x32_bf16 v[88:91], v[200:203], v[156:159], v[88:91]
    ds_read_b64_tr_b16 v[224:225], v50 offset:8192
    v_mfma_f32_16x16x32_bf16 v[92:95], v[156:159], v[204:207], v[92:95]
    ds_read_b64_tr_b16 v[226:227], v50 offset:9216
    v_mfma_f32_16x16x32_bf16 v[96:99], v[208:211], v[156:159], v[96:99]
    ds_read_b128 v[184:187], v42 offset:6144
    v_mfma_f32_16x16x32_bf16 v[112:115], v[208:211], v[160:163], v[112:115]
    ds_read_b128 v[188:191], v42 offset:8192
    v_mfma_f32_16x16x32_bf16 v[108:111], v[160:163], v[204:207], v[108:111]
    ds_read_b128 v[192:195], v42 offset:10240
    v_mfma_f32_16x16x32_bf16 v[104:107], v[200:203], v[160:163], v[104:107]
    v_mfma_f32_16x16x32_bf16 v[100:103], v[196:199], v[160:163], v[100:103]
    v_mfma_f32_16x16x32_bf16 v[116:119], v[196:199], v[164:167], v[116:119]
    v_mfma_f32_16x16x32_bf16 v[120:123], v[200:203], v[164:167], v[120:123]
    v_mfma_f32_16x16x32_bf16 v[124:127], v[164:167], v[204:207], v[124:127]
    v_mfma_f32_16x16x32_bf16 v[128:131], v[208:211], v[164:167], v[128:131]
    v_mfma_f32_16x16x32_bf16 v[144:147], v[208:211], v[168:171], v[144:147]
    v_mfma_f32_16x16x32_bf16 v[140:143], v[168:171], v[204:207], v[140:143]
    v_mfma_f32_16x16x32_bf16 v[136:139], v[200:203], v[168:171], v[136:139]
    v_mfma_f32_16x16x32_bf16 v[132:135], v[196:199], v[168:171], v[132:135]
    s_waitcnt lgkmcnt(0)
    s_barrier
    v_mfma_f32_16x16x32_bf16 v[52:55], v[212:215], v[172:175], v[52:55]
    ds_read_b64_tr_b16 v[196:197], v43 offset:0
    v_mfma_f32_16x16x32_bf16 v[56:59], v[216:219], v[172:175], v[56:59]
    ds_read_b64_tr_b16 v[198:199], v43 offset:1024
    v_mfma_f32_16x16x32_bf16 v[60:63], v[172:175], v[220:223], v[60:63]
    ds_read_b128 v[148:151], v39 offset:0
    v_mfma_f32_16x16x32_bf16 v[64:67], v[224:227], v[172:175], v[64:67]
    ds_read_b64_tr_b16 v[200:201], v44 offset:0
    v_mfma_f32_16x16x32_bf16 v[80:83], v[224:227], v[176:179], v[80:83]
    ds_read_b64_tr_b16 v[202:203], v44 offset:1024
    v_mfma_f32_16x16x32_bf16 v[76:79], v[176:179], v[220:223], v[76:79]
    ds_read_b128 v[152:155], v39 offset:2048
    v_mfma_f32_16x16x32_bf16 v[72:75], v[216:219], v[176:179], v[72:75]
    ds_read_b64_tr_b16 v[204:205], v45 offset:0
    v_mfma_f32_16x16x32_bf16 v[68:71], v[212:215], v[176:179], v[68:71]
    ds_read_b64_tr_b16 v[206:207], v45 offset:1024
    v_mfma_f32_16x16x32_bf16 v[84:87], v[212:215], v[180:183], v[84:87]
    ds_read_b128 v[156:159], v39 offset:4096
    v_mfma_f32_16x16x32_bf16 v[88:91], v[216:219], v[180:183], v[88:91]
    ds_read_b64_tr_b16 v[208:209], v46 offset:0
    v_mfma_f32_16x16x32_bf16 v[92:95], v[180:183], v[220:223], v[92:95]
    ds_read_b64_tr_b16 v[210:211], v46 offset:1024
    v_mfma_f32_16x16x32_bf16 v[96:99], v[224:227], v[180:183], v[96:99]
    ds_read_b128 v[160:163], v39 offset:6144
    v_mfma_f32_16x16x32_bf16 v[112:115], v[224:227], v[184:187], v[112:115]
    ds_read_b128 v[164:167], v39 offset:8192
    v_mfma_f32_16x16x32_bf16 v[108:111], v[184:187], v[220:223], v[108:111]
    ds_read_b128 v[168:171], v39 offset:10240
    v_mfma_f32_16x16x32_bf16 v[104:107], v[216:219], v[184:187], v[104:107]
    v_mfma_f32_16x16x32_bf16 v[100:103], v[212:215], v[184:187], v[100:103]
    v_mfma_f32_16x16x32_bf16 v[116:119], v[212:215], v[188:191], v[116:119]
    v_mfma_f32_16x16x32_bf16 v[120:123], v[216:219], v[188:191], v[120:123]
    v_mfma_f32_16x16x32_bf16 v[124:127], v[188:191], v[220:223], v[124:127]
    v_mfma_f32_16x16x32_bf16 v[128:131], v[224:227], v[188:191], v[128:131]
    v_mfma_f32_16x16x32_bf16 v[144:147], v[224:227], v[192:195], v[144:147]
    v_mfma_f32_16x16x32_bf16 v[140:143], v[192:195], v[220:223], v[140:143]
    v_mfma_f32_16x16x32_bf16 v[136:139], v[216:219], v[192:195], v[136:139]
    v_mfma_f32_16x16x32_bf16 v[132:135], v[212:215], v[192:195], v[132:135]
    s_waitcnt lgkmcnt(0)
    v_mfma_f32_16x16x32_bf16 v[52:55], v[196:199], v[148:151], v[52:55]
    ds_read_b64_tr_b16 v[212:213], v43 offset:8192
    v_mfma_f32_16x16x32_bf16 v[56:59], v[200:203], v[148:151], v[56:59]
    ds_read_b64_tr_b16 v[214:215], v43 offset:9216
    v_mfma_f32_16x16x32_bf16 v[60:63], v[148:151], v[204:207], v[60:63]
    ds_read_b128 v[172:175], v40 offset:0
    v_mfma_f32_16x16x32_bf16 v[64:67], v[208:211], v[148:151], v[64:67]
    ds_read_b64_tr_b16 v[216:217], v44 offset:8192
    v_mfma_f32_16x16x32_bf16 v[80:83], v[208:211], v[152:155], v[80:83]
    ds_read_b64_tr_b16 v[218:219], v44 offset:9216
    v_mfma_f32_16x16x32_bf16 v[76:79], v[152:155], v[204:207], v[76:79]
    ds_read_b128 v[176:179], v40 offset:2048
    v_mfma_f32_16x16x32_bf16 v[72:75], v[200:203], v[152:155], v[72:75]
    ds_read_b64_tr_b16 v[220:221], v45 offset:8192
    v_mfma_f32_16x16x32_bf16 v[68:71], v[196:199], v[152:155], v[68:71]
    ds_read_b64_tr_b16 v[222:223], v45 offset:9216
    v_mfma_f32_16x16x32_bf16 v[84:87], v[196:199], v[156:159], v[84:87]
    ds_read_b128 v[180:183], v40 offset:4096
    v_mfma_f32_16x16x32_bf16 v[88:91], v[200:203], v[156:159], v[88:91]
    ds_read_b64_tr_b16 v[224:225], v46 offset:8192
    v_mfma_f32_16x16x32_bf16 v[92:95], v[156:159], v[204:207], v[92:95]
    ds_read_b64_tr_b16 v[226:227], v46 offset:9216
    v_mfma_f32_16x16x32_bf16 v[96:99], v[208:211], v[156:159], v[96:99]
    ds_read_b128 v[184:187], v40 offset:6144
    v_mfma_f32_16x16x32_bf16 v[112:115], v[208:211], v[160:163], v[112:115]
    ds_read_b128 v[188:191], v40 offset:8192
    v_mfma_f32_16x16x32_bf16 v[108:111], v[160:163], v[204:207], v[108:111]
    ds_read_b128 v[192:195], v40 offset:10240
    v_mfma_f32_16x16x32_bf16 v[104:107], v[200:203], v[160:163], v[104:107]
    v_mfma_f32_16x16x32_bf16 v[100:103], v[196:199], v[160:163], v[100:103]
    v_mfma_f32_16x16x32_bf16 v[116:119], v[196:199], v[164:167], v[116:119]
    v_mfma_f32_16x16x32_bf16 v[120:123], v[200:203], v[164:167], v[120:123]
    v_mfma_f32_16x16x32_bf16 v[124:127], v[164:167], v[204:207], v[124:127]
    v_mfma_f32_16x16x32_bf16 v[128:131], v[208:211], v[164:167], v[128:131]
    v_mfma_f32_16x16x32_bf16 v[144:147], v[208:211], v[168:171], v[144:147]
    v_mfma_f32_16x16x32_bf16 v[140:143], v[168:171], v[204:207], v[140:143]
    v_mfma_f32_16x16x32_bf16 v[136:139], v[200:203], v[168:171], v[136:139]
    v_mfma_f32_16x16x32_bf16 v[132:135], v[196:199], v[168:171], v[132:135]
    s_waitcnt lgkmcnt(0)
    s_barrier
    v_mfma_f32_16x16x32_bf16 v[52:55], v[212:215], v[172:175], v[52:55]
    ds_read_b64_tr_b16 v[196:197], v43 offset:40960
    v_mfma_f32_16x16x32_bf16 v[56:59], v[216:219], v[172:175], v[56:59]
    ds_read_b64_tr_b16 v[198:199], v43 offset:41984
    v_mfma_f32_16x16x32_bf16 v[60:63], v[172:175], v[220:223], v[60:63]
    ds_read_b128 v[148:151], v39 offset:40960
    v_mfma_f32_16x16x32_bf16 v[64:67], v[224:227], v[172:175], v[64:67]
    ds_read_b64_tr_b16 v[200:201], v44 offset:40960
    v_mfma_f32_16x16x32_bf16 v[80:83], v[224:227], v[176:179], v[80:83]
    ds_read_b64_tr_b16 v[202:203], v44 offset:41984
    v_mfma_f32_16x16x32_bf16 v[76:79], v[176:179], v[220:223], v[76:79]
    ds_read_b128 v[152:155], v39 offset:43008
    v_mfma_f32_16x16x32_bf16 v[72:75], v[216:219], v[176:179], v[72:75]
    ds_read_b64_tr_b16 v[204:205], v45 offset:40960
    v_mfma_f32_16x16x32_bf16 v[68:71], v[212:215], v[176:179], v[68:71]
    ds_read_b64_tr_b16 v[206:207], v45 offset:41984
    v_mfma_f32_16x16x32_bf16 v[84:87], v[212:215], v[180:183], v[84:87]
    ds_read_b128 v[156:159], v39 offset:45056
    v_mfma_f32_16x16x32_bf16 v[88:91], v[216:219], v[180:183], v[88:91]
    ds_read_b64_tr_b16 v[208:209], v46 offset:40960
    v_mfma_f32_16x16x32_bf16 v[92:95], v[180:183], v[220:223], v[92:95]
    ds_read_b64_tr_b16 v[210:211], v46 offset:41984
    v_mfma_f32_16x16x32_bf16 v[96:99], v[224:227], v[180:183], v[96:99]
    ds_read_b128 v[160:163], v39 offset:47104
    v_mfma_f32_16x16x32_bf16 v[112:115], v[224:227], v[184:187], v[112:115]
    ds_read_b128 v[164:167], v39 offset:49152
    v_mfma_f32_16x16x32_bf16 v[108:111], v[184:187], v[220:223], v[108:111]
    ds_read_b128 v[168:171], v39 offset:51200
    v_mfma_f32_16x16x32_bf16 v[104:107], v[216:219], v[184:187], v[104:107]
    v_mfma_f32_16x16x32_bf16 v[100:103], v[212:215], v[184:187], v[100:103]
    v_mfma_f32_16x16x32_bf16 v[116:119], v[212:215], v[188:191], v[116:119]
    v_mfma_f32_16x16x32_bf16 v[120:123], v[216:219], v[188:191], v[120:123]
    v_mfma_f32_16x16x32_bf16 v[124:127], v[188:191], v[220:223], v[124:127]
    v_mfma_f32_16x16x32_bf16 v[128:131], v[224:227], v[188:191], v[128:131]
    v_mfma_f32_16x16x32_bf16 v[144:147], v[224:227], v[192:195], v[144:147]
    v_mfma_f32_16x16x32_bf16 v[140:143], v[192:195], v[220:223], v[140:143]
    v_mfma_f32_16x16x32_bf16 v[136:139], v[216:219], v[192:195], v[136:139]
    v_mfma_f32_16x16x32_bf16 v[132:135], v[212:215], v[192:195], v[132:135]
    s_waitcnt lgkmcnt(0)
    v_mfma_f32_16x16x32_bf16 v[52:55], v[196:199], v[148:151], v[52:55]
    ds_read_b64_tr_b16 v[212:213], v43 offset:49152
    v_mfma_f32_16x16x32_bf16 v[56:59], v[200:203], v[148:151], v[56:59]
    ds_read_b64_tr_b16 v[214:215], v43 offset:50176
    v_mfma_f32_16x16x32_bf16 v[60:63], v[148:151], v[204:207], v[60:63]
    ds_read_b128 v[172:175], v40 offset:40960
    v_mfma_f32_16x16x32_bf16 v[64:67], v[208:211], v[148:151], v[64:67]
    ds_read_b64_tr_b16 v[216:217], v44 offset:49152
    v_mfma_f32_16x16x32_bf16 v[80:83], v[208:211], v[152:155], v[80:83]
    ds_read_b64_tr_b16 v[218:219], v44 offset:50176
    v_mfma_f32_16x16x32_bf16 v[76:79], v[152:155], v[204:207], v[76:79]
    ds_read_b128 v[176:179], v40 offset:43008
    v_mfma_f32_16x16x32_bf16 v[72:75], v[200:203], v[152:155], v[72:75]
    ds_read_b64_tr_b16 v[220:221], v45 offset:49152
    v_mfma_f32_16x16x32_bf16 v[68:71], v[196:199], v[152:155], v[68:71]
    ds_read_b64_tr_b16 v[222:223], v45 offset:50176
    v_mfma_f32_16x16x32_bf16 v[84:87], v[196:199], v[156:159], v[84:87]
    ds_read_b128 v[180:183], v40 offset:45056
    v_mfma_f32_16x16x32_bf16 v[88:91], v[200:203], v[156:159], v[88:91]
    ds_read_b64_tr_b16 v[224:225], v46 offset:49152
    v_mfma_f32_16x16x32_bf16 v[92:95], v[156:159], v[204:207], v[92:95]
    ds_read_b64_tr_b16 v[226:227], v46 offset:50176
    v_mfma_f32_16x16x32_bf16 v[96:99], v[208:211], v[156:159], v[96:99]
    ds_read_b128 v[184:187], v40 offset:47104
    v_mfma_f32_16x16x32_bf16 v[112:115], v[208:211], v[160:163], v[112:115]
    ds_read_b128 v[188:191], v40 offset:49152
    v_mfma_f32_16x16x32_bf16 v[108:111], v[160:163], v[204:207], v[108:111]
    ds_read_b128 v[192:195], v40 offset:51200
    v_mfma_f32_16x16x32_bf16 v[104:107], v[200:203], v[160:163], v[104:107]
    v_mfma_f32_16x16x32_bf16 v[100:103], v[196:199], v[160:163], v[100:103]
    v_mfma_f32_16x16x32_bf16 v[116:119], v[196:199], v[164:167], v[116:119]
    v_mfma_f32_16x16x32_bf16 v[120:123], v[200:203], v[164:167], v[120:123]
    v_mfma_f32_16x16x32_bf16 v[124:127], v[164:167], v[204:207], v[124:127]
    v_mfma_f32_16x16x32_bf16 v[128:131], v[208:211], v[164:167], v[128:131]
    v_mfma_f32_16x16x32_bf16 v[144:147], v[208:211], v[168:171], v[144:147]
    v_mfma_f32_16x16x32_bf16 v[140:143], v[168:171], v[204:207], v[140:143]
    v_mfma_f32_16x16x32_bf16 v[136:139], v[200:203], v[168:171], v[136:139]
    v_mfma_f32_16x16x32_bf16 v[132:135], v[196:199], v[168:171], v[132:135]
    s_waitcnt lgkmcnt(0)
    s_barrier
    v_mfma_f32_16x16x32_bf16 v[52:55], v[212:215], v[172:175], v[52:55]
    ds_read_b64_tr_b16 v[196:197], v47 offset:0
    v_mfma_f32_16x16x32_bf16 v[56:59], v[216:219], v[172:175], v[56:59]
    ds_read_b64_tr_b16 v[198:199], v47 offset:1024
    v_mfma_f32_16x16x32_bf16 v[60:63], v[172:175], v[220:223], v[60:63]
    ds_read_b128 v[148:151], v41 offset:0
    v_mfma_f32_16x16x32_bf16 v[64:67], v[224:227], v[172:175], v[64:67]
    ds_read_b64_tr_b16 v[200:201], v48 offset:0
    v_mfma_f32_16x16x32_bf16 v[80:83], v[224:227], v[176:179], v[80:83]
    ds_read_b64_tr_b16 v[202:203], v48 offset:1024
    v_mfma_f32_16x16x32_bf16 v[76:79], v[176:179], v[220:223], v[76:79]
    ds_read_b128 v[152:155], v41 offset:2048
    v_mfma_f32_16x16x32_bf16 v[72:75], v[216:219], v[176:179], v[72:75]
    ds_read_b64_tr_b16 v[204:205], v49 offset:0
    v_mfma_f32_16x16x32_bf16 v[68:71], v[212:215], v[176:179], v[68:71]
    ds_read_b64_tr_b16 v[206:207], v49 offset:1024
    v_mfma_f32_16x16x32_bf16 v[84:87], v[212:215], v[180:183], v[84:87]
    ds_read_b128 v[156:159], v41 offset:4096
    v_mfma_f32_16x16x32_bf16 v[88:91], v[216:219], v[180:183], v[88:91]
    ds_read_b64_tr_b16 v[208:209], v50 offset:0
    v_mfma_f32_16x16x32_bf16 v[92:95], v[180:183], v[220:223], v[92:95]
    ds_read_b64_tr_b16 v[210:211], v50 offset:1024
    v_mfma_f32_16x16x32_bf16 v[96:99], v[224:227], v[180:183], v[96:99]
    ds_read_b128 v[160:163], v41 offset:6144
    v_mfma_f32_16x16x32_bf16 v[112:115], v[224:227], v[184:187], v[112:115]
    ds_read_b128 v[164:167], v41 offset:8192
    v_mfma_f32_16x16x32_bf16 v[108:111], v[184:187], v[220:223], v[108:111]
    ds_read_b128 v[168:171], v41 offset:10240
    v_mfma_f32_16x16x32_bf16 v[104:107], v[216:219], v[184:187], v[104:107]
    v_mfma_f32_16x16x32_bf16 v[100:103], v[212:215], v[184:187], v[100:103]
    v_mfma_f32_16x16x32_bf16 v[116:119], v[212:215], v[188:191], v[116:119]
    v_mfma_f32_16x16x32_bf16 v[120:123], v[216:219], v[188:191], v[120:123]
    v_mfma_f32_16x16x32_bf16 v[124:127], v[188:191], v[220:223], v[124:127]
    v_mfma_f32_16x16x32_bf16 v[128:131], v[224:227], v[188:191], v[128:131]
    v_mfma_f32_16x16x32_bf16 v[144:147], v[224:227], v[192:195], v[144:147]
    v_mfma_f32_16x16x32_bf16 v[140:143], v[192:195], v[220:223], v[140:143]
    v_mfma_f32_16x16x32_bf16 v[136:139], v[216:219], v[192:195], v[136:139]
    v_mfma_f32_16x16x32_bf16 v[132:135], v[212:215], v[192:195], v[132:135]
    s_waitcnt lgkmcnt(0)
    v_mfma_f32_16x16x32_bf16 v[52:55], v[196:199], v[148:151], v[52:55]
    ds_read_b64_tr_b16 v[212:213], v47 offset:8192
    v_mfma_f32_16x16x32_bf16 v[56:59], v[200:203], v[148:151], v[56:59]
    ds_read_b64_tr_b16 v[214:215], v47 offset:9216
    v_mfma_f32_16x16x32_bf16 v[60:63], v[148:151], v[204:207], v[60:63]
    ds_read_b128 v[172:175], v42 offset:0
    v_mfma_f32_16x16x32_bf16 v[64:67], v[208:211], v[148:151], v[64:67]
    ds_read_b64_tr_b16 v[216:217], v48 offset:8192
    v_mfma_f32_16x16x32_bf16 v[80:83], v[208:211], v[152:155], v[80:83]
    ds_read_b64_tr_b16 v[218:219], v48 offset:9216
    v_mfma_f32_16x16x32_bf16 v[76:79], v[152:155], v[204:207], v[76:79]
    ds_read_b128 v[176:179], v42 offset:2048
    v_mfma_f32_16x16x32_bf16 v[72:75], v[200:203], v[152:155], v[72:75]
    ds_read_b64_tr_b16 v[220:221], v49 offset:8192
    v_mfma_f32_16x16x32_bf16 v[68:71], v[196:199], v[152:155], v[68:71]
    ds_read_b64_tr_b16 v[222:223], v49 offset:9216
    v_mfma_f32_16x16x32_bf16 v[84:87], v[196:199], v[156:159], v[84:87]
    ds_read_b128 v[180:183], v42 offset:4096
    v_mfma_f32_16x16x32_bf16 v[88:91], v[200:203], v[156:159], v[88:91]
    ds_read_b64_tr_b16 v[224:225], v50 offset:8192
    v_mfma_f32_16x16x32_bf16 v[92:95], v[156:159], v[204:207], v[92:95]
    ds_read_b64_tr_b16 v[226:227], v50 offset:9216
    v_mfma_f32_16x16x32_bf16 v[96:99], v[208:211], v[156:159], v[96:99]
    ds_read_b128 v[184:187], v42 offset:6144
    v_mfma_f32_16x16x32_bf16 v[112:115], v[208:211], v[160:163], v[112:115]
    ds_read_b128 v[188:191], v42 offset:8192
    v_mfma_f32_16x16x32_bf16 v[108:111], v[160:163], v[204:207], v[108:111]
    ds_read_b128 v[192:195], v42 offset:10240
    v_mfma_f32_16x16x32_bf16 v[104:107], v[200:203], v[160:163], v[104:107]
    v_mfma_f32_16x16x32_bf16 v[100:103], v[196:199], v[160:163], v[100:103]
    v_mfma_f32_16x16x32_bf16 v[116:119], v[196:199], v[164:167], v[116:119]
    v_mfma_f32_16x16x32_bf16 v[120:123], v[200:203], v[164:167], v[120:123]
    v_mfma_f32_16x16x32_bf16 v[124:127], v[164:167], v[204:207], v[124:127]
    v_mfma_f32_16x16x32_bf16 v[128:131], v[208:211], v[164:167], v[128:131]
    v_mfma_f32_16x16x32_bf16 v[144:147], v[208:211], v[168:171], v[144:147]
    v_mfma_f32_16x16x32_bf16 v[140:143], v[168:171], v[204:207], v[140:143]
    v_mfma_f32_16x16x32_bf16 v[136:139], v[200:203], v[168:171], v[136:139]
    v_mfma_f32_16x16x32_bf16 v[132:135], v[196:199], v[168:171], v[132:135]
    s_waitcnt lgkmcnt(0)
    s_barrier
    v_mfma_f32_16x16x32_bf16 v[52:55], v[212:215], v[172:175], v[52:55]
    ds_read_b64_tr_b16 v[196:197], v43 offset:0
    v_mfma_f32_16x16x32_bf16 v[56:59], v[216:219], v[172:175], v[56:59]
    ds_read_b64_tr_b16 v[198:199], v43 offset:1024
    v_mfma_f32_16x16x32_bf16 v[60:63], v[172:175], v[220:223], v[60:63]
    ds_read_b128 v[148:151], v39 offset:0
    v_mfma_f32_16x16x32_bf16 v[64:67], v[224:227], v[172:175], v[64:67]
    ds_read_b64_tr_b16 v[200:201], v44 offset:0
    v_mfma_f32_16x16x32_bf16 v[80:83], v[224:227], v[176:179], v[80:83]
    ds_read_b64_tr_b16 v[202:203], v44 offset:1024
    v_mfma_f32_16x16x32_bf16 v[76:79], v[176:179], v[220:223], v[76:79]
    ds_read_b128 v[152:155], v39 offset:2048
    v_mfma_f32_16x16x32_bf16 v[72:75], v[216:219], v[176:179], v[72:75]
    ds_read_b64_tr_b16 v[204:205], v45 offset:0
    v_mfma_f32_16x16x32_bf16 v[68:71], v[212:215], v[176:179], v[68:71]
    ds_read_b64_tr_b16 v[206:207], v45 offset:1024
    v_mfma_f32_16x16x32_bf16 v[84:87], v[212:215], v[180:183], v[84:87]
    ds_read_b128 v[156:159], v39 offset:4096
    v_mfma_f32_16x16x32_bf16 v[88:91], v[216:219], v[180:183], v[88:91]
    ds_read_b64_tr_b16 v[208:209], v46 offset:0
    v_mfma_f32_16x16x32_bf16 v[92:95], v[180:183], v[220:223], v[92:95]
    ds_read_b64_tr_b16 v[210:211], v46 offset:1024
    v_mfma_f32_16x16x32_bf16 v[96:99], v[224:227], v[180:183], v[96:99]
    ds_read_b128 v[160:163], v39 offset:6144
    v_mfma_f32_16x16x32_bf16 v[112:115], v[224:227], v[184:187], v[112:115]
    ds_read_b128 v[164:167], v39 offset:8192
    v_mfma_f32_16x16x32_bf16 v[108:111], v[184:187], v[220:223], v[108:111]
    ds_read_b128 v[168:171], v39 offset:10240
    v_mfma_f32_16x16x32_bf16 v[104:107], v[216:219], v[184:187], v[104:107]
    v_mfma_f32_16x16x32_bf16 v[100:103], v[212:215], v[184:187], v[100:103]
    v_mfma_f32_16x16x32_bf16 v[116:119], v[212:215], v[188:191], v[116:119]
    v_mfma_f32_16x16x32_bf16 v[120:123], v[216:219], v[188:191], v[120:123]
    v_mfma_f32_16x16x32_bf16 v[124:127], v[188:191], v[220:223], v[124:127]
    v_mfma_f32_16x16x32_bf16 v[128:131], v[224:227], v[188:191], v[128:131]
    v_mfma_f32_16x16x32_bf16 v[144:147], v[224:227], v[192:195], v[144:147]
    v_mfma_f32_16x16x32_bf16 v[140:143], v[192:195], v[220:223], v[140:143]
    v_mfma_f32_16x16x32_bf16 v[136:139], v[216:219], v[192:195], v[136:139]
    v_mfma_f32_16x16x32_bf16 v[132:135], v[212:215], v[192:195], v[132:135]
    s_waitcnt lgkmcnt(0)
    v_mfma_f32_16x16x32_bf16 v[52:55], v[196:199], v[148:151], v[52:55]
    ds_read_b64_tr_b16 v[212:213], v43 offset:8192
    v_mfma_f32_16x16x32_bf16 v[56:59], v[200:203], v[148:151], v[56:59]
    ds_read_b64_tr_b16 v[214:215], v43 offset:9216
    v_mfma_f32_16x16x32_bf16 v[60:63], v[148:151], v[204:207], v[60:63]
    ds_read_b128 v[172:175], v40 offset:0
    v_mfma_f32_16x16x32_bf16 v[64:67], v[208:211], v[148:151], v[64:67]
    ds_read_b64_tr_b16 v[216:217], v44 offset:8192
    v_mfma_f32_16x16x32_bf16 v[80:83], v[208:211], v[152:155], v[80:83]
    ds_read_b64_tr_b16 v[218:219], v44 offset:9216
    v_mfma_f32_16x16x32_bf16 v[76:79], v[152:155], v[204:207], v[76:79]
    ds_read_b128 v[176:179], v40 offset:2048
    v_mfma_f32_16x16x32_bf16 v[72:75], v[200:203], v[152:155], v[72:75]
    ds_read_b64_tr_b16 v[220:221], v45 offset:8192
    v_mfma_f32_16x16x32_bf16 v[68:71], v[196:199], v[152:155], v[68:71]
    ds_read_b64_tr_b16 v[222:223], v45 offset:9216
    v_mfma_f32_16x16x32_bf16 v[84:87], v[196:199], v[156:159], v[84:87]
    ds_read_b128 v[180:183], v40 offset:4096
    v_mfma_f32_16x16x32_bf16 v[88:91], v[200:203], v[156:159], v[88:91]
    ds_read_b64_tr_b16 v[224:225], v46 offset:8192
    v_mfma_f32_16x16x32_bf16 v[92:95], v[156:159], v[204:207], v[92:95]
    ds_read_b64_tr_b16 v[226:227], v46 offset:9216
    v_mfma_f32_16x16x32_bf16 v[96:99], v[208:211], v[156:159], v[96:99]
    ds_read_b128 v[184:187], v40 offset:6144
    v_mfma_f32_16x16x32_bf16 v[112:115], v[208:211], v[160:163], v[112:115]
    ds_read_b128 v[188:191], v40 offset:8192
    v_mfma_f32_16x16x32_bf16 v[108:111], v[160:163], v[204:207], v[108:111]
    ds_read_b128 v[192:195], v40 offset:10240
    v_mfma_f32_16x16x32_bf16 v[104:107], v[200:203], v[160:163], v[104:107]
    v_mfma_f32_16x16x32_bf16 v[100:103], v[196:199], v[160:163], v[100:103]
    v_mfma_f32_16x16x32_bf16 v[116:119], v[196:199], v[164:167], v[116:119]
    v_mfma_f32_16x16x32_bf16 v[120:123], v[200:203], v[164:167], v[120:123]
    v_mfma_f32_16x16x32_bf16 v[124:127], v[164:167], v[204:207], v[124:127]
    v_mfma_f32_16x16x32_bf16 v[128:131], v[208:211], v[164:167], v[128:131]
    v_mfma_f32_16x16x32_bf16 v[144:147], v[208:211], v[168:171], v[144:147]
    v_mfma_f32_16x16x32_bf16 v[140:143], v[168:171], v[204:207], v[140:143]
    v_mfma_f32_16x16x32_bf16 v[136:139], v[200:203], v[168:171], v[136:139]
    v_mfma_f32_16x16x32_bf16 v[132:135], v[196:199], v[168:171], v[132:135]
    s_waitcnt lgkmcnt(0)
    s_barrier
    v_mfma_f32_16x16x32_bf16 v[52:55], v[212:215], v[172:175], v[52:55]
    ds_read_b64_tr_b16 v[196:197], v43 offset:40960
    v_mfma_f32_16x16x32_bf16 v[56:59], v[216:219], v[172:175], v[56:59]
    ds_read_b64_tr_b16 v[198:199], v43 offset:41984
    v_mfma_f32_16x16x32_bf16 v[60:63], v[172:175], v[220:223], v[60:63]
    ds_read_b128 v[148:151], v39 offset:40960
    v_mfma_f32_16x16x32_bf16 v[64:67], v[224:227], v[172:175], v[64:67]
    ds_read_b64_tr_b16 v[200:201], v44 offset:40960
    v_mfma_f32_16x16x32_bf16 v[80:83], v[224:227], v[176:179], v[80:83]
    ds_read_b64_tr_b16 v[202:203], v44 offset:41984
    v_mfma_f32_16x16x32_bf16 v[76:79], v[176:179], v[220:223], v[76:79]
    ds_read_b128 v[152:155], v39 offset:43008
    v_mfma_f32_16x16x32_bf16 v[72:75], v[216:219], v[176:179], v[72:75]
    ds_read_b64_tr_b16 v[204:205], v45 offset:40960
    v_mfma_f32_16x16x32_bf16 v[68:71], v[212:215], v[176:179], v[68:71]
    ds_read_b64_tr_b16 v[206:207], v45 offset:41984
    v_mfma_f32_16x16x32_bf16 v[84:87], v[212:215], v[180:183], v[84:87]
    ds_read_b128 v[156:159], v39 offset:45056
    v_mfma_f32_16x16x32_bf16 v[88:91], v[216:219], v[180:183], v[88:91]
    ds_read_b64_tr_b16 v[208:209], v46 offset:40960
    v_mfma_f32_16x16x32_bf16 v[92:95], v[180:183], v[220:223], v[92:95]
    ds_read_b64_tr_b16 v[210:211], v46 offset:41984
    v_mfma_f32_16x16x32_bf16 v[96:99], v[224:227], v[180:183], v[96:99]
    ds_read_b128 v[160:163], v39 offset:47104
    v_mfma_f32_16x16x32_bf16 v[112:115], v[224:227], v[184:187], v[112:115]
    ds_read_b128 v[164:167], v39 offset:49152
    v_mfma_f32_16x16x32_bf16 v[108:111], v[184:187], v[220:223], v[108:111]
    ds_read_b128 v[168:171], v39 offset:51200
    v_mfma_f32_16x16x32_bf16 v[104:107], v[216:219], v[184:187], v[104:107]
    v_mfma_f32_16x16x32_bf16 v[100:103], v[212:215], v[184:187], v[100:103]
    v_mfma_f32_16x16x32_bf16 v[116:119], v[212:215], v[188:191], v[116:119]
    v_mfma_f32_16x16x32_bf16 v[120:123], v[216:219], v[188:191], v[120:123]
    v_mfma_f32_16x16x32_bf16 v[124:127], v[188:191], v[220:223], v[124:127]
    v_mfma_f32_16x16x32_bf16 v[128:131], v[224:227], v[188:191], v[128:131]
    s_branch K_PG2
.p2align 12
K_CHM2:
K_STM2:
    s_branch K_WRET_M
    s_nop 0
K_PG2:
    v_mfma_f32_16x16x32_bf16 v[144:147], v[224:227], v[192:195], v[144:147]
    v_mfma_f32_16x16x32_bf16 v[140:143], v[192:195], v[220:223], v[140:143]
    v_mfma_f32_16x16x32_bf16 v[136:139], v[216:219], v[192:195], v[136:139]
    v_mfma_f32_16x16x32_bf16 v[132:135], v[212:215], v[192:195], v[132:135]
    s_waitcnt lgkmcnt(0)
    v_mfma_f32_16x16x32_bf16 v[52:55], v[196:199], v[148:151], v[52:55]
    ds_read_b64_tr_b16 v[212:213], v43 offset:49152
    v_mfma_f32_16x16x32_bf16 v[56:59], v[200:203], v[148:151], v[56:59]
    ds_read_b64_tr_b16 v[214:215], v43 offset:50176
    v_mfma_f32_16x16x32_bf16 v[60:63], v[148:151], v[204:207], v[60:63]
    ds_read_b128 v[172:175], v40 offset:40960
    v_mfma_f32_16x16x32_bf16 v[64:67], v[208:211], v[148:151], v[64:67]
    ds_read_b64_tr_b16 v[216:217], v44 offset:49152
    v_mfma_f32_16x16x32_bf16 v[80:83], v[208:211], v[152:155], v[80:83]
    ds_read_b64_tr_b16 v[218:219], v44 offset:50176
    v_mfma_f32_16x16x32_bf16 v[76:79], v[152:155], v[204:207], v[76:79]
    ds_read_b128 v[176:179], v40 offset:43008
    v_mfma_f32_16x16x32_bf16 v[72:75], v[200:203], v[152:155], v[72:75]
    ds_read_b64_tr_b16 v[220:221], v45 offset:49152
    v_mfma_f32_16x16x32_bf16 v[68:71], v[196:199], v[152:155], v[68:71]
    ds_read_b64_tr_b16 v[222:223], v45 offset:50176
    v_mfma_f32_16x16x32_bf16 v[84:87], v[196:199], v[156:159], v[84:87]
    ds_read_b128 v[180:183], v40 offset:45056
    v_mfma_f32_16x16x32_bf16 v[88:91], v[200:203], v[156:159], v[88:91]
    ds_read_b64_tr_b16 v[224:225], v46 offset:49152
    v_mfma_f32_16x16x32_bf16 v[92:95], v[156:159], v[204:207], v[92:95]
    ds_read_b64_tr_b16 v[226:227], v46 offset:50176
    v_mfma_f32_16x16x32_bf16 v[96:99], v[208:211], v[156:159], v[96:99]
    ds_read_b128 v[184:187], v40 offset:47104
    v_mfma_f32_16x16x32_bf16 v[112:115], v[208:211], v[160:163], v[112:115]
    ds_read_b128 v[188:191], v40 offset:49152
    v_mfma_f32_16x16x32_bf16 v[108:111], v[160:163], v[204:207], v[108:111]
    ds_read_b128 v[192:195], v40 offset:51200
    v_mfma_f32_16x16x32_bf16 v[104:107], v[200:203], v[160:163], v[104:107]
    v_mfma_f32_16x16x32_bf16 v[100:103], v[196:199], v[160:163], v[100:103]
    v_mfma_f32_16x16x32_bf16 v[116:119], v[196:199], v[164:167], v[116:119]
    v_mfma_f32_16x16x32_bf16 v[120:123], v[200:203], v[164:167], v[120:123]
    v_mfma_f32_16x16x32_bf16 v[124:127], v[164:167], v[204:207], v[124:127]
    v_mfma_f32_16x16x32_bf16 v[128:131], v[208:211], v[164:167], v[128:131]
    v_mfma_f32_16x16x32_bf16 v[144:147], v[208:211], v[168:171], v[144:147]
    v_mfma_f32_16x16x32_bf16 v[140:143], v[168:171], v[204:207], v[140:143]
    v_mfma_f32_16x16x32_bf16 v[136:139], v[200:203], v[168:171], v[136:139]
    v_mfma_f32_16x16x32_bf16 v[132:135], v[196:199], v[168:171], v[132:135]
    s_waitcnt lgkmcnt(0)
    s_barrier
    v_mfma_f32_16x16x32_bf16 v[52:55], v[212:215], v[172:175], v[52:55]
    ds_read_b64_tr_b16 v[196:197], v47 offset:0
    v_mfma_f32_16x16x32_bf16 v[56:59], v[216:219], v[172:175], v[56:59]
    ds_read_b64_tr_b16 v[198:199], v47 offset:1024
    v_mfma_f32_16x16x32_bf16 v[60:63], v[172:175], v[220:223], v[60:63]
    ds_read_b128 v[148:151], v41 offset:0
    v_mfma_f32_16x16x32_bf16 v[64:67], v[224:227], v[172:175], v[64:67]
    ds_read_b64_tr_b16 v[200:201], v48 offset:0
    v_mfma_f32_16x16x32_bf16 v[80:83], v[224:227], v[176:179], v[80:83]
    ds_read_b64_tr_b16 v[202:203], v48 offset:1024
    v_mfma_f32_16x16x32_bf16 v[76:79], v[176:179], v[220:223], v[76:79]
    ds_read_b128 v[152:155], v41 offset:2048
    v_mfma_f32_16x16x32_bf16 v[72:75], v[216:219], v[176:179], v[72:75]
    ds_read_b64_tr_b16 v[204:205], v49 offset:0
    v_mfma_f32_16x16x32_bf16 v[68:71], v[212:215], v[176:179], v[68:71]
    ds_read_b64_tr_b16 v[206:207], v49 offset:1024
    v_mfma_f32_16x16x32_bf16 v[84:87], v[212:215], v[180:183], v[84:87]
    ds_read_b128 v[156:159], v41 offset:4096
    v_mfma_f32_16x16x32_bf16 v[88:91], v[216:219], v[180:183], v[88:91]
    ds_read_b64_tr_b16 v[208:209], v50 offset:0
    v_mfma_f32_16x16x32_bf16 v[92:95], v[180:183], v[220:223], v[92:95]
    ds_read_b64_tr_b16 v[210:211], v50 offset:1024
    v_mfma_f32_16x16x32_bf16 v[96:99], v[224:227], v[180:183], v[96:99]
    ds_read_b128 v[160:163], v41 offset:6144
    v_mfma_f32_16x16x32_bf16 v[112:115], v[224:227], v[184:187], v[112:115]
    ds_read_b128 v[164:167], v41 offset:8192
    v_mfma_f32_16x16x32_bf16 v[108:111], v[184:187], v[220:223], v[108:111]
    ds_read_b128 v[168:171], v41 offset:10240
    v_mfma_f32_16x16x32_bf16 v[104:107], v[216:219], v[184:187], v[104:107]
    v_mfma_f32_16x16x32_bf16 v[100:103], v[212:215], v[184:187], v[100:103]
    v_mfma_f32_16x16x32_bf16 v[116:119], v[212:215], v[188:191], v[116:119]
    v_mfma_f32_16x16x32_bf16 v[120:123], v[216:219], v[188:191], v[120:123]
    v_mfma_f32_16x16x32_bf16 v[124:127], v[188:191], v[220:223], v[124:127]
    v_mfma_f32_16x16x32_bf16 v[128:131], v[224:227], v[188:191], v[128:131]
    v_mfma_f32_16x16x32_bf16 v[144:147], v[224:227], v[192:195], v[144:147]
    v_mfma_f32_16x16x32_bf16 v[140:143], v[192:195], v[220:223], v[140:143]
    v_mfma_f32_16x16x32_bf16 v[136:139], v[216:219], v[192:195], v[136:139]
    v_mfma_f32_16x16x32_bf16 v[132:135], v[212:215], v[192:195], v[132:135]
    s_waitcnt lgkmcnt(0)
    v_mfma_f32_16x16x32_bf16 v[132:135], v[196:199], v[168:171], v[132:135]
    ds_read_b64_tr_b16 v[212:213], v47 offset:8192
    ds_read_b64_tr_b16 v[214:215], v47 offset:9216
    v_mfma_f32_16x16x32_bf16 v[136:139], v[200:203], v[168:171], v[136:139]
    ds_read_b128 v[192:195], v42 offset:10240
    ds_read_b64_tr_b16 v[216:217], v48 offset:8192
    v_mfma_f32_16x16x32_bf16 v[140:143], v[168:171], v[204:207], v[140:143]
    ds_read_b64_tr_b16 v[218:219], v48 offset:9216
    ds_read_b64_tr_b16 v[220:221], v49 offset:8192
    v_mfma_f32_16x16x32_bf16 v[144:147], v[208:211], v[168:171], v[144:147]
    ds_read_b64_tr_b16 v[222:223], v49 offset:9216
    ds_read_b64_tr_b16 v[224:225], v50 offset:8192
    v_mfma_f32_16x16x32_bf16 v[116:119], v[196:199], v[164:167], v[116:119]
    ds_read_b64_tr_b16 v[226:227], v50 offset:9216
    ds_read_b128 v[188:191], v42 offset:8192
    v_mfma_f32_16x16x32_bf16 v[120:123], v[200:203], v[164:167], v[120:123]
    ds_read_b128 v[184:187], v42 offset:6144
    ds_read_b128 v[180:183], v42 offset:4096
    v_mfma_f32_16x16x32_bf16 v[124:127], v[164:167], v[204:207], v[124:127]
    ds_read_b128 v[176:179], v42 offset:2048
    ds_read_b128 v[172:175], v42 offset:0
    v_mfma_f32_16x16x32_bf16 v[128:131], v[208:211], v[164:167], v[128:131]
    s_waitcnt lgkmcnt(11)
    v_mfma_f32_16x16x32_bf16 v[132:135], v[212:215], v[192:195], v[132:135]
    s_waitcnt lgkmcnt(9)
    v_mfma_f32_16x16x32_bf16 v[136:139], v[216:219], v[192:195], v[136:139]
    s_waitcnt lgkmcnt(7)
    v_mfma_f32_16x16x32_bf16 v[140:143], v[192:195], v[220:223], v[140:143]
    s_waitcnt lgkmcnt(5)
    v_mfma_f32_16x16x32_bf16 v[144:147], v[224:227], v[192:195], v[144:147]
    s_waitcnt lgkmcnt(4)
    v_mfma_f32_16x16x32_bf16 v[116:119], v[212:215], v[188:191], v[116:119]
    v_cvt_pk_bf16_f32 v132, v132, v133
    v_cvt_pk_bf16_f32 v133, v134, v135
    v_mfma_f32_16x16x32_bf16 v[120:123], v[216:219], v[188:191], v[120:123]
    v_cvt_pk_bf16_f32 v136, v136, v137
    v_cvt_pk_bf16_f32 v137, v138, v139
    v_mfma_f32_16x16x32_bf16 v[124:127], v[188:191], v[220:223], v[124:127]
    v_mov_b32 v138, 0
    v_mov_b32 v139, 0
    v_mfma_f32_16x16x32_bf16 v[128:131], v[224:227], v[188:191], v[128:131]
    v_cvt_pk_bf16_f32 v134, v144, v145
    v_cvt_pk_bf16_f32 v135, v146, v147
    v_mfma_f32_16x16x32_bf16 v[100:103], v[196:199], v[160:163], v[100:103]
    v_cvt_pk_bf16_f32 v254, v140, v141
    v_cvt_pk_bf16_f32 v255, v142, v143
    v_mfma_f32_16x16x32_bf16 v[104:107], v[200:203], v[160:163], v[104:107]
    v_permlane16_swap_b32 v134, v138
    v_permlane16_swap_b32 v135, v139
    ds_write_b64 v32, v[134:135] offset:768
    v_mfma_f32_16x16x32_bf16 v[108:111], v[160:163], v[204:207], v[108:111]
    ds_read_b64_tr_b16 v[240:241], v33 offset:768
    s_cmp_lg_u32 s54, 0
    s_cbranch_scc1 K_NOX
    ds_write_b64 v34, v[132:133]
    ds_write_b64 v34, v[134:135] offset:512
    ds_write_b64 v34, v[254:255] offset:1024
    v_lshl_add_u32 v2, s55, 2, v38
    ds_write_b16 v2, v38 offset:30
K_NOX:
    v_mfma_f32_16x16x32_bf16 v[112:115], v[208:211], v[160:163], v[112:115]
    v_cvt_pk_bf16_f32 v116, v116, v117
    v_cvt_pk_bf16_f32 v117, v118, v119
    v_mfma_f32_16x16x32_bf16 v[192:195], v[132:135], v[136:139], v[16:19]
    v_cvt_pk_bf16_f32 v120, v120, v121
    v_cvt_pk_bf16_f32 v121, v122, v123
    s_waitcnt lgkmcnt(5)
    v_mfma_f32_16x16x32_bf16 v[100:103], v[212:215], v[184:187], v[100:103]
    v_mov_b32 v122, 0
    v_mov_b32 v123, 0
    v_mfma_f32_16x16x32_bf16 v[104:107], v[216:219], v[184:187], v[104:107]
    v_cvt_pk_bf16_f32 v118, v128, v129
    v_cvt_pk_bf16_f32 v119, v130, v131
    v_mfma_f32_16x16x32_bf16 v[108:111], v[184:187], v[220:223], v[108:111]
    v_cvt_pk_bf16_f32 v252, v124, v125
    v_cvt_pk_bf16_f32 v253, v126, v127
    v_mfma_f32_16x16x32_bf16 v[112:115], v[224:227], v[184:187], v[112:115]
    v_permlane16_swap_b32 v118, v122
    v_permlane16_swap_b32 v119, v123
    ds_write_b64 v32, v[118:119] offset:640
    v_mfma_f32_16x16x32_bf16 v[84:87], v[196:199], v[156:159], v[84:87]
    ds_read_b64_tr_b16 v[238:239], v33 offset:640
    v_cvt_pk_bf16_f32 v100, v100, v101
    v_mfma_f32_16x16x32_bf16 v[88:91], v[200:203], v[156:159], v[88:91]
    v_cvt_pk_bf16_f32 v101, v102, v103
    v_cvt_pk_bf16_f32 v104, v104, v105
    v_mfma_f32_16x16x32_bf16 v[168:171], v[116:119], v[136:139], v[12:15]
    v_cvt_pk_bf16_f32 v105, v106, v107
    v_mov_b32 v106, 0
    v_mfma_f32_16x16x32_bf16 v[92:95], v[156:159], v[204:207], v[92:95]
    v_mov_b32 v107, 0
    v_cvt_pk_bf16_f32 v102, v112, v113
    v_mfma_f32_16x16x32_bf16 v[188:191], v[116:119], v[120:123], v[16:19]
    v_cvt_pk_bf16_f32 v103, v114, v115
    v_cvt_pk_bf16_f32 v250, v108, v109
    v_mfma_f32_16x16x32_bf16 v[96:99], v[208:211], v[156:159], v[96:99]
    v_cvt_pk_bf16_f32 v251, v110, v111
    v_permlane16_swap_b32 v102, v106
    s_waitcnt lgkmcnt(6)
    v_mfma_f32_16x16x32_bf16 v[84:87], v[212:215], v[180:183], v[84:87]
    v_permlane16_swap_b32 v103, v107
    ds_write_b64 v32, v[102:103] offset:512
    v_mfma_f32_16x16x32_bf16 v[88:91], v[216:219], v[180:183], v[88:91]
    ds_read_b64_tr_b16 v[236:237], v33 offset:512
    v_max3_f32 v168, v168, v169, v192
    v_mfma_f32_16x16x32_bf16 v[92:95], v[180:183], v[220:223], v[92:95]
    v_max3_f32 v170, v170, v171, v194
    v_max_f32 v168, v168, v193
    v_mfma_f32_16x16x32_bf16 v[164:167], v[100:103], v[120:123], v[12:15]
    v_max_f32 v169, v170, v195
    v_cvt_pk_bf16_f32 v168, v168, v169
    v_mfma_f32_16x16x32_bf16 v[96:99], v[224:227], v[180:183], v[96:99]
    v_cvt_pk_bf16_f32 v84, v84, v85
    v_cvt_pk_bf16_f32 v85, v86, v87
    v_mfma_f32_16x16x32_bf16 v[184:187], v[100:103], v[104:107], v[16:19]
    v_cvt_pk_bf16_f32 v88, v88, v89
    v_cvt_pk_bf16_f32 v89, v90, v91
    v_mfma_f32_16x16x32_bf16 v[68:71], v[196:199], v[152:155], v[68:71]
    v_mov_b32 v90, 0
    v_mov_b32 v91, 0
    v_mfma_f32_16x16x32_bf16 v[72:75], v[200:203], v[152:155], v[72:75]
    v_max3_f32 v164, v164, v165, v188
    v_max3_f32 v166, v166, v167, v190
    v_mfma_f32_16x16x32_bf16 v[76:79], v[152:155], v[204:207], v[76:79]
    v_max_f32 v164, v164, v189
    v_max_f32 v165, v166, v191
    v_mfma_f32_16x16x32_bf16 v[80:83], v[208:211], v[152:155], v[80:83]
    v_cvt_pk_bf16_f32 v164, v164, v165
    v_cvt_pk_bf16_f32 v86, v96, v97
    s_waitcnt lgkmcnt(7)
    v_mfma_f32_16x16x32_bf16 v[68:71], v[212:215], v[176:179], v[68:71]
    v_cvt_pk_bf16_f32 v87, v98, v99
    v_cvt_pk_bf16_f32 v248, v92, v93
    v_mfma_f32_16x16x32_bf16 v[72:75], v[216:219], v[176:179], v[72:75]
    v_cvt_pk_bf16_f32 v249, v94, v95
    v_permlane16_swap_b32 v86, v90
    v_mfma_f32_16x16x32_bf16 v[76:79], v[176:179], v[220:223], v[76:79]
    v_permlane16_swap_b32 v87, v91
    ds_write_b64 v32, v[86:87] offset:384
    v_mfma_f32_16x16x32_bf16 v[80:83], v[224:227], v[176:179], v[80:83]
    ds_read_b64_tr_b16 v[234:235], v33 offset:384
    v_lshl_add_u32 v2, s55, 2, v38
    v_mfma_f32_16x16x32_bf16 v[52:55], v[196:199], v[148:151], v[52:55]
    ds_read_b32 v3, v2 offset:28
    ds_read_b64 v[144:145], v34
    v_mfma_f32_16x16x32_bf16 v[160:163], v[84:87], v[104:107], v[12:15]
    ds_read_b64 v[146:147], v34 offset:512
    ds_read_b64 v[242:243], v34 offset:1024
    v_mfma_f32_16x16x32_bf16 v[56:59], v[200:203], v[148:151], v[56:59]
    ds_read_b64_tr_b16 v[228:229], v33
    v_cvt_pk_bf16_f32 v68, v68, v69
    v_mfma_f32_16x16x32_bf16 v[180:183], v[84:87], v[88:91], v[16:19]
    v_cvt_pk_bf16_f32 v69, v70, v71
    v_cvt_pk_bf16_f32 v72, v72, v73
    v_mfma_f32_16x16x32_bf16 v[60:63], v[148:151], v[204:207], v[60:63]
    v_cvt_pk_bf16_f32 v73, v74, v75
    v_mov_b32 v74, 0
    v_mfma_f32_16x16x32_bf16 v[64:67], v[208:211], v[148:151], v[64:67]
    v_mov_b32 v75, 0
    v_cvt_pk_bf16_f32 v70, v80, v81
    s_waitcnt lgkmcnt(13)
    v_mfma_f32_16x16x32_bf16 v[52:55], v[212:215], v[172:175], v[52:55]
    v_cvt_pk_bf16_f32 v71, v82, v83
    v_cvt_pk_bf16_f32 v246, v76, v77
    v_mfma_f32_16x16x32_bf16 v[56:59], v[216:219], v[172:175], v[56:59]
    v_cvt_pk_bf16_f32 v247, v78, v79
    v_permlane16_swap_b32 v70, v74
    v_mfma_f32_16x16x32_bf16 v[60:63], v[172:175], v[220:223], v[60:63]
    v_permlane16_swap_b32 v71, v75
    ds_write_b64 v32, v[70:71] offset:256
    v_mfma_f32_16x16x32_bf16 v[64:67], v[224:227], v[172:175], v[64:67]
    ds_read_b64_tr_b16 v[232:233], v33 offset:256
    v_max3_f32 v160, v160, v161, v184
    v_max3_f32 v162, v162, v163, v186
    v_max_f32 v160, v160, v185
    v_max_f32 v161, v162, v187
    v_mfma_f32_16x16x32_bf16 v[156:159], v[68:71], v[88:91], v[12:15]
    v_cvt_pk_bf16_f32 v160, v160, v161
    v_cvt_pk_bf16_f32 v52, v52, v53
    v_cvt_pk_bf16_f32 v53, v54, v55
    v_mfma_f32_16x16x32_bf16 v[176:179], v[68:71], v[72:75], v[16:19]
    v_cvt_pk_bf16_f32 v56, v56, v57
    v_cvt_pk_bf16_f32 v57, v58, v59
    v_mov_b32 v58, 0
    v_mov_b32 v59, 0
    v_cvt_pk_bf16_f32 v54, v64, v65
    v_cvt_pk_bf16_f32 v55, v66, v67
    v_cvt_pk_bf16_f32 v244, v60, v61
    v_cvt_pk_bf16_f32 v245, v62, v63
    v_permlane16_swap_b32 v54, v58
    v_permlane16_swap_b32 v55, v59
    ds_write_b64 v32, v[54:55] offset:128
    ds_read_b64_tr_b16 v[230:231], v33 offset:128
    v_max3_f32 v156, v156, v157, v180
    v_max3_f32 v158, v158, v159, v182
    v_max_f32 v156, v156, v181
    v_mfma_f32_16x16x32_bf16 v[152:155], v[52:55], v[72:75], v[20:23]
    v_max_f32 v157, v158, v183
    v_cvt_pk_bf16_f32 v156, v156, v157
    v_mfma_f32_16x16x32_bf16 v[172:175], v[52:55], v[56:59], v[16:19]
    s_waitcnt lgkmcnt(4)
    v_readfirstlane_b32 s33, v3
    s_cmp_lt_u32 s33, 1811939328
    s_cbranch_scc1 K_XW
K_XR:
    v_mfma_f32_16x16x32_bf16 v[148:151], v[144:147], v[56:59], v[12:15]
    v_max3_f32 v152, v152, v153, v176
    v_max3_f32 v154, v154, v155, v178
    v_max_f32 v152, v152, v177
    v_max_f32 v153, v154, v179
    v_cvt_pk_bf16_f32 v152, v152, v153
    v_permlane16_swap_b32 v164, v168
    v_permlane16_swap_b32 v156, v160
    s_nop 1
    v_max3_f32 v148, v148, v149, v172
    v_max3_f32 v150, v150, v151, v174
    v_max_f32 v148, v148, v173
    v_max_f32 v149, v150, v175
    v_cvt_pk_bf16_f32 v148, v148, v149
    v_permlane32_swap_b32 v156, v164
    v_permlane32_swap_b32 v160, v168
    v_lshlrev_b32 v220, 16, v156
    v_and_b32 v221, 0xffff0000, v156
    v_lshlrev_b32 v224, 16, v164
    v_and_b32 v225, 0xffff0000, v164
    v_lshlrev_b32 v222, 16, v160
    v_and_b32 v223, 0xffff0000, v160
    v_lshlrev_b32 v226, 16, v168
    v_and_b32 v227, 0xffff0000, v168
    v_permlane16_swap_b32 v148, v152
    v_lshlrev_b32 v216, 16, v148
    v_and_b32 v217, 0xffff0000, v148
    v_lshlrev_b32 v218, 16, v152
    v_and_b32 v219, 0xffff0000, v152
    v_pk_mul_f32 v[220:221], v[220:221], s[60:61]
    v_pk_mul_f32 v[224:225], v[224:225], s[60:61]
    v_pk_mul_f32 v[222:223], v[222:223], s[60:61]
    v_pk_mul_f32 v[226:227], v[226:227], s[60:61]
    v_pk_mul_f32 v[216:217], v[216:217], s[60:61]
    v_pk_mul_f32 v[218:219], v[218:219], s[60:61]
    v_cvt_pk_bf16_f32 v156, v220, v221
    v_cvt_pk_bf16_f32 v164, v224, v225
    v_cvt_pk_bf16_f32 v160, v222, v223
    v_cvt_pk_bf16_f32 v168, v226, v227
    v_cvt_pk_bf16_f32 v148, v216, v217
    v_cvt_pk_bf16_f32 v152, v218, v219
    v_lshlrev_b32 v218, 16, v152
    v_and_b32 v219, 0xffff0000, v152
    v_lshlrev_b32 v216, 16, v148
    v_and_b32 v217, 0xffff0000, v148
    v_lshlrev_b32 v226, 16, v168
    v_and_b32 v227, 0xffff0000, v168
    v_lshlrev_b32 v222, 16, v160
    v_and_b32 v223, 0xffff0000, v160
    v_lshlrev_b32 v224, 16, v164
    v_and_b32 v225, 0xffff0000, v164
    v_lshlrev_b32 v220, 16, v156
    v_and_b32 v221, 0xffff0000, v156
    v_max3_f32 v174, v216, v217, v218
    v_max3_f32 v172, v220, v221, v224
    v_max_f32 v174, v174, v219
    v_max3_f32 v172, v172, v225, v222
    v_mov_b32 v176, v174
    v_max3_f32 v172, v172, v223, v226
    v_max_f32 v172, v172, v227
    v_permlane32_swap_b32 v174, v176
    v_mul_f32 v172, s58, v172
    v_max_f32 v174, v174, v176
    v_mul_f32 v174, s58, v174
    v_pk_fma_f32 v[220:221], v[220:221], s[58:59], v[172:173] op_sel_hi:[1,1,0] neg_lo:[0,0,1] neg_hi:[0,0,1]
    v_pk_fma_f32 v[222:223], v[222:223], s[58:59], v[172:173] op_sel_hi:[1,1,0] neg_lo:[0,0,1] neg_hi:[0,0,1]
    v_pk_fma_f32 v[224:225], v[224:225], s[58:59], v[172:173] op_sel_hi:[1,1,0] neg_lo:[0,0,1] neg_hi:[0,0,1]
    v_pk_fma_f32 v[226:227], v[226:227], s[58:59], v[172:173] op_sel_hi:[1,1,0] neg_lo:[0,0,1] neg_hi:[0,0,1]
    v_pk_fma_f32 v[216:217], v[216:217], s[58:59], v[174:175] op_sel_hi:[1,1,0] neg_lo:[0,0,1] neg_hi:[0,0,1]
    v_pk_fma_f32 v[218:219], v[218:219], s[58:59], v[174:175] op_sel_hi:[1,1,0] neg_lo:[0,0,1] neg_hi:[0,0,1]
    v_exp_f32 v216, v216
    v_exp_f32 v217, v217
    v_exp_f32 v218, v218
    v_exp_f32 v219, v219
    v_exp_f32 v220, v220
    v_exp_f32 v221, v221
    v_exp_f32 v222, v222
    v_exp_f32 v223, v223
    v_exp_f32 v224, v224
    v_exp_f32 v225, v225
    v_exp_f32 v226, v226
    v_exp_f32 v227, v227
    ds_read_b32 v3, v2 offset:28
    v_pk_add_f32 v[174:175], v[216:217], v[218:219]
    v_pk_add_f32 v[172:173], v[220:221], v[222:223]
    v_add_f32 v174, v174, v175
    v_pk_add_f32 v[178:179], v[224:225], v[226:227]
    v_mov_b32 v176, v174
    v_pk_add_f32 v[172:173], v[172:173], v[178:179]
    v_add_f32 v172, v172, v173
    v_permlane32_swap_b32 v174, v176
    v_rcp_f32 v172, v172
    v_add_f32 v174, v174, v176
    v_rcp_f32 v174, v174
    v_pk_mul_f32 v[220:221], v[220:221], v[172:173] op_sel_hi:[1,0]
    v_pk_mul_f32 v[222:223], v[222:223], v[172:173] op_sel_hi:[1,0]
    v_pk_mul_f32 v[224:225], v[224:225], v[172:173] op_sel_hi:[1,0]
    v_pk_mul_f32 v[226:227], v[226:227], v[172:173] op_sel_hi:[1,0]
    v_pk_mul_f32 v[216:217], v[216:217], v[174:175] op_sel_hi:[1,0]
    v_pk_mul_f32 v[218:219], v[218:219], v[174:175] op_sel_hi:[1,0]
    v_cvt_pk_bf16_f32 v156, v220, v221
    v_cvt_pk_bf16_f32 v164, v224, v225
    v_cvt_pk_bf16_f32 v160, v222, v223
    v_cvt_pk_bf16_f32 v168, v226, v227
    v_cvt_pk_bf16_f32 v148, v216, v217
    v_cvt_pk_bf16_f32 v152, v218, v219
    v_permlane32_swap_b32 v156, v164
    v_permlane32_swap_b32 v160, v168
    v_permlane16_swap_b32 v148, v152
    s_waitcnt lgkmcnt(0)
    v_permlane16_swap_b32 v156, v160
    v_permlane16_swap_b32 v164, v168
    v_readfirstlane_b32 s33, v3
    s_cmp_lt_u32 s33, 1811939332
    s_cbranch_scc1 K_PW
K_PR:
    s_and_b32 s3, s36, 0xffc00
    s_cbranch_scc0 K_NOHa3
    v_mov_b32 v4, s36
    s_mov_b32 exec_lo, s37
    s_mov_b32 exec_hi, 0
    global_atomic_add v37, v4, s[6:7] sc1
    s_mov_b64 exec, -1
K_NOHa3:
    v_perm_b32 v56, v148, v148, v24
    v_perm_b32 v57, v148, v148, v25
    v_perm_b32 v58, v148, v148, v26
    v_perm_b32 v59, v148, v148, v27
    v_perm_b32 v72, v152, v152, v24
    v_perm_b32 v73, v152, v152, v25
    v_mfma_f32_16x16x32_bf16 v[64:67], v[228:231], v[56:59], 0
    v_perm_b32 v74, v152, v152, v26
    v_perm_b32 v75, v152, v152, v27
    v_mfma_f32_16x16x32_bf16 v[60:63], v[242:245], v[56:59], 0
    v_perm_b32 v88, v156, v156, v24
    v_perm_b32 v89, v156, v156, v25
    v_mfma_f32_16x16x32_bf16 v[80:83], v[230:233], v[72:75], 0
    v_perm_b32 v90, v156, v156, v26
    v_perm_b32 v91, v156, v156, v27
    v_mfma_f32_16x16x32_bf16 v[76:79], v[244:247], v[72:75], 0
    v_perm_b32 v104, v160, v160, v24
    v_perm_b32 v105, v160, v160, v25
    v_mfma_f32_16x16x32_bf16 v[96:99], v[232:235], v[88:91], 0
    v_perm_b32 v106, v160, v160, v26
    v_perm_b32 v107, v160, v160, v27
    v_mfma_f32_16x16x32_bf16 v[92:95], v[246:249], v[88:91], 0
    v_cvt_pk_bf16_f32 v68, v64, v65
    v_cvt_pk_bf16_f32 v69, v66, v67
    ds_write_b64 v35, v[68:69] offset:0
    v_perm_b32 v120, v164, v164, v24
    v_perm_b32 v121, v164, v164, v25
    v_mfma_f32_16x16x32_bf16 v[112:115], v[234:237], v[104:107], 0
    v_perm_b32 v122, v164, v164, v26
    v_perm_b32 v123, v164, v164, v27
    v_mfma_f32_16x16x32_bf16 v[108:111], v[248:251], v[104:107], 0
    v_cvt_pk_bf16_f32 v70, v80, v81
    v_cvt_pk_bf16_f32 v71, v82, v83
    ds_write_b64 v35, v[70:71] offset:256
    v_perm_b32 v136, v168, v168, v24
    v_perm_b32 v137, v168, v168, v25
    v_mfma_f32_16x16x32_bf16 v[128:131], v[236:239], v[120:123], 0
    v_perm_b32 v138, v168, v168, v26
    v_perm_b32 v139, v168, v168, v27
    v_mfma_f32_16x16x32_bf16 v[124:127], v[250:253], v[120:123], 0
    v_cvt_pk_bf16_f32 v100, v96, v97
    v_cvt_pk_bf16_f32 v101, v98, v99
    ds_write_b64 v35, v[100:101] offset:512
    v_mov_b32 v3, 1
    v_mfma_f32_16x16x32_bf16 v[144:147], v[238:241], v[136:139], 0
    s_and_b32 s3, s36, 0x3ff
    s_cbranch_scc0 K_NOHa4
    v_mov_b32 v4, s36
    s_mov_b32 exec_lo, s37
    s_mov_b32 exec_hi, 0
    global_atomic_add v37, v4, s[6:7] sc1
    s_mov_b64 exec, -1
K_NOHa4:
    v_lshl_add_u32 v2, s54, 2, v38
    v_cvt_pk_bf16_f32 v102, v112, v113
    v_cvt_pk_bf16_f32 v103, v114, v115
    ds_write_b64 v35, v[102:103] offset:768
    v_mfma_f32_16x16x32_bf16 v[140:143], v[252:255], v[136:139], 0
    v_cvt_pk_bf16_f32 v132, v128, v129
    v_cvt_pk_bf16_f32 v133, v130, v131
    ds_write_b64 v35, v[132:133] offset:1024
    v_cvt_pk_bf16_f32 v134, v144, v145
    v_cvt_pk_bf16_f32 v135, v146, v147
    ds_write_b64 v35, v[134:135] offset:1280
    s_mov_b64 exec, 1
    ds_add_u32 v2, v3 offset:48
    s_mov_b64 exec, -1
    v_cvt_pk_bf16_f32 v52, v60, v61
    v_cvt_pk_bf16_f32 v54, v76, v77
    v_cvt_pk_bf16_f32 v53, v62, v63
    v_cvt_pk_bf16_f32 v55, v78, v79
    s_nop 0
    v_permlane16_swap_b32 v52, v54
    v_permlane16_swap_b32 v53, v55
    v_min_u32 v52, -2, v52
    buffer_store_dwordx4 v[52:55], v28, s[20:23], 0 offen sc1
    v_cvt_pk_bf16_f32 v84, v92, v93
    v_cvt_pk_bf16_f32 v86, v108, v109
    v_cvt_pk_bf16_f32 v85, v94, v95
    v_cvt_pk_bf16_f32 v87, v110, v111
    s_nop 0
    v_permlane16_swap_b32 v84, v86
    v_permlane16_swap_b32 v85, v87
    v_min_u32 v84, -2, v84
    buffer_store_dwordx4 v[84:87], v29, s[20:23], 0 offen sc1
    ds_read_b32 v3, v2 offset:48
    ds_read_b128 v[196:199], v36
    v_cvt_pk_bf16_f32 v116, v124, v125
    v_cvt_pk_bf16_f32 v118, v140, v141
    v_cvt_pk_bf16_f32 v117, v126, v127
    v_cvt_pk_bf16_f32 v119, v142, v143
    s_nop 0
    v_permlane16_swap_b32 v116, v118
    v_permlane16_swap_b32 v117, v119
    v_min_u32 v116, -2, v116
    buffer_store_dwordx4 v[116:119], v30, s[20:23], 0 offen sc1
    s_waitcnt lgkmcnt(0)
    v_readfirstlane_b32 s33, v3
    s_cmp_lt_u32 s33, 2
    s_cbranch_scc1 K_TW
K_TR:
    v_min_u32 v196, -2, v196
    buffer_store_dwordx4 v[196:199], v31, s[20:23], 0 offen sc1
    s_cmp_eq_u32 s34, -1
    s_cbranch_scc1 K_END
    s_add_u32 s30, s30, 4
    s_branch K_P2_HELP
K_CHM3:
K_STM3:
    s_branch K_WRET_M
    s_nop 0
K_XW:
    s_mov_b32 s3, 1048576
K_CGX:
    ds_read_b32 v3, v2 offset:28
    s_sub_u32 s3, s3, 1
    s_waitcnt lgkmcnt(0)
    v_readfirstlane_b32 s33, v3
    s_cselect_b32 s33, 1811939328, s33
    s_cmp_lt_u32 s33, 1811939328
    s_cbranch_scc1 K_CGX
    ds_read_b64 v[144:145], v34
    ds_read_b64 v[146:147], v34 offset:512
    ds_read_b64 v[242:243], v34 offset:1024
    ds_read_b64_tr_b16 v[228:229], v33
    s_waitcnt lgkmcnt(0)
    s_branch K_XR
K_PW:
    s_mov_b32 s3, 1048576
K_CGP:
    ds_read_b32 v3, v2 offset:28
    s_sub_u32 s3, s3, 1
    s_waitcnt lgkmcnt(0)
    v_readfirstlane_b32 s33, v3
    s_cselect_b32 s33, 1811939332, s33
    s_cmp_lt_u32 s33, 1811939332
    s_cbranch_scc1 K_CGP
    s_branch K_PR
K_TW:
    s_mov_b32 s3, 1048576
K_CGT:
    ds_read_b32 v3, v2 offset:48
    s_sub_u32 s3, s3, 1
    s_waitcnt lgkmcnt(0)
    v_readfirstlane_b32 s33, v3
    s_cselect_b32 s33, 2, s33
    s_cmp_lt_u32 s33, 2
    s_cbranch_scc1 K_CGT
    ds_read_b128 v[196:199], v36
    s_waitcnt lgkmcnt(0)
    s_branch K_TR
K_P2_EARLY:
    s_lshl_b32 s62, s40, 7
    v_lshrrev_b32 v8, 3, v1
    v_lshrrev_b32 v9, 4, v1
    v_mov_b32 v15, 158720
    s_lshl_b32 s61, s40, 3
    s_add_u32 s61, s61, s30
    s_mul_i32 s3, s61, 20480
    s_lshl_b32 s33, s41, 7
    s_add_u32 s3, s3, s33
    v_and_b32 v2, 7, v1
    v_lshlrev_b32 v2, 4, v2
    v_mul_u32_u24 v4, 1280, v8
    v_add3_u32 v10, v2, v4, s3
    s_lshl_b32 s3, s30, 7
    s_add_u32 s3, s3, 159744
    v_lshl_add_u32 v11, v8, 3, s3
    s_mov_b32 s63, 10240
    s_add_u32 s20, s6, 0x100000
    s_addc_u32 s21, s7, 0
    s_mov_b32 s22, 0x280000
    s_mov_b32 s23, 0x20000
    s_mov_b32 s56, s10
    s_mov_b32 s57, s11
    s_mov_b32 s58, 0x280000
    s_mov_b32 s59, 0x20000
    v_mul_u32_u24 v3, 144, v8
    v_add_u32 v3, v2, v3
    s_mul_i32 s3, s30, 2304
    s_add_u32 s3, s3, 140288
    v_add_u32 v14, s3, v3
    buffer_load_dwordx4 v[16:19], v10, s[12:15], 0 offen
    buffer_load_dwordx4 v[20:23], v10, s[12:15], s63 offen
    v_bfe_u32 v48, v1, 2, 2
    v_and_b32 v49, 3, v1
    s_add_u32 s3, s61, s30
    s_lshr_b32 s33, s3, 2
    s_mul_i32 s33, s33, 76
    s_add_u32 s3, s3, s33
    s_lshl_b32 s3, s3, 10
    v_and_b32 v2, 15, v1
    v_lshl_add_u32 v2, v2, 4, s3
    v_lshrrev_b32 v3, 5, v1
    v_lshl_add_u32 v2, v3, 8, v2
    v_and_b32 v4, 1, v9
    v_lshl_add_u32 v52, v4, 10, v2
    v_mov_b32 v53, 0x1f000
    v_lshl_add_u32 v2, v3, 3, v48
    v_lshlrev_b32 v2, 7, v2
    v_lshl_add_u32 v2, v49, 3, v2
    v_lshl_add_u32 v2, v4, 5, v2
    v_lshrrev_b32 v4, 1, v48
    v_lshl_add_u32 v54, v4, 6, v2
    v_xor_b32 v55, 64, v54
    v_mov_b32 v56, v54
    v_mov_b32 v57, v54
    s_branch K_PG3
.p2align 12
K_CHA0:
K_STA4:
    s_branch K_STA8
K_CHB0:
K_STB4:
    s_branch K_STB8
K_PG3:
    v_and_b32 v2, 31, v1
    v_mul_u32_u24 v2, 144, v2
    v_lshl_add_u32 v2, v3, 3, v2
    s_mul_i32 s3, s30, 4608
    s_add_u32 s3, s3, 140288
    v_add_u32 v50, s3, v2
    s_lshl_b32 s3, s40, 3
    s_mul_i32 s33, s3, 187
    s_lshr_b32 s33, s33, 11
    s_add_u32 s33, s33, 1
    s_mul_i32 s33, s33, 11
    s_add_u32 s3, s61, s30
    s_add_u32 s3, s3, 1
    s_cmp_ge_u32 s3, s33
    s_cselect_b32 s60, 24, 16
    s_cmp_gt_u32 s3, s33
    s_cselect_b32 s60, 20, s60
    v_add_u32 v58, s60, v15
    s_mov_b32 s64, -1
    s_mov_b32 s65, -1
    s_mov_b32 s66, -1
    s_mov_b32 s67, -1
    s_mov_b32 s68, -1
    s_mov_b32 s69, -1
    s_mov_b32 s70, 0xfffff
    s_mov_b32 s71, 131072
    v_mov_b32 v108, 0
    v_mov_b32 v109, 0
    v_mov_b32 v110, 0
    v_mov_b32 v111, 0
    v_mov_b32 v112, 0
    v_mov_b32 v113, 0
    v_mov_b32 v114, 0
    v_mov_b32 v115, 0
    v_mov_b32 v116, 0
    v_mov_b32 v117, 0
    v_mov_b32 v118, 0
    v_mov_b32 v119, 0
    v_mov_b32 v120, 0
    v_mov_b32 v121, 0
    v_mov_b32 v122, 0
    v_mov_b32 v123, 0
    v_mov_b32 v124, 0
    v_mov_b32 v125, 0
    v_mov_b32 v126, 0
    v_mov_b32 v127, 0
    v_mov_b32 v128, 0
    v_mov_b32 v129, 0
    v_mov_b32 v130, 0
    v_mov_b32 v131, 0
    v_mov_b32 v132, 0
    v_mov_b32 v133, 0
    v_mov_b32 v134, 0
    v_mov_b32 v135, 0
    v_mov_b32 v136, 0
    v_mov_b32 v137, 0
    v_mov_b32 v138, 0
    v_mov_b32 v139, 0
    s_barrier
    s_branch K_P2_AUXW
K_P2_GM:
    s_lshl_b32 s62, s40, 7
    v_lshrrev_b32 v8, 3, v1
    v_lshrrev_b32 v9, 4, v1
    v_mov_b32 v15, 158720
    s_lshl_b32 s61, s40, 3
    s_add_u32 s61, s61, s30
    s_mul_i32 s3, s61, 20480
    s_lshl_b32 s33, s41, 7
    s_add_u32 s3, s3, s33
    v_and_b32 v2, 7, v1
    v_lshlrev_b32 v2, 4, v2
    v_mul_u32_u24 v4, 1280, v8
    v_add3_u32 v10, v2, v4, s3
    s_lshl_b32 s3, s30, 7
    s_add_u32 s3, s3, 159744
    v_lshl_add_u32 v11, v8, 3, s3
    s_mov_b32 s63, 10240
    s_add_u32 s20, s6, 0x100000
    s_addc_u32 s21, s7, 0
    s_mov_b32 s22, 0x280000
    s_mov_b32 s23, 0x20000
    s_mov_b32 s56, s10
    s_mov_b32 s57, s11
    s_mov_b32 s58, 0x280000
    s_mov_b32 s59, 0x20000
    v_mul_u32_u24 v3, 144, v8
    v_add_u32 v3, v2, v3
    s_mul_i32 s3, s30, 2304
    s_add_u32 s3, s3, 140288
    v_add_u32 v14, s3, v3
    v_bfe_u32 v48, v1, 2, 2
    v_and_b32 v49, 3, v1
    s_add_u32 s3, s61, s30
    s_lshr_b32 s33, s3, 2
    s_mul_i32 s33, s33, 76
    s_add_u32 s3, s3, s33
    s_lshl_b32 s3, s3, 10
    v_and_b32 v2, 15, v1
    v_lshl_add_u32 v2, v2, 4, s3
    v_lshrrev_b32 v3, 5, v1
    v_lshl_add_u32 v2, v3, 8, v2
    v_and_b32 v4, 1, v9
    v_lshl_add_u32 v52, v4, 10, v2
    v_mov_b32 v53, 0x1f000
    v_lshl_add_u32 v2, v3, 3, v48
    v_lshlrev_b32 v2, 7, v2
    v_lshl_add_u32 v2, v49, 3, v2
    v_lshl_add_u32 v2, v4, 5, v2
    v_lshrrev_b32 v4, 1, v48
    v_lshl_add_u32 v54, v4, 6, v2
    v_xor_b32 v55, 64, v54
    v_mov_b32 v56, v54
    v_mov_b32 v57, v54
    v_and_b32 v2, 31, v1
    v_mul_u32_u24 v2, 144, v2
    v_lshl_add_u32 v2, v3, 3, v2
    s_mul_i32 s3, s30, 4608
    s_add_u32 s3, s3, 140288
    v_add_u32 v50, s3, v2
    s_lshl_b32 s3, s40, 3
    s_mul_i32 s33, s3, 187
    s_lshr_b32 s33, s33, 11
    s_add_u32 s33, s33, 1
    s_mul_i32 s33, s33, 11
    s_add_u32 s3, s61, s30
    s_add_u32 s3, s3, 1
    s_cmp_ge_u32 s3, s33
    s_cselect_b32 s60, 24, 16
    s_cmp_gt_u32 s3, s33
    s_cselect_b32 s60, 20, s60
    v_add_u32 v58, s60, v15
    s_mov_b32 s64, -1
    s_mov_b32 s65, -1
    s_mov_b32 s66, -1
    s_mov_b32 s67, -1
    s_mov_b32 s68, -1
    s_mov_b32 s69, -1
    s_mov_b32 s70, 0xfffff
    s_mov_b32 s71, 131072
    v_mov_b32 v108, 0
    v_mov_b32 v109, 0
    v_mov_b32 v110, 0
    v_mov_b32 v111, 0
    v_mov_b32 v112, 0
    v_mov_b32 v113, 0
    v_mov_b32 v114, 0
    v_mov_b32 v115, 0
    v_mov_b32 v116, 0
    v_mov_b32 v117, 0
    v_mov_b32 v118, 0
    v_mov_b32 v119, 0
    v_mov_b32 v120, 0
    v_mov_b32 v121, 0
    v_mov_b32 v122, 0
    v_mov_b32 v123, 0
    v_mov_b32 v124, 0
    v_mov_b32 v125, 0
    v_mov_b32 v126, 0
    v_mov_b32 v127, 0
    v_mov_b32 v128, 0
    v_mov_b32 v129, 0
    v_mov_b32 v130, 0
    v_mov_b32 v131, 0
    v_mov_b32 v132, 0
    v_mov_b32 v133, 0
    v_mov_b32 v134, 0
    v_mov_b32 v135, 0
    v_mov_b32 v136, 0
    v_mov_b32 v137, 0
    v_mov_b32 v138, 0
    v_mov_b32 v139, 0
    buffer_load_dwordx4 v[16:19], v10, s[12:15], 0 offen
    buffer_load_dwordx4 v[20:23], v10, s[12:15], s63 offen
    s_cmp_eq_u32 s30, 0
    s_cbranch_scc1 K_CHB0
    s_cmp_eq_u32 s30, 1
    s_cbranch_scc1 K_CHB1
    s_cmp_eq_u32 s30, 2
    s_cbranch_scc1 K_CHB2
    s_branch K_CHB3
K_WRET_B:
    v_mov_b32 v3, 1
    s_waitcnt vmcnt(2)
    s_mov_b64 exec, 1
    ds_add_u32 v15, v3 offset:44
    s_mov_b64 exec, -1
    s_mov_b32 s3, 1048576
K_P2_GWM:
    ds_read_b32 v2, v15 offset:44
    s_sleep 1
    s_sub_u32 s3, s3, 1
    s_waitcnt lgkmcnt(0)
    v_readfirstlane_b32 s33, v2
    s_nop 3
    s_cselect_b32 s33, 4, s33
    s_cmp_lt_u32 s33, 4
    s_cbranch_scc1 K_P2_GWM
    ds_write_b32 v15, v15 offset:56
K_P2_GEMM:
    s_setprio 1
    s_mul_i32 s52, s40, 1496
    s_add_u32 s53, s52, 1309
    s_lshr_b32 s52, s52, 11
    s_lshr_b32 s53, s53, 11
    s_sub_u32 s53, s53, s52
    s_mov_b32 s46, 0x84210
    s_mov_b32 s47, s46
    s_waitcnt vmcnt(0)
    v_lshlrev_b32 v32, 16, v16
    v_and_b32 v33, 0xffff0000, v16
    v_lshlrev_b32 v34, 16, v17
    v_and_b32 v35, 0xffff0000, v17
    v_lshlrev_b32 v36, 16, v18
    v_and_b32 v37, 0xffff0000, v18
    v_lshlrev_b32 v38, 16, v19
    v_and_b32 v39, 0xffff0000, v19
    v_lshlrev_b32 v40, 16, v20
    v_and_b32 v41, 0xffff0000, v20
    v_lshlrev_b32 v42, 16, v21
    v_and_b32 v43, 0xffff0000, v21
    v_lshlrev_b32 v44, 16, v22
    v_and_b32 v45, 0xffff0000, v22
    v_lshlrev_b32 v46, 16, v23
    v_and_b32 v47, 0xffff0000, v23
    s_branch K_SPL
K_IT0:
    v_mfma_f32_32x32x16_bf16 v[108:123], v[156:159], v[68:71], v[108:123]
    ds_read_b64_tr_b16 v[140:141], v56 offset:0
    ds_read_b64_tr_b16 v[142:143], v56 offset:512
    s_and_b32 s33, s50, s70
    s_cbranch_scc0 K_RF0
K_RB0:
    s_ff1_i32_b32 s51, s33
    ds_read_b64_tr_b16 v[144:145], v56 offset:2048
    v_mfma_f32_32x32x16_bf16 v[124:139], v[164:167], v[68:71], v[124:139]
    s_bitset0_b32 s70, s51
    s_lshl_b32 s64, s51, 12
    buffer_load_dwordx4 v[60:63], v52, s[20:23], s64 offen offset:0 sc1
    ds_read_b64_tr_b16 v[146:147], v56 offset:2560
    ds_read_b64_tr_b16 v[148:149], v57 offset:0
    v_mfma_f32_32x32x16_bf16 v[108:123], v[160:163], v[72:75], v[108:123]
    buffer_load_dwordx4 v[64:67], v52, s[20:23], s64 offen offset:512 sc1
    ds_read_b64_tr_b16 v[150:151], v57 offset:512
    ds_read_b64_tr_b16 v[152:153], v57 offset:2048
    ds_read_b64_tr_b16 v[154:155], v57 offset:2560
    v_mfma_f32_32x32x16_bf16 v[124:139], v[168:171], v[72:75], v[124:139]
K_TL0:
    s_waitcnt vmcnt(8) lgkmcnt(8)
    v_cmp_u_f32 vcc, v76, v80
    v_and_or_b32 v56, s68, v53, v54
    v_and_or_b32 v57, s68, v53, v55
    s_cbranch_vccnz K_FX1
K_IT1:
    v_mfma_f32_32x32x16_bf16 v[108:123], v[172:175], v[76:79], v[108:123]
    ds_read_b64_tr_b16 v[156:157], v56 offset:0
    ds_read_b64_tr_b16 v[158:159], v56 offset:512
    s_and_b32 s33, s50, s70
    s_cbranch_scc0 K_RF1
K_RB1:
    s_ff1_i32_b32 s51, s33
    ds_read_b64_tr_b16 v[160:161], v56 offset:2048
    v_mfma_f32_32x32x16_bf16 v[124:139], v[180:183], v[76:79], v[124:139]
    s_bitset0_b32 s70, s51
    s_lshl_b32 s65, s51, 12
    buffer_load_dwordx4 v[68:71], v52, s[20:23], s65 offen offset:0 sc1
    ds_read_b64_tr_b16 v[162:163], v56 offset:2560
    ds_read_b64_tr_b16 v[164:165], v57 offset:0
    v_mfma_f32_32x32x16_bf16 v[108:123], v[176:179], v[80:83], v[108:123]
    buffer_load_dwordx4 v[72:75], v52, s[20:23], s65 offen offset:512 sc1
    ds_read_b64_tr_b16 v[166:167], v57 offset:512
    ds_read_b64_tr_b16 v[168:169], v57 offset:2048
    ds_read_b64_tr_b16 v[170:171], v57 offset:2560
    v_mfma_f32_32x32x16_bf16 v[124:139], v[184:187], v[80:83], v[124:139]
K_TL1:
    s_waitcnt vmcnt(8) lgkmcnt(8)
    v_cmp_u_f32 vcc, v84, v88
    v_and_or_b32 v56, s69, v53, v54
    v_and_or_b32 v57, s69, v53, v55
    s_cbranch_vccnz K_FX2
K_IT2:
    v_mfma_f32_32x32x16_bf16 v[108:123], v[140:143], v[84:87], v[108:123]
    ds_read_b64_tr_b16 v[172:173], v56 offset:0
    ds_read_b64_tr_b16 v[174:175], v56 offset:512
    s_and_b32 s33, s50, s70
    s_cbranch_scc0 K_RF2
K_RB2:
    s_ff1_i32_b32 s51, s33
    ds_read_b64_tr_b16 v[176:177], v56 offset:2048
    v_mfma_f32_32x32x16_bf16 v[124:139], v[148:151], v[84:87], v[124:139]
    s_bitset0_b32 s70, s51
    s_lshl_b32 s66, s51, 12
    buffer_load_dwordx4 v[76:79], v52, s[20:23], s66 offen offset:0 sc1
    ds_read_b64_tr_b16 v[178:179], v56 offset:2560
    ds_read_b64_tr_b16 v[180:181], v57 offset:0
    v_mfma_f32_32x32x16_bf16 v[108:123], v[144:147], v[88:91], v[108:123]
    buffer_load_dwordx4 v[80:83], v52, s[20:23], s66 offen offset:512 sc1
    ds_read_b64_tr_b16 v[182:183], v57 offset:512
    ds_read_b64_tr_b16 v[184:185], v57 offset:2048
    ds_read_b64_tr_b16 v[186:187], v57 offset:2560
    v_mfma_f32_32x32x16_bf16 v[124:139], v[152:155], v[88:91], v[124:139]
K_TL2:
    s_waitcnt vmcnt(8) lgkmcnt(8)
    v_cmp_u_f32 vcc, v92, v96
    v_and_or_b32 v56, s64, v53, v54
    v_and_or_b32 v57, s64, v53, v55
    s_cbranch_vccnz K_FX3
K_IT3:
    v_mfma_f32_32x32x16_bf16 v[108:123], v[156:159], v[92:95], v[108:123]
    ds_read_b64_tr_b16 v[140:141], v56 offset:0
    ds_read_b64_tr_b16 v[142:143], v56 offset:512
    s_and_b32 s33, s50, s70
    s_cbranch_scc0 K_RF3
K_RB3:
    s_ff1_i32_b32 s51, s33
    ds_read_b64_tr_b16 v[144:145], v56 offset:2048
    v_mfma_f32_32x32x16_bf16 v[124:139], v[164:167], v[92:95], v[124:139]
    s_bitset0_b32 s70, s51
    s_lshl_b32 s67, s51, 12
    buffer_load_dwordx4 v[84:87], v52, s[20:23], s67 offen offset:0 sc1
    ds_read_b64_tr_b16 v[146:147], v56 offset:2560
    ds_read_b64_tr_b16 v[148:149], v57 offset:0
    v_mfma_f32_32x32x16_bf16 v[108:123], v[160:163], v[96:99], v[108:123]
    buffer_load_dwordx4 v[88:91], v52, s[20:23], s67 offen offset:512 sc1
    ds_read_b64_tr_b16 v[150:151], v57 offset:512
    ds_read_b64_tr_b16 v[152:153], v57 offset:2048
    ds_read_b64_tr_b16 v[154:155], v57 offset:2560
    v_mfma_f32_32x32x16_bf16 v[124:139], v[168:171], v[96:99], v[124:139]
K_TL3:
    s_waitcnt vmcnt(8) lgkmcnt(8)
    v_cmp_u_f32 vcc, v100, v104
    v_and_or_b32 v56, s65, v53, v54
    v_and_or_b32 v57, s65, v53, v55
    s_cbranch_vccnz K_FX4
K_IT4:
    v_mfma_f32_32x32x16_bf16 v[108:123], v[172:175], v[100:103], v[108:123]
    ds_read_b64_tr_b16 v[156:157], v56 offset:0
    ds_read_b64_tr_b16 v[158:159], v56 offset:512
    s_and_b32 s33, s50, s70
    s_cbranch_scc0 K_RF4
K_RB4:
    s_ff1_i32_b32 s51, s33
    ds_read_b64_tr_b16 v[160:161], v56 offset:2048
    v_mfma_f32_32x32x16_bf16 v[124:139], v[180:183], v[100:103], v[124:139]
    s_bitset0_b32 s70, s51
    s_lshl_b32 s68, s51, 12
    buffer_load_dwordx4 v[92:95], v52, s[20:23], s68 offen offset:0 sc1
    ds_read_b64_tr_b16 v[162:163], v56 offset:2560
    ds_read_b64_tr_b16 v[164:165], v57 offset:0
    v_mfma_f32_32x32x16_bf16 v[108:123], v[176:179], v[104:107], v[108:123]
    buffer_load_dwordx4 v[96:99], v52, s[20:23], s68 offen offset:512 sc1
    ds_read_b64_tr_b16 v[166:167], v57 offset:512
    ds_read_b64_tr_b16 v[168:169], v57 offset:2048
    ds_read_b64_tr_b16 v[170:171], v57 offset:2560
    v_mfma_f32_32x32x16_bf16 v[124:139], v[184:187], v[104:107], v[124:139]
K_TL4:
    s_waitcnt vmcnt(8) lgkmcnt(8)
    v_cmp_u_f32 vcc, v60, v64
    v_and_or_b32 v56, s66, v53, v54
    v_and_or_b32 v57, s66, v53, v55
    s_cbranch_vccnz K_FX5
K_IT5:
    v_mfma_f32_32x32x16_bf16 v[108:123], v[140:143], v[60:63], v[108:123]
    ds_read_b64_tr_b16 v[172:173], v56 offset:0
    ds_read_b64_tr_b16 v[174:175], v56 offset:512
    s_and_b32 s33, s50, s70
    s_cbranch_scc0 K_RF5
K_RB5:
    s_ff1_i32_b32 s51, s33
    ds_read_b64_tr_b16 v[176:177], v56 offset:2048
    v_mfma_f32_32x32x16_bf16 v[124:139], v[148:151], v[60:63], v[124:139]
    s_bitset0_b32 s70, s51
    s_lshl_b32 s69, s51, 12
    buffer_load_dwordx4 v[100:103], v52, s[20:23], s69 offen offset:0 sc1
    ds_read_b64_tr_b16 v[178:179], v56 offset:2560
    ds_read_b64_tr_b16 v[180:181], v57 offset:0
    v_mfma_f32_32x32x16_bf16 v[108:123], v[144:147], v[64:67], v[108:123]
    buffer_load_dwordx4 v[104:107], v52, s[20:23], s69 offen offset:512 sc1
    ds_read_b64_tr_b16 v[182:183], v57 offset:512
    ds_read_b64_tr_b16 v[184:185], v57 offset:2048
    ds_read_b64_tr_b16 v[186:187], v57 offset:2560
    v_mfma_f32_32x32x16_bf16 v[124:139], v[152:155], v[64:67], v[124:139]
K_TL5:
    s_waitcnt vmcnt(8) lgkmcnt(8)
    v_cmp_u_f32 vcc, v68, v72
    v_and_or_b32 v56, s67, v53, v54
    v_and_or_b32 v57, s67, v53, v55
    s_cbranch_vccnz K_FX0
    s_branch K_IT0
K_DR0:
    v_mfma_f32_32x32x16_bf16 v[108:123], v[156:159], v[68:71], v[108:123]
    ds_read_b64_tr_b16 v[140:141], v56 offset:0
    ds_read_b64_tr_b16 v[142:143], v56 offset:512
K_DM0:
    ds_read_b64_tr_b16 v[144:145], v56 offset:2048
    s_mov_b32 s64, -1
    v_mfma_f32_32x32x16_bf16 v[124:139], v[164:167], v[68:71], v[124:139]
    buffer_load_dword v3, v52, s[20:23], s64 offen
    ds_read_b64_tr_b16 v[146:147], v56 offset:2560
    ds_read_b64_tr_b16 v[148:149], v57 offset:0
    v_mfma_f32_32x32x16_bf16 v[108:123], v[160:163], v[72:75], v[108:123]
    buffer_load_dword v3, v52, s[20:23], s64 offen
    ds_read_b64_tr_b16 v[150:151], v57 offset:512
    ds_read_b64_tr_b16 v[152:153], v57 offset:2048
    ds_read_b64_tr_b16 v[154:155], v57 offset:2560
    v_mfma_f32_32x32x16_bf16 v[124:139], v[168:171], v[72:75], v[124:139]
    s_waitcnt vmcnt(8) lgkmcnt(8)
    v_cmp_u_f32 vcc, v76, v80
    v_and_or_b32 v56, s68, v53, v54
    v_and_or_b32 v57, s68, v53, v55
    v_mov_b32 v60, -1
    s_cbranch_vccnz K_FX1
K_DR1:
    v_mfma_f32_32x32x16_bf16 v[108:123], v[172:175], v[76:79], v[108:123]
    ds_read_b64_tr_b16 v[156:157], v56 offset:0
    ds_read_b64_tr_b16 v[158:159], v56 offset:512
K_DM1:
    ds_read_b64_tr_b16 v[160:161], v56 offset:2048
    s_mov_b32 s65, -1
    v_mfma_f32_32x32x16_bf16 v[124:139], v[180:183], v[76:79], v[124:139]
    buffer_load_dword v3, v52, s[20:23], s65 offen
    ds_read_b64_tr_b16 v[162:163], v56 offset:2560
    ds_read_b64_tr_b16 v[164:165], v57 offset:0
    v_mfma_f32_32x32x16_bf16 v[108:123], v[176:179], v[80:83], v[108:123]
    buffer_load_dword v3, v52, s[20:23], s65 offen
    ds_read_b64_tr_b16 v[166:167], v57 offset:512
    ds_read_b64_tr_b16 v[168:169], v57 offset:2048
    ds_read_b64_tr_b16 v[170:171], v57 offset:2560
    v_mfma_f32_32x32x16_bf16 v[124:139], v[184:187], v[80:83], v[124:139]
    s_waitcnt vmcnt(8) lgkmcnt(8)
    v_cmp_u_f32 vcc, v84, v88
    v_and_or_b32 v56, s69, v53, v54
    v_and_or_b32 v57, s69, v53, v55
    v_mov_b32 v68, -1
    s_cbranch_vccnz K_FX2
K_DR2:
    v_mfma_f32_32x32x16_bf16 v[108:123], v[140:143], v[84:87], v[108:123]
    ds_read_b64_tr_b16 v[172:173], v56 offset:0
    ds_read_b64_tr_b16 v[174:175], v56 offset:512
K_DM2:
    ds_read_b64_tr_b16 v[176:177], v56 offset:2048
    s_mov_b32 s66, -1
    v_mfma_f32_32x32x16_bf16 v[124:139], v[148:151], v[84:87], v[124:139]
    buffer_load_dword v3, v52, s[20:23], s66 offen
    ds_read_b64_tr_b16 v[178:179], v56 offset:2560
    ds_read_b64_tr_b16 v[180:181], v57 offset:0
    v_mfma_f32_32x32x16_bf16 v[108:123], v[144:147], v[88:91], v[108:123]
    buffer_load_dword v3, v52, s[20:23], s66 offen
    ds_read_b64_tr_b16 v[182:183], v57 offset:512
    ds_read_b64_tr_b16 v[184:185], v57 offset:2048
    ds_read_b64_tr_b16 v[186:187], v57 offset:2560
    v_mfma_f32_32x32x16_bf16 v[124:139], v[152:155], v[88:91], v[124:139]
    s_waitcnt vmcnt(8) lgkmcnt(8)
    v_cmp_u_f32 vcc, v92, v96
    v_and_or_b32 v56, s64, v53, v54
    v_and_or_b32 v57, s64, v53, v55
    v_mov_b32 v76, -1
    s_cbranch_vccnz K_FX3
K_DR3:
    v_mfma_f32_32x32x16_bf16 v[108:123], v[156:159], v[92:95], v[108:123]
    ds_read_b64_tr_b16 v[140:141], v56 offset:0
    ds_read_b64_tr_b16 v[142:143], v56 offset:512
K_DM3:
    ds_read_b64_tr_b16 v[144:145], v56 offset:2048
    s_mov_b32 s67, -1
    v_mfma_f32_32x32x16_bf16 v[124:139], v[164:167], v[92:95], v[124:139]
    buffer_load_dword v3, v52, s[20:23], s67 offen
    ds_read_b64_tr_b16 v[146:147], v56 offset:2560
    ds_read_b64_tr_b16 v[148:149], v57 offset:0
    v_mfma_f32_32x32x16_bf16 v[108:123], v[160:163], v[96:99], v[108:123]
    buffer_load_dword v3, v52, s[20:23], s67 offen
    ds_read_b64_tr_b16 v[150:151], v57 offset:512
    ds_read_b64_tr_b16 v[152:153], v57 offset:2048
    ds_read_b64_tr_b16 v[154:155], v57 offset:2560
    v_mfma_f32_32x32x16_bf16 v[124:139], v[168:171], v[96:99], v[124:139]
    s_waitcnt vmcnt(8) lgkmcnt(8)
    v_cmp_u_f32 vcc, v100, v104
    v_and_or_b32 v56, s65, v53, v54
    v_and_or_b32 v57, s65, v53, v55
    v_mov_b32 v84, -1
    s_cbranch_vccnz K_FX4
K_DR4:
    v_mfma_f32_32x32x16_bf16 v[108:123], v[172:175], v[100:103], v[108:123]
    ds_read_b64_tr_b16 v[156:157], v56 offset:0
    ds_read_b64_tr_b16 v[158:159], v56 offset:512
K_DM4:
    ds_read_b64_tr_b16 v[160:161], v56 offset:2048
    s_mov_b32 s68, -1
    v_mfma_f32_32x32x16_bf16 v[124:139], v[180:183], v[100:103], v[124:139]
    buffer_load_dword v3, v52, s[20:23], s68 offen
    ds_read_b64_tr_b16 v[162:163], v56 offset:2560
    ds_read_b64_tr_b16 v[164:165], v57 offset:0
    v_mfma_f32_32x32x16_bf16 v[108:123], v[176:179], v[104:107], v[108:123]
    buffer_load_dword v3, v52, s[20:23], s68 offen
    ds_read_b64_tr_b16 v[166:167], v57 offset:512
    ds_read_b64_tr_b16 v[168:169], v57 offset:2048
    ds_read_b64_tr_b16 v[170:171], v57 offset:2560
    v_mfma_f32_32x32x16_bf16 v[124:139], v[184:187], v[104:107], v[124:139]
    s_waitcnt vmcnt(8) lgkmcnt(8)
    v_cmp_u_f32 vcc, v60, v64
    v_and_or_b32 v56, s66, v53, v54
    v_and_or_b32 v57, s66, v53, v55
    v_mov_b32 v92, -1
    s_cbranch_vccnz K_FX5
K_DR5:
    v_mfma_f32_32x32x16_bf16 v[108:123], v[140:143], v[60:63], v[108:123]
    ds_read_b64_tr_b16 v[172:173], v56 offset:0
    ds_read_b64_tr_b16 v[174:175], v56 offset:512
K_DM5:
    ds_read_b64_tr_b16 v[176:177], v56 offset:2048
    s_mov_b32 s69, -1
    v_mfma_f32_32x32x16_bf16 v[124:139], v[148:151], v[60:63], v[124:139]
    buffer_load_dword v3, v52, s[20:23], s69 offen
    ds_read_b64_tr_b16 v[178:179], v56 offset:2560
    ds_read_b64_tr_b16 v[180:181], v57 offset:0
    v_mfma_f32_32x32x16_bf16 v[108:123], v[144:147], v[64:67], v[108:123]
    buffer_load_dword v3, v52, s[20:23], s69 offen
    ds_read_b64_tr_b16 v[182:183], v57 offset:512
    ds_read_b64_tr_b16 v[184:185], v57 offset:2048
    ds_read_b64_tr_b16 v[186:187], v57 offset:2560
    v_mfma_f32_32x32x16_bf16 v[124:139], v[152:155], v[64:67], v[124:139]
    s_waitcnt vmcnt(8) lgkmcnt(8)
    v_cmp_u_f32 vcc, v68, v72
    v_and_or_b32 v56, s67, v53, v54
    v_and_or_b32 v57, s67, v53, v55
    v_mov_b32 v100, -1
    s_cbranch_vccnz K_FX0
    s_branch K_DR0
K_CHA1:
K_STA5:
    s_branch K_STA9
K_CHB1:
K_STB5:
    s_branch K_STB9
K_RF0:
    s_cmp_eq_u32 s70, 0
    s_cbranch_scc1 K_DM0
    ds_read_b32 v59, v58
    s_waitcnt lgkmcnt(0)
    v_readfirstlane_b32 s50, v59
    s_and_b32 s33, s50, s70
    s_cbranch_scc1 K_RB0
K_NV0:
    ds_read_b64_tr_b16 v[144:145], v56 offset:2048
    v_mfma_f32_32x32x16_bf16 v[124:139], v[164:167], v[68:71], v[124:139]
    s_mov_b32 s64, -1
    v_mov_b32 v60, -1
    buffer_load_dword v3, v52, s[20:23], s64 offen
    ds_read_b64_tr_b16 v[146:147], v56 offset:2560
    ds_read_b64_tr_b16 v[148:149], v57 offset:0
    v_mfma_f32_32x32x16_bf16 v[108:123], v[160:163], v[72:75], v[108:123]
    buffer_load_dword v3, v52, s[20:23], s64 offen
    ds_read_b64_tr_b16 v[150:151], v57 offset:512
    ds_read_b64_tr_b16 v[152:153], v57 offset:2048
    ds_read_b64_tr_b16 v[154:155], v57 offset:2560
    v_mfma_f32_32x32x16_bf16 v[124:139], v[168:171], v[72:75], v[124:139]
    s_branch K_TL0
K_FX0:
    s_cmp_lt_i32 s65, 0
    s_cbranch_scc1 K_SK0
    v_max_u32 v2, v68, v72
    v_cmp_eq_u32 vcc, -1, v2
    s_cbranch_vccz K_IT0
    s_sub_u32 s71, s71, 1
    s_cbranch_scc1 K_IT0
    s_lshr_b32 s51, s65, 12
    s_bitset1_b32 s70, s51
K_SK0:
    s_and_b32 s33, s50, s70
    s_cbranch_scc0 K_NUL0
K_BK0:
    s_ff1_i32_b32 s51, s33
    s_lshl_b32 s64, s51, 12
    buffer_load_dwordx4 v[60:63], v52, s[20:23], s64 offen offset:0 sc1
    buffer_load_dwordx4 v[64:67], v52, s[20:23], s64 offen offset:512 sc1
    s_bitset0_b32 s70, s51
K_RD0:
    ds_read_b64_tr_b16 v[140:141], v56 offset:0
    ds_read_b64_tr_b16 v[142:143], v56 offset:512
    ds_read_b64_tr_b16 v[144:145], v56 offset:2048
    ds_read_b64_tr_b16 v[146:147], v56 offset:2560
    ds_read_b64_tr_b16 v[148:149], v57 offset:0
    ds_read_b64_tr_b16 v[150:151], v57 offset:512
    ds_read_b64_tr_b16 v[152:153], v57 offset:2048
    ds_read_b64_tr_b16 v[154:155], v57 offset:2560
    s_cmp_lt_i32 s66, 0
    s_cbranch_scc0 K_TL0
    v_and_or_b32 v56, s68, v53, v54
    v_and_or_b32 v57, s68, v53, v55
    s_branch K_SK1
K_NUL0:
    s_and_b32 s51, s66, s67
    s_and_b32 s51, s51, s68
    s_and_b32 s51, s51, s69
    s_cmp_lt_i32 s51, 0
    s_cbranch_scc0 K_PC0
    s_cmp_eq_u32 s70, 0
    s_cbranch_scc1 K_P2_MM
    s_branch K_SPN
K_PC0:
    s_cmp_eq_u32 s70, 0
    s_cbranch_scc1 K_NI0
    ds_read_b32 v59, v58
    s_waitcnt lgkmcnt(0)
    v_readfirstlane_b32 s50, v59
    s_and_b32 s33, s50, s70
    s_cbranch_scc1 K_BK0
    ds_read_b32 v59, v58
    s_waitcnt lgkmcnt(0)
    v_readfirstlane_b32 s50, v59
    s_and_b32 s33, s50, s70
    s_cbranch_scc1 K_BK0
K_NI0:
    s_mov_b32 s64, -1
    v_mov_b32 v60, -1
    buffer_load_dword v3, v52, s[20:23], s64 offen
    buffer_load_dword v3, v52, s[20:23], s64 offen
    s_branch K_RD0
K_RF1:
    s_cmp_eq_u32 s70, 0
    s_cbranch_scc1 K_DM1
    ds_read_b32 v59, v58
    s_waitcnt lgkmcnt(0)
    v_readfirstlane_b32 s50, v59
    s_and_b32 s33, s50, s70
    s_cbranch_scc1 K_RB1
K_NV1:
    ds_read_b64_tr_b16 v[160:161], v56 offset:2048
    v_mfma_f32_32x32x16_bf16 v[124:139], v[180:183], v[76:79], v[124:139]
    s_mov_b32 s65, -1
    v_mov_b32 v68, -1
    buffer_load_dword v3, v52, s[20:23], s65 offen
    ds_read_b64_tr_b16 v[162:163], v56 offset:2560
    ds_read_b64_tr_b16 v[164:165], v57 offset:0
    v_mfma_f32_32x32x16_bf16 v[108:123], v[176:179], v[80:83], v[108:123]
    buffer_load_dword v3, v52, s[20:23], s65 offen
    ds_read_b64_tr_b16 v[166:167], v57 offset:512
    ds_read_b64_tr_b16 v[168:169], v57 offset:2048
    ds_read_b64_tr_b16 v[170:171], v57 offset:2560
    v_mfma_f32_32x32x16_bf16 v[124:139], v[184:187], v[80:83], v[124:139]
    s_branch K_TL1
K_CHA2:
K_STA6:
    s_branch K_STA10
K_CHB2:
K_STB6:
    s_branch K_STB10
K_FX1:
    s_cmp_lt_i32 s66, 0
    s_cbranch_scc1 K_SK1
    v_max_u32 v2, v76, v80
    v_cmp_eq_u32 vcc, -1, v2
    s_cbranch_vccz K_IT1
    s_sub_u32 s71, s71, 1
    s_cbranch_scc1 K_IT1
    s_lshr_b32 s51, s66, 12
    s_bitset1_b32 s70, s51
K_SK1:
    s_and_b32 s33, s50, s70
    s_cbranch_scc0 K_NUL1
K_BK1:
    s_ff1_i32_b32 s51, s33
    s_lshl_b32 s65, s51, 12
    buffer_load_dwordx4 v[68:71], v52, s[20:23], s65 offen offset:0 sc1
    buffer_load_dwordx4 v[72:75], v52, s[20:23], s65 offen offset:512 sc1
    s_bitset0_b32 s70, s51
K_RD1:
    ds_read_b64_tr_b16 v[156:157], v56 offset:0
    ds_read_b64_tr_b16 v[158:159], v56 offset:512
    ds_read_b64_tr_b16 v[160:161], v56 offset:2048
    ds_read_b64_tr_b16 v[162:163], v56 offset:2560
    ds_read_b64_tr_b16 v[164:165], v57 offset:0
    ds_read_b64_tr_b16 v[166:167], v57 offset:512
    ds_read_b64_tr_b16 v[168:169], v57 offset:2048
    ds_read_b64_tr_b16 v[170:171], v57 offset:2560
    s_cmp_lt_i32 s67, 0
    s_cbranch_scc0 K_TL1
    v_and_or_b32 v56, s69, v53, v54
    v_and_or_b32 v57, s69, v53, v55
    s_branch K_SK2
K_NUL1:
    s_and_b32 s51, s64, s67
    s_and_b32 s51, s51, s68
    s_and_b32 s51, s51, s69
    s_cmp_lt_i32 s51, 0
    s_cbranch_scc0 K_PC1
    s_cmp_eq_u32 s70, 0
    s_cbranch_scc1 K_P2_MM
    s_branch K_SPN
K_PC1:
    s_cmp_eq_u32 s70, 0
    s_cbranch_scc1 K_NI1
    ds_read_b32 v59, v58
    s_waitcnt lgkmcnt(0)
    v_readfirstlane_b32 s50, v59
    s_and_b32 s33, s50, s70
    s_cbranch_scc1 K_BK1
    ds_read_b32 v59, v58
    s_waitcnt lgkmcnt(0)
    v_readfirstlane_b32 s50, v59
    s_and_b32 s33, s50, s70
    s_cbranch_scc1 K_BK1
K_NI1:
    s_mov_b32 s65, -1
    v_mov_b32 v68, -1
    buffer_load_dword v3, v52, s[20:23], s65 offen
    buffer_load_dword v3, v52, s[20:23], s65 offen
    s_branch K_RD1
K_RF2:
    s_cmp_eq_u32 s70, 0
    s_cbranch_scc1 K_DM2
    ds_read_b32 v59, v58
    s_waitcnt lgkmcnt(0)
    v_readfirstlane_b32 s50, v59
    s_and_b32 s33, s50, s70
    s_cbranch_scc1 K_RB2
K_NV2:
    ds_read_b64_tr_b16 v[176:177], v56 offset:2048
    v_mfma_f32_32x32x16_bf16 v[124:139], v[148:151], v[84:87], v[124:139]
    s_mov_b32 s66, -1
    v_mov_b32 v76, -1
    buffer_load_dword v3, v52, s[20:23], s66 offen
    ds_read_b64_tr_b16 v[178:179], v56 offset:2560
    ds_read_b64_tr_b16 v[180:181], v57 offset:0
    v_mfma_f32_32x32x16_bf16 v[108:123], v[144:147], v[88:91], v[108:123]
    buffer_load_dword v3, v52, s[20:23], s66 offen
    ds_read_b64_tr_b16 v[182:183], v57 offset:512
    ds_read_b64_tr_b16 v[184:185], v57 offset:2048
    ds_read_b64_tr_b16 v[186:187], v57 offset:2560
    v_mfma_f32_32x32x16_bf16 v[124:139], v[152:155], v[88:91], v[124:139]
    s_branch K_TL2
K_FX2:
    s_cmp_lt_i32 s67, 0
    s_cbranch_scc1 K_SK2
    v_max_u32 v2, v84, v88
    v_cmp_eq_u32 vcc, -1, v2
    s_cbranch_vccz K_IT2
    s_sub_u32 s71, s71, 1
    s_cbranch_scc1 K_IT2
    s_lshr_b32 s51, s67, 12
    s_bitset1_b32 s70, s51
K_SK2:
    s_and_b32 s33, s50, s70
    s_cbranch_scc0 K_NUL2
K_BK2:
    s_ff1_i32_b32 s51, s33
    s_lshl_b32 s66, s51, 12
    buffer_load_dwordx4 v[76:79], v52, s[20:23], s66 offen offset:0 sc1
    buffer_load_dwordx4 v[80:83], v52, s[20:23], s66 offen offset:512 sc1
    s_bitset0_b32 s70, s51
K_RD2:
    ds_read_b64_tr_b16 v[172:173], v56 offset:0
    ds_read_b64_tr_b16 v[174:175], v56 offset:512
    ds_read_b64_tr_b16 v[176:177], v56 offset:2048
    ds_read_b64_tr_b16 v[178:179], v56 offset:2560
    ds_read_b64_tr_b16 v[180:181], v57 offset:0
    ds_read_b64_tr_b16 v[182:183], v57 offset:512
    ds_read_b64_tr_b16 v[184:185], v57 offset:2048
    ds_read_b64_tr_b16 v[186:187], v57 offset:2560
    s_cmp_lt_i32 s68, 0
    s_cbranch_scc0 K_TL2
    s_branch K_PG4
.p2align 12
K_CHA3:
K_STA7:
    s_branch K_STA11
K_CHB3:
K_STB7:
    s_branch K_STB11
K_PG4:
    v_and_or_b32 v56, s64, v53, v54
    v_and_or_b32 v57, s64, v53, v55
    s_branch K_SK3
K_NUL2:
    s_and_b32 s51, s64, s65
    s_and_b32 s51, s51, s68
    s_and_b32 s51, s51, s69
    s_cmp_lt_i32 s51, 0
    s_cbranch_scc0 K_PC2
    s_cmp_eq_u32 s70, 0
    s_cbranch_scc1 K_P2_MM
    s_branch K_SPN
K_PC2:
    s_cmp_eq_u32 s70, 0
    s_cbranch_scc1 K_NI2
    ds_read_b32 v59, v58
    s_waitcnt lgkmcnt(0)
    v_readfirstlane_b32 s50, v59
    s_and_b32 s33, s50, s70
    s_cbranch_scc1 K_BK2
    ds_read_b32 v59, v58
    s_waitcnt lgkmcnt(0)
    v_readfirstlane_b32 s50, v59
    s_and_b32 s33, s50, s70
    s_cbranch_scc1 K_BK2
K_NI2:
    s_mov_b32 s66, -1
    v_mov_b32 v76, -1
    buffer_load_dword v3, v52, s[20:23], s66 offen
    buffer_load_dword v3, v52, s[20:23], s66 offen
    s_branch K_RD2
K_RF3:
    s_cmp_eq_u32 s70, 0
    s_cbranch_scc1 K_DM3
    ds_read_b32 v59, v58
    s_waitcnt lgkmcnt(0)
    v_readfirstlane_b32 s50, v59
    s_and_b32 s33, s50, s70
    s_cbranch_scc1 K_RB3
K_NV3:
    ds_read_b64_tr_b16 v[144:145], v56 offset:2048
    v_mfma_f32_32x32x16_bf16 v[124:139], v[164:167], v[92:95], v[124:139]
    s_mov_b32 s67, -1
    v_mov_b32 v84, -1
    buffer_load_dword v3, v52, s[20:23], s67 offen
    ds_read_b64_tr_b16 v[146:147], v56 offset:2560
    ds_read_b64_tr_b16 v[148:149], v57 offset:0
    v_mfma_f32_32x32x16_bf16 v[108:123], v[160:163], v[96:99], v[108:123]
    buffer_load_dword v3, v52, s[20:23], s67 offen
    ds_read_b64_tr_b16 v[150:151], v57 offset:512
    ds_read_b64_tr_b16 v[152:153], v57 offset:2048
    ds_read_b64_tr_b16 v[154:155], v57 offset:2560
    v_mfma_f32_32x32x16_bf16 v[124:139], v[168:171], v[96:99], v[124:139]
    s_branch K_TL3
K_FX3:
    s_cmp_lt_i32 s68, 0
    s_cbranch_scc1 K_SK3
    v_max_u32 v2, v92, v96
    v_cmp_eq_u32 vcc, -1, v2
    s_cbranch_vccz K_IT3
    s_sub_u32 s71, s71, 1
    s_cbranch_scc1 K_IT3
    s_lshr_b32 s51, s68, 12
    s_bitset1_b32 s70, s51
K_SK3:
    s_and_b32 s33, s50, s70
    s_cbranch_scc0 K_NUL3
K_BK3:
    s_ff1_i32_b32 s51, s33
    s_lshl_b32 s67, s51, 12
    buffer_load_dwordx4 v[84:87], v52, s[20:23], s67 offen offset:0 sc1
    buffer_load_dwordx4 v[88:91], v52, s[20:23], s67 offen offset:512 sc1
    s_bitset0_b32 s70, s51
K_RD3:
    ds_read_b64_tr_b16 v[140:141], v56 offset:0
    ds_read_b64_tr_b16 v[142:143], v56 offset:512
    ds_read_b64_tr_b16 v[144:145], v56 offset:2048
    ds_read_b64_tr_b16 v[146:147], v56 offset:2560
    ds_read_b64_tr_b16 v[148:149], v57 offset:0
    ds_read_b64_tr_b16 v[150:151], v57 offset:512
    ds_read_b64_tr_b16 v[152:153], v57 offset:2048
    ds_read_b64_tr_b16 v[154:155], v57 offset:2560
    s_cmp_lt_i32 s69, 0
    s_cbranch_scc0 K_TL3
    v_and_or_b32 v56, s65, v53, v54
    v_and_or_b32 v57, s65, v53, v55
    s_branch K_SK4
K_NUL3:
    s_and_b32 s51, s64, s65
    s_and_b32 s51, s51, s66
    s_and_b32 s51, s51, s69
    s_cmp_lt_i32 s51, 0
    s_cbranch_scc0 K_PC3
    s_cmp_eq_u32 s70, 0
    s_cbranch_scc1 K_P2_MM
    s_branch K_SPN
K_PC3:
    s_cmp_eq_u32 s70, 0
    s_cbranch_scc1 K_NI3
    ds_read_b32 v59, v58
    s_waitcnt lgkmcnt(0)
    v_readfirstlane_b32 s50, v59
    s_and_b32 s33, s50, s70
    s_cbranch_scc1 K_BK3
    ds_read_b32 v59, v58
    s_waitcnt lgkmcnt(0)
    v_readfirstlane_b32 s50, v59
    s_and_b32 s33, s50, s70
    s_cbranch_scc1 K_BK3
K_NI3:
    s_mov_b32 s67, -1
    v_mov_b32 v84, -1
    buffer_load_dword v3, v52, s[20:23], s67 offen
    buffer_load_dword v3, v52, s[20:23], s67 offen
    s_branch K_RD3
K_STA8:
    s_branch K_STA12
K_STB8:
    s_branch K_STB12
K_RF4:
    s_cmp_eq_u32 s70, 0
    s_cbranch_scc1 K_DM4
    ds_read_b32 v59, v58
    s_waitcnt lgkmcnt(0)
    v_readfirstlane_b32 s50, v59
    s_and_b32 s33, s50, s70
    s_cbranch_scc1 K_RB4
K_NV4:
    ds_read_b64_tr_b16 v[160:161], v56 offset:2048
    v_mfma_f32_32x32x16_bf16 v[124:139], v[180:183], v[100:103], v[124:139]
    s_mov_b32 s68, -1
    v_mov_b32 v92, -1
    buffer_load_dword v3, v52, s[20:23], s68 offen
    ds_read_b64_tr_b16 v[162:163], v56 offset:2560
    ds_read_b64_tr_b16 v[164:165], v57 offset:0
    v_mfma_f32_32x32x16_bf16 v[108:123], v[176:179], v[104:107], v[108:123]
    buffer_load_dword v3, v52, s[20:23], s68 offen
    ds_read_b64_tr_b16 v[166:167], v57 offset:512
    ds_read_b64_tr_b16 v[168:169], v57 offset:2048
    ds_read_b64_tr_b16 v[170:171], v57 offset:2560
    v_mfma_f32_32x32x16_bf16 v[124:139], v[184:187], v[104:107], v[124:139]
    s_branch K_TL4
K_FX4:
    s_cmp_lt_i32 s69, 0
    s_cbranch_scc1 K_SK4
    v_max_u32 v2, v100, v104
    v_cmp_eq_u32 vcc, -1, v2
    s_cbranch_vccz K_IT4
    s_sub_u32 s71, s71, 1
    s_cbranch_scc1 K_IT4
    s_lshr_b32 s51, s69, 12
    s_bitset1_b32 s70, s51
K_SK4:
    s_and_b32 s33, s50, s70
    s_cbranch_scc0 K_NUL4
K_BK4:
    s_ff1_i32_b32 s51, s33
    s_lshl_b32 s68, s51, 12
    buffer_load_dwordx4 v[92:95], v52, s[20:23], s68 offen offset:0 sc1
    buffer_load_dwordx4 v[96:99], v52, s[20:23], s68 offen offset:512 sc1
    s_bitset0_b32 s70, s51
K_RD4:
    ds_read_b64_tr_b16 v[156:157], v56 offset:0
    ds_read_b64_tr_b16 v[158:159], v56 offset:512
    ds_read_b64_tr_b16 v[160:161], v56 offset:2048
    ds_read_b64_tr_b16 v[162:163], v56 offset:2560
    ds_read_b64_tr_b16 v[164:165], v57 offset:0
    ds_read_b64_tr_b16 v[166:167], v57 offset:512
    ds_read_b64_tr_b16 v[168:169], v57 offset:2048
    ds_read_b64_tr_b16 v[170:171], v57 offset:2560
    s_cmp_lt_i32 s64, 0
    s_cbranch_scc0 K_TL4
    v_and_or_b32 v56, s66, v53, v54
    v_and_or_b32 v57, s66, v53, v55
    s_branch K_SK5
K_NUL4:
    s_and_b32 s51, s64, s65
    s_and_b32 s51, s51, s66
    s_and_b32 s51, s51, s67
    s_cmp_lt_i32 s51, 0
    s_cbranch_scc0 K_PC4
    s_cmp_eq_u32 s70, 0
    s_cbranch_scc1 K_P2_MM
    s_branch K_SPN
K_PC4:
    s_cmp_eq_u32 s70, 0
    s_cbranch_scc1 K_NI4
    ds_read_b32 v59, v58
    s_waitcnt lgkmcnt(0)
    v_readfirstlane_b32 s50, v59
    s_and_b32 s33, s50, s70
    s_cbranch_scc1 K_BK4
    ds_read_b32 v59, v58
    s_waitcnt lgkmcnt(0)
    v_readfirstlane_b32 s50, v59
    s_and_b32 s33, s50, s70
    s_cbranch_scc1 K_BK4
K_NI4:
    s_mov_b32 s68, -1
    v_mov_b32 v92, -1
    buffer_load_dword v3, v52, s[20:23], s68 offen
    buffer_load_dword v3, v52, s[20:23], s68 offen
    s_branch K_RD4
K_RF5:
    s_cmp_eq_u32 s70, 0
    s_cbranch_scc1 K_DM5
    ds_read_b32 v59, v58
    s_waitcnt lgkmcnt(0)
    v_readfirstlane_b32 s50, v59
    s_and_b32 s33, s50, s70
    s_cbranch_scc1 K_RB5
K_NV5:
    ds_read_b64_tr_b16 v[176:177], v56 offset:2048
    v_mfma_f32_32x32x16_bf16 v[124:139], v[148:151], v[60:63], v[124:139]
    s_mov_b32 s69, -1
    v_mov_b32 v100, -1
    buffer_load_dword v3, v52, s[20:23], s69 offen
    ds_read_b64_tr_b16 v[178:179], v56 offset:2560
    ds_read_b64_tr_b16 v[180:181], v57 offset:0
    v_mfma_f32_32x32x16_bf16 v[108:123], v[144:147], v[64:67], v[108:123]
    buffer_load_dword v3, v52, s[20:23], s69 offen
    ds_read_b64_tr_b16 v[182:183], v57 offset:512
    ds_read_b64_tr_b16 v[184:185], v57 offset:2048
    ds_read_b64_tr_b16 v[186:187], v57 offset:2560
    v_mfma_f32_32x32x16_bf16 v[124:139], v[152:155], v[64:67], v[124:139]
    s_branch K_TL5
K_STA9:
    s_branch K_STA13
K_STB9:
    s_branch K_STB13
K_FX5:
    s_cmp_lt_i32 s64, 0
    s_cbranch_scc1 K_SK5
    v_max_u32 v2, v60, v64
    v_cmp_eq_u32 vcc, -1, v2
    s_cbranch_vccz K_IT5
    s_sub_u32 s71, s71, 1
    s_cbranch_scc1 K_IT5
    s_lshr_b32 s51, s64, 12
    s_bitset1_b32 s70, s51
K_SK5:
    s_and_b32 s33, s50, s70
    s_cbranch_scc0 K_NUL5
K_BK5:
    s_ff1_i32_b32 s51, s33
    s_lshl_b32 s69, s51, 12
    buffer_load_dwordx4 v[100:103], v52, s[20:23], s69 offen offset:0 sc1
    buffer_load_dwordx4 v[104:107], v52, s[20:23], s69 offen offset:512 sc1
    s_bitset0_b32 s70, s51
K_RD5:
    ds_read_b64_tr_b16 v[172:173], v56 offset:0
    ds_read_b64_tr_b16 v[174:175], v56 offset:512
    ds_read_b64_tr_b16 v[176:177], v56 offset:2048
    ds_read_b64_tr_b16 v[178:179], v56 offset:2560
    ds_read_b64_tr_b16 v[180:181], v57 offset:0
    ds_read_b64_tr_b16 v[182:183], v57 offset:512
    ds_read_b64_tr_b16 v[184:185], v57 offset:2048
    ds_read_b64_tr_b16 v[186:187], v57 offset:2560
    s_cmp_lt_i32 s65, 0
    s_cbranch_scc0 K_TL5
    v_and_or_b32 v56, s67, v53, v54
    v_and_or_b32 v57, s67, v53, v55
    s_branch K_SK0
K_NUL5:
    s_and_b32 s51, s65, s66
    s_and_b32 s51, s51, s67
    s_and_b32 s51, s51, s68
    s_cmp_lt_i32 s51, 0
    s_cbranch_scc0 K_PC5
    s_cmp_eq_u32 s70, 0
    s_cbranch_scc1 K_P2_MM
    s_branch K_SPN
K_PC5:
    s_cmp_eq_u32 s70, 0
    s_cbranch_scc1 K_NI5
    ds_read_b32 v59, v58
    s_waitcnt lgkmcnt(0)
    v_readfirstlane_b32 s50, v59
    s_and_b32 s33, s50, s70
    s_cbranch_scc1 K_BK5
    ds_read_b32 v59, v58
    s_waitcnt lgkmcnt(0)
    v_readfirstlane_b32 s50, v59
    s_and_b32 s33, s50, s70
    s_cbranch_scc1 K_BK5
K_NI5:
    s_mov_b32 s69, -1
    v_mov_b32 v100, -1
    buffer_load_dword v3, v52, s[20:23], s69 offen
    buffer_load_dword v3, v52, s[20:23], s69 offen
    s_branch K_RD5
K_P2_MM:
    v_cvt_pk_bf16_f32 v188, v108, v109
    v_cvt_pk_bf16_f32 v189, v110, v111
    ds_write_b64 v50, v[188:189] offset:0
    v_cvt_pk_bf16_f32 v190, v112, v113
    v_cvt_pk_bf16_f32 v191, v114, v115
    ds_write_b64 v50, v[190:191] offset:16
    v_cvt_pk_bf16_f32 v192, v116, v117
    v_cvt_pk_bf16_f32 v193, v118, v119
    ds_write_b64 v50, v[192:193] offset:32
    v_cvt_pk_bf16_f32 v194, v120, v121
    v_cvt_pk_bf16_f32 v195, v122, v123
    ds_write_b64 v50, v[194:195] offset:48
    v_cvt_pk_bf16_f32 v188, v124, v125
    v_cvt_pk_bf16_f32 v189, v126, v127
    ds_write_b64 v50, v[188:189] offset:64
    v_cvt_pk_bf16_f32 v190, v128, v129
    v_cvt_pk_bf16_f32 v191, v130, v131
    ds_write_b64 v50, v[190:191] offset:80
    v_cvt_pk_bf16_f32 v192, v132, v133
    v_cvt_pk_bf16_f32 v193, v134, v135
    ds_write_b64 v50, v[192:193] offset:96
    v_cvt_pk_bf16_f32 v194, v136, v137
    v_cvt_pk_bf16_f32 v195, v138, v139
    ds_write_b64 v50, v[194:195] offset:112
K_P2_E2:
    s_waitcnt vmcnt(0) lgkmcnt(0)
    s_lshl_b32 s72, s61, 4
    s_barrier
    ds_read_b64 v[28:29], v15
    ds_read_b64 v[24:25], v11
    ds_read_b128 v[48:51], v14
    ds_read_b64 v[26:27], v11 offset:64
    ds_read_b128 v[52:55], v14 offset:1152
    s_waitcnt lgkmcnt(4)
    v_readfirstlane_b32 s48, v28
    v_readfirstlane_b32 s49, v29
    s_sub_u32 s3, s48, s72
    s_cmp_lt_u32 s3, 16
    s_cbranch_scc1 K_YROW0
K_NOY0:
    s_sub_u32 s3, s49, s72
    s_cmp_lt_u32 s3, 16
    s_cbranch_scc1 K_YROW1
K_NOY1:
    s_waitcnt lgkmcnt(3)
    v_pk_mul_f32 v[32:33], v[32:33], v[24:25] op_sel:[0,1] op_sel_hi:[1,1]
    v_pk_mul_f32 v[34:35], v[34:35], v[24:25] op_sel:[0,1] op_sel_hi:[1,1]
    v_pk_mul_f32 v[36:37], v[36:37], v[24:25] op_sel:[0,1] op_sel_hi:[1,1]
    v_pk_mul_f32 v[38:39], v[38:39], v[24:25] op_sel:[0,1] op_sel_hi:[1,1]
    s_waitcnt lgkmcnt(2)
    v_lshlrev_b32 v68, 16, v48
    v_and_b32 v69, 0xffff0000, v48
    v_pk_fma_f32 v[68:69], v[68:69], v[24:25], v[32:33] op_sel_hi:[1,0,1]
    v_cvt_pk_bf16_f32 v48, v68, v69
    v_lshlrev_b32 v70, 16, v49
    v_and_b32 v71, 0xffff0000, v49
    v_pk_fma_f32 v[70:71], v[70:71], v[24:25], v[34:35] op_sel_hi:[1,0,1]
    v_cvt_pk_bf16_f32 v49, v70, v71
    v_lshlrev_b32 v68, 16, v50
    v_and_b32 v69, 0xffff0000, v50
    v_pk_fma_f32 v[68:69], v[68:69], v[24:25], v[36:37] op_sel_hi:[1,0,1]
    v_cvt_pk_bf16_f32 v50, v68, v69
    v_lshlrev_b32 v70, 16, v51
    v_and_b32 v71, 0xffff0000, v51
    v_pk_fma_f32 v[70:71], v[70:71], v[24:25], v[38:39] op_sel_hi:[1,0,1]
    v_cvt_pk_bf16_f32 v51, v70, v71
    buffer_store_dwordx4 v[48:51], v10, s[56:59], 0 offen sc1
    s_waitcnt lgkmcnt(1)
    v_pk_mul_f32 v[40:41], v[40:41], v[26:27] op_sel:[0,1] op_sel_hi:[1,1]
    v_pk_mul_f32 v[42:43], v[42:43], v[26:27] op_sel:[0,1] op_sel_hi:[1,1]
    v_pk_mul_f32 v[44:45], v[44:45], v[26:27] op_sel:[0,1] op_sel_hi:[1,1]
    v_pk_mul_f32 v[46:47], v[46:47], v[26:27] op_sel:[0,1] op_sel_hi:[1,1]
    s_waitcnt lgkmcnt(0)
    v_lshlrev_b32 v68, 16, v52
    v_and_b32 v69, 0xffff0000, v52
    v_pk_fma_f32 v[68:69], v[68:69], v[26:27], v[40:41] op_sel_hi:[1,0,1]
    v_cvt_pk_bf16_f32 v52, v68, v69
    v_lshlrev_b32 v70, 16, v53
    v_and_b32 v71, 0xffff0000, v53
    v_pk_fma_f32 v[70:71], v[70:71], v[26:27], v[42:43] op_sel_hi:[1,0,1]
    v_cvt_pk_bf16_f32 v53, v70, v71
    v_lshlrev_b32 v68, 16, v54
    v_and_b32 v69, 0xffff0000, v54
    v_pk_fma_f32 v[68:69], v[68:69], v[26:27], v[44:45] op_sel_hi:[1,0,1]
    v_cvt_pk_bf16_f32 v54, v68, v69
    v_lshlrev_b32 v70, 16, v55
    v_and_b32 v71, 0xffff0000, v55
    v_pk_fma_f32 v[70:71], v[70:71], v[26:27], v[46:47] op_sel_hi:[1,0,1]
    v_cvt_pk_bf16_f32 v55, v70, v71
    buffer_store_dwordx4 v[52:55], v10, s[56:59], s63 offen sc1
K_END:
K_EXIT:
    s_endpgm
K_YROW0:
    v_and_b32 v2, 7, v1
    v_lshlrev_b32 v2, 5, v2
    v_add_u32 v2, 158976, v2
    ds_read_b128 v[56:59], v2
    ds_read_b128 v[60:63], v2 offset:16
    s_and_b32 s33, s3, 7
    v_cmp_eq_u32 vcc, s33, v8
    s_cmp_ge_u32 s3, 8
    s_cbranch_scc1 K_YR1_0
    s_waitcnt lgkmcnt(0)
    v_add_f32 v64, v32, v56
    v_cvt_pk_bf16_f32 v64, v64, v64
    v_lshlrev_b32 v64, 16, v64
    v_cndmask_b32 v32, v32, v64, vcc
    v_add_f32 v65, v33, v57
    v_cvt_pk_bf16_f32 v65, v65, v65
    v_lshlrev_b32 v65, 16, v65
    v_cndmask_b32 v33, v33, v65, vcc
    v_add_f32 v66, v34, v58
    v_cvt_pk_bf16_f32 v66, v66, v66
    v_lshlrev_b32 v66, 16, v66
    v_cndmask_b32 v34, v34, v66, vcc
    v_add_f32 v67, v35, v59
    v_cvt_pk_bf16_f32 v67, v67, v67
    v_lshlrev_b32 v67, 16, v67
    v_cndmask_b32 v35, v35, v67, vcc
    v_add_f32 v64, v36, v60
    v_cvt_pk_bf16_f32 v64, v64, v64
    v_lshlrev_b32 v64, 16, v64
    v_cndmask_b32 v36, v36, v64, vcc
    v_add_f32 v65, v37, v61
    v_cvt_pk_bf16_f32 v65, v65, v65
    v_lshlrev_b32 v65, 16, v65
    v_cndmask_b32 v37, v37, v65, vcc
    v_add_f32 v66, v38, v62
    v_cvt_pk_bf16_f32 v66, v66, v66
    v_lshlrev_b32 v66, 16, v66
    v_cndmask_b32 v38, v38, v66, vcc
    v_add_f32 v67, v39, v63
    v_cvt_pk_bf16_f32 v67, v67, v67
    v_lshlrev_b32 v67, 16, v67
    v_cndmask_b32 v39, v39, v67, vcc
    s_branch K_NOY0
K_YR1_0:
    s_waitcnt lgkmcnt(0)
    v_add_f32 v64, v40, v56
    v_cvt_pk_bf16_f32 v64, v64, v64
    v_lshlrev_b32 v64, 16, v64
    v_cndmask_b32 v40, v40, v64, vcc
    v_add_f32 v65, v41, v57
    v_cvt_pk_bf16_f32 v65, v65, v65
    v_lshlrev_b32 v65, 16, v65
    v_cndmask_b32 v41, v41, v65, vcc
    v_add_f32 v66, v42, v58
    v_cvt_pk_bf16_f32 v66, v66, v66
    v_lshlrev_b32 v66, 16, v66
    v_cndmask_b32 v42, v42, v66, vcc
    v_add_f32 v67, v43, v59
    v_cvt_pk_bf16_f32 v67, v67, v67
    v_lshlrev_b32 v67, 16, v67
    v_cndmask_b32 v43, v43, v67, vcc
    v_add_f32 v64, v44, v60
    v_cvt_pk_bf16_f32 v64, v64, v64
    v_lshlrev_b32 v64, 16, v64
    v_cndmask_b32 v44, v44, v64, vcc
    v_add_f32 v65, v45, v61
    v_cvt_pk_bf16_f32 v65, v65, v65
    v_lshlrev_b32 v65, 16, v65
    v_cndmask_b32 v45, v45, v65, vcc
    v_add_f32 v66, v46, v62
    v_cvt_pk_bf16_f32 v66, v66, v66
    v_lshlrev_b32 v66, 16, v66
    v_cndmask_b32 v46, v46, v66, vcc
    v_add_f32 v67, v47, v63
    v_cvt_pk_bf16_f32 v67, v67, v67
    v_lshlrev_b32 v67, 16, v67
    v_cndmask_b32 v47, v47, v67, vcc
    s_branch K_NOY0
K_YROW1:
    v_and_b32 v2, 7, v1
    v_lshlrev_b32 v2, 5, v2
    v_add_u32 v2, 159232, v2
    ds_read_b128 v[56:59], v2
    ds_read_b128 v[60:63], v2 offset:16
    s_and_b32 s33, s3, 7
    v_cmp_eq_u32 vcc, s33, v8
    s_cmp_ge_u32 s3, 8
    s_cbranch_scc1 K_YR1_1
    s_waitcnt lgkmcnt(0)
    v_add_f32 v64, v32, v56
    v_cvt_pk_bf16_f32 v64, v64, v64
    v_lshlrev_b32 v64, 16, v64
    v_cndmask_b32 v32, v32, v64, vcc
    v_add_f32 v65, v33, v57
    v_cvt_pk_bf16_f32 v65, v65, v65
    v_lshlrev_b32 v65, 16, v65
    v_cndmask_b32 v33, v33, v65, vcc
    v_add_f32 v66, v34, v58
    v_cvt_pk_bf16_f32 v66, v66, v66
    v_lshlrev_b32 v66, 16, v66
    v_cndmask_b32 v34, v34, v66, vcc
    v_add_f32 v67, v35, v59
    v_cvt_pk_bf16_f32 v67, v67, v67
    v_lshlrev_b32 v67, 16, v67
    v_cndmask_b32 v35, v35, v67, vcc
    v_add_f32 v64, v36, v60
    v_cvt_pk_bf16_f32 v64, v64, v64
    v_lshlrev_b32 v64, 16, v64
    v_cndmask_b32 v36, v36, v64, vcc
    v_add_f32 v65, v37, v61
    v_cvt_pk_bf16_f32 v65, v65, v65
    v_lshlrev_b32 v65, 16, v65
    v_cndmask_b32 v37, v37, v65, vcc
    v_add_f32 v66, v38, v62
    v_cvt_pk_bf16_f32 v66, v66, v66
    v_lshlrev_b32 v66, 16, v66
    v_cndmask_b32 v38, v38, v66, vcc
    v_add_f32 v67, v39, v63
    v_cvt_pk_bf16_f32 v67, v67, v67
    v_lshlrev_b32 v67, 16, v67
    v_cndmask_b32 v39, v39, v67, vcc
    s_branch K_NOY1
K_YR1_1:
    s_waitcnt lgkmcnt(0)
    v_add_f32 v64, v40, v56
    v_cvt_pk_bf16_f32 v64, v64, v64
    v_lshlrev_b32 v64, 16, v64
    v_cndmask_b32 v40, v40, v64, vcc
    v_add_f32 v65, v41, v57
    v_cvt_pk_bf16_f32 v65, v65, v65
    v_lshlrev_b32 v65, 16, v65
    v_cndmask_b32 v41, v41, v65, vcc
    v_add_f32 v66, v42, v58
    v_cvt_pk_bf16_f32 v66, v66, v66
    v_lshlrev_b32 v66, 16, v66
    v_cndmask_b32 v42, v42, v66, vcc
    v_add_f32 v67, v43, v59
    v_cvt_pk_bf16_f32 v67, v67, v67
    v_lshlrev_b32 v67, 16, v67
    v_cndmask_b32 v43, v43, v67, vcc
    v_add_f32 v64, v44, v60
    v_cvt_pk_bf16_f32 v64, v64, v64
    v_lshlrev_b32 v64, 16, v64
    v_cndmask_b32 v44, v44, v64, vcc
    v_add_f32 v65, v45, v61
    v_cvt_pk_bf16_f32 v65, v65, v65
    v_lshlrev_b32 v65, 16, v65
    v_cndmask_b32 v45, v45, v65, vcc
    v_add_f32 v66, v46, v62
    v_cvt_pk_bf16_f32 v66, v66, v66
    v_lshlrev_b32 v66, 16, v66
    v_cndmask_b32 v46, v46, v66, vcc
    v_add_f32 v67, v47, v63
    v_cvt_pk_bf16_f32 v67, v67, v67
    v_lshlrev_b32 v67, 16, v67
    v_cndmask_b32 v47, v47, v67, vcc
    s_branch K_NOY1
K_STA10:
    s_branch K_STA14
K_STB10:
    s_branch K_STB14
K_P2:
    s_cmp_ge_u32 s30, 4
    s_cbranch_scc1 K_P2_HELP
    s_lshl_b32 s62, s40, 7
    v_lshrrev_b32 v8, 3, v1
    v_lshrrev_b32 v9, 4, v1
    v_mov_b32 v15, 158720
    s_lshl_b32 s61, s40, 3
    s_add_u32 s61, s61, s30
    s_mul_i32 s3, s61, 20480
    s_lshl_b32 s33, s41, 7
    s_add_u32 s3, s3, s33
    v_and_b32 v2, 7, v1
    v_lshlrev_b32 v2, 4, v2
    v_mul_u32_u24 v4, 1280, v8
    v_add3_u32 v10, v2, v4, s3
    s_lshl_b32 s3, s30, 7
    s_add_u32 s3, s3, 159744
    v_lshl_add_u32 v11, v8, 3, s3
    s_mov_b32 s63, 10240
    s_add_u32 s20, s6, 0x100000
    s_addc_u32 s21, s7, 0
    s_mov_b32 s22, 0x280000
    s_mov_b32 s23, 0x20000
    s_mov_b32 s56, s10
    s_mov_b32 s57, s11
    s_mov_b32 s58, 0x280000
    s_mov_b32 s59, 0x20000
    v_mul_u32_u24 v3, 144, v8
    v_add_u32 v3, v2, v3
    s_mul_i32 s3, s30, 2304
    s_add_u32 s3, s3, 140288
    v_add_u32 v14, s3, v3
    buffer_load_dwordx4 v[16:19], v10, s[12:15], 0 offen
    buffer_load_dwordx4 v[20:23], v10, s[12:15], s63 offen
    v_bfe_u32 v48, v1, 2, 2
    v_and_b32 v49, 3, v1
    s_add_u32 s3, s61, s30
    s_lshr_b32 s33, s3, 2
    s_mul_i32 s33, s33, 76
    s_add_u32 s3, s3, s33
    s_lshl_b32 s3, s3, 10
    v_and_b32 v2, 15, v1
    v_lshl_add_u32 v2, v2, 4, s3
    v_lshrrev_b32 v3, 5, v1
    v_lshl_add_u32 v2, v3, 8, v2
    v_and_b32 v4, 1, v9
    v_lshl_add_u32 v52, v4, 10, v2
    v_mov_b32 v53, 0x1f000
    v_lshl_add_u32 v2, v3, 3, v48
    v_lshlrev_b32 v2, 7, v2
    v_lshl_add_u32 v2, v49, 3, v2
    v_lshl_add_u32 v2, v4, 5, v2
    v_lshrrev_b32 v4, 1, v48
    v_lshl_add_u32 v54, v4, 6, v2
    v_xor_b32 v55, 64, v54
    v_mov_b32 v56, v54
    v_mov_b32 v57, v54
    v_and_b32 v2, 31, v1
    v_mul_u32_u24 v2, 144, v2
    v_lshl_add_u32 v2, v3, 3, v2
    s_mul_i32 s3, s30, 4608
    s_add_u32 s3, s3, 140288
    v_add_u32 v50, s3, v2
    s_lshl_b32 s3, s40, 3
    s_mul_i32 s33, s3, 187
    s_lshr_b32 s33, s33, 11
    s_add_u32 s33, s33, 1
    s_mul_i32 s33, s33, 11
    s_add_u32 s3, s61, s30
    s_add_u32 s3, s3, 1
    s_cmp_ge_u32 s3, s33
    s_cselect_b32 s60, 24, 16
    s_cmp_gt_u32 s3, s33
    s_cselect_b32 s60, 20, s60
    v_add_u32 v58, s60, v15
    s_mov_b32 s64, -1
    s_mov_b32 s65, -1
    s_mov_b32 s66, -1
    s_mov_b32 s67, -1
    s_mov_b32 s68, -1
    s_mov_b32 s69, -1
    s_mov_b32 s70, 0xfffff
    s_mov_b32 s71, 131072
    v_mov_b32 v108, 0
    v_mov_b32 v109, 0
    v_mov_b32 v110, 0
    v_mov_b32 v111, 0
    v_mov_b32 v112, 0
    v_mov_b32 v113, 0
    v_mov_b32 v114, 0
    v_mov_b32 v115, 0
    v_mov_b32 v116, 0
    v_mov_b32 v117, 0
    v_mov_b32 v118, 0
    v_mov_b32 v119, 0
    v_mov_b32 v120, 0
    v_mov_b32 v121, 0
    v_mov_b32 v122, 0
    v_mov_b32 v123, 0
    v_mov_b32 v124, 0
    v_mov_b32 v125, 0
    v_mov_b32 v126, 0
    v_mov_b32 v127, 0
    v_mov_b32 v128, 0
    v_mov_b32 v129, 0
    v_mov_b32 v130, 0
    v_mov_b32 v131, 0
    v_mov_b32 v132, 0
    v_mov_b32 v133, 0
    v_mov_b32 v134, 0
    v_mov_b32 v135, 0
    v_mov_b32 v136, 0
    v_mov_b32 v137, 0
    v_mov_b32 v138, 0
    v_mov_b32 v139, 0
K_P2_AUXW:
    v_lshrrev_b32 v2, 3, v1
    v_mul_u32_u24 v2, 1280, v2
    v_lshrrev_b32 v3, 2, v1
    v_and_b32 v3, 4, v3
    v_and_b32 v4, 7, v1
    v_xor_b32 v3, v3, v4
    v_lshl_add_u32 v2, v3, 4, v2
    s_lshl_b32 s33, s41, 7
    v_add_u32 v51, s33, v2
    v_lshrrev_b32 v5, 5, v1
    v_mul_u32_u24 v5, 20480, v5
    v_add_u32 v5, v5, v51
    s_lshl_b32 s52, s30, 2
    s_lshr_b32 s52, 0x7520, s52
    s_and_b32 s52, s52, 7
    s_mul_i32 s52, s52, 51200
    s_lshl_b32 s53, s30, 12
    s_add_u32 s60, s52, 0
    s_add_u32 m0, s53, 0
    s_waitcnt vmcnt(5)
    buffer_load_dwordx4 v51, s[24:27], s60 offen lds
    s_add_u32 s60, s52, 10240
    s_add_u32 m0, s53, 1024
    s_waitcnt vmcnt(5)
    buffer_load_dwordx4 v51, s[24:27], s60 offen lds
    s_add_u32 s60, s52, 25600
    s_add_u32 m0, s53, 2048
    s_waitcnt vmcnt(5)
    buffer_load_dwordx4 v51, s[24:27], s60 offen lds
    s_add_u32 s60, s52, 35840
    s_add_u32 m0, s53, 3072
    s_waitcnt vmcnt(5)
    buffer_load_dwordx4 v51, s[24:27], s60 offen lds
    s_add_u32 s60, s52, 409600
    s_add_u32 m0, s53, 20480
    s_waitcnt vmcnt(5)
    buffer_load_dwordx4 v51, s[24:27], s60 offen lds
    s_add_u32 s60, s52, 419840
    s_add_u32 m0, s53, 21504
    s_waitcnt vmcnt(5)
    buffer_load_dwordx4 v51, s[24:27], s60 offen lds
    v_mov_b32 v3, 1
    s_mov_b64 exec, 1
    ds_add_u32 v15, v3 offset:52
    s_mov_b64 exec, -1
    s_add_u32 s60, s52, 435200
    s_add_u32 m0, s53, 22528
    s_waitcnt vmcnt(5)
    buffer_load_dwordx4 v51, s[24:27], s60 offen lds
    s_add_u32 s60, s52, 445440
    s_add_u32 m0, s53, 23552
    s_waitcnt vmcnt(5)
    buffer_load_dwordx4 v51, s[24:27], s60 offen lds
    s_lshl_b32 s53, s30, 10
    s_add_u32 s60, s52, 20480
    s_add_u32 m0, s53, 16384
    s_waitcnt vmcnt(5)
    buffer_load_dwordx4 v5, s[24:27], s60 offen lds
    s_add_u32 s60, s52, 430080
    s_add_u32 m0, s53, 36864
    s_waitcnt vmcnt(5)
    buffer_load_dwordx4 v5, s[24:27], s60 offen lds
    s_cmp_eq_u32 s30, 0
    s_cbranch_scc1 K_CHA0
    s_cmp_eq_u32 s30, 1
    s_cbranch_scc1 K_CHA1
    s_cmp_eq_u32 s30, 2
    s_cbranch_scc1 K_CHA2
    s_branch K_CHA3
K_WRET_A:
    v_mov_b32 v3, 1
    s_waitcnt vmcnt(0)
    s_mov_b64 exec, 1
    ds_add_u32 v15, v3 offset:44
    s_mov_b64 exec, -1
    s_mov_b32 s3, 1048576
K_P2_GWA:
    ds_read_b32 v2, v15 offset:44
    s_sub_u32 s3, s3, 1
    s_waitcnt lgkmcnt(0)
    v_readfirstlane_b32 s33, v2
    s_nop 3
    s_cselect_b32 s33, 4, s33
    s_cmp_lt_u32 s33, 4
    s_cbranch_scc1 K_P2_GWA
    s_branch K_P2_GEMM
K_STA11:
    s_branch K_STA15
K_STB11:
    s_branch K_STB15
K_P2_HELP:
    s_setprio 3
    s_cmp_eq_u32 s30, 7
    s_cbranch_scc1 K_P2_W7
    s_cmp_eq_u32 s30, 4
    s_cbranch_scc1 K_P2_NL
    s_cmp_ge_u32 s29, 8
    s_cbranch_scc1 K_P2_NL
    s_mov_b32 s24, s8
    s_mov_b32 s25, s9
    s_mov_b32 s26, 0xc8000
    s_mov_b32 s27, 0x20000
    v_lshrrev_b32 v2, 3, v1
    v_mul_u32_u24 v2, 1280, v2
    v_lshrrev_b32 v3, 2, v1
    v_and_b32 v3, 4, v3
    v_and_b32 v4, 7, v1
    v_xor_b32 v3, v3, v4
    v_lshl_add_u32 v2, v3, 4, v2
    s_lshl_b32 s33, s41, 7
    v_add_u32 v12, s33, v2
    v_lshrrev_b32 v5, 5, v1
    v_mul_u32_u24 v5, 20480, v5
    v_add_u32 v5, v5, v12
    s_sub_u32 s61, s30, 5
    s_lshl_b32 s52, s61, 2
    s_lshr_b32 s52, 0x6431, s52
    s_and_b32 s52, s52, 7
    s_mul_i32 s52, s52, 51200
    s_lshl_b32 s53, s61, 12
    s_add_u32 s60, s52, 0
    s_add_u32 m0, s53, 40960
    s_nop 0
    buffer_load_dwordx4 v12, s[24:27], s60 offen lds
    s_add_u32 s60, s52, 10240
    s_add_u32 m0, s53, 41984
    s_nop 0
    buffer_load_dwordx4 v12, s[24:27], s60 offen lds
    s_add_u32 s60, s52, 25600
    s_add_u32 m0, s53, 43008
    s_nop 0
    buffer_load_dwordx4 v12, s[24:27], s60 offen lds
    s_branch K_PG5
.p2align 12
K_STA12:
    s_branch K_WRET_A
K_STB12:
    s_branch K_WRET_B
K_PG5:
    s_add_u32 s60, s52, 35840
    s_add_u32 m0, s53, 44032
    s_nop 0
    buffer_load_dwordx4 v12, s[24:27], s60 offen lds
    s_add_u32 s60, s52, 409600
    s_add_u32 m0, s53, 61440
    s_nop 0
    buffer_load_dwordx4 v12, s[24:27], s60 offen lds
    s_add_u32 s60, s52, 419840
    s_add_u32 m0, s53, 62464
    s_nop 0
    buffer_load_dwordx4 v12, s[24:27], s60 offen lds
    s_add_u32 s60, s52, 435200
    s_add_u32 m0, s53, 63488
    s_nop 0
    buffer_load_dwordx4 v12, s[24:27], s60 offen lds
    s_add_u32 s60, s52, 445440
    s_add_u32 m0, s53, 64512
    s_nop 0
    buffer_load_dwordx4 v12, s[24:27], s60 offen lds
    s_lshl_b32 s53, s61, 10
    s_add_u32 s60, s52, 20480
    s_add_u32 m0, s53, 57344
    s_nop 0
    buffer_load_dwordx4 v5, s[24:27], s60 offen lds
    s_add_u32 s60, s52, 430080
    s_add_u32 m0, s53, 77824
    s_nop 0
    buffer_load_dwordx4 v5, s[24:27], s60 offen lds
    s_add_u32 s61, s61, 2
    s_lshl_b32 s52, s61, 2
    s_lshr_b32 s52, 0x6431, s52
    s_and_b32 s52, s52, 7
    s_mul_i32 s52, s52, 51200
    s_lshl_b32 s53, s61, 12
    s_add_u32 s60, s52, 0
    s_add_u32 m0, s53, 40960
    s_nop 0
    buffer_load_dwordx4 v12, s[24:27], s60 offen lds
    s_add_u32 s60, s52, 10240
    s_add_u32 m0, s53, 41984
    s_nop 0
    buffer_load_dwordx4 v12, s[24:27], s60 offen lds
    s_add_u32 s60, s52, 25600
    s_add_u32 m0, s53, 43008
    s_nop 0
    buffer_load_dwordx4 v12, s[24:27], s60 offen lds
    s_add_u32 s60, s52, 35840
    s_add_u32 m0, s53, 44032
    s_nop 0
    buffer_load_dwordx4 v12, s[24:27], s60 offen lds
    s_add_u32 s60, s52, 409600
    s_add_u32 m0, s53, 61440
    s_nop 0
    buffer_load_dwordx4 v12, s[24:27], s60 offen lds
    s_add_u32 s60, s52, 419840
    s_add_u32 m0, s53, 62464
    s_nop 0
    buffer_load_dwordx4 v12, s[24:27], s60 offen lds
    s_add_u32 s60, s52, 435200
    s_add_u32 m0, s53, 63488
    s_nop 0
    buffer_load_dwordx4 v12, s[24:27], s60 offen lds
    s_add_u32 s60, s52, 445440
    s_add_u32 m0, s53, 64512
    s_nop 0
    buffer_load_dwordx4 v12, s[24:27], s60 offen lds
    s_lshl_b32 s53, s61, 10
    s_add_u32 s60, s52, 20480
    s_add_u32 m0, s53, 57344
    s_nop 0
    buffer_load_dwordx4 v5, s[24:27], s60 offen lds
    s_add_u32 s60, s52, 430080
    s_add_u32 m0, s53, 77824
    s_nop 0
    buffer_load_dwordx4 v5, s[24:27], s60 offen lds
    v_mov_b32 v2, 158720
    v_mov_b32 v3, 1
    s_waitcnt vmcnt(0)
    s_mov_b64 exec, 1
    ds_add_u32 v2, v3 offset:56
    s_mov_b64 exec, -1
K_P2_NL:
    s_lshl_b32 s62, s40, 7
    v_lshrrev_b32 v8, 3, v1
    v_lshrrev_b32 v9, 4, v1
    v_mov_b32 v15, 158720
    s_lshl_b32 s61, s40, 3
    s_add_u32 s61, s61, s30
    s_mul_i32 s3, s61, 20480
    s_lshl_b32 s33, s41, 7
    s_add_u32 s3, s3, s33
    v_and_b32 v2, 7, v1
    v_lshlrev_b32 v2, 4, v2
    v_mul_u32_u24 v4, 1280, v8
    v_add3_u32 v10, v2, v4, s3
    s_lshl_b32 s3, s30, 7
    s_add_u32 s3, s3, 159744
    v_lshl_add_u32 v11, v8, 3, s3
    s_mov_b32 s63, 10240
    s_add_u32 s20, s6, 0x100000
    s_addc_u32 s21, s7, 0
    s_mov_b32 s22, 0x280000
    s_mov_b32 s23, 0x20000
    s_mov_b32 s56, s10
    s_mov_b32 s57, s11
    s_mov_b32 s58, 0x280000
    s_mov_b32 s59, 0x20000
    v_mul_u32_u24 v3, 144, v8
    v_add_u32 v3, v2, v3
    s_mul_i32 s3, s30, 2304
    s_add_u32 s3, s3, 140288
    v_add_u32 v14, s3, v3
    s_add_u32 s44, s6, 0x10000
    s_addc_u32 s45, s7, 0
    s_mov_b32 s46, 0x43800
    s_mov_b32 s47, 0x20000
    v_mov_b32 v108, 1
    buffer_load_dwordx4 v[16:19], v10, s[12:15], 0 offen
    buffer_load_dwordx4 v[20:23], v10, s[12:15], s63 offen
    s_cmp_lg_u32 s30, 6
    s_cbranch_scc1 K_P2_HW
    s_mov_b32 s3, 131072
    s_waitcnt vmcnt(2)
K_P2_DPOLL:
    v_min_u32 v2, v7, v6
    v_cmp_eq_u32 vcc, 0, v2
    s_cbranch_vccz K_P2_DOK
    s_cmp_eq_u32 s3, 131072
    s_cbranch_scc1 K_P2_DNS
    s_sleep 12
K_P2_DNS:
    v_lshl_add_u32 v13, v1, 2, s42
    global_load_dword v7, v13, s[6:7] offset:256 sc1
    v_and_b32 v13, 0xfffffe04, v13
    global_load_dword v6, v13, s[6:7] offset:128 sc1
    s_sub_u32 s3, s3, 1
    s_waitcnt vmcnt(0)
    s_cmp_lg_u32 s3, 0
    s_cbranch_scc1 K_P2_DPOLL
K_P2_DOK:
    v_readlane_b32 s52, v6, 0
    v_readlane_b32 s53, v6, 1
    s_nop 1
    s_and_b32 s3, s52, 0x7ff
    s_sub_u32 s3, 2047, s3
    v_mov_b32 v48, s3
    v_mov_b32 v4, s52
    v_and_b32 v4, 0xffff0000, v4
    v_ashrrev_i32 v5, 31, v4
    v_not_b32 v5, v5
    v_or_b32 v5, 0x80000000, v5
    v_xor_b32 v4, v4, v5
    v_and_b32 v4, 0xffff0000, v4
    v_mul_f32 v5, 0xbfb8aa3b, v4
    v_exp_f32 v5, v5
    s_nop 0
    v_add_f32 v5, 1.0, v5
    v_rcp_f32 v4, v5
    s_nop 0
    v_cvt_pk_bf16_f32 v50, v4, v4
    v_lshlrev_b32 v50, 16, v50
    s_and_b32 s3, s53, 0x7ff
    s_sub_u32 s3, 2047, s3
    v_mov_b32 v49, s3
    v_mov_b32 v4, s53
    v_and_b32 v4, 0xffff0000, v4
    v_ashrrev_i32 v5, 31, v4
    v_not_b32 v5, v5
    v_or_b32 v5, 0x80000000, v5
    v_xor_b32 v4, v4, v5
    v_and_b32 v4, 0xffff0000, v4
    v_mul_f32 v5, 0xbfb8aa3b, v4
    v_exp_f32 v5, v5
    s_nop 0
    v_add_f32 v5, 1.0, v5
    v_rcp_f32 v4, v5
    s_nop 0
    v_cvt_pk_bf16_f32 v51, v4, v4
    v_lshlrev_b32 v51, 16, v51
    ds_write_b128 v15, v[48:51]
    ds_write_b32 v15, v108 offset:40
    v_lshl_add_u32 v13, v1, 4, v15
    v_lshlrev_b32 v52, 16, v7
    v_and_b32 v52, 0x7fff0000, v52
    v_and_b32 v54, 0x7fff0000, v7
    v_sub_f32 v53, 1.0, v52
    v_cvt_pk_bf16_f32 v53, v53, v53
    v_lshlrev_b32 v53, 16, v53
    v_sub_f32 v55, 1.0, v54
    v_cvt_pk_bf16_f32 v55, v55, v55
    v_lshlrev_b32 v55, 16, v55
    ds_write_b128 v13, v[52:55] offset:1024
    s_branch K_P2_E
K_STA13:
    s_branch K_WRET_A
K_STB13:
    s_branch K_WRET_B
K_P2_HW:
    s_mov_b32 s3, 1048576
K_P2_GS2:
    ds_read_b32 v2, v15 offset:40
    s_sleep 1
    s_sub_u32 s3, s3, 1
    s_waitcnt lgkmcnt(0)
    v_readfirstlane_b32 s33, v2
    s_nop 3
    s_cselect_b32 s33, 1, s33
    s_cmp_lt_u32 s33, 1
    s_cbranch_scc1 K_P2_GS2
    ds_read_b128 v[28:31], v15
    s_waitcnt lgkmcnt(0)
    s_cmp_eq_u32 s30, 4
    s_cselect_b64 vcc, -1, 0
    s_nop 1
    v_cndmask_b32 v2, v29, v28, vcc
    v_cndmask_b32 v5, v31, v30, vcc
    s_nop 0
    v_readfirstlane_b32 s52, v2
    s_nop 3
    s_sub_u32 s3, s52, s62
    s_cmp_lt_u32 s3, 128
    s_cbranch_scc0 K_P2_E
    s_mov_b32 s3, 131072
K_P2_YPOLL:
    s_load_dword s33, s[6:7], s42 offset:136 glc
    s_waitcnt lgkmcnt(0)
    s_cmp_lg_u32 s33, 0
    s_cbranch_scc1 K_P2_YGO
    s_sleep 4
    s_sub_u32 s3, s3, 1
    s_cbranch_scc0 K_P2_YPOLL
K_P2_YGO:
    v_and_b32 v2, 15, v1
    v_lshlrev_b32 v2, 4, v2
    v_mul_u32_u24 v4, 5120, v9
    s_sub_u32 s53, s30, 4
    s_mul_i32 s33, s53, 2560
    s_lshl_b32 s3, s41, 8
    s_add_u32 s3, s3, s33
    v_add3_u32 v3, v2, v4, s3
    s_mov_b32 s60, 0
    buffer_load_dwordx4 v[52:55], v3, s[44:47], s60 offen sc1
    s_mov_b32 s60, 20480
    buffer_load_dwordx4 v[56:59], v3, s[44:47], s60 offen sc1
    s_mov_b32 s60, 40960
    buffer_load_dwordx4 v[60:63], v3, s[44:47], s60 offen sc1
    s_mov_b32 s60, 61440
    buffer_load_dwordx4 v[64:67], v3, s[44:47], s60 offen sc1
    s_mov_b32 s60, 81920
    buffer_load_dwordx4 v[68:71], v3, s[44:47], s60 offen sc1
    s_mov_b32 s60, 102400
    buffer_load_dwordx4 v[72:75], v3, s[44:47], s60 offen sc1
    s_mov_b32 s60, 122880
    buffer_load_dwordx4 v[76:79], v3, s[44:47], s60 offen sc1
    s_mov_b32 s60, 143360
    buffer_load_dwordx4 v[80:83], v3, s[44:47], s60 offen sc1
    s_mov_b32 s60, 163840
    buffer_load_dwordx4 v[84:87], v3, s[44:47], s60 offen sc1
    s_mov_b32 s60, 184320
    buffer_load_dwordx4 v[88:91], v3, s[44:47], s60 offen sc1
    s_mov_b32 s60, 204800
    buffer_load_dwordx4 v[92:95], v3, s[44:47], s60 offen sc1
    s_mov_b32 s60, 225280
    buffer_load_dwordx4 v[96:99], v3, s[44:47], s60 offen sc1
    s_mov_b32 s60, 245760
    buffer_load_dwordx4 v[100:103], v3, s[44:47], s60 offen sc1
    s_mov_b32 s60, 266240
    buffer_load_dwordx4 v[104:107], v3, s[44:47], s60 offen sc1
    s_waitcnt vmcnt(12)
    v_add_f32 v48, v52, v56
    v_add_f32 v49, v53, v57
    v_add_f32 v50, v54, v58
    v_add_f32 v51, v55, v59
    s_waitcnt vmcnt(11)
    v_add_f32 v48, v48, v60
    v_add_f32 v49, v49, v61
    v_add_f32 v50, v50, v62
    v_add_f32 v51, v51, v63
    s_waitcnt vmcnt(10)
    v_add_f32 v48, v48, v64
    v_add_f32 v49, v49, v65
    v_add_f32 v50, v50, v66
    v_add_f32 v51, v51, v67
    s_waitcnt vmcnt(9)
    v_add_f32 v48, v48, v68
    v_add_f32 v49, v49, v69
    v_add_f32 v50, v50, v70
    v_add_f32 v51, v51, v71
    s_waitcnt vmcnt(8)
    v_add_f32 v48, v48, v72
    v_add_f32 v49, v49, v73
    v_add_f32 v50, v50, v74
    v_add_f32 v51, v51, v75
    s_waitcnt vmcnt(7)
    v_add_f32 v48, v48, v76
    v_add_f32 v49, v49, v77
    v_add_f32 v50, v50, v78
    v_add_f32 v51, v51, v79
    s_waitcnt vmcnt(6)
    v_add_f32 v48, v48, v80
    v_add_f32 v49, v49, v81
    v_add_f32 v50, v50, v82
    v_add_f32 v51, v51, v83
    s_waitcnt vmcnt(5)
    v_add_f32 v48, v48, v84
    v_add_f32 v49, v49, v85
    v_add_f32 v50, v50, v86
    v_add_f32 v51, v51, v87
    s_waitcnt vmcnt(4)
    v_add_f32 v48, v48, v88
    v_add_f32 v49, v49, v89
    v_add_f32 v50, v50, v90
    v_add_f32 v51, v51, v91
    s_waitcnt vmcnt(3)
    v_add_f32 v48, v48, v92
    v_add_f32 v49, v49, v93
    v_add_f32 v50, v50, v94
    v_add_f32 v51, v51, v95
    s_waitcnt vmcnt(2)
    v_add_f32 v48, v48, v96
    v_add_f32 v49, v49, v97
    v_add_f32 v50, v50, v98
    v_add_f32 v51, v51, v99
    s_waitcnt vmcnt(1)
    v_add_f32 v48, v48, v100
    v_add_f32 v49, v49, v101
    v_add_f32 v50, v50, v102
    v_add_f32 v51, v51, v103
    s_waitcnt vmcnt(0)
    v_add_f32 v48, v48, v104
    v_add_f32 v49, v49, v105
    v_add_f32 v50, v50, v106
    v_add_f32 v51, v51, v107
    v_mov_b32 v52, v48
    v_mov_b32 v53, v49
    v_mov_b32 v54, v50
    v_mov_b32 v55, v51
    s_nop 0
    v_permlane16_swap_b32 v48, v52
    v_permlane16_swap_b32 v49, v53
    v_permlane16_swap_b32 v50, v54
    v_permlane16_swap_b32 v51, v55
    v_add_f32 v48, v48, v52
    v_add_f32 v49, v49, v53
    v_add_f32 v50, v50, v54
    v_add_f32 v51, v51, v55
    v_mov_b32 v52, v48
    v_mov_b32 v53, v49
    v_mov_b32 v54, v50
    v_mov_b32 v55, v51
    s_nop 0
    v_permlane32_swap_b32 v48, v52
    v_permlane32_swap_b32 v49, v53
    v_permlane32_swap_b32 v50, v54
    v_permlane32_swap_b32 v51, v55
    v_add_f32 v48, v48, v52
    v_add_f32 v49, v49, v53
    v_add_f32 v50, v50, v54
    v_add_f32 v51, v51, v55
    v_cvt_pk_bf16_f32 v48, v48, v48
    v_lshlrev_b32 v48, 16, v48
    v_mul_f32 v48, v5, v48
    v_cvt_pk_bf16_f32 v48, v48, v48
    v_lshlrev_b32 v48, 16, v48
    v_cvt_pk_bf16_f32 v49, v49, v49
    v_lshlrev_b32 v49, 16, v49
    v_mul_f32 v49, v5, v49
    v_cvt_pk_bf16_f32 v49, v49, v49
    v_lshlrev_b32 v49, 16, v49
    v_cvt_pk_bf16_f32 v50, v50, v50
    v_lshlrev_b32 v50, 16, v50
    v_mul_f32 v50, v5, v50
    v_cvt_pk_bf16_f32 v50, v50, v50
    v_lshlrev_b32 v50, 16, v50
    v_cvt_pk_bf16_f32 v51, v51, v51
    v_lshlrev_b32 v51, 16, v51
    v_mul_f32 v51, v5, v51
    v_cvt_pk_bf16_f32 v51, v51, v51
    v_lshlrev_b32 v51, 16, v51
    s_lshl_b32 s3, s53, 8
    s_add_u32 s3, s3, 158976
    v_add_u32 v2, s3, v2
    ds_write_b128 v2, v[48:51]
    s_branch K_P2_E
K_STA14:
    s_branch K_WRET_A
K_STB14:
    s_branch K_WRET_B
K_P2_W7:
    s_mov_b32 s37, s42
    s_waitcnt lgkmcnt(0)
    s_load_dwordx2 s[48:49], s[6:7], s37 glc
    s_mul_i32 s52, s40, 1496
    s_add_u32 s53, s52, 1309
    s_lshr_b32 s52, s52, 11
    s_lshr_b32 s53, s53, 11
    s_sub_u32 s53, s53, s52
    s_mov_b32 s46, 0x84210
    s_mov_b32 s47, s46
    v_mov_b32 v15, 158720
    v_mov_b32 v5, 0
    v_mov_b32 v48, 0x80000000
    s_mov_b64 exec, 1
    ds_or_b32 v15, v48 offset:16
    ds_or_b32 v15, v48 offset:20
    ds_or_b32 v15, v48 offset:24
    s_waitcnt lgkmcnt(0)
    s_cmp_eq_u32 s53, 0
    s_cselect_b32 s49, s48, s49
    s_lshl_b64 s[50:51], s[48:49], 1
    s_and_b64 s[50:51], s[50:51], s[48:49]
    s_lshl_b64 vcc, s[50:51], 2
    s_and_b64 s[50:51], s[50:51], vcc
    s_lshl_b64 s[50:51], s[50:51], 1
    s_and_b64 s[50:51], s[50:51], s[46:47]
    s_or_b64 s[48:49], s[48:49], s[50:51]
    v_readfirstlane_b32 s52, v5
    s_cmp_ge_u32 s52, 2
    s_cselect_b32 s52, -1, 0x3ff
    s_and_b32 s48, s48, s52
    s_and_b32 s49, s49, s52
    s_and_b32 s52, s48, s49
    v_mov_b32 v48, s48
    v_mov_b32 v49, s49
    v_mov_b32 v50, s52
    s_mov_b64 exec, 1
    ds_or_b64 v15, v[48:49] offset:16
    ds_or_b32 v15, v50 offset:24
    s_mov_b64 exec, -1
    s_load_dwordx2 s[48:49], s[6:7], s37 glc
    s_lshl_b32 s62, s40, 7
    v_lshrrev_b32 v8, 3, v1
    v_lshrrev_b32 v9, 4, v1
    v_mov_b32 v15, 158720
    s_lshl_b32 s61, s40, 3
    s_add_u32 s61, s61, s30
    s_mul_i32 s3, s61, 20480
    s_lshl_b32 s33, s41, 7
    s_add_u32 s3, s3, s33
    v_and_b32 v2, 7, v1
    v_lshlrev_b32 v2, 4, v2
    v_mul_u32_u24 v4, 1280, v8
    v_add3_u32 v10, v2, v4, s3
    s_lshl_b32 s3, s30, 7
    s_add_u32 s3, s3, 159744
    v_lshl_add_u32 v11, v8, 3, s3
    s_mov_b32 s63, 10240
    s_add_u32 s20, s6, 0x100000
    s_addc_u32 s21, s7, 0
    s_mov_b32 s22, 0x280000
    s_mov_b32 s23, 0x20000
    s_mov_b32 s56, s10
    s_mov_b32 s57, s11
    s_mov_b32 s58, 0x280000
    s_mov_b32 s59, 0x20000
    v_mul_u32_u24 v3, 144, v8
    v_add_u32 v3, v2, v3
    s_mul_i32 s3, s30, 2304
    s_add_u32 s3, s3, 140288
    v_add_u32 v14, s3, v3
    buffer_load_dwordx4 v[16:19], v10, s[12:15], 0 offen
    buffer_load_dwordx4 v[20:23], v10, s[12:15], s63 offen
    s_mov_b32 s3, 131072
    s_waitcnt lgkmcnt(0)
K_P2_FP:
    s_load_dwordx2 s[44:45], s[6:7], s37 glc
    s_cmp_eq_u32 s53, 0
    s_cselect_b32 s49, s48, s49
    s_lshl_b64 s[50:51], s[48:49], 1
    s_and_b64 s[50:51], s[50:51], s[48:49]
    s_lshl_b64 vcc, s[50:51], 2
    s_and_b64 s[50:51], s[50:51], vcc
    s_lshl_b64 s[50:51], s[50:51], 1
    s_and_b64 s[50:51], s[50:51], s[46:47]
    s_or_b64 s[48:49], s[48:49], s[50:51]
    v_readfirstlane_b32 s52, v5
    s_cmp_ge_u32 s52, 2
    s_cselect_b32 s52, -1, 0x3ff
    s_and_b32 s48, s48, s52
    s_and_b32 s49, s49, s52
    s_and_b32 s52, s48, s49
    v_mov_b32 v48, s48
    v_mov_b32 v49, s49
    v_mov_b32 v50, s52
    s_mov_b64 exec, 1
    ds_or_b64 v15, v[48:49] offset:16
    ds_or_b32 v15, v50 offset:24
    s_mov_b64 exec, -1
    ds_read_b32 v5, v15 offset:56
    s_cmp_eq_u32 s52, 0xfffff
    s_cbranch_scc1 K_P2_FGO
    s_cmp_lg_u64 s[48:49], 0
    s_cbranch_scc1 K_P2_FS2
    s_sleep 8
K_P2_FS2:
    s_sub_u32 s3, s3, 1
    s_waitcnt lgkmcnt(0)
    s_mov_b64 s[48:49], s[44:45]
    s_cbranch_scc0 K_P2_FP
    s_mov_b32 s3, 0
K_P2_FCHK:
    s_cmp_eq_u32 s53, 0
    s_cselect_b32 s49, s48, s49
    s_lshl_b64 s[50:51], s[48:49], 1
    s_and_b64 s[50:51], s[50:51], s[48:49]
    s_lshl_b64 vcc, s[50:51], 2
    s_and_b64 s[50:51], s[50:51], vcc
    s_lshl_b64 s[50:51], s[50:51], 1
    s_and_b64 s[50:51], s[50:51], s[46:47]
    s_or_b64 s[48:49], s[48:49], s[50:51]
    v_readfirstlane_b32 s52, v5
    s_cmp_ge_u32 s52, 2
    s_cselect_b32 s52, -1, 0x3ff
    s_and_b32 s48, s48, s52
    s_and_b32 s49, s49, s52
    s_and_b32 s52, s48, s49
    v_mov_b32 v48, s48
    v_mov_b32 v49, s49
    v_mov_b32 v50, s52
    s_mov_b64 exec, 1
    ds_or_b64 v15, v[48:49] offset:16
    ds_or_b32 v15, v50 offset:24
    s_mov_b64 exec, -1
    s_cmp_eq_u32 s52, 0xfffff
    s_cbranch_scc1 K_P2_FGO
    s_cmp_lg_u64 s[48:49], 0
    s_cbranch_scc1 K_P2_FS
    s_sleep 8
K_P2_FS:
    s_sleep 2
    s_load_dwordx2 s[48:49], s[6:7], s37 glc
    ds_read_b32 v5, v15 offset:56
    s_sub_u32 s3, s3, 1
    s_waitcnt lgkmcnt(0)
    s_cbranch_scc0 K_P2_FCHK
    v_mov_b32 v48, -1
    v_mov_b32 v49, -1
    v_mov_b32 v50, -1
    ds_write_b96 v15, v[48:50] offset:16
K_P2_FGO:
K_P2_E:
    s_setprio 0
    s_waitcnt vmcnt(0)
    v_lshlrev_b32 v32, 16, v16
    v_and_b32 v33, 0xffff0000, v16
    v_lshlrev_b32 v34, 16, v17
    v_and_b32 v35, 0xffff0000, v17
    v_lshlrev_b32 v36, 16, v18
    v_and_b32 v37, 0xffff0000, v18
    v_lshlrev_b32 v38, 16, v19
    v_and_b32 v39, 0xffff0000, v19
    v_lshlrev_b32 v40, 16, v20
    v_and_b32 v41, 0xffff0000, v20
    v_lshlrev_b32 v42, 16, v21
    v_and_b32 v43, 0xffff0000, v21
    v_lshlrev_b32 v44, 16, v22
    v_and_b32 v45, 0xffff0000, v22
    v_lshlrev_b32 v46, 16, v23
    v_and_b32 v47, 0xffff0000, v23
    s_branch K_P2_E2
K_STA15:
    s_branch K_WRET_A
K_STB15:
    s_branch K_WRET_B
K_SPN:
    s_mov_b32 s64, -1
    s_mov_b32 s65, -1
    s_mov_b32 s66, -1
    s_mov_b32 s67, -1
    s_mov_b32 s68, -1
    s_mov_b32 s69, -1
K_SPL:
    ds_read_b32 v59, v58
    s_waitcnt lgkmcnt(0)
    v_readfirstlane_b32 s50, v59
    s_and_b32 s33, s50, s70
    s_cbranch_scc1 K_BK0
    s_cmp_lt_i32 s50, 0
    s_cbranch_scc0 K_SPG
    s_sleep 1
    s_branch K_SPL
K_SPG:
    s_load_dwordx2 s[48:49], s[6:7], s42 glc
    ds_read_b32 v5, v15 offset:56
    s_waitcnt lgkmcnt(0)
    s_cmp_eq_u32 s53, 0
    s_cselect_b32 s49, s48, s49
    s_lshl_b64 s[50:51], s[48:49], 1
    s_and_b64 s[50:51], s[50:51], s[48:49]
    s_lshl_b64 vcc, s[50:51], 2
    s_and_b64 s[50:51], s[50:51], vcc
    s_lshl_b64 s[50:51], s[50:51], 1
    s_and_b64 s[50:51], s[50:51], s[46:47]
    s_or_b64 s[48:49], s[48:49], s[50:51]
    v_readfirstlane_b32 s52, v5
    s_cmp_ge_u32 s52, 2
    s_cselect_b32 s52, -1, 0x3ff
    s_and_b32 s48, s48, s52
    s_and_b32 s49, s49, s52
    s_and_b32 s52, s48, s49
    v_mov_b32 v188, s48
    v_mov_b32 v189, s49
    v_mov_b32 v190, s52
    s_mov_b64 exec, 1
    ds_or_b64 v15, v[188:189] offset:16
    ds_or_b32 v15, v190 offset:24
    s_mov_b64 exec, -1
    ds_read_b32 v59, v58
    s_waitcnt lgkmcnt(0)
    v_readfirstlane_b32 s50, v59
    s_and_b32 s33, s50, s70
    s_cbranch_scc1 K_BK0
    s_sleep 2
    ds_read_b32 v59, v58
    s_waitcnt lgkmcnt(0)
    v_readfirstlane_b32 s50, v59
    s_and_b32 s33, s50, s70
    s_cbranch_scc1 K_BK0
    s_sleep 2
    ds_read_b32 v59, v58
    s_waitcnt lgkmcnt(0)
    v_readfirstlane_b32 s50, v59
    s_and_b32 s33, s50, s70
    s_cbranch_scc1 K_BK0
    s_sleep 2
    ds_read_b32 v59, v58
    s_waitcnt lgkmcnt(0)
    v_readfirstlane_b32 s50, v59
    s_and_b32 s33, s50, s70
    s_cbranch_scc1 K_BK0
    s_branch K_SPL
K_CHEND:
K_AUX:
    s_cmp_ge_u32 s30, 4
    s_cbranch_scc1 K_AUX_L
    s_and_b32 s3, s2, 7
    s_lshr_b32 s70, s2, 3
    s_lshl3_add_u32 s3, s3, s70
    s_lshl_b32 s3, s3, 5
    s_lshl3_add_u32 s3, s30, s3
    v_bfe_u32 v8, v0, 4, 2
    v_add_u32 v8, s3, v8
    v_and_b32 v10, 15, v0
    v_lshlrev_b32 v10, 4, v10
    v_mul_u32_u24 v9, 1280, v8
    v_add_u32 v9, v9, v10
    v_and_b32 v2, 63, v0
    v_lshlrev_b32 v2, 4, v2
    s_lshl_b32 s71, s30, 12
    s_add_u32 s71, s71, 126016
    s_mov_b32 s70, 5120
    s_mov_b32 m0, s71
    s_waitcnt lgkmcnt(0)
    s_mov_b32 s16, s44
    s_mov_b32 s17, s45
    s_mov_b32 s18, 0x500
    s_mov_b32 s19, 0x20000
    s_mov_b32 s20, s52
    s_mov_b32 s21, s53
    s_mov_b32 s22, 0x500
    s_mov_b32 s23, 0x20000
    buffer_load_dwordx4 v2, s[16:19], 0 offen lds
    buffer_load_dwordx4 v2, s[16:19], 0 offen offset:1024 lds
    s_add_u32 m0, s71, 2048
    v_add_u32 v10, s71, v10
    buffer_load_dwordx4 v2, s[20:23], 0 offen lds
    buffer_load_dwordx4 v2, s[20:23], 0 offen offset:1024 lds
    buffer_load_dwordx4 v[16:19], v9, s[12:15], 0 offen offset:0
    buffer_load_dwordx4 v[20:23], v9, s[12:15], s70 offen offset:0
    buffer_load_dwordx4 v[24:27], v9, s[12:15], 0 offen offset:256
    buffer_load_dwordx4 v[28:31], v9, s[12:15], s70 offen offset:256
    buffer_load_dwordx4 v[32:35], v9, s[12:15], 0 offen offset:512
    buffer_load_dwordx4 v[36:39], v9, s[12:15], s70 offen offset:512
    buffer_load_dwordx4 v[40:43], v9, s[12:15], 0 offen offset:768
    buffer_load_dwordx4 v[44:47], v9, s[12:15], s70 offen offset:768
    buffer_load_dwordx4 v[48:51], v9, s[12:15], 0 offen offset:1024
    buffer_load_dwordx4 v[52:55], v9, s[12:15], s70 offen offset:1024
    s_barrier
    v_and_b32 v1, 63, v0
    v_mov_b32 v7, 0
    s_and_b32 s28, s2, 7
    s_lshr_b32 s29, s2, 3
    s_xor_b32 s30, s30, 4
    s_lshr_b32 s34, s29, 3
    s_lshl_b32 s34, s34, 2
    s_and_b32 s3, s29, 3
    s_add_u32 s34, s34, s3
    s_add_u32 s34, s34, 4
    s_bitcmp1_b32 s29, 2
    s_cselect_b32 s34, -1, s34
    s_cmp_lt_u32 s29, 8
    s_cselect_b32 s34, s29, s34
    s_lshl_b32 s40, s28, 1
    s_cmp_ge_u32 s34, 10
    s_addc_u32 s40, s40, 0
    s_sub_u32 s41, s34, 10
    s_cmp_ge_u32 s34, 10
    s_cselect_b32 s41, s41, s34
    s_mul_i32 s42, s28, 20
    s_add_u32 s42, s42, s34
    s_and_b32 s42, s42, 255
    s_lshl_b32 s42, s42, 9
    s_add_u32 s42, s42, 524288
    s_mul_i32 s43, s28, 7
    s_add_u32 s43, s43, s29
    s_sub_u32 s43, s43, 1
    s_cmp_lt_u32 s43, 54
    s_cselect_b32 s43, s43, 63
    s_cmp_eq_u32 s29, 0
    s_cselect_b32 s43, 63, s43
    s_mov_b32 s24, s8
    s_mov_b32 s25, s9
    s_mov_b32 s26, 0xc8000
    s_mov_b32 s27, 0x20000
    s_add_u32 s64, s6, 0x80000
    s_addc_u32 s65, s7, 0
    s_mov_b32 s66, 0x14400
    s_mov_b32 s67, 0x20000
    s_add_u32 s60, s6, 0x10000
    s_addc_u32 s61, s7, 0
    s_mov_b32 s62, 0x43800
    s_mov_b32 s63, 0x20000
    v_mov_b32 v96, 0
    v_mov_b32 v97, 0
    v_mov_b32 v98, 0
    v_mov_b32 v99, 0
    v_mov_b32 v13, 158720
    s_waitcnt vmcnt(10)
    ds_read_b128 v[56:59], v10 offset:0
    ds_read_b128 v[76:79], v10 offset:2048
    ds_read_b128 v[60:63], v10 offset:256
    ds_read_b128 v[80:83], v10 offset:2304
    ds_read_b128 v[64:67], v10 offset:512
    ds_read_b128 v[84:87], v10 offset:2560
    ds_read_b128 v[68:71], v10 offset:768
    ds_read_b128 v[88:91], v10 offset:2816
    ds_read_b128 v[72:75], v10 offset:1024
    ds_read_b128 v[92:95], v10 offset:3072
    s_waitcnt vmcnt(8) lgkmcnt(8)
    v_dot2c_f32_bf16 v96, v16, v56
    v_dot2c_f32_bf16 v98, v16, v76
    v_dot2c_f32_bf16 v97, v20, v56
    v_dot2c_f32_bf16 v99, v20, v76
    v_dot2c_f32_bf16 v96, v17, v57
    v_dot2c_f32_bf16 v98, v17, v77
    v_dot2c_f32_bf16 v97, v21, v57
    v_dot2c_f32_bf16 v99, v21, v77
    v_dot2c_f32_bf16 v96, v18, v58
    v_dot2c_f32_bf16 v98, v18, v78
    v_dot2c_f32_bf16 v97, v22, v58
    v_dot2c_f32_bf16 v99, v22, v78
    v_dot2c_f32_bf16 v96, v19, v59
    v_dot2c_f32_bf16 v98, v19, v79
    v_dot2c_f32_bf16 v97, v23, v59
    v_dot2c_f32_bf16 v99, v23, v79
    s_waitcnt vmcnt(6) lgkmcnt(6)
    v_dot2c_f32_bf16 v96, v24, v60
    v_dot2c_f32_bf16 v98, v24, v80
    v_dot2c_f32_bf16 v97, v28, v60
    v_dot2c_f32_bf16 v99, v28, v80
    v_dot2c_f32_bf16 v96, v25, v61
    v_dot2c_f32_bf16 v98, v25, v81
    v_dot2c_f32_bf16 v97, v29, v61
    v_dot2c_f32_bf16 v99, v29, v81
    v_dot2c_f32_bf16 v96, v26, v62
    v_dot2c_f32_bf16 v98, v26, v82
    v_dot2c_f32_bf16 v97, v30, v62
    v_dot2c_f32_bf16 v99, v30, v82
    v_dot2c_f32_bf16 v96, v27, v63
    v_dot2c_f32_bf16 v98, v27, v83
    v_dot2c_f32_bf16 v97, v31, v63
    v_dot2c_f32_bf16 v99, v31, v83
    s_waitcnt vmcnt(4) lgkmcnt(4)
    v_dot2c_f32_bf16 v96, v32, v64
    v_dot2c_f32_bf16 v98, v32, v84
    v_dot2c_f32_bf16 v97, v36, v64
    v_dot2c_f32_bf16 v99, v36, v84
    v_dot2c_f32_bf16 v96, v33, v65
    v_dot2c_f32_bf16 v98, v33, v85
    v_dot2c_f32_bf16 v97, v37, v65
    v_dot2c_f32_bf16 v99, v37, v85
    v_dot2c_f32_bf16 v96, v34, v66
    v_dot2c_f32_bf16 v98, v34, v86
    v_dot2c_f32_bf16 v97, v38, v66
    v_dot2c_f32_bf16 v99, v38, v86
    v_dot2c_f32_bf16 v96, v35, v67
    v_dot2c_f32_bf16 v98, v35, v87
    v_dot2c_f32_bf16 v97, v39, v67
    v_dot2c_f32_bf16 v99, v39, v87
    s_waitcnt vmcnt(2) lgkmcnt(2)
    s_branch K_PG6
.p2align 12
K_PG6:
    v_dot2c_f32_bf16 v96, v40, v68
    v_dot2c_f32_bf16 v98, v40, v88
    v_dot2c_f32_bf16 v97, v44, v68
    v_dot2c_f32_bf16 v99, v44, v88
    v_dot2c_f32_bf16 v96, v41, v69
    v_dot2c_f32_bf16 v98, v41, v89
    v_dot2c_f32_bf16 v97, v45, v69
    v_dot2c_f32_bf16 v99, v45, v89
    v_dot2c_f32_bf16 v96, v42, v70
    v_dot2c_f32_bf16 v98, v42, v90
    v_dot2c_f32_bf16 v97, v46, v70
    v_dot2c_f32_bf16 v99, v46, v90
    v_dot2c_f32_bf16 v96, v43, v71
    v_dot2c_f32_bf16 v98, v43, v91
    v_dot2c_f32_bf16 v97, v47, v71
    v_dot2c_f32_bf16 v99, v47, v91
    s_waitcnt vmcnt(0) lgkmcnt(0)
    v_dot2c_f32_bf16 v96, v48, v72
    v_dot2c_f32_bf16 v98, v48, v92
    v_dot2c_f32_bf16 v97, v52, v72
    v_dot2c_f32_bf16 v99, v52, v92
    v_dot2c_f32_bf16 v96, v49, v73
    v_dot2c_f32_bf16 v98, v49, v93
    v_dot2c_f32_bf16 v97, v53, v73
    v_dot2c_f32_bf16 v99, v53, v93
    v_dot2c_f32_bf16 v96, v50, v74
    v_dot2c_f32_bf16 v98, v50, v94
    v_dot2c_f32_bf16 v97, v54, v74
    v_dot2c_f32_bf16 v99, v54, v94
    v_dot2c_f32_bf16 v96, v51, v75
    v_dot2c_f32_bf16 v98, v51, v95
    v_dot2c_f32_bf16 v97, v55, v75
    v_dot2c_f32_bf16 v99, v55, v95
    s_nop 2
    v_add_f32_dpp v96, v96, v96 quad_perm:[1,0,3,2] row_mask:0xf bank_mask:0xf
    v_add_f32_dpp v97, v97, v97 quad_perm:[1,0,3,2] row_mask:0xf bank_mask:0xf
    v_add_f32_dpp v98, v98, v98 quad_perm:[1,0,3,2] row_mask:0xf bank_mask:0xf
    v_add_f32_dpp v99, v99, v99 quad_perm:[1,0,3,2] row_mask:0xf bank_mask:0xf
    v_add_f32_dpp v96, v96, v96 quad_perm:[2,3,0,1] row_mask:0xf bank_mask:0xf
    v_add_f32_dpp v97, v97, v97 quad_perm:[2,3,0,1] row_mask:0xf bank_mask:0xf
    v_add_f32_dpp v98, v98, v98 quad_perm:[2,3,0,1] row_mask:0xf bank_mask:0xf
    v_add_f32_dpp v99, v99, v99 quad_perm:[2,3,0,1] row_mask:0xf bank_mask:0xf
    v_add_f32_dpp v96, v96, v96 row_half_mirror row_mask:0xf bank_mask:0xf
    v_add_f32_dpp v97, v97, v97 row_half_mirror row_mask:0xf bank_mask:0xf
    v_add_f32_dpp v98, v98, v98 row_half_mirror row_mask:0xf bank_mask:0xf
    v_add_f32_dpp v99, v99, v99 row_half_mirror row_mask:0xf bank_mask:0xf
    v_add_f32_dpp v96, v96, v96 row_mirror row_mask:0xf bank_mask:0xf
    v_add_f32_dpp v97, v97, v97 row_mirror row_mask:0xf bank_mask:0xf
    v_add_f32_dpp v98, v98, v98 row_mirror row_mask:0xf bank_mask:0xf
    v_add_f32_dpp v99, v99, v99 row_mirror row_mask:0xf bank_mask:0xf
    v_and_b32 v4, 31, v8
    v_lshlrev_b32 v11, 2, v4
    v_add_u32 v11, 122880, v11
    v_lshlrev_b32 v12, 1, v4
    v_add_u32 v12, 123008, v12
    v_cvt_pk_bf16_f32 v2, v96, v96
    v_lshlrev_b32 v2, 16, v2
    v_ashrrev_i32 v3, 31, v2
    v_or_b32 v3, 0x80000000, v3
    v_xor_b32 v2, v2, v3
    v_and_b32 v2, 0xffff0000, v2
    v_sub_u32 v3, 0x87ff, v8
    v_or_b32 v96, v2, v3
    ds_write_b32 v11, v96 offset:0
    v_cvt_pk_bf16_f32 v98, v98, v98
    v_lshlrev_b32 v98, 16, v98
    v_mul_f32 v5, 0xbfb8aa3b, v98
    v_exp_f32 v5, v5
    s_nop 0
    v_add_f32 v5, 1.0, v5
    v_rcp_f32 v98, v5
    s_nop 0
    v_cvt_pk_bf16_f32 v98, v98, v98
    v_or_b32 v98, 0x8000, v98
    ds_write_b16 v12, v98 offset:0
    v_cvt_pk_bf16_f32 v2, v97, v97
    v_lshlrev_b32 v2, 16, v2
    v_ashrrev_i32 v3, 31, v2
    v_or_b32 v3, 0x80000000, v3
    v_xor_b32 v2, v2, v3
    v_and_b32 v2, 0xffff0000, v2
    v_sub_u32 v3, 0x87fb, v8
    v_or_b32 v97, v2, v3
    ds_write_b32 v11, v97 offset:16
    v_cvt_pk_bf16_f32 v99, v99, v99
    v_lshlrev_b32 v99, 16, v99
    v_mul_f32 v5, 0xbfb8aa3b, v99
    v_exp_f32 v5, v5
    s_nop 0
    v_add_f32 v5, 1.0, v5
    v_rcp_f32 v99, v5
    s_nop 0
    v_cvt_pk_bf16_f32 v99, v99, v99
    v_or_b32 v99, 0x8000, v99
    ds_write_b16 v12, v99 offset:8
    v_mov_b32 v3, 1
    s_mov_b64 exec, 1
    ds_add_u32 v13, v3 offset:48
    s_mov_b64 exec, -1
    s_cmp_ge_u32 s30, 6
    s_cbranch_scc1 K_AUX_G1
    s_mov_b32 s3, 1048576
K_FGR:
    ds_read_b32 v2, v13 offset:48
    s_sleep 1
    s_sub_u32 s3, s3, 1
    s_waitcnt lgkmcnt(0)
    v_readfirstlane_b32 s33, v2
    s_nop 3
    s_cselect_b32 s33, 4, s33
    s_cmp_lt_u32 s33, 4
    s_cbranch_scc1 K_FGR
    s_cmp_lg_u32 s30, 4
    s_cbranch_scc1 K_AUX_G0
    v_and_b32 v3, 31, v1
    v_lshlrev_b32 v3, 2, v3
    v_add_u32 v3, 122880, v3
    ds_read_b32 v2, v3
    s_waitcnt lgkmcnt(0)
    s_nop 1
    v_max_u32_dpp v3, v2, v2 quad_perm:[1,0,3,2] row_mask:0xf bank_mask:0xf
    s_nop 1
    v_max_u32_dpp v3, v3, v3 quad_perm:[2,3,0,1] row_mask:0xf bank_mask:0xf
    s_nop 1
    v_max_u32_dpp v3, v3, v3 row_half_mirror row_mask:0xf bank_mask:0xf
    s_nop 1
    v_max_u32_dpp v3, v3, v3 row_mirror row_mask:0xf bank_mask:0xf
    s_nop 1
    v_readlane_b32 s68, v3, 0
    v_readlane_b32 s76, v3, 16
    v_readlane_b32 s77, v3, 32
    v_readlane_b32 s78, v3, 48
    s_nop 3
    s_max_u32 s68, s68, s76
    s_max_u32 s77, s77, s78
    s_max_u32 s68, s68, s77
    v_cmp_ne_u32 vcc, s68, v2
    s_nop 1
    v_cndmask_b32 v2, 0, v2, vcc
    s_nop 1
    v_max_u32_dpp v3, v2, v2 quad_perm:[1,0,3,2] row_mask:0xf bank_mask:0xf
    s_nop 1
    v_max_u32_dpp v3, v3, v3 quad_perm:[2,3,0,1] row_mask:0xf bank_mask:0xf
    s_nop 1
    v_max_u32_dpp v3, v3, v3 row_half_mirror row_mask:0xf bank_mask:0xf
    s_nop 1
    v_max_u32_dpp v3, v3, v3 row_mirror row_mask:0xf bank_mask:0xf
    s_nop 1
    v_readlane_b32 s69, v3, 0
    v_readlane_b32 s76, v3, 16
    v_readlane_b32 s77, v3, 32
    v_readlane_b32 s78, v3, 48
    s_nop 3
    s_max_u32 s69, s69, s76
    s_max_u32 s77, s77, s78
    s_max_u32 s69, s69, s77
    s_load_dword s33, s[4:5], 0
    s_waitcnt lgkmcnt(0)
    s_cmp_ge_u32 s33, 1
    s_cbranch_scc1 K_ZO3
    s_sleep 8
    s_load_dword s33, s[4:5], 64
    s_waitcnt lgkmcnt(0)
    s_cmp_ge_u32 s33, 1
    s_cbranch_scc1 K_ZO3
    s_sleep 8
    s_mov_b32 s3, 16384
K_ZB3:
    v_mov_b32 v4, 0
    global_load_dword v4, v4, s[4:5] sc1
    s_waitcnt vmcnt(0)
    v_readfirstlane_b32 s33, v4
    s_cmp_ge_u32 s33, 1
    s_cbranch_scc1 K_ZO3
    s_sleep 8
    s_sub_u32 s3, s3, 1
    s_cbranch_scc0 K_ZB3
K_ZO3:
    s_lshl_b32 s3, s2, 3
    s_add_u32 s3, s3, 606208
    s_atomic_add_x2 s[68:69], s[6:7], s3
    s_cmp_lg_u32 s2, 63
    s_cbranch_scc1 K_AUX_G1
    s_mov_b32 s70, 81920
    v_lshlrev_b32 v3, 3, v1
    s_mov_b32 s3, 131072
K_AUX_POLL:
    buffer_load_dwordx2 v[176:177], v3, s[64:67], s70 offen sc1
    s_waitcnt vmcnt(0)
    v_min_u32 v2, v176, v177
    v_cmp_eq_u32 vcc, 0, v2
    s_cbranch_vccz K_AUX_GOT
    s_sleep 2
    s_sub_u32 s3, s3, 1
    s_cmp_lg_u32 s3, 0
    s_cbranch_scc1 K_AUX_POLL
K_AUX_GOT:
    s_waitcnt lgkmcnt(0)
    s_nop 1
    v_max_u32_dpp v3, v176, v176 quad_perm:[1,0,3,2] row_mask:0xf bank_mask:0xf
    s_nop 1
    v_max_u32_dpp v3, v3, v3 quad_perm:[2,3,0,1] row_mask:0xf bank_mask:0xf
    s_nop 1
    v_max_u32_dpp v3, v3, v3 row_half_mirror row_mask:0xf bank_mask:0xf
    s_nop 1
    v_max_u32_dpp v3, v3, v3 row_mirror row_mask:0xf bank_mask:0xf
    s_nop 1
    v_readlane_b32 s68, v3, 0
    v_readlane_b32 s76, v3, 16
    v_readlane_b32 s77, v3, 32
    v_readlane_b32 s78, v3, 48
    s_nop 3
    s_max_u32 s68, s68, s76
    s_max_u32 s77, s77, s78
    s_max_u32 s68, s68, s77
    v_cmp_ne_u32 vcc, s68, v176
    s_nop 1
    v_cndmask_b32 v2, v177, v176, vcc
    s_nop 1
    v_max_u32_dpp v3, v2, v2 quad_perm:[1,0,3,2] row_mask:0xf bank_mask:0xf
    s_nop 1
    v_max_u32_dpp v3, v3, v3 quad_perm:[2,3,0,1] row_mask:0xf bank_mask:0xf
    s_nop 1
    v_max_u32_dpp v3, v3, v3 row_half_mirror row_mask:0xf bank_mask:0xf
    s_nop 1
    v_max_u32_dpp v3, v3, v3 row_mirror row_mask:0xf bank_mask:0xf
    s_nop 1
    v_readlane_b32 s69, v3, 0
    v_readlane_b32 s76, v3, 16
    v_readlane_b32 s77, v3, 32
    v_readlane_b32 s78, v3, 48
    s_nop 3
    s_max_u32 s69, s69, s76
    s_max_u32 s77, s77, s78
    s_max_u32 s69, s69, s77
    v_mov_b32 v176, s68
    v_mov_b32 v177, s69
    s_mov_b32 s3, 1048576
K_FGZ:
    ds_read_b32 v2, v13 offset:36
    s_sleep 1
    s_sub_u32 s3, s3, 1
    s_waitcnt lgkmcnt(0)
    v_readfirstlane_b32 s33, v2
    s_nop 3
    s_cselect_b32 s33, 1, s33
    s_cmp_lt_u32 s33, 1
    s_cbranch_scc1 K_FGZ
    v_lshlrev_b32 v3, 9, v1
    s_mov_b32 s66, 81920
    s_mov_b32 s70, 0
    buffer_store_dwordx2 v[176:177], v3, s[64:67], s70 offen offset:128 sc1
    s_mov_b32 s70, 32768
    buffer_store_dwordx2 v[176:177], v3, s[64:67], s70 offen offset:128 sc1
    s_mov_b32 s70, 65536
    buffer_store_dwordx2 v[176:177], v3, s[64:67], s70 offen offset:128 sc1
    v_mov_b32 v3, 16
    ds_write_b32 v13, v3 offset:48
    s_branch K_AUX_G1
K_AUX_G0:
    v_and_b32 v3, 3, v1
    v_lshlrev_b32 v3, 4, v3
    v_add_u32 v2, 123008, v3
    ds_read_b128 v[176:179], v2
    v_lshrrev_b32 v2, 2, v1
    v_lshl_add_u32 v3, v2, 9, v3
    s_sleep 12
    s_load_dword s33, s[4:5], 128
    s_waitcnt lgkmcnt(0)
    s_cmp_ge_u32 s33, 8
    s_cbranch_scc1 K_ZO4
    s_sleep 8
    s_mov_b32 s3, 16384
K_ZB4:
    v_mov_b32 v4, 128
    global_load_dword v4, v4, s[4:5] sc1
    s_waitcnt vmcnt(0)
    v_readfirstlane_b32 s33, v4
    s_cmp_ge_u32 s33, 8
    s_cbranch_scc1 K_ZO4
    s_sleep 8
    s_sub_u32 s3, s3, 1
    s_cbranch_scc0 K_ZB4
K_ZO4:
    v_mov_b32 v2, 1
    ds_write_b32 v13, v2 offset:36
    s_lshr_b32 s3, s29, 2
    s_lshl1_add_u32 s3, s28, s3
    s_mul_i32 s3, s3, 5120
    s_and_b32 s70, s29, 3
    s_lshl_b32 s70, s70, 6
    s_add_u32 s3, s3, s70
    s_mov_b32 exec_hi, 0xff
    s_waitcnt lgkmcnt(0)
    buffer_store_dwordx4 v[176:179], v3, s[64:67], s3 offen offset:256 sc1
    s_mov_b64 exec, -1
K_AUX_G1:
    s_cmp_lg_u32 s43, 63
    s_cbranch_scc1 K_FFN_C
    s_cmp_lg_u32 s29, 0
    s_cbranch_scc1 K_AUX_NT
    s_lshl2_add_u32 s3, s28, s30
    s_sub_u32 s3, s3, 4
    s_mul_i32 s3, s3, 25600
    v_lshlrev_b32 v2, 7, v1
    buffer_load_dword v5, v2, s[24:27], s3 offen
    s_add_u32 s3, s3, 8192
    buffer_load_dword v5, v2, s[24:27], s3 offen
    s_add_u32 s3, s3, 8192
    buffer_load_dword v5, v2, s[24:27], s3 offen
    s_add_u32 s3, s3, 8192
    s_mov_b64 exec, 0xff
    buffer_load_dword v5, v2, s[24:27], s3 offen
    s_add_u32 s3, s3, 8192
    s_mov_b64 exec, -1
K_AUX_NT:
    s_mov_b32 s3, 1048576
K_FGZ2:
    ds_read_b32 v2, v13 offset:36
    s_sleep 1
    s_sub_u32 s3, s3, 1
    s_waitcnt lgkmcnt(0)
    v_readfirstlane_b32 s33, v2
    s_nop 3
    s_cselect_b32 s33, 1, s33
    s_cmp_lt_u32 s33, 1
    s_cbranch_scc1 K_FGZ2
    s_waitcnt vmcnt(0)
    s_branch K_P2
K_AUX_L:
    v_and_b32 v1, 63, v0
    v_mov_b32 v7, 0
    s_and_b32 s28, s2, 7
    s_lshr_b32 s29, s2, 3
    s_xor_b32 s30, s30, 4
    s_lshr_b32 s34, s29, 3
    s_lshl_b32 s34, s34, 2
    s_and_b32 s3, s29, 3
    s_add_u32 s34, s34, s3
    s_add_u32 s34, s34, 4
    s_bitcmp1_b32 s29, 2
    s_cselect_b32 s34, -1, s34
    s_cmp_lt_u32 s29, 8
    s_cselect_b32 s34, s29, s34
    s_lshl_b32 s40, s28, 1
    s_cmp_ge_u32 s34, 10
    s_addc_u32 s40, s40, 0
    s_sub_u32 s41, s34, 10
    s_cmp_ge_u32 s34, 10
    s_cselect_b32 s41, s41, s34
    s_mul_i32 s42, s28, 20
    s_add_u32 s42, s42, s34
    s_and_b32 s42, s42, 255
    s_lshl_b32 s42, s42, 9
    s_add_u32 s42, s42, 524288
    s_mul_i32 s43, s28, 7
    s_add_u32 s43, s43, s29
    s_sub_u32 s43, s43, 1
    s_cmp_lt_u32 s43, 54
    s_cselect_b32 s43, s43, 63
    s_cmp_eq_u32 s29, 0
    s_cselect_b32 s43, 63, s43
    v_mov_b32 v3, 158736
    ds_write2_b32 v3, v7, v7 offset0:0 offset1:1
    ds_write2_b32 v3, v7, v7 offset0:2 offset1:3
    ds_write2_b32 v3, v7, v7 offset0:4 offset1:5
    ds_write2_b32 v3, v7, v7 offset0:6 offset1:7
    ds_write2_b32 v3, v7, v7 offset0:8 offset1:9
    ds_write2_b32 v3, v7, v7 offset0:10 offset1:11
    v_lshrrev_b32 v3, 2, v1
    v_mul_u32_u24 v11, 3456, v3
    v_lshrrev_b32 v3, 4, v1
    v_and_b32 v3, 2, v3
    v_xor_b32 v3, v3, v1
    v_and_b32 v3, 3, v3
    v_lshl_add_u32 v11, v3, 4, v11
    s_mul_i32 s3, s30, 552960
    s_lshl_b32 s70, s43, 6
    s_add_u32 s3, s3, s70
    v_add_u32 v11, s3, v11
    s_mul_i32 s68, s30, 10240
    s_add_u32 s72, s68, 40960
    s_bitcmp1_b32 s43, 0
    s_cselect_b32 s71, s72, s68
    s_cselect_b32 s72, s68, s72
    v_lshlrev_b32 v8, 4, v1
    s_waitcnt lgkmcnt(0)
    s_barrier
    s_mov_b32 s24, s8
    s_mov_b32 s25, s9
    s_mov_b32 s26, 0xc8000
    s_mov_b32 s27, 0x20000
    s_cmp_lg_u32 s43, 63
    s_cbranch_scc1 K_AUX_FFN1
    s_cmp_lg_u32 s30, 0
    s_cbranch_scc1 K_AUX_NR
    s_cmp_eq_u32 s2, 55
    s_cbranch_scc1 K_AUX_NR
    s_cmp_eq_u32 s2, 63
    s_cselect_b32 s70, 0, 128
    s_mov_b32 s3, 1
    s_waitcnt vmcnt(0)
    s_atomic_add s3, s[4:5], s70
    s_atomic_add s3, s[4:5], s70 offset:64
    s_waitcnt lgkmcnt(0)
K_AUX_NR:
    v_mov_b32 v13, 158720
    s_mov_b32 s3, 1048576
K_FGZ3:
    ds_read_b32 v2, v13 offset:36
    s_sleep 1
    s_sub_u32 s3, s3, 1
    s_waitcnt lgkmcnt(0)
    v_readfirstlane_b32 s33, v2
    s_nop 3
    s_cselect_b32 s33, 1, s33
    s_cmp_lt_u32 s33, 1
    s_cbranch_scc1 K_FGZ3
    s_cmp_lg_u32 s2, 63
    s_cbranch_scc1 K_AUX_NH
    s_mov_b32 s3, 1048576
K_FGH:
    ds_read_b32 v2, v13 offset:48
    s_sleep 1
    s_sub_u32 s3, s3, 1
    s_waitcnt lgkmcnt(0)
    v_readfirstlane_b32 s33, v2
    s_nop 3
    s_cselect_b32 s33, 16, s33
    s_cmp_lt_u32 s33, 16
    s_cbranch_scc1 K_FGH
K_AUX_NH:
    s_branch K_P2
K_AUX_FFN1:
    s_bitcmp1_b32 s43, 0
    s_cselect_b64 s[56:57], s[48:49], s[46:47]
    s_cselect_b64 s[60:61], s[46:47], s[48:49]
    s_mov_b32 s58, 2211840
    s_mov_b32 s59, 0x20000
    s_mov_b32 s62, 2211840
    s_mov_b32 s63, 0x20000
    s_add_u32 m0, s71, 0
    s_mov_b32 s70, 0
    buffer_load_dwordx4 v11, s[56:59], s70 offen  lds
    s_add_u32 m0, s71, 1024
    s_mov_b32 s70, 55296
    buffer_load_dwordx4 v11, s[56:59], s70 offen  lds
    s_add_u32 m0, s71, 2048
    s_mov_b32 s70, 110592
    buffer_load_dwordx4 v11, s[56:59], s70 offen  lds
    s_add_u32 m0, s71, 3072
    s_mov_b32 s70, 165888
    buffer_load_dwordx4 v11, s[56:59], s70 offen  lds
    s_add_u32 m0, s71, 4096
    s_mov_b32 s70, 221184
    buffer_load_dwordx4 v11, s[56:59], s70 offen  lds
    s_add_u32 m0, s71, 5120
    s_mov_b32 s70, 276480
    buffer_load_dwordx4 v11, s[56:59], s70 offen  lds
    s_add_u32 m0, s71, 6144
    s_mov_b32 s70, 331776
    buffer_load_dwordx4 v11, s[56:59], s70 offen  lds
    s_add_u32 m0, s71, 7168
    s_mov_b32 s70, 387072
    buffer_load_dwordx4 v11, s[56:59], s70 offen  lds
    s_add_u32 m0, s71, 8192
    s_mov_b32 s70, 442368
    buffer_load_dwordx4 v11, s[56:59], s70 offen  lds
    s_add_u32 m0, s71, 9216
    s_mov_b32 s70, 497664
    buffer_load_dwordx4 v11, s[56:59], s70 offen  lds
    s_add_u32 m0, s72, 0
    s_mov_b32 s70, 0
    buffer_load_dwordx4 v11, s[60:63], s70 offen  lds
    s_add_u32 m0, s72, 1024
    s_mov_b32 s70, 55296
    buffer_load_dwordx4 v11, s[60:63], s70 offen  lds
    s_add_u32 m0, s72, 2048
    s_mov_b32 s70, 110592
    buffer_load_dwordx4 v11, s[60:63], s70 offen  lds
    s_add_u32 m0, s72, 3072
    s_mov_b32 s70, 165888
    buffer_load_dwordx4 v11, s[60:63], s70 offen  lds
    s_add_u32 m0, s72, 4096
    s_mov_b32 s70, 221184
    buffer_load_dwordx4 v11, s[60:63], s70 offen  lds
    s_add_u32 m0, s72, 5120
    s_mov_b32 s70, 276480
    buffer_load_dwordx4 v11, s[60:63], s70 offen  lds
    s_add_u32 m0, s72, 6144
    s_mov_b32 s70, 331776
    buffer_load_dwordx4 v11, s[60:63], s70 offen  lds
    s_add_u32 m0, s72, 7168
    s_mov_b32 s70, 387072
    buffer_load_dwordx4 v11, s[60:63], s70 offen  lds
    s_add_u32 m0, s72, 8192
    s_mov_b32 s70, 442368
    buffer_load_dwordx4 v11, s[60:63], s70 offen  lds
    s_add_u32 m0, s72, 9216
    s_mov_b32 s70, 497664
    buffer_load_dwordx4 v11, s[60:63], s70 offen  lds
    s_mov_b32 s64, s50
    s_mov_b32 s65, s51
    s_mov_b32 s66, 0x21c000
    s_mov_b32 s67, 0x20000
    s_mul_i32 s3, s43, 40960
    s_add_u32 s3, s3, s68
    v_lshrrev_b32 v2, 3, v1
    v_and_b32 v3, 2, v2
    s_lshl_b32 s70, s30, 2
    v_xor_b32 v3, s70, v3
    v_xor_b32 v3, v3, v1
    v_and_b32 v3, 7, v3
    v_mul_u32_u24 v2, 1280, v2
    v_lshl_add_u32 v2, v3, 4, v2
    v_add_u32 v12, s3, v2
    s_add_u32 m0, s68, 81920
    s_mov_b32 s70, 0
    buffer_load_dwordx4 v12, s[64:67], s70 offen  lds
    s_add_u32 m0, s68, 82944
    s_mov_b32 s70, 128
    buffer_load_dwordx4 v12, s[64:67], s70 offen  lds
    s_add_u32 m0, s68, 83968
    s_mov_b32 s70, 256
    buffer_load_dwordx4 v12, s[64:67], s70 offen  lds
    s_add_u32 m0, s68, 84992
    s_mov_b32 s70, 384
    buffer_load_dwordx4 v12, s[64:67], s70 offen  lds
    s_add_u32 m0, s68, 86016
    s_mov_b32 s70, 512
    buffer_load_dwordx4 v12, s[64:67], s70 offen  lds
    s_add_u32 m0, s68, 87040
    s_mov_b32 s70, 640
    buffer_load_dwordx4 v12, s[64:67], s70 offen  lds
    s_add_u32 m0, s68, 88064
    s_mov_b32 s70, 768
    buffer_load_dwordx4 v12, s[64:67], s70 offen  lds
    s_add_u32 m0, s68, 89088
    s_mov_b32 s70, 896
    buffer_load_dwordx4 v12, s[64:67], s70 offen  lds
    s_add_u32 m0, s68, 90112
    s_mov_b32 s70, 1024
    buffer_load_dwordx4 v12, s[64:67], s70 offen  lds
    s_add_u32 m0, s68, 91136
    s_mov_b32 s70, 1152
    buffer_load_dwordx4 v12, s[64:67], s70 offen  lds
    s_waitcnt vmcnt(10)
    s_barrier
    s_branch K_P2_EARLY
K_FFN_C:
    v_lshrrev_b32 v180, 4, v1
    v_bfe_u32 v2, v1, 2, 2
    v_lshl_add_u32 v2, v180, 3, v2
    v_and_b32 v3, 3, v1
    v_lshlrev_b32 v3, 3, v3
    v_lshl_add_u32 v181, v2, 6, v3
    s_bfe_u32 s3, s30, 0x10001
    s_mul_i32 s3, s3, 40960
    v_xor_b32 v4, s30, v180
    v_and_b32 v4, 1, v4
    v_lshl_add_u32 v181, v4, 5, v181
    v_add_u32 v181, s3, v181
    v_bfe_u32 v4, v1, 3, 2
    v_xor_b32 v4, s30, v4
    v_and_b32 v4, 3, v4
    v_lshl_add_u32 v3, v4, 5, v3
    v_and_b32 v2, 3, v2
    v_lshl_add_u32 v3, v2, 7, v3
    v_mul_u32_u24 v182, 10240, v180
    s_mov_b32 s3, 81920
    v_add3_u32 v182, v182, v3, s3
    v_mov_b32 v183, 123904
    s_cmp_lg_u32 s30, 5
    s_cbranch_scc1 K_KW
    s_mov_b32 s3, 131072
K_KPOLL:
    s_load_dwordx2 s[68:69], s[6:7], s42 offset:128 glc
    s_waitcnt lgkmcnt(0)
    s_min_u32 s33, s68, s69
    s_cmp_lg_u32 s33, 0
    s_cbranch_scc1 K_KGOT
    s_sleep 2
    s_sub_u32 s3, s3, 1
    s_cbranch_scc0 K_KPOLL
K_KGOT:
    v_mov_b32 v176, s68
    v_mov_b32 v177, s69
    ds_write_b64 v183, v[176:177]
    v_lshlrev_b32 v2, 4, v1
    s_and_b32 s70, s68, 0x7ff
    s_sub_u32 s70, 2047, s70
    s_mul_i32 s70, s70, 1280
    s_mov_b32 m0, 134208
    s_mov_b64 exec, -1
    buffer_load_dwordx4 v2, s[12:15], s70 offen lds
    s_mov_b64 exec, 0xffff
    buffer_load_dwordx4 v2, s[12:15], s70 offen offset:1024 lds
    s_and_b32 s70, s69, 0x7ff
    s_sub_u32 s70, 2047, s70
    s_mul_i32 s70, s70, 1280
    s_mov_b32 m0, 135552
    s_mov_b64 exec, -1
    buffer_load_dwordx4 v2, s[12:15], s70 offen lds
    s_mov_b64 exec, 0xffff
    buffer_load_dwordx4 v2, s[12:15], s70 offen offset:1024 lds
    s_mov_b64 exec, -1
    v_mov_b32 v3, 16
    s_waitcnt vmcnt(0)
    ds_write_b32 v13, v3 offset:48
    s_branch K_KW2
K_KW:
    s_cmp_lt_u32 s30, 6
    s_cbranch_scc1 K_KW2
    s_cmp_eq_u32 s30, 6
    s_cbranch_scc1 K_CHF0
    s_branch K_CHF1
K_WRET_F:
K_KW2:
    s_branch K_J7d6c
K_CHF0:
K_STF16:
    s_branch K_STF18
    s_nop 0
K_J7d6c:
    v_and_b32 v2, 1, v1
    v_mul_u32_u24 v9, 1344, v2
    v_lshl_add_u32 v9, v180, 4, v9
    v_add_u32 v9, 134208, v9
    v_and_b32 v2, 1, v1
    v_lshlrev_b32 v192, 6, v2
    v_lshl_add_u32 v192, v180, 4, v192
    s_and_b32 s3, s30, 3
    s_lshl_b32 s3, s3, 7
    v_add3_u32 v193, v192, s3, v183
    v_add_u32 v192, 64, v193
    v_add_u32 v193, 1088, v193
    v_lshrrev_b32 v2, 5, v1
    v_bfe_u32 v3, v1, 4, 1
    v_lshl_add_u32 v3, v3, 1, v2
    v_lshlrev_b32 v3, 6, v3
    v_and_b32 v4, 15, v1
    v_lshl_add_u32 v3, v4, 2, v3
    v_add_u32 v194, 123968, v3
    v_lshlrev_b32 v4, 1, v1
    s_add_u32 s3, s3, 124992
    v_add_u32 v195, s3, v4
    v_and_b32 v2, 1, v1
    v_mul_u32_u24 v2, 2560, v2
    v_lshl_add_u32 v196, v180, 4, v2
    s_lshl_b32 s70, s30, 6
    s_add_u32 s70, s70, 125760
    v_add_u32 v196, s70, v196
    v_mov_b32 v3, 1
    s_mov_b32 s3, 1048576
K_FGK:
    ds_read_b32 v2, v13 offset:48
    s_sleep 1
    s_sub_u32 s3, s3, 1
    s_waitcnt lgkmcnt(0)
    v_readfirstlane_b32 s33, v2
    s_nop 3
    s_cselect_b32 s33, 16, s33
    s_cmp_lt_u32 s33, 16
    s_cbranch_scc1 K_FGK
    ds_read_b128 v[96:99], v9 offset:0
    ds_read_b128 v[100:103], v9 offset:64
    ds_read_b128 v[104:107], v9 offset:128
    ds_read_b128 v[108:111], v9 offset:192
    ds_read_b128 v[112:115], v9 offset:256
    ds_read_b128 v[116:119], v9 offset:320
    ds_read_b128 v[120:123], v9 offset:384
    ds_read_b128 v[124:127], v9 offset:448
    ds_read_b128 v[128:131], v9 offset:512
    ds_read_b128 v[132:135], v9 offset:576
    ds_read_b128 v[136:139], v9 offset:640
    ds_read_b128 v[140:143], v9 offset:704
    ds_read_b128 v[144:147], v9 offset:768
    ds_read_b128 v[148:151], v9 offset:832
    ds_read_b128 v[152:155], v9 offset:896
    ds_read_b128 v[156:159], v9 offset:960
    ds_read_b128 v[160:163], v9 offset:1024
    ds_read_b128 v[164:167], v9 offset:1088
    ds_read_b128 v[168:171], v9 offset:1152
    ds_read_b128 v[172:175], v9 offset:1216
    s_setprio 3
    s_barrier
    ds_read_b64_tr_b16 v[16:17], v181 offset:0
    ds_read_b64_tr_b16 v[18:19], v181 offset:256
    ds_read_b64_tr_b16 v[20:21], v181 offset:2048
    ds_read_b64_tr_b16 v[22:23], v181 offset:2304
    ds_read_b64_tr_b16 v[24:25], v181 offset:4096
    ds_read_b64_tr_b16 v[26:27], v181 offset:4352
    ds_read_b64_tr_b16 v[28:29], v181 offset:6144
    ds_read_b64_tr_b16 v[30:31], v181 offset:6400
    ds_read_b64_tr_b16 v[32:33], v181 offset:8192
    ds_read_b64_tr_b16 v[34:35], v181 offset:8448
    ds_read_b64_tr_b16 v[36:37], v181 offset:10240
    ds_read_b64_tr_b16 v[38:39], v181 offset:10496
    ds_read_b64_tr_b16 v[40:41], v181 offset:12288
    ds_read_b64_tr_b16 v[42:43], v181 offset:12544
    ds_read_b64_tr_b16 v[44:45], v181 offset:14336
    ds_read_b64_tr_b16 v[46:47], v181 offset:14592
    ds_read_b64_tr_b16 v[48:49], v181 offset:16384
    ds_read_b64_tr_b16 v[50:51], v181 offset:16640
    ds_read_b64_tr_b16 v[52:53], v181 offset:18432
    ds_read_b64_tr_b16 v[54:55], v181 offset:18688
    ds_read_b64_tr_b16 v[56:57], v181 offset:20480
    ds_read_b64_tr_b16 v[58:59], v181 offset:20736
    ds_read_b64_tr_b16 v[60:61], v181 offset:22528
    ds_read_b64_tr_b16 v[62:63], v181 offset:22784
    ds_read_b64_tr_b16 v[64:65], v181 offset:24576
    ds_read_b64_tr_b16 v[66:67], v181 offset:24832
    ds_read_b64_tr_b16 v[68:69], v181 offset:26624
    ds_read_b64_tr_b16 v[70:71], v181 offset:26880
    ds_read_b64_tr_b16 v[72:73], v181 offset:28672
    ds_read_b64_tr_b16 v[74:75], v181 offset:28928
    ds_read_b64_tr_b16 v[76:77], v181 offset:30720
    ds_read_b64_tr_b16 v[78:79], v181 offset:30976
    s_branch K_PG7
.p2align 12
K_CHF1:
K_STF17:
    s_branch K_WRET_F
    s_nop 0
K_PG7:
    ds_read_b64_tr_b16 v[80:81], v181 offset:32768
    ds_read_b64_tr_b16 v[82:83], v181 offset:33024
    ds_read_b64_tr_b16 v[84:85], v181 offset:34816
    ds_read_b64_tr_b16 v[86:87], v181 offset:35072
    ds_read_b64_tr_b16 v[88:89], v181 offset:36864
    ds_read_b64_tr_b16 v[90:91], v181 offset:37120
    ds_read_b64_tr_b16 v[92:93], v181 offset:38912
    ds_read_b64_tr_b16 v[94:95], v181 offset:39168
    s_waitcnt lgkmcnt(0)
    s_barrier
    v_mfma_f32_16x16x32_bf16 v[184:187], v[16:19], v[96:99], 0
    v_mfma_f32_16x16x32_bf16 v[188:191], v[20:23], v[100:103], 0
    v_mfma_f32_16x16x32_bf16 v[184:187], v[24:27], v[104:107], v[184:187]
    v_mfma_f32_16x16x32_bf16 v[188:191], v[28:31], v[108:111], v[188:191]
    v_mfma_f32_16x16x32_bf16 v[184:187], v[32:35], v[112:115], v[184:187]
    v_mfma_f32_16x16x32_bf16 v[188:191], v[36:39], v[116:119], v[188:191]
    v_mfma_f32_16x16x32_bf16 v[184:187], v[40:43], v[120:123], v[184:187]
    v_mfma_f32_16x16x32_bf16 v[188:191], v[44:47], v[124:127], v[188:191]
    v_mfma_f32_16x16x32_bf16 v[184:187], v[48:51], v[128:131], v[184:187]
    v_mfma_f32_16x16x32_bf16 v[188:191], v[52:55], v[132:135], v[188:191]
    v_mfma_f32_16x16x32_bf16 v[184:187], v[56:59], v[136:139], v[184:187]
    v_mfma_f32_16x16x32_bf16 v[188:191], v[60:63], v[140:143], v[188:191]
    v_mfma_f32_16x16x32_bf16 v[184:187], v[64:67], v[144:147], v[184:187]
    v_mfma_f32_16x16x32_bf16 v[188:191], v[68:71], v[148:151], v[188:191]
    v_mfma_f32_16x16x32_bf16 v[184:187], v[72:75], v[152:155], v[184:187]
    v_mfma_f32_16x16x32_bf16 v[188:191], v[76:79], v[156:159], v[188:191]
    v_mfma_f32_16x16x32_bf16 v[184:187], v[80:83], v[160:163], v[184:187]
    v_mfma_f32_16x16x32_bf16 v[188:191], v[84:87], v[164:167], v[188:191]
    v_mfma_f32_16x16x32_bf16 v[184:187], v[88:91], v[168:171], v[184:187]
    v_mfma_f32_16x16x32_bf16 v[188:191], v[92:95], v[172:175], v[188:191]
    s_nop 7
    v_add_f32 v184, v184, v188
    v_add_f32 v185, v185, v189
    v_add_f32 v186, v186, v190
    v_add_f32 v187, v187, v191
    s_mov_b32 exec_lo, 0x00030003
    s_mov_b32 exec_hi, 0x00030003
    ds_write_b128 v192, v[184:187]
    s_mov_b64 exec, 1
    ds_add_u32 v13, v3 offset:52
    s_mov_b64 exec, -1
    s_cmp_lg_u32 s30, 6
    s_cbranch_scc1 K_NOS6B
    v_lshl_add_u32 v4, v1, 2, s42
    global_load_dword v7, v4, s[6:7] offset:256 sc1
    v_and_b32 v4, 0xfffffe04, v4
    global_load_dword v6, v4, s[6:7] offset:128 sc1
K_NOS6B:
    s_mov_b32 s3, 1048576
K_FGP:
    ds_read_b32 v2, v13 offset:52
    s_sleep 1
    s_sub_u32 s3, s3, 1
    s_waitcnt lgkmcnt(0)
    v_readfirstlane_b32 s33, v2
    s_nop 3
    s_cselect_b32 s33, 8, s33
    s_cmp_lt_u32 s33, 8
    s_cbranch_scc1 K_FGP
    ds_read_b32 v200, v194
    ds_read_b32 v202, v194 offset:256
    ds_read_b64_tr_b16 v[16:17], v182 offset:0
    ds_read_b64_tr_b16 v[18:19], v182 offset:512
    ds_read_b64_tr_b16 v[20:21], v182 offset:1024
    ds_read_b64_tr_b16 v[22:23], v182 offset:1536
    ds_read_b64_tr_b16 v[24:25], v182 offset:2048
    ds_read_b64_tr_b16 v[26:27], v182 offset:2560
    ds_read_b64_tr_b16 v[28:29], v182 offset:3072
    ds_read_b64_tr_b16 v[30:31], v182 offset:3584
    ds_read_b64_tr_b16 v[32:33], v182 offset:4096
    ds_read_b64_tr_b16 v[34:35], v182 offset:4608
    ds_read_b64_tr_b16 v[36:37], v182 offset:5120
    ds_read_b64_tr_b16 v[38:39], v182 offset:5632
    ds_read_b64_tr_b16 v[40:41], v182 offset:6144
    ds_read_b64_tr_b16 v[42:43], v182 offset:6656
    s_waitcnt lgkmcnt(14)
    v_cvt_pk_bf16_f32 v200, v200, v200
    v_lshlrev_b32 v200, 16, v200
    v_cvt_pk_bf16_f32 v202, v202, v202
    v_lshlrev_b32 v202, 16, v202
    v_mul_f32 v201, 0xbfb8aa3b, v200
    v_exp_f32 v201, v201
    s_nop 0
    v_add_f32 v201, 1.0, v201
    v_rcp_f32 v201, v201
    s_nop 0
    v_mul_f32 v200, v200, v201
    v_cvt_pk_bf16_f32 v200, v200, v200
    v_lshlrev_b32 v200, 16, v200
    v_mul_f32 v200, v200, v202
    v_cvt_pk_bf16_f32 v200, v200, v200
    ds_write_b16 v195, v200
    s_waitcnt lgkmcnt(0)
    ds_read_b128 v[200:203], v193
    ds_read_b64_tr_b16 v[44:45], v182 offset:7168
    ds_read_b64_tr_b16 v[46:47], v182 offset:7680
    ds_read_b64_tr_b16 v[48:49], v182 offset:8192
    ds_read_b64_tr_b16 v[50:51], v182 offset:8704
    ds_read_b64_tr_b16 v[52:53], v182 offset:9216
    ds_read_b64_tr_b16 v[54:55], v182 offset:9728
    s_waitcnt lgkmcnt(6)
    v_mfma_f32_16x16x32_bf16 v[96:99], v[16:19], v[200:203], 0
    v_mfma_f32_16x16x32_bf16 v[100:103], v[20:23], v[200:203], 0
    v_mfma_f32_16x16x32_bf16 v[104:107], v[24:27], v[200:203], 0
    v_mfma_f32_16x16x32_bf16 v[108:111], v[28:31], v[200:203], 0
    v_mfma_f32_16x16x32_bf16 v[112:115], v[32:35], v[200:203], 0
    v_mfma_f32_16x16x32_bf16 v[116:119], v[36:39], v[200:203], 0
    v_mfma_f32_16x16x32_bf16 v[120:123], v[40:43], v[200:203], 0
    s_waitcnt lgkmcnt(4)
    v_mfma_f32_16x16x32_bf16 v[124:127], v[44:47], v[200:203], 0
    s_waitcnt lgkmcnt(2)
    v_mfma_f32_16x16x32_bf16 v[128:131], v[48:51], v[200:203], 0
    s_waitcnt lgkmcnt(0)
    v_mfma_f32_16x16x32_bf16 v[132:135], v[52:55], v[200:203], 0
    s_mov_b32 exec_lo, 0x00030003
    s_mov_b32 exec_hi, 0x00030003
    ds_write_b128 v196, v[96:99] offset:0
    ds_write_b128 v196, v[100:103] offset:256
    ds_write_b128 v196, v[104:107] offset:512
    ds_write_b128 v196, v[108:111] offset:768
    ds_write_b128 v196, v[112:115] offset:1024
    ds_write_b128 v196, v[116:119] offset:1280
    ds_write_b128 v196, v[120:123] offset:1536
    ds_write_b128 v196, v[124:127] offset:1792
    ds_write_b128 v196, v[128:131] offset:2048
    ds_write_b128 v196, v[132:135] offset:2304
    v_mov_b32 v3, 1
    s_mov_b64 exec, 1
    ds_add_u32 v13, v3 offset:52
    s_mov_b64 exec, -1
    s_cmp_lg_u32 s30, 4
    s_cbranch_scc1 K_P2
    v_lshlrev_b32 v3, 4, v1
    v_add_u32 v4, 126016, v3
    s_mul_i32 s70, s43, 5120
    s_add_u32 s71, s70, 4096
    s_mov_b32 s3, 1048576
K_FGQ:
    ds_read_b32 v2, v13 offset:52
    s_sleep 1
    s_sub_u32 s3, s3, 1
    s_waitcnt lgkmcnt(0)
    v_readfirstlane_b32 s33, v2
    s_nop 3
    s_cselect_b32 s33, 12, s33
    s_cmp_lt_u32 s33, 12
    s_cbranch_scc1 K_FGQ
    ds_read_b128 v[16:19], v4 offset:0
    s_branch K_J83cc
K_STF18:
    s_branch K_WRET_F
    s_nop 0
K_J83cc:
    ds_read_b128 v[20:23], v4 offset:1024
    ds_read_b128 v[24:27], v4 offset:2048
    ds_read_b128 v[28:31], v4 offset:3072
    ds_read_b128 v[32:35], v4 offset:4096
    s_waitcnt lgkmcnt(4)
    buffer_store_dwordx4 v[16:19], v3, s[60:63], s70 offen offset:0 sc1
    s_waitcnt lgkmcnt(3)
    buffer_store_dwordx4 v[20:23], v3, s[60:63], s70 offen offset:1024 sc1
    s_waitcnt lgkmcnt(2)
    buffer_store_dwordx4 v[24:27], v3, s[60:63], s70 offen offset:2048 sc1
    s_waitcnt lgkmcnt(1)
    buffer_store_dwordx4 v[28:31], v3, s[60:63], s70 offen offset:3072 sc1
    s_waitcnt lgkmcnt(0)
    buffer_store_dwordx4 v[32:35], v3, s[60:63], s71 offen offset:0 sc1
    s_mov_b32 s3, 1
    s_waitcnt vmcnt(0)
    s_atomic_add s3, s[6:7], 606720 glc
    ds_read_b64 v[176:177], v183
    s_waitcnt lgkmcnt(0)
    s_cmp_lg_u32 s3, 53
    s_cbranch_scc1 K_P2
    v_readfirstlane_b32 s70, v176
    s_and_b32 s70, s70, 0x7ff
    s_sub_u32 s70, 2047, s70
    s_lshr_b32 s70, s70, 7
    s_mul_i32 s70, s70, 5120
    s_atomic_add s3, s[6:7], s70 offset:524424
    s_atomic_add s3, s[6:7], s70 offset:524936
    s_atomic_add s3, s[6:7], s70 offset:525448
    s_atomic_add s3, s[6:7], s70 offset:525960
    s_atomic_add s3, s[6:7], s70 offset:526472
    s_atomic_add s3, s[6:7], s70 offset:526984
    s_atomic_add s3, s[6:7], s70 offset:527496
    s_atomic_add s3, s[6:7], s70 offset:528008
    s_atomic_add s3, s[6:7], s70 offset:528520
    s_atomic_add s3, s[6:7], s70 offset:529032
    v_readfirstlane_b32 s70, v177
    s_and_b32 s70, s70, 0x7ff
    s_sub_u32 s70, 2047, s70
    s_lshr_b32 s70, s70, 7
    s_mul_i32 s70, s70, 5120
    s_atomic_add s3, s[6:7], s70 offset:524424
    s_atomic_add s3, s[6:7], s70 offset:524936
    s_atomic_add s3, s[6:7], s70 offset:525448
    s_atomic_add s3, s[6:7], s70 offset:525960
    s_atomic_add s3, s[6:7], s70 offset:526472
    s_atomic_add s3, s[6:7], s70 offset:526984
    s_atomic_add s3, s[6:7], s70 offset:527496
    s_atomic_add s3, s[6:7], s70 offset:528008
    s_atomic_add s3, s[6:7], s70 offset:528520
    s_atomic_add s3, s[6:7], s70 offset:529032
    s_waitcnt lgkmcnt(0)
    s_branch K_P2
K_CODE_END:
.section .rodata,"a"
.p2align 6
.amdhsa_kernel gated_mix__sliding_local_dilated__moe_arch_mod__prompt_kernel
  .amdhsa_next_free_vgpr 256
  .amdhsa_next_free_sgpr 79
  .amdhsa_accum_offset 256
  .amdhsa_group_segment_fixed_size 0
  .amdhsa_kernarg_size 96
  .amdhsa_user_sgpr_count 2
  .amdhsa_user_sgpr_kernarg_segment_ptr 1
  .amdhsa_system_sgpr_workgroup_id_x 1
.end_amdhsa_kernel
```

```asm
; @launch grid=(256,1,1) block=(512,1,1) lds=163840
.amdgcn_target "amdgcn-amd-amdhsa--gfx950"
.text
K_CPL = 33
.p2align 12
.p2align 8
.globl gated_mix__sliding_local_dilated__moe_arch_mod__prompt_kernel
.type gated_mix__sliding_local_dilated__moe_arch_mod__prompt_kernel,@function
gated_mix__sliding_local_dilated__moe_arch_mod__prompt_kernel:
    s_cmp_ge_u32 s2, 256
    s_cbranch_scc1 K_EXIT
    s_load_dwordx2 s[12:13], s[0:1], 0
    s_load_dwordx2 s[16:17], s[0:1], 8
    s_load_dwordx4 s[4:7], s[0:1], 80
    s_load_dwordx2 s[8:9], s[0:1], 16
    s_load_dwordx2 s[10:11], s[0:1], 72
    v_readfirstlane_b32 s30, v0
    s_mov_b32 s14, 0x280000
    s_mov_b32 s15, 0x20000
    s_lshr_b32 s30, s30, 6
    s_cmp_ge_u32 s2, 64
    s_cbranch_scc1 K_MAIN
    s_load_dwordx8 s[44:51], s[0:1], 32
    s_load_dwordx2 s[52:53], s[0:1], 64
    s_getpc_b64 s[38:39]
K_PC:
    s_lshr_b32 s3, s2, 3
    s_mul_i32 s3, s3, K_CPL
    v_add_u32 v2, s3, v0
    v_lshlrev_b32 v2, 7, v2
    v_min_u32 v2, K_CODE_END-K_PC-4, v2
    v_cmp_gt_u32 vcc, K_CPL, v0
    s_and_saveexec_b64 s[20:21], vcc
    s_cbranch_execz K_NOPF
    global_load_dword v6, v2, s[38:39]
K_NOPF:
    s_mov_b64 exec, -1
    s_cmp_lg_u32 s30, 4
    s_cbranch_scc1 K_AUX
    s_min_u32 s3, s2, 8
    s_mul_i32 s3, s3, 10240
    s_add_u32 s33, s3, 10240
    s_cmp_lt_u32 s2, 8
    s_cbranch_scc1 K_ZS
    s_cmp_lg_u32 s2, 63
    s_cbranch_scc1 K_AUX
    s_mov_b32 s33, 0
K_ZS:
    v_lshlrev_b32 v2, 4, v0
    v_mov_b32 v8, 0
    v_mov_b32 v9, 0
    v_mov_b32 v10, 0
    v_mov_b32 v11, 0
    s_waitcnt lgkmcnt(0)
    s_add_u32 s20, s6, 0x7f000
    s_addc_u32 s21, s7, 0
    s_mov_b32 s22, 0x15400
    s_mov_b32 s23, 0x20000
K_ZL:
    buffer_store_dwordx4 v[8:11], v2, s[20:23], s3 offen sc1
    s_add_u32 s3, s3, 1024
    s_cmp_lt_u32 s3, s33
    s_cbranch_scc1 K_ZL
    s_branch K_AUX
K_MAIN:
    s_cmp_ge_u32 s30, 4
    s_cbranch_scc1 K_CONS
    s_bfe_u32 s3, s2, 0x20001
    s_mul_i32 s44, s3, 675840
    s_lshr_b32 s33, s2, 6
    s_mul_i32 s3, s33, 225280
    s_add_u32 s44, s44, s3
    s_mul_i32 s3, s30, 61440
    s_add_u32 s44, s44, s3
    s_sub_u32 s44, s44, 245760
    v_bfe_u32 v3, v0, 4, 2
    s_lshr_b32 s3, s2, 1
    s_and_b32 s3, s3, 28
    s_or_b32 s3, s3, 0x40000
    v_lshlrev_b32 v2, 1, v3
    v_sub_u32 v2, v0, v2
    s_and_b32 s50, s2, 0xc1
    s_mov_b32 s49, 0x225510
    s_cmpk_eq_u32 s50, 128
    s_cselect_b32 s49, 0x75275525, s49
    s_cmpk_eq_u32 s50, 192
    s_cselect_b32 s49, 0x37765750, s49
    s_cmpk_eq_u32 s50, 65
    s_cselect_b32 s49, 0x225510, s49
    s_cmpk_eq_u32 s50, 129
    s_cselect_b32 s49, 0x75275525, s49
    s_cmpk_eq_u32 s50, 193
    s_cselect_b32 s49, 0x37765750, s49
    s_bfe_u32 s49, s49, s3
    s_bfe_u32 s32, 0x64317520, s3
    v_and_b32 v2, 15, v2
    v_mul_u32_u24 v5, 3840, v3
    s_lshl_b32 s3, s2, 2
    s_lshr_b32 s3, 0x44032335, s3
    s_and_b32 s3, s3, 15
    s_add_u32 s49, s49, s3
    s_mov_b32 s33, 0x00a55a
    v_subrev_u32 v5, 160, v5
    s_sub_u32 s3, s49, 10
    s_cselect_b32 s49, s49, s3
    v_mul_u32_u24 v4, 52, v2
    v_lshrrev_b32 v4, 5, v4
    v_and_b32 v4, 24, v4
    v_bfe_u32 v4, s33, v4, 8
    v_add_u32 v4, v4, v2
    v_lshl_add_u32 v218, v4, 4, v5
    v_add_u32 v4, 1, v2
    v_lshrrev_b32 v4, 4, v4
    v_lshl_add_u32 v218, v4, 28, v218
    v_xor_b32 v2, 8, v2
    v_mul_u32_u24 v4, 52, v2
    v_lshrrev_b32 v4, 5, v4
    v_and_b32 v4, 24, v4
    v_bfe_u32 v4, s33, v4, 8
    v_add_u32 v4, v4, v2
    v_lshl_add_u32 v219, v4, 4, v5
    v_add_u32 v4, 1, v2
    v_lshrrev_b32 v4, 4, v4
    v_lshl_add_u32 v219, v4, 28, v219
    s_bitcmp1_b32 s2, 0
    s_cselect_b32 s3, 8, 0
    s_add_u32 s32, s32, s3
    s_mul_i32 s50, s32, 80
    s_mul_i32 s3, s30, 61440
    s_add_u32 s50, s50, s3
    s_lshl_b32 s46, s30, 12
    s_add_u32 s46, s46, 24576
    s_mul_i32 s45, s30, 6144
    s_mov_b32 s18, 0x258000
    s_mov_b32 s19, 0x20000
    v_xor_b32 v3, v3, v0
    v_and_b32 v3, 7, v3
    v_bfe_u32 v2, v0, 3, 3
    v_mul_u32_u24 v2, 1280, v2
    v_lshl_add_u32 v216, v3, 4, v2
    v_xor_b32 v217, 64, v216
    s_lshl_b32 s47, s49, 7
    s_mul_i32 s48, s49, 245760
    s_add_u32 s51, s44, s47
    s_add_u32 s48, s48, s50
    s_add_u32 s49, s49, 1
    s_cmp_eq_u32 s49, 10
    s_cselect_b32 s49, 0, s49
    s_waitcnt lgkmcnt(0)
    s_add_u32 m0, s46, 81920
    s_add_u32 s52, s48, 0
    buffer_load_dwordx4 v218, s[16:19], s52 offen lds
    s_add_u32 m0, s45, 81920
    s_max_i32 s52, s51, s47
    buffer_load_dwordx4 v216, s[12:15], s52 offen lds
    s_add_u32 m0, s46, 82944
    s_add_u32 s52, s48, 15360
    buffer_load_dwordx4 v218, s[16:19], s52 offen lds
    s_add_u32 m0, s45, 82944
    s_add_u32 s52, s51, 10240
    s_max_i32 s52, s52, s47
    buffer_load_dwordx4 v217, s[12:15], s52 offen lds
    s_add_u32 m0, s45, 83968
    s_add_u32 s52, s51, 20480
    buffer_load_dwordx4 v216, s[12:15], s52 offen lds
    s_add_u32 m0, s46, 83968
    s_add_u32 s52, s48, 30720
    buffer_load_dwordx4 v219, s[16:19], s52 offen lds
    s_add_u32 m0, s45, 84992
    s_add_u32 s52, s51, 30720
    buffer_load_dwordx4 v217, s[12:15], s52 offen lds
    s_add_u32 m0, s46, 84992
    s_add_u32 s52, s48, 46080
    buffer_load_dwordx4 v219, s[16:19], s52 offen lds
    s_add_u32 m0, s45, 86016
    s_add_u32 s52, s51, 40960
    buffer_load_dwordx4 v216, s[12:15], s52 offen lds
    s_add_u32 m0, s45, 87040
    s_add_u32 s52, s51, 51200
    buffer_load_dwordx4 v217, s[12:15], s52 offen lds
    s_lshl_b32 s47, s49, 7
    s_mul_i32 s48, s49, 245760
    s_add_u32 s51, s44, s47
    s_add_u32 s48, s48, s50
    s_add_u32 s49, s49, 1
    s_cmp_eq_u32 s49, 10
    s_cselect_b32 s49, 0, s49
    s_add_u32 m0, s46, 0
    s_add_u32 s52, s48, 0
    buffer_load_dwordx4 v218, s[16:19], s52 offen lds
    s_add_u32 m0, s45, 0
    s_max_i32 s52, s51, s47
    buffer_load_dwordx4 v216, s[12:15], s52 offen lds
    s_add_u32 m0, s46, 1024
    s_add_u32 s52, s48, 15360
    buffer_load_dwordx4 v218, s[16:19], s52 offen lds
    s_add_u32 m0, s45, 1024
    s_add_u32 s52, s51, 10240
    s_max_i32 s52, s52, s47
    buffer_load_dwordx4 v217, s[12:15], s52 offen lds
    s_add_u32 m0, s45, 2048
    s_add_u32 s52, s51, 20480
    buffer_load_dwordx4 v216, s[12:15], s52 offen lds
    s_add_u32 m0, s46, 2048
    s_add_u32 s52, s48, 30720
    buffer_load_dwordx4 v219, s[16:19], s52 offen lds
    s_mov_b32 s43, s30
    v_and_b32 v1, 63, v0
    v_mov_b32 v7, 0
    s_and_b32 s28, s2, 7
    s_lshr_b32 s29, s2, 3
    s_xor_b32 s30, s30, 4
    s_lshr_b32 s34, s29, 3
    s_lshl_b32 s34, s34, 2
    s_and_b32 s3, s29, 3
    s_add_u32 s34, s34, s3
    s_add_u32 s34, s34, 4
    s_bitcmp1_b32 s29, 2
    s_cselect_b32 s34, -1, s34
    s_cmp_lt_u32 s29, 8
    s_cselect_b32 s34, s29, s34
    s_lshl_b32 s40, s28, 1
    s_cmp_ge_u32 s34, 10
    s_addc_u32 s40, s40, 0
    s_sub_u32 s41, s34, 10
    s_cmp_ge_u32 s34, 10
    s_cselect_b32 s41, s41, s34
    s_mul_i32 s42, s28, 20
    s_add_u32 s42, s42, s34
    s_and_b32 s42, s42, 255
    s_lshl_b32 s42, s42, 9
    s_add_u32 s42, s42, 524288
    s_lshr_b32 s31, s28, 1
    s_mul_i32 s31, s31, 3
    s_lshr_b32 s3, s29, 3
    s_add_u32 s31, s31, s3
    s_sub_u32 s31, s31, 1
    s_and_b32 s32, s28, 1
    s_lshl_b32 s32, s32, 3
    s_and_b32 s3, s29, 7
    s_lshl_b32 s3, s3, 2
    s_lshr_b32 s3, 0x64317520, s3
    s_and_b32 s3, s3, 7
    s_add_u32 s32, s32, s3
    s_and_b32 s35, s29, 3
    s_and_b32 s3, s29, 4
    s_lshl_b32 s3, s3, 1
    s_add_u32 s35, s35, s3
    s_and_b32 s3, s28, 1
    s_lshl_b32 s3, s3, 2
    s_add_u32 s35, s35, s3
K_LOADER:
    s_mov_b32 s24, s8
    s_mov_b32 s25, s9
    s_mov_b32 s26, 0xc8000
    s_mov_b32 s27, 0x20000
    v_and_b32 v8, 15, v1
    v_lshrrev_b32 v9, 4, v1
    v_bfe_u32 v10, v1, 2, 2
    v_and_b32 v11, 3, v1
    s_add_u32 s20, s6, 0x100000
    s_addc_u32 s21, s7, 0
    s_mov_b32 s22, 0x280000
    s_mov_b32 s23, 0x20000
    s_lshr_b32 s53, s35, 2
    s_add_u32 s3, s53, s35
    s_lshl_b32 s3, s3, 12
    s_mul_i32 s33, s53, 19456
    s_lshl_b32 s53, s35, 8
    s_add_u32 s33, s33, s53
    s_add_u32 s33, s33, 16384
    s_mul_i32 s53, s31, 11
    s_add_u32 s54, s53, s43
    v_mov_b32 v3, s54
    v_lshrrev_b32 v2, 2, v3
    v_mul_u32_u24 v2, 76, v2
    v_add_lshl_u32 v2, v2, v3, 10
    v_lshl_add_u32 v2, v8, 4, v2
    v_add_u32 v220, s3, v2
    v_lshl_add_u32 v220, v9, 8, v220
    s_lshl_b32 s3, s43, 2
    v_add_u32 v4, s3, v9
    v_add_u32 v3, s53, v4
    v_lshrrev_b32 v2, 2, v3
    v_mul_u32_u24 v2, 76, v2
    v_add_lshl_u32 v2, v2, v3, 10
    v_lshl_add_u32 v2, v8, 4, v2
    v_add_u32 v221, s33, v2
    v_mov_b32 v5, 0x10000000
    v_cmp_gt_u32 vcc, 11, v4
    v_mov_b32 v224, -1
    v_mov_b32 v225, -1
    v_mov_b32 v226, -1
    v_mov_b32 v227, -1
    v_cndmask_b32 v221, v5, v221, vcc
    v_lshrrev_b32 v2, 3, v1
    v_mul_u32_u24 v2, 1280, v2
    v_lshrrev_b32 v3, 2, v1
    v_and_b32 v3, 4, v3
    v_and_b32 v4, 7, v1
    v_xor_b32 v3, v3, v4
    v_lshl_add_u32 v2, v3, 4, v2
    s_lshl_b32 s33, s41, 7
    v_add_u32 v222, s33, v2
    v_lshrrev_b32 v5, 5, v1
    v_mul_u32_u24 v5, 20480, v5
    v_add_u32 v5, v5, v222
    s_mov_b32 s30, s43
    s_waitcnt vmcnt(6)
    s_barrier
    s_add_u32 m0, s45, 3072
    s_add_u32 s52, s51, 30720
    buffer_load_dwordx4 v217, s[12:15], s52 offen lds
    s_add_u32 m0, s46, 3072
    s_add_u32 s52, s48, 46080
    buffer_load_dwordx4 v219, s[16:19], s52 offen lds
    s_add_u32 m0, s45, 4096
    s_add_u32 s52, s51, 40960
    buffer_load_dwordx4 v216, s[12:15], s52 offen lds
    s_add_u32 m0, s45, 5120
    s_add_u32 s52, s51, 51200
    buffer_load_dwordx4 v217, s[12:15], s52 offen lds
    s_lshl_b32 s47, s49, 7
    s_mul_i32 s48, s49, 245760
    s_add_u32 s51, s44, s47
    s_add_u32 s48, s48, s50
    s_add_u32 s49, s49, 1
    s_cmp_eq_u32 s49, 10
    s_cselect_b32 s49, 0, s49
    s_add_u32 m0, s46, 40960
    s_add_u32 s52, s48, 0
    buffer_load_dwordx4 v218, s[16:19], s52 offen lds
    s_add_u32 m0, s45, 40960
    s_max_i32 s52, s51, s47
    buffer_load_dwordx4 v216, s[12:15], s52 offen lds
    s_add_u32 m0, s46, 41984
    s_add_u32 s52, s48, 15360
    buffer_load_dwordx4 v218, s[16:19], s52 offen lds
    s_add_u32 m0, s45, 41984
    s_add_u32 s52, s51, 10240
    s_max_i32 s52, s52, s47
    buffer_load_dwordx4 v217, s[12:15], s52 offen lds
    s_add_u32 m0, s45, 43008
    s_add_u32 s52, s51, 20480
    buffer_load_dwordx4 v216, s[12:15], s52 offen lds
    s_add_u32 m0, s46, 43008
    s_add_u32 s52, s48, 30720
    buffer_load_dwordx4 v219, s[16:19], s52 offen lds
    s_waitcnt vmcnt(6)
    s_barrier
    s_add_u32 m0, s45, 44032
    s_add_u32 s52, s51, 30720
    buffer_load_dwordx4 v217, s[12:15], s52 offen lds
    s_add_u32 m0, s46, 44032
    s_add_u32 s52, s48, 46080
    buffer_load_dwordx4 v219, s[16:19], s52 offen lds
    s_add_u32 m0, s45, 45056
    s_add_u32 s52, s51, 40960
    buffer_load_dwordx4 v216, s[12:15], s52 offen lds
    s_add_u32 m0, s45, 46080
    s_add_u32 s52, s51, 51200
    buffer_load_dwordx4 v217, s[12:15], s52 offen lds
    s_lshl_b32 s47, s49, 7
    s_mul_i32 s48, s49, 245760
    s_add_u32 s51, s44, s47
    s_add_u32 s48, s48, s50
    s_add_u32 s49, s49, 1
    s_cmp_eq_u32 s49, 10
    s_cselect_b32 s49, 0, s49
    s_add_u32 m0, s46, 81920
    s_add_u32 s52, s48, 0
    buffer_load_dwordx4 v218, s[16:19], s52 offen lds
    s_add_u32 m0, s45, 81920
    s_max_i32 s52, s51, s47
    buffer_load_dwordx4 v216, s[12:15], s52 offen lds
    s_add_u32 m0, s46, 82944
    s_add_u32 s52, s48, 15360
    buffer_load_dwordx4 v218, s[16:19], s52 offen lds
    s_add_u32 m0, s45, 82944
    s_add_u32 s52, s51, 10240
    s_max_i32 s52, s52, s47
    buffer_load_dwordx4 v217, s[12:15], s52 offen lds
    s_add_u32 m0, s45, 83968
    s_add_u32 s52, s51, 20480
    buffer_load_dwordx4 v216, s[12:15], s52 offen lds
    s_add_u32 m0, s46, 83968
    s_add_u32 s52, s48, 30720
    buffer_load_dwordx4 v219, s[16:19], s52 offen lds
    s_waitcnt vmcnt(6)
    s_barrier
    s_add_u32 m0, s45, 84992
    s_add_u32 s52, s51, 30720
    buffer_load_dwordx4 v217, s[12:15], s52 offen lds
    s_add_u32 m0, s46, 84992
    s_add_u32 s52, s48, 46080
    buffer_load_dwordx4 v219, s[16:19], s52 offen lds
    s_add_u32 m0, s45, 86016
    s_add_u32 s52, s51, 40960
    buffer_load_dwordx4 v216, s[12:15], s52 offen lds
    s_add_u32 m0, s45, 87040
    s_add_u32 s52, s51, 51200
    buffer_load_dwordx4 v217, s[12:15], s52 offen lds
    s_lshl_b32 s47, s49, 7
    s_mul_i32 s48, s49, 245760
    s_add_u32 s51, s44, s47
    s_add_u32 s48, s48, s50
    s_add_u32 s49, s49, 1
    s_cmp_eq_u32 s49, 10
    s_cselect_b32 s49, 0, s49
    s_add_u32 m0, s46, 0
    s_add_u32 s52, s48, 0
    buffer_load_dwordx4 v218, s[16:19], s52 offen lds
    s_add_u32 m0, s45, 0
    s_max_i32 s52, s51, s47
    buffer_load_dwordx4 v216, s[12:15], s52 offen lds
    s_add_u32 m0, s46, 1024
    s_add_u32 s52, s48, 15360
    buffer_load_dwordx4 v218, s[16:19], s52 offen lds
    s_add_u32 m0, s45, 1024
    s_add_u32 s52, s51, 10240
    s_max_i32 s52, s52, s47
    buffer_load_dwordx4 v217, s[12:15], s52 offen lds
    s_add_u32 m0, s45, 2048
    s_add_u32 s52, s51, 20480
    buffer_load_dwordx4 v216, s[12:15], s52 offen lds
    s_add_u32 m0, s46, 2048
    s_add_u32 s52, s48, 30720
    buffer_load_dwordx4 v219, s[16:19], s52 offen lds
    s_waitcnt vmcnt(6)
    s_barrier
    s_add_u32 m0, s45, 3072
    s_add_u32 s52, s51, 30720
    buffer_load_dwordx4 v217, s[12:15], s52 offen lds
    s_add_u32 m0, s46, 3072
    s_add_u32 s52, s48, 46080
    buffer_load_dwordx4 v219, s[16:19], s52 offen lds
    s_add_u32 m0, s45, 4096
    s_add_u32 s52, s51, 40960
    buffer_load_dwordx4 v216, s[12:15], s52 offen lds
    s_add_u32 m0, s45, 5120
    s_add_u32 s52, s51, 51200
    buffer_load_dwordx4 v217, s[12:15], s52 offen lds
    s_lshl_b32 s47, s49, 7
    s_mul_i32 s48, s49, 245760
    s_add_u32 s51, s44, s47
    s_add_u32 s48, s48, s50
    s_add_u32 s49, s49, 1
    s_cmp_eq_u32 s49, 10
    s_cselect_b32 s49, 0, s49
    s_add_u32 m0, s46, 40960
    s_add_u32 s52, s48, 0
    buffer_load_dwordx4 v218, s[16:19], s52 offen lds
    s_add_u32 m0, s45, 40960
    s_max_i32 s52, s51, s47
    buffer_load_dwordx4 v216, s[12:15], s52 offen lds
    s_add_u32 m0, s46, 41984
    s_add_u32 s52, s48, 15360
    buffer_load_dwordx4 v218, s[16:19], s52 offen lds
    s_add_u32 m0, s45, 41984
    s_add_u32 s52, s51, 10240
    s_max_i32 s52, s52, s47
    buffer_load_dwordx4 v217, s[12:15], s52 offen lds
    s_add_u32 m0, s45, 43008
    s_add_u32 s52, s51, 20480
    buffer_load_dwordx4 v216, s[12:15], s52 offen lds
    s_add_u32 m0, s46, 43008
    s_add_u32 s52, s48, 30720
    buffer_load_dwordx4 v219, s[16:19], s52 offen lds
    s_waitcnt vmcnt(6)
    s_barrier
    s_add_u32 m0, s45, 44032
    s_add_u32 s52, s51, 30720
    buffer_load_dwordx4 v217, s[12:15], s52 offen lds
    s_add_u32 m0, s46, 44032
    s_add_u32 s52, s48, 46080
    buffer_load_dwordx4 v219, s[16:19], s52 offen lds
    s_add_u32 m0, s45, 45056
    s_add_u32 s52, s51, 40960
    buffer_load_dwordx4 v216, s[12:15], s52 offen lds
    s_add_u32 m0, s45, 46080
    s_add_u32 s52, s51, 51200
    buffer_load_dwordx4 v217, s[12:15], s52 offen lds
    s_lshl_b32 s47, s49, 7
    s_mul_i32 s48, s49, 245760
    s_add_u32 s51, s44, s47
    s_add_u32 s48, s48, s50
    s_add_u32 s49, s49, 1
    s_cmp_eq_u32 s49, 10
    s_cselect_b32 s49, 0, s49
    s_add_u32 m0, s46, 81920
    s_add_u32 s52, s48, 0
    buffer_load_dwordx4 v218, s[16:19], s52 offen lds
    s_add_u32 m0, s45, 81920
    s_max_i32 s52, s51, s47
    buffer_load_dwordx4 v216, s[12:15], s52 offen lds
    s_add_u32 m0, s46, 82944
    s_add_u32 s52, s48, 15360
    buffer_load_dwordx4 v218, s[16:19], s52 offen lds
    s_add_u32 m0, s45, 82944
    s_add_u32 s52, s51, 10240
    s_max_i32 s52, s52, s47
    buffer_load_dwordx4 v217, s[12:15], s52 offen lds
    s_add_u32 m0, s45, 83968
    s_add_u32 s52, s51, 20480
    buffer_load_dwordx4 v216, s[12:15], s52 offen lds
    s_add_u32 m0, s46, 83968
    s_add_u32 s52, s48, 30720
    buffer_load_dwordx4 v219, s[16:19], s52 offen lds
    s_waitcnt vmcnt(6)
    s_barrier
    s_add_u32 m0, s45, 84992
    s_add_u32 s52, s51, 30720
    buffer_load_dwordx4 v217, s[12:15], s52 offen lds
    s_add_u32 m0, s46, 84992
    s_add_u32 s52, s48, 46080
    buffer_load_dwordx4 v219, s[16:19], s52 offen lds
    s_add_u32 m0, s45, 86016
    s_add_u32 s52, s51, 40960
    buffer_load_dwordx4 v216, s[12:15], s52 offen lds
    s_add_u32 m0, s45, 87040
    s_add_u32 s52, s51, 51200
    buffer_load_dwordx4 v217, s[12:15], s52 offen lds
    s_lshl_b32 s47, s49, 7
    s_mul_i32 s48, s49, 245760
    s_add_u32 s51, s44, s47
    s_add_u32 s48, s48, s50
    s_add_u32 s49, s49, 1
    s_cmp_eq_u32 s49, 10
    s_cselect_b32 s49, 0, s49
    s_add_u32 m0, s46, 0
    s_add_u32 s52, s48, 0
    buffer_load_dwordx4 v218, s[16:19], s52 offen lds
    s_add_u32 m0, s45, 0
    s_max_i32 s52, s51, s47
    buffer_load_dwordx4 v216, s[12:15], s52 offen lds
    s_add_u32 m0, s46, 1024
    s_add_u32 s52, s48, 15360
    buffer_load_dwordx4 v218, s[16:19], s52 offen lds
    s_add_u32 m0, s45, 1024
    s_add_u32 s52, s51, 10240
    s_max_i32 s52, s52, s47
    buffer_load_dwordx4 v217, s[12:15], s52 offen lds
    s_add_u32 m0, s45, 2048
    s_add_u32 s52, s51, 20480
    buffer_load_dwordx4 v216, s[12:15], s52 offen lds
    s_add_u32 m0, s46, 2048
    s_add_u32 s52, s48, 30720
    buffer_load_dwordx4 v219, s[16:19], s52 offen lds
    s_waitcnt vmcnt(6)
    s_barrier
    s_add_u32 m0, s45, 3072
    s_add_u32 s52, s51, 30720
    s_branch K_PG0
.p2align 12
K_CHM0:
K_STM0:
    s_branch K_WRET_M
    s_nop 0
K_PG0:
    buffer_load_dwordx4 v217, s[12:15], s52 offen lds
    s_add_u32 m0, s46, 3072
    s_add_u32 s52, s48, 46080
    buffer_load_dwordx4 v219, s[16:19], s52 offen lds
    s_add_u32 m0, s45, 4096
    s_add_u32 s52, s51, 40960
    buffer_load_dwordx4 v216, s[12:15], s52 offen lds
    s_add_u32 m0, s45, 5120
    s_add_u32 s52, s51, 51200
    buffer_load_dwordx4 v217, s[12:15], s52 offen lds
    s_lshl_b32 s47, s49, 7
    s_mul_i32 s48, s49, 245760
    s_add_u32 s51, s44, s47
    s_add_u32 s48, s48, s50
    s_add_u32 s49, s49, 1
    s_cmp_eq_u32 s49, 10
    s_cselect_b32 s49, 0, s49
    s_add_u32 m0, s46, 40960
    s_add_u32 s52, s48, 0
    buffer_load_dwordx4 v218, s[16:19], s52 offen lds
    s_add_u32 m0, s45, 40960
    s_max_i32 s52, s51, s47
    buffer_load_dwordx4 v216, s[12:15], s52 offen lds
    s_add_u32 m0, s46, 41984
    s_add_u32 s52, s48, 15360
    buffer_load_dwordx4 v218, s[16:19], s52 offen lds
    s_add_u32 m0, s45, 41984
    s_add_u32 s52, s51, 10240
    s_max_i32 s52, s52, s47
    buffer_load_dwordx4 v217, s[12:15], s52 offen lds
    s_add_u32 m0, s45, 43008
    s_add_u32 s52, s51, 20480
    buffer_load_dwordx4 v216, s[12:15], s52 offen lds
    s_add_u32 m0, s46, 43008
    s_add_u32 s52, s48, 30720
    buffer_load_dwordx4 v219, s[16:19], s52 offen lds
    s_waitcnt vmcnt(6)
    s_barrier
    s_add_u32 m0, s45, 44032
    s_add_u32 s52, s51, 30720
    buffer_load_dwordx4 v217, s[12:15], s52 offen lds
    s_add_u32 m0, s46, 44032
    s_add_u32 s52, s48, 46080
    buffer_load_dwordx4 v219, s[16:19], s52 offen lds
    s_add_u32 m0, s45, 45056
    s_add_u32 s52, s51, 40960
    buffer_load_dwordx4 v216, s[12:15], s52 offen lds
    s_add_u32 m0, s45, 46080
    s_add_u32 s52, s51, 51200
    buffer_load_dwordx4 v217, s[12:15], s52 offen lds
    s_lshl_b32 s47, s49, 7
    s_mul_i32 s48, s49, 245760
    s_add_u32 s51, s44, s47
    s_add_u32 s48, s48, s50
    s_add_u32 s49, s49, 1
    s_cmp_eq_u32 s49, 10
    s_cselect_b32 s49, 0, s49
    s_add_u32 m0, s46, 81920
    s_add_u32 s52, s48, 0
    buffer_load_dwordx4 v218, s[16:19], s52 offen lds
    s_add_u32 m0, s45, 81920
    s_max_i32 s52, s51, s47
    buffer_load_dwordx4 v216, s[12:15], s52 offen lds
    s_add_u32 m0, s46, 82944
    s_add_u32 s52, s48, 15360
    buffer_load_dwordx4 v218, s[16:19], s52 offen lds
    s_add_u32 m0, s45, 82944
    s_add_u32 s52, s51, 10240
    s_max_i32 s52, s52, s47
    buffer_load_dwordx4 v217, s[12:15], s52 offen lds
    s_add_u32 m0, s45, 83968
    s_add_u32 s52, s51, 20480
    buffer_load_dwordx4 v216, s[12:15], s52 offen lds
    s_add_u32 m0, s46, 83968
    s_add_u32 s52, s48, 30720
    buffer_load_dwordx4 v219, s[16:19], s52 offen lds
    s_waitcnt vmcnt(6)
    s_barrier
    s_load_dword s54, s[4:5], 192
    s_add_u32 m0, s45, 84992
    s_add_u32 s52, s51, 30720
    buffer_load_dwordx4 v217, s[12:15], s52 offen lds
    s_add_u32 m0, s46, 84992
    s_add_u32 s52, s48, 46080
    buffer_load_dwordx4 v219, s[16:19], s52 offen lds
    s_add_u32 m0, s45, 86016
    s_add_u32 s52, s51, 40960
    buffer_load_dwordx4 v216, s[12:15], s52 offen lds
    s_add_u32 m0, s45, 87040
    s_add_u32 s52, s51, 51200
    buffer_load_dwordx4 v217, s[12:15], s52 offen lds
    s_waitcnt lgkmcnt(0)
    s_cmp_ge_u32 s54, 8
    s_cbranch_scc1 K_ZO0
    s_mov_b32 s3, 16384
K_ZB0:
    v_mov_b32 v4, 192
    global_load_dword v4, v4, s[4:5] sc1
    s_waitcnt vmcnt(0)
    v_readfirstlane_b32 s33, v4
    s_cmp_ge_u32 s33, 8
    s_cbranch_scc1 K_ZO0
    s_sleep 8
    s_sub_u32 s3, s3, 1
    s_cbranch_scc0 K_ZB0
K_ZO0:
    s_cmp_eq_u32 s34, -1
    s_cbranch_scc1 K_NOLT
    s_lshl_b32 s47, s43, 2
    s_lshr_b32 s47, 0x7520, s47
    s_and_b32 s47, s47, 7
    s_mul_i32 s47, s47, 51200
    s_lshl_b32 s48, s43, 12
    s_add_u32 s3, s47, 0
    s_add_u32 m0, s48, 0
    s_nop 0
    buffer_load_dwordx4 v222, s[24:27], s3 offen lds
    s_add_u32 s3, s47, 10240
    s_add_u32 m0, s48, 1024
    s_nop 0
    buffer_load_dwordx4 v222, s[24:27], s3 offen lds
    s_add_u32 s3, s47, 25600
    s_add_u32 m0, s48, 2048
    s_nop 0
    buffer_load_dwordx4 v222, s[24:27], s3 offen lds
    s_add_u32 s3, s47, 35840
    s_add_u32 m0, s48, 3072
    s_nop 0
    buffer_load_dwordx4 v222, s[24:27], s3 offen lds
    s_add_u32 s3, s47, 409600
    s_add_u32 m0, s48, 20480
    s_nop 0
    buffer_load_dwordx4 v222, s[24:27], s3 offen lds
    s_add_u32 s3, s47, 419840
    s_add_u32 m0, s48, 21504
    s_nop 0
    buffer_load_dwordx4 v222, s[24:27], s3 offen lds
    s_add_u32 s3, s47, 435200
    s_add_u32 m0, s48, 22528
    s_nop 0
    buffer_load_dwordx4 v222, s[24:27], s3 offen lds
    s_add_u32 s3, s47, 445440
    s_add_u32 m0, s48, 23552
    s_nop 0
    buffer_load_dwordx4 v222, s[24:27], s3 offen lds
    s_lshl_b32 s48, s43, 10
    s_add_u32 s3, s47, 20480
    s_add_u32 m0, s48, 16384
    s_nop 0
    buffer_load_dwordx4 v5, s[24:27], s3 offen lds
    s_add_u32 s3, s47, 430080
    s_add_u32 m0, s48, 36864
    s_nop 0
    buffer_load_dwordx4 v5, s[24:27], s3 offen lds
    s_waitcnt vmcnt(10)
    s_barrier
    s_mov_b32 s33, 81920
    s_cmp_eq_u32 s43, 3
    s_cselect_b32 s3, 0, 163840
    buffer_store_dwordx4 v[224:227], v220, s[20:23], 0 offen sc1
    buffer_store_dwordx4 v[224:227], v220, s[20:23], s33 offen sc1
    buffer_store_dwordx4 v[224:227], v220, s[20:23], s3 offen sc1
    buffer_store_dwordx4 v[224:227], v221, s[20:23], 0 offen sc1
    v_mov_b32 v2, 158720
    v_mov_b32 v3, 1
    s_waitcnt vmcnt(0)
    s_mov_b64 exec, 1
    ds_add_u32 v2, v3 offset:28
    ds_add_u32 v2, v3 offset:32
    s_mov_b64 exec, -1
    s_lshl_b32 s47, s43, 2
    s_lshr_b32 s47, 0x6431, s47
    s_and_b32 s47, s47, 7
    s_mul_i32 s47, s47, 51200
    s_lshl_b32 s48, s43, 12
    s_add_u32 s3, s47, 0
    s_add_u32 m0, s48, 40960
    s_nop 0
    buffer_load_dwordx4 v222, s[24:27], s3 offen lds
    s_add_u32 s3, s47, 10240
    s_add_u32 m0, s48, 41984
    s_nop 0
    buffer_load_dwordx4 v222, s[24:27], s3 offen lds
    s_add_u32 s3, s47, 25600
    s_add_u32 m0, s48, 43008
    s_nop 0
    buffer_load_dwordx4 v222, s[24:27], s3 offen lds
    s_add_u32 s3, s47, 35840
    s_add_u32 m0, s48, 44032
    s_nop 0
    buffer_load_dwordx4 v222, s[24:27], s3 offen lds
    s_add_u32 s3, s47, 409600
    s_add_u32 m0, s48, 61440
    s_nop 0
    buffer_load_dwordx4 v222, s[24:27], s3 offen lds
    s_add_u32 s3, s47, 419840
    s_add_u32 m0, s48, 62464
    s_nop 0
    buffer_load_dwordx4 v222, s[24:27], s3 offen lds
    s_add_u32 s3, s47, 435200
    s_add_u32 m0, s48, 63488
    s_nop 0
    buffer_load_dwordx4 v222, s[24:27], s3 offen lds
    s_add_u32 s3, s47, 445440
    s_add_u32 m0, s48, 64512
    s_nop 0
    buffer_load_dwordx4 v222, s[24:27], s3 offen lds
    s_lshl_b32 s48, s43, 10
    s_add_u32 s3, s47, 20480
    s_add_u32 m0, s48, 57344
    s_nop 0
    buffer_load_dwordx4 v5, s[24:27], s3 offen lds
    s_add_u32 s3, s47, 430080
    s_add_u32 m0, s48, 77824
    s_nop 0
    buffer_load_dwordx4 v5, s[24:27], s3 offen lds
    s_branch K_P2_GM
K_NOLT:
    s_waitcnt vmcnt(0)
    s_barrier
    s_mov_b32 s33, 81920
    s_cmp_eq_u32 s43, 3
    s_cselect_b32 s3, 0, 163840
    buffer_store_dwordx4 v[224:227], v220, s[20:23], 0 offen sc1
    buffer_store_dwordx4 v[224:227], v220, s[20:23], s33 offen sc1
    buffer_store_dwordx4 v[224:227], v220, s[20:23], s3 offen sc1
    buffer_store_dwordx4 v[224:227], v221, s[20:23], 0 offen sc1
    v_mov_b32 v2, 158720
    v_mov_b32 v3, 1
    s_waitcnt vmcnt(0)
    s_mov_b64 exec, 1
    ds_add_u32 v2, v3 offset:28
    ds_add_u32 v2, v3 offset:32
    s_mov_b64 exec, -1
    s_branch K_END
K_CONS:
    v_and_b32 v1, 63, v0
    v_and_b32 v8, 15, v1
    v_lshrrev_b32 v9, 4, v1
    v_bfe_u32 v10, v1, 2, 2
    v_and_b32 v11, 3, v1
    s_bfe_u32 s54, s30, 0x10001
    s_and_b32 s55, s30, 1
    v_lshrrev_b32 v2, 1, v8
    v_xor_b32 v2, v2, v9
    v_lshlrev_b32 v2, 4, v2
    v_lshl_add_u32 v2, v8, 7, v2
    s_mul_i32 s3, s54, 12288
    v_add_u32 v39, s3, v2
    v_xor_b32 v40, 64, v39
    v_add_u32 v41, 81920, v39
    v_add_u32 v42, 81920, v40
    v_and_b32 v2, 1, v9
    v_lshl_or_b32 v2, v2, 2, v10
    s_mul_i32 s3, s55, 40
    v_lshl_add_u32 v2, v2, 5, s3
    v_lshl_add_u32 v3, v9, 3, v10
    v_lshlrev_b32 v3, 8, v3
    v_add_u32 v3, 24576, v3
    v_lshl_add_u32 v5, v11, 3, v2
    s_mul_i32 s33, s55, 805306368
    s_sub_u32 s33, 0xf870c020, s33
    v_add_u32 v4, 0, v5
    v_and_b32 v4, 255, v4
    v_add_u32 v43, v4, v3
    v_add_u32 v47, 81920, v43
    v_add_u32 v4, 160, v5
    v_and_b32 v4, 255, v4
    v_add_u32 v44, v4, v3
    v_add_u32 v48, 81920, v44
    v_add_u32 v4, 80, v5
    v_and_b32 v4, 255, v4
    v_add_u32 v45, v4, v3
    v_add_u32 v49, 81920, v45
    v_lshlrev_b32 v4, 3, v11
    v_bfe_u32 v4, s33, v4, 8
    v_add_u32 v4, v4, v2
    v_and_b32 v4, 255, v4
    v_add_u32 v46, v4, v3
    v_add_u32 v50, 81920, v46
    v_and_b32 v1, 63, v0
    v_mov_b32 v7, 0
    s_and_b32 s28, s2, 7
    s_lshr_b32 s29, s2, 3
    s_xor_b32 s30, s30, 4
    s_lshr_b32 s34, s29, 3
    s_lshl_b32 s34, s34, 2
    s_and_b32 s3, s29, 3
    s_add_u32 s34, s34, s3
    s_add_u32 s34, s34, 4
    s_bitcmp1_b32 s29, 2
    s_cselect_b32 s34, -1, s34
    s_cmp_lt_u32 s29, 8
    s_cselect_b32 s34, s29, s34
    s_lshl_b32 s40, s28, 1
    s_cmp_ge_u32 s34, 10
    s_addc_u32 s40, s40, 0
    s_sub_u32 s41, s34, 10
    s_cmp_ge_u32 s34, 10
    s_cselect_b32 s41, s41, s34
    s_mul_i32 s42, s28, 20
    s_add_u32 s42, s42, s34
    s_and_b32 s42, s42, 255
    s_lshl_b32 s42, s42, 9
    s_add_u32 s42, s42, 524288
    v_mov_b32 v3, 158736
    ds_write2_b32 v3, v7, v7 offset0:0 offset1:1
    ds_write2_b32 v3, v7, v7 offset0:2 offset1:3
    ds_write2_b32 v3, v7, v7 offset0:4 offset1:5
    ds_write2_b32 v3, v7, v7 offset0:6 offset1:7
    ds_write2_b32 v3, v7, v7 offset0:8 offset1:9
    ds_write2_b32 v3, v7, v7 offset0:10 offset1:11
    s_lshr_b32 s31, s28, 1
    s_mul_i32 s31, s31, 3
    s_lshr_b32 s3, s29, 3
    s_add_u32 s31, s31, s3
    s_sub_u32 s31, s31, 1
    s_and_b32 s32, s28, 1
    s_lshl_b32 s32, s32, 3
    s_and_b32 s3, s29, 7
    s_lshl_b32 s3, s3, 2
    s_lshr_b32 s3, 0x64317520, s3
    s_and_b32 s3, s3, 7
    s_add_u32 s32, s32, s3
    s_and_b32 s35, s29, 3
    s_and_b32 s3, s29, 4
    s_lshl_b32 s3, s3, 1
    s_add_u32 s35, s35, s3
    s_and_b32 s3, s28, 1
    s_lshl_b32 s3, s3, 2
    s_add_u32 s35, s35, s3
    s_or_b32 s56, s31, s54
    v_mov_b32 v37, 0xf149f2ca
    v_lshlrev_b32 v2, 2, v9
    v_sub_u32 v2, v8, v2
    s_cmp_eq_u32 s56, 0
    s_cselect_b32 s3, 0xf149f2ca, 0
    v_subrev_u32 v3, 0, v2
    v_and_b32 v4, 0x80000001, v3
    v_cmp_eq_u32 vcc, 0, v4
    s_nop 1
    v_cndmask_b32 v16, v37, 0, vcc
    v_cmp_eq_u32 vcc, 0x80000000, v4
    s_nop 1
    v_cndmask_b32 v12, v37, 0, vcc
    v_add_f32 v20, s3, v12
    v_subrev_u32 v3, 1, v2
    v_and_b32 v4, 0x80000001, v3
    v_cmp_eq_u32 vcc, 0, v4
    s_nop 1
    v_cndmask_b32 v17, v37, 0, vcc
    v_cmp_eq_u32 vcc, 0x80000000, v4
    s_nop 1
    v_cndmask_b32 v13, v37, 0, vcc
    v_add_f32 v21, s3, v13
    v_subrev_u32 v3, 2, v2
    v_and_b32 v4, 0x80000001, v3
    v_cmp_eq_u32 vcc, 0, v4
    s_nop 1
    v_cndmask_b32 v18, v37, 0, vcc
    v_cmp_eq_u32 vcc, 0x80000000, v4
    s_nop 1
    v_cndmask_b32 v14, v37, 0, vcc
    v_add_f32 v22, s3, v14
    v_subrev_u32 v3, 3, v2
    v_and_b32 v4, 0x80000001, v3
    v_cmp_eq_u32 vcc, 0, v4
    s_nop 1
    v_cndmask_b32 v19, v37, 0, vcc
    v_cmp_eq_u32 vcc, 0x80000000, v4
    s_nop 1
    v_cndmask_b32 v15, v37, 0, vcc
    v_add_f32 v23, s3, v15
    v_mov_b32 v3, 0x0c0c0c0c
    v_mov_b32 v4, 0xc0c0100
    v_cmp_eq_u32 vcc, 0, v12
    v_mov_b32 v5, 0x1000c0c
    s_nop 0
    v_cndmask_b32 v3, v3, v4, vcc
    v_cmp_eq_u32 vcc, 0, v13
    s_nop 1
    v_cndmask_b32 v24, v3, v5, vcc
    v_mov_b32 v3, 0x0c0c0c0c
    v_mov_b32 v4, 0xc0c0302
    v_cmp_eq_u32 vcc, 0, v14
    v_mov_b32 v5, 0x3020c0c
    s_nop 0
    v_cndmask_b32 v3, v3, v4, vcc
    v_cmp_eq_u32 vcc, 0, v15
    s_nop 1
    v_cndmask_b32 v25, v3, v5, vcc
    v_mov_b32 v3, 0x0c0c0c0c
    v_mov_b32 v4, 0xc0c0100
    v_cmp_eq_u32 vcc, 0, v16
    v_mov_b32 v5, 0x1000c0c
    s_nop 0
    v_cndmask_b32 v3, v3, v4, vcc
    v_cmp_eq_u32 vcc, 0, v17
    s_nop 1
    v_cndmask_b32 v26, v3, v5, vcc
    v_mov_b32 v3, 0x0c0c0c0c
    v_mov_b32 v4, 0xc0c0302
    v_cmp_eq_u32 vcc, 0, v18
    v_mov_b32 v5, 0x3020c0c
    s_nop 0
    v_cndmask_b32 v3, v3, v4, vcc
    v_cmp_eq_u32 vcc, 0, v19
    s_nop 1
    v_cndmask_b32 v27, v3, v5, vcc
    s_mul_i32 s3, s55, 1664
    s_mul_i32 s33, s54, 768
    s_add_u32 s3, s3, s33
    s_add_u32 s3, s3, 125952
    v_lshl_add_u32 v2, v9, 2, v10
    v_lshl_add_u32 v33, v2, 3, s3
    v_lshl_add_u32 v2, v8, 3, s3
    v_lshlrev_b32 v3, 3, v1
    v_add_u32 v3, 129280, v3
    v_cmp_eq_u32 vcc, 2, v9
    s_mul_i32 s3, s55, 1536
    s_add_u32 s3, s3, 122880
    v_cndmask_b32 v32, v3, v2, vcc
    v_lshl_add_u32 v34, v1, 3, s3
    s_mul_i32 s3, s54, 1536
    s_add_u32 s3, s3, 131328
    s_lshl3_add_u32 s33, s55, s3
    v_lshl_add_u32 v35, v8, 4, s33
    v_cmp_eq_u32 vcc, 0, v9
    s_nop 1
    v_cndmask_b32 v35, v3, v35, vcc
    s_mul_i32 s33, s55, 768
    s_add_u32 s3, s3, s33
    v_lshl_add_u32 v36, v1, 4, s3
    v_mov_b32 v38, 158720
    s_waitcnt lgkmcnt(0)
    s_add_u32 s20, s6, 0x100000
    s_addc_u32 s21, s7, 0
    s_mov_b32 s22, 0x280000
    s_mov_b32 s23, 0x20000
    s_lshr_b32 s53, s35, 2
    s_add_u32 s58, s53, s35
    s_lshl_b32 s58, s58, 12
    s_mul_i32 s59, s53, 19456
    s_lshl_b32 s53, s35, 8
    s_add_u32 s59, s59, s53
    s_add_u32 s59, s59, 16384
    s_mul_i32 s53, s31, 11
    s_mul_i32 s3, s54, 6
    s_add_u32 s53, s53, s3
    s_add_u32 s53, s53, 3
    s_lshl_b32 s3, s55, 9
    s_add_u32 s58, s58, s3
    v_and_b32 v4, 1, v9
    v_lshrrev_b32 v5, 1, v9
    v_add_u32 v3, s53, v4
    v_lshrrev_b32 v2, 2, v3
    v_mul_u32_u24 v2, 76, v2
    v_add_lshl_u32 v2, v2, v3, 10
    v_lshl_add_u32 v2, v8, 4, v2
    v_add_u32 v30, s58, v2
    v_lshl_add_u32 v30, v5, 8, v30
    v_subrev_u32 v3, 2, v3
    v_lshrrev_b32 v2, 2, v3
    v_mul_u32_u24 v2, 76, v2
    v_add_lshl_u32 v2, v2, v3, 10
    v_lshl_add_u32 v2, v8, 4, v2
    v_add_u32 v29, s58, v2
    v_lshl_add_u32 v29, v5, 8, v29
    v_or_b32 v4, s54, v4
    v_cmp_eq_u32 vcc, 0, v4
    v_mov_b32 v5, 0x10000000
    v_subrev_u32 v28, 81920, v30
    v_cndmask_b32 v28, v28, v5, vcc
    s_mul_i32 s3, s55, 3
    s_add_u32 s53, s53, s3
    v_add_u32 v3, s53, v9
    v_lshrrev_b32 v2, 2, v3
    v_mul_u32_u24 v2, 76, v2
    v_add_lshl_u32 v2, v2, v3, 10
    v_lshl_add_u32 v2, v8, 4, v2
    v_add_u32 v31, s59, v2
    v_subrev_u32 v31, 81920, v31
    v_or_b32 v4, s30, v9
    v_cmp_eq_u32 vcc, 0, v4
    s_nop 1
    v_cndmask_b32 v31, v31, v5, vcc
    v_cmp_eq_u32 vcc, 3, v9
    s_nop 1
    v_cndmask_b32 v31, v31, v5, vcc
    s_mul_i32 s3, s31, 11
    s_add_u32 s33, s3, 10
    s_lshr_b32 s3, s3, 3
    s_lshr_b32 s33, s33, 3
    s_min_u32 s33, s33, 15
    s_sub_u32 s33, s33, s3
    s_add_u32 s33, s33, 1
    s_mul_i32 s33, s33, 10
    s_bfm_b32 s37, s33, 0
    v_mul_u32_u24 v2, 205, v1
    v_lshrrev_b32 v2, 11, v2
    v_add_u32 v2, s3, v2
    v_mul_u32_u24 v2, 1496, v2
    v_lshrrev_b32 v2, 11, v2
    v_sub_u32 v2, s31, v2
    v_and_b32 v2, 1, v2
    v_lshlrev_b32 v2, 2, v2
    v_lshl_add_u32 v2, v1, 9, v2
    s_mul_i32 s3, s3, 5120
    s_add_u32 s3, s3, 524288
    v_add_u32 v37, s3, v2
    s_lshr_b32 s36, s35, 2
    s_add_u32 s36, s36, s35
    s_lshl_b32 s36, 1, s36
    s_cmp_eq_u32 s30, 0
    s_cselect_b32 s36, s36, 0
    s_mov_b32 s58, 0x3fb8aa3b
    s_mov_b32 s59, s58
    s_mov_b32 s60, 0x3e64f92e
    s_mov_b32 s61, s60
    s_cmp_eq_u32 s30, 0
    s_cbranch_scc1 K_CHM0
    s_cmp_eq_u32 s30, 1
    s_cbranch_scc1 K_CHM1
    s_cmp_eq_u32 s30, 2
    s_cbranch_scc1 K_CHM2
    s_branch K_CHM3
K_WRET_M:
    s_setprio 2
    s_barrier
K_L0:
    ds_read_b64_tr_b16 v[196:197], v47 offset:0
    ds_read_b64_tr_b16 v[198:199], v47 offset:1024
    ds_read_b128 v[148:151], v41 offset:0
    ds_read_b64_tr_b16 v[200:201], v48 offset:0
    ds_read_b64_tr_b16 v[202:203], v48 offset:1024
    ds_read_b128 v[152:155], v41 offset:2048
    ds_read_b64_tr_b16 v[204:205], v49 offset:0
    ds_read_b64_tr_b16 v[206:207], v49 offset:1024
    ds_read_b128 v[156:159], v41 offset:4096
    ds_read_b64_tr_b16 v[208:209], v50 offset:0
    ds_read_b64_tr_b16 v[210:211], v50 offset:1024
    ds_read_b128 v[160:163], v41 offset:6144
    ds_read_b128 v[164:167], v41 offset:8192
    ds_read_b128 v[168:171], v41 offset:10240
    s_waitcnt lgkmcnt(0)
    v_mfma_f32_16x16x32_bf16 v[52:55], v[196:199], v[148:151], 0
    ds_read_b64_tr_b16 v[212:213], v47 offset:8192
    v_mfma_f32_16x16x32_bf16 v[56:59], v[200:203], v[148:151], 0
    ds_read_b64_tr_b16 v[214:215], v47 offset:9216
    v_mfma_f32_16x16x32_bf16 v[60:63], v[148:151], v[204:207], 0
    ds_read_b128 v[172:175], v42 offset:0
    v_mfma_f32_16x16x32_bf16 v[64:67], v[208:211], v[148:151], 0
    ds_read_b64_tr_b16 v[216:217], v48 offset:8192
    v_mfma_f32_16x16x32_bf16 v[80:83], v[208:211], v[152:155], 0
    ds_read_b64_tr_b16 v[218:219], v48 offset:9216
    v_mfma_f32_16x16x32_bf16 v[76:79], v[152:155], v[204:207], 0
    ds_read_b128 v[176:179], v42 offset:2048
    v_mfma_f32_16x16x32_bf16 v[72:75], v[200:203], v[152:155], 0
    ds_read_b64_tr_b16 v[220:221], v49 offset:8192
    v_mfma_f32_16x16x32_bf16 v[68:71], v[196:199], v[152:155], 0
    ds_read_b64_tr_b16 v[222:223], v49 offset:9216
    v_mfma_f32_16x16x32_bf16 v[84:87], v[196:199], v[156:159], 0
    ds_read_b128 v[180:183], v42 offset:4096
    v_mfma_f32_16x16x32_bf16 v[88:91], v[200:203], v[156:159], 0
    ds_read_b64_tr_b16 v[224:225], v50 offset:8192
    v_mfma_f32_16x16x32_bf16 v[92:95], v[156:159], v[204:207], 0
    ds_read_b64_tr_b16 v[226:227], v50 offset:9216
    v_mfma_f32_16x16x32_bf16 v[96:99], v[208:211], v[156:159], 0
    ds_read_b128 v[184:187], v42 offset:6144
    v_mfma_f32_16x16x32_bf16 v[112:115], v[208:211], v[160:163], 0
    ds_read_b128 v[188:191], v42 offset:8192
    v_mfma_f32_16x16x32_bf16 v[108:111], v[160:163], v[204:207], 0
    ds_read_b128 v[192:195], v42 offset:10240
    v_mfma_f32_16x16x32_bf16 v[104:107], v[200:203], v[160:163], 0
    v_mfma_f32_16x16x32_bf16 v[100:103], v[196:199], v[160:163], 0
    v_mfma_f32_16x16x32_bf16 v[116:119], v[196:199], v[164:167], 0
    v_mfma_f32_16x16x32_bf16 v[120:123], v[200:203], v[164:167], 0
    v_mfma_f32_16x16x32_bf16 v[124:127], v[164:167], v[204:207], 0
    v_mfma_f32_16x16x32_bf16 v[128:131], v[208:211], v[164:167], 0
    v_mfma_f32_16x16x32_bf16 v[144:147], v[208:211], v[168:171], 0
    v_mfma_f32_16x16x32_bf16 v[140:143], v[168:171], v[204:207], 0
    v_mfma_f32_16x16x32_bf16 v[136:139], v[200:203], v[168:171], 0
    v_mfma_f32_16x16x32_bf16 v[132:135], v[196:199], v[168:171], 0
    s_waitcnt lgkmcnt(0)
    s_barrier
    v_mfma_f32_16x16x32_bf16 v[52:55], v[212:215], v[172:175], v[52:55]
    ds_read_b64_tr_b16 v[196:197], v43 offset:0
    v_mfma_f32_16x16x32_bf16 v[56:59], v[216:219], v[172:175], v[56:59]
    ds_read_b64_tr_b16 v[198:199], v43 offset:1024
    v_mfma_f32_16x16x32_bf16 v[60:63], v[172:175], v[220:223], v[60:63]
    ds_read_b128 v[148:151], v39 offset:0
    v_mfma_f32_16x16x32_bf16 v[64:67], v[224:227], v[172:175], v[64:67]
    ds_read_b64_tr_b16 v[200:201], v44 offset:0
    v_mfma_f32_16x16x32_bf16 v[80:83], v[224:227], v[176:179], v[80:83]
    ds_read_b64_tr_b16 v[202:203], v44 offset:1024
    v_mfma_f32_16x16x32_bf16 v[76:79], v[176:179], v[220:223], v[76:79]
    ds_read_b128 v[152:155], v39 offset:2048
    v_mfma_f32_16x16x32_bf16 v[72:75], v[216:219], v[176:179], v[72:75]
    ds_read_b64_tr_b16 v[204:205], v45 offset:0
    v_mfma_f32_16x16x32_bf16 v[68:71], v[212:215], v[176:179], v[68:71]
    ds_read_b64_tr_b16 v[206:207], v45 offset:1024
    v_mfma_f32_16x16x32_bf16 v[84:87], v[212:215], v[180:183], v[84:87]
    ds_read_b128 v[156:159], v39 offset:4096
    v_mfma_f32_16x16x32_bf16 v[88:91], v[216:219], v[180:183], v[88:91]
    ds_read_b64_tr_b16 v[208:209], v46 offset:0
    v_mfma_f32_16x16x32_bf16 v[92:95], v[180:183], v[220:223], v[92:95]
    ds_read_b64_tr_b16 v[210:211], v46 offset:1024
    v_mfma_f32_16x16x32_bf16 v[96:99], v[224:227], v[180:183], v[96:99]
    ds_read_b128 v[160:163], v39 offset:6144
    v_mfma_f32_16x16x32_bf16 v[112:115], v[224:227], v[184:187], v[112:115]
    ds_read_b128 v[164:167], v39 offset:8192
    v_mfma_f32_16x16x32_bf16 v[108:111], v[184:187], v[220:223], v[108:111]
    ds_read_b128 v[168:171], v39 offset:10240
    v_mfma_f32_16x16x32_bf16 v[104:107], v[216:219], v[184:187], v[104:107]
    v_mfma_f32_16x16x32_bf16 v[100:103], v[212:215], v[184:187], v[100:103]
    v_mfma_f32_16x16x32_bf16 v[116:119], v[212:215], v[188:191], v[116:119]
    v_mfma_f32_16x16x32_bf16 v[120:123], v[216:219], v[188:191], v[120:123]
    v_mfma_f32_16x16x32_bf16 v[124:127], v[188:191], v[220:223], v[124:127]
    v_mfma_f32_16x16x32_bf16 v[128:131], v[224:227], v[188:191], v[128:131]
    v_mfma_f32_16x16x32_bf16 v[144:147], v[224:227], v[192:195], v[144:147]
    v_mfma_f32_16x16x32_bf16 v[140:143], v[192:195], v[220:223], v[140:143]
    v_mfma_f32_16x16x32_bf16 v[136:139], v[216:219], v[192:195], v[136:139]
    v_mfma_f32_16x16x32_bf16 v[132:135], v[212:215], v[192:195], v[132:135]
    s_waitcnt lgkmcnt(0)
    v_mfma_f32_16x16x32_bf16 v[52:55], v[196:199], v[148:151], v[52:55]
    ds_read_b64_tr_b16 v[212:213], v43 offset:8192
    v_mfma_f32_16x16x32_bf16 v[56:59], v[200:203], v[148:151], v[56:59]
    ds_read_b64_tr_b16 v[214:215], v43 offset:9216
    v_mfma_f32_16x16x32_bf16 v[60:63], v[148:151], v[204:207], v[60:63]
    ds_read_b128 v[172:175], v40 offset:0
    v_mfma_f32_16x16x32_bf16 v[64:67], v[208:211], v[148:151], v[64:67]
    ds_read_b64_tr_b16 v[216:217], v44 offset:8192
    v_mfma_f32_16x16x32_bf16 v[80:83], v[208:211], v[152:155], v[80:83]
    ds_read_b64_tr_b16 v[218:219], v44 offset:9216
    v_mfma_f32_16x16x32_bf16 v[76:79], v[152:155], v[204:207], v[76:79]
    ds_read_b128 v[176:179], v40 offset:2048
    v_mfma_f32_16x16x32_bf16 v[72:75], v[200:203], v[152:155], v[72:75]
    ds_read_b64_tr_b16 v[220:221], v45 offset:8192
    v_mfma_f32_16x16x32_bf16 v[68:71], v[196:199], v[152:155], v[68:71]
    ds_read_b64_tr_b16 v[222:223], v45 offset:9216
    v_mfma_f32_16x16x32_bf16 v[84:87], v[196:199], v[156:159], v[84:87]
    ds_read_b128 v[180:183], v40 offset:4096
    v_mfma_f32_16x16x32_bf16 v[88:91], v[200:203], v[156:159], v[88:91]
    ds_read_b64_tr_b16 v[224:225], v46 offset:8192
    v_mfma_f32_16x16x32_bf16 v[92:95], v[156:159], v[204:207], v[92:95]
    ds_read_b64_tr_b16 v[226:227], v46 offset:9216
    v_mfma_f32_16x16x32_bf16 v[96:99], v[208:211], v[156:159], v[96:99]
    ds_read_b128 v[184:187], v40 offset:6144
    v_mfma_f32_16x16x32_bf16 v[112:115], v[208:211], v[160:163], v[112:115]
    ds_read_b128 v[188:191], v40 offset:8192
    v_mfma_f32_16x16x32_bf16 v[108:111], v[160:163], v[204:207], v[108:111]
    ds_read_b128 v[192:195], v40 offset:10240
    s_branch K_PG1
.p2align 12
K_CHM1:
K_STM1:
    s_branch K_WRET_M
    s_nop 0
K_PG1:
    v_mfma_f32_16x16x32_bf16 v[104:107], v[200:203], v[160:163], v[104:107]
    v_mfma_f32_16x16x32_bf16 v[100:103], v[196:199], v[160:163], v[100:103]
    v_mfma_f32_16x16x32_bf16 v[116:119], v[196:199], v[164:167], v[116:119]
    v_mfma_f32_16x16x32_bf16 v[120:123], v[200:203], v[164:167], v[120:123]
    v_mfma_f32_16x16x32_bf16 v[124:127], v[164:167], v[204:207], v[124:127]
    v_mfma_f32_16x16x32_bf16 v[128:131], v[208:211], v[164:167], v[128:131]
    v_mfma_f32_16x16x32_bf16 v[144:147], v[208:211], v[168:171], v[144:147]
    v_mfma_f32_16x16x32_bf16 v[140:143], v[168:171], v[204:207], v[140:143]
    v_mfma_f32_16x16x32_bf16 v[136:139], v[200:203], v[168:171], v[136:139]
    v_mfma_f32_16x16x32_bf16 v[132:135], v[196:199], v[168:171], v[132:135]
    s_waitcnt lgkmcnt(0)
    s_barrier
    v_mfma_f32_16x16x32_bf16 v[52:55], v[212:215], v[172:175], v[52:55]
    ds_read_b64_tr_b16 v[196:197], v43 offset:40960
    v_mfma_f32_16x16x32_bf16 v[56:59], v[216:219], v[172:175], v[56:59]
    ds_read_b64_tr_b16 v[198:199], v43 offset:41984
    v_mfma_f32_16x16x32_bf16 v[60:63], v[172:175], v[220:223], v[60:63]
    ds_read_b128 v[148:151], v39 offset:40960
    v_mfma_f32_16x16x32_bf16 v[64:67], v[224:227], v[172:175], v[64:67]
    ds_read_b64_tr_b16 v[200:201], v44 offset:40960
    v_mfma_f32_16x16x32_bf16 v[80:83], v[224:227], v[176:179], v[80:83]
    ds_read_b64_tr_b16 v[202:203], v44 offset:41984
    v_mfma_f32_16x16x32_bf16 v[76:79], v[176:179], v[220:223], v[76:79]
    ds_read_b128 v[152:155], v39 offset:43008
    v_mfma_f32_16x16x32_bf16 v[72:75], v[216:219], v[176:179], v[72:75]
    ds_read_b64_tr_b16 v[204:205], v45 offset:40960
    v_mfma_f32_16x16x32_bf16 v[68:71], v[212:215], v[176:179], v[68:71]
    ds_read_b64_tr_b16 v[206:207], v45 offset:41984
    v_mfma_f32_16x16x32_bf16 v[84:87], v[212:215], v[180:183], v[84:87]
    ds_read_b128 v[156:159], v39 offset:45056
    v_mfma_f32_16x16x32_bf16 v[88:91], v[216:219], v[180:183], v[88:91]
    ds_read_b64_tr_b16 v[208:209], v46 offset:40960
    v_mfma_f32_16x16x32_bf16 v[92:95], v[180:183], v[220:223], v[92:95]
    ds_read_b64_tr_b16 v[210:211], v46 offset:41984
    v_mfma_f32_16x16x32_bf16 v[96:99], v[224:227], v[180:183], v[96:99]
    ds_read_b128 v[160:163], v39 offset:47104
    v_mfma_f32_16x16x32_bf16 v[112:115], v[224:227], v[184:187], v[112:115]
    ds_read_b128 v[164:167], v39 offset:49152
    v_mfma_f32_16x16x32_bf16 v[108:111], v[184:187], v[220:223], v[108:111]
    ds_read_b128 v[168:171], v39 offset:51200
    v_mfma_f32_16x16x32_bf16 v[104:107], v[216:219], v[184:187], v[104:107]
    v_mfma_f32_16x16x32_bf16 v[100:103], v[212:215], v[184:187], v[100:103]
    v_mfma_f32_16x16x32_bf16 v[116:119], v[212:215], v[188:191], v[116:119]
    v_mfma_f32_16x16x32_bf16 v[120:123], v[216:219], v[188:191], v[120:123]
    v_mfma_f32_16x16x32_bf16 v[124:127], v[188:191], v[220:223], v[124:127]
    v_mfma_f32_16x16x32_bf16 v[128:131], v[224:227], v[188:191], v[128:131]
    v_mfma_f32_16x16x32_bf16 v[144:147], v[224:227], v[192:195], v[144:147]
    v_mfma_f32_16x16x32_bf16 v[140:143], v[192:195], v[220:223], v[140:143]
    v_mfma_f32_16x16x32_bf16 v[136:139], v[216:219], v[192:195], v[136:139]
    v_mfma_f32_16x16x32_bf16 v[132:135], v[212:215], v[192:195], v[132:135]
    s_waitcnt lgkmcnt(0)
    v_mfma_f32_16x16x32_bf16 v[52:55], v[196:199], v[148:151], v[52:55]
    ds_read_b64_tr_b16 v[212:213], v43 offset:49152
    v_mfma_f32_16x16x32_bf16 v[56:59], v[200:203], v[148:151], v[56:59]
    ds_read_b64_tr_b16 v[214:215], v43 offset:50176
    v_mfma_f32_16x16x32_bf16 v[60:63], v[148:151], v[204:207], v[60:63]
    ds_read_b128 v[172:175], v40 offset:40960
    v_mfma_f32_16x16x32_bf16 v[64:67], v[208:211], v[148:151], v[64:67]
    ds_read_b64_tr_b16 v[216:217], v44 offset:49152
    v_mfma_f32_16x16x32_bf16 v[80:83], v[208:211], v[152:155], v[80:83]
    ds_read_b64_tr_b16 v[218:219], v44 offset:50176
    v_mfma_f32_16x16x32_bf16 v[76:79], v[152:155], v[204:207], v[76:79]
    ds_read_b128 v[176:179], v40 offset:43008
    v_mfma_f32_16x16x32_bf16 v[72:75], v[200:203], v[152:155], v[72:75]
    ds_read_b64_tr_b16 v[220:221], v45 offset:49152
    v_mfma_f32_16x16x32_bf16 v[68:71], v[196:199], v[152:155], v[68:71]
    ds_read_b64_tr_b16 v[222:223], v45 offset:50176
    v_mfma_f32_16x16x32_bf16 v[84:87], v[196:199], v[156:159], v[84:87]
    ds_read_b128 v[180:183], v40 offset:45056
    v_mfma_f32_16x16x32_bf16 v[88:91], v[200:203], v[156:159], v[88:91]
    ds_read_b64_tr_b16 v[224:225], v46 offset:49152
    v_mfma_f32_16x16x32_bf16 v[92:95], v[156:159], v[204:207], v[92:95]
    ds_read_b64_tr_b16 v[226:227], v46 offset:50176
    v_mfma_f32_16x16x32_bf16 v[96:99], v[208:211], v[156:159], v[96:99]
    ds_read_b128 v[184:187], v40 offset:47104
    v_mfma_f32_16x16x32_bf16 v[112:115], v[208:211], v[160:163], v[112:115]
    ds_read_b128 v[188:191], v40 offset:49152
    v_mfma_f32_16x16x32_bf16 v[108:111], v[160:163], v[204:207], v[108:111]
    ds_read_b128 v[192:195], v40 offset:51200
    v_mfma_f32_16x16x32_bf16 v[104:107], v[200:203], v[160:163], v[104:107]
    v_mfma_f32_16x16x32_bf16 v[100:103], v[196:199], v[160:163], v[100:103]
    v_mfma_f32_16x16x32_bf16 v[116:119], v[196:199], v[164:167], v[116:119]
    v_mfma_f32_16x16x32_bf16 v[120:123], v[200:203], v[164:167], v[120:123]
    v_mfma_f32_16x16x32_bf16 v[124:127], v[164:167], v[204:207], v[124:127]
    v_mfma_f32_16x16x32_bf16 v[128:131], v[208:211], v[164:167], v[128:131]
    v_mfma_f32_16x16x32_bf16 v[144:147], v[208:211], v[168:171], v[144:147]
    v_mfma_f32_16x16x32_bf16 v[140:143], v[168:171], v[204:207], v[140:143]
    v_mfma_f32_16x16x32_bf16 v[136:139], v[200:203], v[168:171], v[136:139]
    v_mfma_f32_16x16x32_bf16 v[132:135], v[196:199], v[168:171], v[132:135]
    s_waitcnt lgkmcnt(0)
    s_barrier
    v_mfma_f32_16x16x32_bf16 v[52:55], v[212:215], v[172:175], v[52:55]
    ds_read_b64_tr_b16 v[196:197], v47 offset:0
    v_mfma_f32_16x16x32_bf16 v[56:59], v[216:219], v[172:175], v[56:59]
    ds_read_b64_tr_b16 v[198:199], v47 offset:1024
    v_mfma_f32_16x16x32_bf16 v[60:63], v[172:175], v[220:223], v[60:63]
    ds_read_b128 v[148:151], v41 offset:0
    v_mfma_f32_16x16x32_bf16 v[64:67], v[224:227], v[172:175], v[64:67]
    ds_read_b64_tr_b16 v[200:201], v48 offset:0
    v_mfma_f32_16x16x32_bf16 v[80:83], v[224:227], v[176:179], v[80:83]
    ds_read_b64_tr_b16 v[202:203], v48 offset:1024
    v_mfma_f32_16x16x32_bf16 v[76:79], v[176:179], v[220:223], v[76:79]
    ds_read_b128 v[152:155], v41 offset:2048
    v_mfma_f32_16x16x32_bf16 v[72:75], v[216:219], v[176:179], v[72:75]
    ds_read_b64_tr_b16 v[204:205], v49 offset:0
    v_mfma_f32_16x16x32_bf16 v[68:71], v[212:215], v[176:179], v[68:71]
    ds_read_b64_tr_b16 v[206:207], v49 offset:1024
    v_mfma_f32_16x16x32_bf16 v[84:87], v[212:215], v[180:183], v[84:87]
    ds_read_b128 v[156:159], v41 offset:4096
    v_mfma_f32_16x16x32_bf16 v[88:91], v[216:219], v[180:183], v[88:91]
    ds_read_b64_tr_b16 v[208:209], v50 offset:0
    v_mfma_f32_16x16x32_bf16 v[92:95], v[180:183], v[220:223], v[92:95]
    ds_read_b64_tr_b16 v[210:211], v50 offset:1024
    v_mfma_f32_16x16x32_bf16 v[96:99], v[224:227], v[180:183], v[96:99]
    ds_read_b128 v[160:163], v41 offset:6144
    v_mfma_f32_16x16x32_bf16 v[112:115], v[224:227], v[184:187], v[112:115]
    ds_read_b128 v[164:167], v41 offset:8192
    v_mfma_f32_16x16x32_bf16 v[108:111], v[184:187], v[220:223], v[108:111]
    ds_read_b128 v[168:171], v41 offset:10240
    v_mfma_f32_16x16x32_bf16 v[104:107], v[216:219], v[184:187], v[104:107]
    v_mfma_f32_16x16x32_bf16 v[100:103], v[212:215], v[184:187], v[100:103]
    v_mfma_f32_16x16x32_bf16 v[116:119], v[212:215], v[188:191], v[116:119]
    v_mfma_f32_16x16x32_bf16 v[120:123], v[216:219], v[188:191], v[120:123]
    v_mfma_f32_16x16x32_bf16 v[124:127], v[188:191], v[220:223], v[124:127]
    v_mfma_f32_16x16x32_bf16 v[128:131], v[224:227], v[188:191], v[128:131]
    v_mfma_f32_16x16x32_bf16 v[144:147], v[224:227], v[192:195], v[144:147]
    v_mfma_f32_16x16x32_bf16 v[140:143], v[192:195], v[220:223], v[140:143]
    v_mfma_f32_16x16x32_bf16 v[136:139], v[216:219], v[192:195], v[136:139]
    v_mfma_f32_16x16x32_bf16 v[132:135], v[212:215], v[192:195], v[132:135]
    s_waitcnt lgkmcnt(0)
    v_mfma_f32_16x16x32_bf16 v[52:55], v[196:199], v[148:151], v[52:55]
    ds_read_b64_tr_b16 v[212:213], v47 offset:8192
    v_mfma_f32_16x16x32_bf16 v[56:59], v[200:203], v[148:151], v[56:59]
    ds_read_b64_tr_b16 v[214:215], v47 offset:9216
    v_mfma_f32_16x16x32_bf16 v[60:63], v[148:151], v[204:207], v[60:63]
    ds_read_b128 v[172:175], v42 offset:0
    v_mfma_f32_16x16x32_bf16 v[64:67], v[208:211], v[148:151], v[64:67]
    ds_read_b64_tr_b16 v[216:217], v48 offset:8192
    v_mfma_f32_16x16x32_bf16 v[80:83], v[208:211], v[152:155], v[80:83]
    ds_read_b64_tr_b16 v[218:219], v48 offset:9216
    v_mfma_f32_16x16x32_bf16 v[76:79], v[152:155], v[204:207], v[76:79]
    ds_read_b128 v[176:179], v42 offset:2048
    v_mfma_f32_16x16x32_bf16 v[72:75], v[200:203], v[152:155], v[72:75]
    ds_read_b64_tr_b16 v[220:221], v49 offset:8192
    v_mfma_f32_16x16x32_bf16 v[68:71], v[196:199], v[152:155], v[68:71]
    ds_read_b64_tr_b16 v[222:223], v49 offset:9216
    v_mfma_f32_16x16x32_bf16 v[84:87], v[196:199], v[156:159], v[84:87]
    ds_read_b128 v[180:183], v42 offset:4096
    v_mfma_f32_16x16x32_bf16 v[88:91], v[200:203], v[156:159], v[88:91]
    ds_read_b64_tr_b16 v[224:225], v50 offset:8192
    v_mfma_f32_16x16x32_bf16 v[92:95], v[156:159], v[204:207], v[92:95]
    ds_read_b64_tr_b16 v[226:227], v50 offset:9216
    v_mfma_f32_16x16x32_bf16 v[96:99], v[208:211], v[156:159], v[96:99]
    ds_read_b128 v[184:187], v42 offset:6144
    v_mfma_f32_16x16x32_bf16 v[112:115], v[208:211], v[160:163], v[112:115]
    ds_read_b128 v[188:191], v42 offset:8192
    v_mfma_f32_16x16x32_bf16 v[108:111], v[160:163], v[204:207], v[108:111]
    ds_read_b128 v[192:195], v42 offset:10240
    v_mfma_f32_16x16x32_bf16 v[104:107], v[200:203], v[160:163], v[104:107]
    v_mfma_f32_16x16x32_bf16 v[100:103], v[196:199], v[160:163], v[100:103]
    v_mfma_f32_16x16x32_bf16 v[116:119], v[196:199], v[164:167], v[116:119]
    v_mfma_f32_16x16x32_bf16 v[120:123], v[200:203], v[164:167], v[120:123]
    v_mfma_f32_16x16x32_bf16 v[124:127], v[164:167], v[204:207], v[124:127]
    v_mfma_f32_16x16x32_bf16 v[128:131], v[208:211], v[164:167], v[128:131]
    v_mfma_f32_16x16x32_bf16 v[144:147], v[208:211], v[168:171], v[144:147]
    v_mfma_f32_16x16x32_bf16 v[140:143], v[168:171], v[204:207], v[140:143]
    v_mfma_f32_16x16x32_bf16 v[136:139], v[200:203], v[168:171], v[136:139]
    v_mfma_f32_16x16x32_bf16 v[132:135], v[196:199], v[168:171], v[132:135]
    s_waitcnt lgkmcnt(0)
    s_barrier
    v_mfma_f32_16x16x32_bf16 v[52:55], v[212:215], v[172:175], v[52:55]
    ds_read_b64_tr_b16 v[196:197], v43 offset:0
    v_mfma_f32_16x16x32_bf16 v[56:59], v[216:219], v[172:175], v[56:59]
    ds_read_b64_tr_b16 v[198:199], v43 offset:1024
    v_mfma_f32_16x16x32_bf16 v[60:63], v[172:175], v[220:223], v[60:63]
    ds_read_b128 v[148:151], v39 offset:0
    v_mfma_f32_16x16x32_bf16 v[64:67], v[224:227], v[172:175], v[64:67]
    ds_read_b64_tr_b16 v[200:201], v44 offset:0
    v_mfma_f32_16x16x32_bf16 v[80:83], v[224:227], v[176:179], v[80:83]
    ds_read_b64_tr_b16 v[202:203], v44 offset:1024
    v_mfma_f32_16x16x32_bf16 v[76:79], v[176:179], v[220:223], v[76:79]
    ds_read_b128 v[152:155], v39 offset:2048
    v_mfma_f32_16x16x32_bf16 v[72:75], v[216:219], v[176:179], v[72:75]
    ds_read_b64_tr_b16 v[204:205], v45 offset:0
    v_mfma_f32_16x16x32_bf16 v[68:71], v[212:215], v[176:179], v[68:71]
    ds_read_b64_tr_b16 v[206:207], v45 offset:1024
    v_mfma_f32_16x16x32_bf16 v[84:87], v[212:215], v[180:183], v[84:87]
    ds_read_b128 v[156:159], v39 offset:4096
    v_mfma_f32_16x16x32_bf16 v[88:91], v[216:219], v[180:183], v[88:91]
    ds_read_b64_tr_b16 v[208:209], v46 offset:0
    v_mfma_f32_16x16x32_bf16 v[92:95], v[180:183], v[220:223], v[92:95]
    ds_read_b64_tr_b16 v[210:211], v46 offset:1024
    v_mfma_f32_16x16x32_bf16 v[96:99], v[224:227], v[180:183], v[96:99]
    ds_read_b128 v[160:163], v39 offset:6144
    v_mfma_f32_16x16x32_bf16 v[112:115], v[224:227], v[184:187], v[112:115]
    ds_read_b128 v[164:167], v39 offset:8192
    v_mfma_f32_16x16x32_bf16 v[108:111], v[184:187], v[220:223], v[108:111]
    ds_read_b128 v[168:171], v39 offset:10240
    v_mfma_f32_16x16x32_bf16 v[104:107], v[216:219], v[184:187], v[104:107]
    v_mfma_f32_16x16x32_bf16 v[100:103], v[212:215], v[184:187], v[100:103]
    v_mfma_f32_16x16x32_bf16 v[116:119], v[212:215], v[188:191], v[116:119]
    v_mfma_f32_16x16x32_bf16 v[120:123], v[216:219], v[188:191], v[120:123]
    v_mfma_f32_16x16x32_bf16 v[124:127], v[188:191], v[220:223], v[124:127]
    v_mfma_f32_16x16x32_bf16 v[128:131], v[224:227], v[188:191], v[128:131]
    v_mfma_f32_16x16x32_bf16 v[144:147], v[224:227], v[192:195], v[144:147]
    v_mfma_f32_16x16x32_bf16 v[140:143], v[192:195], v[220:223], v[140:143]
    v_mfma_f32_16x16x32_bf16 v[136:139], v[216:219], v[192:195], v[136:139]
    v_mfma_f32_16x16x32_bf16 v[132:135], v[212:215], v[192:195], v[132:135]
    s_waitcnt lgkmcnt(0)
    v_mfma_f32_16x16x32_bf16 v[52:55], v[196:199], v[148:151], v[52:55]
    ds_read_b64_tr_b16 v[212:213], v43 offset:8192
    v_mfma_f32_16x16x32_bf16 v[56:59], v[200:203], v[148:151], v[56:59]
    ds_read_b64_tr_b16 v[214:215], v43 offset:9216
    v_mfma_f32_16x16x32_bf16 v[60:63], v[148:151], v[204:207], v[60:63]
    ds_read_b128 v[172:175], v40 offset:0
    v_mfma_f32_16x16x32_bf16 v[64:67], v[208:211], v[148:151], v[64:67]
    ds_read_b64_tr_b16 v[216:217], v44 offset:8192
    v_mfma_f32_16x16x32_bf16 v[80:83], v[208:211], v[152:155], v[80:83]
    ds_read_b64_tr_b16 v[218:219], v44 offset:9216
    v_mfma_f32_16x16x32_bf16 v[76:79], v[152:155], v[204:207], v[76:79]
    ds_read_b128 v[176:179], v40 offset:2048
    v_mfma_f32_16x16x32_bf16 v[72:75], v[200:203], v[152:155], v[72:75]
    ds_read_b64_tr_b16 v[220:221], v45 offset:8192
    v_mfma_f32_16x16x32_bf16 v[68:71], v[196:199], v[152:155], v[68:71]
    ds_read_b64_tr_b16 v[222:223], v45 offset:9216
    v_mfma_f32_16x16x32_bf16 v[84:87], v[196:199], v[156:159], v[84:87]
    ds_read_b128 v[180:183], v40 offset:4096
    v_mfma_f32_16x16x32_bf16 v[88:91], v[200:203], v[156:159], v[88:91]
    ds_read_b64_tr_b16 v[224:225], v46 offset:8192
    v_mfma_f32_16x16x32_bf16 v[92:95], v[156:159], v[204:207], v[92:95]
    ds_read_b64_tr_b16 v[226:227], v46 offset:9216
    v_mfma_f32_16x16x32_bf16 v[96:99], v[208:211], v[156:159], v[96:99]
    ds_read_b128 v[184:187], v40 offset:6144
    v_mfma_f32_16x16x32_bf16 v[112:115], v[208:211], v[160:163], v[112:115]
    ds_read_b128 v[188:191], v40 offset:8192
    v_mfma_f32_16x16x32_bf16 v[108:111], v[160:163], v[204:207], v[108:111]
    ds_read_b128 v[192:195], v40 offset:10240
    v_mfma_f32_16x16x32_bf16 v[104:107], v[200:203], v[160:163], v[104:107]
    v_mfma_f32_16x16x32_bf16 v[100:103], v[196:199], v[160:163], v[100:103]
    v_mfma_f32_16x16x32_bf16 v[116:119], v[196:199], v[164:167], v[116:119]
    v_mfma_f32_16x16x32_bf16 v[120:123], v[200:203], v[164:167], v[120:123]
    v_mfma_f32_16x16x32_bf16 v[124:127], v[164:167], v[204:207], v[124:127]
    v_mfma_f32_16x16x32_bf16 v[128:131], v[208:211], v[164:167], v[128:131]
    v_mfma_f32_16x16x32_bf16 v[144:147], v[208:211], v[168:171], v[144:147]
    v_mfma_f32_16x16x32_bf16 v[140:143], v[168:171], v[204:207], v[140:143]
    v_mfma_f32_16x16x32_bf16 v[136:139], v[200:203], v[168:171], v[136:139]
    v_mfma_f32_16x16x32_bf16 v[132:135], v[196:199], v[168:171], v[132:135]
    s_waitcnt lgkmcnt(0)
    s_barrier
    v_mfma_f32_16x16x32_bf16 v[52:55], v[212:215], v[172:175], v[52:55]
    ds_read_b64_tr_b16 v[196:197], v43 offset:40960
    v_mfma_f32_16x16x32_bf16 v[56:59], v[216:219], v[172:175], v[56:59]
    ds_read_b64_tr_b16 v[198:199], v43 offset:41984
    v_mfma_f32_16x16x32_bf16 v[60:63], v[172:175], v[220:223], v[60:63]
    ds_read_b128 v[148:151], v39 offset:40960
    v_mfma_f32_16x16x32_bf16 v[64:67], v[224:227], v[172:175], v[64:67]
    ds_read_b64_tr_b16 v[200:201], v44 offset:40960
    v_mfma_f32_16x16x32_bf16 v[80:83], v[224:227], v[176:179], v[80:83]
    ds_read_b64_tr_b16 v[202:203], v44 offset:41984
    v_mfma_f32_16x16x32_bf16 v[76:79], v[176:179], v[220:223], v[76:79]
    ds_read_b128 v[152:155], v39 offset:43008
    v_mfma_f32_16x16x32_bf16 v[72:75], v[216:219], v[176:179], v[72:75]
    ds_read_b64_tr_b16 v[204:205], v45 offset:40960
    v_mfma_f32_16x16x32_bf16 v[68:71], v[212:215], v[176:179], v[68:71]
    ds_read_b64_tr_b16 v[206:207], v45 offset:41984
    v_mfma_f32_16x16x32_bf16 v[84:87], v[212:215], v[180:183], v[84:87]
    ds_read_b128 v[156:159], v39 offset:45056
    v_mfma_f32_16x16x32_bf16 v[88:91], v[216:219], v[180:183], v[88:91]
    ds_read_b64_tr_b16 v[208:209], v46 offset:40960
    v_mfma_f32_16x16x32_bf16 v[92:95], v[180:183], v[220:223], v[92:95]
    ds_read_b64_tr_b16 v[210:211], v46 offset:41984
    v_mfma_f32_16x16x32_bf16 v[96:99], v[224:227], v[180:183], v[96:99]
    ds_read_b128 v[160:163], v39 offset:47104
    v_mfma_f32_16x16x32_bf16 v[112:115], v[224:227], v[184:187], v[112:115]
    ds_read_b128 v[164:167], v39 offset:49152
    v_mfma_f32_16x16x32_bf16 v[108:111], v[184:187], v[220:223], v[108:111]
    ds_read_b128 v[168:171], v39 offset:51200
    v_mfma_f32_16x16x32_bf16 v[104:107], v[216:219], v[184:187], v[104:107]
    v_mfma_f32_16x16x32_bf16 v[100:103], v[212:215], v[184:187], v[100:103]
    v_mfma_f32_16x16x32_bf16 v[116:119], v[212:215], v[188:191], v[116:119]
    v_mfma_f32_16x16x32_bf16 v[120:123], v[216:219], v[188:191], v[120:123]
    v_mfma_f32_16x16x32_bf16 v[124:127], v[188:191], v[220:223], v[124:127]
    v_mfma_f32_16x16x32_bf16 v[128:131], v[224:227], v[188:191], v[128:131]
    v_mfma_f32_16x16x32_bf16 v[144:147], v[224:227], v[192:195], v[144:147]
    v_mfma_f32_16x16x32_bf16 v[140:143], v[192:195], v[220:223], v[140:143]
    v_mfma_f32_16x16x32_bf16 v[136:139], v[216:219], v[192:195], v[136:139]
    v_mfma_f32_16x16x32_bf16 v[132:135], v[212:215], v[192:195], v[132:135]
    s_waitcnt lgkmcnt(0)
    v_mfma_f32_16x16x32_bf16 v[52:55], v[196:199], v[148:151], v[52:55]
    ds_read_b64_tr_b16 v[212:213], v43 offset:49152
    v_mfma_f32_16x16x32_bf16 v[56:59], v[200:203], v[148:151], v[56:59]
    ds_read_b64_tr_b16 v[214:215], v43 offset:50176
    v_mfma_f32_16x16x32_bf16 v[60:63], v[148:151], v[204:207], v[60:63]
    ds_read_b128 v[172:175], v40 offset:40960
    v_mfma_f32_16x16x32_bf16 v[64:67], v[208:211], v[148:151], v[64:67]
    ds_read_b64_tr_b16 v[216:217], v44 offset:49152
    v_mfma_f32_16x16x32_bf16 v[80:83], v[208:211], v[152:155], v[80:83]
    ds_read_b64_tr_b16 v[218:219], v44 offset:50176
    v_mfma_f32_16x16x32_bf16 v[76:79], v[152:155], v[204:207], v[76:79]
    ds_read_b128 v[176:179], v40 offset:43008
    v_mfma_f32_16x16x32_bf16 v[72:75], v[200:203], v[152:155], v[72:75]
    ds_read_b64_tr_b16 v[220:221], v45 offset:49152
    v_mfma_f32_16x16x32_bf16 v[68:71], v[196:199], v[152:155], v[68:71]
    ds_read_b64_tr_b16 v[222:223], v45 offset:50176
    v_mfma_f32_16x16x32_bf16 v[84:87], v[196:199], v[156:159], v[84:87]
    ds_read_b128 v[180:183], v40 offset:45056
    v_mfma_f32_16x16x32_bf16 v[88:91], v[200:203], v[156:159], v[88:91]
    ds_read_b64_tr_b16 v[224:225], v46 offset:49152
    v_mfma_f32_16x16x32_bf16 v[92:95], v[156:159], v[204:207], v[92:95]
    ds_read_b64_tr_b16 v[226:227], v46 offset:50176
    v_mfma_f32_16x16x32_bf16 v[96:99], v[208:211], v[156:159], v[96:99]
    ds_read_b128 v[184:187], v40 offset:47104
    v_mfma_f32_16x16x32_bf16 v[112:115], v[208:211], v[160:163], v[112:115]
    ds_read_b128 v[188:191], v40 offset:49152
    v_mfma_f32_16x16x32_bf16 v[108:111], v[160:163], v[204:207], v[108:111]
    ds_read_b128 v[192:195], v40 offset:51200
    v_mfma_f32_16x16x32_bf16 v[104:107], v[200:203], v[160:163], v[104:107]
    v_mfma_f32_16x16x32_bf16 v[100:103], v[196:199], v[160:163], v[100:103]
    v_mfma_f32_16x16x32_bf16 v[116:119], v[196:199], v[164:167], v[116:119]
    v_mfma_f32_16x16x32_bf16 v[120:123], v[200:203], v[164:167], v[120:123]
    v_mfma_f32_16x16x32_bf16 v[124:127], v[164:167], v[204:207], v[124:127]
    v_mfma_f32_16x16x32_bf16 v[128:131], v[208:211], v[164:167], v[128:131]
    v_mfma_f32_16x16x32_bf16 v[144:147], v[208:211], v[168:171], v[144:147]
    v_mfma_f32_16x16x32_bf16 v[140:143], v[168:171], v[204:207], v[140:143]
    v_mfma_f32_16x16x32_bf16 v[136:139], v[200:203], v[168:171], v[136:139]
    v_mfma_f32_16x16x32_bf16 v[132:135], v[196:199], v[168:171], v[132:135]
    s_waitcnt lgkmcnt(0)
    s_barrier
    v_mfma_f32_16x16x32_bf16 v[52:55], v[212:215], v[172:175], v[52:55]
    ds_read_b64_tr_b16 v[196:197], v47 offset:0
    v_mfma_f32_16x16x32_bf16 v[56:59], v[216:219], v[172:175], v[56:59]
    ds_read_b64_tr_b16 v[198:199], v47 offset:1024
    v_mfma_f32_16x16x32_bf16 v[60:63], v[172:175], v[220:223], v[60:63]
    ds_read_b128 v[148:151], v41 offset:0
    v_mfma_f32_16x16x32_bf16 v[64:67], v[224:227], v[172:175], v[64:67]
    ds_read_b64_tr_b16 v[200:201], v48 offset:0
    v_mfma_f32_16x16x32_bf16 v[80:83], v[224:227], v[176:179], v[80:83]
    ds_read_b64_tr_b16 v[202:203], v48 offset:1024
    v_mfma_f32_16x16x32_bf16 v[76:79], v[176:179], v[220:223], v[76:79]
    ds_read_b128 v[152:155], v41 offset:2048
    v_mfma_f32_16x16x32_bf16 v[72:75], v[216:219], v[176:179], v[72:75]
    ds_read_b64_tr_b16 v[204:205], v49 offset:0
    v_mfma_f32_16x16x32_bf16 v[68:71], v[212:215], v[176:179], v[68:71]
    ds_read_b64_tr_b16 v[206:207], v49 offset:1024
    v_mfma_f32_16x16x32_bf16 v[84:87], v[212:215], v[180:183], v[84:87]
    ds_read_b128 v[156:159], v41 offset:4096
    v_mfma_f32_16x16x32_bf16 v[88:91], v[216:219], v[180:183], v[88:91]
    ds_read_b64_tr_b16 v[208:209], v50 offset:0
    v_mfma_f32_16x16x32_bf16 v[92:95], v[180:183], v[220:223], v[92:95]
    ds_read_b64_tr_b16 v[210:211], v50 offset:1024
    v_mfma_f32_16x16x32_bf16 v[96:99], v[224:227], v[180:183], v[96:99]
    ds_read_b128 v[160:163], v41 offset:6144
    v_mfma_f32_16x16x32_bf16 v[112:115], v[224:227], v[184:187], v[112:115]
    ds_read_b128 v[164:167], v41 offset:8192
    v_mfma_f32_16x16x32_bf16 v[108:111], v[184:187], v[220:223], v[108:111]
    ds_read_b128 v[168:171], v41 offset:10240
    v_mfma_f32_16x16x32_bf16 v[104:107], v[216:219], v[184:187], v[104:107]
    v_mfma_f32_16x16x32_bf16 v[100:103], v[212:215], v[184:187], v[100:103]
    v_mfma_f32_16x16x32_bf16 v[116:119], v[212:215], v[188:191], v[116:119]
    v_mfma_f32_16x16x32_bf16 v[120:123], v[216:219], v[188:191], v[120:123]
    v_mfma_f32_16x16x32_bf16 v[124:127], v[188:191], v[220:223], v[124:127]
    v_mfma_f32_16x16x32_bf16 v[128:131], v[224:227], v[188:191], v[128:131]
    v_mfma_f32_16x16x32_bf16 v[144:147], v[224:227], v[192:195], v[144:147]
    v_mfma_f32_16x16x32_bf16 v[140:143], v[192:195], v[220:223], v[140:143]
    v_mfma_f32_16x16x32_bf16 v[136:139], v[216:219], v[192:195], v[136:139]
    v_mfma_f32_16x16x32_bf16 v[132:135], v[212:215], v[192:195], v[132:135]
    s_waitcnt lgkmcnt(0)
    v_mfma_f32_16x16x32_bf16 v[52:55], v[196:199], v[148:151], v[52:55]
    ds_read_b64_tr_b16 v[212:213], v47 offset:8192
    v_mfma_f32_16x16x32_bf16 v[56:59], v[200:203], v[148:151], v[56:59]
    ds_read_b64_tr_b16 v[214:215], v47 offset:9216
    v_mfma_f32_16x16x32_bf16 v[60:63], v[148:151], v[204:207], v[60:63]
    ds_read_b128 v[172:175], v42 offset:0
    v_mfma_f32_16x16x32_bf16 v[64:67], v[208:211], v[148:151], v[64:67]
    ds_read_b64_tr_b16 v[216:217], v48 offset:8192
    v_mfma_f32_16x16x32_bf16 v[80:83], v[208:211], v[152:155], v[80:83]
    ds_read_b64_tr_b16 v[218:219], v48 offset:9216
    v_mfma_f32_16x16x32_bf16 v[76:79], v[152:155], v[204:207], v[76:79]
    ds_read_b128 v[176:179], v42 offset:2048
    v_mfma_f32_16x16x32_bf16 v[72:75], v[200:203], v[152:155], v[72:75]
    ds_read_b64_tr_b16 v[220:221], v49 offset:8192
    v_mfma_f32_16x16x32_bf16 v[68:71], v[196:199], v[152:155], v[68:71]
    ds_read_b64_tr_b16 v[222:223], v49 offset:9216
    v_mfma_f32_16x16x32_bf16 v[84:87], v[196:199], v[156:159], v[84:87]
    ds_read_b128 v[180:183], v42 offset:4096
    v_mfma_f32_16x16x32_bf16 v[88:91], v[200:203], v[156:159], v[88:91]
    ds_read_b64_tr_b16 v[224:225], v50 offset:8192
    v_mfma_f32_16x16x32_bf16 v[92:95], v[156:159], v[204:207], v[92:95]
    ds_read_b64_tr_b16 v[226:227], v50 offset:9216
    v_mfma_f32_16x16x32_bf16 v[96:99], v[208:211], v[156:159], v[96:99]
    ds_read_b128 v[184:187], v42 offset:6144
    v_mfma_f32_16x16x32_bf16 v[112:115], v[208:211], v[160:163], v[112:115]
    ds_read_b128 v[188:191], v42 offset:8192
    v_mfma_f32_16x16x32_bf16 v[108:111], v[160:163], v[204:207], v[108:111]
    ds_read_b128 v[192:195], v42 offset:10240
    v_mfma_f32_16x16x32_bf16 v[104:107], v[200:203], v[160:163], v[104:107]
    v_mfma_f32_16x16x32_bf16 v[100:103], v[196:199], v[160:163], v[100:103]
    v_mfma_f32_16x16x32_bf16 v[116:119], v[196:199], v[164:167], v[116:119]
    v_mfma_f32_16x16x32_bf16 v[120:123], v[200:203], v[164:167], v[120:123]
    v_mfma_f32_16x16x32_bf16 v[124:127], v[164:167], v[204:207], v[124:127]
    v_mfma_f32_16x16x32_bf16 v[128:131], v[208:211], v[164:167], v[128:131]
    v_mfma_f32_16x16x32_bf16 v[144:147], v[208:211], v[168:171], v[144:147]
    v_mfma_f32_16x16x32_bf16 v[140:143], v[168:171], v[204:207], v[140:143]
    v_mfma_f32_16x16x32_bf16 v[136:139], v[200:203], v[168:171], v[136:139]
    v_mfma_f32_16x16x32_bf16 v[132:135], v[196:199], v[168:171], v[132:135]
    s_waitcnt lgkmcnt(0)
    s_barrier
    v_mfma_f32_16x16x32_bf16 v[52:55], v[212:215], v[172:175], v[52:55]
    ds_read_b64_tr_b16 v[196:197], v43 offset:0
    v_mfma_f32_16x16x32_bf16 v[56:59], v[216:219], v[172:175], v[56:59]
    ds_read_b64_tr_b16 v[198:199], v43 offset:1024
    v_mfma_f32_16x16x32_bf16 v[60:63], v[172:175], v[220:223], v[60:63]
    ds_read_b128 v[148:151], v39 offset:0
    v_mfma_f32_16x16x32_bf16 v[64:67], v[224:227], v[172:175], v[64:67]
    ds_read_b64_tr_b16 v[200:201], v44 offset:0
    v_mfma_f32_16x16x32_bf16 v[80:83], v[224:227], v[176:179], v[80:83]
    ds_read_b64_tr_b16 v[202:203], v44 offset:1024
    v_mfma_f32_16x16x32_bf16 v[76:79], v[176:179], v[220:223], v[76:79]
    ds_read_b128 v[152:155], v39 offset:2048
    v_mfma_f32_16x16x32_bf16 v[72:75], v[216:219], v[176:179], v[72:75]
    ds_read_b64_tr_b16 v[204:205], v45 offset:0
    v_mfma_f32_16x16x32_bf16 v[68:71], v[212:215], v[176:179], v[68:71]
    ds_read_b64_tr_b16 v[206:207], v45 offset:1024
    v_mfma_f32_16x16x32_bf16 v[84:87], v[212:215], v[180:183], v[84:87]
    ds_read_b128 v[156:159], v39 offset:4096
    v_mfma_f32_16x16x32_bf16 v[88:91], v[216:219], v[180:183], v[88:91]
    ds_read_b64_tr_b16 v[208:209], v46 offset:0
    v_mfma_f32_16x16x32_bf16 v[92:95], v[180:183], v[220:223], v[92:95]
    ds_read_b64_tr_b16 v[210:211], v46 offset:1024
    v_mfma_f32_16x16x32_bf16 v[96:99], v[224:227], v[180:183], v[96:99]
    ds_read_b128 v[160:163], v39 offset:6144
    v_mfma_f32_16x16x32_bf16 v[112:115], v[224:227], v[184:187], v[112:115]
    ds_read_b128 v[164:167], v39 offset:8192
    v_mfma_f32_16x16x32_bf16 v[108:111], v[184:187], v[220:223], v[108:111]
    ds_read_b128 v[168:171], v39 offset:10240
    v_mfma_f32_16x16x32_bf16 v[104:107], v[216:219], v[184:187], v[104:107]
    v_mfma_f32_16x16x32_bf16 v[100:103], v[212:215], v[184:187], v[100:103]
    v_mfma_f32_16x16x32_bf16 v[116:119], v[212:215], v[188:191], v[116:119]
    v_mfma_f32_16x16x32_bf16 v[120:123], v[216:219], v[188:191], v[120:123]
    v_mfma_f32_16x16x32_bf16 v[124:127], v[188:191], v[220:223], v[124:127]
    v_mfma_f32_16x16x32_bf16 v[128:131], v[224:227], v[188:191], v[128:131]
    v_mfma_f32_16x16x32_bf16 v[144:147], v[224:227], v[192:195], v[144:147]
    v_mfma_f32_16x16x32_bf16 v[140:143], v[192:195], v[220:223], v[140:143]
    v_mfma_f32_16x16x32_bf16 v[136:139], v[216:219], v[192:195], v[136:139]
    v_mfma_f32_16x16x32_bf16 v[132:135], v[212:215], v[192:195], v[132:135]
    s_waitcnt lgkmcnt(0)
    v_mfma_f32_16x16x32_bf16 v[52:55], v[196:199], v[148:151], v[52:55]
    ds_read_b64_tr_b16 v[212:213], v43 offset:8192
    v_mfma_f32_16x16x32_bf16 v[56:59], v[200:203], v[148:151], v[56:59]
    ds_read_b64_tr_b16 v[214:215], v43 offset:9216
    v_mfma_f32_16x16x32_bf16 v[60:63], v[148:151], v[204:207], v[60:63]
    ds_read_b128 v[172:175], v40 offset:0
    v_mfma_f32_16x16x32_bf16 v[64:67], v[208:211], v[148:151], v[64:67]
    ds_read_b64_tr_b16 v[216:217], v44 offset:8192
    v_mfma_f32_16x16x32_bf16 v[80:83], v[208:211], v[152:155], v[80:83]
    ds_read_b64_tr_b16 v[218:219], v44 offset:9216
    v_mfma_f32_16x16x32_bf16 v[76:79], v[152:155], v[204:207], v[76:79]
    ds_read_b128 v[176:179], v40 offset:2048
    v_mfma_f32_16x16x32_bf16 v[72:75], v[200:203], v[152:155], v[72:75]
    ds_read_b64_tr_b16 v[220:221], v45 offset:8192
    v_mfma_f32_16x16x32_bf16 v[68:71], v[196:199], v[152:155], v[68:71]
    ds_read_b64_tr_b16 v[222:223], v45 offset:9216
    v_mfma_f32_16x16x32_bf16 v[84:87], v[196:199], v[156:159], v[84:87]
    ds_read_b128 v[180:183], v40 offset:4096
    v_mfma_f32_16x16x32_bf16 v[88:91], v[200:203], v[156:159], v[88:91]
    ds_read_b64_tr_b16 v[224:225], v46 offset:8192
    v_mfma_f32_16x16x32_bf16 v[92:95], v[156:159], v[204:207], v[92:95]
    ds_read_b64_tr_b16 v[226:227], v46 offset:9216
    v_mfma_f32_16x16x32_bf16 v[96:99], v[208:211], v[156:159], v[96:99]
    ds_read_b128 v[184:187], v40 offset:6144
    v_mfma_f32_16x16x32_bf16 v[112:115], v[208:211], v[160:163], v[112:115]
    ds_read_b128 v[188:191], v40 offset:8192
    v_mfma_f32_16x16x32_bf16 v[108:111], v[160:163], v[204:207], v[108:111]
    ds_read_b128 v[192:195], v40 offset:10240
    v_mfma_f32_16x16x32_bf16 v[104:107], v[200:203], v[160:163], v[104:107]
    v_mfma_f32_16x16x32_bf16 v[100:103], v[196:199], v[160:163], v[100:103]
    v_mfma_f32_16x16x32_bf16 v[116:119], v[196:199], v[164:167], v[116:119]
    v_mfma_f32_16x16x32_bf16 v[120:123], v[200:203], v[164:167], v[120:123]
    v_mfma_f32_16x16x32_bf16 v[124:127], v[164:167], v[204:207], v[124:127]
    v_mfma_f32_16x16x32_bf16 v[128:131], v[208:211], v[164:167], v[128:131]
    v_mfma_f32_16x16x32_bf16 v[144:147], v[208:211], v[168:171], v[144:147]
    v_mfma_f32_16x16x32_bf16 v[140:143], v[168:171], v[204:207], v[140:143]
    v_mfma_f32_16x16x32_bf16 v[136:139], v[200:203], v[168:171], v[136:139]
    v_mfma_f32_16x16x32_bf16 v[132:135], v[196:199], v[168:171], v[132:135]
    s_waitcnt lgkmcnt(0)
    s_barrier
    v_mfma_f32_16x16x32_bf16 v[52:55], v[212:215], v[172:175], v[52:55]
    ds_read_b64_tr_b16 v[196:197], v43 offset:40960
    v_mfma_f32_16x16x32_bf16 v[56:59], v[216:219], v[172:175], v[56:59]
    ds_read_b64_tr_b16 v[198:199], v43 offset:41984
    v_mfma_f32_16x16x32_bf16 v[60:63], v[172:175], v[220:223], v[60:63]
    ds_read_b128 v[148:151], v39 offset:40960
    v_mfma_f32_16x16x32_bf16 v[64:67], v[224:227], v[172:175], v[64:67]
    ds_read_b64_tr_b16 v[200:201], v44 offset:40960
    v_mfma_f32_16x16x32_bf16 v[80:83], v[224:227], v[176:179], v[80:83]
    ds_read_b64_tr_b16 v[202:203], v44 offset:41984
    v_mfma_f32_16x16x32_bf16 v[76:79], v[176:179], v[220:223], v[76:79]
    ds_read_b128 v[152:155], v39 offset:43008
    v_mfma_f32_16x16x32_bf16 v[72:75], v[216:219], v[176:179], v[72:75]
    ds_read_b64_tr_b16 v[204:205], v45 offset:40960
    v_mfma_f32_16x16x32_bf16 v[68:71], v[212:215], v[176:179], v[68:71]
    ds_read_b64_tr_b16 v[206:207], v45 offset:41984
    v_mfma_f32_16x16x32_bf16 v[84:87], v[212:215], v[180:183], v[84:87]
    ds_read_b128 v[156:159], v39 offset:45056
    v_mfma_f32_16x16x32_bf16 v[88:91], v[216:219], v[180:183], v[88:91]
    ds_read_b64_tr_b16 v[208:209], v46 offset:40960
    v_mfma_f32_16x16x32_bf16 v[92:95], v[180:183], v[220:223], v[92:95]
    ds_read_b64_tr_b16 v[210:211], v46 offset:41984
    v_mfma_f32_16x16x32_bf16 v[96:99], v[224:227], v[180:183], v[96:99]
    ds_read_b128 v[160:163], v39 offset:47104
    v_mfma_f32_16x16x32_bf16 v[112:115], v[224:227], v[184:187], v[112:115]
    ds_read_b128 v[164:167], v39 offset:49152
    v_mfma_f32_16x16x32_bf16 v[108:111], v[184:187], v[220:223], v[108:111]
    ds_read_b128 v[168:171], v39 offset:51200
    v_mfma_f32_16x16x32_bf16 v[104:107], v[216:219], v[184:187], v[104:107]
    v_mfma_f32_16x16x32_bf16 v[100:103], v[212:215], v[184:187], v[100:103]
    v_mfma_f32_16x16x32_bf16 v[116:119], v[212:215], v[188:191], v[116:119]
    v_mfma_f32_16x16x32_bf16 v[120:123], v[216:219], v[188:191], v[120:123]
    v_mfma_f32_16x16x32_bf16 v[124:127], v[188:191], v[220:223], v[124:127]
    v_mfma_f32_16x16x32_bf16 v[128:131], v[224:227], v[188:191], v[128:131]
    s_branch K_PG2
.p2align 12
K_CHM2:
K_STM2:
    s_branch K_WRET_M
    s_nop 0
K_PG2:
    v_mfma_f32_16x16x32_bf16 v[144:147], v[224:227], v[192:195], v[144:147]
    v_mfma_f32_16x16x32_bf16 v[140:143], v[192:195], v[220:223], v[140:143]
    v_mfma_f32_16x16x32_bf16 v[136:139], v[216:219], v[192:195], v[136:139]
    v_mfma_f32_16x16x32_bf16 v[132:135], v[212:215], v[192:195], v[132:135]
    s_waitcnt lgkmcnt(0)
    v_mfma_f32_16x16x32_bf16 v[52:55], v[196:199], v[148:151], v[52:55]
    ds_read_b64_tr_b16 v[212:213], v43 offset:49152
    v_mfma_f32_16x16x32_bf16 v[56:59], v[200:203], v[148:151], v[56:59]
    ds_read_b64_tr_b16 v[214:215], v43 offset:50176
    v_mfma_f32_16x16x32_bf16 v[60:63], v[148:151], v[204:207], v[60:63]
    ds_read_b128 v[172:175], v40 offset:40960
    v_mfma_f32_16x16x32_bf16 v[64:67], v[208:211], v[148:151], v[64:67]
    ds_read_b64_tr_b16 v[216:217], v44 offset:49152
    v_mfma_f32_16x16x32_bf16 v[80:83], v[208:211], v[152:155], v[80:83]
    ds_read_b64_tr_b16 v[218:219], v44 offset:50176
    v_mfma_f32_16x16x32_bf16 v[76:79], v[152:155], v[204:207], v[76:79]
    ds_read_b128 v[176:179], v40 offset:43008
    v_mfma_f32_16x16x32_bf16 v[72:75], v[200:203], v[152:155], v[72:75]
    ds_read_b64_tr_b16 v[220:221], v45 offset:49152
    v_mfma_f32_16x16x32_bf16 v[68:71], v[196:199], v[152:155], v[68:71]
    ds_read_b64_tr_b16 v[222:223], v45 offset:50176
    v_mfma_f32_16x16x32_bf16 v[84:87], v[196:199], v[156:159], v[84:87]
    ds_read_b128 v[180:183], v40 offset:45056
    v_mfma_f32_16x16x32_bf16 v[88:91], v[200:203], v[156:159], v[88:91]
    ds_read_b64_tr_b16 v[224:225], v46 offset:49152
    v_mfma_f32_16x16x32_bf16 v[92:95], v[156:159], v[204:207], v[92:95]
    ds_read_b64_tr_b16 v[226:227], v46 offset:50176
    v_mfma_f32_16x16x32_bf16 v[96:99], v[208:211], v[156:159], v[96:99]
    ds_read_b128 v[184:187], v40 offset:47104
    v_mfma_f32_16x16x32_bf16 v[112:115], v[208:211], v[160:163], v[112:115]
    ds_read_b128 v[188:191], v40 offset:49152
    v_mfma_f32_16x16x32_bf16 v[108:111], v[160:163], v[204:207], v[108:111]
    ds_read_b128 v[192:195], v40 offset:51200
    v_mfma_f32_16x16x32_bf16 v[104:107], v[200:203], v[160:163], v[104:107]
    v_mfma_f32_16x16x32_bf16 v[100:103], v[196:199], v[160:163], v[100:103]
    v_mfma_f32_16x16x32_bf16 v[116:119], v[196:199], v[164:167], v[116:119]
    v_mfma_f32_16x16x32_bf16 v[120:123], v[200:203], v[164:167], v[120:123]
    v_mfma_f32_16x16x32_bf16 v[124:127], v[164:167], v[204:207], v[124:127]
    v_mfma_f32_16x16x32_bf16 v[128:131], v[208:211], v[164:167], v[128:131]
    v_mfma_f32_16x16x32_bf16 v[144:147], v[208:211], v[168:171], v[144:147]
    v_mfma_f32_16x16x32_bf16 v[140:143], v[168:171], v[204:207], v[140:143]
    v_mfma_f32_16x16x32_bf16 v[136:139], v[200:203], v[168:171], v[136:139]
    v_mfma_f32_16x16x32_bf16 v[132:135], v[196:199], v[168:171], v[132:135]
    s_waitcnt lgkmcnt(0)
    s_barrier
    v_mfma_f32_16x16x32_bf16 v[52:55], v[212:215], v[172:175], v[52:55]
    ds_read_b64_tr_b16 v[196:197], v47 offset:0
    v_mfma_f32_16x16x32_bf16 v[56:59], v[216:219], v[172:175], v[56:59]
    ds_read_b64_tr_b16 v[198:199], v47 offset:1024
    v_mfma_f32_16x16x32_bf16 v[60:63], v[172:175], v[220:223], v[60:63]
    ds_read_b128 v[148:151], v41 offset:0
    v_mfma_f32_16x16x32_bf16 v[64:67], v[224:227], v[172:175], v[64:67]
    ds_read_b64_tr_b16 v[200:201], v48 offset:0
    v_mfma_f32_16x16x32_bf16 v[80:83], v[224:227], v[176:179], v[80:83]
    ds_read_b64_tr_b16 v[202:203], v48 offset:1024
    v_mfma_f32_16x16x32_bf16 v[76:79], v[176:179], v[220:223], v[76:79]
    ds_read_b128 v[152:155], v41 offset:2048
    v_mfma_f32_16x16x32_bf16 v[72:75], v[216:219], v[176:179], v[72:75]
    ds_read_b64_tr_b16 v[204:205], v49 offset:0
    v_mfma_f32_16x16x32_bf16 v[68:71], v[212:215], v[176:179], v[68:71]
    ds_read_b64_tr_b16 v[206:207], v49 offset:1024
    v_mfma_f32_16x16x32_bf16 v[84:87], v[212:215], v[180:183], v[84:87]
    ds_read_b128 v[156:159], v41 offset:4096
    v_mfma_f32_16x16x32_bf16 v[88:91], v[216:219], v[180:183], v[88:91]
    ds_read_b64_tr_b16 v[208:209], v50 offset:0
    v_mfma_f32_16x16x32_bf16 v[92:95], v[180:183], v[220:223], v[92:95]
    ds_read_b64_tr_b16 v[210:211], v50 offset:1024
    v_mfma_f32_16x16x32_bf16 v[96:99], v[224:227], v[180:183], v[96:99]
    ds_read_b128 v[160:163], v41 offset:6144
    v_mfma_f32_16x16x32_bf16 v[112:115], v[224:227], v[184:187], v[112:115]
    ds_read_b128 v[164:167], v41 offset:8192
    v_mfma_f32_16x16x32_bf16 v[108:111], v[184:187], v[220:223], v[108:111]
    ds_read_b128 v[168:171], v41 offset:10240
    v_mfma_f32_16x16x32_bf16 v[104:107], v[216:219], v[184:187], v[104:107]
    v_mfma_f32_16x16x32_bf16 v[100:103], v[212:215], v[184:187], v[100:103]
    v_mfma_f32_16x16x32_bf16 v[116:119], v[212:215], v[188:191], v[116:119]
    v_mfma_f32_16x16x32_bf16 v[120:123], v[216:219], v[188:191], v[120:123]
    v_mfma_f32_16x16x32_bf16 v[124:127], v[188:191], v[220:223], v[124:127]
    v_mfma_f32_16x16x32_bf16 v[128:131], v[224:227], v[188:191], v[128:131]
    v_mfma_f32_16x16x32_bf16 v[144:147], v[224:227], v[192:195], v[144:147]
    v_mfma_f32_16x16x32_bf16 v[140:143], v[192:195], v[220:223], v[140:143]
    v_mfma_f32_16x16x32_bf16 v[136:139], v[216:219], v[192:195], v[136:139]
    v_mfma_f32_16x16x32_bf16 v[132:135], v[212:215], v[192:195], v[132:135]
    s_waitcnt lgkmcnt(0)
    v_mfma_f32_16x16x32_bf16 v[132:135], v[196:199], v[168:171], v[132:135]
    ds_read_b64_tr_b16 v[212:213], v47 offset:8192
    ds_read_b64_tr_b16 v[214:215], v47 offset:9216
    v_mfma_f32_16x16x32_bf16 v[136:139], v[200:203], v[168:171], v[136:139]
    ds_read_b128 v[192:195], v42 offset:10240
    ds_read_b64_tr_b16 v[216:217], v48 offset:8192
    v_mfma_f32_16x16x32_bf16 v[140:143], v[168:171], v[204:207], v[140:143]
    ds_read_b64_tr_b16 v[218:219], v48 offset:9216
    ds_read_b64_tr_b16 v[220:221], v49 offset:8192
    v_mfma_f32_16x16x32_bf16 v[144:147], v[208:211], v[168:171], v[144:147]
    ds_read_b64_tr_b16 v[222:223], v49 offset:9216
    ds_read_b64_tr_b16 v[224:225], v50 offset:8192
    v_mfma_f32_16x16x32_bf16 v[116:119], v[196:199], v[164:167], v[116:119]
    ds_read_b64_tr_b16 v[226:227], v50 offset:9216
    ds_read_b128 v[188:191], v42 offset:8192
    v_mfma_f32_16x16x32_bf16 v[120:123], v[200:203], v[164:167], v[120:123]
    ds_read_b128 v[184:187], v42 offset:6144
    ds_read_b128 v[180:183], v42 offset:4096
    v_mfma_f32_16x16x32_bf16 v[124:127], v[164:167], v[204:207], v[124:127]
    ds_read_b128 v[176:179], v42 offset:2048
    ds_read_b128 v[172:175], v42 offset:0
    v_mfma_f32_16x16x32_bf16 v[128:131], v[208:211], v[164:167], v[128:131]
    s_waitcnt lgkmcnt(11)
    v_mfma_f32_16x16x32_bf16 v[132:135], v[212:215], v[192:195], v[132:135]
    s_waitcnt lgkmcnt(9)
    v_mfma_f32_16x16x32_bf16 v[136:139], v[216:219], v[192:195], v[136:139]
    s_waitcnt lgkmcnt(7)
    v_mfma_f32_16x16x32_bf16 v[140:143], v[192:195], v[220:223], v[140:143]
    s_waitcnt lgkmcnt(5)
    v_mfma_f32_16x16x32_bf16 v[144:147], v[224:227], v[192:195], v[144:147]
    s_waitcnt lgkmcnt(4)
    v_mfma_f32_16x16x32_bf16 v[116:119], v[212:215], v[188:191], v[116:119]
    v_cvt_pk_bf16_f32 v132, v132, v133
    v_cvt_pk_bf16_f32 v133, v134, v135
    v_mfma_f32_16x16x32_bf16 v[120:123], v[216:219], v[188:191], v[120:123]
    v_cvt_pk_bf16_f32 v136, v136, v137
    v_cvt_pk_bf16_f32 v137, v138, v139
    v_mfma_f32_16x16x32_bf16 v[124:127], v[188:191], v[220:223], v[124:127]
    v_mov_b32 v138, 0
    v_mov_b32 v139, 0
    v_mfma_f32_16x16x32_bf16 v[128:131], v[224:227], v[188:191], v[128:131]
    v_cvt_pk_bf16_f32 v134, v144, v145
    v_cvt_pk_bf16_f32 v135, v146, v147
    v_mfma_f32_16x16x32_bf16 v[100:103], v[196:199], v[160:163], v[100:103]
    v_cvt_pk_bf16_f32 v254, v140, v141
    v_cvt_pk_bf16_f32 v255, v142, v143
    v_mfma_f32_16x16x32_bf16 v[104:107], v[200:203], v[160:163], v[104:107]
    v_permlane16_swap_b32 v134, v138
    v_permlane16_swap_b32 v135, v139
    ds_write_b64 v32, v[134:135] offset:768
    v_mfma_f32_16x16x32_bf16 v[108:111], v[160:163], v[204:207], v[108:111]
    ds_read_b64_tr_b16 v[240:241], v33 offset:768
    s_cmp_lg_u32 s54, 0
    s_cbranch_scc1 K_NOX
    ds_write_b64 v34, v[132:133]
    ds_write_b64 v34, v[134:135] offset:512
    ds_write_b64 v34, v[254:255] offset:1024
    v_lshl_add_u32 v2, s55, 2, v38
    ds_write_b16 v2, v38 offset:30
K_NOX:
    v_mfma_f32_16x16x32_bf16 v[112:115], v[208:211], v[160:163], v[112:115]
    v_cvt_pk_bf16_f32 v116, v116, v117
    v_cvt_pk_bf16_f32 v117, v118, v119
    v_mfma_f32_16x16x32_bf16 v[192:195], v[132:135], v[136:139], v[16:19]
    v_cvt_pk_bf16_f32 v120, v120, v121
    v_cvt_pk_bf16_f32 v121, v122, v123
    s_waitcnt lgkmcnt(5)
    v_mfma_f32_16x16x32_bf16 v[100:103], v[212:215], v[184:187], v[100:103]
    v_mov_b32 v122, 0
    v_mov_b32 v123, 0
    v_mfma_f32_16x16x32_bf16 v[104:107], v[216:219], v[184:187], v[104:107]
    v_cvt_pk_bf16_f32 v118, v128, v129
    v_cvt_pk_bf16_f32 v119, v130, v131
    v_mfma_f32_16x16x32_bf16 v[108:111], v[184:187], v[220:223], v[108:111]
    v_cvt_pk_bf16_f32 v252, v124, v125
    v_cvt_pk_bf16_f32 v253, v126, v127
    v_mfma_f32_16x16x32_bf16 v[112:115], v[224:227], v[184:187], v[112:115]
    v_permlane16_swap_b32 v118, v122
    v_permlane16_swap_b32 v119, v123
    ds_write_b64 v32, v[118:119] offset:640
    v_mfma_f32_16x16x32_bf16 v[84:87], v[196:199], v[156:159], v[84:87]
    ds_read_b64_tr_b16 v[238:239], v33 offset:640
    v_cvt_pk_bf16_f32 v100, v100, v101
    v_mfma_f32_16x16x32_bf16 v[88:91], v[200:203], v[156:159], v[88:91]
    v_cvt_pk_bf16_f32 v101, v102, v103
    v_cvt_pk_bf16_f32 v104, v104, v105
    v_mfma_f32_16x16x32_bf16 v[168:171], v[116:119], v[136:139], v[12:15]
    v_cvt_pk_bf16_f32 v105, v106, v107
    v_mov_b32 v106, 0
    v_mfma_f32_16x16x32_bf16 v[92:95], v[156:159], v[204:207], v[92:95]
    v_mov_b32 v107, 0
    v_cvt_pk_bf16_f32 v102, v112, v113
    v_mfma_f32_16x16x32_bf16 v[188:191], v[116:119], v[120:123], v[16:19]
    v_cvt_pk_bf16_f32 v103, v114, v115
    v_cvt_pk_bf16_f32 v250, v108, v109
    v_mfma_f32_16x16x32_bf16 v[96:99], v[208:211], v[156:159], v[96:99]
    v_cvt_pk_bf16_f32 v251, v110, v111
    v_permlane16_swap_b32 v102, v106
    s_waitcnt lgkmcnt(6)
    v_mfma_f32_16x16x32_bf16 v[84:87], v[212:215], v[180:183], v[84:87]
    v_permlane16_swap_b32 v103, v107
    ds_write_b64 v32, v[102:103] offset:512
    v_mfma_f32_16x16x32_bf16 v[88:91], v[216:219], v[180:183], v[88:91]
    ds_read_b64_tr_b16 v[236:237], v33 offset:512
    v_max3_f32 v168, v168, v169, v192
    v_mfma_f32_16x16x32_bf16 v[92:95], v[180:183], v[220:223], v[92:95]
    v_max3_f32 v170, v170, v171, v194
    v_max_f32 v168, v168, v193
    v_mfma_f32_16x16x32_bf16 v[164:167], v[100:103], v[120:123], v[12:15]
    v_max_f32 v169, v170, v195
    v_cvt_pk_bf16_f32 v168, v168, v169
    v_mfma_f32_16x16x32_bf16 v[96:99], v[224:227], v[180:183], v[96:99]
    v_cvt_pk_bf16_f32 v84, v84, v85
    v_cvt_pk_bf16_f32 v85, v86, v87
    v_mfma_f32_16x16x32_bf16 v[184:187], v[100:103], v[104:107], v[16:19]
    v_cvt_pk_bf16_f32 v88, v88, v89
    v_cvt_pk_bf16_f32 v89, v90, v91
    v_mfma_f32_16x16x32_bf16 v[68:71], v[196:199], v[152:155], v[68:71]
    v_mov_b32 v90, 0
    v_mov_b32 v91, 0
    v_mfma_f32_16x16x32_bf16 v[72:75], v[200:203], v[152:155], v[72:75]
    v_max3_f32 v164, v164, v165, v188
    v_max3_f32 v166, v166, v167, v190
    v_mfma_f32_16x16x32_bf16 v[76:79], v[152:155], v[204:207], v[76:79]
    v_max_f32 v164, v164, v189
    v_max_f32 v165, v166, v191
    v_mfma_f32_16x16x32_bf16 v[80:83], v[208:211], v[152:155], v[80:83]
    v_cvt_pk_bf16_f32 v164, v164, v165
    v_cvt_pk_bf16_f32 v86, v96, v97
    s_waitcnt lgkmcnt(7)
    v_mfma_f32_16x16x32_bf16 v[68:71], v[212:215], v[176:179], v[68:71]
    v_cvt_pk_bf16_f32 v87, v98, v99
    v_cvt_pk_bf16_f32 v248, v92, v93
    v_mfma_f32_16x16x32_bf16 v[72:75], v[216:219], v[176:179], v[72:75]
    v_cvt_pk_bf16_f32 v249, v94, v95
    v_permlane16_swap_b32 v86, v90
    v_mfma_f32_16x16x32_bf16 v[76:79], v[176:179], v[220:223], v[76:79]
    v_permlane16_swap_b32 v87, v91
    ds_write_b64 v32, v[86:87] offset:384
    v_mfma_f32_16x16x32_bf16 v[80:83], v[224:227], v[176:179], v[80:83]
    ds_read_b64_tr_b16 v[234:235], v33 offset:384
    v_lshl_add_u32 v2, s55, 2, v38
    v_mfma_f32_16x16x32_bf16 v[52:55], v[196:199], v[148:151], v[52:55]
    ds_read_b32 v3, v2 offset:28
    ds_read_b64 v[144:145], v34
    v_mfma_f32_16x16x32_bf16 v[160:163], v[84:87], v[104:107], v[12:15]
    ds_read_b64 v[146:147], v34 offset:512
    ds_read_b64 v[242:243], v34 offset:1024
    v_mfma_f32_16x16x32_bf16 v[56:59], v[200:203], v[148:151], v[56:59]
    ds_read_b64_tr_b16 v[228:229], v33
    v_cvt_pk_bf16_f32 v68, v68, v69
    v_mfma_f32_16x16x32_bf16 v[180:183], v[84:87], v[88:91], v[16:19]
    v_cvt_pk_bf16_f32 v69, v70, v71
    v_cvt_pk_bf16_f32 v72, v72, v73
    v_mfma_f32_16x16x32_bf16 v[60:63], v[148:151], v[204:207], v[60:63]
    v_cvt_pk_bf16_f32 v73, v74, v75
    v_mov_b32 v74, 0
    v_mfma_f32_16x16x32_bf16 v[64:67], v[208:211], v[148:151], v[64:67]
    v_mov_b32 v75, 0
    v_cvt_pk_bf16_f32 v70, v80, v81
    s_waitcnt lgkmcnt(13)
    v_mfma_f32_16x16x32_bf16 v[52:55], v[212:215], v[172:175], v[52:55]
    v_cvt_pk_bf16_f32 v71, v82, v83
    v_cvt_pk_bf16_f32 v246, v76, v77
    v_mfma_f32_16x16x32_bf16 v[56:59], v[216:219], v[172:175], v[56:59]
    v_cvt_pk_bf16_f32 v247, v78, v79
    v_permlane16_swap_b32 v70, v74
    v_mfma_f32_16x16x32_bf16 v[60:63], v[172:175], v[220:223], v[60:63]
    v_permlane16_swap_b32 v71, v75
    ds_write_b64 v32, v[70:71] offset:256
    v_mfma_f32_16x16x32_bf16 v[64:67], v[224:227], v[172:175], v[64:67]
    ds_read_b64_tr_b16 v[232:233], v33 offset:256
    v_max3_f32 v160, v160, v161, v184
    v_max3_f32 v162, v162, v163, v186
    v_max_f32 v160, v160, v185
    v_max_f32 v161, v162, v187
    v_mfma_f32_16x16x32_bf16 v[156:159], v[68:71], v[88:91], v[12:15]
    v_cvt_pk_bf16_f32 v160, v160, v161
    v_cvt_pk_bf16_f32 v52, v52, v53
    v_cvt_pk_bf16_f32 v53, v54, v55
    v_mfma_f32_16x16x32_bf16 v[176:179], v[68:71], v[72:75], v[16:19]
    v_cvt_pk_bf16_f32 v56, v56, v57
    v_cvt_pk_bf16_f32 v57, v58, v59
    v_mov_b32 v58, 0
    v_mov_b32 v59, 0
    v_cvt_pk_bf16_f32 v54, v64, v65
    v_cvt_pk_bf16_f32 v55, v66, v67
    v_cvt_pk_bf16_f32 v244, v60, v61
    v_cvt_pk_bf16_f32 v245, v62, v63
    v_permlane16_swap_b32 v54, v58
    v_permlane16_swap_b32 v55, v59
    ds_write_b64 v32, v[54:55] offset:128
    ds_read_b64_tr_b16 v[230:231], v33 offset:128
    v_max3_f32 v156, v156, v157, v180
    v_max3_f32 v158, v158, v159, v182
    v_max_f32 v156, v156, v181
    v_mfma_f32_16x16x32_bf16 v[152:155], v[52:55], v[72:75], v[20:23]
    v_max_f32 v157, v158, v183
    v_cvt_pk_bf16_f32 v156, v156, v157
    v_mfma_f32_16x16x32_bf16 v[172:175], v[52:55], v[56:59], v[16:19]
    s_waitcnt lgkmcnt(4)
    v_readfirstlane_b32 s33, v3
    s_cmp_lt_u32 s33, 1811939328
    s_cbranch_scc1 K_XW
K_XR:
    v_mfma_f32_16x16x32_bf16 v[148:151], v[144:147], v[56:59], v[12:15]
    v_max3_f32 v152, v152, v153, v176
    v_max3_f32 v154, v154, v155, v178
    v_max_f32 v152, v152, v177
    v_max_f32 v153, v154, v179
    v_cvt_pk_bf16_f32 v152, v152, v153
    v_permlane16_swap_b32 v164, v168
    v_permlane16_swap_b32 v156, v160
    s_nop 1
    v_max3_f32 v148, v148, v149, v172
    v_max3_f32 v150, v150, v151, v174
    v_max_f32 v148, v148, v173
    v_max_f32 v149, v150, v175
    v_cvt_pk_bf16_f32 v148, v148, v149
    v_permlane32_swap_b32 v156, v164
    v_permlane32_swap_b32 v160, v168
    v_lshlrev_b32 v220, 16, v156
    v_and_b32 v221, 0xffff0000, v156
    v_lshlrev_b32 v224, 16, v164
    v_and_b32 v225, 0xffff0000, v164
    v_lshlrev_b32 v222, 16, v160
    v_and_b32 v223, 0xffff0000, v160
    v_lshlrev_b32 v226, 16, v168
    v_and_b32 v227, 0xffff0000, v168
    v_permlane16_swap_b32 v148, v152
    v_lshlrev_b32 v216, 16, v148
    v_and_b32 v217, 0xffff0000, v148
    v_lshlrev_b32 v218, 16, v152
    v_and_b32 v219, 0xffff0000, v152
    v_pk_mul_f32 v[220:221], v[220:221], s[60:61]
    v_pk_mul_f32 v[224:225], v[224:225], s[60:61]
    v_pk_mul_f32 v[222:223], v[222:223], s[60:61]
    v_pk_mul_f32 v[226:227], v[226:227], s[60:61]
    v_pk_mul_f32 v[216:217], v[216:217], s[60:61]
    v_pk_mul_f32 v[218:219], v[218:219], s[60:61]
    v_cvt_pk_bf16_f32 v156, v220, v221
    v_cvt_pk_bf16_f32 v164, v224, v225
    v_cvt_pk_bf16_f32 v160, v222, v223
    v_cvt_pk_bf16_f32 v168, v226, v227
    v_cvt_pk_bf16_f32 v148, v216, v217
    v_cvt_pk_bf16_f32 v152, v218, v219
    v_lshlrev_b32 v218, 16, v152
    v_and_b32 v219, 0xffff0000, v152
    v_lshlrev_b32 v216, 16, v148
    v_and_b32 v217, 0xffff0000, v148
    v_lshlrev_b32 v226, 16, v168
    v_and_b32 v227, 0xffff0000, v168
    v_lshlrev_b32 v222, 16, v160
    v_and_b32 v223, 0xffff0000, v160
    v_lshlrev_b32 v224, 16, v164
    v_and_b32 v225, 0xffff0000, v164
    v_lshlrev_b32 v220, 16, v156
    v_and_b32 v221, 0xffff0000, v156
    v_max3_f32 v174, v216, v217, v218
    v_max3_f32 v172, v220, v221, v224
    v_max_f32 v174, v174, v219
    v_max3_f32 v172, v172, v225, v222
    v_mov_b32 v176, v174
    v_max3_f32 v172, v172, v223, v226
    v_max_f32 v172, v172, v227
    v_permlane32_swap_b32 v174, v176
    v_mul_f32 v172, s58, v172
    v_max_f32 v174, v174, v176
    v_mul_f32 v174, s58, v174
    v_pk_fma_f32 v[220:221], v[220:221], s[58:59], v[172:173] op_sel_hi:[1,1,0] neg_lo:[0,0,1] neg_hi:[0,0,1]
    v_pk_fma_f32 v[222:223], v[222:223], s[58:59], v[172:173] op_sel_hi:[1,1,0] neg_lo:[0,0,1] neg_hi:[0,0,1]
    v_pk_fma_f32 v[224:225], v[224:225], s[58:59], v[172:173] op_sel_hi:[1,1,0] neg_lo:[0,0,1] neg_hi:[0,0,1]
    v_pk_fma_f32 v[226:227], v[226:227], s[58:59], v[172:173] op_sel_hi:[1,1,0] neg_lo:[0,0,1] neg_hi:[0,0,1]
    v_pk_fma_f32 v[216:217], v[216:217], s[58:59], v[174:175] op_sel_hi:[1,1,0] neg_lo:[0,0,1] neg_hi:[0,0,1]
    v_pk_fma_f32 v[218:219], v[218:219], s[58:59], v[174:175] op_sel_hi:[1,1,0] neg_lo:[0,0,1] neg_hi:[0,0,1]
    v_exp_f32 v216, v216
    v_exp_f32 v217, v217
    v_exp_f32 v218, v218
    v_exp_f32 v219, v219
    v_exp_f32 v220, v220
    v_exp_f32 v221, v221
    v_exp_f32 v222, v222
    v_exp_f32 v223, v223
    v_exp_f32 v224, v224
    v_exp_f32 v225, v225
    v_exp_f32 v226, v226
    v_exp_f32 v227, v227
    ds_read_b32 v3, v2 offset:28
    v_pk_add_f32 v[174:175], v[216:217], v[218:219]
    v_pk_add_f32 v[172:173], v[220:221], v[222:223]
    v_add_f32 v174, v174, v175
    v_pk_add_f32 v[178:179], v[224:225], v[226:227]
    v_mov_b32 v176, v174
    v_pk_add_f32 v[172:173], v[172:173], v[178:179]
    v_add_f32 v172, v172, v173
    v_permlane32_swap_b32 v174, v176
    v_rcp_f32 v172, v172
    v_add_f32 v174, v174, v176
    v_rcp_f32 v174, v174
    v_pk_mul_f32 v[220:221], v[220:221], v[172:173] op_sel_hi:[1,0]
    v_pk_mul_f32 v[222:223], v[222:223], v[172:173] op_sel_hi:[1,0]
    v_pk_mul_f32 v[224:225], v[224:225], v[172:173] op_sel_hi:[1,0]
    v_pk_mul_f32 v[226:227], v[226:227], v[172:173] op_sel_hi:[1,0]
    v_pk_mul_f32 v[216:217], v[216:217], v[174:175] op_sel_hi:[1,0]
    v_pk_mul_f32 v[218:219], v[218:219], v[174:175] op_sel_hi:[1,0]
    v_cvt_pk_bf16_f32 v156, v220, v221
    v_cvt_pk_bf16_f32 v164, v224, v225
    v_cvt_pk_bf16_f32 v160, v222, v223
    v_cvt_pk_bf16_f32 v168, v226, v227
    v_cvt_pk_bf16_f32 v148, v216, v217
    v_cvt_pk_bf16_f32 v152, v218, v219
    v_permlane32_swap_b32 v156, v164
    v_permlane32_swap_b32 v160, v168
    v_permlane16_swap_b32 v148, v152
    s_waitcnt lgkmcnt(0)
    v_permlane16_swap_b32 v156, v160
    v_permlane16_swap_b32 v164, v168
    v_readfirstlane_b32 s33, v3
    s_cmp_lt_u32 s33, 1811939332
    s_cbranch_scc1 K_PW
K_PR:
    s_and_b32 s3, s36, 0xffc00
    s_cbranch_scc0 K_NOHa3
    v_mov_b32 v4, s36
    s_mov_b32 exec_lo, s37
    s_mov_b32 exec_hi, 0
    global_atomic_add v37, v4, s[6:7] sc1
    s_mov_b64 exec, -1
K_NOHa3:
    v_perm_b32 v56, v148, v148, v24
    v_perm_b32 v57, v148, v148, v25
    v_perm_b32 v58, v148, v148, v26
    v_perm_b32 v59, v148, v148, v27
    v_perm_b32 v72, v152, v152, v24
    v_perm_b32 v73, v152, v152, v25
    v_mfma_f32_16x16x32_bf16 v[64:67], v[228:231], v[56:59], 0
    v_perm_b32 v74, v152, v152, v26
    v_perm_b32 v75, v152, v152, v27
    v_mfma_f32_16x16x32_bf16 v[60:63], v[242:245], v[56:59], 0
    v_perm_b32 v88, v156, v156, v24
    v_perm_b32 v89, v156, v156, v25
    v_mfma_f32_16x16x32_bf16 v[80:83], v[230:233], v[72:75], 0
    v_perm_b32 v90, v156, v156, v26
    v_perm_b32 v91, v156, v156, v27
    v_mfma_f32_16x16x32_bf16 v[76:79], v[244:247], v[72:75], 0
    v_perm_b32 v104, v160, v160, v24
    v_perm_b32 v105, v160, v160, v25
    v_mfma_f32_16x16x32_bf16 v[96:99], v[232:235], v[88:91], 0
    v_perm_b32 v106, v160, v160, v26
    v_perm_b32 v107, v160, v160, v27
    v_mfma_f32_16x16x32_bf16 v[92:95], v[246:249], v[88:91], 0
    v_cvt_pk_bf16_f32 v68, v64, v65
    v_cvt_pk_bf16_f32 v69, v66, v67
    ds_write_b64 v35, v[68:69] offset:0
    v_perm_b32 v120, v164, v164, v24
    v_perm_b32 v121, v164, v164, v25
    v_mfma_f32_16x16x32_bf16 v[112:115], v[234:237], v[104:107], 0
    v_perm_b32 v122, v164, v164, v26
    v_perm_b32 v123, v164, v164, v27
    v_mfma_f32_16x16x32_bf16 v[108:111], v[248:251], v[104:107], 0
    v_cvt_pk_bf16_f32 v70, v80, v81
    v_cvt_pk_bf16_f32 v71, v82, v83
    ds_write_b64 v35, v[70:71] offset:256
    v_perm_b32 v136, v168, v168, v24
    v_perm_b32 v137, v168, v168, v25
    v_mfma_f32_16x16x32_bf16 v[128:131], v[236:239], v[120:123], 0
    v_perm_b32 v138, v168, v168, v26
    v_perm_b32 v139, v168, v168, v27
    v_mfma_f32_16x16x32_bf16 v[124:127], v[250:253], v[120:123], 0
    v_cvt_pk_bf16_f32 v100, v96, v97
    v_cvt_pk_bf16_f32 v101, v98, v99
    ds_write_b64 v35, v[100:101] offset:512
    v_mov_b32 v3, 1
    v_mfma_f32_16x16x32_bf16 v[144:147], v[238:241], v[136:139], 0
    s_and_b32 s3, s36, 0x3ff
    s_cbranch_scc0 K_NOHa4
    v_mov_b32 v4, s36
    s_mov_b32 exec_lo, s37
    s_mov_b32 exec_hi, 0
    global_atomic_add v37, v4, s[6:7] sc1
    s_mov_b64 exec, -1
K_NOHa4:
    v_lshl_add_u32 v2, s54, 2, v38
    v_cvt_pk_bf16_f32 v102, v112, v113
    v_cvt_pk_bf16_f32 v103, v114, v115
    ds_write_b64 v35, v[102:103] offset:768
    v_mfma_f32_16x16x32_bf16 v[140:143], v[252:255], v[136:139], 0
    v_cvt_pk_bf16_f32 v132, v128, v129
    v_cvt_pk_bf16_f32 v133, v130, v131
    ds_write_b64 v35, v[132:133] offset:1024
    v_cvt_pk_bf16_f32 v134, v144, v145
    v_cvt_pk_bf16_f32 v135, v146, v147
    ds_write_b64 v35, v[134:135] offset:1280
    s_mov_b64 exec, 1
    ds_add_u32 v2, v3 offset:48
    s_mov_b64 exec, -1
    v_cvt_pk_bf16_f32 v52, v60, v61
    v_cvt_pk_bf16_f32 v54, v76, v77
    v_cvt_pk_bf16_f32 v53, v62, v63
    v_cvt_pk_bf16_f32 v55, v78, v79
    s_nop 0
    v_permlane16_swap_b32 v52, v54
    v_permlane16_swap_b32 v53, v55
    v_min_u32 v52, -2, v52
    buffer_store_dwordx4 v[52:55], v28, s[20:23], 0 offen sc1
    v_cvt_pk_bf16_f32 v84, v92, v93
    v_cvt_pk_bf16_f32 v86, v108, v109
    v_cvt_pk_bf16_f32 v85, v94, v95
    v_cvt_pk_bf16_f32 v87, v110, v111
    s_nop 0
    v_permlane16_swap_b32 v84, v86
    v_permlane16_swap_b32 v85, v87
    v_min_u32 v84, -2, v84
    buffer_store_dwordx4 v[84:87], v29, s[20:23], 0 offen sc1
    ds_read_b32 v3, v2 offset:48
    ds_read_b128 v[196:199], v36
    v_cvt_pk_bf16_f32 v116, v124, v125
    v_cvt_pk_bf16_f32 v118, v140, v141
    v_cvt_pk_bf16_f32 v117, v126, v127
    v_cvt_pk_bf16_f32 v119, v142, v143
    s_nop 0
    v_permlane16_swap_b32 v116, v118
    v_permlane16_swap_b32 v117, v119
    v_min_u32 v116, -2, v116
    buffer_store_dwordx4 v[116:119], v30, s[20:23], 0 offen sc1
    s_waitcnt lgkmcnt(0)
    v_readfirstlane_b32 s33, v3
    s_cmp_lt_u32 s33, 2
    s_cbranch_scc1 K_TW
K_TR:
    v_min_u32 v196, -2, v196
    buffer_store_dwordx4 v[196:199], v31, s[20:23], 0 offen sc1
    s_cmp_eq_u32 s34, -1
    s_cbranch_scc1 K_END
    s_add_u32 s30, s30, 4
    s_branch K_P2_HELP
K_CHM3:
K_STM3:
    s_branch K_WRET_M
    s_nop 0
K_XW:
    s_mov_b32 s3, 1048576
K_CGX:
    ds_read_b32 v3, v2 offset:28
    s_sub_u32 s3, s3, 1
    s_waitcnt lgkmcnt(0)
    v_readfirstlane_b32 s33, v3
    s_cselect_b32 s33, 1811939328, s33
    s_cmp_lt_u32 s33, 1811939328
    s_cbranch_scc1 K_CGX
    ds_read_b64 v[144:145], v34
    ds_read_b64 v[146:147], v34 offset:512
    ds_read_b64 v[242:243], v34 offset:1024
    ds_read_b64_tr_b16 v[228:229], v33
    s_waitcnt lgkmcnt(0)
    s_branch K_XR
K_PW:
    s_mov_b32 s3, 1048576
K_CGP:
    ds_read_b32 v3, v2 offset:28
    s_sub_u32 s3, s3, 1
    s_waitcnt lgkmcnt(0)
    v_readfirstlane_b32 s33, v3
    s_cselect_b32 s33, 1811939332, s33
    s_cmp_lt_u32 s33, 1811939332
    s_cbranch_scc1 K_CGP
    s_branch K_PR
K_TW:
    s_mov_b32 s3, 1048576
K_CGT:
    ds_read_b32 v3, v2 offset:48
    s_sub_u32 s3, s3, 1
    s_waitcnt lgkmcnt(0)
    v_readfirstlane_b32 s33, v3
    s_cselect_b32 s33, 2, s33
    s_cmp_lt_u32 s33, 2
    s_cbranch_scc1 K_CGT
    ds_read_b128 v[196:199], v36
    s_waitcnt lgkmcnt(0)
    s_branch K_TR
K_P2_EARLY:
    s_lshl_b32 s62, s40, 7
    v_lshrrev_b32 v8, 3, v1
    v_lshrrev_b32 v9, 4, v1
    v_mov_b32 v15, 158720
    s_lshl_b32 s61, s40, 3
    s_add_u32 s61, s61, s30
    s_mul_i32 s3, s61, 20480
    s_lshl_b32 s33, s41, 7
    s_add_u32 s3, s3, s33
    v_and_b32 v2, 7, v1
    v_lshlrev_b32 v2, 4, v2
    v_mul_u32_u24 v4, 1280, v8
    v_add3_u32 v10, v2, v4, s3
    s_lshl_b32 s3, s30, 7
    s_add_u32 s3, s3, 159744
    v_lshl_add_u32 v11, v8, 3, s3
    s_mov_b32 s63, 10240
    s_add_u32 s20, s6, 0x100000
    s_addc_u32 s21, s7, 0
    s_mov_b32 s22, 0x280000
    s_mov_b32 s23, 0x20000
    s_mov_b32 s56, s10
    s_mov_b32 s57, s11
    s_mov_b32 s58, 0x280000
    s_mov_b32 s59, 0x20000
    v_mul_u32_u24 v3, 144, v8
    v_add_u32 v3, v2, v3
    s_mul_i32 s3, s30, 2304
    s_add_u32 s3, s3, 140288
    v_add_u32 v14, s3, v3
    buffer_load_dwordx4 v[16:19], v10, s[12:15], 0 offen
    buffer_load_dwordx4 v[20:23], v10, s[12:15], s63 offen
    v_bfe_u32 v48, v1, 2, 2
    v_and_b32 v49, 3, v1
    s_add_u32 s3, s61, s30
    s_lshr_b32 s33, s3, 2
    s_mul_i32 s33, s33, 76
    s_add_u32 s3, s3, s33
    s_lshl_b32 s3, s3, 10
    v_and_b32 v2, 15, v1
    v_lshl_add_u32 v2, v2, 4, s3
    v_lshrrev_b32 v3, 5, v1
    v_lshl_add_u32 v2, v3, 8, v2
    v_and_b32 v4, 1, v9
    v_lshl_add_u32 v52, v4, 10, v2
    v_mov_b32 v53, 0x1f000
    v_lshl_add_u32 v2, v3, 3, v48
    v_lshlrev_b32 v2, 7, v2
    v_lshl_add_u32 v2, v49, 3, v2
    v_lshl_add_u32 v2, v4, 5, v2
    v_lshrrev_b32 v4, 1, v48
    v_lshl_add_u32 v54, v4, 6, v2
    v_xor_b32 v55, 64, v54
    v_mov_b32 v56, v54
    v_mov_b32 v57, v54
    s_branch K_PG3
.p2align 12
K_CHA0:
K_STA4:
    s_branch K_STA8
K_CHB0:
K_STB4:
    s_branch K_STB8
K_PG3:
    v_and_b32 v2, 31, v1
    v_mul_u32_u24 v2, 144, v2
    v_lshl_add_u32 v2, v3, 3, v2
    s_mul_i32 s3, s30, 4608
    s_add_u32 s3, s3, 140288
    v_add_u32 v50, s3, v2
    s_lshl_b32 s3, s40, 3
    s_mul_i32 s33, s3, 187
    s_lshr_b32 s33, s33, 11
    s_add_u32 s33, s33, 1
    s_mul_i32 s33, s33, 11
    s_add_u32 s3, s61, s30
    s_add_u32 s3, s3, 1
    s_cmp_ge_u32 s3, s33
    s_cselect_b32 s60, 24, 16
    s_cmp_gt_u32 s3, s33
    s_cselect_b32 s60, 20, s60
    v_add_u32 v58, s60, v15
    s_mov_b32 s64, -1
    s_mov_b32 s65, -1
    s_mov_b32 s66, -1
    s_mov_b32 s67, -1
    s_mov_b32 s68, -1
    s_mov_b32 s69, -1
    s_mov_b32 s70, 0xfffff
    s_mov_b32 s71, 131072
    v_mov_b32 v108, 0
    v_mov_b32 v109, 0
    v_mov_b32 v110, 0
    v_mov_b32 v111, 0
    v_mov_b32 v112, 0
    v_mov_b32 v113, 0
    v_mov_b32 v114, 0
    v_mov_b32 v115, 0
    v_mov_b32 v116, 0
    v_mov_b32 v117, 0
    v_mov_b32 v118, 0
    v_mov_b32 v119, 0
    v_mov_b32 v120, 0
    v_mov_b32 v121, 0
    v_mov_b32 v122, 0
    v_mov_b32 v123, 0
    v_mov_b32 v124, 0
    v_mov_b32 v125, 0
    v_mov_b32 v126, 0
    v_mov_b32 v127, 0
    v_mov_b32 v128, 0
    v_mov_b32 v129, 0
    v_mov_b32 v130, 0
    v_mov_b32 v131, 0
    v_mov_b32 v132, 0
    v_mov_b32 v133, 0
    v_mov_b32 v134, 0
    v_mov_b32 v135, 0
    v_mov_b32 v136, 0
    v_mov_b32 v137, 0
    v_mov_b32 v138, 0
    v_mov_b32 v139, 0
    s_barrier
    s_branch K_P2_AUXW
K_P2_GM:
    s_lshl_b32 s62, s40, 7
    v_lshrrev_b32 v8, 3, v1
    v_lshrrev_b32 v9, 4, v1
    v_mov_b32 v15, 158720
    s_lshl_b32 s61, s40, 3
    s_add_u32 s61, s61, s30
    s_mul_i32 s3, s61, 20480
    s_lshl_b32 s33, s41, 7
    s_add_u32 s3, s3, s33
    v_and_b32 v2, 7, v1
    v_lshlrev_b32 v2, 4, v2
    v_mul_u32_u24 v4, 1280, v8
    v_add3_u32 v10, v2, v4, s3
    s_lshl_b32 s3, s30, 7
    s_add_u32 s3, s3, 159744
    v_lshl_add_u32 v11, v8, 3, s3
    s_mov_b32 s63, 10240
    s_add_u32 s20, s6, 0x100000
    s_addc_u32 s21, s7, 0
    s_mov_b32 s22, 0x280000
    s_mov_b32 s23, 0x20000
    s_mov_b32 s56, s10
    s_mov_b32 s57, s11
    s_mov_b32 s58, 0x280000
    s_mov_b32 s59, 0x20000
    v_mul_u32_u24 v3, 144, v8
    v_add_u32 v3, v2, v3
    s_mul_i32 s3, s30, 2304
    s_add_u32 s3, s3, 140288
    v_add_u32 v14, s3, v3
    v_bfe_u32 v48, v1, 2, 2
    v_and_b32 v49, 3, v1
    s_add_u32 s3, s61, s30
    s_lshr_b32 s33, s3, 2
    s_mul_i32 s33, s33, 76
    s_add_u32 s3, s3, s33
    s_lshl_b32 s3, s3, 10
    v_and_b32 v2, 15, v1
    v_lshl_add_u32 v2, v2, 4, s3
    v_lshrrev_b32 v3, 5, v1
    v_lshl_add_u32 v2, v3, 8, v2
    v_and_b32 v4, 1, v9
    v_lshl_add_u32 v52, v4, 10, v2
    v_mov_b32 v53, 0x1f000
    v_lshl_add_u32 v2, v3, 3, v48
    v_lshlrev_b32 v2, 7, v2
    v_lshl_add_u32 v2, v49, 3, v2
    v_lshl_add_u32 v2, v4, 5, v2
    v_lshrrev_b32 v4, 1, v48
    v_lshl_add_u32 v54, v4, 6, v2
    v_xor_b32 v55, 64, v54
    v_mov_b32 v56, v54
    v_mov_b32 v57, v54
    v_and_b32 v2, 31, v1
    v_mul_u32_u24 v2, 144, v2
    v_lshl_add_u32 v2, v3, 3, v2
    s_mul_i32 s3, s30, 4608
    s_add_u32 s3, s3, 140288
    v_add_u32 v50, s3, v2
    s_lshl_b32 s3, s40, 3
    s_mul_i32 s33, s3, 187
    s_lshr_b32 s33, s33, 11
    s_add_u32 s33, s33, 1
    s_mul_i32 s33, s33, 11
    s_add_u32 s3, s61, s30
    s_add_u32 s3, s3, 1
    s_cmp_ge_u32 s3, s33
    s_cselect_b32 s60, 24, 16
    s_cmp_gt_u32 s3, s33
    s_cselect_b32 s60, 20, s60
    v_add_u32 v58, s60, v15
    s_mov_b32 s64, -1
    s_mov_b32 s65, -1
    s_mov_b32 s66, -1
    s_mov_b32 s67, -1
    s_mov_b32 s68, -1
    s_mov_b32 s69, -1
    s_mov_b32 s70, 0xfffff
    s_mov_b32 s71, 131072
    v_mov_b32 v108, 0
    v_mov_b32 v109, 0
    v_mov_b32 v110, 0
    v_mov_b32 v111, 0
    v_mov_b32 v112, 0
    v_mov_b32 v113, 0
    v_mov_b32 v114, 0
    v_mov_b32 v115, 0
    v_mov_b32 v116, 0
    v_mov_b32 v117, 0
    v_mov_b32 v118, 0
    v_mov_b32 v119, 0
    v_mov_b32 v120, 0
    v_mov_b32 v121, 0
    v_mov_b32 v122, 0
    v_mov_b32 v123, 0
    v_mov_b32 v124, 0
    v_mov_b32 v125, 0
    v_mov_b32 v126, 0
    v_mov_b32 v127, 0
    v_mov_b32 v128, 0
    v_mov_b32 v129, 0
    v_mov_b32 v130, 0
    v_mov_b32 v131, 0
    v_mov_b32 v132, 0
    v_mov_b32 v133, 0
    v_mov_b32 v134, 0
    v_mov_b32 v135, 0
    v_mov_b32 v136, 0
    v_mov_b32 v137, 0
    v_mov_b32 v138, 0
    v_mov_b32 v139, 0
    buffer_load_dwordx4 v[16:19], v10, s[12:15], 0 offen
    buffer_load_dwordx4 v[20:23], v10, s[12:15], s63 offen
    s_cmp_eq_u32 s30, 0
    s_cbranch_scc1 K_CHB0
    s_cmp_eq_u32 s30, 1
    s_cbranch_scc1 K_CHB1
    s_cmp_eq_u32 s30, 2
    s_cbranch_scc1 K_CHB2
    s_branch K_CHB3
K_WRET_B:
    v_mov_b32 v3, 1
    s_waitcnt vmcnt(2)
    s_mov_b64 exec, 1
    ds_add_u32 v15, v3 offset:44
    s_mov_b64 exec, -1
    s_mov_b32 s3, 1048576
K_P2_GWM:
    ds_read_b32 v2, v15 offset:44
    s_sleep 1
    s_sub_u32 s3, s3, 1
    s_waitcnt lgkmcnt(0)
    v_readfirstlane_b32 s33, v2
    s_nop 3
    s_cselect_b32 s33, 4, s33
    s_cmp_lt_u32 s33, 4
    s_cbranch_scc1 K_P2_GWM
    ds_write_b32 v15, v15 offset:56
K_P2_GEMM:
    s_setprio 1
    s_mul_i32 s52, s40, 1496
    s_add_u32 s53, s52, 1309
    s_lshr_b32 s52, s52, 11
    s_lshr_b32 s53, s53, 11
    s_sub_u32 s53, s53, s52
    s_mov_b32 s46, 0x84210
    s_mov_b32 s47, s46
    s_waitcnt vmcnt(0)
    v_lshlrev_b32 v32, 16, v16
    v_and_b32 v33, 0xffff0000, v16
    v_lshlrev_b32 v34, 16, v17
    v_and_b32 v35, 0xffff0000, v17
    v_lshlrev_b32 v36, 16, v18
    v_and_b32 v37, 0xffff0000, v18
    v_lshlrev_b32 v38, 16, v19
    v_and_b32 v39, 0xffff0000, v19
    v_lshlrev_b32 v40, 16, v20
    v_and_b32 v41, 0xffff0000, v20
    v_lshlrev_b32 v42, 16, v21
    v_and_b32 v43, 0xffff0000, v21
    v_lshlrev_b32 v44, 16, v22
    v_and_b32 v45, 0xffff0000, v22
    v_lshlrev_b32 v46, 16, v23
    v_and_b32 v47, 0xffff0000, v23
    s_branch K_SPL
K_IT0:
    v_mfma_f32_32x32x16_bf16 v[108:123], v[156:159], v[68:71], v[108:123]
    ds_read_b64_tr_b16 v[140:141], v56 offset:0
    ds_read_b64_tr_b16 v[142:143], v56 offset:512
    s_and_b32 s33, s50, s70
    s_cbranch_scc0 K_RF0
K_RB0:
    s_ff1_i32_b32 s51, s33
    ds_read_b64_tr_b16 v[144:145], v56 offset:2048
    v_mfma_f32_32x32x16_bf16 v[124:139], v[164:167], v[68:71], v[124:139]
    s_bitset0_b32 s70, s51
    s_lshl_b32 s64, s51, 12
    buffer_load_dwordx4 v[60:63], v52, s[20:23], s64 offen offset:0 sc1
    ds_read_b64_tr_b16 v[146:147], v56 offset:2560
    ds_read_b64_tr_b16 v[148:149], v57 offset:0
    v_mfma_f32_32x32x16_bf16 v[108:123], v[160:163], v[72:75], v[108:123]
    buffer_load_dwordx4 v[64:67], v52, s[20:23], s64 offen offset:512 sc1
    ds_read_b64_tr_b16 v[150:151], v57 offset:512
    ds_read_b64_tr_b16 v[152:153], v57 offset:2048
    ds_read_b64_tr_b16 v[154:155], v57 offset:2560
    v_mfma_f32_32x32x16_bf16 v[124:139], v[168:171], v[72:75], v[124:139]
K_TL0:
    s_waitcnt vmcnt(8) lgkmcnt(8)
    v_cmp_u_f32 vcc, v76, v80
    v_and_or_b32 v56, s68, v53, v54
    v_and_or_b32 v57, s68, v53, v55
    s_cbranch_vccnz K_FX1
K_IT1:
    v_mfma_f32_32x32x16_bf16 v[108:123], v[172:175], v[76:79], v[108:123]
    ds_read_b64_tr_b16 v[156:157], v56 offset:0
    ds_read_b64_tr_b16 v[158:159], v56 offset:512
    s_and_b32 s33, s50, s70
    s_cbranch_scc0 K_RF1
K_RB1:
    s_ff1_i32_b32 s51, s33
    ds_read_b64_tr_b16 v[160:161], v56 offset:2048
    v_mfma_f32_32x32x16_bf16 v[124:139], v[180:183], v[76:79], v[124:139]
    s_bitset0_b32 s70, s51
    s_lshl_b32 s65, s51, 12
    buffer_load_dwordx4 v[68:71], v52, s[20:23], s65 offen offset:0 sc1
    ds_read_b64_tr_b16 v[162:163], v56 offset:2560
    ds_read_b64_tr_b16 v[164:165], v57 offset:0
    v_mfma_f32_32x32x16_bf16 v[108:123], v[176:179], v[80:83], v[108:123]
    buffer_load_dwordx4 v[72:75], v52, s[20:23], s65 offen offset:512 sc1
    ds_read_b64_tr_b16 v[166:167], v57 offset:512
    ds_read_b64_tr_b16 v[168:169], v57 offset:2048
    ds_read_b64_tr_b16 v[170:171], v57 offset:2560
    v_mfma_f32_32x32x16_bf16 v[124:139], v[184:187], v[80:83], v[124:139]
K_TL1:
    s_waitcnt vmcnt(8) lgkmcnt(8)
    v_cmp_u_f32 vcc, v84, v88
    v_and_or_b32 v56, s69, v53, v54
    v_and_or_b32 v57, s69, v53, v55
    s_cbranch_vccnz K_FX2
K_IT2:
    v_mfma_f32_32x32x16_bf16 v[108:123], v[140:143], v[84:87], v[108:123]
    ds_read_b64_tr_b16 v[172:173], v56 offset:0
    ds_read_b64_tr_b16 v[174:175], v56 offset:512
    s_and_b32 s33, s50, s70
    s_cbranch_scc0 K_RF2
K_RB2:
    s_ff1_i32_b32 s51, s33
    ds_read_b64_tr_b16 v[176:177], v56 offset:2048
    v_mfma_f32_32x32x16_bf16 v[124:139], v[148:151], v[84:87], v[124:139]
    s_bitset0_b32 s70, s51
    s_lshl_b32 s66, s51, 12
    buffer_load_dwordx4 v[76:79], v52, s[20:23], s66 offen offset:0 sc1
    ds_read_b64_tr_b16 v[178:179], v56 offset:2560
    ds_read_b64_tr_b16 v[180:181], v57 offset:0
    v_mfma_f32_32x32x16_bf16 v[108:123], v[144:147], v[88:91], v[108:123]
    buffer_load_dwordx4 v[80:83], v52, s[20:23], s66 offen offset:512 sc1
    ds_read_b64_tr_b16 v[182:183], v57 offset:512
    ds_read_b64_tr_b16 v[184:185], v57 offset:2048
    ds_read_b64_tr_b16 v[186:187], v57 offset:2560
    v_mfma_f32_32x32x16_bf16 v[124:139], v[152:155], v[88:91], v[124:139]
K_TL2:
    s_waitcnt vmcnt(8) lgkmcnt(8)
    v_cmp_u_f32 vcc, v92, v96
    v_and_or_b32 v56, s64, v53, v54
    v_and_or_b32 v57, s64, v53, v55
    s_cbranch_vccnz K_FX3
K_IT3:
    v_mfma_f32_32x32x16_bf16 v[108:123], v[156:159], v[92:95], v[108:123]
    ds_read_b64_tr_b16 v[140:141], v56 offset:0
    ds_read_b64_tr_b16 v[142:143], v56 offset:512
    s_and_b32 s33, s50, s70
    s_cbranch_scc0 K_RF3
K_RB3:
    s_ff1_i32_b32 s51, s33
    ds_read_b64_tr_b16 v[144:145], v56 offset:2048
    v_mfma_f32_32x32x16_bf16 v[124:139], v[164:167], v[92:95], v[124:139]
    s_bitset0_b32 s70, s51
    s_lshl_b32 s67, s51, 12
    buffer_load_dwordx4 v[84:87], v52, s[20:23], s67 offen offset:0 sc1
    ds_read_b64_tr_b16 v[146:147], v56 offset:2560
    ds_read_b64_tr_b16 v[148:149], v57 offset:0
    v_mfma_f32_32x32x16_bf16 v[108:123], v[160:163], v[96:99], v[108:123]
    buffer_load_dwordx4 v[88:91], v52, s[20:23], s67 offen offset:512 sc1
    ds_read_b64_tr_b16 v[150:151], v57 offset:512
    ds_read_b64_tr_b16 v[152:153], v57 offset:2048
    ds_read_b64_tr_b16 v[154:155], v57 offset:2560
    v_mfma_f32_32x32x16_bf16 v[124:139], v[168:171], v[96:99], v[124:139]
K_TL3:
    s_waitcnt vmcnt(8) lgkmcnt(8)
    v_cmp_u_f32 vcc, v100, v104
    v_and_or_b32 v56, s65, v53, v54
    v_and_or_b32 v57, s65, v53, v55
    s_cbranch_vccnz K_FX4
K_IT4:
    v_mfma_f32_32x32x16_bf16 v[108:123], v[172:175], v[100:103], v[108:123]
    ds_read_b64_tr_b16 v[156:157], v56 offset:0
    ds_read_b64_tr_b16 v[158:159], v56 offset:512
    s_and_b32 s33, s50, s70
    s_cbranch_scc0 K_RF4
K_RB4:
    s_ff1_i32_b32 s51, s33
    ds_read_b64_tr_b16 v[160:161], v56 offset:2048
    v_mfma_f32_32x32x16_bf16 v[124:139], v[180:183], v[100:103], v[124:139]
    s_bitset0_b32 s70, s51
    s_lshl_b32 s68, s51, 12
    buffer_load_dwordx4 v[92:95], v52, s[20:23], s68 offen offset:0 sc1
    ds_read_b64_tr_b16 v[162:163], v56 offset:2560
    ds_read_b64_tr_b16 v[164:165], v57 offset:0
    v_mfma_f32_32x32x16_bf16 v[108:123], v[176:179], v[104:107], v[108:123]
    buffer_load_dwordx4 v[96:99], v52, s[20:23], s68 offen offset:512 sc1
    ds_read_b64_tr_b16 v[166:167], v57 offset:512
    ds_read_b64_tr_b16 v[168:169], v57 offset:2048
    ds_read_b64_tr_b16 v[170:171], v57 offset:2560
    v_mfma_f32_32x32x16_bf16 v[124:139], v[184:187], v[104:107], v[124:139]
K_TL4:
    s_waitcnt vmcnt(8) lgkmcnt(8)
    v_cmp_u_f32 vcc, v60, v64
    v_and_or_b32 v56, s66, v53, v54
    v_and_or_b32 v57, s66, v53, v55
    s_cbranch_vccnz K_FX5
K_IT5:
    v_mfma_f32_32x32x16_bf16 v[108:123], v[140:143], v[60:63], v[108:123]
    ds_read_b64_tr_b16 v[172:173], v56 offset:0
    ds_read_b64_tr_b16 v[174:175], v56 offset:512
    s_and_b32 s33, s50, s70
    s_cbranch_scc0 K_RF5
K_RB5:
    s_ff1_i32_b32 s51, s33
    ds_read_b64_tr_b16 v[176:177], v56 offset:2048
    v_mfma_f32_32x32x16_bf16 v[124:139], v[148:151], v[60:63], v[124:139]
    s_bitset0_b32 s70, s51
    s_lshl_b32 s69, s51, 12
    buffer_load_dwordx4 v[100:103], v52, s[20:23], s69 offen offset:0 sc1
    ds_read_b64_tr_b16 v[178:179], v56 offset:2560
    ds_read_b64_tr_b16 v[180:181], v57 offset:0
    v_mfma_f32_32x32x16_bf16 v[108:123], v[144:147], v[64:67], v[108:123]
    buffer_load_dwordx4 v[104:107], v52, s[20:23], s69 offen offset:512 sc1
    ds_read_b64_tr_b16 v[182:183], v57 offset:512
    ds_read_b64_tr_b16 v[184:185], v57 offset:2048
    ds_read_b64_tr_b16 v[186:187], v57 offset:2560
    v_mfma_f32_32x32x16_bf16 v[124:139], v[152:155], v[64:67], v[124:139]
K_TL5:
    s_waitcnt vmcnt(8) lgkmcnt(8)
    v_cmp_u_f32 vcc, v68, v72
    v_and_or_b32 v56, s67, v53, v54
    v_and_or_b32 v57, s67, v53, v55
    s_cbranch_vccnz K_FX0
    s_branch K_IT0
K_DR0:
    v_mfma_f32_32x32x16_bf16 v[108:123], v[156:159], v[68:71], v[108:123]
    ds_read_b64_tr_b16 v[140:141], v56 offset:0
    ds_read_b64_tr_b16 v[142:143], v56 offset:512
K_DM0:
    ds_read_b64_tr_b16 v[144:145], v56 offset:2048
    s_mov_b32 s64, -1
    v_mfma_f32_32x32x16_bf16 v[124:139], v[164:167], v[68:71], v[124:139]
    buffer_load_dword v3, v52, s[20:23], s64 offen
    ds_read_b64_tr_b16 v[146:147], v56 offset:2560
    ds_read_b64_tr_b16 v[148:149], v57 offset:0
    v_mfma_f32_32x32x16_bf16 v[108:123], v[160:163], v[72:75], v[108:123]
    buffer_load_dword v3, v52, s[20:23], s64 offen
    ds_read_b64_tr_b16 v[150:151], v57 offset:512
    ds_read_b64_tr_b16 v[152:153], v57 offset:2048
    ds_read_b64_tr_b16 v[154:155], v57 offset:2560
    v_mfma_f32_32x32x16_bf16 v[124:139], v[168:171], v[72:75], v[124:139]
    s_waitcnt vmcnt(8) lgkmcnt(8)
    v_cmp_u_f32 vcc, v76, v80
    v_and_or_b32 v56, s68, v53, v54
    v_and_or_b32 v57, s68, v53, v55
    v_mov_b32 v60, -1
    s_cbranch_vccnz K_DX1
K_DR1:
    v_mfma_f32_32x32x16_bf16 v[108:123], v[172:175], v[76:79], v[108:123]
    ds_read_b64_tr_b16 v[156:157], v56 offset:0
    ds_read_b64_tr_b16 v[158:159], v56 offset:512
K_DM1:
    ds_read_b64_tr_b16 v[160:161], v56 offset:2048
    s_mov_b32 s65, -1
    v_mfma_f32_32x32x16_bf16 v[124:139], v[180:183], v[76:79], v[124:139]
    buffer_load_dword v3, v52, s[20:23], s65 offen
    ds_read_b64_tr_b16 v[162:163], v56 offset:2560
    ds_read_b64_tr_b16 v[164:165], v57 offset:0
    v_mfma_f32_32x32x16_bf16 v[108:123], v[176:179], v[80:83], v[108:123]
    buffer_load_dword v3, v52, s[20:23], s65 offen
    ds_read_b64_tr_b16 v[166:167], v57 offset:512
    ds_read_b64_tr_b16 v[168:169], v57 offset:2048
    ds_read_b64_tr_b16 v[170:171], v57 offset:2560
    v_mfma_f32_32x32x16_bf16 v[124:139], v[184:187], v[80:83], v[124:139]
    s_waitcnt vmcnt(8) lgkmcnt(8)
    v_cmp_u_f32 vcc, v84, v88
    v_and_or_b32 v56, s69, v53, v54
    v_and_or_b32 v57, s69, v53, v55
    v_mov_b32 v68, -1
    s_cbranch_vccnz K_DX2
K_DR2:
    v_mfma_f32_32x32x16_bf16 v[108:123], v[140:143], v[84:87], v[108:123]
    ds_read_b64_tr_b16 v[172:173], v56 offset:0
    ds_read_b64_tr_b16 v[174:175], v56 offset:512
K_DM2:
    ds_read_b64_tr_b16 v[176:177], v56 offset:2048
    s_mov_b32 s66, -1
    v_mfma_f32_32x32x16_bf16 v[124:139], v[148:151], v[84:87], v[124:139]
    buffer_load_dword v3, v52, s[20:23], s66 offen
    ds_read_b64_tr_b16 v[178:179], v56 offset:2560
    ds_read_b64_tr_b16 v[180:181], v57 offset:0
    v_mfma_f32_32x32x16_bf16 v[108:123], v[144:147], v[88:91], v[108:123]
    buffer_load_dword v3, v52, s[20:23], s66 offen
    ds_read_b64_tr_b16 v[182:183], v57 offset:512
    ds_read_b64_tr_b16 v[184:185], v57 offset:2048
    ds_read_b64_tr_b16 v[186:187], v57 offset:2560
    v_mfma_f32_32x32x16_bf16 v[124:139], v[152:155], v[88:91], v[124:139]
    s_waitcnt vmcnt(8) lgkmcnt(8)
    v_cmp_u_f32 vcc, v92, v96
    v_and_or_b32 v56, s64, v53, v54
    v_and_or_b32 v57, s64, v53, v55
    v_mov_b32 v76, -1
    s_cbranch_vccnz K_DX3
K_DR3:
    v_mfma_f32_32x32x16_bf16 v[108:123], v[156:159], v[92:95], v[108:123]
    ds_read_b64_tr_b16 v[140:141], v56 offset:0
    ds_read_b64_tr_b16 v[142:143], v56 offset:512
K_DM3:
    ds_read_b64_tr_b16 v[144:145], v56 offset:2048
    s_mov_b32 s67, -1
    v_mfma_f32_32x32x16_bf16 v[124:139], v[164:167], v[92:95], v[124:139]
    buffer_load_dword v3, v52, s[20:23], s67 offen
    ds_read_b64_tr_b16 v[146:147], v56 offset:2560
    ds_read_b64_tr_b16 v[148:149], v57 offset:0
    v_mfma_f32_32x32x16_bf16 v[108:123], v[160:163], v[96:99], v[108:123]
    buffer_load_dword v3, v52, s[20:23], s67 offen
    ds_read_b64_tr_b16 v[150:151], v57 offset:512
    ds_read_b64_tr_b16 v[152:153], v57 offset:2048
    ds_read_b64_tr_b16 v[154:155], v57 offset:2560
    v_mfma_f32_32x32x16_bf16 v[124:139], v[168:171], v[96:99], v[124:139]
    s_waitcnt vmcnt(8) lgkmcnt(8)
    v_cmp_u_f32 vcc, v100, v104
    v_and_or_b32 v56, s65, v53, v54
    v_and_or_b32 v57, s65, v53, v55
    v_mov_b32 v84, -1
    s_cbranch_vccnz K_DX4
K_DR4:
    v_mfma_f32_32x32x16_bf16 v[108:123], v[172:175], v[100:103], v[108:123]
    ds_read_b64_tr_b16 v[156:157], v56 offset:0
    ds_read_b64_tr_b16 v[158:159], v56 offset:512
K_DM4:
    ds_read_b64_tr_b16 v[160:161], v56 offset:2048
    s_mov_b32 s68, -1
    v_mfma_f32_32x32x16_bf16 v[124:139], v[180:183], v[100:103], v[124:139]
    buffer_load_dword v3, v52, s[20:23], s68 offen
    ds_read_b64_tr_b16 v[162:163], v56 offset:2560
    ds_read_b64_tr_b16 v[164:165], v57 offset:0
    v_mfma_f32_32x32x16_bf16 v[108:123], v[176:179], v[104:107], v[108:123]
    buffer_load_dword v3, v52, s[20:23], s68 offen
    ds_read_b64_tr_b16 v[166:167], v57 offset:512
    ds_read_b64_tr_b16 v[168:169], v57 offset:2048
    ds_read_b64_tr_b16 v[170:171], v57 offset:2560
    v_mfma_f32_32x32x16_bf16 v[124:139], v[184:187], v[104:107], v[124:139]
    s_waitcnt vmcnt(8) lgkmcnt(8)
    v_cmp_u_f32 vcc, v60, v64
    v_and_or_b32 v56, s66, v53, v54
    v_and_or_b32 v57, s66, v53, v55
    v_mov_b32 v92, -1
    s_cbranch_vccnz K_DX5
K_DR5:
    v_mfma_f32_32x32x16_bf16 v[108:123], v[140:143], v[60:63], v[108:123]
    ds_read_b64_tr_b16 v[172:173], v56 offset:0
    ds_read_b64_tr_b16 v[174:175], v56 offset:512
K_DM5:
    ds_read_b64_tr_b16 v[176:177], v56 offset:2048
    s_mov_b32 s69, -1
    v_mfma_f32_32x32x16_bf16 v[124:139], v[148:151], v[60:63], v[124:139]
    buffer_load_dword v3, v52, s[20:23], s69 offen
    ds_read_b64_tr_b16 v[178:179], v56 offset:2560
    ds_read_b64_tr_b16 v[180:181], v57 offset:0
    v_mfma_f32_32x32x16_bf16 v[108:123], v[144:147], v[64:67], v[108:123]
    buffer_load_dword v3, v52, s[20:23], s69 offen
    ds_read_b64_tr_b16 v[182:183], v57 offset:512
    ds_read_b64_tr_b16 v[184:185], v57 offset:2048
    ds_read_b64_tr_b16 v[186:187], v57 offset:2560
    v_mfma_f32_32x32x16_bf16 v[124:139], v[152:155], v[64:67], v[124:139]
    s_waitcnt vmcnt(8) lgkmcnt(8)
    v_cmp_u_f32 vcc, v68, v72
    v_and_or_b32 v56, s67, v53, v54
    v_and_or_b32 v57, s67, v53, v55
    v_mov_b32 v100, -1
    s_cbranch_vccnz K_DX0
    s_branch K_DR0
K_CHA1:
K_STA5:
    s_branch K_STA9
K_CHB1:
K_STB5:
    s_branch K_STB9
K_RF0:
    s_cmp_eq_u32 s70, 0
    s_cbranch_scc1 K_DM0
    ds_read_b32 v59, v58
    s_waitcnt lgkmcnt(0)
    v_readfirstlane_b32 s50, v59
    s_and_b32 s33, s50, s70
    s_cbranch_scc1 K_RB0
K_NV0:
    ds_read_b64_tr_b16 v[144:145], v56 offset:2048
    v_mfma_f32_32x32x16_bf16 v[124:139], v[164:167], v[68:71], v[124:139]
    s_mov_b32 s64, -1
    v_mov_b32 v60, -1
    buffer_load_dword v3, v52, s[20:23], s64 offen
    ds_read_b64_tr_b16 v[146:147], v56 offset:2560
    ds_read_b64_tr_b16 v[148:149], v57 offset:0
    v_mfma_f32_32x32x16_bf16 v[108:123], v[160:163], v[72:75], v[108:123]
    buffer_load_dword v3, v52, s[20:23], s64 offen
    ds_read_b64_tr_b16 v[150:151], v57 offset:512
    ds_read_b64_tr_b16 v[152:153], v57 offset:2048
    ds_read_b64_tr_b16 v[154:155], v57 offset:2560
    v_mfma_f32_32x32x16_bf16 v[124:139], v[168:171], v[72:75], v[124:139]
    s_branch K_TL0
K_DX0:
    s_and_b32 s51, s65, s66
    s_and_b32 s51, s51, s67
    s_and_b32 s51, s51, s68
    s_cmp_lt_i32 s51, 0
    s_cbranch_scc1 K_P2_MM
K_FX0:
    s_cmp_lt_i32 s65, 0
    s_cbranch_scc1 K_SK0
    v_max_u32 v2, v68, v72
    v_cmp_eq_u32 vcc, -1, v2
    s_cbranch_vccz K_IT0
    s_sub_u32 s71, s71, 1
    s_cbranch_scc1 K_IT0
    s_lshr_b32 s51, s65, 12
    s_bitset1_b32 s70, s51
K_SK0:
    s_and_b32 s33, s50, s70
    s_cbranch_scc0 K_NUL0
K_BK0:
    s_ff1_i32_b32 s51, s33
    s_lshl_b32 s64, s51, 12
    buffer_load_dwordx4 v[60:63], v52, s[20:23], s64 offen offset:0 sc1
    buffer_load_dwordx4 v[64:67], v52, s[20:23], s64 offen offset:512 sc1
    s_bitset0_b32 s70, s51
K_RD0:
    ds_read_b64_tr_b16 v[140:141], v56 offset:0
    ds_read_b64_tr_b16 v[142:143], v56 offset:512
    ds_read_b64_tr_b16 v[144:145], v56 offset:2048
    ds_read_b64_tr_b16 v[146:147], v56 offset:2560
    ds_read_b64_tr_b16 v[148:149], v57 offset:0
    ds_read_b64_tr_b16 v[150:151], v57 offset:512
    ds_read_b64_tr_b16 v[152:153], v57 offset:2048
    ds_read_b64_tr_b16 v[154:155], v57 offset:2560
    s_cmp_lt_i32 s66, 0
    s_cbranch_scc0 K_TL0
    v_and_or_b32 v56, s68, v53, v54
    v_and_or_b32 v57, s68, v53, v55
    s_branch K_SK1
K_NUL0:
    s_and_b32 s51, s66, s67
    s_and_b32 s51, s51, s68
    s_and_b32 s51, s51, s69
    s_cmp_lt_i32 s51, 0
    s_cbranch_scc0 K_PC0
    s_cmp_eq_u32 s70, 0
    s_cbranch_scc1 K_P2_MM
    s_branch K_SPN
K_PC0:
    s_cmp_eq_u32 s70, 0
    s_cbranch_scc1 K_NI0
    ds_read_b32 v59, v58
    s_waitcnt lgkmcnt(0)
    v_readfirstlane_b32 s50, v59
    s_and_b32 s33, s50, s70
    s_cbranch_scc1 K_BK0
    ds_read_b32 v59, v58
    s_waitcnt lgkmcnt(0)
    v_readfirstlane_b32 s50, v59
    s_and_b32 s33, s50, s70
    s_cbranch_scc1 K_BK0
K_NI0:
    s_mov_b32 s64, -1
    v_mov_b32 v60, -1
    buffer_load_dword v3, v52, s[20:23], s64 offen
    buffer_load_dword v3, v52, s[20:23], s64 offen
    s_branch K_RD0
K_RF1:
    s_cmp_eq_u32 s70, 0
    s_cbranch_scc1 K_DM1
    ds_read_b32 v59, v58
    s_waitcnt lgkmcnt(0)
    v_readfirstlane_b32 s50, v59
    s_and_b32 s33, s50, s70
    s_cbranch_scc1 K_RB1
K_NV1:
    ds_read_b64_tr_b16 v[160:161], v56 offset:2048
    v_mfma_f32_32x32x16_bf16 v[124:139], v[180:183], v[76:79], v[124:139]
    s_mov_b32 s65, -1
    v_mov_b32 v68, -1
    buffer_load_dword v3, v52, s[20:23], s65 offen
    ds_read_b64_tr_b16 v[162:163], v56 offset:2560
    ds_read_b64_tr_b16 v[164:165], v57 offset:0
    v_mfma_f32_32x32x16_bf16 v[108:123], v[176:179], v[80:83], v[108:123]
    buffer_load_dword v3, v52, s[20:23], s65 offen
    ds_read_b64_tr_b16 v[166:167], v57 offset:512
    ds_read_b64_tr_b16 v[168:169], v57 offset:2048
    ds_read_b64_tr_b16 v[170:171], v57 offset:2560
    v_mfma_f32_32x32x16_bf16 v[124:139], v[184:187], v[80:83], v[124:139]
    s_branch K_TL1
K_CHA2:
K_STA6:
    s_branch K_STA10
K_CHB2:
K_STB6:
    s_branch K_STB10
K_DX1:
    s_and_b32 s51, s66, s67
    s_and_b32 s51, s51, s68
    s_and_b32 s51, s51, s69
    s_cmp_lt_i32 s51, 0
    s_cbranch_scc1 K_P2_MM
K_FX1:
    s_cmp_lt_i32 s66, 0
    s_cbranch_scc1 K_SK1
    v_max_u32 v2, v76, v80
    v_cmp_eq_u32 vcc, -1, v2
    s_cbranch_vccz K_IT1
    s_sub_u32 s71, s71, 1
    s_cbranch_scc1 K_IT1
    s_lshr_b32 s51, s66, 12
    s_bitset1_b32 s70, s51
K_SK1:
    s_and_b32 s33, s50, s70
    s_cbranch_scc0 K_NUL1
K_BK1:
    s_ff1_i32_b32 s51, s33
    s_lshl_b32 s65, s51, 12
    buffer_load_dwordx4 v[68:71], v52, s[20:23], s65 offen offset:0 sc1
    buffer_load_dwordx4 v[72:75], v52, s[20:23], s65 offen offset:512 sc1
    s_bitset0_b32 s70, s51
K_RD1:
    ds_read_b64_tr_b16 v[156:157], v56 offset:0
    ds_read_b64_tr_b16 v[158:159], v56 offset:512
    ds_read_b64_tr_b16 v[160:161], v56 offset:2048
    ds_read_b64_tr_b16 v[162:163], v56 offset:2560
    ds_read_b64_tr_b16 v[164:165], v57 offset:0
    ds_read_b64_tr_b16 v[166:167], v57 offset:512
    ds_read_b64_tr_b16 v[168:169], v57 offset:2048
    ds_read_b64_tr_b16 v[170:171], v57 offset:2560
    s_cmp_lt_i32 s67, 0
    s_cbranch_scc0 K_TL1
    v_and_or_b32 v56, s69, v53, v54
    v_and_or_b32 v57, s69, v53, v55
    s_branch K_SK2
K_NUL1:
    s_and_b32 s51, s64, s67
    s_and_b32 s51, s51, s68
    s_and_b32 s51, s51, s69
    s_cmp_lt_i32 s51, 0
    s_cbranch_scc0 K_PC1
    s_cmp_eq_u32 s70, 0
    s_cbranch_scc1 K_P2_MM
    s_branch K_SPN
K_PC1:
    s_cmp_eq_u32 s70, 0
    s_cbranch_scc1 K_NI1
    ds_read_b32 v59, v58
    s_waitcnt lgkmcnt(0)
    v_readfirstlane_b32 s50, v59
    s_and_b32 s33, s50, s70
    s_cbranch_scc1 K_BK1
    ds_read_b32 v59, v58
    s_waitcnt lgkmcnt(0)
    v_readfirstlane_b32 s50, v59
    s_and_b32 s33, s50, s70
    s_cbranch_scc1 K_BK1
K_NI1:
    s_mov_b32 s65, -1
    v_mov_b32 v68, -1
    buffer_load_dword v3, v52, s[20:23], s65 offen
    buffer_load_dword v3, v52, s[20:23], s65 offen
    s_branch K_RD1
K_RF2:
    s_cmp_eq_u32 s70, 0
    s_cbranch_scc1 K_DM2
    ds_read_b32 v59, v58
    s_waitcnt lgkmcnt(0)
    v_readfirstlane_b32 s50, v59
    s_and_b32 s33, s50, s70
    s_cbranch_scc1 K_RB2
K_NV2:
    ds_read_b64_tr_b16 v[176:177], v56 offset:2048
    v_mfma_f32_32x32x16_bf16 v[124:139], v[148:151], v[84:87], v[124:139]
    s_mov_b32 s66, -1
    v_mov_b32 v76, -1
    buffer_load_dword v3, v52, s[20:23], s66 offen
    ds_read_b64_tr_b16 v[178:179], v56 offset:2560
    ds_read_b64_tr_b16 v[180:181], v57 offset:0
    v_mfma_f32_32x32x16_bf16 v[108:123], v[144:147], v[88:91], v[108:123]
    buffer_load_dword v3, v52, s[20:23], s66 offen
    ds_read_b64_tr_b16 v[182:183], v57 offset:512
    ds_read_b64_tr_b16 v[184:185], v57 offset:2048
    ds_read_b64_tr_b16 v[186:187], v57 offset:2560
    v_mfma_f32_32x32x16_bf16 v[124:139], v[152:155], v[88:91], v[124:139]
    s_branch K_TL2
K_DX2:
    s_and_b32 s51, s64, s67
    s_and_b32 s51, s51, s68
    s_and_b32 s51, s51, s69
    s_cmp_lt_i32 s51, 0
    s_cbranch_scc1 K_P2_MM
K_FX2:
    s_cmp_lt_i32 s67, 0
    s_cbranch_scc1 K_SK2
    v_max_u32 v2, v84, v88
    v_cmp_eq_u32 vcc, -1, v2
    s_cbranch_vccz K_IT2
    s_sub_u32 s71, s71, 1
    s_cbranch_scc1 K_IT2
    s_lshr_b32 s51, s67, 12
    s_bitset1_b32 s70, s51
K_SK2:
    s_and_b32 s33, s50, s70
    s_cbranch_scc0 K_NUL2
K_BK2:
    s_ff1_i32_b32 s51, s33
    s_lshl_b32 s66, s51, 12
    buffer_load_dwordx4 v[76:79], v52, s[20:23], s66 offen offset:0 sc1
    buffer_load_dwordx4 v[80:83], v52, s[20:23], s66 offen offset:512 sc1
    s_bitset0_b32 s70, s51
K_RD2:
    ds_read_b64_tr_b16 v[172:173], v56 offset:0
    s_branch K_PG4
.p2align 12
K_CHA3:
K_STA7:
    s_branch K_STA11
K_CHB3:
K_STB7:
    s_branch K_STB11
K_PG4:
    ds_read_b64_tr_b16 v[174:175], v56 offset:512
    ds_read_b64_tr_b16 v[176:177], v56 offset:2048
    ds_read_b64_tr_b16 v[178:179], v56 offset:2560
    ds_read_b64_tr_b16 v[180:181], v57 offset:0
    ds_read_b64_tr_b16 v[182:183], v57 offset:512
    ds_read_b64_tr_b16 v[184:185], v57 offset:2048
    ds_read_b64_tr_b16 v[186:187], v57 offset:2560
    s_cmp_lt_i32 s68, 0
    s_cbranch_scc0 K_TL2
    v_and_or_b32 v56, s64, v53, v54
    v_and_or_b32 v57, s64, v53, v55
    s_branch K_SK3
K_NUL2:
    s_and_b32 s51, s64, s65
    s_and_b32 s51, s51, s68
    s_and_b32 s51, s51, s69
    s_cmp_lt_i32 s51, 0
    s_cbranch_scc0 K_PC2
    s_cmp_eq_u32 s70, 0
    s_cbranch_scc1 K_P2_MM
    s_branch K_SPN
K_PC2:
    s_cmp_eq_u32 s70, 0
    s_cbranch_scc1 K_NI2
    ds_read_b32 v59, v58
    s_waitcnt lgkmcnt(0)
    v_readfirstlane_b32 s50, v59
    s_and_b32 s33, s50, s70
    s_cbranch_scc1 K_BK2
    ds_read_b32 v59, v58
    s_waitcnt lgkmcnt(0)
    v_readfirstlane_b32 s50, v59
    s_and_b32 s33, s50, s70
    s_cbranch_scc1 K_BK2
K_NI2:
    s_mov_b32 s66, -1
    v_mov_b32 v76, -1
    buffer_load_dword v3, v52, s[20:23], s66 offen
    buffer_load_dword v3, v52, s[20:23], s66 offen
    s_branch K_RD2
K_RF3:
    s_cmp_eq_u32 s70, 0
    s_cbranch_scc1 K_DM3
    ds_read_b32 v59, v58
    s_waitcnt lgkmcnt(0)
    v_readfirstlane_b32 s50, v59
    s_and_b32 s33, s50, s70
    s_cbranch_scc1 K_RB3
K_NV3:
    ds_read_b64_tr_b16 v[144:145], v56 offset:2048
    v_mfma_f32_32x32x16_bf16 v[124:139], v[164:167], v[92:95], v[124:139]
    s_mov_b32 s67, -1
    v_mov_b32 v84, -1
    buffer_load_dword v3, v52, s[20:23], s67 offen
    ds_read_b64_tr_b16 v[146:147], v56 offset:2560
    ds_read_b64_tr_b16 v[148:149], v57 offset:0
    v_mfma_f32_32x32x16_bf16 v[108:123], v[160:163], v[96:99], v[108:123]
    buffer_load_dword v3, v52, s[20:23], s67 offen
    ds_read_b64_tr_b16 v[150:151], v57 offset:512
    ds_read_b64_tr_b16 v[152:153], v57 offset:2048
    ds_read_b64_tr_b16 v[154:155], v57 offset:2560
    v_mfma_f32_32x32x16_bf16 v[124:139], v[168:171], v[96:99], v[124:139]
    s_branch K_TL3
K_DX3:
    s_and_b32 s51, s64, s65
    s_and_b32 s51, s51, s68
    s_and_b32 s51, s51, s69
    s_cmp_lt_i32 s51, 0
    s_cbranch_scc1 K_P2_MM
K_FX3:
    s_cmp_lt_i32 s68, 0
    s_cbranch_scc1 K_SK3
    v_max_u32 v2, v92, v96
    v_cmp_eq_u32 vcc, -1, v2
    s_cbranch_vccz K_IT3
    s_sub_u32 s71, s71, 1
    s_cbranch_scc1 K_IT3
    s_lshr_b32 s51, s68, 12
    s_bitset1_b32 s70, s51
K_SK3:
    s_and_b32 s33, s50, s70
    s_cbranch_scc0 K_NUL3
K_BK3:
    s_ff1_i32_b32 s51, s33
    s_lshl_b32 s67, s51, 12
    buffer_load_dwordx4 v[84:87], v52, s[20:23], s67 offen offset:0 sc1
    buffer_load_dwordx4 v[88:91], v52, s[20:23], s67 offen offset:512 sc1
    s_bitset0_b32 s70, s51
K_RD3:
    ds_read_b64_tr_b16 v[140:141], v56 offset:0
    ds_read_b64_tr_b16 v[142:143], v56 offset:512
    ds_read_b64_tr_b16 v[144:145], v56 offset:2048
    ds_read_b64_tr_b16 v[146:147], v56 offset:2560
    ds_read_b64_tr_b16 v[148:149], v57 offset:0
    ds_read_b64_tr_b16 v[150:151], v57 offset:512
    ds_read_b64_tr_b16 v[152:153], v57 offset:2048
    ds_read_b64_tr_b16 v[154:155], v57 offset:2560
    s_cmp_lt_i32 s69, 0
    s_cbranch_scc0 K_TL3
    v_and_or_b32 v56, s65, v53, v54
    v_and_or_b32 v57, s65, v53, v55
    s_branch K_SK4
K_STA8:
    s_branch K_STA12
K_STB8:
    s_branch K_STB12
K_NUL3:
    s_and_b32 s51, s64, s65
    s_and_b32 s51, s51, s66
    s_and_b32 s51, s51, s69
    s_cmp_lt_i32 s51, 0
    s_cbranch_scc0 K_PC3
    s_cmp_eq_u32 s70, 0
    s_cbranch_scc1 K_P2_MM
    s_branch K_SPN
K_PC3:
    s_cmp_eq_u32 s70, 0
    s_cbranch_scc1 K_NI3
    ds_read_b32 v59, v58
    s_waitcnt lgkmcnt(0)
    v_readfirstlane_b32 s50, v59
    s_and_b32 s33, s50, s70
    s_cbranch_scc1 K_BK3
    ds_read_b32 v59, v58
    s_waitcnt lgkmcnt(0)
    v_readfirstlane_b32 s50, v59
    s_and_b32 s33, s50, s70
    s_cbranch_scc1 K_BK3
K_NI3:
    s_mov_b32 s67, -1
    v_mov_b32 v84, -1
    buffer_load_dword v3, v52, s[20:23], s67 offen
    buffer_load_dword v3, v52, s[20:23], s67 offen
    s_branch K_RD3
K_RF4:
    s_cmp_eq_u32 s70, 0
    s_cbranch_scc1 K_DM4
    ds_read_b32 v59, v58
    s_waitcnt lgkmcnt(0)
    v_readfirstlane_b32 s50, v59
    s_and_b32 s33, s50, s70
    s_cbranch_scc1 K_RB4
K_NV4:
    ds_read_b64_tr_b16 v[160:161], v56 offset:2048
    v_mfma_f32_32x32x16_bf16 v[124:139], v[180:183], v[100:103], v[124:139]
    s_mov_b32 s68, -1
    v_mov_b32 v92, -1
    buffer_load_dword v3, v52, s[20:23], s68 offen
    ds_read_b64_tr_b16 v[162:163], v56 offset:2560
    ds_read_b64_tr_b16 v[164:165], v57 offset:0
    v_mfma_f32_32x32x16_bf16 v[108:123], v[176:179], v[104:107], v[108:123]
    buffer_load_dword v3, v52, s[20:23], s68 offen
    ds_read_b64_tr_b16 v[166:167], v57 offset:512
    ds_read_b64_tr_b16 v[168:169], v57 offset:2048
    ds_read_b64_tr_b16 v[170:171], v57 offset:2560
    v_mfma_f32_32x32x16_bf16 v[124:139], v[184:187], v[104:107], v[124:139]
    s_branch K_TL4
K_DX4:
    s_and_b32 s51, s64, s65
    s_and_b32 s51, s51, s66
    s_and_b32 s51, s51, s69
    s_cmp_lt_i32 s51, 0
    s_cbranch_scc1 K_P2_MM
K_FX4:
    s_cmp_lt_i32 s69, 0
    s_cbranch_scc1 K_SK4
    v_max_u32 v2, v100, v104
    v_cmp_eq_u32 vcc, -1, v2
    s_cbranch_vccz K_IT4
    s_sub_u32 s71, s71, 1
    s_cbranch_scc1 K_IT4
    s_lshr_b32 s51, s69, 12
    s_bitset1_b32 s70, s51
K_SK4:
    s_and_b32 s33, s50, s70
    s_cbranch_scc0 K_NUL4
K_BK4:
    s_ff1_i32_b32 s51, s33
    s_lshl_b32 s68, s51, 12
    buffer_load_dwordx4 v[92:95], v52, s[20:23], s68 offen offset:0 sc1
    buffer_load_dwordx4 v[96:99], v52, s[20:23], s68 offen offset:512 sc1
    s_bitset0_b32 s70, s51
K_RD4:
    ds_read_b64_tr_b16 v[156:157], v56 offset:0
    ds_read_b64_tr_b16 v[158:159], v56 offset:512
    ds_read_b64_tr_b16 v[160:161], v56 offset:2048
    ds_read_b64_tr_b16 v[162:163], v56 offset:2560
    ds_read_b64_tr_b16 v[164:165], v57 offset:0
    ds_read_b64_tr_b16 v[166:167], v57 offset:512
    ds_read_b64_tr_b16 v[168:169], v57 offset:2048
    ds_read_b64_tr_b16 v[170:171], v57 offset:2560
    s_cmp_lt_i32 s64, 0
    s_cbranch_scc0 K_TL4
    v_and_or_b32 v56, s66, v53, v54
    v_and_or_b32 v57, s66, v53, v55
    s_branch K_SK5
K_NUL4:
    s_and_b32 s51, s64, s65
    s_and_b32 s51, s51, s66
    s_and_b32 s51, s51, s67
    s_cmp_lt_i32 s51, 0
    s_cbranch_scc0 K_PC4
    s_cmp_eq_u32 s70, 0
    s_cbranch_scc1 K_P2_MM
    s_branch K_SPN
K_PC4:
    s_cmp_eq_u32 s70, 0
    s_cbranch_scc1 K_NI4
    ds_read_b32 v59, v58
    s_waitcnt lgkmcnt(0)
    v_readfirstlane_b32 s50, v59
    s_and_b32 s33, s50, s70
    s_cbranch_scc1 K_BK4
    ds_read_b32 v59, v58
    s_waitcnt lgkmcnt(0)
    v_readfirstlane_b32 s50, v59
    s_and_b32 s33, s50, s70
    s_cbranch_scc1 K_BK4
K_NI4:
    s_mov_b32 s68, -1
    v_mov_b32 v92, -1
    buffer_load_dword v3, v52, s[20:23], s68 offen
    buffer_load_dword v3, v52, s[20:23], s68 offen
    s_branch K_RD4
K_STA9:
    s_branch K_STA13
K_STB9:
    s_branch K_STB13
K_RF5:
    s_cmp_eq_u32 s70, 0
    s_cbranch_scc1 K_DM5
    ds_read_b32 v59, v58
    s_waitcnt lgkmcnt(0)
    v_readfirstlane_b32 s50, v59
    s_and_b32 s33, s50, s70
    s_cbranch_scc1 K_RB5
K_NV5:
    ds_read_b64_tr_b16 v[176:177], v56 offset:2048
    v_mfma_f32_32x32x16_bf16 v[124:139], v[148:151], v[60:63], v[124:139]
    s_mov_b32 s69, -1
    v_mov_b32 v100, -1
    buffer_load_dword v3, v52, s[20:23], s69 offen
    ds_read_b64_tr_b16 v[178:179], v56 offset:2560
    ds_read_b64_tr_b16 v[180:181], v57 offset:0
    v_mfma_f32_32x32x16_bf16 v[108:123], v[144:147], v[64:67], v[108:123]
    buffer_load_dword v3, v52, s[20:23], s69 offen
    ds_read_b64_tr_b16 v[182:183], v57 offset:512
    ds_read_b64_tr_b16 v[184:185], v57 offset:2048
    ds_read_b64_tr_b16 v[186:187], v57 offset:2560
    v_mfma_f32_32x32x16_bf16 v[124:139], v[152:155], v[64:67], v[124:139]
    s_branch K_TL5
K_DX5:
    s_and_b32 s51, s64, s65
    s_and_b32 s51, s51, s66
    s_and_b32 s51, s51, s67
    s_cmp_lt_i32 s51, 0
    s_cbranch_scc1 K_P2_MM
K_FX5:
    s_cmp_lt_i32 s64, 0
    s_cbranch_scc1 K_SK5
    v_max_u32 v2, v60, v64
    v_cmp_eq_u32 vcc, -1, v2
    s_cbranch_vccz K_IT5
    s_sub_u32 s71, s71, 1
    s_cbranch_scc1 K_IT5
    s_lshr_b32 s51, s64, 12
    s_bitset1_b32 s70, s51
K_SK5:
    s_and_b32 s33, s50, s70
    s_cbranch_scc0 K_NUL5
K_BK5:
    s_ff1_i32_b32 s51, s33
    s_lshl_b32 s69, s51, 12
    buffer_load_dwordx4 v[100:103], v52, s[20:23], s69 offen offset:0 sc1
    buffer_load_dwordx4 v[104:107], v52, s[20:23], s69 offen offset:512 sc1
    s_bitset0_b32 s70, s51
K_RD5:
    ds_read_b64_tr_b16 v[172:173], v56 offset:0
    ds_read_b64_tr_b16 v[174:175], v56 offset:512
    ds_read_b64_tr_b16 v[176:177], v56 offset:2048
    ds_read_b64_tr_b16 v[178:179], v56 offset:2560
    ds_read_b64_tr_b16 v[180:181], v57 offset:0
    ds_read_b64_tr_b16 v[182:183], v57 offset:512
    ds_read_b64_tr_b16 v[184:185], v57 offset:2048
    ds_read_b64_tr_b16 v[186:187], v57 offset:2560
    s_cmp_lt_i32 s65, 0
    s_cbranch_scc0 K_TL5
    v_and_or_b32 v56, s67, v53, v54
    v_and_or_b32 v57, s67, v53, v55
    s_branch K_SK0
K_NUL5:
    s_and_b32 s51, s65, s66
    s_and_b32 s51, s51, s67
    s_and_b32 s51, s51, s68
    s_cmp_lt_i32 s51, 0
    s_cbranch_scc0 K_PC5
    s_cmp_eq_u32 s70, 0
    s_cbranch_scc1 K_P2_MM
    s_branch K_SPN
K_PC5:
    s_cmp_eq_u32 s70, 0
    s_cbranch_scc1 K_NI5
    ds_read_b32 v59, v58
    s_waitcnt lgkmcnt(0)
    v_readfirstlane_b32 s50, v59
    s_and_b32 s33, s50, s70
    s_cbranch_scc1 K_BK5
    ds_read_b32 v59, v58
    s_waitcnt lgkmcnt(0)
    v_readfirstlane_b32 s50, v59
    s_and_b32 s33, s50, s70
    s_cbranch_scc1 K_BK5
K_NI5:
    s_mov_b32 s69, -1
    v_mov_b32 v100, -1
    buffer_load_dword v3, v52, s[20:23], s69 offen
    buffer_load_dword v3, v52, s[20:23], s69 offen
    s_branch K_RD5
K_P2_MM:
    v_cvt_pk_bf16_f32 v188, v108, v109
    v_cvt_pk_bf16_f32 v189, v110, v111
    ds_write_b64 v50, v[188:189] offset:0
    v_cvt_pk_bf16_f32 v190, v112, v113
    v_cvt_pk_bf16_f32 v191, v114, v115
    ds_write_b64 v50, v[190:191] offset:16
    v_cvt_pk_bf16_f32 v192, v116, v117
    v_cvt_pk_bf16_f32 v193, v118, v119
    ds_write_b64 v50, v[192:193] offset:32
    v_cvt_pk_bf16_f32 v194, v120, v121
    v_cvt_pk_bf16_f32 v195, v122, v123
    ds_write_b64 v50, v[194:195] offset:48
    v_cvt_pk_bf16_f32 v188, v124, v125
    v_cvt_pk_bf16_f32 v189, v126, v127
    ds_write_b64 v50, v[188:189] offset:64
    v_cvt_pk_bf16_f32 v190, v128, v129
    v_cvt_pk_bf16_f32 v191, v130, v131
    ds_write_b64 v50, v[190:191] offset:80
    v_cvt_pk_bf16_f32 v192, v132, v133
    v_cvt_pk_bf16_f32 v193, v134, v135
    ds_write_b64 v50, v[192:193] offset:96
    v_cvt_pk_bf16_f32 v194, v136, v137
    v_cvt_pk_bf16_f32 v195, v138, v139
    ds_write_b64 v50, v[194:195] offset:112
K_P2_E2:
    s_waitcnt vmcnt(0) lgkmcnt(0)
    s_lshl_b32 s72, s61, 4
    s_barrier
    ds_read_b64 v[28:29], v15
    ds_read_b64 v[24:25], v11
    ds_read_b128 v[48:51], v14
    ds_read_b64 v[26:27], v11 offset:64
    ds_read_b128 v[52:55], v14 offset:1152
    s_waitcnt lgkmcnt(4)
    v_readfirstlane_b32 s48, v28
    v_readfirstlane_b32 s49, v29
    s_sub_u32 s3, s48, s72
    s_cmp_lt_u32 s3, 16
    s_cbranch_scc1 K_YROW0
K_NOY0:
    s_sub_u32 s3, s49, s72
    s_cmp_lt_u32 s3, 16
    s_cbranch_scc1 K_YROW1
K_NOY1:
    s_waitcnt lgkmcnt(3)
    v_pk_mul_f32 v[32:33], v[32:33], v[24:25] op_sel:[0,1] op_sel_hi:[1,1]
    v_pk_mul_f32 v[34:35], v[34:35], v[24:25] op_sel:[0,1] op_sel_hi:[1,1]
    v_pk_mul_f32 v[36:37], v[36:37], v[24:25] op_sel:[0,1] op_sel_hi:[1,1]
    v_pk_mul_f32 v[38:39], v[38:39], v[24:25] op_sel:[0,1] op_sel_hi:[1,1]
    s_waitcnt lgkmcnt(2)
    v_lshlrev_b32 v68, 16, v48
    v_and_b32 v69, 0xffff0000, v48
    v_pk_fma_f32 v[68:69], v[68:69], v[24:25], v[32:33] op_sel_hi:[1,0,1]
    v_cvt_pk_bf16_f32 v48, v68, v69
    v_lshlrev_b32 v70, 16, v49
    v_and_b32 v71, 0xffff0000, v49
    v_pk_fma_f32 v[70:71], v[70:71], v[24:25], v[34:35] op_sel_hi:[1,0,1]
    v_cvt_pk_bf16_f32 v49, v70, v71
    v_lshlrev_b32 v68, 16, v50
    v_and_b32 v69, 0xffff0000, v50
    v_pk_fma_f32 v[68:69], v[68:69], v[24:25], v[36:37] op_sel_hi:[1,0,1]
    v_cvt_pk_bf16_f32 v50, v68, v69
    v_lshlrev_b32 v70, 16, v51
    v_and_b32 v71, 0xffff0000, v51
    v_pk_fma_f32 v[70:71], v[70:71], v[24:25], v[38:39] op_sel_hi:[1,0,1]
    v_cvt_pk_bf16_f32 v51, v70, v71
    buffer_store_dwordx4 v[48:51], v10, s[56:59], 0 offen sc1
    s_waitcnt lgkmcnt(1)
    v_pk_mul_f32 v[40:41], v[40:41], v[26:27] op_sel:[0,1] op_sel_hi:[1,1]
    v_pk_mul_f32 v[42:43], v[42:43], v[26:27] op_sel:[0,1] op_sel_hi:[1,1]
    v_pk_mul_f32 v[44:45], v[44:45], v[26:27] op_sel:[0,1] op_sel_hi:[1,1]
    v_pk_mul_f32 v[46:47], v[46:47], v[26:27] op_sel:[0,1] op_sel_hi:[1,1]
    s_waitcnt lgkmcnt(0)
    v_lshlrev_b32 v68, 16, v52
    v_and_b32 v69, 0xffff0000, v52
    v_pk_fma_f32 v[68:69], v[68:69], v[26:27], v[40:41] op_sel_hi:[1,0,1]
    v_cvt_pk_bf16_f32 v52, v68, v69
    v_lshlrev_b32 v70, 16, v53
    v_and_b32 v71, 0xffff0000, v53
    v_pk_fma_f32 v[70:71], v[70:71], v[26:27], v[42:43] op_sel_hi:[1,0,1]
    v_cvt_pk_bf16_f32 v53, v70, v71
    v_lshlrev_b32 v68, 16, v54
    v_and_b32 v69, 0xffff0000, v54
    v_pk_fma_f32 v[68:69], v[68:69], v[26:27], v[44:45] op_sel_hi:[1,0,1]
    v_cvt_pk_bf16_f32 v54, v68, v69
    v_lshlrev_b32 v70, 16, v55
    v_and_b32 v71, 0xffff0000, v55
    v_pk_fma_f32 v[70:71], v[70:71], v[26:27], v[46:47] op_sel_hi:[1,0,1]
    v_cvt_pk_bf16_f32 v55, v70, v71
    buffer_store_dwordx4 v[52:55], v10, s[56:59], s63 offen sc1
K_END:
K_EXIT:
    s_endpgm
K_YROW0:
    v_and_b32 v2, 7, v1
    v_lshlrev_b32 v2, 5, v2
    v_add_u32 v2, 158976, v2
    ds_read_b128 v[56:59], v2
    ds_read_b128 v[60:63], v2 offset:16
    s_and_b32 s33, s3, 7
    v_cmp_eq_u32 vcc, s33, v8
    s_cmp_ge_u32 s3, 8
    s_cbranch_scc1 K_YR1_0
    s_waitcnt lgkmcnt(0)
    v_add_f32 v64, v32, v56
    v_cvt_pk_bf16_f32 v64, v64, v64
    v_lshlrev_b32 v64, 16, v64
    v_cndmask_b32 v32, v32, v64, vcc
    v_add_f32 v65, v33, v57
    v_cvt_pk_bf16_f32 v65, v65, v65
    v_lshlrev_b32 v65, 16, v65
    v_cndmask_b32 v33, v33, v65, vcc
    v_add_f32 v66, v34, v58
    v_cvt_pk_bf16_f32 v66, v66, v66
    v_lshlrev_b32 v66, 16, v66
    v_cndmask_b32 v34, v34, v66, vcc
    v_add_f32 v67, v35, v59
    v_cvt_pk_bf16_f32 v67, v67, v67
    v_lshlrev_b32 v67, 16, v67
    v_cndmask_b32 v35, v35, v67, vcc
    v_add_f32 v64, v36, v60
    v_cvt_pk_bf16_f32 v64, v64, v64
    v_lshlrev_b32 v64, 16, v64
    v_cndmask_b32 v36, v36, v64, vcc
    v_add_f32 v65, v37, v61
    v_cvt_pk_bf16_f32 v65, v65, v65
    v_lshlrev_b32 v65, 16, v65
    v_cndmask_b32 v37, v37, v65, vcc
    v_add_f32 v66, v38, v62
    v_cvt_pk_bf16_f32 v66, v66, v66
    v_lshlrev_b32 v66, 16, v66
    v_cndmask_b32 v38, v38, v66, vcc
    v_add_f32 v67, v39, v63
    v_cvt_pk_bf16_f32 v67, v67, v67
    v_lshlrev_b32 v67, 16, v67
    v_cndmask_b32 v39, v39, v67, vcc
    s_branch K_NOY0
K_YR1_0:
    s_waitcnt lgkmcnt(0)
    v_add_f32 v64, v40, v56
    v_cvt_pk_bf16_f32 v64, v64, v64
    v_lshlrev_b32 v64, 16, v64
    v_cndmask_b32 v40, v40, v64, vcc
    v_add_f32 v65, v41, v57
    v_cvt_pk_bf16_f32 v65, v65, v65
    v_lshlrev_b32 v65, 16, v65
    v_cndmask_b32 v41, v41, v65, vcc
    v_add_f32 v66, v42, v58
    v_cvt_pk_bf16_f32 v66, v66, v66
    v_lshlrev_b32 v66, 16, v66
    v_cndmask_b32 v42, v42, v66, vcc
    v_add_f32 v67, v43, v59
    v_cvt_pk_bf16_f32 v67, v67, v67
    v_lshlrev_b32 v67, 16, v67
    v_cndmask_b32 v43, v43, v67, vcc
    v_add_f32 v64, v44, v60
    v_cvt_pk_bf16_f32 v64, v64, v64
    v_lshlrev_b32 v64, 16, v64
    v_cndmask_b32 v44, v44, v64, vcc
    v_add_f32 v65, v45, v61
    v_cvt_pk_bf16_f32 v65, v65, v65
    v_lshlrev_b32 v65, 16, v65
    v_cndmask_b32 v45, v45, v65, vcc
    v_add_f32 v66, v46, v62
    v_cvt_pk_bf16_f32 v66, v66, v66
    v_lshlrev_b32 v66, 16, v66
    v_cndmask_b32 v46, v46, v66, vcc
    v_add_f32 v67, v47, v63
    v_cvt_pk_bf16_f32 v67, v67, v67
    v_lshlrev_b32 v67, 16, v67
    v_cndmask_b32 v47, v47, v67, vcc
    s_branch K_NOY0
K_YROW1:
    v_and_b32 v2, 7, v1
    v_lshlrev_b32 v2, 5, v2
    v_add_u32 v2, 159232, v2
    ds_read_b128 v[56:59], v2
    ds_read_b128 v[60:63], v2 offset:16
    s_and_b32 s33, s3, 7
    v_cmp_eq_u32 vcc, s33, v8
    s_cmp_ge_u32 s3, 8
    s_cbranch_scc1 K_YR1_1
    s_waitcnt lgkmcnt(0)
    v_add_f32 v64, v32, v56
    v_cvt_pk_bf16_f32 v64, v64, v64
    v_lshlrev_b32 v64, 16, v64
    v_cndmask_b32 v32, v32, v64, vcc
    v_add_f32 v65, v33, v57
    v_cvt_pk_bf16_f32 v65, v65, v65
    v_lshlrev_b32 v65, 16, v65
    v_cndmask_b32 v33, v33, v65, vcc
    v_add_f32 v66, v34, v58
    v_cvt_pk_bf16_f32 v66, v66, v66
    v_lshlrev_b32 v66, 16, v66
    v_cndmask_b32 v34, v34, v66, vcc
    v_add_f32 v67, v35, v59
    v_cvt_pk_bf16_f32 v67, v67, v67
    v_lshlrev_b32 v67, 16, v67
    v_cndmask_b32 v35, v35, v67, vcc
    v_add_f32 v64, v36, v60
    v_cvt_pk_bf16_f32 v64, v64, v64
    v_lshlrev_b32 v64, 16, v64
    v_cndmask_b32 v36, v36, v64, vcc
    v_add_f32 v65, v37, v61
    v_cvt_pk_bf16_f32 v65, v65, v65
    v_lshlrev_b32 v65, 16, v65
    v_cndmask_b32 v37, v37, v65, vcc
    v_add_f32 v66, v38, v62
    v_cvt_pk_bf16_f32 v66, v66, v66
    v_lshlrev_b32 v66, 16, v66
    v_cndmask_b32 v38, v38, v66, vcc
    v_add_f32 v67, v39, v63
    v_cvt_pk_bf16_f32 v67, v67, v67
    v_lshlrev_b32 v67, 16, v67
    v_cndmask_b32 v39, v39, v67, vcc
    s_branch K_NOY1
K_YR1_1:
    s_waitcnt lgkmcnt(0)
    v_add_f32 v64, v40, v56
    v_cvt_pk_bf16_f32 v64, v64, v64
    v_lshlrev_b32 v64, 16, v64
    v_cndmask_b32 v40, v40, v64, vcc
    v_add_f32 v65, v41, v57
    v_cvt_pk_bf16_f32 v65, v65, v65
    v_lshlrev_b32 v65, 16, v65
    v_cndmask_b32 v41, v41, v65, vcc
    v_add_f32 v66, v42, v58
    v_cvt_pk_bf16_f32 v66, v66, v66
    v_lshlrev_b32 v66, 16, v66
    v_cndmask_b32 v42, v42, v66, vcc
    v_add_f32 v67, v43, v59
    v_cvt_pk_bf16_f32 v67, v67, v67
    v_lshlrev_b32 v67, 16, v67
    v_cndmask_b32 v43, v43, v67, vcc
    v_add_f32 v64, v44, v60
    v_cvt_pk_bf16_f32 v64, v64, v64
    v_lshlrev_b32 v64, 16, v64
    v_cndmask_b32 v44, v44, v64, vcc
    v_add_f32 v65, v45, v61
    v_cvt_pk_bf16_f32 v65, v65, v65
    v_lshlrev_b32 v65, 16, v65
    v_cndmask_b32 v45, v45, v65, vcc
    v_add_f32 v66, v46, v62
    v_cvt_pk_bf16_f32 v66, v66, v66
    v_lshlrev_b32 v66, 16, v66
    v_cndmask_b32 v46, v46, v66, vcc
    v_add_f32 v67, v47, v63
    v_cvt_pk_bf16_f32 v67, v67, v67
    v_lshlrev_b32 v67, 16, v67
    v_cndmask_b32 v47, v47, v67, vcc
    s_branch K_NOY1
K_STA10:
    s_branch K_STA14
K_STB10:
    s_branch K_STB14
K_P2:
    s_cmp_ge_u32 s30, 4
    s_cbranch_scc1 K_P2_HELP
    s_lshl_b32 s62, s40, 7
    v_lshrrev_b32 v8, 3, v1
    v_lshrrev_b32 v9, 4, v1
    v_mov_b32 v15, 158720
    s_lshl_b32 s61, s40, 3
    s_add_u32 s61, s61, s30
    s_mul_i32 s3, s61, 20480
    s_lshl_b32 s33, s41, 7
    s_add_u32 s3, s3, s33
    v_and_b32 v2, 7, v1
    v_lshlrev_b32 v2, 4, v2
    v_mul_u32_u24 v4, 1280, v8
    v_add3_u32 v10, v2, v4, s3
    s_lshl_b32 s3, s30, 7
    s_add_u32 s3, s3, 159744
    v_lshl_add_u32 v11, v8, 3, s3
    s_mov_b32 s63, 10240
    s_add_u32 s20, s6, 0x100000
    s_addc_u32 s21, s7, 0
    s_mov_b32 s22, 0x280000
    s_mov_b32 s23, 0x20000
    s_mov_b32 s56, s10
    s_mov_b32 s57, s11
    s_mov_b32 s58, 0x280000
    s_mov_b32 s59, 0x20000
    v_mul_u32_u24 v3, 144, v8
    v_add_u32 v3, v2, v3
    s_mul_i32 s3, s30, 2304
    s_add_u32 s3, s3, 140288
    v_add_u32 v14, s3, v3
    buffer_load_dwordx4 v[16:19], v10, s[12:15], 0 offen
    buffer_load_dwordx4 v[20:23], v10, s[12:15], s63 offen
    v_bfe_u32 v48, v1, 2, 2
    v_and_b32 v49, 3, v1
    s_add_u32 s3, s61, s30
    s_lshr_b32 s33, s3, 2
    s_mul_i32 s33, s33, 76
    s_add_u32 s3, s3, s33
    s_lshl_b32 s3, s3, 10
    v_and_b32 v2, 15, v1
    v_lshl_add_u32 v2, v2, 4, s3
    v_lshrrev_b32 v3, 5, v1
    v_lshl_add_u32 v2, v3, 8, v2
    v_and_b32 v4, 1, v9
    v_lshl_add_u32 v52, v4, 10, v2
    v_mov_b32 v53, 0x1f000
    v_lshl_add_u32 v2, v3, 3, v48
    v_lshlrev_b32 v2, 7, v2
    v_lshl_add_u32 v2, v49, 3, v2
    v_lshl_add_u32 v2, v4, 5, v2
    v_lshrrev_b32 v4, 1, v48
    v_lshl_add_u32 v54, v4, 6, v2
    v_xor_b32 v55, 64, v54
    v_mov_b32 v56, v54
    v_mov_b32 v57, v54
    v_and_b32 v2, 31, v1
    v_mul_u32_u24 v2, 144, v2
    v_lshl_add_u32 v2, v3, 3, v2
    s_mul_i32 s3, s30, 4608
    s_add_u32 s3, s3, 140288
    v_add_u32 v50, s3, v2
    s_lshl_b32 s3, s40, 3
    s_mul_i32 s33, s3, 187
    s_lshr_b32 s33, s33, 11
    s_add_u32 s33, s33, 1
    s_mul_i32 s33, s33, 11
    s_add_u32 s3, s61, s30
    s_add_u32 s3, s3, 1
    s_cmp_ge_u32 s3, s33
    s_cselect_b32 s60, 24, 16
    s_cmp_gt_u32 s3, s33
    s_cselect_b32 s60, 20, s60
    v_add_u32 v58, s60, v15
    s_mov_b32 s64, -1
    s_mov_b32 s65, -1
    s_mov_b32 s66, -1
    s_mov_b32 s67, -1
    s_mov_b32 s68, -1
    s_mov_b32 s69, -1
    s_mov_b32 s70, 0xfffff
    s_mov_b32 s71, 131072
    v_mov_b32 v108, 0
    v_mov_b32 v109, 0
    v_mov_b32 v110, 0
    v_mov_b32 v111, 0
    v_mov_b32 v112, 0
    v_mov_b32 v113, 0
    v_mov_b32 v114, 0
    v_mov_b32 v115, 0
    v_mov_b32 v116, 0
    v_mov_b32 v117, 0
    v_mov_b32 v118, 0
    v_mov_b32 v119, 0
    v_mov_b32 v120, 0
    v_mov_b32 v121, 0
    v_mov_b32 v122, 0
    v_mov_b32 v123, 0
    v_mov_b32 v124, 0
    v_mov_b32 v125, 0
    v_mov_b32 v126, 0
    v_mov_b32 v127, 0
    v_mov_b32 v128, 0
    v_mov_b32 v129, 0
    v_mov_b32 v130, 0
    v_mov_b32 v131, 0
    v_mov_b32 v132, 0
    v_mov_b32 v133, 0
    v_mov_b32 v134, 0
    v_mov_b32 v135, 0
    v_mov_b32 v136, 0
    v_mov_b32 v137, 0
    v_mov_b32 v138, 0
    v_mov_b32 v139, 0
K_P2_AUXW:
    v_lshrrev_b32 v2, 3, v1
    v_mul_u32_u24 v2, 1280, v2
    v_lshrrev_b32 v3, 2, v1
    v_and_b32 v3, 4, v3
    v_and_b32 v4, 7, v1
    v_xor_b32 v3, v3, v4
    v_lshl_add_u32 v2, v3, 4, v2
    s_lshl_b32 s33, s41, 7
    v_add_u32 v51, s33, v2
    v_lshrrev_b32 v5, 5, v1
    v_mul_u32_u24 v5, 20480, v5
    v_add_u32 v5, v5, v51
    s_lshl_b32 s52, s30, 2
    s_lshr_b32 s52, 0x7520, s52
    s_and_b32 s52, s52, 7
    s_mul_i32 s52, s52, 51200
    s_lshl_b32 s53, s30, 12
    s_add_u32 s60, s52, 0
    s_add_u32 m0, s53, 0
    s_waitcnt vmcnt(5)
    buffer_load_dwordx4 v51, s[24:27], s60 offen lds
    s_add_u32 s60, s52, 10240
    s_add_u32 m0, s53, 1024
    s_waitcnt vmcnt(5)
    buffer_load_dwordx4 v51, s[24:27], s60 offen lds
    s_add_u32 s60, s52, 25600
    s_add_u32 m0, s53, 2048
    s_waitcnt vmcnt(5)
    buffer_load_dwordx4 v51, s[24:27], s60 offen lds
    s_add_u32 s60, s52, 35840
    s_add_u32 m0, s53, 3072
    s_waitcnt vmcnt(5)
    buffer_load_dwordx4 v51, s[24:27], s60 offen lds
    s_add_u32 s60, s52, 409600
    s_add_u32 m0, s53, 20480
    s_waitcnt vmcnt(5)
    buffer_load_dwordx4 v51, s[24:27], s60 offen lds
    s_add_u32 s60, s52, 419840
    s_add_u32 m0, s53, 21504
    s_waitcnt vmcnt(5)
    buffer_load_dwordx4 v51, s[24:27], s60 offen lds
    v_mov_b32 v3, 1
    s_mov_b64 exec, 1
    ds_add_u32 v15, v3 offset:52
    s_mov_b64 exec, -1
    s_add_u32 s60, s52, 435200
    s_add_u32 m0, s53, 22528
    s_waitcnt vmcnt(5)
    buffer_load_dwordx4 v51, s[24:27], s60 offen lds
    s_add_u32 s60, s52, 445440
    s_add_u32 m0, s53, 23552
    s_waitcnt vmcnt(5)
    buffer_load_dwordx4 v51, s[24:27], s60 offen lds
    s_lshl_b32 s53, s30, 10
    s_add_u32 s60, s52, 20480
    s_add_u32 m0, s53, 16384
    s_waitcnt vmcnt(5)
    buffer_load_dwordx4 v5, s[24:27], s60 offen lds
    s_add_u32 s60, s52, 430080
    s_add_u32 m0, s53, 36864
    s_waitcnt vmcnt(5)
    buffer_load_dwordx4 v5, s[24:27], s60 offen lds
    s_cmp_eq_u32 s30, 0
    s_cbranch_scc1 K_CHA0
    s_cmp_eq_u32 s30, 1
    s_cbranch_scc1 K_CHA1
    s_cmp_eq_u32 s30, 2
    s_cbranch_scc1 K_CHA2
    s_branch K_CHA3
K_WRET_A:
    v_mov_b32 v3, 1
    s_waitcnt vmcnt(0)
    s_mov_b64 exec, 1
    ds_add_u32 v15, v3 offset:44
    s_mov_b64 exec, -1
    s_mov_b32 s3, 1048576
K_P2_GWA:
    ds_read_b32 v2, v15 offset:44
    s_sub_u32 s3, s3, 1
    s_waitcnt lgkmcnt(0)
    v_readfirstlane_b32 s33, v2
    s_nop 3
    s_cselect_b32 s33, 4, s33
    s_cmp_lt_u32 s33, 4
    s_cbranch_scc1 K_P2_GWA
    s_branch K_P2_GEMM
K_STA11:
    s_branch K_STA15
K_STB11:
    s_branch K_STB15
K_P2_HELP:
    s_setprio 3
    s_cmp_eq_u32 s30, 7
    s_cbranch_scc1 K_P2_W7
    s_cmp_eq_u32 s30, 4
    s_cbranch_scc1 K_P2_NL
    s_cmp_ge_u32 s29, 8
    s_cbranch_scc1 K_P2_NL
    s_mov_b32 s24, s8
    s_mov_b32 s25, s9
    s_mov_b32 s26, 0xc8000
    s_mov_b32 s27, 0x20000
    v_lshrrev_b32 v2, 3, v1
    v_mul_u32_u24 v2, 1280, v2
    v_lshrrev_b32 v3, 2, v1
    v_and_b32 v3, 4, v3
    v_and_b32 v4, 7, v1
    v_xor_b32 v3, v3, v4
    v_lshl_add_u32 v2, v3, 4, v2
    s_lshl_b32 s33, s41, 7
    v_add_u32 v12, s33, v2
    v_lshrrev_b32 v5, 5, v1
    s_branch K_PG5
.p2align 12
K_STA12:
    s_branch K_WRET_A
K_STB12:
    s_branch K_WRET_B
K_PG5:
    v_mul_u32_u24 v5, 20480, v5
    v_add_u32 v5, v5, v12
    s_sub_u32 s61, s30, 5
    s_lshl_b32 s52, s61, 2
    s_lshr_b32 s52, 0x6431, s52
    s_and_b32 s52, s52, 7
    s_mul_i32 s52, s52, 51200
    s_lshl_b32 s53, s61, 12
    s_add_u32 s60, s52, 0
    s_add_u32 m0, s53, 40960
    s_nop 0
    buffer_load_dwordx4 v12, s[24:27], s60 offen lds
    s_add_u32 s60, s52, 10240
    s_add_u32 m0, s53, 41984
    s_nop 0
    buffer_load_dwordx4 v12, s[24:27], s60 offen lds
    s_add_u32 s60, s52, 25600
    s_add_u32 m0, s53, 43008
    s_nop 0
    buffer_load_dwordx4 v12, s[24:27], s60 offen lds
    s_add_u32 s60, s52, 35840
    s_add_u32 m0, s53, 44032
    s_nop 0
    buffer_load_dwordx4 v12, s[24:27], s60 offen lds
    s_add_u32 s60, s52, 409600
    s_add_u32 m0, s53, 61440
    s_nop 0
    buffer_load_dwordx4 v12, s[24:27], s60 offen lds
    s_add_u32 s60, s52, 419840
    s_add_u32 m0, s53, 62464
    s_nop 0
    buffer_load_dwordx4 v12, s[24:27], s60 offen lds
    s_add_u32 s60, s52, 435200
    s_add_u32 m0, s53, 63488
    s_nop 0
    buffer_load_dwordx4 v12, s[24:27], s60 offen lds
    s_add_u32 s60, s52, 445440
    s_add_u32 m0, s53, 64512
    s_nop 0
    buffer_load_dwordx4 v12, s[24:27], s60 offen lds
    s_lshl_b32 s53, s61, 10
    s_add_u32 s60, s52, 20480
    s_add_u32 m0, s53, 57344
    s_nop 0
    buffer_load_dwordx4 v5, s[24:27], s60 offen lds
    s_add_u32 s60, s52, 430080
    s_add_u32 m0, s53, 77824
    s_nop 0
    buffer_load_dwordx4 v5, s[24:27], s60 offen lds
    s_add_u32 s61, s61, 2
    s_lshl_b32 s52, s61, 2
    s_lshr_b32 s52, 0x6431, s52
    s_and_b32 s52, s52, 7
    s_mul_i32 s52, s52, 51200
    s_lshl_b32 s53, s61, 12
    s_add_u32 s60, s52, 0
    s_add_u32 m0, s53, 40960
    s_nop 0
    buffer_load_dwordx4 v12, s[24:27], s60 offen lds
    s_add_u32 s60, s52, 10240
    s_add_u32 m0, s53, 41984
    s_nop 0
    buffer_load_dwordx4 v12, s[24:27], s60 offen lds
    s_add_u32 s60, s52, 25600
    s_add_u32 m0, s53, 43008
    s_nop 0
    buffer_load_dwordx4 v12, s[24:27], s60 offen lds
    s_add_u32 s60, s52, 35840
    s_add_u32 m0, s53, 44032
    s_nop 0
    buffer_load_dwordx4 v12, s[24:27], s60 offen lds
    s_add_u32 s60, s52, 409600
    s_add_u32 m0, s53, 61440
    s_nop 0
    buffer_load_dwordx4 v12, s[24:27], s60 offen lds
    s_add_u32 s60, s52, 419840
    s_add_u32 m0, s53, 62464
    s_nop 0
    buffer_load_dwordx4 v12, s[24:27], s60 offen lds
    s_add_u32 s60, s52, 435200
    s_add_u32 m0, s53, 63488
    s_nop 0
    buffer_load_dwordx4 v12, s[24:27], s60 offen lds
    s_add_u32 s60, s52, 445440
    s_add_u32 m0, s53, 64512
    s_nop 0
    buffer_load_dwordx4 v12, s[24:27], s60 offen lds
    s_lshl_b32 s53, s61, 10
    s_add_u32 s60, s52, 20480
    s_add_u32 m0, s53, 57344
    s_nop 0
    buffer_load_dwordx4 v5, s[24:27], s60 offen lds
    s_add_u32 s60, s52, 430080
    s_add_u32 m0, s53, 77824
    s_nop 0
    buffer_load_dwordx4 v5, s[24:27], s60 offen lds
    v_mov_b32 v2, 158720
    v_mov_b32 v3, 1
    s_waitcnt vmcnt(0)
    s_mov_b64 exec, 1
    ds_add_u32 v2, v3 offset:56
    s_mov_b64 exec, -1
K_P2_NL:
    s_lshl_b32 s62, s40, 7
    v_lshrrev_b32 v8, 3, v1
    v_lshrrev_b32 v9, 4, v1
    v_mov_b32 v15, 158720
    s_lshl_b32 s61, s40, 3
    s_add_u32 s61, s61, s30
    s_mul_i32 s3, s61, 20480
    s_lshl_b32 s33, s41, 7
    s_add_u32 s3, s3, s33
    v_and_b32 v2, 7, v1
    v_lshlrev_b32 v2, 4, v2
    v_mul_u32_u24 v4, 1280, v8
    v_add3_u32 v10, v2, v4, s3
    s_lshl_b32 s3, s30, 7
    s_add_u32 s3, s3, 159744
    v_lshl_add_u32 v11, v8, 3, s3
    s_mov_b32 s63, 10240
    s_add_u32 s20, s6, 0x100000
    s_addc_u32 s21, s7, 0
    s_mov_b32 s22, 0x280000
    s_mov_b32 s23, 0x20000
    s_mov_b32 s56, s10
    s_mov_b32 s57, s11
    s_mov_b32 s58, 0x280000
    s_mov_b32 s59, 0x20000
    v_mul_u32_u24 v3, 144, v8
    v_add_u32 v3, v2, v3
    s_mul_i32 s3, s30, 2304
    s_add_u32 s3, s3, 140288
    v_add_u32 v14, s3, v3
    s_add_u32 s44, s6, 0x10000
    s_addc_u32 s45, s7, 0
    s_mov_b32 s46, 0x43800
    s_mov_b32 s47, 0x20000
    v_mov_b32 v108, 1
    buffer_load_dwordx4 v[16:19], v10, s[12:15], 0 offen
    buffer_load_dwordx4 v[20:23], v10, s[12:15], s63 offen
    s_cmp_lg_u32 s30, 6
    s_cbranch_scc1 K_P2_HW
    s_mov_b32 s3, 131072
    s_waitcnt vmcnt(2)
K_P2_DPOLL:
    v_min_u32 v2, v7, v6
    v_cmp_eq_u32 vcc, 0, v2
    s_cbranch_vccz K_P2_DOK
    s_cmp_eq_u32 s3, 131072
    s_cbranch_scc1 K_P2_DNS
    s_sleep 12
K_P2_DNS:
    v_lshl_add_u32 v13, v1, 2, s42
    global_load_dword v7, v13, s[6:7] offset:256 sc1
    v_and_b32 v13, 0xfffffe04, v13
    global_load_dword v6, v13, s[6:7] offset:128 sc1
    s_sub_u32 s3, s3, 1
    s_waitcnt vmcnt(0)
    s_cmp_lg_u32 s3, 0
    s_cbranch_scc1 K_P2_DPOLL
K_P2_DOK:
    v_readlane_b32 s52, v6, 0
    v_readlane_b32 s53, v6, 1
    s_nop 1
    s_and_b32 s3, s52, 0x7ff
    s_sub_u32 s3, 2047, s3
    v_mov_b32 v48, s3
    v_mov_b32 v4, s52
    v_and_b32 v4, 0xffff0000, v4
    v_ashrrev_i32 v5, 31, v4
    v_not_b32 v5, v5
    v_or_b32 v5, 0x80000000, v5
    v_xor_b32 v4, v4, v5
    v_and_b32 v4, 0xffff0000, v4
    v_mul_f32 v5, 0xbfb8aa3b, v4
    v_exp_f32 v5, v5
    s_nop 0
    v_add_f32 v5, 1.0, v5
    v_rcp_f32 v4, v5
    s_nop 0
    v_cvt_pk_bf16_f32 v50, v4, v4
    v_lshlrev_b32 v50, 16, v50
    s_and_b32 s3, s53, 0x7ff
    s_sub_u32 s3, 2047, s3
    v_mov_b32 v49, s3
    v_mov_b32 v4, s53
    v_and_b32 v4, 0xffff0000, v4
    v_ashrrev_i32 v5, 31, v4
    v_not_b32 v5, v5
    v_or_b32 v5, 0x80000000, v5
    v_xor_b32 v4, v4, v5
    v_and_b32 v4, 0xffff0000, v4
    v_mul_f32 v5, 0xbfb8aa3b, v4
    v_exp_f32 v5, v5
    s_nop 0
    v_add_f32 v5, 1.0, v5
    v_rcp_f32 v4, v5
    s_nop 0
    v_cvt_pk_bf16_f32 v51, v4, v4
    v_lshlrev_b32 v51, 16, v51
    ds_write_b128 v15, v[48:51]
    ds_write_b32 v15, v108 offset:40
    v_lshl_add_u32 v13, v1, 4, v15
    v_lshlrev_b32 v52, 16, v7
    v_and_b32 v52, 0x7fff0000, v52
    v_and_b32 v54, 0x7fff0000, v7
    v_sub_f32 v53, 1.0, v52
    v_cvt_pk_bf16_f32 v53, v53, v53
    v_lshlrev_b32 v53, 16, v53
    v_sub_f32 v55, 1.0, v54
    v_cvt_pk_bf16_f32 v55, v55, v55
    v_lshlrev_b32 v55, 16, v55
    ds_write_b128 v13, v[52:55] offset:1024
    s_branch K_P2_E
K_STA13:
    s_branch K_WRET_A
K_STB13:
    s_branch K_WRET_B
K_P2_HW:
    s_mov_b32 s3, 1048576
K_P2_GS2:
    ds_read_b32 v2, v15 offset:40
    s_sleep 1
    s_sub_u32 s3, s3, 1
    s_waitcnt lgkmcnt(0)
    v_readfirstlane_b32 s33, v2
    s_nop 3
    s_cselect_b32 s33, 1, s33
    s_cmp_lt_u32 s33, 1
    s_cbranch_scc1 K_P2_GS2
    ds_read_b128 v[28:31], v15
    s_waitcnt lgkmcnt(0)
    s_cmp_eq_u32 s30, 4
    s_cselect_b64 vcc, -1, 0
    s_nop 1
    v_cndmask_b32 v2, v29, v28, vcc
    v_cndmask_b32 v5, v31, v30, vcc
    s_nop 0
    v_readfirstlane_b32 s52, v2
    s_nop 3
    s_sub_u32 s3, s52, s62
    s_cmp_lt_u32 s3, 128
    s_cbranch_scc0 K_P2_E
    s_mov_b32 s3, 131072
K_P2_YPOLL:
    s_load_dword s33, s[6:7], s42 offset:136 glc
    s_waitcnt lgkmcnt(0)
    s_cmp_lg_u32 s33, 0
    s_cbranch_scc1 K_P2_YGO
    s_sleep 4
    s_sub_u32 s3, s3, 1
    s_cbranch_scc0 K_P2_YPOLL
K_P2_YGO:
    v_and_b32 v2, 15, v1
    v_lshlrev_b32 v2, 4, v2
    v_mul_u32_u24 v4, 5120, v9
    s_sub_u32 s53, s30, 4
    s_mul_i32 s33, s53, 2560
    s_lshl_b32 s3, s41, 8
    s_add_u32 s3, s3, s33
    v_add3_u32 v3, v2, v4, s3
    s_mov_b32 s60, 0
    buffer_load_dwordx4 v[52:55], v3, s[44:47], s60 offen sc1
    s_mov_b32 s60, 20480
    buffer_load_dwordx4 v[56:59], v3, s[44:47], s60 offen sc1
    s_mov_b32 s60, 40960
    buffer_load_dwordx4 v[60:63], v3, s[44:47], s60 offen sc1
    s_mov_b32 s60, 61440
    buffer_load_dwordx4 v[64:67], v3, s[44:47], s60 offen sc1
    s_mov_b32 s60, 81920
    buffer_load_dwordx4 v[68:71], v3, s[44:47], s60 offen sc1
    s_mov_b32 s60, 102400
    buffer_load_dwordx4 v[72:75], v3, s[44:47], s60 offen sc1
    s_mov_b32 s60, 122880
    buffer_load_dwordx4 v[76:79], v3, s[44:47], s60 offen sc1
    s_mov_b32 s60, 143360
    buffer_load_dwordx4 v[80:83], v3, s[44:47], s60 offen sc1
    s_mov_b32 s60, 163840
    buffer_load_dwordx4 v[84:87], v3, s[44:47], s60 offen sc1
    s_mov_b32 s60, 184320
    buffer_load_dwordx4 v[88:91], v3, s[44:47], s60 offen sc1
    s_mov_b32 s60, 204800
    buffer_load_dwordx4 v[92:95], v3, s[44:47], s60 offen sc1
    s_mov_b32 s60, 225280
    buffer_load_dwordx4 v[96:99], v3, s[44:47], s60 offen sc1
    s_mov_b32 s60, 245760
    buffer_load_dwordx4 v[100:103], v3, s[44:47], s60 offen sc1
    s_mov_b32 s60, 266240
    buffer_load_dwordx4 v[104:107], v3, s[44:47], s60 offen sc1
    s_waitcnt vmcnt(12)
    v_add_f32 v48, v52, v56
    v_add_f32 v49, v53, v57
    v_add_f32 v50, v54, v58
    v_add_f32 v51, v55, v59
    s_waitcnt vmcnt(11)
    v_add_f32 v48, v48, v60
    v_add_f32 v49, v49, v61
    v_add_f32 v50, v50, v62
    v_add_f32 v51, v51, v63
    s_waitcnt vmcnt(10)
    v_add_f32 v48, v48, v64
    v_add_f32 v49, v49, v65
    v_add_f32 v50, v50, v66
    v_add_f32 v51, v51, v67
    s_waitcnt vmcnt(9)
    v_add_f32 v48, v48, v68
    v_add_f32 v49, v49, v69
    v_add_f32 v50, v50, v70
    v_add_f32 v51, v51, v71
    s_waitcnt vmcnt(8)
    v_add_f32 v48, v48, v72
    v_add_f32 v49, v49, v73
    v_add_f32 v50, v50, v74
    v_add_f32 v51, v51, v75
    s_waitcnt vmcnt(7)
    v_add_f32 v48, v48, v76
    v_add_f32 v49, v49, v77
    v_add_f32 v50, v50, v78
    v_add_f32 v51, v51, v79
    s_waitcnt vmcnt(6)
    v_add_f32 v48, v48, v80
    v_add_f32 v49, v49, v81
    v_add_f32 v50, v50, v82
    v_add_f32 v51, v51, v83
    s_waitcnt vmcnt(5)
    v_add_f32 v48, v48, v84
    v_add_f32 v49, v49, v85
    v_add_f32 v50, v50, v86
    v_add_f32 v51, v51, v87
    s_waitcnt vmcnt(4)
    v_add_f32 v48, v48, v88
    v_add_f32 v49, v49, v89
    v_add_f32 v50, v50, v90
    v_add_f32 v51, v51, v91
    s_waitcnt vmcnt(3)
    v_add_f32 v48, v48, v92
    v_add_f32 v49, v49, v93
    v_add_f32 v50, v50, v94
    v_add_f32 v51, v51, v95
    s_waitcnt vmcnt(2)
    v_add_f32 v48, v48, v96
    v_add_f32 v49, v49, v97
    v_add_f32 v50, v50, v98
    v_add_f32 v51, v51, v99
    s_waitcnt vmcnt(1)
    v_add_f32 v48, v48, v100
    v_add_f32 v49, v49, v101
    v_add_f32 v50, v50, v102
    v_add_f32 v51, v51, v103
    s_waitcnt vmcnt(0)
    v_add_f32 v48, v48, v104
    v_add_f32 v49, v49, v105
    v_add_f32 v50, v50, v106
    v_add_f32 v51, v51, v107
    v_mov_b32 v52, v48
    v_mov_b32 v53, v49
    v_mov_b32 v54, v50
    v_mov_b32 v55, v51
    s_nop 0
    v_permlane16_swap_b32 v48, v52
    v_permlane16_swap_b32 v49, v53
    v_permlane16_swap_b32 v50, v54
    v_permlane16_swap_b32 v51, v55
    v_add_f32 v48, v48, v52
    v_add_f32 v49, v49, v53
    v_add_f32 v50, v50, v54
    v_add_f32 v51, v51, v55
    v_mov_b32 v52, v48
    v_mov_b32 v53, v49
    v_mov_b32 v54, v50
    v_mov_b32 v55, v51
    s_nop 0
    v_permlane32_swap_b32 v48, v52
    v_permlane32_swap_b32 v49, v53
    v_permlane32_swap_b32 v50, v54
    v_permlane32_swap_b32 v51, v55
    v_add_f32 v48, v48, v52
    v_add_f32 v49, v49, v53
    v_add_f32 v50, v50, v54
    v_add_f32 v51, v51, v55
    v_cvt_pk_bf16_f32 v48, v48, v48
    v_lshlrev_b32 v48, 16, v48
    v_mul_f32 v48, v5, v48
    v_cvt_pk_bf16_f32 v48, v48, v48
    v_lshlrev_b32 v48, 16, v48
    v_cvt_pk_bf16_f32 v49, v49, v49
    v_lshlrev_b32 v49, 16, v49
    v_mul_f32 v49, v5, v49
    v_cvt_pk_bf16_f32 v49, v49, v49
    v_lshlrev_b32 v49, 16, v49
    v_cvt_pk_bf16_f32 v50, v50, v50
    v_lshlrev_b32 v50, 16, v50
    v_mul_f32 v50, v5, v50
    v_cvt_pk_bf16_f32 v50, v50, v50
    v_lshlrev_b32 v50, 16, v50
    v_cvt_pk_bf16_f32 v51, v51, v51
    v_lshlrev_b32 v51, 16, v51
    v_mul_f32 v51, v5, v51
    v_cvt_pk_bf16_f32 v51, v51, v51
    v_lshlrev_b32 v51, 16, v51
    s_lshl_b32 s3, s53, 8
    s_add_u32 s3, s3, 158976
    v_add_u32 v2, s3, v2
    ds_write_b128 v2, v[48:51]
    s_branch K_P2_E
K_STA14:
    s_branch K_WRET_A
K_STB14:
    s_branch K_WRET_B
K_P2_W7:
    s_mov_b32 s37, s42
    s_waitcnt lgkmcnt(0)
    s_load_dwordx2 s[48:49], s[6:7], s37 glc
    s_mul_i32 s52, s40, 1496
    s_add_u32 s53, s52, 1309
    s_lshr_b32 s52, s52, 11
    s_lshr_b32 s53, s53, 11
    s_sub_u32 s53, s53, s52
    s_mov_b32 s46, 0x84210
    s_mov_b32 s47, s46
    v_mov_b32 v15, 158720
    v_mov_b32 v5, 0
    v_mov_b32 v48, 0x80000000
    s_mov_b64 exec, 1
    ds_or_b32 v15, v48 offset:16
    ds_or_b32 v15, v48 offset:20
    ds_or_b32 v15, v48 offset:24
    s_waitcnt lgkmcnt(0)
    s_cmp_eq_u32 s53, 0
    s_cselect_b32 s49, s48, s49
    s_lshl_b64 s[50:51], s[48:49], 1
    s_and_b64 s[50:51], s[50:51], s[48:49]
    s_lshl_b64 vcc, s[50:51], 2
    s_and_b64 s[50:51], s[50:51], vcc
    s_lshl_b64 s[50:51], s[50:51], 1
    s_and_b64 s[50:51], s[50:51], s[46:47]
    s_or_b64 s[48:49], s[48:49], s[50:51]
    v_readfirstlane_b32 s52, v5
    s_cmp_ge_u32 s52, 2
    s_cselect_b32 s52, -1, 0x3ff
    s_and_b32 s48, s48, s52
    s_and_b32 s49, s49, s52
    s_and_b32 s52, s48, s49
    v_mov_b32 v48, s48
    v_mov_b32 v49, s49
    v_mov_b32 v50, s52
    s_mov_b64 exec, 1
    ds_or_b64 v15, v[48:49] offset:16
    ds_or_b32 v15, v50 offset:24
    s_mov_b64 exec, -1
    s_load_dwordx2 s[48:49], s[6:7], s37 glc
    s_lshl_b32 s62, s40, 7
    v_lshrrev_b32 v8, 3, v1
    v_lshrrev_b32 v9, 4, v1
    v_mov_b32 v15, 158720
    s_lshl_b32 s61, s40, 3
    s_add_u32 s61, s61, s30
    s_mul_i32 s3, s61, 20480
    s_lshl_b32 s33, s41, 7
    s_add_u32 s3, s3, s33
    v_and_b32 v2, 7, v1
    v_lshlrev_b32 v2, 4, v2
    v_mul_u32_u24 v4, 1280, v8
    v_add3_u32 v10, v2, v4, s3
    s_lshl_b32 s3, s30, 7
    s_add_u32 s3, s3, 159744
    v_lshl_add_u32 v11, v8, 3, s3
    s_mov_b32 s63, 10240
    s_add_u32 s20, s6, 0x100000
    s_addc_u32 s21, s7, 0
    s_mov_b32 s22, 0x280000
    s_mov_b32 s23, 0x20000
    s_mov_b32 s56, s10
    s_mov_b32 s57, s11
    s_mov_b32 s58, 0x280000
    s_mov_b32 s59, 0x20000
    v_mul_u32_u24 v3, 144, v8
    v_add_u32 v3, v2, v3
    s_mul_i32 s3, s30, 2304
    s_add_u32 s3, s3, 140288
    v_add_u32 v14, s3, v3
    buffer_load_dwordx4 v[16:19], v10, s[12:15], 0 offen
    buffer_load_dwordx4 v[20:23], v10, s[12:15], s63 offen
    s_mov_b32 s3, 131072
    s_waitcnt lgkmcnt(0)
K_P2_FP:
    s_load_dwordx2 s[44:45], s[6:7], s37 glc
    s_cmp_eq_u32 s53, 0
    s_cselect_b32 s49, s48, s49
    s_lshl_b64 s[50:51], s[48:49], 1
    s_and_b64 s[50:51], s[50:51], s[48:49]
    s_lshl_b64 vcc, s[50:51], 2
    s_and_b64 s[50:51], s[50:51], vcc
    s_lshl_b64 s[50:51], s[50:51], 1
    s_and_b64 s[50:51], s[50:51], s[46:47]
    s_or_b64 s[48:49], s[48:49], s[50:51]
    v_readfirstlane_b32 s52, v5
    s_cmp_ge_u32 s52, 2
    s_cselect_b32 s52, -1, 0x3ff
    s_and_b32 s48, s48, s52
    s_and_b32 s49, s49, s52
    s_and_b32 s52, s48, s49
    v_mov_b32 v48, s48
    v_mov_b32 v49, s49
    v_mov_b32 v50, s52
    s_mov_b64 exec, 1
    ds_or_b64 v15, v[48:49] offset:16
    ds_or_b32 v15, v50 offset:24
    s_mov_b64 exec, -1
    ds_read_b32 v5, v15 offset:56
    s_cmp_eq_u32 s52, 0xfffff
    s_cbranch_scc1 K_P2_FGO
    s_cmp_lg_u64 s[48:49], 0
    s_cbranch_scc1 K_P2_FS2
    s_sleep 8
K_P2_FS2:
    s_sub_u32 s3, s3, 1
    s_waitcnt lgkmcnt(0)
    s_mov_b64 s[48:49], s[44:45]
    s_cbranch_scc0 K_P2_FP
    s_mov_b32 s3, 0
K_P2_FCHK:
    s_cmp_eq_u32 s53, 0
    s_cselect_b32 s49, s48, s49
    s_lshl_b64 s[50:51], s[48:49], 1
    s_and_b64 s[50:51], s[50:51], s[48:49]
    s_lshl_b64 vcc, s[50:51], 2
    s_and_b64 s[50:51], s[50:51], vcc
    s_lshl_b64 s[50:51], s[50:51], 1
    s_and_b64 s[50:51], s[50:51], s[46:47]
    s_or_b64 s[48:49], s[48:49], s[50:51]
    v_readfirstlane_b32 s52, v5
    s_cmp_ge_u32 s52, 2
    s_cselect_b32 s52, -1, 0x3ff
    s_and_b32 s48, s48, s52
    s_and_b32 s49, s49, s52
    s_and_b32 s52, s48, s49
    v_mov_b32 v48, s48
    v_mov_b32 v49, s49
    v_mov_b32 v50, s52
    s_mov_b64 exec, 1
    ds_or_b64 v15, v[48:49] offset:16
    ds_or_b32 v15, v50 offset:24
    s_mov_b64 exec, -1
    s_cmp_eq_u32 s52, 0xfffff
    s_cbranch_scc1 K_P2_FGO
    s_cmp_lg_u64 s[48:49], 0
    s_cbranch_scc1 K_P2_FS
    s_sleep 8
K_P2_FS:
    s_sleep 2
    s_load_dwordx2 s[48:49], s[6:7], s37 glc
    ds_read_b32 v5, v15 offset:56
    s_sub_u32 s3, s3, 1
    s_waitcnt lgkmcnt(0)
    s_cbranch_scc0 K_P2_FCHK
    v_mov_b32 v48, -1
    v_mov_b32 v49, -1
    v_mov_b32 v50, -1
    ds_write_b96 v15, v[48:50] offset:16
K_P2_FGO:
K_P2_E:
    s_setprio 0
    s_waitcnt vmcnt(0)
    v_lshlrev_b32 v32, 16, v16
    v_and_b32 v33, 0xffff0000, v16
    v_lshlrev_b32 v34, 16, v17
    v_and_b32 v35, 0xffff0000, v17
    v_lshlrev_b32 v36, 16, v18
    v_and_b32 v37, 0xffff0000, v18
    v_lshlrev_b32 v38, 16, v19
    v_and_b32 v39, 0xffff0000, v19
    v_lshlrev_b32 v40, 16, v20
    v_and_b32 v41, 0xffff0000, v20
    v_lshlrev_b32 v42, 16, v21
    v_and_b32 v43, 0xffff0000, v21
    v_lshlrev_b32 v44, 16, v22
    v_and_b32 v45, 0xffff0000, v22
    v_lshlrev_b32 v46, 16, v23
    v_and_b32 v47, 0xffff0000, v23
    s_branch K_P2_E2
K_STA15:
    s_branch K_WRET_A
K_STB15:
    s_branch K_WRET_B
K_SPN:
    s_mov_b32 s64, -1
    s_mov_b32 s65, -1
    s_mov_b32 s66, -1
    s_mov_b32 s67, -1
    s_mov_b32 s68, -1
    s_mov_b32 s69, -1
K_SPL:
    ds_read_b32 v59, v58
    s_waitcnt lgkmcnt(0)
    v_readfirstlane_b32 s50, v59
    s_and_b32 s33, s50, s70
    s_cbranch_scc1 K_BK0
    s_cmp_lt_i32 s50, 0
    s_cbranch_scc0 K_SPG
    s_sleep 1
    s_branch K_SPL
K_SPG:
    s_load_dwordx2 s[48:49], s[6:7], s42 glc
    ds_read_b32 v5, v15 offset:56
    s_waitcnt lgkmcnt(0)
    s_cmp_eq_u32 s53, 0
    s_cselect_b32 s49, s48, s49
    s_lshl_b64 s[50:51], s[48:49], 1
    s_and_b64 s[50:51], s[50:51], s[48:49]
    s_lshl_b64 vcc, s[50:51], 2
    s_and_b64 s[50:51], s[50:51], vcc
    s_lshl_b64 s[50:51], s[50:51], 1
    s_and_b64 s[50:51], s[50:51], s[46:47]
    s_or_b64 s[48:49], s[48:49], s[50:51]
    v_readfirstlane_b32 s52, v5
    s_cmp_ge_u32 s52, 2
    s_cselect_b32 s52, -1, 0x3ff
    s_and_b32 s48, s48, s52
    s_and_b32 s49, s49, s52
    s_and_b32 s52, s48, s49
    v_mov_b32 v188, s48
    v_mov_b32 v189, s49
    v_mov_b32 v190, s52
    s_mov_b64 exec, 1
    ds_or_b64 v15, v[188:189] offset:16
    ds_or_b32 v15, v190 offset:24
    s_mov_b64 exec, -1
    ds_read_b32 v59, v58
    s_waitcnt lgkmcnt(0)
    v_readfirstlane_b32 s50, v59
    s_and_b32 s33, s50, s70
    s_cbranch_scc1 K_BK0
    s_sleep 2
    ds_read_b32 v59, v58
    s_waitcnt lgkmcnt(0)
    v_readfirstlane_b32 s50, v59
    s_and_b32 s33, s50, s70
    s_cbranch_scc1 K_BK0
    s_sleep 2
    ds_read_b32 v59, v58
    s_waitcnt lgkmcnt(0)
    v_readfirstlane_b32 s50, v59
    s_and_b32 s33, s50, s70
    s_cbranch_scc1 K_BK0
    s_sleep 2
    ds_read_b32 v59, v58
    s_waitcnt lgkmcnt(0)
    v_readfirstlane_b32 s50, v59
    s_and_b32 s33, s50, s70
    s_cbranch_scc1 K_BK0
    s_branch K_SPL
K_CHEND:
K_AUX:
    s_cmp_ge_u32 s30, 4
    s_cbranch_scc1 K_AUX_L
    s_and_b32 s3, s2, 7
    s_lshr_b32 s70, s2, 3
    s_lshl3_add_u32 s3, s3, s70
    s_lshl_b32 s3, s3, 5
    s_lshl3_add_u32 s3, s30, s3
    v_bfe_u32 v8, v0, 4, 2
    v_add_u32 v8, s3, v8
    v_and_b32 v10, 15, v0
    v_lshlrev_b32 v10, 4, v10
    v_mul_u32_u24 v9, 1280, v8
    v_add_u32 v9, v9, v10
    v_and_b32 v2, 63, v0
    v_lshlrev_b32 v2, 4, v2
    s_lshl_b32 s71, s30, 12
    s_add_u32 s71, s71, 126016
    s_mov_b32 s70, 5120
    s_mov_b32 m0, s71
    s_waitcnt lgkmcnt(0)
    s_mov_b32 s16, s44
    s_mov_b32 s17, s45
    s_mov_b32 s18, 0x500
    s_mov_b32 s19, 0x20000
    s_mov_b32 s20, s52
    s_mov_b32 s21, s53
    s_mov_b32 s22, 0x500
    s_mov_b32 s23, 0x20000
    buffer_load_dwordx4 v2, s[16:19], 0 offen lds
    buffer_load_dwordx4 v2, s[16:19], 0 offen offset:1024 lds
    s_add_u32 m0, s71, 2048
    v_add_u32 v10, s71, v10
    buffer_load_dwordx4 v2, s[20:23], 0 offen lds
    buffer_load_dwordx4 v2, s[20:23], 0 offen offset:1024 lds
    buffer_load_dwordx4 v[16:19], v9, s[12:15], 0 offen offset:0
    buffer_load_dwordx4 v[20:23], v9, s[12:15], s70 offen offset:0
    buffer_load_dwordx4 v[24:27], v9, s[12:15], 0 offen offset:256
    buffer_load_dwordx4 v[28:31], v9, s[12:15], s70 offen offset:256
    buffer_load_dwordx4 v[32:35], v9, s[12:15], 0 offen offset:512
    buffer_load_dwordx4 v[36:39], v9, s[12:15], s70 offen offset:512
    buffer_load_dwordx4 v[40:43], v9, s[12:15], 0 offen offset:768
    buffer_load_dwordx4 v[44:47], v9, s[12:15], s70 offen offset:768
    buffer_load_dwordx4 v[48:51], v9, s[12:15], 0 offen offset:1024
    buffer_load_dwordx4 v[52:55], v9, s[12:15], s70 offen offset:1024
    s_barrier
    v_and_b32 v1, 63, v0
    v_mov_b32 v7, 0
    s_and_b32 s28, s2, 7
    s_lshr_b32 s29, s2, 3
    s_xor_b32 s30, s30, 4
    s_lshr_b32 s34, s29, 3
    s_lshl_b32 s34, s34, 2
    s_and_b32 s3, s29, 3
    s_add_u32 s34, s34, s3
    s_add_u32 s34, s34, 4
    s_bitcmp1_b32 s29, 2
    s_cselect_b32 s34, -1, s34
    s_cmp_lt_u32 s29, 8
    s_cselect_b32 s34, s29, s34
    s_lshl_b32 s40, s28, 1
    s_cmp_ge_u32 s34, 10
    s_addc_u32 s40, s40, 0
    s_sub_u32 s41, s34, 10
    s_cmp_ge_u32 s34, 10
    s_cselect_b32 s41, s41, s34
    s_mul_i32 s42, s28, 20
    s_add_u32 s42, s42, s34
    s_and_b32 s42, s42, 255
    s_lshl_b32 s42, s42, 9
    s_add_u32 s42, s42, 524288
    s_mul_i32 s43, s28, 7
    s_add_u32 s43, s43, s29
    s_sub_u32 s43, s43, 1
    s_cmp_lt_u32 s43, 54
    s_cselect_b32 s43, s43, 63
    s_cmp_eq_u32 s29, 0
    s_cselect_b32 s43, 63, s43
    s_mov_b32 s24, s8
    s_mov_b32 s25, s9
    s_mov_b32 s26, 0xc8000
    s_mov_b32 s27, 0x20000
    s_add_u32 s64, s6, 0x80000
    s_addc_u32 s65, s7, 0
    s_mov_b32 s66, 0x14400
    s_mov_b32 s67, 0x20000
    s_add_u32 s60, s6, 0x10000
    s_addc_u32 s61, s7, 0
    s_mov_b32 s62, 0x43800
    s_mov_b32 s63, 0x20000
    v_mov_b32 v96, 0
    v_mov_b32 v97, 0
    v_mov_b32 v98, 0
    v_mov_b32 v99, 0
    v_mov_b32 v13, 158720
    s_waitcnt vmcnt(10)
    ds_read_b128 v[56:59], v10 offset:0
    ds_read_b128 v[76:79], v10 offset:2048
    ds_read_b128 v[60:63], v10 offset:256
    ds_read_b128 v[80:83], v10 offset:2304
    ds_read_b128 v[64:67], v10 offset:512
    ds_read_b128 v[84:87], v10 offset:2560
    ds_read_b128 v[68:71], v10 offset:768
    ds_read_b128 v[88:91], v10 offset:2816
    ds_read_b128 v[72:75], v10 offset:1024
    ds_read_b128 v[92:95], v10 offset:3072
    s_waitcnt vmcnt(8) lgkmcnt(8)
    v_dot2c_f32_bf16 v96, v16, v56
    v_dot2c_f32_bf16 v98, v16, v76
    v_dot2c_f32_bf16 v97, v20, v56
    v_dot2c_f32_bf16 v99, v20, v76
    v_dot2c_f32_bf16 v96, v17, v57
    v_dot2c_f32_bf16 v98, v17, v77
    v_dot2c_f32_bf16 v97, v21, v57
    v_dot2c_f32_bf16 v99, v21, v77
    v_dot2c_f32_bf16 v96, v18, v58
    v_dot2c_f32_bf16 v98, v18, v78
    v_dot2c_f32_bf16 v97, v22, v58
    v_dot2c_f32_bf16 v99, v22, v78
    v_dot2c_f32_bf16 v96, v19, v59
    v_dot2c_f32_bf16 v98, v19, v79
    v_dot2c_f32_bf16 v97, v23, v59
    v_dot2c_f32_bf16 v99, v23, v79
    s_waitcnt vmcnt(6) lgkmcnt(6)
    v_dot2c_f32_bf16 v96, v24, v60
    v_dot2c_f32_bf16 v98, v24, v80
    v_dot2c_f32_bf16 v97, v28, v60
    s_branch K_PG6
.p2align 12
K_PG6:
    v_dot2c_f32_bf16 v99, v28, v80
    v_dot2c_f32_bf16 v96, v25, v61
    v_dot2c_f32_bf16 v98, v25, v81
    v_dot2c_f32_bf16 v97, v29, v61
    v_dot2c_f32_bf16 v99, v29, v81
    v_dot2c_f32_bf16 v96, v26, v62
    v_dot2c_f32_bf16 v98, v26, v82
    v_dot2c_f32_bf16 v97, v30, v62
    v_dot2c_f32_bf16 v99, v30, v82
    v_dot2c_f32_bf16 v96, v27, v63
    v_dot2c_f32_bf16 v98, v27, v83
    v_dot2c_f32_bf16 v97, v31, v63
    v_dot2c_f32_bf16 v99, v31, v83
    s_waitcnt vmcnt(4) lgkmcnt(4)
    v_dot2c_f32_bf16 v96, v32, v64
    v_dot2c_f32_bf16 v98, v32, v84
    v_dot2c_f32_bf16 v97, v36, v64
    v_dot2c_f32_bf16 v99, v36, v84
    v_dot2c_f32_bf16 v96, v33, v65
    v_dot2c_f32_bf16 v98, v33, v85
    v_dot2c_f32_bf16 v97, v37, v65
    v_dot2c_f32_bf16 v99, v37, v85
    v_dot2c_f32_bf16 v96, v34, v66
    v_dot2c_f32_bf16 v98, v34, v86
    v_dot2c_f32_bf16 v97, v38, v66
    v_dot2c_f32_bf16 v99, v38, v86
    v_dot2c_f32_bf16 v96, v35, v67
    v_dot2c_f32_bf16 v98, v35, v87
    v_dot2c_f32_bf16 v97, v39, v67
    v_dot2c_f32_bf16 v99, v39, v87
    s_waitcnt vmcnt(2) lgkmcnt(2)
    v_dot2c_f32_bf16 v96, v40, v68
    v_dot2c_f32_bf16 v98, v40, v88
    v_dot2c_f32_bf16 v97, v44, v68
    v_dot2c_f32_bf16 v99, v44, v88
    v_dot2c_f32_bf16 v96, v41, v69
    v_dot2c_f32_bf16 v98, v41, v89
    v_dot2c_f32_bf16 v97, v45, v69
    v_dot2c_f32_bf16 v99, v45, v89
    v_dot2c_f32_bf16 v96, v42, v70
    v_dot2c_f32_bf16 v98, v42, v90
    v_dot2c_f32_bf16 v97, v46, v70
    v_dot2c_f32_bf16 v99, v46, v90
    v_dot2c_f32_bf16 v96, v43, v71
    v_dot2c_f32_bf16 v98, v43, v91
    v_dot2c_f32_bf16 v97, v47, v71
    v_dot2c_f32_bf16 v99, v47, v91
    s_waitcnt vmcnt(0) lgkmcnt(0)
    v_dot2c_f32_bf16 v96, v48, v72
    v_dot2c_f32_bf16 v98, v48, v92
    v_dot2c_f32_bf16 v97, v52, v72
    v_dot2c_f32_bf16 v99, v52, v92
    v_dot2c_f32_bf16 v96, v49, v73
    v_dot2c_f32_bf16 v98, v49, v93
    v_dot2c_f32_bf16 v97, v53, v73
    v_dot2c_f32_bf16 v99, v53, v93
    v_dot2c_f32_bf16 v96, v50, v74
    v_dot2c_f32_bf16 v98, v50, v94
    v_dot2c_f32_bf16 v97, v54, v74
    v_dot2c_f32_bf16 v99, v54, v94
    v_dot2c_f32_bf16 v96, v51, v75
    v_dot2c_f32_bf16 v98, v51, v95
    v_dot2c_f32_bf16 v97, v55, v75
    v_dot2c_f32_bf16 v99, v55, v95
    s_nop 2
    v_add_f32_dpp v96, v96, v96 quad_perm:[1,0,3,2] row_mask:0xf bank_mask:0xf
    v_add_f32_dpp v97, v97, v97 quad_perm:[1,0,3,2] row_mask:0xf bank_mask:0xf
    v_add_f32_dpp v98, v98, v98 quad_perm:[1,0,3,2] row_mask:0xf bank_mask:0xf
    v_add_f32_dpp v99, v99, v99 quad_perm:[1,0,3,2] row_mask:0xf bank_mask:0xf
    v_add_f32_dpp v96, v96, v96 quad_perm:[2,3,0,1] row_mask:0xf bank_mask:0xf
    v_add_f32_dpp v97, v97, v97 quad_perm:[2,3,0,1] row_mask:0xf bank_mask:0xf
    v_add_f32_dpp v98, v98, v98 quad_perm:[2,3,0,1] row_mask:0xf bank_mask:0xf
    v_add_f32_dpp v99, v99, v99 quad_perm:[2,3,0,1] row_mask:0xf bank_mask:0xf
    v_add_f32_dpp v96, v96, v96 row_half_mirror row_mask:0xf bank_mask:0xf
    v_add_f32_dpp v97, v97, v97 row_half_mirror row_mask:0xf bank_mask:0xf
    v_add_f32_dpp v98, v98, v98 row_half_mirror row_mask:0xf bank_mask:0xf
    v_add_f32_dpp v99, v99, v99 row_half_mirror row_mask:0xf bank_mask:0xf
    v_add_f32_dpp v96, v96, v96 row_mirror row_mask:0xf bank_mask:0xf
    v_add_f32_dpp v97, v97, v97 row_mirror row_mask:0xf bank_mask:0xf
    v_add_f32_dpp v98, v98, v98 row_mirror row_mask:0xf bank_mask:0xf
    v_add_f32_dpp v99, v99, v99 row_mirror row_mask:0xf bank_mask:0xf
    v_and_b32 v4, 31, v8
    v_lshlrev_b32 v11, 2, v4
    v_add_u32 v11, 122880, v11
    v_lshlrev_b32 v12, 1, v4
    v_add_u32 v12, 123008, v12
    v_cvt_pk_bf16_f32 v2, v96, v96
    v_lshlrev_b32 v2, 16, v2
    v_ashrrev_i32 v3, 31, v2
    v_or_b32 v3, 0x80000000, v3
    v_xor_b32 v2, v2, v3
    v_and_b32 v2, 0xffff0000, v2
    v_sub_u32 v3, 0x87ff, v8
    v_or_b32 v96, v2, v3
    ds_write_b32 v11, v96 offset:0
    v_cvt_pk_bf16_f32 v98, v98, v98
    v_lshlrev_b32 v98, 16, v98
    v_mul_f32 v5, 0xbfb8aa3b, v98
    v_exp_f32 v5, v5
    s_nop 0
    v_add_f32 v5, 1.0, v5
    v_rcp_f32 v98, v5
    s_nop 0
    v_cvt_pk_bf16_f32 v98, v98, v98
    v_or_b32 v98, 0x8000, v98
    ds_write_b16 v12, v98 offset:0
    v_cvt_pk_bf16_f32 v2, v97, v97
    v_lshlrev_b32 v2, 16, v2
    v_ashrrev_i32 v3, 31, v2
    v_or_b32 v3, 0x80000000, v3
    v_xor_b32 v2, v2, v3
    v_and_b32 v2, 0xffff0000, v2
    v_sub_u32 v3, 0x87fb, v8
    v_or_b32 v97, v2, v3
    ds_write_b32 v11, v97 offset:16
    v_cvt_pk_bf16_f32 v99, v99, v99
    v_lshlrev_b32 v99, 16, v99
    v_mul_f32 v5, 0xbfb8aa3b, v99
    v_exp_f32 v5, v5
    s_nop 0
    v_add_f32 v5, 1.0, v5
    v_rcp_f32 v99, v5
    s_nop 0
    v_cvt_pk_bf16_f32 v99, v99, v99
    v_or_b32 v99, 0x8000, v99
    ds_write_b16 v12, v99 offset:8
    v_mov_b32 v3, 1
    s_mov_b64 exec, 1
    ds_add_u32 v13, v3 offset:48
    s_mov_b64 exec, -1
    s_cmp_ge_u32 s30, 6
    s_cbranch_scc1 K_AUX_G1
    s_mov_b32 s3, 1048576
K_FGR:
    ds_read_b32 v2, v13 offset:48
    s_sleep 1
    s_sub_u32 s3, s3, 1
    s_waitcnt lgkmcnt(0)
    v_readfirstlane_b32 s33, v2
    s_nop 3
    s_cselect_b32 s33, 4, s33
    s_cmp_lt_u32 s33, 4
    s_cbranch_scc1 K_FGR
    s_cmp_lg_u32 s30, 4
    s_cbranch_scc1 K_AUX_G0
    v_and_b32 v3, 31, v1
    v_lshlrev_b32 v3, 2, v3
    v_add_u32 v3, 122880, v3
    ds_read_b32 v2, v3
    s_waitcnt lgkmcnt(0)
    s_nop 1
    v_max_u32_dpp v3, v2, v2 quad_perm:[1,0,3,2] row_mask:0xf bank_mask:0xf
    s_nop 1
    v_max_u32_dpp v3, v3, v3 quad_perm:[2,3,0,1] row_mask:0xf bank_mask:0xf
    s_nop 1
    v_max_u32_dpp v3, v3, v3 row_half_mirror row_mask:0xf bank_mask:0xf
    s_nop 1
    v_max_u32_dpp v3, v3, v3 row_mirror row_mask:0xf bank_mask:0xf
    s_nop 1
    v_readlane_b32 s68, v3, 0
    v_readlane_b32 s76, v3, 16
    v_readlane_b32 s77, v3, 32
    v_readlane_b32 s78, v3, 48
    s_nop 3
    s_max_u32 s68, s68, s76
    s_max_u32 s77, s77, s78
    s_max_u32 s68, s68, s77
    v_cmp_ne_u32 vcc, s68, v2
    s_nop 1
    v_cndmask_b32 v2, 0, v2, vcc
    s_nop 1
    v_max_u32_dpp v3, v2, v2 quad_perm:[1,0,3,2] row_mask:0xf bank_mask:0xf
    s_nop 1
    v_max_u32_dpp v3, v3, v3 quad_perm:[2,3,0,1] row_mask:0xf bank_mask:0xf
    s_nop 1
    v_max_u32_dpp v3, v3, v3 row_half_mirror row_mask:0xf bank_mask:0xf
    s_nop 1
    v_max_u32_dpp v3, v3, v3 row_mirror row_mask:0xf bank_mask:0xf
    s_nop 1
    v_readlane_b32 s69, v3, 0
    v_readlane_b32 s76, v3, 16
    v_readlane_b32 s77, v3, 32
    v_readlane_b32 s78, v3, 48
    s_nop 3
    s_max_u32 s69, s69, s76
    s_max_u32 s77, s77, s78
    s_max_u32 s69, s69, s77
    s_load_dword s33, s[4:5], 0
    s_waitcnt lgkmcnt(0)
    s_cmp_ge_u32 s33, 1
    s_cbranch_scc1 K_ZO3
    s_sleep 8
    s_load_dword s33, s[4:5], 64
    s_waitcnt lgkmcnt(0)
    s_cmp_ge_u32 s33, 1
    s_cbranch_scc1 K_ZO3
    s_sleep 8
    s_mov_b32 s3, 16384
K_ZB3:
    v_mov_b32 v4, 0
    global_load_dword v4, v4, s[4:5] sc1
    s_waitcnt vmcnt(0)
    v_readfirstlane_b32 s33, v4
    s_cmp_ge_u32 s33, 1
    s_cbranch_scc1 K_ZO3
    s_sleep 8
    s_sub_u32 s3, s3, 1
    s_cbranch_scc0 K_ZB3
K_ZO3:
    s_lshl_b32 s3, s2, 3
    s_add_u32 s3, s3, 606208
    s_atomic_add_x2 s[68:69], s[6:7], s3
    s_cmp_lg_u32 s2, 63
    s_cbranch_scc1 K_AUX_G1
    s_mov_b32 s70, 81920
    v_lshlrev_b32 v3, 3, v1
    s_mov_b32 s3, 131072
K_AUX_POLL:
    buffer_load_dwordx2 v[176:177], v3, s[64:67], s70 offen sc1
    s_waitcnt vmcnt(0)
    v_min_u32 v2, v176, v177
    v_cmp_eq_u32 vcc, 0, v2
    s_cbranch_vccz K_AUX_GOT
    s_sleep 2
    s_sub_u32 s3, s3, 1
    s_cmp_lg_u32 s3, 0
    s_cbranch_scc1 K_AUX_POLL
K_AUX_GOT:
    s_waitcnt lgkmcnt(0)
    s_nop 1
    v_max_u32_dpp v3, v176, v176 quad_perm:[1,0,3,2] row_mask:0xf bank_mask:0xf
    s_nop 1
    v_max_u32_dpp v3, v3, v3 quad_perm:[2,3,0,1] row_mask:0xf bank_mask:0xf
    s_nop 1
    v_max_u32_dpp v3, v3, v3 row_half_mirror row_mask:0xf bank_mask:0xf
    s_nop 1
    v_max_u32_dpp v3, v3, v3 row_mirror row_mask:0xf bank_mask:0xf
    s_nop 1
    v_readlane_b32 s68, v3, 0
    v_readlane_b32 s76, v3, 16
    v_readlane_b32 s77, v3, 32
    v_readlane_b32 s78, v3, 48
    s_nop 3
    s_max_u32 s68, s68, s76
    s_max_u32 s77, s77, s78
    s_max_u32 s68, s68, s77
    v_cmp_ne_u32 vcc, s68, v176
    s_nop 1
    v_cndmask_b32 v2, v177, v176, vcc
    s_nop 1
    v_max_u32_dpp v3, v2, v2 quad_perm:[1,0,3,2] row_mask:0xf bank_mask:0xf
    s_nop 1
    v_max_u32_dpp v3, v3, v3 quad_perm:[2,3,0,1] row_mask:0xf bank_mask:0xf
    s_nop 1
    v_max_u32_dpp v3, v3, v3 row_half_mirror row_mask:0xf bank_mask:0xf
    s_nop 1
    v_max_u32_dpp v3, v3, v3 row_mirror row_mask:0xf bank_mask:0xf
    s_nop 1
    v_readlane_b32 s69, v3, 0
    v_readlane_b32 s76, v3, 16
    v_readlane_b32 s77, v3, 32
    v_readlane_b32 s78, v3, 48
    s_nop 3
    s_max_u32 s69, s69, s76
    s_max_u32 s77, s77, s78
    s_max_u32 s69, s69, s77
    v_mov_b32 v176, s68
    v_mov_b32 v177, s69
    s_mov_b32 s3, 1048576
K_FGZ:
    ds_read_b32 v2, v13 offset:36
    s_sleep 1
    s_sub_u32 s3, s3, 1
    s_waitcnt lgkmcnt(0)
    v_readfirstlane_b32 s33, v2
    s_nop 3
    s_cselect_b32 s33, 1, s33
    s_cmp_lt_u32 s33, 1
    s_cbranch_scc1 K_FGZ
    v_lshlrev_b32 v3, 9, v1
    s_mov_b32 s66, 81920
    s_mov_b32 s70, 0
    buffer_store_dwordx2 v[176:177], v3, s[64:67], s70 offen offset:128 sc1
    s_mov_b32 s70, 32768
    buffer_store_dwordx2 v[176:177], v3, s[64:67], s70 offen offset:128 sc1
    s_mov_b32 s70, 65536
    buffer_store_dwordx2 v[176:177], v3, s[64:67], s70 offen offset:128 sc1
    v_mov_b32 v3, 16
    ds_write_b32 v13, v3 offset:48
    s_branch K_AUX_G1
K_AUX_G0:
    v_and_b32 v3, 3, v1
    v_lshlrev_b32 v3, 4, v3
    v_add_u32 v2, 123008, v3
    ds_read_b128 v[176:179], v2
    v_lshrrev_b32 v2, 2, v1
    v_lshl_add_u32 v3, v2, 9, v3
    s_sleep 12
    s_load_dword s33, s[4:5], 128
    s_waitcnt lgkmcnt(0)
    s_cmp_ge_u32 s33, 8
    s_cbranch_scc1 K_ZO4
    s_sleep 8
    s_mov_b32 s3, 16384
K_ZB4:
    v_mov_b32 v4, 128
    global_load_dword v4, v4, s[4:5] sc1
    s_waitcnt vmcnt(0)
    v_readfirstlane_b32 s33, v4
    s_cmp_ge_u32 s33, 8
    s_cbranch_scc1 K_ZO4
    s_sleep 8
    s_sub_u32 s3, s3, 1
    s_cbranch_scc0 K_ZB4
K_ZO4:
    v_mov_b32 v2, 1
    ds_write_b32 v13, v2 offset:36
    s_lshr_b32 s3, s29, 2
    s_lshl1_add_u32 s3, s28, s3
    s_mul_i32 s3, s3, 5120
    s_and_b32 s70, s29, 3
    s_lshl_b32 s70, s70, 6
    s_add_u32 s3, s3, s70
    s_mov_b32 exec_hi, 0xff
    s_waitcnt lgkmcnt(0)
    buffer_store_dwordx4 v[176:179], v3, s[64:67], s3 offen offset:256 sc1
    s_mov_b64 exec, -1
K_AUX_G1:
    s_cmp_lg_u32 s43, 63
    s_cbranch_scc1 K_FFN_C
    s_cmp_lg_u32 s29, 0
    s_cbranch_scc1 K_AUX_NT
    s_lshl2_add_u32 s3, s28, s30
    s_sub_u32 s3, s3, 4
    s_mul_i32 s3, s3, 25600
    v_lshlrev_b32 v2, 7, v1
    buffer_load_dword v5, v2, s[24:27], s3 offen
    s_add_u32 s3, s3, 8192
    buffer_load_dword v5, v2, s[24:27], s3 offen
    s_add_u32 s3, s3, 8192
    buffer_load_dword v5, v2, s[24:27], s3 offen
    s_add_u32 s3, s3, 8192
    s_mov_b64 exec, 0xff
    buffer_load_dword v5, v2, s[24:27], s3 offen
    s_add_u32 s3, s3, 8192
    s_mov_b64 exec, -1
K_AUX_NT:
    s_mov_b32 s3, 1048576
K_FGZ2:
    ds_read_b32 v2, v13 offset:36
    s_sleep 1
    s_sub_u32 s3, s3, 1
    s_waitcnt lgkmcnt(0)
    v_readfirstlane_b32 s33, v2
    s_nop 3
    s_cselect_b32 s33, 1, s33
    s_cmp_lt_u32 s33, 1
    s_cbranch_scc1 K_FGZ2
    s_waitcnt vmcnt(0)
    s_branch K_P2
K_AUX_L:
    v_and_b32 v1, 63, v0
    v_mov_b32 v7, 0
    s_and_b32 s28, s2, 7
    s_lshr_b32 s29, s2, 3
    s_xor_b32 s30, s30, 4
    s_lshr_b32 s34, s29, 3
    s_lshl_b32 s34, s34, 2
    s_and_b32 s3, s29, 3
    s_add_u32 s34, s34, s3
    s_add_u32 s34, s34, 4
    s_bitcmp1_b32 s29, 2
    s_cselect_b32 s34, -1, s34
    s_cmp_lt_u32 s29, 8
    s_cselect_b32 s34, s29, s34
    s_lshl_b32 s40, s28, 1
    s_cmp_ge_u32 s34, 10
    s_addc_u32 s40, s40, 0
    s_sub_u32 s41, s34, 10
    s_cmp_ge_u32 s34, 10
    s_cselect_b32 s41, s41, s34
    s_mul_i32 s42, s28, 20
    s_add_u32 s42, s42, s34
    s_and_b32 s42, s42, 255
    s_lshl_b32 s42, s42, 9
    s_add_u32 s42, s42, 524288
    s_mul_i32 s43, s28, 7
    s_add_u32 s43, s43, s29
    s_sub_u32 s43, s43, 1
    s_cmp_lt_u32 s43, 54
    s_cselect_b32 s43, s43, 63
    s_cmp_eq_u32 s29, 0
    s_cselect_b32 s43, 63, s43
    v_mov_b32 v3, 158736
    ds_write2_b32 v3, v7, v7 offset0:0 offset1:1
    ds_write2_b32 v3, v7, v7 offset0:2 offset1:3
    ds_write2_b32 v3, v7, v7 offset0:4 offset1:5
    ds_write2_b32 v3, v7, v7 offset0:6 offset1:7
    ds_write2_b32 v3, v7, v7 offset0:8 offset1:9
    ds_write2_b32 v3, v7, v7 offset0:10 offset1:11
    v_lshrrev_b32 v3, 2, v1
    v_mul_u32_u24 v11, 3456, v3
    v_lshrrev_b32 v3, 4, v1
    v_and_b32 v3, 2, v3
    v_xor_b32 v3, v3, v1
    v_and_b32 v3, 3, v3
    v_lshl_add_u32 v11, v3, 4, v11
    s_mul_i32 s3, s30, 552960
    s_lshl_b32 s70, s43, 6
    s_add_u32 s3, s3, s70
    v_add_u32 v11, s3, v11
    s_mul_i32 s68, s30, 10240
    s_add_u32 s72, s68, 40960
    s_bitcmp1_b32 s43, 0
    s_cselect_b32 s71, s72, s68
    s_cselect_b32 s72, s68, s72
    v_lshlrev_b32 v8, 4, v1
    s_waitcnt lgkmcnt(0)
    s_barrier
    s_mov_b32 s24, s8
    s_mov_b32 s25, s9
    s_mov_b32 s26, 0xc8000
    s_mov_b32 s27, 0x20000
    s_cmp_lg_u32 s43, 63
    s_cbranch_scc1 K_AUX_FFN1
    s_cmp_lg_u32 s30, 0
    s_cbranch_scc1 K_AUX_NR
    s_cmp_eq_u32 s2, 55
    s_cbranch_scc1 K_AUX_NR
    s_cmp_eq_u32 s2, 63
    s_cselect_b32 s70, 0, 128
    s_mov_b32 s3, 1
    s_waitcnt vmcnt(0)
    s_atomic_add s3, s[4:5], s70
    s_atomic_add s3, s[4:5], s70 offset:64
    s_waitcnt lgkmcnt(0)
K_AUX_NR:
    v_mov_b32 v13, 158720
    s_mov_b32 s3, 1048576
K_FGZ3:
    ds_read_b32 v2, v13 offset:36
    s_sleep 1
    s_sub_u32 s3, s3, 1
    s_waitcnt lgkmcnt(0)
    v_readfirstlane_b32 s33, v2
    s_nop 3
    s_cselect_b32 s33, 1, s33
    s_cmp_lt_u32 s33, 1
    s_cbranch_scc1 K_FGZ3
    s_cmp_lg_u32 s2, 63
    s_cbranch_scc1 K_AUX_NH
    s_mov_b32 s3, 1048576
K_FGH:
    ds_read_b32 v2, v13 offset:48
    s_sleep 1
    s_sub_u32 s3, s3, 1
    s_waitcnt lgkmcnt(0)
    v_readfirstlane_b32 s33, v2
    s_nop 3
    s_cselect_b32 s33, 16, s33
    s_cmp_lt_u32 s33, 16
    s_cbranch_scc1 K_FGH
K_AUX_NH:
    s_branch K_P2
K_AUX_FFN1:
    s_bitcmp1_b32 s43, 0
    s_cselect_b64 s[56:57], s[48:49], s[46:47]
    s_cselect_b64 s[60:61], s[46:47], s[48:49]
    s_mov_b32 s58, 2211840
    s_mov_b32 s59, 0x20000
    s_mov_b32 s62, 2211840
    s_mov_b32 s63, 0x20000
    s_add_u32 m0, s71, 0
    s_mov_b32 s70, 0
    buffer_load_dwordx4 v11, s[56:59], s70 offen  lds
    s_add_u32 m0, s71, 1024
    s_mov_b32 s70, 55296
    buffer_load_dwordx4 v11, s[56:59], s70 offen  lds
    s_add_u32 m0, s71, 2048
    s_mov_b32 s70, 110592
    buffer_load_dwordx4 v11, s[56:59], s70 offen  lds
    s_add_u32 m0, s71, 3072
    s_mov_b32 s70, 165888
    buffer_load_dwordx4 v11, s[56:59], s70 offen  lds
    s_add_u32 m0, s71, 4096
    s_mov_b32 s70, 221184
    buffer_load_dwordx4 v11, s[56:59], s70 offen  lds
    s_add_u32 m0, s71, 5120
    s_mov_b32 s70, 276480
    buffer_load_dwordx4 v11, s[56:59], s70 offen  lds
    s_add_u32 m0, s71, 6144
    s_mov_b32 s70, 331776
    buffer_load_dwordx4 v11, s[56:59], s70 offen  lds
    s_add_u32 m0, s71, 7168
    s_mov_b32 s70, 387072
    buffer_load_dwordx4 v11, s[56:59], s70 offen  lds
    s_add_u32 m0, s71, 8192
    s_mov_b32 s70, 442368
    buffer_load_dwordx4 v11, s[56:59], s70 offen  lds
    s_add_u32 m0, s71, 9216
    s_mov_b32 s70, 497664
    buffer_load_dwordx4 v11, s[56:59], s70 offen  lds
    s_add_u32 m0, s72, 0
    s_mov_b32 s70, 0
    buffer_load_dwordx4 v11, s[60:63], s70 offen  lds
    s_add_u32 m0, s72, 1024
    s_mov_b32 s70, 55296
    buffer_load_dwordx4 v11, s[60:63], s70 offen  lds
    s_add_u32 m0, s72, 2048
    s_mov_b32 s70, 110592
    buffer_load_dwordx4 v11, s[60:63], s70 offen  lds
    s_add_u32 m0, s72, 3072
    s_mov_b32 s70, 165888
    buffer_load_dwordx4 v11, s[60:63], s70 offen  lds
    s_add_u32 m0, s72, 4096
    s_mov_b32 s70, 221184
    buffer_load_dwordx4 v11, s[60:63], s70 offen  lds
    s_add_u32 m0, s72, 5120
    s_mov_b32 s70, 276480
    buffer_load_dwordx4 v11, s[60:63], s70 offen  lds
    s_add_u32 m0, s72, 6144
    s_mov_b32 s70, 331776
    buffer_load_dwordx4 v11, s[60:63], s70 offen  lds
    s_add_u32 m0, s72, 7168
    s_mov_b32 s70, 387072
    buffer_load_dwordx4 v11, s[60:63], s70 offen  lds
    s_add_u32 m0, s72, 8192
    s_mov_b32 s70, 442368
    buffer_load_dwordx4 v11, s[60:63], s70 offen  lds
    s_add_u32 m0, s72, 9216
    s_mov_b32 s70, 497664
    buffer_load_dwordx4 v11, s[60:63], s70 offen  lds
    s_mov_b32 s64, s50
    s_mov_b32 s65, s51
    s_mov_b32 s66, 0x21c000
    s_mov_b32 s67, 0x20000
    s_mul_i32 s3, s43, 40960
    s_add_u32 s3, s3, s68
    v_lshrrev_b32 v2, 3, v1
    v_and_b32 v3, 2, v2
    s_lshl_b32 s70, s30, 2
    v_xor_b32 v3, s70, v3
    v_xor_b32 v3, v3, v1
    v_and_b32 v3, 7, v3
    v_mul_u32_u24 v2, 1280, v2
    v_lshl_add_u32 v2, v3, 4, v2
    v_add_u32 v12, s3, v2
    s_add_u32 m0, s68, 81920
    s_mov_b32 s70, 0
    buffer_load_dwordx4 v12, s[64:67], s70 offen  lds
    s_add_u32 m0, s68, 82944
    s_mov_b32 s70, 128
    buffer_load_dwordx4 v12, s[64:67], s70 offen  lds
    s_add_u32 m0, s68, 83968
    s_mov_b32 s70, 256
    buffer_load_dwordx4 v12, s[64:67], s70 offen  lds
    s_add_u32 m0, s68, 84992
    s_mov_b32 s70, 384
    buffer_load_dwordx4 v12, s[64:67], s70 offen  lds
    s_add_u32 m0, s68, 86016
    s_mov_b32 s70, 512
    buffer_load_dwordx4 v12, s[64:67], s70 offen  lds
    s_add_u32 m0, s68, 87040
    s_mov_b32 s70, 640
    buffer_load_dwordx4 v12, s[64:67], s70 offen  lds
    s_add_u32 m0, s68, 88064
    s_mov_b32 s70, 768
    buffer_load_dwordx4 v12, s[64:67], s70 offen  lds
    s_add_u32 m0, s68, 89088
    s_mov_b32 s70, 896
    buffer_load_dwordx4 v12, s[64:67], s70 offen  lds
    s_add_u32 m0, s68, 90112
    s_mov_b32 s70, 1024
    buffer_load_dwordx4 v12, s[64:67], s70 offen  lds
    s_add_u32 m0, s68, 91136
    s_mov_b32 s70, 1152
    buffer_load_dwordx4 v12, s[64:67], s70 offen  lds
    s_waitcnt vmcnt(10)
    s_barrier
    s_branch K_P2_EARLY
K_FFN_C:
    v_lshrrev_b32 v180, 4, v1
    v_bfe_u32 v2, v1, 2, 2
    v_lshl_add_u32 v2, v180, 3, v2
    v_and_b32 v3, 3, v1
    v_lshlrev_b32 v3, 3, v3
    v_lshl_add_u32 v181, v2, 6, v3
    s_bfe_u32 s3, s30, 0x10001
    s_mul_i32 s3, s3, 40960
    v_xor_b32 v4, s30, v180
    v_and_b32 v4, 1, v4
    v_lshl_add_u32 v181, v4, 5, v181
    v_add_u32 v181, s3, v181
    v_bfe_u32 v4, v1, 3, 2
    v_xor_b32 v4, s30, v4
    v_and_b32 v4, 3, v4
    v_lshl_add_u32 v3, v4, 5, v3
    v_and_b32 v2, 3, v2
    v_lshl_add_u32 v3, v2, 7, v3
    v_mul_u32_u24 v182, 10240, v180
    s_mov_b32 s3, 81920
    v_add3_u32 v182, v182, v3, s3
    v_mov_b32 v183, 123904
    s_cmp_lg_u32 s30, 5
    s_cbranch_scc1 K_KW
    s_mov_b32 s3, 131072
K_KPOLL:
    s_load_dwordx2 s[68:69], s[6:7], s42 offset:128 glc
    s_waitcnt lgkmcnt(0)
    s_min_u32 s33, s68, s69
    s_cmp_lg_u32 s33, 0
    s_cbranch_scc1 K_KGOT
    s_sleep 2
    s_sub_u32 s3, s3, 1
    s_cbranch_scc0 K_KPOLL
K_KGOT:
    v_mov_b32 v176, s68
    v_mov_b32 v177, s69
    ds_write_b64 v183, v[176:177]
    v_lshlrev_b32 v2, 4, v1
    s_and_b32 s70, s68, 0x7ff
    s_sub_u32 s70, 2047, s70
    s_mul_i32 s70, s70, 1280
    s_mov_b32 m0, 134208
    s_mov_b64 exec, -1
    buffer_load_dwordx4 v2, s[12:15], s70 offen lds
    s_mov_b64 exec, 0xffff
    buffer_load_dwordx4 v2, s[12:15], s70 offen offset:1024 lds
    s_and_b32 s70, s69, 0x7ff
    s_sub_u32 s70, 2047, s70
    s_mul_i32 s70, s70, 1280
    s_mov_b32 m0, 135552
    s_mov_b64 exec, -1
    buffer_load_dwordx4 v2, s[12:15], s70 offen lds
    s_mov_b64 exec, 0xffff
    buffer_load_dwordx4 v2, s[12:15], s70 offen offset:1024 lds
    s_mov_b64 exec, -1
    v_mov_b32 v3, 16
    s_waitcnt vmcnt(0)
    ds_write_b32 v13, v3 offset:48
    s_branch K_KW2
K_KW:
    s_cmp_lt_u32 s30, 6
    s_cbranch_scc1 K_KW2
    s_cmp_eq_u32 s30, 6
    s_cbranch_scc1 K_CHF0
    s_branch K_CHF1
K_WRET_F:
K_KW2:
    s_branch K_J7de8
K_CHF0:
K_STF16:
    s_branch K_STF18
    s_nop 0
K_J7de8:
    v_and_b32 v2, 1, v1
    v_mul_u32_u24 v9, 1344, v2
    v_lshl_add_u32 v9, v180, 4, v9
    v_add_u32 v9, 134208, v9
    v_and_b32 v2, 1, v1
    v_lshlrev_b32 v192, 6, v2
    v_lshl_add_u32 v192, v180, 4, v192
    s_and_b32 s3, s30, 3
    s_lshl_b32 s3, s3, 7
    v_add3_u32 v193, v192, s3, v183
    v_add_u32 v192, 64, v193
    v_add_u32 v193, 1088, v193
    v_lshrrev_b32 v2, 5, v1
    v_bfe_u32 v3, v1, 4, 1
    v_lshl_add_u32 v3, v3, 1, v2
    v_lshlrev_b32 v3, 6, v3
    v_and_b32 v4, 15, v1
    v_lshl_add_u32 v3, v4, 2, v3
    v_add_u32 v194, 123968, v3
    v_lshlrev_b32 v4, 1, v1
    s_add_u32 s3, s3, 124992
    v_add_u32 v195, s3, v4
    v_and_b32 v2, 1, v1
    v_mul_u32_u24 v2, 2560, v2
    v_lshl_add_u32 v196, v180, 4, v2
    s_lshl_b32 s70, s30, 6
    s_add_u32 s70, s70, 125760
    v_add_u32 v196, s70, v196
    v_mov_b32 v3, 1
    s_mov_b32 s3, 1048576
K_FGK:
    ds_read_b32 v2, v13 offset:48
    s_sleep 1
    s_sub_u32 s3, s3, 1
    s_waitcnt lgkmcnt(0)
    v_readfirstlane_b32 s33, v2
    s_nop 3
    s_cselect_b32 s33, 16, s33
    s_cmp_lt_u32 s33, 16
    s_cbranch_scc1 K_FGK
    ds_read_b128 v[96:99], v9 offset:0
    ds_read_b128 v[100:103], v9 offset:64
    ds_read_b128 v[104:107], v9 offset:128
    ds_read_b128 v[108:111], v9 offset:192
    ds_read_b128 v[112:115], v9 offset:256
    ds_read_b128 v[116:119], v9 offset:320
    ds_read_b128 v[120:123], v9 offset:384
    ds_read_b128 v[124:127], v9 offset:448
    ds_read_b128 v[128:131], v9 offset:512
    ds_read_b128 v[132:135], v9 offset:576
    ds_read_b128 v[136:139], v9 offset:640
    ds_read_b128 v[140:143], v9 offset:704
    ds_read_b128 v[144:147], v9 offset:768
    ds_read_b128 v[148:151], v9 offset:832
    ds_read_b128 v[152:155], v9 offset:896
    ds_read_b128 v[156:159], v9 offset:960
    ds_read_b128 v[160:163], v9 offset:1024
    ds_read_b128 v[164:167], v9 offset:1088
    ds_read_b128 v[168:171], v9 offset:1152
    ds_read_b128 v[172:175], v9 offset:1216
    s_setprio 3
    s_barrier
    ds_read_b64_tr_b16 v[16:17], v181 offset:0
    ds_read_b64_tr_b16 v[18:19], v181 offset:256
    ds_read_b64_tr_b16 v[20:21], v181 offset:2048
    ds_read_b64_tr_b16 v[22:23], v181 offset:2304
    ds_read_b64_tr_b16 v[24:25], v181 offset:4096
    ds_read_b64_tr_b16 v[26:27], v181 offset:4352
    ds_read_b64_tr_b16 v[28:29], v181 offset:6144
    ds_read_b64_tr_b16 v[30:31], v181 offset:6400
    ds_read_b64_tr_b16 v[32:33], v181 offset:8192
    ds_read_b64_tr_b16 v[34:35], v181 offset:8448
    ds_read_b64_tr_b16 v[36:37], v181 offset:10240
    ds_read_b64_tr_b16 v[38:39], v181 offset:10496
    ds_read_b64_tr_b16 v[40:41], v181 offset:12288
    ds_read_b64_tr_b16 v[42:43], v181 offset:12544
    ds_read_b64_tr_b16 v[44:45], v181 offset:14336
    ds_read_b64_tr_b16 v[46:47], v181 offset:14592
    s_branch K_PG7
.p2align 12
K_CHF1:
K_STF17:
    s_branch K_WRET_F
    s_nop 0
K_PG7:
    ds_read_b64_tr_b16 v[48:49], v181 offset:16384
    ds_read_b64_tr_b16 v[50:51], v181 offset:16640
    ds_read_b64_tr_b16 v[52:53], v181 offset:18432
    ds_read_b64_tr_b16 v[54:55], v181 offset:18688
    ds_read_b64_tr_b16 v[56:57], v181 offset:20480
    ds_read_b64_tr_b16 v[58:59], v181 offset:20736
    ds_read_b64_tr_b16 v[60:61], v181 offset:22528
    ds_read_b64_tr_b16 v[62:63], v181 offset:22784
    ds_read_b64_tr_b16 v[64:65], v181 offset:24576
    ds_read_b64_tr_b16 v[66:67], v181 offset:24832
    ds_read_b64_tr_b16 v[68:69], v181 offset:26624
    ds_read_b64_tr_b16 v[70:71], v181 offset:26880
    ds_read_b64_tr_b16 v[72:73], v181 offset:28672
    ds_read_b64_tr_b16 v[74:75], v181 offset:28928
    ds_read_b64_tr_b16 v[76:77], v181 offset:30720
    ds_read_b64_tr_b16 v[78:79], v181 offset:30976
    ds_read_b64_tr_b16 v[80:81], v181 offset:32768
    ds_read_b64_tr_b16 v[82:83], v181 offset:33024
    ds_read_b64_tr_b16 v[84:85], v181 offset:34816
    ds_read_b64_tr_b16 v[86:87], v181 offset:35072
    ds_read_b64_tr_b16 v[88:89], v181 offset:36864
    ds_read_b64_tr_b16 v[90:91], v181 offset:37120
    ds_read_b64_tr_b16 v[92:93], v181 offset:38912
    ds_read_b64_tr_b16 v[94:95], v181 offset:39168
    s_waitcnt lgkmcnt(0)
    s_barrier
    v_mfma_f32_16x16x32_bf16 v[184:187], v[16:19], v[96:99], 0
    v_mfma_f32_16x16x32_bf16 v[188:191], v[20:23], v[100:103], 0
    v_mfma_f32_16x16x32_bf16 v[184:187], v[24:27], v[104:107], v[184:187]
    v_mfma_f32_16x16x32_bf16 v[188:191], v[28:31], v[108:111], v[188:191]
    v_mfma_f32_16x16x32_bf16 v[184:187], v[32:35], v[112:115], v[184:187]
    v_mfma_f32_16x16x32_bf16 v[188:191], v[36:39], v[116:119], v[188:191]
    v_mfma_f32_16x16x32_bf16 v[184:187], v[40:43], v[120:123], v[184:187]
    v_mfma_f32_16x16x32_bf16 v[188:191], v[44:47], v[124:127], v[188:191]
    v_mfma_f32_16x16x32_bf16 v[184:187], v[48:51], v[128:131], v[184:187]
    v_mfma_f32_16x16x32_bf16 v[188:191], v[52:55], v[132:135], v[188:191]
    v_mfma_f32_16x16x32_bf16 v[184:187], v[56:59], v[136:139], v[184:187]
    v_mfma_f32_16x16x32_bf16 v[188:191], v[60:63], v[140:143], v[188:191]
    v_mfma_f32_16x16x32_bf16 v[184:187], v[64:67], v[144:147], v[184:187]
    v_mfma_f32_16x16x32_bf16 v[188:191], v[68:71], v[148:151], v[188:191]
    v_mfma_f32_16x16x32_bf16 v[184:187], v[72:75], v[152:155], v[184:187]
    v_mfma_f32_16x16x32_bf16 v[188:191], v[76:79], v[156:159], v[188:191]
    v_mfma_f32_16x16x32_bf16 v[184:187], v[80:83], v[160:163], v[184:187]
    v_mfma_f32_16x16x32_bf16 v[188:191], v[84:87], v[164:167], v[188:191]
    v_mfma_f32_16x16x32_bf16 v[184:187], v[88:91], v[168:171], v[184:187]
    v_mfma_f32_16x16x32_bf16 v[188:191], v[92:95], v[172:175], v[188:191]
    s_nop 7
    v_add_f32 v184, v184, v188
    v_add_f32 v185, v185, v189
    v_add_f32 v186, v186, v190
    v_add_f32 v187, v187, v191
    s_mov_b32 exec_lo, 0x00030003
    s_mov_b32 exec_hi, 0x00030003
    ds_write_b128 v192, v[184:187]
    s_mov_b64 exec, 1
    ds_add_u32 v13, v3 offset:52
    s_mov_b64 exec, -1
    s_cmp_lg_u32 s30, 6
    s_cbranch_scc1 K_NOS6B
    v_lshl_add_u32 v4, v1, 2, s42
    global_load_dword v7, v4, s[6:7] offset:256 sc1
    v_and_b32 v4, 0xfffffe04, v4
    global_load_dword v6, v4, s[6:7] offset:128 sc1
K_NOS6B:
    s_mov_b32 s3, 1048576
K_FGP:
    ds_read_b32 v2, v13 offset:52
    s_sleep 1
    s_sub_u32 s3, s3, 1
    s_waitcnt lgkmcnt(0)
    v_readfirstlane_b32 s33, v2
    s_nop 3
    s_cselect_b32 s33, 8, s33
    s_cmp_lt_u32 s33, 8
    s_cbranch_scc1 K_FGP
    ds_read_b32 v200, v194
    ds_read_b32 v202, v194 offset:256
    ds_read_b64_tr_b16 v[16:17], v182 offset:0
    ds_read_b64_tr_b16 v[18:19], v182 offset:512
    ds_read_b64_tr_b16 v[20:21], v182 offset:1024
    ds_read_b64_tr_b16 v[22:23], v182 offset:1536
    ds_read_b64_tr_b16 v[24:25], v182 offset:2048
    ds_read_b64_tr_b16 v[26:27], v182 offset:2560
    ds_read_b64_tr_b16 v[28:29], v182 offset:3072
    ds_read_b64_tr_b16 v[30:31], v182 offset:3584
    ds_read_b64_tr_b16 v[32:33], v182 offset:4096
    ds_read_b64_tr_b16 v[34:35], v182 offset:4608
    ds_read_b64_tr_b16 v[36:37], v182 offset:5120
    ds_read_b64_tr_b16 v[38:39], v182 offset:5632
    ds_read_b64_tr_b16 v[40:41], v182 offset:6144
    ds_read_b64_tr_b16 v[42:43], v182 offset:6656
    s_waitcnt lgkmcnt(14)
    v_cvt_pk_bf16_f32 v200, v200, v200
    v_lshlrev_b32 v200, 16, v200
    v_cvt_pk_bf16_f32 v202, v202, v202
    v_lshlrev_b32 v202, 16, v202
    v_mul_f32 v201, 0xbfb8aa3b, v200
    v_exp_f32 v201, v201
    s_nop 0
    v_add_f32 v201, 1.0, v201
    v_rcp_f32 v201, v201
    s_nop 0
    v_mul_f32 v200, v200, v201
    v_cvt_pk_bf16_f32 v200, v200, v200
    v_lshlrev_b32 v200, 16, v200
    v_mul_f32 v200, v200, v202
    v_cvt_pk_bf16_f32 v200, v200, v200
    ds_write_b16 v195, v200
    s_waitcnt lgkmcnt(0)
    ds_read_b128 v[200:203], v193
    ds_read_b64_tr_b16 v[44:45], v182 offset:7168
    ds_read_b64_tr_b16 v[46:47], v182 offset:7680
    ds_read_b64_tr_b16 v[48:49], v182 offset:8192
    ds_read_b64_tr_b16 v[50:51], v182 offset:8704
    ds_read_b64_tr_b16 v[52:53], v182 offset:9216
    ds_read_b64_tr_b16 v[54:55], v182 offset:9728
    s_waitcnt lgkmcnt(6)
    v_mfma_f32_16x16x32_bf16 v[96:99], v[16:19], v[200:203], 0
    v_mfma_f32_16x16x32_bf16 v[100:103], v[20:23], v[200:203], 0
    v_mfma_f32_16x16x32_bf16 v[104:107], v[24:27], v[200:203], 0
    v_mfma_f32_16x16x32_bf16 v[108:111], v[28:31], v[200:203], 0
    v_mfma_f32_16x16x32_bf16 v[112:115], v[32:35], v[200:203], 0
    v_mfma_f32_16x16x32_bf16 v[116:119], v[36:39], v[200:203], 0
    v_mfma_f32_16x16x32_bf16 v[120:123], v[40:43], v[200:203], 0
    s_waitcnt lgkmcnt(4)
    v_mfma_f32_16x16x32_bf16 v[124:127], v[44:47], v[200:203], 0
    s_waitcnt lgkmcnt(2)
    v_mfma_f32_16x16x32_bf16 v[128:131], v[48:51], v[200:203], 0
    s_waitcnt lgkmcnt(0)
    v_mfma_f32_16x16x32_bf16 v[132:135], v[52:55], v[200:203], 0
    s_mov_b32 exec_lo, 0x00030003
    s_mov_b32 exec_hi, 0x00030003
    ds_write_b128 v196, v[96:99] offset:0
    ds_write_b128 v196, v[100:103] offset:256
    ds_write_b128 v196, v[104:107] offset:512
    ds_write_b128 v196, v[108:111] offset:768
    ds_write_b128 v196, v[112:115] offset:1024
    ds_write_b128 v196, v[116:119] offset:1280
    ds_write_b128 v196, v[120:123] offset:1536
    ds_write_b128 v196, v[124:127] offset:1792
    s_branch K_J83cc
K_STF18:
    s_branch K_WRET_F
    s_nop 0
K_J83cc:
    ds_write_b128 v196, v[128:131] offset:2048
    ds_write_b128 v196, v[132:135] offset:2304
    v_mov_b32 v3, 1
    s_mov_b64 exec, 1
    ds_add_u32 v13, v3 offset:52
    s_mov_b64 exec, -1
    s_cmp_lg_u32 s30, 4
    s_cbranch_scc1 K_P2
    v_lshlrev_b32 v3, 4, v1
    v_add_u32 v4, 126016, v3
    s_mul_i32 s70, s43, 5120
    s_add_u32 s71, s70, 4096
    s_mov_b32 s3, 1048576
K_FGQ:
    ds_read_b32 v2, v13 offset:52
    s_sleep 1
    s_sub_u32 s3, s3, 1
    s_waitcnt lgkmcnt(0)
    v_readfirstlane_b32 s33, v2
    s_nop 3
    s_cselect_b32 s33, 12, s33
    s_cmp_lt_u32 s33, 12
    s_cbranch_scc1 K_FGQ
    ds_read_b128 v[16:19], v4 offset:0
    ds_read_b128 v[20:23], v4 offset:1024
    ds_read_b128 v[24:27], v4 offset:2048
    ds_read_b128 v[28:31], v4 offset:3072
    ds_read_b128 v[32:35], v4 offset:4096
    s_waitcnt lgkmcnt(4)
    buffer_store_dwordx4 v[16:19], v3, s[60:63], s70 offen offset:0 sc1
    s_waitcnt lgkmcnt(3)
    buffer_store_dwordx4 v[20:23], v3, s[60:63], s70 offen offset:1024 sc1
    s_waitcnt lgkmcnt(2)
    buffer_store_dwordx4 v[24:27], v3, s[60:63], s70 offen offset:2048 sc1
    s_waitcnt lgkmcnt(1)
    buffer_store_dwordx4 v[28:31], v3, s[60:63], s70 offen offset:3072 sc1
    s_waitcnt lgkmcnt(0)
    buffer_store_dwordx4 v[32:35], v3, s[60:63], s71 offen offset:0 sc1
    s_mov_b32 s3, 1
    s_waitcnt vmcnt(0)
    s_atomic_add s3, s[6:7], 606720 glc
    ds_read_b64 v[176:177], v183
    s_waitcnt lgkmcnt(0)
    s_cmp_lg_u32 s3, 53
    s_cbranch_scc1 K_P2
    v_readfirstlane_b32 s70, v176
    s_and_b32 s70, s70, 0x7ff
    s_sub_u32 s70, 2047, s70
    s_lshr_b32 s70, s70, 7
    s_mul_i32 s70, s70, 5120
    s_atomic_add s3, s[6:7], s70 offset:524424
    s_atomic_add s3, s[6:7], s70 offset:524936
    s_atomic_add s3, s[6:7], s70 offset:525448
    s_atomic_add s3, s[6:7], s70 offset:525960
    s_atomic_add s3, s[6:7], s70 offset:526472
    s_atomic_add s3, s[6:7], s70 offset:526984
    s_atomic_add s3, s[6:7], s70 offset:527496
    s_atomic_add s3, s[6:7], s70 offset:528008
    s_atomic_add s3, s[6:7], s70 offset:528520
    s_atomic_add s3, s[6:7], s70 offset:529032
    v_readfirstlane_b32 s70, v177
    s_and_b32 s70, s70, 0x7ff
    s_sub_u32 s70, 2047, s70
    s_lshr_b32 s70, s70, 7
    s_mul_i32 s70, s70, 5120
    s_atomic_add s3, s[6:7], s70 offset:524424
    s_atomic_add s3, s[6:7], s70 offset:524936
    s_atomic_add s3, s[6:7], s70 offset:525448
    s_atomic_add s3, s[6:7], s70 offset:525960
    s_atomic_add s3, s[6:7], s70 offset:526472
    s_atomic_add s3, s[6:7], s70 offset:526984
    s_atomic_add s3, s[6:7], s70 offset:527496
    s_atomic_add s3, s[6:7], s70 offset:528008
    s_atomic_add s3, s[6:7], s70 offset:528520
    s_atomic_add s3, s[6:7], s70 offset:529032
    s_waitcnt lgkmcnt(0)
    s_branch K_P2
K_CODE_END:
.section .rodata,"a"
.p2align 6
.amdhsa_kernel gated_mix__sliding_local_dilated__moe_arch_mod__prompt_kernel
  .amdhsa_next_free_vgpr 256
  .amdhsa_next_free_sgpr 79
  .amdhsa_accum_offset 256
  .amdhsa_group_segment_fixed_size 0
  .amdhsa_kernarg_size 96
  .amdhsa_user_sgpr_count 2
  .amdhsa_user_sgpr_kernarg_segment_ptr 1
  .amdhsa_system_sgpr_workgroup_id_x 1
.end_amdhsa_kernel
```

```asm
; @launch grid=(256,1,1) block=(512,1,1) lds=163840
.amdgcn_target "amdgcn-amd-amdhsa--gfx950"
.text
K_CPL = 33
.p2align 12
.p2align 8
.globl gated_mix__sliding_local_dilated__moe_arch_mod__prompt_kernel
.type gated_mix__sliding_local_dilated__moe_arch_mod__prompt_kernel,@function
gated_mix__sliding_local_dilated__moe_arch_mod__prompt_kernel:
    s_cmp_ge_u32 s2, 256
    s_cbranch_scc1 K_EXIT
    s_load_dwordx2 s[12:13], s[0:1], 0
    s_load_dwordx2 s[16:17], s[0:1], 8
    s_load_dwordx4 s[4:7], s[0:1], 80
    s_load_dwordx2 s[8:9], s[0:1], 16
    s_load_dwordx2 s[10:11], s[0:1], 72
    v_readfirstlane_b32 s30, v0
    s_mov_b32 s14, 0x280000
    s_mov_b32 s15, 0x20000
    s_lshr_b32 s30, s30, 6
    s_cmp_ge_u32 s2, 64
    s_cbranch_scc1 K_MAIN
    s_load_dwordx8 s[44:51], s[0:1], 32
    s_load_dwordx2 s[52:53], s[0:1], 64
    s_getpc_b64 s[38:39]
K_PC:
    s_lshr_b32 s3, s2, 3
    s_mul_i32 s3, s3, K_CPL
    v_add_u32 v2, s3, v0
    v_lshlrev_b32 v2, 7, v2
    v_min_u32 v2, K_CODE_END-K_PC-4, v2
    v_cmp_gt_u32 vcc, K_CPL, v0
    s_and_saveexec_b64 s[20:21], vcc
    s_cbranch_execz K_NOPF
    global_load_dword v6, v2, s[38:39]
K_NOPF:
    s_mov_b64 exec, -1
    s_cmp_lg_u32 s30, 4
    s_cbranch_scc1 K_AUX
    s_min_u32 s3, s2, 8
    s_mul_i32 s3, s3, 10240
    s_add_u32 s33, s3, 10240
    s_cmp_lt_u32 s2, 8
    s_cbranch_scc1 K_ZS
    s_cmp_lg_u32 s2, 63
    s_cbranch_scc1 K_AUX
    s_mov_b32 s33, 0
K_ZS:
    v_lshlrev_b32 v2, 4, v0
    v_mov_b32 v8, 0
    v_mov_b32 v9, 0
    v_mov_b32 v10, 0
    v_mov_b32 v11, 0
    s_waitcnt lgkmcnt(0)
    s_add_u32 s20, s6, 0x7f000
    s_addc_u32 s21, s7, 0
    s_mov_b32 s22, 0x15400
    s_mov_b32 s23, 0x20000
K_ZL:
    buffer_store_dwordx4 v[8:11], v2, s[20:23], s3 offen sc1
    s_add_u32 s3, s3, 1024
    s_cmp_lt_u32 s3, s33
    s_cbranch_scc1 K_ZL
    s_branch K_AUX
K_MAIN:
    s_cmp_ge_u32 s30, 4
    s_cbranch_scc1 K_CONS
    s_bfe_u32 s3, s2, 0x20001
    s_mul_i32 s44, s3, 655360
    s_add_u32 s14, s44, 655360
    s_lshr_b32 s33, s2, 6
    s_mul_i32 s3, s33, 225280
    s_add_u32 s44, s44, s3
    s_mul_i32 s3, s30, 61440
    s_add_u32 s44, s44, s3
    s_sub_u32 s44, s44, 245760
    v_bfe_u32 v3, v0, 4, 2
    s_lshr_b32 s3, s2, 1
    s_and_b32 s3, s3, 28
    s_or_b32 s3, s3, 0x40000
    v_lshlrev_b32 v2, 1, v3
    v_sub_u32 v2, v0, v2
    s_and_b32 s50, s2, 0xc1
    s_mov_b32 s49, 0x225310
    s_cmpk_eq_u32 s50, 128
    s_cselect_b32 s49, 0x75275526, s49
    s_cmpk_eq_u32 s50, 192
    s_cselect_b32 s49, 0x37750756, s49
    s_cmpk_eq_u32 s50, 65
    s_cselect_b32 s49, 0x225510, s49
    s_cmpk_eq_u32 s50, 129
    s_cselect_b32 s49, 0x75275525, s49
    s_cmpk_eq_u32 s50, 193
    s_cselect_b32 s49, 0x37769756, s49
    s_bfe_u32 s49, s49, s3
    s_bfe_u32 s32, 0x64317520, s3
    v_and_b32 v2, 15, v2
    v_mul_u32_u24 v5, 3840, v3
    s_lshl_b32 s3, s2, 2
    s_lshr_b32 s3, 0x44032335, s3
    s_and_b32 s3, s3, 15
    s_add_u32 s49, s49, s3
    s_mov_b32 s33, 0x00a55a
    v_subrev_u32 v5, 160, v5
    s_sub_u32 s3, s49, 10
    s_cselect_b32 s49, s49, s3
    v_mul_u32_u24 v4, 52, v2
    v_lshrrev_b32 v4, 5, v4
    v_and_b32 v4, 24, v4
    v_bfe_u32 v4, s33, v4, 8
    v_add_u32 v4, v4, v2
    v_lshl_add_u32 v218, v4, 4, v5
    v_add_u32 v4, 1, v2
    v_lshrrev_b32 v4, 4, v4
    v_lshl_add_u32 v218, v4, 28, v218
    v_xor_b32 v2, 8, v2
    v_mul_u32_u24 v4, 52, v2
    v_lshrrev_b32 v4, 5, v4
    v_and_b32 v4, 24, v4
    v_bfe_u32 v4, s33, v4, 8
    v_add_u32 v4, v4, v2
    v_lshl_add_u32 v219, v4, 4, v5
    v_add_u32 v4, 1, v2
    v_lshrrev_b32 v4, 4, v4
    v_lshl_add_u32 v219, v4, 28, v219
    s_bitcmp1_b32 s2, 0
    s_cselect_b32 s3, 8, 0
    s_add_u32 s32, s32, s3
    s_mul_i32 s50, s32, 80
    s_mul_i32 s3, s30, 61440
    s_add_u32 s50, s50, s3
    s_lshl_b32 s46, s30, 12
    s_add_u32 s46, s46, 24576
    s_mul_i32 s45, s30, 6144
    s_mov_b32 s18, 0x258000
    s_mov_b32 s19, 0x20000
    v_xor_b32 v3, v3, v0
    v_and_b32 v3, 7, v3
    v_bfe_u32 v2, v0, 3, 3
    v_mul_u32_u24 v2, 1280, v2
    v_lshl_add_u32 v216, v3, 4, v2
    v_xor_b32 v217, 64, v216
    s_lshl_b32 s47, s49, 7
    s_mul_i32 s48, s49, 245760
    s_add_u32 s51, s44, s47
    s_add_u32 s48, s48, s50
    s_add_u32 s49, s49, 1
    s_cmp_eq_u32 s49, 10
    s_cselect_b32 s49, 0, s49
    s_waitcnt lgkmcnt(0)
    s_add_u32 m0, s46, 81920
    s_add_u32 s52, s48, 0
    buffer_load_dwordx4 v218, s[16:19], s52 offen lds
    s_add_u32 m0, s45, 81920
    s_max_i32 s52, s51, s47
    buffer_load_dwordx4 v216, s[12:15], s52 offen lds
    s_add_u32 m0, s46, 82944
    s_add_u32 s52, s48, 15360
    buffer_load_dwordx4 v218, s[16:19], s52 offen lds
    s_add_u32 m0, s45, 82944
    s_add_u32 s52, s51, 10240
    s_max_i32 s52, s52, s47
    buffer_load_dwordx4 v217, s[12:15], s52 offen lds
    s_add_u32 m0, s45, 83968
    s_add_u32 s52, s51, 20480
    buffer_load_dwordx4 v216, s[12:15], s52 offen lds
    s_add_u32 m0, s46, 83968
    s_add_u32 s52, s48, 30720
    buffer_load_dwordx4 v219, s[16:19], s52 offen lds
    s_add_u32 m0, s45, 84992
    s_add_u32 s52, s51, 30720
    buffer_load_dwordx4 v217, s[12:15], s52 offen lds
    s_add_u32 m0, s46, 84992
    s_add_u32 s52, s48, 46080
    buffer_load_dwordx4 v219, s[16:19], s52 offen lds
    s_add_u32 m0, s45, 86016
    s_add_u32 s52, s51, 40960
    buffer_load_dwordx4 v216, s[12:15], s52 offen lds
    s_add_u32 m0, s45, 87040
    s_add_u32 s52, s51, 51200
    buffer_load_dwordx4 v217, s[12:15], s52 offen lds
    s_lshl_b32 s47, s49, 7
    s_mul_i32 s48, s49, 245760
    s_add_u32 s51, s44, s47
    s_add_u32 s48, s48, s50
    s_add_u32 s49, s49, 1
    s_cmp_eq_u32 s49, 10
    s_cselect_b32 s49, 0, s49
    s_add_u32 m0, s46, 0
    s_add_u32 s52, s48, 0
    buffer_load_dwordx4 v218, s[16:19], s52 offen lds
    s_add_u32 m0, s45, 0
    s_max_i32 s52, s51, s47
    buffer_load_dwordx4 v216, s[12:15], s52 offen lds
    s_add_u32 m0, s46, 1024
    s_add_u32 s52, s48, 15360
    buffer_load_dwordx4 v218, s[16:19], s52 offen lds
    s_add_u32 m0, s45, 1024
    s_add_u32 s52, s51, 10240
    s_max_i32 s52, s52, s47
    buffer_load_dwordx4 v217, s[12:15], s52 offen lds
    s_add_u32 m0, s45, 2048
    s_add_u32 s52, s51, 20480
    buffer_load_dwordx4 v216, s[12:15], s52 offen lds
    s_add_u32 m0, s46, 2048
    s_add_u32 s52, s48, 30720
    buffer_load_dwordx4 v219, s[16:19], s52 offen lds
    s_mov_b32 s43, s30
    v_and_b32 v1, 63, v0
    v_mov_b32 v7, 0
    s_and_b32 s28, s2, 7
    s_lshr_b32 s29, s2, 3
    s_xor_b32 s30, s30, 4
    s_lshr_b32 s34, s29, 3
    s_lshl_b32 s34, s34, 2
    s_and_b32 s3, s29, 3
    s_add_u32 s34, s34, s3
    s_add_u32 s34, s34, 4
    s_bitcmp1_b32 s29, 2
    s_cselect_b32 s34, -1, s34
    s_cmp_lt_u32 s29, 8
    s_cselect_b32 s34, s29, s34
    s_lshl_b32 s40, s28, 1
    s_cmp_ge_u32 s34, 10
    s_addc_u32 s40, s40, 0
    s_sub_u32 s41, s34, 10
    s_cmp_ge_u32 s34, 10
    s_cselect_b32 s41, s41, s34
    s_mul_i32 s42, s28, 20
    s_add_u32 s42, s42, s34
    s_and_b32 s42, s42, 255
    s_lshl_b32 s42, s42, 9
    s_add_u32 s42, s42, 524288
    s_lshr_b32 s31, s28, 1
    s_lshl_b32 s31, s31, 5
    s_lshr_b32 s3, s29, 3
    s_mul_i32 s3, s3, 11
    s_add_u32 s31, s31, s3
    s_sub_u32 s31, s31, 11
    s_and_b32 s32, s28, 1
    s_lshl_b32 s32, s32, 3
    s_and_b32 s3, s29, 7
    s_lshl_b32 s3, s3, 2
    s_lshr_b32 s3, 0x64317520, s3
    s_and_b32 s3, s3, 7
    s_add_u32 s32, s32, s3
    s_and_b32 s35, s29, 3
    s_and_b32 s3, s29, 4
    s_lshl_b32 s3, s3, 1
    s_add_u32 s35, s35, s3
    s_and_b32 s3, s28, 1
    s_lshl_b32 s3, s3, 2
    s_add_u32 s35, s35, s3
K_LOADER:
    s_mov_b32 s24, s8
    s_mov_b32 s25, s9
    s_mov_b32 s26, 0xc8000
    s_mov_b32 s27, 0x20000
    v_and_b32 v8, 15, v1
    v_lshrrev_b32 v9, 4, v1
    v_bfe_u32 v10, v1, 2, 2
    v_and_b32 v11, 3, v1
    s_add_u32 s20, s6, 0x100000
    s_addc_u32 s21, s7, 0
    s_mov_b32 s22, 0x280000
    s_mov_b32 s23, 0x20000
    s_lshr_b32 s53, s35, 2
    s_add_u32 s3, s53, s35
    s_lshl_b32 s3, s3, 12
    s_mul_i32 s33, s53, 19456
    s_lshl_b32 s53, s35, 8
    s_add_u32 s33, s33, s53
    s_add_u32 s33, s33, 16384
    s_lshr_b32 s53, s31, 5
    s_add_u32 s53, s53, 1
    s_mul_i32 s22, s53, 655360
    s_mov_b32 s53, s31
    s_add_u32 s54, s53, s43
    v_mov_b32 v3, s54
    v_lshrrev_b32 v2, 2, v3
    v_mul_u32_u24 v2, 76, v2
    v_add_lshl_u32 v2, v2, v3, 10
    v_lshl_add_u32 v2, v8, 4, v2
    v_add_u32 v220, s3, v2
    v_lshl_add_u32 v220, v9, 8, v220
    s_lshl_b32 s3, s43, 2
    v_add_u32 v4, s3, v9
    v_add_u32 v3, s53, v4
    v_lshrrev_b32 v2, 2, v3
    v_mul_u32_u24 v2, 76, v2
    v_add_lshl_u32 v2, v2, v3, 10
    v_lshl_add_u32 v2, v8, 4, v2
    v_add_u32 v221, s33, v2
    v_mov_b32 v5, 0x10000000
    v_cmp_gt_u32 vcc, 11, v4
    v_mov_b32 v224, -1
    v_mov_b32 v225, -1
    v_mov_b32 v226, -1
    v_mov_b32 v227, -1
    v_cndmask_b32 v221, v5, v221, vcc
    v_lshrrev_b32 v2, 3, v1
    v_mul_u32_u24 v2, 1280, v2
    v_lshrrev_b32 v3, 2, v1
    v_and_b32 v3, 4, v3
    v_and_b32 v4, 7, v1
    v_xor_b32 v3, v3, v4
    v_lshl_add_u32 v2, v3, 4, v2
    s_lshl_b32 s33, s41, 7
    v_add_u32 v222, s33, v2
    v_lshrrev_b32 v5, 5, v1
    v_mul_u32_u24 v5, 20480, v5
    v_add_u32 v5, v5, v222
    s_mov_b32 s30, s43
    s_waitcnt vmcnt(6)
    s_barrier
    s_add_u32 m0, s45, 3072
    s_add_u32 s52, s51, 30720
    buffer_load_dwordx4 v217, s[12:15], s52 offen lds
    s_add_u32 m0, s46, 3072
    s_add_u32 s52, s48, 46080
    buffer_load_dwordx4 v219, s[16:19], s52 offen lds
    s_add_u32 m0, s45, 4096
    s_add_u32 s52, s51, 40960
    buffer_load_dwordx4 v216, s[12:15], s52 offen lds
    s_add_u32 m0, s45, 5120
    s_add_u32 s52, s51, 51200
    buffer_load_dwordx4 v217, s[12:15], s52 offen lds
    s_lshl_b32 s47, s49, 7
    s_mul_i32 s48, s49, 245760
    s_add_u32 s51, s44, s47
    s_add_u32 s48, s48, s50
    s_add_u32 s49, s49, 1
    s_cmp_eq_u32 s49, 10
    s_cselect_b32 s49, 0, s49
    s_add_u32 m0, s46, 40960
    s_add_u32 s52, s48, 0
    buffer_load_dwordx4 v218, s[16:19], s52 offen lds
    s_add_u32 m0, s45, 40960
    s_max_i32 s52, s51, s47
    buffer_load_dwordx4 v216, s[12:15], s52 offen lds
    s_add_u32 m0, s46, 41984
    s_add_u32 s52, s48, 15360
    buffer_load_dwordx4 v218, s[16:19], s52 offen lds
    s_add_u32 m0, s45, 41984
    s_add_u32 s52, s51, 10240
    s_max_i32 s52, s52, s47
    buffer_load_dwordx4 v217, s[12:15], s52 offen lds
    s_add_u32 m0, s45, 43008
    s_add_u32 s52, s51, 20480
    buffer_load_dwordx4 v216, s[12:15], s52 offen lds
    s_add_u32 m0, s46, 43008
    s_add_u32 s52, s48, 30720
    buffer_load_dwordx4 v219, s[16:19], s52 offen lds
    s_waitcnt vmcnt(6)
    s_barrier
    s_add_u32 m0, s45, 44032
    s_add_u32 s52, s51, 30720
    buffer_load_dwordx4 v217, s[12:15], s52 offen lds
    s_add_u32 m0, s46, 44032
    s_add_u32 s52, s48, 46080
    buffer_load_dwordx4 v219, s[16:19], s52 offen lds
    s_add_u32 m0, s45, 45056
    s_add_u32 s52, s51, 40960
    buffer_load_dwordx4 v216, s[12:15], s52 offen lds
    s_add_u32 m0, s45, 46080
    s_add_u32 s52, s51, 51200
    buffer_load_dwordx4 v217, s[12:15], s52 offen lds
    s_lshl_b32 s47, s49, 7
    s_mul_i32 s48, s49, 245760
    s_add_u32 s51, s44, s47
    s_add_u32 s48, s48, s50
    s_add_u32 s49, s49, 1
    s_cmp_eq_u32 s49, 10
    s_cselect_b32 s49, 0, s49
    s_add_u32 m0, s46, 81920
    s_add_u32 s52, s48, 0
    buffer_load_dwordx4 v218, s[16:19], s52 offen lds
    s_add_u32 m0, s45, 81920
    s_max_i32 s52, s51, s47
    buffer_load_dwordx4 v216, s[12:15], s52 offen lds
    s_add_u32 m0, s46, 82944
    s_add_u32 s52, s48, 15360
    buffer_load_dwordx4 v218, s[16:19], s52 offen lds
    s_add_u32 m0, s45, 82944
    s_add_u32 s52, s51, 10240
    s_max_i32 s52, s52, s47
    buffer_load_dwordx4 v217, s[12:15], s52 offen lds
    s_add_u32 m0, s45, 83968
    s_add_u32 s52, s51, 20480
    buffer_load_dwordx4 v216, s[12:15], s52 offen lds
    s_add_u32 m0, s46, 83968
    s_add_u32 s52, s48, 30720
    buffer_load_dwordx4 v219, s[16:19], s52 offen lds
    s_waitcnt vmcnt(6)
    s_barrier
    s_add_u32 m0, s45, 84992
    s_add_u32 s52, s51, 30720
    buffer_load_dwordx4 v217, s[12:15], s52 offen lds
    s_add_u32 m0, s46, 84992
    s_add_u32 s52, s48, 46080
    buffer_load_dwordx4 v219, s[16:19], s52 offen lds
    s_add_u32 m0, s45, 86016
    s_add_u32 s52, s51, 40960
    buffer_load_dwordx4 v216, s[12:15], s52 offen lds
    s_add_u32 m0, s45, 87040
    s_add_u32 s52, s51, 51200
    buffer_load_dwordx4 v217, s[12:15], s52 offen lds
    s_lshl_b32 s47, s49, 7
    s_mul_i32 s48, s49, 245760
    s_add_u32 s51, s44, s47
    s_add_u32 s48, s48, s50
    s_add_u32 s49, s49, 1
    s_cmp_eq_u32 s49, 10
    s_cselect_b32 s49, 0, s49
    s_add_u32 m0, s46, 0
    s_add_u32 s52, s48, 0
    buffer_load_dwordx4 v218, s[16:19], s52 offen lds
    s_add_u32 m0, s45, 0
    s_max_i32 s52, s51, s47
    buffer_load_dwordx4 v216, s[12:15], s52 offen lds
    s_add_u32 m0, s46, 1024
    s_add_u32 s52, s48, 15360
    buffer_load_dwordx4 v218, s[16:19], s52 offen lds
    s_add_u32 m0, s45, 1024
    s_add_u32 s52, s51, 10240
    s_max_i32 s52, s52, s47
    buffer_load_dwordx4 v217, s[12:15], s52 offen lds
    s_add_u32 m0, s45, 2048
    s_add_u32 s52, s51, 20480
    buffer_load_dwordx4 v216, s[12:15], s52 offen lds
    s_add_u32 m0, s46, 2048
    s_add_u32 s52, s48, 30720
    buffer_load_dwordx4 v219, s[16:19], s52 offen lds
    s_waitcnt vmcnt(6)
    s_barrier
    s_add_u32 m0, s45, 3072
    s_add_u32 s52, s51, 30720
    buffer_load_dwordx4 v217, s[12:15], s52 offen lds
    s_add_u32 m0, s46, 3072
    s_add_u32 s52, s48, 46080
    buffer_load_dwordx4 v219, s[16:19], s52 offen lds
    s_add_u32 m0, s45, 4096
    s_add_u32 s52, s51, 40960
    buffer_load_dwordx4 v216, s[12:15], s52 offen lds
    s_add_u32 m0, s45, 5120
    s_add_u32 s52, s51, 51200
    buffer_load_dwordx4 v217, s[12:15], s52 offen lds
    s_lshl_b32 s47, s49, 7
    s_mul_i32 s48, s49, 245760
    s_add_u32 s51, s44, s47
    s_add_u32 s48, s48, s50
    s_add_u32 s49, s49, 1
    s_cmp_eq_u32 s49, 10
    s_cselect_b32 s49, 0, s49
    s_add_u32 m0, s46, 40960
    s_add_u32 s52, s48, 0
    buffer_load_dwordx4 v218, s[16:19], s52 offen lds
    s_add_u32 m0, s45, 40960
    s_max_i32 s52, s51, s47
    buffer_load_dwordx4 v216, s[12:15], s52 offen lds
    s_add_u32 m0, s46, 41984
    s_add_u32 s52, s48, 15360
    buffer_load_dwordx4 v218, s[16:19], s52 offen lds
    s_add_u32 m0, s45, 41984
    s_add_u32 s52, s51, 10240
    s_max_i32 s52, s52, s47
    buffer_load_dwordx4 v217, s[12:15], s52 offen lds
    s_add_u32 m0, s45, 43008
    s_add_u32 s52, s51, 20480
    buffer_load_dwordx4 v216, s[12:15], s52 offen lds
    s_add_u32 m0, s46, 43008
    s_add_u32 s52, s48, 30720
    buffer_load_dwordx4 v219, s[16:19], s52 offen lds
    s_waitcnt vmcnt(6)
    s_barrier
    s_add_u32 m0, s45, 44032
    s_add_u32 s52, s51, 30720
    buffer_load_dwordx4 v217, s[12:15], s52 offen lds
    s_add_u32 m0, s46, 44032
    s_add_u32 s52, s48, 46080
    buffer_load_dwordx4 v219, s[16:19], s52 offen lds
    s_add_u32 m0, s45, 45056
    s_add_u32 s52, s51, 40960
    buffer_load_dwordx4 v216, s[12:15], s52 offen lds
    s_add_u32 m0, s45, 46080
    s_add_u32 s52, s51, 51200
    buffer_load_dwordx4 v217, s[12:15], s52 offen lds
    s_lshl_b32 s47, s49, 7
    s_mul_i32 s48, s49, 245760
    s_add_u32 s51, s44, s47
    s_add_u32 s48, s48, s50
    s_add_u32 s49, s49, 1
    s_cmp_eq_u32 s49, 10
    s_cselect_b32 s49, 0, s49
    s_add_u32 m0, s46, 81920
    s_add_u32 s52, s48, 0
    buffer_load_dwordx4 v218, s[16:19], s52 offen lds
    s_add_u32 m0, s45, 81920
    s_max_i32 s52, s51, s47
    buffer_load_dwordx4 v216, s[12:15], s52 offen lds
    s_add_u32 m0, s46, 82944
    s_add_u32 s52, s48, 15360
    buffer_load_dwordx4 v218, s[16:19], s52 offen lds
    s_add_u32 m0, s45, 82944
    s_add_u32 s52, s51, 10240
    s_max_i32 s52, s52, s47
    buffer_load_dwordx4 v217, s[12:15], s52 offen lds
    s_add_u32 m0, s45, 83968
    s_add_u32 s52, s51, 20480
    buffer_load_dwordx4 v216, s[12:15], s52 offen lds
    s_add_u32 m0, s46, 83968
    s_add_u32 s52, s48, 30720
    buffer_load_dwordx4 v219, s[16:19], s52 offen lds
    s_waitcnt vmcnt(6)
    s_barrier
    s_add_u32 m0, s45, 84992
    s_add_u32 s52, s51, 30720
    buffer_load_dwordx4 v217, s[12:15], s52 offen lds
    s_add_u32 m0, s46, 84992
    s_add_u32 s52, s48, 46080
    buffer_load_dwordx4 v219, s[16:19], s52 offen lds
    s_add_u32 m0, s45, 86016
    s_add_u32 s52, s51, 40960
    buffer_load_dwordx4 v216, s[12:15], s52 offen lds
    s_add_u32 m0, s45, 87040
    s_add_u32 s52, s51, 51200
    buffer_load_dwordx4 v217, s[12:15], s52 offen lds
    s_lshl_b32 s47, s49, 7
    s_mul_i32 s48, s49, 245760
    s_add_u32 s51, s44, s47
    s_add_u32 s48, s48, s50
    s_add_u32 s49, s49, 1
    s_cmp_eq_u32 s49, 10
    s_cselect_b32 s49, 0, s49
    s_add_u32 m0, s46, 0
    s_add_u32 s52, s48, 0
    buffer_load_dwordx4 v218, s[16:19], s52 offen lds
    s_add_u32 m0, s45, 0
    s_max_i32 s52, s51, s47
    buffer_load_dwordx4 v216, s[12:15], s52 offen lds
    s_add_u32 m0, s46, 1024
    s_add_u32 s52, s48, 15360
    buffer_load_dwordx4 v218, s[16:19], s52 offen lds
    s_add_u32 m0, s45, 1024
    s_add_u32 s52, s51, 10240
    s_max_i32 s52, s52, s47
    buffer_load_dwordx4 v217, s[12:15], s52 offen lds
    s_add_u32 m0, s45, 2048
    s_add_u32 s52, s51, 20480
    buffer_load_dwordx4 v216, s[12:15], s52 offen lds
    s_add_u32 m0, s46, 2048
    s_add_u32 s52, s48, 30720
    buffer_load_dwordx4 v219, s[16:19], s52 offen lds
    s_branch K_PG0
.p2align 12
K_CHM0:
K_STM0:
    s_branch K_WRET_M
    s_nop 0
K_PG0:
    s_waitcnt vmcnt(6)
    s_barrier
    s_add_u32 m0, s45, 3072
    s_add_u32 s52, s51, 30720
    buffer_load_dwordx4 v217, s[12:15], s52 offen lds
    s_add_u32 m0, s46, 3072
    s_add_u32 s52, s48, 46080
    buffer_load_dwordx4 v219, s[16:19], s52 offen lds
    s_add_u32 m0, s45, 4096
    s_add_u32 s52, s51, 40960
    buffer_load_dwordx4 v216, s[12:15], s52 offen lds
    s_add_u32 m0, s45, 5120
    s_add_u32 s52, s51, 51200
    buffer_load_dwordx4 v217, s[12:15], s52 offen lds
    s_lshl_b32 s47, s49, 7
    s_mul_i32 s48, s49, 245760
    s_add_u32 s51, s44, s47
    s_add_u32 s48, s48, s50
    s_add_u32 s49, s49, 1
    s_cmp_eq_u32 s49, 10
    s_cselect_b32 s49, 0, s49
    s_add_u32 m0, s46, 40960
    s_add_u32 s52, s48, 0
    buffer_load_dwordx4 v218, s[16:19], s52 offen lds
    s_add_u32 m0, s45, 40960
    s_max_i32 s52, s51, s47
    buffer_load_dwordx4 v216, s[12:15], s52 offen lds
    s_add_u32 m0, s46, 41984
    s_add_u32 s52, s48, 15360
    buffer_load_dwordx4 v218, s[16:19], s52 offen lds
    s_add_u32 m0, s45, 41984
    s_add_u32 s52, s51, 10240
    s_max_i32 s52, s52, s47
    buffer_load_dwordx4 v217, s[12:15], s52 offen lds
    s_add_u32 m0, s45, 43008
    s_add_u32 s52, s51, 20480
    buffer_load_dwordx4 v216, s[12:15], s52 offen lds
    s_add_u32 m0, s46, 43008
    s_add_u32 s52, s48, 30720
    buffer_load_dwordx4 v219, s[16:19], s52 offen lds
    s_waitcnt vmcnt(6)
    s_barrier
    s_add_u32 m0, s45, 44032
    s_add_u32 s52, s51, 30720
    buffer_load_dwordx4 v217, s[12:15], s52 offen lds
    s_add_u32 m0, s46, 44032
    s_add_u32 s52, s48, 46080
    buffer_load_dwordx4 v219, s[16:19], s52 offen lds
    s_add_u32 m0, s45, 45056
    s_add_u32 s52, s51, 40960
    buffer_load_dwordx4 v216, s[12:15], s52 offen lds
    s_add_u32 m0, s45, 46080
    s_add_u32 s52, s51, 51200
    buffer_load_dwordx4 v217, s[12:15], s52 offen lds
    s_lshl_b32 s47, s49, 7
    s_mul_i32 s48, s49, 245760
    s_add_u32 s51, s44, s47
    s_add_u32 s48, s48, s50
    s_add_u32 s49, s49, 1
    s_cmp_eq_u32 s49, 10
    s_cselect_b32 s49, 0, s49
    s_add_u32 m0, s46, 81920
    s_add_u32 s52, s48, 0
    buffer_load_dwordx4 v218, s[16:19], s52 offen lds
    s_add_u32 m0, s45, 81920
    s_max_i32 s52, s51, s47
    buffer_load_dwordx4 v216, s[12:15], s52 offen lds
    s_add_u32 m0, s46, 82944
    s_add_u32 s52, s48, 15360
    buffer_load_dwordx4 v218, s[16:19], s52 offen lds
    s_add_u32 m0, s45, 82944
    s_add_u32 s52, s51, 10240
    s_max_i32 s52, s52, s47
    buffer_load_dwordx4 v217, s[12:15], s52 offen lds
    s_add_u32 m0, s45, 83968
    s_add_u32 s52, s51, 20480
    buffer_load_dwordx4 v216, s[12:15], s52 offen lds
    s_add_u32 m0, s46, 83968
    s_add_u32 s52, s48, 30720
    buffer_load_dwordx4 v219, s[16:19], s52 offen lds
    s_waitcnt vmcnt(6)
    s_barrier
    s_load_dword s54, s[4:5], 192
    s_add_u32 m0, s45, 84992
    s_add_u32 s52, s51, 30720
    buffer_load_dwordx4 v217, s[12:15], s52 offen lds
    s_add_u32 m0, s46, 84992
    s_add_u32 s52, s48, 46080
    buffer_load_dwordx4 v219, s[16:19], s52 offen lds
    s_add_u32 m0, s45, 86016
    s_add_u32 s52, s51, 40960
    buffer_load_dwordx4 v216, s[12:15], s52 offen lds
    s_add_u32 m0, s45, 87040
    s_add_u32 s52, s51, 51200
    buffer_load_dwordx4 v217, s[12:15], s52 offen lds
    s_waitcnt lgkmcnt(0)
    s_cmp_ge_u32 s54, 8
    s_cbranch_scc1 K_ZO0
    s_mov_b32 s3, 16384
K_ZB0:
    v_mov_b32 v4, 192
    global_load_dword v4, v4, s[4:5] sc1
    s_waitcnt vmcnt(0)
    v_readfirstlane_b32 s33, v4
    s_cmp_ge_u32 s33, 8
    s_cbranch_scc1 K_ZO0
    s_sleep 8
    s_sub_u32 s3, s3, 1
    s_cbranch_scc0 K_ZB0
K_ZO0:
    s_cmp_eq_u32 s34, -1
    s_cbranch_scc1 K_NOLT
    s_lshl_b32 s47, s43, 2
    s_lshr_b32 s47, 0x7520, s47
    s_and_b32 s47, s47, 7
    s_mul_i32 s47, s47, 51200
    s_lshl_b32 s48, s43, 12
    s_add_u32 s3, s47, 0
    s_add_u32 m0, s48, 0
    s_nop 0
    buffer_load_dwordx4 v222, s[24:27], s3 offen lds
    s_add_u32 s3, s47, 10240
    s_add_u32 m0, s48, 1024
    s_nop 0
    buffer_load_dwordx4 v222, s[24:27], s3 offen lds
    s_add_u32 s3, s47, 25600
    s_add_u32 m0, s48, 2048
    s_nop 0
    buffer_load_dwordx4 v222, s[24:27], s3 offen lds
    s_add_u32 s3, s47, 35840
    s_add_u32 m0, s48, 3072
    s_nop 0
    buffer_load_dwordx4 v222, s[24:27], s3 offen lds
    s_add_u32 s3, s47, 409600
    s_add_u32 m0, s48, 20480
    s_nop 0
    buffer_load_dwordx4 v222, s[24:27], s3 offen lds
    s_add_u32 s3, s47, 419840
    s_add_u32 m0, s48, 21504
    s_nop 0
    buffer_load_dwordx4 v222, s[24:27], s3 offen lds
    s_add_u32 s3, s47, 435200
    s_add_u32 m0, s48, 22528
    s_nop 0
    buffer_load_dwordx4 v222, s[24:27], s3 offen lds
    s_add_u32 s3, s47, 445440
    s_add_u32 m0, s48, 23552
    s_nop 0
    buffer_load_dwordx4 v222, s[24:27], s3 offen lds
    s_lshl_b32 s48, s43, 10
    s_add_u32 s3, s47, 20480
    s_add_u32 m0, s48, 16384
    s_nop 0
    buffer_load_dwordx4 v5, s[24:27], s3 offen lds
    s_add_u32 s3, s47, 430080
    s_add_u32 m0, s48, 36864
    s_nop 0
    buffer_load_dwordx4 v5, s[24:27], s3 offen lds
    s_waitcnt vmcnt(10)
    s_barrier
    s_mov_b32 s33, 81920
    s_cmp_eq_u32 s43, 3
    s_cselect_b32 s3, 0, 163840
    buffer_store_dwordx4 v[224:227], v220, s[20:23], 0 offen sc1
    buffer_store_dwordx4 v[224:227], v220, s[20:23], s33 offen sc1
    buffer_store_dwordx4 v[224:227], v220, s[20:23], s3 offen sc1
    buffer_store_dwordx4 v[224:227], v221, s[20:23], 0 offen sc1
    v_mov_b32 v2, 158720
    v_mov_b32 v3, 1
    s_waitcnt vmcnt(0)
    s_mov_b64 exec, 1
    ds_add_u32 v2, v3 offset:28
    ds_add_u32 v2, v3 offset:32
    s_mov_b64 exec, -1
    s_lshl_b32 s47, s43, 2
    s_lshr_b32 s47, 0x6431, s47
    s_and_b32 s47, s47, 7
    s_mul_i32 s47, s47, 51200
    s_lshl_b32 s48, s43, 12
    s_add_u32 s3, s47, 0
    s_add_u32 m0, s48, 40960
    s_nop 0
    buffer_load_dwordx4 v222, s[24:27], s3 offen lds
    s_add_u32 s3, s47, 10240
    s_add_u32 m0, s48, 41984
    s_nop 0
    buffer_load_dwordx4 v222, s[24:27], s3 offen lds
    s_add_u32 s3, s47, 25600
    s_add_u32 m0, s48, 43008
    s_nop 0
    buffer_load_dwordx4 v222, s[24:27], s3 offen lds
    s_add_u32 s3, s47, 35840
    s_add_u32 m0, s48, 44032
    s_nop 0
    buffer_load_dwordx4 v222, s[24:27], s3 offen lds
    s_add_u32 s3, s47, 409600
    s_add_u32 m0, s48, 61440
    s_nop 0
    buffer_load_dwordx4 v222, s[24:27], s3 offen lds
    s_add_u32 s3, s47, 419840
    s_add_u32 m0, s48, 62464
    s_nop 0
    buffer_load_dwordx4 v222, s[24:27], s3 offen lds
    s_add_u32 s3, s47, 435200
    s_add_u32 m0, s48, 63488
    s_nop 0
    buffer_load_dwordx4 v222, s[24:27], s3 offen lds
    s_add_u32 s3, s47, 445440
    s_add_u32 m0, s48, 64512
    s_nop 0
    buffer_load_dwordx4 v222, s[24:27], s3 offen lds
    s_lshl_b32 s48, s43, 10
    s_add_u32 s3, s47, 20480
    s_add_u32 m0, s48, 57344
    s_nop 0
    buffer_load_dwordx4 v5, s[24:27], s3 offen lds
    s_add_u32 s3, s47, 430080
    s_add_u32 m0, s48, 77824
    s_nop 0
    buffer_load_dwordx4 v5, s[24:27], s3 offen lds
    s_branch K_P2_GM
K_NOLT:
    s_waitcnt vmcnt(0)
    s_barrier
    s_mov_b32 s33, 81920
    s_cmp_eq_u32 s43, 3
    s_cselect_b32 s3, 0, 163840
    buffer_store_dwordx4 v[224:227], v220, s[20:23], 0 offen sc1
    buffer_store_dwordx4 v[224:227], v220, s[20:23], s33 offen sc1
    buffer_store_dwordx4 v[224:227], v220, s[20:23], s3 offen sc1
    buffer_store_dwordx4 v[224:227], v221, s[20:23], 0 offen sc1
    v_mov_b32 v2, 158720
    v_mov_b32 v3, 1
    s_waitcnt vmcnt(0)
    s_mov_b64 exec, 1
    ds_add_u32 v2, v3 offset:28
    ds_add_u32 v2, v3 offset:32
    s_mov_b64 exec, -1
    s_branch K_END
K_CONS:
    v_and_b32 v1, 63, v0
    v_and_b32 v8, 15, v1
    v_lshrrev_b32 v9, 4, v1
    v_bfe_u32 v10, v1, 2, 2
    v_and_b32 v11, 3, v1
    s_bfe_u32 s54, s30, 0x10001
    s_and_b32 s55, s30, 1
    v_lshrrev_b32 v2, 1, v8
    v_xor_b32 v2, v2, v9
    v_lshlrev_b32 v2, 4, v2
    v_lshl_add_u32 v2, v8, 7, v2
    s_mul_i32 s3, s54, 12288
    v_add_u32 v39, s3, v2
    v_xor_b32 v40, 64, v39
    v_add_u32 v41, 81920, v39
    v_add_u32 v42, 81920, v40
    v_and_b32 v2, 1, v9
    v_lshl_or_b32 v2, v2, 2, v10
    s_mul_i32 s3, s55, 40
    v_lshl_add_u32 v2, v2, 5, s3
    v_lshl_add_u32 v3, v9, 3, v10
    v_lshlrev_b32 v3, 8, v3
    v_add_u32 v3, 24576, v3
    v_lshl_add_u32 v5, v11, 3, v2
    s_mul_i32 s33, s55, 805306368
    s_sub_u32 s33, 0xf870c020, s33
    v_add_u32 v4, 0, v5
    v_and_b32 v4, 255, v4
    v_add_u32 v43, v4, v3
    v_add_u32 v47, 81920, v43
    v_add_u32 v4, 160, v5
    v_and_b32 v4, 255, v4
    v_add_u32 v44, v4, v3
    v_add_u32 v48, 81920, v44
    v_add_u32 v4, 80, v5
    v_and_b32 v4, 255, v4
    v_add_u32 v45, v4, v3
    v_add_u32 v49, 81920, v45
    v_lshlrev_b32 v4, 3, v11
    v_bfe_u32 v4, s33, v4, 8
    v_add_u32 v4, v4, v2
    v_and_b32 v4, 255, v4
    v_add_u32 v46, v4, v3
    v_add_u32 v50, 81920, v46
    v_and_b32 v1, 63, v0
    v_mov_b32 v7, 0
    s_and_b32 s28, s2, 7
    s_lshr_b32 s29, s2, 3
    s_xor_b32 s30, s30, 4
    s_lshr_b32 s34, s29, 3
    s_lshl_b32 s34, s34, 2
    s_and_b32 s3, s29, 3
    s_add_u32 s34, s34, s3
    s_add_u32 s34, s34, 4
    s_bitcmp1_b32 s29, 2
    s_cselect_b32 s34, -1, s34
    s_cmp_lt_u32 s29, 8
    s_cselect_b32 s34, s29, s34
    s_lshl_b32 s40, s28, 1
    s_cmp_ge_u32 s34, 10
    s_addc_u32 s40, s40, 0
    s_sub_u32 s41, s34, 10
    s_cmp_ge_u32 s34, 10
    s_cselect_b32 s41, s41, s34
    s_mul_i32 s42, s28, 20
    s_add_u32 s42, s42, s34
    s_and_b32 s42, s42, 255
    s_lshl_b32 s42, s42, 9
    s_add_u32 s42, s42, 524288
    v_mov_b32 v3, 158736
    ds_write2_b32 v3, v7, v7 offset0:0 offset1:1
    ds_write2_b32 v3, v7, v7 offset0:2 offset1:3
    ds_write2_b32 v3, v7, v7 offset0:4 offset1:5
    ds_write2_b32 v3, v7, v7 offset0:6 offset1:7
    ds_write2_b32 v3, v7, v7 offset0:8 offset1:9
    ds_write2_b32 v3, v7, v7 offset0:10 offset1:11
    s_lshr_b32 s31, s28, 1
    s_lshl_b32 s31, s31, 5
    s_lshr_b32 s3, s29, 3
    s_mul_i32 s3, s3, 11
    s_add_u32 s31, s31, s3
    s_sub_u32 s31, s31, 11
    s_and_b32 s32, s28, 1
    s_lshl_b32 s32, s32, 3
    s_and_b32 s3, s29, 7
    s_lshl_b32 s3, s3, 2
    s_lshr_b32 s3, 0x64317520, s3
    s_and_b32 s3, s3, 7
    s_add_u32 s32, s32, s3
    s_and_b32 s35, s29, 3
    s_and_b32 s3, s29, 4
    s_lshl_b32 s3, s3, 1
    s_add_u32 s35, s35, s3
    s_and_b32 s3, s28, 1
    s_lshl_b32 s3, s3, 2
    s_add_u32 s35, s35, s3
    s_or_b32 s56, s31, s54
    v_mov_b32 v37, 0xf149f2ca
    v_lshlrev_b32 v2, 2, v9
    v_sub_u32 v2, v8, v2
    s_cmp_eq_u32 s56, 0
    s_cselect_b32 s3, 0xf149f2ca, 0
    v_subrev_u32 v3, 0, v2
    v_and_b32 v4, 0x80000001, v3
    v_cmp_eq_u32 vcc, 0, v4
    s_nop 1
    v_cndmask_b32 v16, v37, 0, vcc
    v_cmp_eq_u32 vcc, 0x80000000, v4
    s_nop 1
    v_cndmask_b32 v12, v37, 0, vcc
    v_add_f32 v20, s3, v12
    v_subrev_u32 v3, 1, v2
    v_and_b32 v4, 0x80000001, v3
    v_cmp_eq_u32 vcc, 0, v4
    s_nop 1
    v_cndmask_b32 v17, v37, 0, vcc
    v_cmp_eq_u32 vcc, 0x80000000, v4
    s_nop 1
    v_cndmask_b32 v13, v37, 0, vcc
    v_add_f32 v21, s3, v13
    v_subrev_u32 v3, 2, v2
    v_and_b32 v4, 0x80000001, v3
    v_cmp_eq_u32 vcc, 0, v4
    s_nop 1
    v_cndmask_b32 v18, v37, 0, vcc
    v_cmp_eq_u32 vcc, 0x80000000, v4
    s_nop 1
    v_cndmask_b32 v14, v37, 0, vcc
    v_add_f32 v22, s3, v14
    v_subrev_u32 v3, 3, v2
    v_and_b32 v4, 0x80000001, v3
    v_cmp_eq_u32 vcc, 0, v4
    s_nop 1
    v_cndmask_b32 v19, v37, 0, vcc
    v_cmp_eq_u32 vcc, 0x80000000, v4
    s_nop 1
    v_cndmask_b32 v15, v37, 0, vcc
    v_add_f32 v23, s3, v15
    v_mov_b32 v3, 0x0c0c0c0c
    v_mov_b32 v4, 0xc0c0100
    v_cmp_eq_u32 vcc, 0, v12
    v_mov_b32 v5, 0x1000c0c
    s_nop 0
    v_cndmask_b32 v3, v3, v4, vcc
    v_cmp_eq_u32 vcc, 0, v13
    s_nop 1
    v_cndmask_b32 v24, v3, v5, vcc
    v_mov_b32 v3, 0x0c0c0c0c
    v_mov_b32 v4, 0xc0c0302
    v_cmp_eq_u32 vcc, 0, v14
    v_mov_b32 v5, 0x3020c0c
    s_nop 0
    v_cndmask_b32 v3, v3, v4, vcc
    v_cmp_eq_u32 vcc, 0, v15
    s_nop 1
    v_cndmask_b32 v25, v3, v5, vcc
    v_mov_b32 v3, 0x0c0c0c0c
    v_mov_b32 v4, 0xc0c0100
    v_cmp_eq_u32 vcc, 0, v16
    v_mov_b32 v5, 0x1000c0c
    s_nop 0
    v_cndmask_b32 v3, v3, v4, vcc
    v_cmp_eq_u32 vcc, 0, v17
    s_nop 1
    v_cndmask_b32 v26, v3, v5, vcc
    v_mov_b32 v3, 0x0c0c0c0c
    v_mov_b32 v4, 0xc0c0302
    v_cmp_eq_u32 vcc, 0, v18
    v_mov_b32 v5, 0x3020c0c
    s_nop 0
    v_cndmask_b32 v3, v3, v4, vcc
    v_cmp_eq_u32 vcc, 0, v19
    s_nop 1
    v_cndmask_b32 v27, v3, v5, vcc
    s_mul_i32 s3, s55, 1664
    s_mul_i32 s33, s54, 768
    s_add_u32 s3, s3, s33
    s_add_u32 s3, s3, 125952
    v_lshl_add_u32 v2, v9, 2, v10
    v_lshl_add_u32 v33, v2, 3, s3
    v_lshl_add_u32 v2, v8, 3, s3
    v_lshlrev_b32 v3, 3, v1
    v_add_u32 v3, 129280, v3
    v_cmp_eq_u32 vcc, 2, v9
    s_mul_i32 s3, s55, 1536
    s_add_u32 s3, s3, 122880
    v_cndmask_b32 v32, v3, v2, vcc
    v_lshl_add_u32 v34, v1, 3, s3
    s_mul_i32 s3, s54, 1536
    s_add_u32 s3, s3, 131328
    s_lshl3_add_u32 s33, s55, s3
    v_lshl_add_u32 v35, v8, 4, s33
    v_cmp_eq_u32 vcc, 0, v9
    s_nop 1
    v_cndmask_b32 v35, v3, v35, vcc
    s_mul_i32 s33, s55, 768
    s_add_u32 s3, s3, s33
    v_lshl_add_u32 v36, v1, 4, s3
    v_mov_b32 v38, 158720
    s_waitcnt lgkmcnt(0)
    s_add_u32 s20, s6, 0x100000
    s_addc_u32 s21, s7, 0
    s_mov_b32 s22, 0x280000
    s_mov_b32 s23, 0x20000
    s_lshr_b32 s53, s35, 2
    s_add_u32 s58, s53, s35
    s_lshl_b32 s58, s58, 12
    s_mul_i32 s59, s53, 19456
    s_lshl_b32 s53, s35, 8
    s_add_u32 s59, s59, s53
    s_add_u32 s59, s59, 16384
    s_lshr_b32 s53, s31, 5
    s_add_u32 s53, s53, 1
    s_mul_i32 s22, s53, 655360
    s_mov_b32 s53, s31
    s_mul_i32 s3, s54, 6
    s_add_u32 s53, s53, s3
    s_add_u32 s53, s53, 3
    s_lshl_b32 s3, s55, 9
    s_add_u32 s58, s58, s3
    v_and_b32 v4, 1, v9
    v_lshrrev_b32 v5, 1, v9
    v_add_u32 v3, s53, v4
    v_lshrrev_b32 v2, 2, v3
    v_mul_u32_u24 v2, 76, v2
    v_add_lshl_u32 v2, v2, v3, 10
    v_lshl_add_u32 v2, v8, 4, v2
    v_add_u32 v30, s58, v2
    v_lshl_add_u32 v30, v5, 8, v30
    v_subrev_u32 v3, 2, v3
    v_lshrrev_b32 v2, 2, v3
    v_mul_u32_u24 v2, 76, v2
    v_add_lshl_u32 v2, v2, v3, 10
    v_lshl_add_u32 v2, v8, 4, v2
    v_add_u32 v29, s58, v2
    v_lshl_add_u32 v29, v5, 8, v29
    v_or_b32 v4, s54, v4
    v_cmp_eq_u32 vcc, 0, v4
    v_mov_b32 v5, 0x10000000
    v_subrev_u32 v28, 81920, v30
    v_cndmask_b32 v28, v28, v5, vcc
    s_mul_i32 s3, s55, 3
    s_add_u32 s53, s53, s3
    v_add_u32 v3, s53, v9
    v_lshrrev_b32 v2, 2, v3
    v_mul_u32_u24 v2, 76, v2
    v_add_lshl_u32 v2, v2, v3, 10
    v_lshl_add_u32 v2, v8, 4, v2
    v_add_u32 v31, s59, v2
    v_subrev_u32 v31, 81920, v31
    v_or_b32 v4, s30, v9
    v_cmp_eq_u32 vcc, 0, v4
    s_nop 1
    v_cndmask_b32 v31, v31, v5, vcc
    v_cmp_eq_u32 vcc, 3, v9
    s_nop 1
    v_cndmask_b32 v31, v31, v5, vcc
    s_lshr_b32 s3, s31, 3
    s_mul_i32 s3, s3, 5120
    s_add_u32 s3, s3, 524288
    s_and_b32 s33, s31, 31
    s_cselect_b32 s33, 4, 0
    v_mov_b32 v2, s33
    v_cmp_gt_u32 vcc, 10, v1
    v_lshl_add_u32 v37, v1, 9, s3
    s_mov_b32 s37, 0xfffff
    v_cndmask_b32 v2, 0, v2, vcc
    v_add_u32 v37, v37, v2
    s_lshr_b32 s36, s35, 2
    s_add_u32 s36, s36, s35
    s_lshl_b32 s36, 1, s36
    s_cmp_eq_u32 s30, 0
    s_cselect_b32 s36, s36, 0
    s_mov_b32 s58, 0x3fb8aa3b
    s_mov_b32 s59, s58
    s_mov_b32 s60, 0x3e64f92e
    s_mov_b32 s61, s60
    s_cmp_eq_u32 s30, 0
    s_cbranch_scc1 K_CHM0
    s_cmp_eq_u32 s30, 1
    s_cbranch_scc1 K_CHM1
    s_cmp_eq_u32 s30, 2
    s_cbranch_scc1 K_CHM2
    s_branch K_CHM3
K_WRET_M:
    s_setprio 2
    s_barrier
K_L0:
    ds_read_b64_tr_b16 v[196:197], v47 offset:0
    ds_read_b64_tr_b16 v[198:199], v47 offset:1024
    ds_read_b128 v[148:151], v41 offset:0
    ds_read_b64_tr_b16 v[200:201], v48 offset:0
    ds_read_b64_tr_b16 v[202:203], v48 offset:1024
    ds_read_b128 v[152:155], v41 offset:2048
    ds_read_b64_tr_b16 v[204:205], v49 offset:0
    ds_read_b64_tr_b16 v[206:207], v49 offset:1024
    ds_read_b128 v[156:159], v41 offset:4096
    ds_read_b64_tr_b16 v[208:209], v50 offset:0
    ds_read_b64_tr_b16 v[210:211], v50 offset:1024
    ds_read_b128 v[160:163], v41 offset:6144
    ds_read_b128 v[164:167], v41 offset:8192
    ds_read_b128 v[168:171], v41 offset:10240
    s_waitcnt lgkmcnt(0)
    v_mfma_f32_16x16x32_bf16 v[52:55], v[196:199], v[148:151], 0
    ds_read_b64_tr_b16 v[212:213], v47 offset:8192
    v_mfma_f32_16x16x32_bf16 v[56:59], v[200:203], v[148:151], 0
    ds_read_b64_tr_b16 v[214:215], v47 offset:9216
    v_mfma_f32_16x16x32_bf16 v[60:63], v[148:151], v[204:207], 0
    ds_read_b128 v[172:175], v42 offset:0
    v_mfma_f32_16x16x32_bf16 v[64:67], v[208:211], v[148:151], 0
    ds_read_b64_tr_b16 v[216:217], v48 offset:8192
    v_mfma_f32_16x16x32_bf16 v[80:83], v[208:211], v[152:155], 0
    ds_read_b64_tr_b16 v[218:219], v48 offset:9216
    v_mfma_f32_16x16x32_bf16 v[76:79], v[152:155], v[204:207], 0
    ds_read_b128 v[176:179], v42 offset:2048
    v_mfma_f32_16x16x32_bf16 v[72:75], v[200:203], v[152:155], 0
    ds_read_b64_tr_b16 v[220:221], v49 offset:8192
    v_mfma_f32_16x16x32_bf16 v[68:71], v[196:199], v[152:155], 0
    ds_read_b64_tr_b16 v[222:223], v49 offset:9216
    v_mfma_f32_16x16x32_bf16 v[84:87], v[196:199], v[156:159], 0
    ds_read_b128 v[180:183], v42 offset:4096
    v_mfma_f32_16x16x32_bf16 v[88:91], v[200:203], v[156:159], 0
    ds_read_b64_tr_b16 v[224:225], v50 offset:8192
    v_mfma_f32_16x16x32_bf16 v[92:95], v[156:159], v[204:207], 0
    ds_read_b64_tr_b16 v[226:227], v50 offset:9216
    v_mfma_f32_16x16x32_bf16 v[96:99], v[208:211], v[156:159], 0
    ds_read_b128 v[184:187], v42 offset:6144
    v_mfma_f32_16x16x32_bf16 v[112:115], v[208:211], v[160:163], 0
    ds_read_b128 v[188:191], v42 offset:8192
    v_mfma_f32_16x16x32_bf16 v[108:111], v[160:163], v[204:207], 0
    ds_read_b128 v[192:195], v42 offset:10240
    v_mfma_f32_16x16x32_bf16 v[104:107], v[200:203], v[160:163], 0
    v_mfma_f32_16x16x32_bf16 v[100:103], v[196:199], v[160:163], 0
    v_mfma_f32_16x16x32_bf16 v[116:119], v[196:199], v[164:167], 0
    v_mfma_f32_16x16x32_bf16 v[120:123], v[200:203], v[164:167], 0
    v_mfma_f32_16x16x32_bf16 v[124:127], v[164:167], v[204:207], 0
    v_mfma_f32_16x16x32_bf16 v[128:131], v[208:211], v[164:167], 0
    v_mfma_f32_16x16x32_bf16 v[144:147], v[208:211], v[168:171], 0
    v_mfma_f32_16x16x32_bf16 v[140:143], v[168:171], v[204:207], 0
    v_mfma_f32_16x16x32_bf16 v[136:139], v[200:203], v[168:171], 0
    v_mfma_f32_16x16x32_bf16 v[132:135], v[196:199], v[168:171], 0
    s_waitcnt lgkmcnt(0)
    s_barrier
    v_mfma_f32_16x16x32_bf16 v[52:55], v[212:215], v[172:175], v[52:55]
    ds_read_b64_tr_b16 v[196:197], v43 offset:0
    v_mfma_f32_16x16x32_bf16 v[56:59], v[216:219], v[172:175], v[56:59]
    ds_read_b64_tr_b16 v[198:199], v43 offset:1024
    v_mfma_f32_16x16x32_bf16 v[60:63], v[172:175], v[220:223], v[60:63]
    ds_read_b128 v[148:151], v39 offset:0
    v_mfma_f32_16x16x32_bf16 v[64:67], v[224:227], v[172:175], v[64:67]
    ds_read_b64_tr_b16 v[200:201], v44 offset:0
    v_mfma_f32_16x16x32_bf16 v[80:83], v[224:227], v[176:179], v[80:83]
    ds_read_b64_tr_b16 v[202:203], v44 offset:1024
    v_mfma_f32_16x16x32_bf16 v[76:79], v[176:179], v[220:223], v[76:79]
    ds_read_b128 v[152:155], v39 offset:2048
    v_mfma_f32_16x16x32_bf16 v[72:75], v[216:219], v[176:179], v[72:75]
    ds_read_b64_tr_b16 v[204:205], v45 offset:0
    v_mfma_f32_16x16x32_bf16 v[68:71], v[212:215], v[176:179], v[68:71]
    ds_read_b64_tr_b16 v[206:207], v45 offset:1024
    v_mfma_f32_16x16x32_bf16 v[84:87], v[212:215], v[180:183], v[84:87]
    ds_read_b128 v[156:159], v39 offset:4096
    v_mfma_f32_16x16x32_bf16 v[88:91], v[216:219], v[180:183], v[88:91]
    ds_read_b64_tr_b16 v[208:209], v46 offset:0
    v_mfma_f32_16x16x32_bf16 v[92:95], v[180:183], v[220:223], v[92:95]
    ds_read_b64_tr_b16 v[210:211], v46 offset:1024
    v_mfma_f32_16x16x32_bf16 v[96:99], v[224:227], v[180:183], v[96:99]
    ds_read_b128 v[160:163], v39 offset:6144
    v_mfma_f32_16x16x32_bf16 v[112:115], v[224:227], v[184:187], v[112:115]
    ds_read_b128 v[164:167], v39 offset:8192
    v_mfma_f32_16x16x32_bf16 v[108:111], v[184:187], v[220:223], v[108:111]
    ds_read_b128 v[168:171], v39 offset:10240
    v_mfma_f32_16x16x32_bf16 v[104:107], v[216:219], v[184:187], v[104:107]
    v_mfma_f32_16x16x32_bf16 v[100:103], v[212:215], v[184:187], v[100:103]
    v_mfma_f32_16x16x32_bf16 v[116:119], v[212:215], v[188:191], v[116:119]
    v_mfma_f32_16x16x32_bf16 v[120:123], v[216:219], v[188:191], v[120:123]
    v_mfma_f32_16x16x32_bf16 v[124:127], v[188:191], v[220:223], v[124:127]
    v_mfma_f32_16x16x32_bf16 v[128:131], v[224:227], v[188:191], v[128:131]
    v_mfma_f32_16x16x32_bf16 v[144:147], v[224:227], v[192:195], v[144:147]
    v_mfma_f32_16x16x32_bf16 v[140:143], v[192:195], v[220:223], v[140:143]
    v_mfma_f32_16x16x32_bf16 v[136:139], v[216:219], v[192:195], v[136:139]
    v_mfma_f32_16x16x32_bf16 v[132:135], v[212:215], v[192:195], v[132:135]
    s_waitcnt lgkmcnt(0)
    v_mfma_f32_16x16x32_bf16 v[52:55], v[196:199], v[148:151], v[52:55]
    ds_read_b64_tr_b16 v[212:213], v43 offset:8192
    v_mfma_f32_16x16x32_bf16 v[56:59], v[200:203], v[148:151], v[56:59]
    ds_read_b64_tr_b16 v[214:215], v43 offset:9216
    v_mfma_f32_16x16x32_bf16 v[60:63], v[148:151], v[204:207], v[60:63]
    ds_read_b128 v[172:175], v40 offset:0
    v_mfma_f32_16x16x32_bf16 v[64:67], v[208:211], v[148:151], v[64:67]
    ds_read_b64_tr_b16 v[216:217], v44 offset:8192
    v_mfma_f32_16x16x32_bf16 v[80:83], v[208:211], v[152:155], v[80:83]
    ds_read_b64_tr_b16 v[218:219], v44 offset:9216
    v_mfma_f32_16x16x32_bf16 v[76:79], v[152:155], v[204:207], v[76:79]
    ds_read_b128 v[176:179], v40 offset:2048
    v_mfma_f32_16x16x32_bf16 v[72:75], v[200:203], v[152:155], v[72:75]
    ds_read_b64_tr_b16 v[220:221], v45 offset:8192
    v_mfma_f32_16x16x32_bf16 v[68:71], v[196:199], v[152:155], v[68:71]
    ds_read_b64_tr_b16 v[222:223], v45 offset:9216
    v_mfma_f32_16x16x32_bf16 v[84:87], v[196:199], v[156:159], v[84:87]
    ds_read_b128 v[180:183], v40 offset:4096
    v_mfma_f32_16x16x32_bf16 v[88:91], v[200:203], v[156:159], v[88:91]
    ds_read_b64_tr_b16 v[224:225], v46 offset:8192
    v_mfma_f32_16x16x32_bf16 v[92:95], v[156:159], v[204:207], v[92:95]
    ds_read_b64_tr_b16 v[226:227], v46 offset:9216
    v_mfma_f32_16x16x32_bf16 v[96:99], v[208:211], v[156:159], v[96:99]
    ds_read_b128 v[184:187], v40 offset:6144
    v_mfma_f32_16x16x32_bf16 v[112:115], v[208:211], v[160:163], v[112:115]
    ds_read_b128 v[188:191], v40 offset:8192
    v_mfma_f32_16x16x32_bf16 v[108:111], v[160:163], v[204:207], v[108:111]
    ds_read_b128 v[192:195], v40 offset:10240
    s_branch K_PG1
.p2align 12
K_CHM1:
K_STM1:
    s_branch K_WRET_M
    s_nop 0
K_PG1:
    v_mfma_f32_16x16x32_bf16 v[104:107], v[200:203], v[160:163], v[104:107]
    v_mfma_f32_16x16x32_bf16 v[100:103], v[196:199], v[160:163], v[100:103]
    v_mfma_f32_16x16x32_bf16 v[116:119], v[196:199], v[164:167], v[116:119]
    v_mfma_f32_16x16x32_bf16 v[120:123], v[200:203], v[164:167], v[120:123]
    v_mfma_f32_16x16x32_bf16 v[124:127], v[164:167], v[204:207], v[124:127]
    v_mfma_f32_16x16x32_bf16 v[128:131], v[208:211], v[164:167], v[128:131]
    v_mfma_f32_16x16x32_bf16 v[144:147], v[208:211], v[168:171], v[144:147]
    v_mfma_f32_16x16x32_bf16 v[140:143], v[168:171], v[204:207], v[140:143]
    v_mfma_f32_16x16x32_bf16 v[136:139], v[200:203], v[168:171], v[136:139]
    v_mfma_f32_16x16x32_bf16 v[132:135], v[196:199], v[168:171], v[132:135]
    s_waitcnt lgkmcnt(0)
    s_barrier
    v_mfma_f32_16x16x32_bf16 v[52:55], v[212:215], v[172:175], v[52:55]
    ds_read_b64_tr_b16 v[196:197], v43 offset:40960
    v_mfma_f32_16x16x32_bf16 v[56:59], v[216:219], v[172:175], v[56:59]
    ds_read_b64_tr_b16 v[198:199], v43 offset:41984
    v_mfma_f32_16x16x32_bf16 v[60:63], v[172:175], v[220:223], v[60:63]
    ds_read_b128 v[148:151], v39 offset:40960
    v_mfma_f32_16x16x32_bf16 v[64:67], v[224:227], v[172:175], v[64:67]
    ds_read_b64_tr_b16 v[200:201], v44 offset:40960
    v_mfma_f32_16x16x32_bf16 v[80:83], v[224:227], v[176:179], v[80:83]
    ds_read_b64_tr_b16 v[202:203], v44 offset:41984
    v_mfma_f32_16x16x32_bf16 v[76:79], v[176:179], v[220:223], v[76:79]
    ds_read_b128 v[152:155], v39 offset:43008
    v_mfma_f32_16x16x32_bf16 v[72:75], v[216:219], v[176:179], v[72:75]
    ds_read_b64_tr_b16 v[204:205], v45 offset:40960
    v_mfma_f32_16x16x32_bf16 v[68:71], v[212:215], v[176:179], v[68:71]
    ds_read_b64_tr_b16 v[206:207], v45 offset:41984
    v_mfma_f32_16x16x32_bf16 v[84:87], v[212:215], v[180:183], v[84:87]
    ds_read_b128 v[156:159], v39 offset:45056
    v_mfma_f32_16x16x32_bf16 v[88:91], v[216:219], v[180:183], v[88:91]
    ds_read_b64_tr_b16 v[208:209], v46 offset:40960
    v_mfma_f32_16x16x32_bf16 v[92:95], v[180:183], v[220:223], v[92:95]
    ds_read_b64_tr_b16 v[210:211], v46 offset:41984
    v_mfma_f32_16x16x32_bf16 v[96:99], v[224:227], v[180:183], v[96:99]
    ds_read_b128 v[160:163], v39 offset:47104
    v_mfma_f32_16x16x32_bf16 v[112:115], v[224:227], v[184:187], v[112:115]
    ds_read_b128 v[164:167], v39 offset:49152
    v_mfma_f32_16x16x32_bf16 v[108:111], v[184:187], v[220:223], v[108:111]
    ds_read_b128 v[168:171], v39 offset:51200
    v_mfma_f32_16x16x32_bf16 v[104:107], v[216:219], v[184:187], v[104:107]
    v_mfma_f32_16x16x32_bf16 v[100:103], v[212:215], v[184:187], v[100:103]
    v_mfma_f32_16x16x32_bf16 v[116:119], v[212:215], v[188:191], v[116:119]
    v_mfma_f32_16x16x32_bf16 v[120:123], v[216:219], v[188:191], v[120:123]
    v_mfma_f32_16x16x32_bf16 v[124:127], v[188:191], v[220:223], v[124:127]
    v_mfma_f32_16x16x32_bf16 v[128:131], v[224:227], v[188:191], v[128:131]
    v_mfma_f32_16x16x32_bf16 v[144:147], v[224:227], v[192:195], v[144:147]
    v_mfma_f32_16x16x32_bf16 v[140:143], v[192:195], v[220:223], v[140:143]
    v_mfma_f32_16x16x32_bf16 v[136:139], v[216:219], v[192:195], v[136:139]
    v_mfma_f32_16x16x32_bf16 v[132:135], v[212:215], v[192:195], v[132:135]
    s_waitcnt lgkmcnt(0)
    v_mfma_f32_16x16x32_bf16 v[52:55], v[196:199], v[148:151], v[52:55]
    ds_read_b64_tr_b16 v[212:213], v43 offset:49152
    v_mfma_f32_16x16x32_bf16 v[56:59], v[200:203], v[148:151], v[56:59]
    ds_read_b64_tr_b16 v[214:215], v43 offset:50176
    v_mfma_f32_16x16x32_bf16 v[60:63], v[148:151], v[204:207], v[60:63]
    ds_read_b128 v[172:175], v40 offset:40960
    v_mfma_f32_16x16x32_bf16 v[64:67], v[208:211], v[148:151], v[64:67]
    ds_read_b64_tr_b16 v[216:217], v44 offset:49152
    v_mfma_f32_16x16x32_bf16 v[80:83], v[208:211], v[152:155], v[80:83]
    ds_read_b64_tr_b16 v[218:219], v44 offset:50176
    v_mfma_f32_16x16x32_bf16 v[76:79], v[152:155], v[204:207], v[76:79]
    ds_read_b128 v[176:179], v40 offset:43008
    v_mfma_f32_16x16x32_bf16 v[72:75], v[200:203], v[152:155], v[72:75]
    ds_read_b64_tr_b16 v[220:221], v45 offset:49152
    v_mfma_f32_16x16x32_bf16 v[68:71], v[196:199], v[152:155], v[68:71]
    ds_read_b64_tr_b16 v[222:223], v45 offset:50176
    v_mfma_f32_16x16x32_bf16 v[84:87], v[196:199], v[156:159], v[84:87]
    ds_read_b128 v[180:183], v40 offset:45056
    v_mfma_f32_16x16x32_bf16 v[88:91], v[200:203], v[156:159], v[88:91]
    ds_read_b64_tr_b16 v[224:225], v46 offset:49152
    v_mfma_f32_16x16x32_bf16 v[92:95], v[156:159], v[204:207], v[92:95]
    ds_read_b64_tr_b16 v[226:227], v46 offset:50176
    v_mfma_f32_16x16x32_bf16 v[96:99], v[208:211], v[156:159], v[96:99]
    ds_read_b128 v[184:187], v40 offset:47104
    v_mfma_f32_16x16x32_bf16 v[112:115], v[208:211], v[160:163], v[112:115]
    ds_read_b128 v[188:191], v40 offset:49152
    v_mfma_f32_16x16x32_bf16 v[108:111], v[160:163], v[204:207], v[108:111]
    ds_read_b128 v[192:195], v40 offset:51200
    v_mfma_f32_16x16x32_bf16 v[104:107], v[200:203], v[160:163], v[104:107]
    v_mfma_f32_16x16x32_bf16 v[100:103], v[196:199], v[160:163], v[100:103]
    v_mfma_f32_16x16x32_bf16 v[116:119], v[196:199], v[164:167], v[116:119]
    v_mfma_f32_16x16x32_bf16 v[120:123], v[200:203], v[164:167], v[120:123]
    v_mfma_f32_16x16x32_bf16 v[124:127], v[164:167], v[204:207], v[124:127]
    v_mfma_f32_16x16x32_bf16 v[128:131], v[208:211], v[164:167], v[128:131]
    v_mfma_f32_16x16x32_bf16 v[144:147], v[208:211], v[168:171], v[144:147]
    v_mfma_f32_16x16x32_bf16 v[140:143], v[168:171], v[204:207], v[140:143]
    v_mfma_f32_16x16x32_bf16 v[136:139], v[200:203], v[168:171], v[136:139]
    v_mfma_f32_16x16x32_bf16 v[132:135], v[196:199], v[168:171], v[132:135]
    s_waitcnt lgkmcnt(0)
    s_barrier
    v_mfma_f32_16x16x32_bf16 v[52:55], v[212:215], v[172:175], v[52:55]
    ds_read_b64_tr_b16 v[196:197], v47 offset:0
    v_mfma_f32_16x16x32_bf16 v[56:59], v[216:219], v[172:175], v[56:59]
    ds_read_b64_tr_b16 v[198:199], v47 offset:1024
    v_mfma_f32_16x16x32_bf16 v[60:63], v[172:175], v[220:223], v[60:63]
    ds_read_b128 v[148:151], v41 offset:0
    v_mfma_f32_16x16x32_bf16 v[64:67], v[224:227], v[172:175], v[64:67]
    ds_read_b64_tr_b16 v[200:201], v48 offset:0
    v_mfma_f32_16x16x32_bf16 v[80:83], v[224:227], v[176:179], v[80:83]
    ds_read_b64_tr_b16 v[202:203], v48 offset:1024
    v_mfma_f32_16x16x32_bf16 v[76:79], v[176:179], v[220:223], v[76:79]
    ds_read_b128 v[152:155], v41 offset:2048
    v_mfma_f32_16x16x32_bf16 v[72:75], v[216:219], v[176:179], v[72:75]
    ds_read_b64_tr_b16 v[204:205], v49 offset:0
    v_mfma_f32_16x16x32_bf16 v[68:71], v[212:215], v[176:179], v[68:71]
    ds_read_b64_tr_b16 v[206:207], v49 offset:1024
    v_mfma_f32_16x16x32_bf16 v[84:87], v[212:215], v[180:183], v[84:87]
    ds_read_b128 v[156:159], v41 offset:4096
    v_mfma_f32_16x16x32_bf16 v[88:91], v[216:219], v[180:183], v[88:91]
    ds_read_b64_tr_b16 v[208:209], v50 offset:0
    v_mfma_f32_16x16x32_bf16 v[92:95], v[180:183], v[220:223], v[92:95]
    ds_read_b64_tr_b16 v[210:211], v50 offset:1024
    v_mfma_f32_16x16x32_bf16 v[96:99], v[224:227], v[180:183], v[96:99]
    ds_read_b128 v[160:163], v41 offset:6144
    v_mfma_f32_16x16x32_bf16 v[112:115], v[224:227], v[184:187], v[112:115]
    ds_read_b128 v[164:167], v41 offset:8192
    v_mfma_f32_16x16x32_bf16 v[108:111], v[184:187], v[220:223], v[108:111]
    ds_read_b128 v[168:171], v41 offset:10240
    v_mfma_f32_16x16x32_bf16 v[104:107], v[216:219], v[184:187], v[104:107]
    v_mfma_f32_16x16x32_bf16 v[100:103], v[212:215], v[184:187], v[100:103]
    v_mfma_f32_16x16x32_bf16 v[116:119], v[212:215], v[188:191], v[116:119]
    v_mfma_f32_16x16x32_bf16 v[120:123], v[216:219], v[188:191], v[120:123]
    v_mfma_f32_16x16x32_bf16 v[124:127], v[188:191], v[220:223], v[124:127]
    v_mfma_f32_16x16x32_bf16 v[128:131], v[224:227], v[188:191], v[128:131]
    v_mfma_f32_16x16x32_bf16 v[144:147], v[224:227], v[192:195], v[144:147]
    v_mfma_f32_16x16x32_bf16 v[140:143], v[192:195], v[220:223], v[140:143]
    v_mfma_f32_16x16x32_bf16 v[136:139], v[216:219], v[192:195], v[136:139]
    v_mfma_f32_16x16x32_bf16 v[132:135], v[212:215], v[192:195], v[132:135]
    s_waitcnt lgkmcnt(0)
    v_mfma_f32_16x16x32_bf16 v[52:55], v[196:199], v[148:151], v[52:55]
    ds_read_b64_tr_b16 v[212:213], v47 offset:8192
    v_mfma_f32_16x16x32_bf16 v[56:59], v[200:203], v[148:151], v[56:59]
    ds_read_b64_tr_b16 v[214:215], v47 offset:9216
    v_mfma_f32_16x16x32_bf16 v[60:63], v[148:151], v[204:207], v[60:63]
    ds_read_b128 v[172:175], v42 offset:0
    v_mfma_f32_16x16x32_bf16 v[64:67], v[208:211], v[148:151], v[64:67]
    ds_read_b64_tr_b16 v[216:217], v48 offset:8192
    v_mfma_f32_16x16x32_bf16 v[80:83], v[208:211], v[152:155], v[80:83]
    ds_read_b64_tr_b16 v[218:219], v48 offset:9216
    v_mfma_f32_16x16x32_bf16 v[76:79], v[152:155], v[204:207], v[76:79]
    ds_read_b128 v[176:179], v42 offset:2048
    v_mfma_f32_16x16x32_bf16 v[72:75], v[200:203], v[152:155], v[72:75]
    ds_read_b64_tr_b16 v[220:221], v49 offset:8192
    v_mfma_f32_16x16x32_bf16 v[68:71], v[196:199], v[152:155], v[68:71]
    ds_read_b64_tr_b16 v[222:223], v49 offset:9216
    v_mfma_f32_16x16x32_bf16 v[84:87], v[196:199], v[156:159], v[84:87]
    ds_read_b128 v[180:183], v42 offset:4096
    v_mfma_f32_16x16x32_bf16 v[88:91], v[200:203], v[156:159], v[88:91]
    ds_read_b64_tr_b16 v[224:225], v50 offset:8192
    v_mfma_f32_16x16x32_bf16 v[92:95], v[156:159], v[204:207], v[92:95]
    ds_read_b64_tr_b16 v[226:227], v50 offset:9216
    v_mfma_f32_16x16x32_bf16 v[96:99], v[208:211], v[156:159], v[96:99]
    ds_read_b128 v[184:187], v42 offset:6144
    v_mfma_f32_16x16x32_bf16 v[112:115], v[208:211], v[160:163], v[112:115]
    ds_read_b128 v[188:191], v42 offset:8192
    v_mfma_f32_16x16x32_bf16 v[108:111], v[160:163], v[204:207], v[108:111]
    ds_read_b128 v[192:195], v42 offset:10240
    v_mfma_f32_16x16x32_bf16 v[104:107], v[200:203], v[160:163], v[104:107]
    v_mfma_f32_16x16x32_bf16 v[100:103], v[196:199], v[160:163], v[100:103]
    v_mfma_f32_16x16x32_bf16 v[116:119], v[196:199], v[164:167], v[116:119]
    v_mfma_f32_16x16x32_bf16 v[120:123], v[200:203], v[164:167], v[120:123]
    v_mfma_f32_16x16x32_bf16 v[124:127], v[164:167], v[204:207], v[124:127]
    v_mfma_f32_16x16x32_bf16 v[128:131], v[208:211], v[164:167], v[128:131]
    v_mfma_f32_16x16x32_bf16 v[144:147], v[208:211], v[168:171], v[144:147]
    v_mfma_f32_16x16x32_bf16 v[140:143], v[168:171], v[204:207], v[140:143]
    v_mfma_f32_16x16x32_bf16 v[136:139], v[200:203], v[168:171], v[136:139]
    v_mfma_f32_16x16x32_bf16 v[132:135], v[196:199], v[168:171], v[132:135]
    s_waitcnt lgkmcnt(0)
    s_barrier
    v_mfma_f32_16x16x32_bf16 v[52:55], v[212:215], v[172:175], v[52:55]
    ds_read_b64_tr_b16 v[196:197], v43 offset:0
    v_mfma_f32_16x16x32_bf16 v[56:59], v[216:219], v[172:175], v[56:59]
    ds_read_b64_tr_b16 v[198:199], v43 offset:1024
    v_mfma_f32_16x16x32_bf16 v[60:63], v[172:175], v[220:223], v[60:63]
    ds_read_b128 v[148:151], v39 offset:0
    v_mfma_f32_16x16x32_bf16 v[64:67], v[224:227], v[172:175], v[64:67]
    ds_read_b64_tr_b16 v[200:201], v44 offset:0
    v_mfma_f32_16x16x32_bf16 v[80:83], v[224:227], v[176:179], v[80:83]
    ds_read_b64_tr_b16 v[202:203], v44 offset:1024
    v_mfma_f32_16x16x32_bf16 v[76:79], v[176:179], v[220:223], v[76:79]
    ds_read_b128 v[152:155], v39 offset:2048
    v_mfma_f32_16x16x32_bf16 v[72:75], v[216:219], v[176:179], v[72:75]
    ds_read_b64_tr_b16 v[204:205], v45 offset:0
    v_mfma_f32_16x16x32_bf16 v[68:71], v[212:215], v[176:179], v[68:71]
    ds_read_b64_tr_b16 v[206:207], v45 offset:1024
    v_mfma_f32_16x16x32_bf16 v[84:87], v[212:215], v[180:183], v[84:87]
    ds_read_b128 v[156:159], v39 offset:4096
    v_mfma_f32_16x16x32_bf16 v[88:91], v[216:219], v[180:183], v[88:91]
    ds_read_b64_tr_b16 v[208:209], v46 offset:0
    v_mfma_f32_16x16x32_bf16 v[92:95], v[180:183], v[220:223], v[92:95]
    ds_read_b64_tr_b16 v[210:211], v46 offset:1024
    v_mfma_f32_16x16x32_bf16 v[96:99], v[224:227], v[180:183], v[96:99]
    ds_read_b128 v[160:163], v39 offset:6144
    v_mfma_f32_16x16x32_bf16 v[112:115], v[224:227], v[184:187], v[112:115]
    ds_read_b128 v[164:167], v39 offset:8192
    v_mfma_f32_16x16x32_bf16 v[108:111], v[184:187], v[220:223], v[108:111]
    ds_read_b128 v[168:171], v39 offset:10240
    v_mfma_f32_16x16x32_bf16 v[104:107], v[216:219], v[184:187], v[104:107]
    v_mfma_f32_16x16x32_bf16 v[100:103], v[212:215], v[184:187], v[100:103]
    v_mfma_f32_16x16x32_bf16 v[116:119], v[212:215], v[188:191], v[116:119]
    v_mfma_f32_16x16x32_bf16 v[120:123], v[216:219], v[188:191], v[120:123]
    v_mfma_f32_16x16x32_bf16 v[124:127], v[188:191], v[220:223], v[124:127]
    v_mfma_f32_16x16x32_bf16 v[128:131], v[224:227], v[188:191], v[128:131]
    v_mfma_f32_16x16x32_bf16 v[144:147], v[224:227], v[192:195], v[144:147]
    v_mfma_f32_16x16x32_bf16 v[140:143], v[192:195], v[220:223], v[140:143]
    v_mfma_f32_16x16x32_bf16 v[136:139], v[216:219], v[192:195], v[136:139]
    v_mfma_f32_16x16x32_bf16 v[132:135], v[212:215], v[192:195], v[132:135]
    s_waitcnt lgkmcnt(0)
    v_mfma_f32_16x16x32_bf16 v[52:55], v[196:199], v[148:151], v[52:55]
    ds_read_b64_tr_b16 v[212:213], v43 offset:8192
    v_mfma_f32_16x16x32_bf16 v[56:59], v[200:203], v[148:151], v[56:59]
    ds_read_b64_tr_b16 v[214:215], v43 offset:9216
    v_mfma_f32_16x16x32_bf16 v[60:63], v[148:151], v[204:207], v[60:63]
    ds_read_b128 v[172:175], v40 offset:0
    v_mfma_f32_16x16x32_bf16 v[64:67], v[208:211], v[148:151], v[64:67]
    ds_read_b64_tr_b16 v[216:217], v44 offset:8192
    v_mfma_f32_16x16x32_bf16 v[80:83], v[208:211], v[152:155], v[80:83]
    ds_read_b64_tr_b16 v[218:219], v44 offset:9216
    v_mfma_f32_16x16x32_bf16 v[76:79], v[152:155], v[204:207], v[76:79]
    ds_read_b128 v[176:179], v40 offset:2048
    v_mfma_f32_16x16x32_bf16 v[72:75], v[200:203], v[152:155], v[72:75]
    ds_read_b64_tr_b16 v[220:221], v45 offset:8192
    v_mfma_f32_16x16x32_bf16 v[68:71], v[196:199], v[152:155], v[68:71]
    ds_read_b64_tr_b16 v[222:223], v45 offset:9216
    v_mfma_f32_16x16x32_bf16 v[84:87], v[196:199], v[156:159], v[84:87]
    ds_read_b128 v[180:183], v40 offset:4096
    v_mfma_f32_16x16x32_bf16 v[88:91], v[200:203], v[156:159], v[88:91]
    ds_read_b64_tr_b16 v[224:225], v46 offset:8192
    v_mfma_f32_16x16x32_bf16 v[92:95], v[156:159], v[204:207], v[92:95]
    ds_read_b64_tr_b16 v[226:227], v46 offset:9216
    v_mfma_f32_16x16x32_bf16 v[96:99], v[208:211], v[156:159], v[96:99]
    ds_read_b128 v[184:187], v40 offset:6144
    v_mfma_f32_16x16x32_bf16 v[112:115], v[208:211], v[160:163], v[112:115]
    ds_read_b128 v[188:191], v40 offset:8192
    v_mfma_f32_16x16x32_bf16 v[108:111], v[160:163], v[204:207], v[108:111]
    ds_read_b128 v[192:195], v40 offset:10240
    v_mfma_f32_16x16x32_bf16 v[104:107], v[200:203], v[160:163], v[104:107]
    v_mfma_f32_16x16x32_bf16 v[100:103], v[196:199], v[160:163], v[100:103]
    v_mfma_f32_16x16x32_bf16 v[116:119], v[196:199], v[164:167], v[116:119]
    v_mfma_f32_16x16x32_bf16 v[120:123], v[200:203], v[164:167], v[120:123]
    v_mfma_f32_16x16x32_bf16 v[124:127], v[164:167], v[204:207], v[124:127]
    v_mfma_f32_16x16x32_bf16 v[128:131], v[208:211], v[164:167], v[128:131]
    v_mfma_f32_16x16x32_bf16 v[144:147], v[208:211], v[168:171], v[144:147]
    v_mfma_f32_16x16x32_bf16 v[140:143], v[168:171], v[204:207], v[140:143]
    v_mfma_f32_16x16x32_bf16 v[136:139], v[200:203], v[168:171], v[136:139]
    v_mfma_f32_16x16x32_bf16 v[132:135], v[196:199], v[168:171], v[132:135]
    s_waitcnt lgkmcnt(0)
    s_barrier
    v_mfma_f32_16x16x32_bf16 v[52:55], v[212:215], v[172:175], v[52:55]
    ds_read_b64_tr_b16 v[196:197], v43 offset:40960
    v_mfma_f32_16x16x32_bf16 v[56:59], v[216:219], v[172:175], v[56:59]
    ds_read_b64_tr_b16 v[198:199], v43 offset:41984
    v_mfma_f32_16x16x32_bf16 v[60:63], v[172:175], v[220:223], v[60:63]
    ds_read_b128 v[148:151], v39 offset:40960
    v_mfma_f32_16x16x32_bf16 v[64:67], v[224:227], v[172:175], v[64:67]
    ds_read_b64_tr_b16 v[200:201], v44 offset:40960
    v_mfma_f32_16x16x32_bf16 v[80:83], v[224:227], v[176:179], v[80:83]
    ds_read_b64_tr_b16 v[202:203], v44 offset:41984
    v_mfma_f32_16x16x32_bf16 v[76:79], v[176:179], v[220:223], v[76:79]
    ds_read_b128 v[152:155], v39 offset:43008
    v_mfma_f32_16x16x32_bf16 v[72:75], v[216:219], v[176:179], v[72:75]
    ds_read_b64_tr_b16 v[204:205], v45 offset:40960
    v_mfma_f32_16x16x32_bf16 v[68:71], v[212:215], v[176:179], v[68:71]
    ds_read_b64_tr_b16 v[206:207], v45 offset:41984
    v_mfma_f32_16x16x32_bf16 v[84:87], v[212:215], v[180:183], v[84:87]
    ds_read_b128 v[156:159], v39 offset:45056
    v_mfma_f32_16x16x32_bf16 v[88:91], v[216:219], v[180:183], v[88:91]
    ds_read_b64_tr_b16 v[208:209], v46 offset:40960
    v_mfma_f32_16x16x32_bf16 v[92:95], v[180:183], v[220:223], v[92:95]
    ds_read_b64_tr_b16 v[210:211], v46 offset:41984
    v_mfma_f32_16x16x32_bf16 v[96:99], v[224:227], v[180:183], v[96:99]
    ds_read_b128 v[160:163], v39 offset:47104
    v_mfma_f32_16x16x32_bf16 v[112:115], v[224:227], v[184:187], v[112:115]
    ds_read_b128 v[164:167], v39 offset:49152
    v_mfma_f32_16x16x32_bf16 v[108:111], v[184:187], v[220:223], v[108:111]
    ds_read_b128 v[168:171], v39 offset:51200
    v_mfma_f32_16x16x32_bf16 v[104:107], v[216:219], v[184:187], v[104:107]
    v_mfma_f32_16x16x32_bf16 v[100:103], v[212:215], v[184:187], v[100:103]
    v_mfma_f32_16x16x32_bf16 v[116:119], v[212:215], v[188:191], v[116:119]
    v_mfma_f32_16x16x32_bf16 v[120:123], v[216:219], v[188:191], v[120:123]
    v_mfma_f32_16x16x32_bf16 v[124:127], v[188:191], v[220:223], v[124:127]
    v_mfma_f32_16x16x32_bf16 v[128:131], v[224:227], v[188:191], v[128:131]
    v_mfma_f32_16x16x32_bf16 v[144:147], v[224:227], v[192:195], v[144:147]
    v_mfma_f32_16x16x32_bf16 v[140:143], v[192:195], v[220:223], v[140:143]
    v_mfma_f32_16x16x32_bf16 v[136:139], v[216:219], v[192:195], v[136:139]
    v_mfma_f32_16x16x32_bf16 v[132:135], v[212:215], v[192:195], v[132:135]
    s_waitcnt lgkmcnt(0)
    v_mfma_f32_16x16x32_bf16 v[52:55], v[196:199], v[148:151], v[52:55]
    ds_read_b64_tr_b16 v[212:213], v43 offset:49152
    v_mfma_f32_16x16x32_bf16 v[56:59], v[200:203], v[148:151], v[56:59]
    ds_read_b64_tr_b16 v[214:215], v43 offset:50176
    v_mfma_f32_16x16x32_bf16 v[60:63], v[148:151], v[204:207], v[60:63]
    ds_read_b128 v[172:175], v40 offset:40960
    v_mfma_f32_16x16x32_bf16 v[64:67], v[208:211], v[148:151], v[64:67]
    ds_read_b64_tr_b16 v[216:217], v44 offset:49152
    v_mfma_f32_16x16x32_bf16 v[80:83], v[208:211], v[152:155], v[80:83]
    ds_read_b64_tr_b16 v[218:219], v44 offset:50176
    v_mfma_f32_16x16x32_bf16 v[76:79], v[152:155], v[204:207], v[76:79]
    ds_read_b128 v[176:179], v40 offset:43008
    v_mfma_f32_16x16x32_bf16 v[72:75], v[200:203], v[152:155], v[72:75]
    ds_read_b64_tr_b16 v[220:221], v45 offset:49152
    v_mfma_f32_16x16x32_bf16 v[68:71], v[196:199], v[152:155], v[68:71]
    ds_read_b64_tr_b16 v[222:223], v45 offset:50176
    v_mfma_f32_16x16x32_bf16 v[84:87], v[196:199], v[156:159], v[84:87]
    ds_read_b128 v[180:183], v40 offset:45056
    v_mfma_f32_16x16x32_bf16 v[88:91], v[200:203], v[156:159], v[88:91]
    ds_read_b64_tr_b16 v[224:225], v46 offset:49152
    v_mfma_f32_16x16x32_bf16 v[92:95], v[156:159], v[204:207], v[92:95]
    ds_read_b64_tr_b16 v[226:227], v46 offset:50176
    v_mfma_f32_16x16x32_bf16 v[96:99], v[208:211], v[156:159], v[96:99]
    ds_read_b128 v[184:187], v40 offset:47104
    v_mfma_f32_16x16x32_bf16 v[112:115], v[208:211], v[160:163], v[112:115]
    ds_read_b128 v[188:191], v40 offset:49152
    v_mfma_f32_16x16x32_bf16 v[108:111], v[160:163], v[204:207], v[108:111]
    ds_read_b128 v[192:195], v40 offset:51200
    v_mfma_f32_16x16x32_bf16 v[104:107], v[200:203], v[160:163], v[104:107]
    v_mfma_f32_16x16x32_bf16 v[100:103], v[196:199], v[160:163], v[100:103]
    v_mfma_f32_16x16x32_bf16 v[116:119], v[196:199], v[164:167], v[116:119]
    v_mfma_f32_16x16x32_bf16 v[120:123], v[200:203], v[164:167], v[120:123]
    v_mfma_f32_16x16x32_bf16 v[124:127], v[164:167], v[204:207], v[124:127]
    v_mfma_f32_16x16x32_bf16 v[128:131], v[208:211], v[164:167], v[128:131]
    v_mfma_f32_16x16x32_bf16 v[144:147], v[208:211], v[168:171], v[144:147]
    v_mfma_f32_16x16x32_bf16 v[140:143], v[168:171], v[204:207], v[140:143]
    v_mfma_f32_16x16x32_bf16 v[136:139], v[200:203], v[168:171], v[136:139]
    v_mfma_f32_16x16x32_bf16 v[132:135], v[196:199], v[168:171], v[132:135]
    s_waitcnt lgkmcnt(0)
    s_barrier
    v_mfma_f32_16x16x32_bf16 v[52:55], v[212:215], v[172:175], v[52:55]
    ds_read_b64_tr_b16 v[196:197], v47 offset:0
    v_mfma_f32_16x16x32_bf16 v[56:59], v[216:219], v[172:175], v[56:59]
    ds_read_b64_tr_b16 v[198:199], v47 offset:1024
    v_mfma_f32_16x16x32_bf16 v[60:63], v[172:175], v[220:223], v[60:63]
    ds_read_b128 v[148:151], v41 offset:0
    v_mfma_f32_16x16x32_bf16 v[64:67], v[224:227], v[172:175], v[64:67]
    ds_read_b64_tr_b16 v[200:201], v48 offset:0
    v_mfma_f32_16x16x32_bf16 v[80:83], v[224:227], v[176:179], v[80:83]
    ds_read_b64_tr_b16 v[202:203], v48 offset:1024
    v_mfma_f32_16x16x32_bf16 v[76:79], v[176:179], v[220:223], v[76:79]
    ds_read_b128 v[152:155], v41 offset:2048
    v_mfma_f32_16x16x32_bf16 v[72:75], v[216:219], v[176:179], v[72:75]
    ds_read_b64_tr_b16 v[204:205], v49 offset:0
    v_mfma_f32_16x16x32_bf16 v[68:71], v[212:215], v[176:179], v[68:71]
    ds_read_b64_tr_b16 v[206:207], v49 offset:1024
    v_mfma_f32_16x16x32_bf16 v[84:87], v[212:215], v[180:183], v[84:87]
    ds_read_b128 v[156:159], v41 offset:4096
    v_mfma_f32_16x16x32_bf16 v[88:91], v[216:219], v[180:183], v[88:91]
    ds_read_b64_tr_b16 v[208:209], v50 offset:0
    v_mfma_f32_16x16x32_bf16 v[92:95], v[180:183], v[220:223], v[92:95]
    ds_read_b64_tr_b16 v[210:211], v50 offset:1024
    v_mfma_f32_16x16x32_bf16 v[96:99], v[224:227], v[180:183], v[96:99]
    ds_read_b128 v[160:163], v41 offset:6144
    v_mfma_f32_16x16x32_bf16 v[112:115], v[224:227], v[184:187], v[112:115]
    ds_read_b128 v[164:167], v41 offset:8192
    v_mfma_f32_16x16x32_bf16 v[108:111], v[184:187], v[220:223], v[108:111]
    ds_read_b128 v[168:171], v41 offset:10240
    v_mfma_f32_16x16x32_bf16 v[104:107], v[216:219], v[184:187], v[104:107]
    v_mfma_f32_16x16x32_bf16 v[100:103], v[212:215], v[184:187], v[100:103]
    v_mfma_f32_16x16x32_bf16 v[116:119], v[212:215], v[188:191], v[116:119]
    v_mfma_f32_16x16x32_bf16 v[120:123], v[216:219], v[188:191], v[120:123]
    v_mfma_f32_16x16x32_bf16 v[124:127], v[188:191], v[220:223], v[124:127]
    v_mfma_f32_16x16x32_bf16 v[128:131], v[224:227], v[188:191], v[128:131]
    v_mfma_f32_16x16x32_bf16 v[144:147], v[224:227], v[192:195], v[144:147]
    v_mfma_f32_16x16x32_bf16 v[140:143], v[192:195], v[220:223], v[140:143]
    v_mfma_f32_16x16x32_bf16 v[136:139], v[216:219], v[192:195], v[136:139]
    v_mfma_f32_16x16x32_bf16 v[132:135], v[212:215], v[192:195], v[132:135]
    s_waitcnt lgkmcnt(0)
    v_mfma_f32_16x16x32_bf16 v[52:55], v[196:199], v[148:151], v[52:55]
    ds_read_b64_tr_b16 v[212:213], v47 offset:8192
    v_mfma_f32_16x16x32_bf16 v[56:59], v[200:203], v[148:151], v[56:59]
    ds_read_b64_tr_b16 v[214:215], v47 offset:9216
    v_mfma_f32_16x16x32_bf16 v[60:63], v[148:151], v[204:207], v[60:63]
    ds_read_b128 v[172:175], v42 offset:0
    v_mfma_f32_16x16x32_bf16 v[64:67], v[208:211], v[148:151], v[64:67]
    ds_read_b64_tr_b16 v[216:217], v48 offset:8192
    v_mfma_f32_16x16x32_bf16 v[80:83], v[208:211], v[152:155], v[80:83]
    ds_read_b64_tr_b16 v[218:219], v48 offset:9216
    v_mfma_f32_16x16x32_bf16 v[76:79], v[152:155], v[204:207], v[76:79]
    ds_read_b128 v[176:179], v42 offset:2048
    v_mfma_f32_16x16x32_bf16 v[72:75], v[200:203], v[152:155], v[72:75]
    ds_read_b64_tr_b16 v[220:221], v49 offset:8192
    v_mfma_f32_16x16x32_bf16 v[68:71], v[196:199], v[152:155], v[68:71]
    ds_read_b64_tr_b16 v[222:223], v49 offset:9216
    v_mfma_f32_16x16x32_bf16 v[84:87], v[196:199], v[156:159], v[84:87]
    ds_read_b128 v[180:183], v42 offset:4096
    v_mfma_f32_16x16x32_bf16 v[88:91], v[200:203], v[156:159], v[88:91]
    ds_read_b64_tr_b16 v[224:225], v50 offset:8192
    v_mfma_f32_16x16x32_bf16 v[92:95], v[156:159], v[204:207], v[92:95]
    ds_read_b64_tr_b16 v[226:227], v50 offset:9216
    v_mfma_f32_16x16x32_bf16 v[96:99], v[208:211], v[156:159], v[96:99]
    ds_read_b128 v[184:187], v42 offset:6144
    v_mfma_f32_16x16x32_bf16 v[112:115], v[208:211], v[160:163], v[112:115]
    ds_read_b128 v[188:191], v42 offset:8192
    v_mfma_f32_16x16x32_bf16 v[108:111], v[160:163], v[204:207], v[108:111]
    ds_read_b128 v[192:195], v42 offset:10240
    v_mfma_f32_16x16x32_bf16 v[104:107], v[200:203], v[160:163], v[104:107]
    v_mfma_f32_16x16x32_bf16 v[100:103], v[196:199], v[160:163], v[100:103]
    v_mfma_f32_16x16x32_bf16 v[116:119], v[196:199], v[164:167], v[116:119]
    v_mfma_f32_16x16x32_bf16 v[120:123], v[200:203], v[164:167], v[120:123]
    v_mfma_f32_16x16x32_bf16 v[124:127], v[164:167], v[204:207], v[124:127]
    v_mfma_f32_16x16x32_bf16 v[128:131], v[208:211], v[164:167], v[128:131]
    v_mfma_f32_16x16x32_bf16 v[144:147], v[208:211], v[168:171], v[144:147]
    v_mfma_f32_16x16x32_bf16 v[140:143], v[168:171], v[204:207], v[140:143]
    v_mfma_f32_16x16x32_bf16 v[136:139], v[200:203], v[168:171], v[136:139]
    v_mfma_f32_16x16x32_bf16 v[132:135], v[196:199], v[168:171], v[132:135]
    s_waitcnt lgkmcnt(0)
    s_barrier
    v_mfma_f32_16x16x32_bf16 v[52:55], v[212:215], v[172:175], v[52:55]
    ds_read_b64_tr_b16 v[196:197], v43 offset:0
    v_mfma_f32_16x16x32_bf16 v[56:59], v[216:219], v[172:175], v[56:59]
    ds_read_b64_tr_b16 v[198:199], v43 offset:1024
    v_mfma_f32_16x16x32_bf16 v[60:63], v[172:175], v[220:223], v[60:63]
    ds_read_b128 v[148:151], v39 offset:0
    v_mfma_f32_16x16x32_bf16 v[64:67], v[224:227], v[172:175], v[64:67]
    ds_read_b64_tr_b16 v[200:201], v44 offset:0
    v_mfma_f32_16x16x32_bf16 v[80:83], v[224:227], v[176:179], v[80:83]
    ds_read_b64_tr_b16 v[202:203], v44 offset:1024
    v_mfma_f32_16x16x32_bf16 v[76:79], v[176:179], v[220:223], v[76:79]
    ds_read_b128 v[152:155], v39 offset:2048
    v_mfma_f32_16x16x32_bf16 v[72:75], v[216:219], v[176:179], v[72:75]
    ds_read_b64_tr_b16 v[204:205], v45 offset:0
    v_mfma_f32_16x16x32_bf16 v[68:71], v[212:215], v[176:179], v[68:71]
    ds_read_b64_tr_b16 v[206:207], v45 offset:1024
    v_mfma_f32_16x16x32_bf16 v[84:87], v[212:215], v[180:183], v[84:87]
    ds_read_b128 v[156:159], v39 offset:4096
    v_mfma_f32_16x16x32_bf16 v[88:91], v[216:219], v[180:183], v[88:91]
    ds_read_b64_tr_b16 v[208:209], v46 offset:0
    v_mfma_f32_16x16x32_bf16 v[92:95], v[180:183], v[220:223], v[92:95]
    ds_read_b64_tr_b16 v[210:211], v46 offset:1024
    v_mfma_f32_16x16x32_bf16 v[96:99], v[224:227], v[180:183], v[96:99]
    ds_read_b128 v[160:163], v39 offset:6144
    v_mfma_f32_16x16x32_bf16 v[112:115], v[224:227], v[184:187], v[112:115]
    ds_read_b128 v[164:167], v39 offset:8192
    v_mfma_f32_16x16x32_bf16 v[108:111], v[184:187], v[220:223], v[108:111]
    ds_read_b128 v[168:171], v39 offset:10240
    v_mfma_f32_16x16x32_bf16 v[104:107], v[216:219], v[184:187], v[104:107]
    v_mfma_f32_16x16x32_bf16 v[100:103], v[212:215], v[184:187], v[100:103]
    v_mfma_f32_16x16x32_bf16 v[116:119], v[212:215], v[188:191], v[116:119]
    v_mfma_f32_16x16x32_bf16 v[120:123], v[216:219], v[188:191], v[120:123]
    v_mfma_f32_16x16x32_bf16 v[124:127], v[188:191], v[220:223], v[124:127]
    v_mfma_f32_16x16x32_bf16 v[128:131], v[224:227], v[188:191], v[128:131]
    v_mfma_f32_16x16x32_bf16 v[144:147], v[224:227], v[192:195], v[144:147]
    v_mfma_f32_16x16x32_bf16 v[140:143], v[192:195], v[220:223], v[140:143]
    v_mfma_f32_16x16x32_bf16 v[136:139], v[216:219], v[192:195], v[136:139]
    v_mfma_f32_16x16x32_bf16 v[132:135], v[212:215], v[192:195], v[132:135]
    s_waitcnt lgkmcnt(0)
    v_mfma_f32_16x16x32_bf16 v[52:55], v[196:199], v[148:151], v[52:55]
    ds_read_b64_tr_b16 v[212:213], v43 offset:8192
    v_mfma_f32_16x16x32_bf16 v[56:59], v[200:203], v[148:151], v[56:59]
    ds_read_b64_tr_b16 v[214:215], v43 offset:9216
    v_mfma_f32_16x16x32_bf16 v[60:63], v[148:151], v[204:207], v[60:63]
    ds_read_b128 v[172:175], v40 offset:0
    v_mfma_f32_16x16x32_bf16 v[64:67], v[208:211], v[148:151], v[64:67]
    ds_read_b64_tr_b16 v[216:217], v44 offset:8192
    v_mfma_f32_16x16x32_bf16 v[80:83], v[208:211], v[152:155], v[80:83]
    ds_read_b64_tr_b16 v[218:219], v44 offset:9216
    v_mfma_f32_16x16x32_bf16 v[76:79], v[152:155], v[204:207], v[76:79]
    ds_read_b128 v[176:179], v40 offset:2048
    v_mfma_f32_16x16x32_bf16 v[72:75], v[200:203], v[152:155], v[72:75]
    ds_read_b64_tr_b16 v[220:221], v45 offset:8192
    v_mfma_f32_16x16x32_bf16 v[68:71], v[196:199], v[152:155], v[68:71]
    ds_read_b64_tr_b16 v[222:223], v45 offset:9216
    v_mfma_f32_16x16x32_bf16 v[84:87], v[196:199], v[156:159], v[84:87]
    ds_read_b128 v[180:183], v40 offset:4096
    v_mfma_f32_16x16x32_bf16 v[88:91], v[200:203], v[156:159], v[88:91]
    ds_read_b64_tr_b16 v[224:225], v46 offset:8192
    v_mfma_f32_16x16x32_bf16 v[92:95], v[156:159], v[204:207], v[92:95]
    ds_read_b64_tr_b16 v[226:227], v46 offset:9216
    v_mfma_f32_16x16x32_bf16 v[96:99], v[208:211], v[156:159], v[96:99]
    ds_read_b128 v[184:187], v40 offset:6144
    v_mfma_f32_16x16x32_bf16 v[112:115], v[208:211], v[160:163], v[112:115]
    ds_read_b128 v[188:191], v40 offset:8192
    v_mfma_f32_16x16x32_bf16 v[108:111], v[160:163], v[204:207], v[108:111]
    ds_read_b128 v[192:195], v40 offset:10240
    v_mfma_f32_16x16x32_bf16 v[104:107], v[200:203], v[160:163], v[104:107]
    v_mfma_f32_16x16x32_bf16 v[100:103], v[196:199], v[160:163], v[100:103]
    v_mfma_f32_16x16x32_bf16 v[116:119], v[196:199], v[164:167], v[116:119]
    v_mfma_f32_16x16x32_bf16 v[120:123], v[200:203], v[164:167], v[120:123]
    v_mfma_f32_16x16x32_bf16 v[124:127], v[164:167], v[204:207], v[124:127]
    v_mfma_f32_16x16x32_bf16 v[128:131], v[208:211], v[164:167], v[128:131]
    v_mfma_f32_16x16x32_bf16 v[144:147], v[208:211], v[168:171], v[144:147]
    v_mfma_f32_16x16x32_bf16 v[140:143], v[168:171], v[204:207], v[140:143]
    v_mfma_f32_16x16x32_bf16 v[136:139], v[200:203], v[168:171], v[136:139]
    v_mfma_f32_16x16x32_bf16 v[132:135], v[196:199], v[168:171], v[132:135]
    s_waitcnt lgkmcnt(0)
    s_barrier
    v_mfma_f32_16x16x32_bf16 v[52:55], v[212:215], v[172:175], v[52:55]
    ds_read_b64_tr_b16 v[196:197], v43 offset:40960
    v_mfma_f32_16x16x32_bf16 v[56:59], v[216:219], v[172:175], v[56:59]
    ds_read_b64_tr_b16 v[198:199], v43 offset:41984
    v_mfma_f32_16x16x32_bf16 v[60:63], v[172:175], v[220:223], v[60:63]
    ds_read_b128 v[148:151], v39 offset:40960
    v_mfma_f32_16x16x32_bf16 v[64:67], v[224:227], v[172:175], v[64:67]
    ds_read_b64_tr_b16 v[200:201], v44 offset:40960
    v_mfma_f32_16x16x32_bf16 v[80:83], v[224:227], v[176:179], v[80:83]
    ds_read_b64_tr_b16 v[202:203], v44 offset:41984
    v_mfma_f32_16x16x32_bf16 v[76:79], v[176:179], v[220:223], v[76:79]
    ds_read_b128 v[152:155], v39 offset:43008
    v_mfma_f32_16x16x32_bf16 v[72:75], v[216:219], v[176:179], v[72:75]
    ds_read_b64_tr_b16 v[204:205], v45 offset:40960
    v_mfma_f32_16x16x32_bf16 v[68:71], v[212:215], v[176:179], v[68:71]
    ds_read_b64_tr_b16 v[206:207], v45 offset:41984
    v_mfma_f32_16x16x32_bf16 v[84:87], v[212:215], v[180:183], v[84:87]
    ds_read_b128 v[156:159], v39 offset:45056
    v_mfma_f32_16x16x32_bf16 v[88:91], v[216:219], v[180:183], v[88:91]
    ds_read_b64_tr_b16 v[208:209], v46 offset:40960
    v_mfma_f32_16x16x32_bf16 v[92:95], v[180:183], v[220:223], v[92:95]
    ds_read_b64_tr_b16 v[210:211], v46 offset:41984
    v_mfma_f32_16x16x32_bf16 v[96:99], v[224:227], v[180:183], v[96:99]
    ds_read_b128 v[160:163], v39 offset:47104
    v_mfma_f32_16x16x32_bf16 v[112:115], v[224:227], v[184:187], v[112:115]
    ds_read_b128 v[164:167], v39 offset:49152
    v_mfma_f32_16x16x32_bf16 v[108:111], v[184:187], v[220:223], v[108:111]
    ds_read_b128 v[168:171], v39 offset:51200
    v_mfma_f32_16x16x32_bf16 v[104:107], v[216:219], v[184:187], v[104:107]
    v_mfma_f32_16x16x32_bf16 v[100:103], v[212:215], v[184:187], v[100:103]
    v_mfma_f32_16x16x32_bf16 v[116:119], v[212:215], v[188:191], v[116:119]
    v_mfma_f32_16x16x32_bf16 v[120:123], v[216:219], v[188:191], v[120:123]
    v_mfma_f32_16x16x32_bf16 v[124:127], v[188:191], v[220:223], v[124:127]
    v_mfma_f32_16x16x32_bf16 v[128:131], v[224:227], v[188:191], v[128:131]
    s_branch K_PG2
.p2align 12
K_CHM2:
K_STM2:
    s_branch K_WRET_M
    s_nop 0
K_PG2:
    v_mfma_f32_16x16x32_bf16 v[144:147], v[224:227], v[192:195], v[144:147]
    v_mfma_f32_16x16x32_bf16 v[140:143], v[192:195], v[220:223], v[140:143]
    v_mfma_f32_16x16x32_bf16 v[136:139], v[216:219], v[192:195], v[136:139]
    v_mfma_f32_16x16x32_bf16 v[132:135], v[212:215], v[192:195], v[132:135]
    s_waitcnt lgkmcnt(0)
    v_mfma_f32_16x16x32_bf16 v[52:55], v[196:199], v[148:151], v[52:55]
    ds_read_b64_tr_b16 v[212:213], v43 offset:49152
    v_mfma_f32_16x16x32_bf16 v[56:59], v[200:203], v[148:151], v[56:59]
    ds_read_b64_tr_b16 v[214:215], v43 offset:50176
    v_mfma_f32_16x16x32_bf16 v[60:63], v[148:151], v[204:207], v[60:63]
    ds_read_b128 v[172:175], v40 offset:40960
    v_mfma_f32_16x16x32_bf16 v[64:67], v[208:211], v[148:151], v[64:67]
    ds_read_b64_tr_b16 v[216:217], v44 offset:49152
    v_mfma_f32_16x16x32_bf16 v[80:83], v[208:211], v[152:155], v[80:83]
    ds_read_b64_tr_b16 v[218:219], v44 offset:50176
    v_mfma_f32_16x16x32_bf16 v[76:79], v[152:155], v[204:207], v[76:79]
    ds_read_b128 v[176:179], v40 offset:43008
    v_mfma_f32_16x16x32_bf16 v[72:75], v[200:203], v[152:155], v[72:75]
    ds_read_b64_tr_b16 v[220:221], v45 offset:49152
    v_mfma_f32_16x16x32_bf16 v[68:71], v[196:199], v[152:155], v[68:71]
    ds_read_b64_tr_b16 v[222:223], v45 offset:50176
    v_mfma_f32_16x16x32_bf16 v[84:87], v[196:199], v[156:159], v[84:87]
    ds_read_b128 v[180:183], v40 offset:45056
    v_mfma_f32_16x16x32_bf16 v[88:91], v[200:203], v[156:159], v[88:91]
    ds_read_b64_tr_b16 v[224:225], v46 offset:49152
    v_mfma_f32_16x16x32_bf16 v[92:95], v[156:159], v[204:207], v[92:95]
    ds_read_b64_tr_b16 v[226:227], v46 offset:50176
    v_mfma_f32_16x16x32_bf16 v[96:99], v[208:211], v[156:159], v[96:99]
    ds_read_b128 v[184:187], v40 offset:47104
    v_mfma_f32_16x16x32_bf16 v[112:115], v[208:211], v[160:163], v[112:115]
    ds_read_b128 v[188:191], v40 offset:49152
    v_mfma_f32_16x16x32_bf16 v[108:111], v[160:163], v[204:207], v[108:111]
    ds_read_b128 v[192:195], v40 offset:51200
    v_mfma_f32_16x16x32_bf16 v[104:107], v[200:203], v[160:163], v[104:107]
    v_mfma_f32_16x16x32_bf16 v[100:103], v[196:199], v[160:163], v[100:103]
    v_mfma_f32_16x16x32_bf16 v[116:119], v[196:199], v[164:167], v[116:119]
    v_mfma_f32_16x16x32_bf16 v[120:123], v[200:203], v[164:167], v[120:123]
    v_mfma_f32_16x16x32_bf16 v[124:127], v[164:167], v[204:207], v[124:127]
    v_mfma_f32_16x16x32_bf16 v[128:131], v[208:211], v[164:167], v[128:131]
    v_mfma_f32_16x16x32_bf16 v[144:147], v[208:211], v[168:171], v[144:147]
    v_mfma_f32_16x16x32_bf16 v[140:143], v[168:171], v[204:207], v[140:143]
    v_mfma_f32_16x16x32_bf16 v[136:139], v[200:203], v[168:171], v[136:139]
    v_mfma_f32_16x16x32_bf16 v[132:135], v[196:199], v[168:171], v[132:135]
    s_waitcnt lgkmcnt(0)
    s_barrier
    v_mfma_f32_16x16x32_bf16 v[52:55], v[212:215], v[172:175], v[52:55]
    ds_read_b64_tr_b16 v[196:197], v47 offset:0
    v_mfma_f32_16x16x32_bf16 v[56:59], v[216:219], v[172:175], v[56:59]
    ds_read_b64_tr_b16 v[198:199], v47 offset:1024
    v_mfma_f32_16x16x32_bf16 v[60:63], v[172:175], v[220:223], v[60:63]
    ds_read_b128 v[148:151], v41 offset:0
    v_mfma_f32_16x16x32_bf16 v[64:67], v[224:227], v[172:175], v[64:67]
    ds_read_b64_tr_b16 v[200:201], v48 offset:0
    v_mfma_f32_16x16x32_bf16 v[80:83], v[224:227], v[176:179], v[80:83]
    ds_read_b64_tr_b16 v[202:203], v48 offset:1024
    v_mfma_f32_16x16x32_bf16 v[76:79], v[176:179], v[220:223], v[76:79]
    ds_read_b128 v[152:155], v41 offset:2048
    v_mfma_f32_16x16x32_bf16 v[72:75], v[216:219], v[176:179], v[72:75]
    ds_read_b64_tr_b16 v[204:205], v49 offset:0
    v_mfma_f32_16x16x32_bf16 v[68:71], v[212:215], v[176:179], v[68:71]
    ds_read_b64_tr_b16 v[206:207], v49 offset:1024
    v_mfma_f32_16x16x32_bf16 v[84:87], v[212:215], v[180:183], v[84:87]
    ds_read_b128 v[156:159], v41 offset:4096
    v_mfma_f32_16x16x32_bf16 v[88:91], v[216:219], v[180:183], v[88:91]
    ds_read_b64_tr_b16 v[208:209], v50 offset:0
    v_mfma_f32_16x16x32_bf16 v[92:95], v[180:183], v[220:223], v[92:95]
    ds_read_b64_tr_b16 v[210:211], v50 offset:1024
    v_mfma_f32_16x16x32_bf16 v[96:99], v[224:227], v[180:183], v[96:99]
    ds_read_b128 v[160:163], v41 offset:6144
    v_mfma_f32_16x16x32_bf16 v[112:115], v[224:227], v[184:187], v[112:115]
    ds_read_b128 v[164:167], v41 offset:8192
    v_mfma_f32_16x16x32_bf16 v[108:111], v[184:187], v[220:223], v[108:111]
    ds_read_b128 v[168:171], v41 offset:10240
    v_mfma_f32_16x16x32_bf16 v[104:107], v[216:219], v[184:187], v[104:107]
    v_mfma_f32_16x16x32_bf16 v[100:103], v[212:215], v[184:187], v[100:103]
    v_mfma_f32_16x16x32_bf16 v[116:119], v[212:215], v[188:191], v[116:119]
    v_mfma_f32_16x16x32_bf16 v[120:123], v[216:219], v[188:191], v[120:123]
    v_mfma_f32_16x16x32_bf16 v[124:127], v[188:191], v[220:223], v[124:127]
    v_mfma_f32_16x16x32_bf16 v[128:131], v[224:227], v[188:191], v[128:131]
    v_mfma_f32_16x16x32_bf16 v[144:147], v[224:227], v[192:195], v[144:147]
    v_mfma_f32_16x16x32_bf16 v[140:143], v[192:195], v[220:223], v[140:143]
    v_mfma_f32_16x16x32_bf16 v[136:139], v[216:219], v[192:195], v[136:139]
    v_mfma_f32_16x16x32_bf16 v[132:135], v[212:215], v[192:195], v[132:135]
    s_waitcnt lgkmcnt(0)
    v_mfma_f32_16x16x32_bf16 v[132:135], v[196:199], v[168:171], v[132:135]
    ds_read_b64_tr_b16 v[212:213], v47 offset:8192
    ds_read_b64_tr_b16 v[214:215], v47 offset:9216
    v_mfma_f32_16x16x32_bf16 v[136:139], v[200:203], v[168:171], v[136:139]
    ds_read_b128 v[192:195], v42 offset:10240
    ds_read_b64_tr_b16 v[216:217], v48 offset:8192
    v_mfma_f32_16x16x32_bf16 v[140:143], v[168:171], v[204:207], v[140:143]
    ds_read_b64_tr_b16 v[218:219], v48 offset:9216
    ds_read_b64_tr_b16 v[220:221], v49 offset:8192
    v_mfma_f32_16x16x32_bf16 v[144:147], v[208:211], v[168:171], v[144:147]
    ds_read_b64_tr_b16 v[222:223], v49 offset:9216
    ds_read_b64_tr_b16 v[224:225], v50 offset:8192
    v_mfma_f32_16x16x32_bf16 v[116:119], v[196:199], v[164:167], v[116:119]
    ds_read_b64_tr_b16 v[226:227], v50 offset:9216
    ds_read_b128 v[188:191], v42 offset:8192
    v_mfma_f32_16x16x32_bf16 v[120:123], v[200:203], v[164:167], v[120:123]
    ds_read_b128 v[184:187], v42 offset:6144
    ds_read_b128 v[180:183], v42 offset:4096
    v_mfma_f32_16x16x32_bf16 v[124:127], v[164:167], v[204:207], v[124:127]
    ds_read_b128 v[176:179], v42 offset:2048
    ds_read_b128 v[172:175], v42 offset:0
    v_mfma_f32_16x16x32_bf16 v[128:131], v[208:211], v[164:167], v[128:131]
    s_waitcnt lgkmcnt(11)
    v_mfma_f32_16x16x32_bf16 v[132:135], v[212:215], v[192:195], v[132:135]
    s_waitcnt lgkmcnt(9)
    v_mfma_f32_16x16x32_bf16 v[136:139], v[216:219], v[192:195], v[136:139]
    s_waitcnt lgkmcnt(7)
    v_mfma_f32_16x16x32_bf16 v[140:143], v[192:195], v[220:223], v[140:143]
    s_waitcnt lgkmcnt(5)
    v_mfma_f32_16x16x32_bf16 v[144:147], v[224:227], v[192:195], v[144:147]
    s_waitcnt lgkmcnt(4)
    v_mfma_f32_16x16x32_bf16 v[116:119], v[212:215], v[188:191], v[116:119]
    v_cvt_pk_bf16_f32 v132, v132, v133
    v_cvt_pk_bf16_f32 v133, v134, v135
    v_mfma_f32_16x16x32_bf16 v[120:123], v[216:219], v[188:191], v[120:123]
    v_cvt_pk_bf16_f32 v136, v136, v137
    v_cvt_pk_bf16_f32 v137, v138, v139
    v_mfma_f32_16x16x32_bf16 v[124:127], v[188:191], v[220:223], v[124:127]
    v_mov_b32 v138, 0
    v_mov_b32 v139, 0
    v_mfma_f32_16x16x32_bf16 v[128:131], v[224:227], v[188:191], v[128:131]
    v_cvt_pk_bf16_f32 v134, v144, v145
    v_cvt_pk_bf16_f32 v135, v146, v147
    v_mfma_f32_16x16x32_bf16 v[100:103], v[196:199], v[160:163], v[100:103]
    v_cvt_pk_bf16_f32 v254, v140, v141
    v_cvt_pk_bf16_f32 v255, v142, v143
    v_mfma_f32_16x16x32_bf16 v[104:107], v[200:203], v[160:163], v[104:107]
    v_permlane16_swap_b32 v134, v138
    v_permlane16_swap_b32 v135, v139
    ds_write_b64 v32, v[134:135] offset:768
    v_mfma_f32_16x16x32_bf16 v[108:111], v[160:163], v[204:207], v[108:111]
    ds_read_b64_tr_b16 v[240:241], v33 offset:768
    s_cmp_lg_u32 s54, 0
    s_cbranch_scc1 K_NOX
    ds_write_b64 v34, v[132:133]
    ds_write_b64 v34, v[134:135] offset:512
    ds_write_b64 v34, v[254:255] offset:1024
    v_lshl_add_u32 v2, s55, 2, v38
    ds_write_b16 v2, v38 offset:30
K_NOX:
    v_mfma_f32_16x16x32_bf16 v[112:115], v[208:211], v[160:163], v[112:115]
    v_cvt_pk_bf16_f32 v116, v116, v117
    v_cvt_pk_bf16_f32 v117, v118, v119
    v_mfma_f32_16x16x32_bf16 v[192:195], v[132:135], v[136:139], v[16:19]
    v_cvt_pk_bf16_f32 v120, v120, v121
    v_cvt_pk_bf16_f32 v121, v122, v123
    s_waitcnt lgkmcnt(5)
    v_mfma_f32_16x16x32_bf16 v[100:103], v[212:215], v[184:187], v[100:103]
    v_mov_b32 v122, 0
    v_mov_b32 v123, 0
    v_mfma_f32_16x16x32_bf16 v[104:107], v[216:219], v[184:187], v[104:107]
    v_cvt_pk_bf16_f32 v118, v128, v129
    v_cvt_pk_bf16_f32 v119, v130, v131
    v_mfma_f32_16x16x32_bf16 v[108:111], v[184:187], v[220:223], v[108:111]
    v_cvt_pk_bf16_f32 v252, v124, v125
    v_cvt_pk_bf16_f32 v253, v126, v127
    v_mfma_f32_16x16x32_bf16 v[112:115], v[224:227], v[184:187], v[112:115]
    v_permlane16_swap_b32 v118, v122
    v_permlane16_swap_b32 v119, v123
    ds_write_b64 v32, v[118:119] offset:640
    v_mfma_f32_16x16x32_bf16 v[84:87], v[196:199], v[156:159], v[84:87]
    ds_read_b64_tr_b16 v[238:239], v33 offset:640
    v_cvt_pk_bf16_f32 v100, v100, v101
    v_mfma_f32_16x16x32_bf16 v[88:91], v[200:203], v[156:159], v[88:91]
    v_cvt_pk_bf16_f32 v101, v102, v103
    v_cvt_pk_bf16_f32 v104, v104, v105
    v_mfma_f32_16x16x32_bf16 v[168:171], v[116:119], v[136:139], v[12:15]
    v_cvt_pk_bf16_f32 v105, v106, v107
    v_mov_b32 v106, 0
    v_mfma_f32_16x16x32_bf16 v[92:95], v[156:159], v[204:207], v[92:95]
    v_mov_b32 v107, 0
    v_cvt_pk_bf16_f32 v102, v112, v113
    v_mfma_f32_16x16x32_bf16 v[188:191], v[116:119], v[120:123], v[16:19]
    v_cvt_pk_bf16_f32 v103, v114, v115
    v_cvt_pk_bf16_f32 v250, v108, v109
    v_mfma_f32_16x16x32_bf16 v[96:99], v[208:211], v[156:159], v[96:99]
    v_cvt_pk_bf16_f32 v251, v110, v111
    v_permlane16_swap_b32 v102, v106
    s_waitcnt lgkmcnt(6)
    v_mfma_f32_16x16x32_bf16 v[84:87], v[212:215], v[180:183], v[84:87]
    v_permlane16_swap_b32 v103, v107
    ds_write_b64 v32, v[102:103] offset:512
    v_mfma_f32_16x16x32_bf16 v[88:91], v[216:219], v[180:183], v[88:91]
    ds_read_b64_tr_b16 v[236:237], v33 offset:512
    v_max3_f32 v168, v168, v169, v192
    v_mfma_f32_16x16x32_bf16 v[92:95], v[180:183], v[220:223], v[92:95]
    v_max3_f32 v170, v170, v171, v194
    v_max_f32 v168, v168, v193
    v_mfma_f32_16x16x32_bf16 v[164:167], v[100:103], v[120:123], v[12:15]
    v_max_f32 v169, v170, v195
    v_cvt_pk_bf16_f32 v168, v168, v169
    v_mfma_f32_16x16x32_bf16 v[96:99], v[224:227], v[180:183], v[96:99]
    v_cvt_pk_bf16_f32 v84, v84, v85
    v_cvt_pk_bf16_f32 v85, v86, v87
    v_mfma_f32_16x16x32_bf16 v[184:187], v[100:103], v[104:107], v[16:19]
    v_cvt_pk_bf16_f32 v88, v88, v89
    v_cvt_pk_bf16_f32 v89, v90, v91
    v_mfma_f32_16x16x32_bf16 v[68:71], v[196:199], v[152:155], v[68:71]
    v_mov_b32 v90, 0
    v_mov_b32 v91, 0
    v_mfma_f32_16x16x32_bf16 v[72:75], v[200:203], v[152:155], v[72:75]
    v_max3_f32 v164, v164, v165, v188
    v_max3_f32 v166, v166, v167, v190
    v_mfma_f32_16x16x32_bf16 v[76:79], v[152:155], v[204:207], v[76:79]
    v_max_f32 v164, v164, v189
    v_max_f32 v165, v166, v191
    v_mfma_f32_16x16x32_bf16 v[80:83], v[208:211], v[152:155], v[80:83]
    v_cvt_pk_bf16_f32 v164, v164, v165
    v_cvt_pk_bf16_f32 v86, v96, v97
    s_waitcnt lgkmcnt(7)
    v_mfma_f32_16x16x32_bf16 v[68:71], v[212:215], v[176:179], v[68:71]
    v_cvt_pk_bf16_f32 v87, v98, v99
    v_cvt_pk_bf16_f32 v248, v92, v93
    v_mfma_f32_16x16x32_bf16 v[72:75], v[216:219], v[176:179], v[72:75]
    v_cvt_pk_bf16_f32 v249, v94, v95
    v_permlane16_swap_b32 v86, v90
    v_mfma_f32_16x16x32_bf16 v[76:79], v[176:179], v[220:223], v[76:79]
    v_permlane16_swap_b32 v87, v91
    ds_write_b64 v32, v[86:87] offset:384
    v_mfma_f32_16x16x32_bf16 v[80:83], v[224:227], v[176:179], v[80:83]
    ds_read_b64_tr_b16 v[234:235], v33 offset:384
    v_lshl_add_u32 v2, s55, 2, v38
    v_mfma_f32_16x16x32_bf16 v[52:55], v[196:199], v[148:151], v[52:55]
    ds_read_b32 v3, v2 offset:28
    ds_read_b64 v[144:145], v34
    v_mfma_f32_16x16x32_bf16 v[160:163], v[84:87], v[104:107], v[12:15]
    ds_read_b64 v[146:147], v34 offset:512
    ds_read_b64 v[242:243], v34 offset:1024
    v_mfma_f32_16x16x32_bf16 v[56:59], v[200:203], v[148:151], v[56:59]
    ds_read_b64_tr_b16 v[228:229], v33
    v_cvt_pk_bf16_f32 v68, v68, v69
    v_mfma_f32_16x16x32_bf16 v[180:183], v[84:87], v[88:91], v[16:19]
    v_cvt_pk_bf16_f32 v69, v70, v71
    v_cvt_pk_bf16_f32 v72, v72, v73
    v_mfma_f32_16x16x32_bf16 v[60:63], v[148:151], v[204:207], v[60:63]
    v_cvt_pk_bf16_f32 v73, v74, v75
    v_mov_b32 v74, 0
    v_mfma_f32_16x16x32_bf16 v[64:67], v[208:211], v[148:151], v[64:67]
    v_mov_b32 v75, 0
    v_cvt_pk_bf16_f32 v70, v80, v81
    s_waitcnt lgkmcnt(13)
    v_mfma_f32_16x16x32_bf16 v[52:55], v[212:215], v[172:175], v[52:55]
    v_cvt_pk_bf16_f32 v71, v82, v83
    v_cvt_pk_bf16_f32 v246, v76, v77
    v_mfma_f32_16x16x32_bf16 v[56:59], v[216:219], v[172:175], v[56:59]
    v_cvt_pk_bf16_f32 v247, v78, v79
    v_permlane16_swap_b32 v70, v74
    v_mfma_f32_16x16x32_bf16 v[60:63], v[172:175], v[220:223], v[60:63]
    v_permlane16_swap_b32 v71, v75
    ds_write_b64 v32, v[70:71] offset:256
    v_mfma_f32_16x16x32_bf16 v[64:67], v[224:227], v[172:175], v[64:67]
    ds_read_b64_tr_b16 v[232:233], v33 offset:256
    v_max3_f32 v160, v160, v161, v184
    v_max3_f32 v162, v162, v163, v186
    v_max_f32 v160, v160, v185
    v_max_f32 v161, v162, v187
    v_mfma_f32_16x16x32_bf16 v[156:159], v[68:71], v[88:91], v[12:15]
    v_cvt_pk_bf16_f32 v160, v160, v161
    v_cvt_pk_bf16_f32 v52, v52, v53
    v_cvt_pk_bf16_f32 v53, v54, v55
    v_mfma_f32_16x16x32_bf16 v[176:179], v[68:71], v[72:75], v[16:19]
    v_cvt_pk_bf16_f32 v56, v56, v57
    v_cvt_pk_bf16_f32 v57, v58, v59
    v_mov_b32 v58, 0
    v_mov_b32 v59, 0
    v_cvt_pk_bf16_f32 v54, v64, v65
    v_cvt_pk_bf16_f32 v55, v66, v67
    v_cvt_pk_bf16_f32 v244, v60, v61
    v_cvt_pk_bf16_f32 v245, v62, v63
    v_permlane16_swap_b32 v54, v58
    v_permlane16_swap_b32 v55, v59
    ds_write_b64 v32, v[54:55] offset:128
    ds_read_b64_tr_b16 v[230:231], v33 offset:128
    v_max3_f32 v156, v156, v157, v180
    v_max3_f32 v158, v158, v159, v182
    v_max_f32 v156, v156, v181
    v_mfma_f32_16x16x32_bf16 v[152:155], v[52:55], v[72:75], v[20:23]
    v_max_f32 v157, v158, v183
    v_cvt_pk_bf16_f32 v156, v156, v157
    v_mfma_f32_16x16x32_bf16 v[172:175], v[52:55], v[56:59], v[16:19]
    s_waitcnt lgkmcnt(4)
    v_readfirstlane_b32 s33, v3
    s_cmp_lt_u32 s33, 1811939328
    s_cbranch_scc1 K_XW
K_XR:
    v_mfma_f32_16x16x32_bf16 v[148:151], v[144:147], v[56:59], v[12:15]
    v_max3_f32 v152, v152, v153, v176
    v_max3_f32 v154, v154, v155, v178
    v_max_f32 v152, v152, v177
    v_max_f32 v153, v154, v179
    v_cvt_pk_bf16_f32 v152, v152, v153
    v_permlane16_swap_b32 v164, v168
    v_permlane16_swap_b32 v156, v160
    s_nop 1
    v_max3_f32 v148, v148, v149, v172
    v_max3_f32 v150, v150, v151, v174
    v_max_f32 v148, v148, v173
    v_max_f32 v149, v150, v175
    v_cvt_pk_bf16_f32 v148, v148, v149
    v_permlane32_swap_b32 v156, v164
    v_permlane32_swap_b32 v160, v168
    v_lshlrev_b32 v220, 16, v156
    v_and_b32 v221, 0xffff0000, v156
    v_lshlrev_b32 v224, 16, v164
    v_and_b32 v225, 0xffff0000, v164
    v_lshlrev_b32 v222, 16, v160
    v_and_b32 v223, 0xffff0000, v160
    v_lshlrev_b32 v226, 16, v168
    v_and_b32 v227, 0xffff0000, v168
    v_permlane16_swap_b32 v148, v152
    v_lshlrev_b32 v216, 16, v148
    v_and_b32 v217, 0xffff0000, v148
    v_lshlrev_b32 v218, 16, v152
    v_and_b32 v219, 0xffff0000, v152
    v_pk_mul_f32 v[220:221], v[220:221], s[60:61]
    v_pk_mul_f32 v[224:225], v[224:225], s[60:61]
    v_pk_mul_f32 v[222:223], v[222:223], s[60:61]
    v_pk_mul_f32 v[226:227], v[226:227], s[60:61]
    v_pk_mul_f32 v[216:217], v[216:217], s[60:61]
    v_pk_mul_f32 v[218:219], v[218:219], s[60:61]
    v_cvt_pk_bf16_f32 v156, v220, v221
    v_cvt_pk_bf16_f32 v164, v224, v225
    v_cvt_pk_bf16_f32 v160, v222, v223
    v_cvt_pk_bf16_f32 v168, v226, v227
    v_cvt_pk_bf16_f32 v148, v216, v217
    v_cvt_pk_bf16_f32 v152, v218, v219
    v_lshlrev_b32 v218, 16, v152
    v_and_b32 v219, 0xffff0000, v152
    v_lshlrev_b32 v216, 16, v148
    v_and_b32 v217, 0xffff0000, v148
    v_lshlrev_b32 v226, 16, v168
    v_and_b32 v227, 0xffff0000, v168
    v_lshlrev_b32 v222, 16, v160
    v_and_b32 v223, 0xffff0000, v160
    v_lshlrev_b32 v224, 16, v164
    v_and_b32 v225, 0xffff0000, v164
    v_lshlrev_b32 v220, 16, v156
    v_and_b32 v221, 0xffff0000, v156
    v_max3_f32 v174, v216, v217, v218
    v_max3_f32 v172, v220, v221, v224
    v_max_f32 v174, v174, v219
    v_max3_f32 v172, v172, v225, v222
    v_mov_b32 v176, v174
    v_max3_f32 v172, v172, v223, v226
    v_max_f32 v172, v172, v227
    v_permlane32_swap_b32 v174, v176
    v_mul_f32 v172, s58, v172
    v_max_f32 v174, v174, v176
    v_mul_f32 v174, s58, v174
    v_pk_fma_f32 v[220:221], v[220:221], s[58:59], v[172:173] op_sel_hi:[1,1,0] neg_lo:[0,0,1] neg_hi:[0,0,1]
    v_pk_fma_f32 v[222:223], v[222:223], s[58:59], v[172:173] op_sel_hi:[1,1,0] neg_lo:[0,0,1] neg_hi:[0,0,1]
    v_pk_fma_f32 v[224:225], v[224:225], s[58:59], v[172:173] op_sel_hi:[1,1,0] neg_lo:[0,0,1] neg_hi:[0,0,1]
    v_pk_fma_f32 v[226:227], v[226:227], s[58:59], v[172:173] op_sel_hi:[1,1,0] neg_lo:[0,0,1] neg_hi:[0,0,1]
    v_pk_fma_f32 v[216:217], v[216:217], s[58:59], v[174:175] op_sel_hi:[1,1,0] neg_lo:[0,0,1] neg_hi:[0,0,1]
    v_pk_fma_f32 v[218:219], v[218:219], s[58:59], v[174:175] op_sel_hi:[1,1,0] neg_lo:[0,0,1] neg_hi:[0,0,1]
    v_exp_f32 v216, v216
    v_exp_f32 v217, v217
    v_exp_f32 v218, v218
    v_exp_f32 v219, v219
    v_exp_f32 v220, v220
    v_exp_f32 v221, v221
    v_exp_f32 v222, v222
    v_exp_f32 v223, v223
    v_exp_f32 v224, v224
    v_exp_f32 v225, v225
    v_exp_f32 v226, v226
    v_exp_f32 v227, v227
    ds_read_b32 v3, v2 offset:28
    v_pk_add_f32 v[174:175], v[216:217], v[218:219]
    v_pk_add_f32 v[172:173], v[220:221], v[222:223]
    v_add_f32 v174, v174, v175
    v_pk_add_f32 v[178:179], v[224:225], v[226:227]
    v_mov_b32 v176, v174
    v_pk_add_f32 v[172:173], v[172:173], v[178:179]
    v_add_f32 v172, v172, v173
    v_permlane32_swap_b32 v174, v176
    v_rcp_f32 v172, v172
    v_add_f32 v174, v174, v176
    v_rcp_f32 v174, v174
    v_pk_mul_f32 v[220:221], v[220:221], v[172:173] op_sel_hi:[1,0]
    v_pk_mul_f32 v[222:223], v[222:223], v[172:173] op_sel_hi:[1,0]
    v_pk_mul_f32 v[224:225], v[224:225], v[172:173] op_sel_hi:[1,0]
    v_pk_mul_f32 v[226:227], v[226:227], v[172:173] op_sel_hi:[1,0]
    v_pk_mul_f32 v[216:217], v[216:217], v[174:175] op_sel_hi:[1,0]
    v_pk_mul_f32 v[218:219], v[218:219], v[174:175] op_sel_hi:[1,0]
    v_cvt_pk_bf16_f32 v156, v220, v221
    v_cvt_pk_bf16_f32 v164, v224, v225
    v_cvt_pk_bf16_f32 v160, v222, v223
    v_cvt_pk_bf16_f32 v168, v226, v227
    v_cvt_pk_bf16_f32 v148, v216, v217
    v_cvt_pk_bf16_f32 v152, v218, v219
    v_permlane32_swap_b32 v156, v164
    v_permlane32_swap_b32 v160, v168
    v_permlane16_swap_b32 v148, v152
    s_waitcnt lgkmcnt(0)
    v_permlane16_swap_b32 v156, v160
    v_permlane16_swap_b32 v164, v168
    v_readfirstlane_b32 s33, v3
    s_cmp_lt_u32 s33, 1811939332
    s_cbranch_scc1 K_PW
K_PR:
    s_and_b32 s3, s36, 0xffc00
    s_cbranch_scc0 K_NOHa3
    v_mov_b32 v4, s36
    s_mov_b32 exec_lo, s37
    s_mov_b32 exec_hi, 0
    global_atomic_add v37, v4, s[6:7] sc1
    s_mov_b64 exec, -1
K_NOHa3:
    v_perm_b32 v56, v148, v148, v24
    v_perm_b32 v57, v148, v148, v25
    v_perm_b32 v58, v148, v148, v26
    v_perm_b32 v59, v148, v148, v27
    v_perm_b32 v72, v152, v152, v24
    v_perm_b32 v73, v152, v152, v25
    v_mfma_f32_16x16x32_bf16 v[64:67], v[228:231], v[56:59], 0
    v_perm_b32 v74, v152, v152, v26
    v_perm_b32 v75, v152, v152, v27
    v_mfma_f32_16x16x32_bf16 v[60:63], v[242:245], v[56:59], 0
    v_perm_b32 v88, v156, v156, v24
    v_perm_b32 v89, v156, v156, v25
    v_mfma_f32_16x16x32_bf16 v[80:83], v[230:233], v[72:75], 0
    v_perm_b32 v90, v156, v156, v26
    v_perm_b32 v91, v156, v156, v27
    v_mfma_f32_16x16x32_bf16 v[76:79], v[244:247], v[72:75], 0
    v_perm_b32 v104, v160, v160, v24
    v_perm_b32 v105, v160, v160, v25
    v_mfma_f32_16x16x32_bf16 v[96:99], v[232:235], v[88:91], 0
    v_perm_b32 v106, v160, v160, v26
    v_perm_b32 v107, v160, v160, v27
    v_mfma_f32_16x16x32_bf16 v[92:95], v[246:249], v[88:91], 0
    v_cvt_pk_bf16_f32 v68, v64, v65
    v_cvt_pk_bf16_f32 v69, v66, v67
    ds_write_b64 v35, v[68:69] offset:0
    v_perm_b32 v120, v164, v164, v24
    v_perm_b32 v121, v164, v164, v25
    v_mfma_f32_16x16x32_bf16 v[112:115], v[234:237], v[104:107], 0
    v_perm_b32 v122, v164, v164, v26
    v_perm_b32 v123, v164, v164, v27
    v_mfma_f32_16x16x32_bf16 v[108:111], v[248:251], v[104:107], 0
    v_cvt_pk_bf16_f32 v70, v80, v81
    v_cvt_pk_bf16_f32 v71, v82, v83
    ds_write_b64 v35, v[70:71] offset:256
    v_perm_b32 v136, v168, v168, v24
    v_perm_b32 v137, v168, v168, v25
    v_mfma_f32_16x16x32_bf16 v[128:131], v[236:239], v[120:123], 0
    v_perm_b32 v138, v168, v168, v26
    v_perm_b32 v139, v168, v168, v27
    v_mfma_f32_16x16x32_bf16 v[124:127], v[250:253], v[120:123], 0
    v_cvt_pk_bf16_f32 v100, v96, v97
    v_cvt_pk_bf16_f32 v101, v98, v99
    ds_write_b64 v35, v[100:101] offset:512
    v_mov_b32 v3, 1
    v_mfma_f32_16x16x32_bf16 v[144:147], v[238:241], v[136:139], 0
    s_and_b32 s3, s36, 0x3ff
    s_cbranch_scc0 K_NOHa4
    v_mov_b32 v4, s36
    s_mov_b32 exec_lo, s37
    s_mov_b32 exec_hi, 0
    global_atomic_add v37, v4, s[6:7] sc1
    s_mov_b64 exec, -1
K_NOHa4:
    v_lshl_add_u32 v2, s54, 2, v38
    v_cvt_pk_bf16_f32 v102, v112, v113
    v_cvt_pk_bf16_f32 v103, v114, v115
    ds_write_b64 v35, v[102:103] offset:768
    v_mfma_f32_16x16x32_bf16 v[140:143], v[252:255], v[136:139], 0
    v_cvt_pk_bf16_f32 v132, v128, v129
    v_cvt_pk_bf16_f32 v133, v130, v131
    ds_write_b64 v35, v[132:133] offset:1024
    v_cvt_pk_bf16_f32 v134, v144, v145
    v_cvt_pk_bf16_f32 v135, v146, v147
    ds_write_b64 v35, v[134:135] offset:1280
    s_mov_b64 exec, 1
    ds_add_u32 v2, v3 offset:48
    s_mov_b64 exec, -1
    v_cvt_pk_bf16_f32 v52, v60, v61
    v_cvt_pk_bf16_f32 v54, v76, v77
    v_cvt_pk_bf16_f32 v53, v62, v63
    v_cvt_pk_bf16_f32 v55, v78, v79
    s_nop 0
    v_permlane16_swap_b32 v52, v54
    v_permlane16_swap_b32 v53, v55
    v_min_u32 v52, -2, v52
    buffer_store_dwordx4 v[52:55], v28, s[20:23], 0 offen sc1
    v_cvt_pk_bf16_f32 v84, v92, v93
    v_cvt_pk_bf16_f32 v86, v108, v109
    v_cvt_pk_bf16_f32 v85, v94, v95
    v_cvt_pk_bf16_f32 v87, v110, v111
    s_nop 0
    v_permlane16_swap_b32 v84, v86
    v_permlane16_swap_b32 v85, v87
    v_min_u32 v84, -2, v84
    buffer_store_dwordx4 v[84:87], v29, s[20:23], 0 offen sc1
    ds_read_b32 v3, v2 offset:48
    ds_read_b128 v[196:199], v36
    v_cvt_pk_bf16_f32 v116, v124, v125
    v_cvt_pk_bf16_f32 v118, v140, v141
    v_cvt_pk_bf16_f32 v117, v126, v127
    v_cvt_pk_bf16_f32 v119, v142, v143
    s_nop 0
    v_permlane16_swap_b32 v116, v118
    v_permlane16_swap_b32 v117, v119
    v_min_u32 v116, -2, v116
    buffer_store_dwordx4 v[116:119], v30, s[20:23], 0 offen sc1
    s_waitcnt lgkmcnt(0)
    v_readfirstlane_b32 s33, v3
    s_cmp_lt_u32 s33, 2
    s_cbranch_scc1 K_TW
K_TR:
    v_min_u32 v196, -2, v196
    buffer_store_dwordx4 v[196:199], v31, s[20:23], 0 offen sc1
    s_cmp_eq_u32 s34, -1
    s_cbranch_scc1 K_END
    s_add_u32 s30, s30, 4
    s_branch K_P2_HELP
K_CHM3:
K_STM3:
    s_branch K_WRET_M
    s_nop 0
K_XW:
    s_mov_b32 s3, 1048576
K_CGX:
    ds_read_b32 v3, v2 offset:28
    s_sub_u32 s3, s3, 1
    s_waitcnt lgkmcnt(0)
    v_readfirstlane_b32 s33, v3
    s_cselect_b32 s33, 1811939328, s33
    s_cmp_lt_u32 s33, 1811939328
    s_cbranch_scc1 K_CGX
    ds_read_b64 v[144:145], v34
    ds_read_b64 v[146:147], v34 offset:512
    ds_read_b64 v[242:243], v34 offset:1024
    ds_read_b64_tr_b16 v[228:229], v33
    s_waitcnt lgkmcnt(0)
    s_branch K_XR
K_PW:
    s_mov_b32 s3, 1048576
K_CGP:
    ds_read_b32 v3, v2 offset:28
    s_sub_u32 s3, s3, 1
    s_waitcnt lgkmcnt(0)
    v_readfirstlane_b32 s33, v3
    s_cselect_b32 s33, 1811939332, s33
    s_cmp_lt_u32 s33, 1811939332
    s_cbranch_scc1 K_CGP
    s_branch K_PR
K_TW:
    s_mov_b32 s3, 1048576
K_CGT:
    ds_read_b32 v3, v2 offset:48
    s_sub_u32 s3, s3, 1
    s_waitcnt lgkmcnt(0)
    v_readfirstlane_b32 s33, v3
    s_cselect_b32 s33, 2, s33
    s_cmp_lt_u32 s33, 2
    s_cbranch_scc1 K_CGT
    ds_read_b128 v[196:199], v36
    s_waitcnt lgkmcnt(0)
    s_branch K_TR
K_P2_EARLY:
    s_lshl_b32 s62, s40, 7
    v_lshrrev_b32 v8, 3, v1
    v_lshrrev_b32 v9, 4, v1
    v_mov_b32 v15, 158720
    s_lshl_b32 s61, s40, 3
    s_add_u32 s61, s61, s30
    s_mul_i32 s3, s61, 20480
    s_lshl_b32 s33, s41, 7
    s_add_u32 s3, s3, s33
    v_and_b32 v2, 7, v1
    v_lshlrev_b32 v2, 4, v2
    v_mul_u32_u24 v4, 1280, v8
    v_add3_u32 v10, v2, v4, s3
    s_lshl_b32 s3, s30, 7
    s_add_u32 s3, s3, 159744
    v_lshl_add_u32 v11, v8, 3, s3
    s_mov_b32 s63, 10240
    s_add_u32 s20, s6, 0x100000
    s_addc_u32 s21, s7, 0
    s_mov_b32 s22, 0x280000
    s_mov_b32 s23, 0x20000
    s_mov_b32 s56, s10
    s_mov_b32 s57, s11
    s_mov_b32 s58, 0x280000
    s_mov_b32 s59, 0x20000
    v_mul_u32_u24 v3, 144, v8
    v_add_u32 v3, v2, v3
    s_mul_i32 s3, s30, 2304
    s_add_u32 s3, s3, 140288
    v_add_u32 v14, s3, v3
    buffer_load_dwordx4 v[16:19], v10, s[12:15], 0 offen
    buffer_load_dwordx4 v[20:23], v10, s[12:15], s63 offen
    v_bfe_u32 v48, v1, 2, 2
    v_and_b32 v49, 3, v1
    s_add_u32 s3, s61, s30
    s_lshr_b32 s33, s3, 2
    s_mul_i32 s33, s33, 76
    s_add_u32 s3, s3, s33
    s_lshl_b32 s3, s3, 10
    v_and_b32 v2, 15, v1
    v_lshl_add_u32 v2, v2, 4, s3
    v_lshrrev_b32 v3, 5, v1
    v_lshl_add_u32 v2, v3, 8, v2
    v_and_b32 v4, 1, v9
    v_lshl_add_u32 v52, v4, 10, v2
    v_mov_b32 v53, 0x1f000
    v_lshl_add_u32 v2, v3, 3, v48
    v_lshlrev_b32 v2, 7, v2
    v_lshl_add_u32 v2, v49, 3, v2
    v_lshl_add_u32 v2, v4, 5, v2
    v_lshrrev_b32 v4, 1, v48
    v_lshl_add_u32 v54, v4, 6, v2
    v_xor_b32 v55, 64, v54
    v_mov_b32 v56, v54
    v_mov_b32 v57, v54
    s_branch K_PG3
.p2align 12
K_CHA0:
K_STA4:
    s_branch K_STA8
K_CHB0:
K_STB4:
    s_branch K_STB8
K_PG3:
    v_and_b32 v2, 31, v1
    v_mul_u32_u24 v2, 144, v2
    v_lshl_add_u32 v2, v3, 3, v2
    s_mul_i32 s3, s30, 4608
    s_add_u32 s3, s3, 140288
    v_add_u32 v50, s3, v2
    s_and_b32 s33, s40, 3
    s_lshl_b32 s33, s33, 2
    s_lshr_b32 s33, 0xf63f, s33
    s_and_b32 s33, s33, 15
    s_lshl1_add_u32 s3, s30, 1
    s_cmp_ge_u32 s3, s33
    s_cselect_b32 s60, 24, 16
    s_cmp_gt_u32 s3, s33
    s_cselect_b32 s60, 20, s60
    v_add_u32 v58, s60, v15
    s_mov_b32 s64, -1
    s_mov_b32 s65, -1
    s_mov_b32 s66, -1
    s_mov_b32 s67, -1
    s_mov_b32 s68, -1
    s_mov_b32 s69, -1
    s_mov_b32 s70, 0xfffff
    s_mov_b32 s71, 131072
    v_mov_b32 v108, 0
    v_mov_b32 v109, 0
    v_mov_b32 v110, 0
    v_mov_b32 v111, 0
    v_mov_b32 v112, 0
    v_mov_b32 v113, 0
    v_mov_b32 v114, 0
    v_mov_b32 v115, 0
    v_mov_b32 v116, 0
    v_mov_b32 v117, 0
    v_mov_b32 v118, 0
    v_mov_b32 v119, 0
    v_mov_b32 v120, 0
    v_mov_b32 v121, 0
    v_mov_b32 v122, 0
    v_mov_b32 v123, 0
    v_mov_b32 v124, 0
    v_mov_b32 v125, 0
    v_mov_b32 v126, 0
    v_mov_b32 v127, 0
    v_mov_b32 v128, 0
    v_mov_b32 v129, 0
    v_mov_b32 v130, 0
    v_mov_b32 v131, 0
    v_mov_b32 v132, 0
    v_mov_b32 v133, 0
    v_mov_b32 v134, 0
    v_mov_b32 v135, 0
    v_mov_b32 v136, 0
    v_mov_b32 v137, 0
    v_mov_b32 v138, 0
    v_mov_b32 v139, 0
    s_barrier
    s_branch K_P2_AUXW
K_P2_GM:
    s_lshl_b32 s62, s40, 7
    v_lshrrev_b32 v8, 3, v1
    v_lshrrev_b32 v9, 4, v1
    v_mov_b32 v15, 158720
    s_lshl_b32 s61, s40, 3
    s_add_u32 s61, s61, s30
    s_mul_i32 s3, s61, 20480
    s_lshl_b32 s33, s41, 7
    s_add_u32 s3, s3, s33
    v_and_b32 v2, 7, v1
    v_lshlrev_b32 v2, 4, v2
    v_mul_u32_u24 v4, 1280, v8
    v_add3_u32 v10, v2, v4, s3
    s_lshl_b32 s3, s30, 7
    s_add_u32 s3, s3, 159744
    v_lshl_add_u32 v11, v8, 3, s3
    s_mov_b32 s63, 10240
    s_add_u32 s20, s6, 0x100000
    s_addc_u32 s21, s7, 0
    s_mov_b32 s22, 0x280000
    s_mov_b32 s23, 0x20000
    s_mov_b32 s56, s10
    s_mov_b32 s57, s11
    s_mov_b32 s58, 0x280000
    s_mov_b32 s59, 0x20000
    v_mul_u32_u24 v3, 144, v8
    v_add_u32 v3, v2, v3
    s_mul_i32 s3, s30, 2304
    s_add_u32 s3, s3, 140288
    v_add_u32 v14, s3, v3
    v_bfe_u32 v48, v1, 2, 2
    v_and_b32 v49, 3, v1
    s_add_u32 s3, s61, s30
    s_lshr_b32 s33, s3, 2
    s_mul_i32 s33, s33, 76
    s_add_u32 s3, s3, s33
    s_lshl_b32 s3, s3, 10
    v_and_b32 v2, 15, v1
    v_lshl_add_u32 v2, v2, 4, s3
    v_lshrrev_b32 v3, 5, v1
    v_lshl_add_u32 v2, v3, 8, v2
    v_and_b32 v4, 1, v9
    v_lshl_add_u32 v52, v4, 10, v2
    v_mov_b32 v53, 0x1f000
    v_lshl_add_u32 v2, v3, 3, v48
    v_lshlrev_b32 v2, 7, v2
    v_lshl_add_u32 v2, v49, 3, v2
    v_lshl_add_u32 v2, v4, 5, v2
    v_lshrrev_b32 v4, 1, v48
    v_lshl_add_u32 v54, v4, 6, v2
    v_xor_b32 v55, 64, v54
    v_mov_b32 v56, v54
    v_mov_b32 v57, v54
    v_and_b32 v2, 31, v1
    v_mul_u32_u24 v2, 144, v2
    v_lshl_add_u32 v2, v3, 3, v2
    s_mul_i32 s3, s30, 4608
    s_add_u32 s3, s3, 140288
    v_add_u32 v50, s3, v2
    s_and_b32 s33, s40, 3
    s_lshl_b32 s33, s33, 2
    s_lshr_b32 s33, 0xf63f, s33
    s_and_b32 s33, s33, 15
    s_lshl1_add_u32 s3, s30, 1
    s_cmp_ge_u32 s3, s33
    s_cselect_b32 s60, 24, 16
    s_cmp_gt_u32 s3, s33
    s_cselect_b32 s60, 20, s60
    v_add_u32 v58, s60, v15
    s_mov_b32 s64, -1
    s_mov_b32 s65, -1
    s_mov_b32 s66, -1
    s_mov_b32 s67, -1
    s_mov_b32 s68, -1
    s_mov_b32 s69, -1
    s_mov_b32 s70, 0xfffff
    s_mov_b32 s71, 131072
    v_mov_b32 v108, 0
    v_mov_b32 v109, 0
    v_mov_b32 v110, 0
    v_mov_b32 v111, 0
    v_mov_b32 v112, 0
    v_mov_b32 v113, 0
    v_mov_b32 v114, 0
    v_mov_b32 v115, 0
    v_mov_b32 v116, 0
    v_mov_b32 v117, 0
    v_mov_b32 v118, 0
    v_mov_b32 v119, 0
    v_mov_b32 v120, 0
    v_mov_b32 v121, 0
    v_mov_b32 v122, 0
    v_mov_b32 v123, 0
    v_mov_b32 v124, 0
    v_mov_b32 v125, 0
    v_mov_b32 v126, 0
    v_mov_b32 v127, 0
    v_mov_b32 v128, 0
    v_mov_b32 v129, 0
    v_mov_b32 v130, 0
    v_mov_b32 v131, 0
    v_mov_b32 v132, 0
    v_mov_b32 v133, 0
    v_mov_b32 v134, 0
    v_mov_b32 v135, 0
    v_mov_b32 v136, 0
    v_mov_b32 v137, 0
    v_mov_b32 v138, 0
    v_mov_b32 v139, 0
    buffer_load_dwordx4 v[16:19], v10, s[12:15], 0 offen
    buffer_load_dwordx4 v[20:23], v10, s[12:15], s63 offen
    s_cmp_eq_u32 s30, 0
    s_cbranch_scc1 K_CHB0
    s_cmp_eq_u32 s30, 1
    s_cbranch_scc1 K_CHB1
    s_cmp_eq_u32 s30, 2
    s_cbranch_scc1 K_CHB2
    s_branch K_CHB3
K_WRET_B:
    v_mov_b32 v3, 1
    s_waitcnt vmcnt(2)
    s_mov_b64 exec, 1
    ds_add_u32 v15, v3 offset:44
    s_mov_b64 exec, -1
    s_mov_b32 s3, 1048576
K_P2_GWM:
    ds_read_b32 v2, v15 offset:44
    s_sleep 1
    s_sub_u32 s3, s3, 1
    s_waitcnt lgkmcnt(0)
    v_readfirstlane_b32 s33, v2
    s_nop 3
    s_cselect_b32 s33, 4, s33
    s_cmp_lt_u32 s33, 4
    s_cbranch_scc1 K_P2_GWM
    ds_write_b32 v15, v15 offset:56
K_P2_GEMM:
    s_setprio 1
    s_add_u32 s53, s40, 1
    s_and_b32 s53, s53, 2
    s_mov_b32 s46, 0x84210
    s_mov_b32 s47, s46
    s_waitcnt vmcnt(0)
    v_lshlrev_b32 v32, 16, v16
    v_and_b32 v33, 0xffff0000, v16
    v_lshlrev_b32 v34, 16, v17
    v_and_b32 v35, 0xffff0000, v17
    v_lshlrev_b32 v36, 16, v18
    v_and_b32 v37, 0xffff0000, v18
    v_lshlrev_b32 v38, 16, v19
    v_and_b32 v39, 0xffff0000, v19
    v_lshlrev_b32 v40, 16, v20
    v_and_b32 v41, 0xffff0000, v20
    v_lshlrev_b32 v42, 16, v21
    v_and_b32 v43, 0xffff0000, v21
    v_lshlrev_b32 v44, 16, v22
    v_and_b32 v45, 0xffff0000, v22
    v_lshlrev_b32 v46, 16, v23
    v_and_b32 v47, 0xffff0000, v23
    s_branch K_SPL
K_IT0:
    v_mfma_f32_32x32x16_bf16 v[108:123], v[156:159], v[68:71], v[108:123]
    ds_read_b64_tr_b16 v[140:141], v56 offset:0
    ds_read_b64_tr_b16 v[142:143], v56 offset:512
    s_and_b32 s33, s50, s70
    s_cbranch_scc0 K_RF0
K_RB0:
    s_ff1_i32_b32 s51, s33
    ds_read_b64_tr_b16 v[144:145], v56 offset:2048
    v_mfma_f32_32x32x16_bf16 v[124:139], v[164:167], v[68:71], v[124:139]
    s_bitset0_b32 s70, s51
    s_lshl_b32 s64, s51, 12
    buffer_load_dwordx4 v[60:63], v52, s[20:23], s64 offen offset:0 sc1
    ds_read_b64_tr_b16 v[146:147], v56 offset:2560
    ds_read_b64_tr_b16 v[148:149], v57 offset:0
    v_mfma_f32_32x32x16_bf16 v[108:123], v[160:163], v[72:75], v[108:123]
    buffer_load_dwordx4 v[64:67], v52, s[20:23], s64 offen offset:512 sc1
    ds_read_b64_tr_b16 v[150:151], v57 offset:512
    ds_read_b64_tr_b16 v[152:153], v57 offset:2048
    ds_read_b64_tr_b16 v[154:155], v57 offset:2560
    v_mfma_f32_32x32x16_bf16 v[124:139], v[168:171], v[72:75], v[124:139]
K_TL0:
    s_waitcnt vmcnt(8) lgkmcnt(8)
    v_cmp_u_f32 vcc, v76, v80
    v_and_or_b32 v56, s68, v53, v54
    v_and_or_b32 v57, s68, v53, v55
    s_cbranch_vccnz K_FX1
K_IT1:
    v_mfma_f32_32x32x16_bf16 v[108:123], v[172:175], v[76:79], v[108:123]
    ds_read_b64_tr_b16 v[156:157], v56 offset:0
    ds_read_b64_tr_b16 v[158:159], v56 offset:512
    s_and_b32 s33, s50, s70
    s_cbranch_scc0 K_RF1
K_RB1:
    s_ff1_i32_b32 s51, s33
    ds_read_b64_tr_b16 v[160:161], v56 offset:2048
    v_mfma_f32_32x32x16_bf16 v[124:139], v[180:183], v[76:79], v[124:139]
    s_bitset0_b32 s70, s51
    s_lshl_b32 s65, s51, 12
    buffer_load_dwordx4 v[68:71], v52, s[20:23], s65 offen offset:0 sc1
    ds_read_b64_tr_b16 v[162:163], v56 offset:2560
    ds_read_b64_tr_b16 v[164:165], v57 offset:0
    v_mfma_f32_32x32x16_bf16 v[108:123], v[176:179], v[80:83], v[108:123]
    buffer_load_dwordx4 v[72:75], v52, s[20:23], s65 offen offset:512 sc1
    ds_read_b64_tr_b16 v[166:167], v57 offset:512
    ds_read_b64_tr_b16 v[168:169], v57 offset:2048
    ds_read_b64_tr_b16 v[170:171], v57 offset:2560
    v_mfma_f32_32x32x16_bf16 v[124:139], v[184:187], v[80:83], v[124:139]
K_TL1:
    s_waitcnt vmcnt(8) lgkmcnt(8)
    v_cmp_u_f32 vcc, v84, v88
    v_and_or_b32 v56, s69, v53, v54
    v_and_or_b32 v57, s69, v53, v55
    s_cbranch_vccnz K_FX2
K_IT2:
    v_mfma_f32_32x32x16_bf16 v[108:123], v[140:143], v[84:87], v[108:123]
    ds_read_b64_tr_b16 v[172:173], v56 offset:0
    ds_read_b64_tr_b16 v[174:175], v56 offset:512
    s_and_b32 s33, s50, s70
    s_cbranch_scc0 K_RF2
K_RB2:
    s_ff1_i32_b32 s51, s33
    ds_read_b64_tr_b16 v[176:177], v56 offset:2048
    v_mfma_f32_32x32x16_bf16 v[124:139], v[148:151], v[84:87], v[124:139]
    s_bitset0_b32 s70, s51
    s_lshl_b32 s66, s51, 12
    buffer_load_dwordx4 v[76:79], v52, s[20:23], s66 offen offset:0 sc1
    ds_read_b64_tr_b16 v[178:179], v56 offset:2560
    ds_read_b64_tr_b16 v[180:181], v57 offset:0
    v_mfma_f32_32x32x16_bf16 v[108:123], v[144:147], v[88:91], v[108:123]
    buffer_load_dwordx4 v[80:83], v52, s[20:23], s66 offen offset:512 sc1
    ds_read_b64_tr_b16 v[182:183], v57 offset:512
    ds_read_b64_tr_b16 v[184:185], v57 offset:2048
    ds_read_b64_tr_b16 v[186:187], v57 offset:2560
    v_mfma_f32_32x32x16_bf16 v[124:139], v[152:155], v[88:91], v[124:139]
K_TL2:
    s_waitcnt vmcnt(8) lgkmcnt(8)
    v_cmp_u_f32 vcc, v92, v96
    v_and_or_b32 v56, s64, v53, v54
    v_and_or_b32 v57, s64, v53, v55
    s_cbranch_vccnz K_FX3
K_IT3:
    v_mfma_f32_32x32x16_bf16 v[108:123], v[156:159], v[92:95], v[108:123]
    ds_read_b64_tr_b16 v[140:141], v56 offset:0
    ds_read_b64_tr_b16 v[142:143], v56 offset:512
    s_and_b32 s33, s50, s70
    s_cbranch_scc0 K_RF3
K_RB3:
    s_ff1_i32_b32 s51, s33
    ds_read_b64_tr_b16 v[144:145], v56 offset:2048
    v_mfma_f32_32x32x16_bf16 v[124:139], v[164:167], v[92:95], v[124:139]
    s_bitset0_b32 s70, s51
    s_lshl_b32 s67, s51, 12
    buffer_load_dwordx4 v[84:87], v52, s[20:23], s67 offen offset:0 sc1
    ds_read_b64_tr_b16 v[146:147], v56 offset:2560
    ds_read_b64_tr_b16 v[148:149], v57 offset:0
    v_mfma_f32_32x32x16_bf16 v[108:123], v[160:163], v[96:99], v[108:123]
    buffer_load_dwordx4 v[88:91], v52, s[20:23], s67 offen offset:512 sc1
    ds_read_b64_tr_b16 v[150:151], v57 offset:512
    ds_read_b64_tr_b16 v[152:153], v57 offset:2048
    ds_read_b64_tr_b16 v[154:155], v57 offset:2560
    v_mfma_f32_32x32x16_bf16 v[124:139], v[168:171], v[96:99], v[124:139]
K_TL3:
    s_waitcnt vmcnt(8) lgkmcnt(8)
    v_cmp_u_f32 vcc, v100, v104
    v_and_or_b32 v56, s65, v53, v54
    v_and_or_b32 v57, s65, v53, v55
    s_cbranch_vccnz K_FX4
K_IT4:
    v_mfma_f32_32x32x16_bf16 v[108:123], v[172:175], v[100:103], v[108:123]
    ds_read_b64_tr_b16 v[156:157], v56 offset:0
    ds_read_b64_tr_b16 v[158:159], v56 offset:512
    s_and_b32 s33, s50, s70
    s_cbranch_scc0 K_RF4
K_RB4:
    s_ff1_i32_b32 s51, s33
    ds_read_b64_tr_b16 v[160:161], v56 offset:2048
    v_mfma_f32_32x32x16_bf16 v[124:139], v[180:183], v[100:103], v[124:139]
    s_bitset0_b32 s70, s51
    s_lshl_b32 s68, s51, 12
    buffer_load_dwordx4 v[92:95], v52, s[20:23], s68 offen offset:0 sc1
    ds_read_b64_tr_b16 v[162:163], v56 offset:2560
    ds_read_b64_tr_b16 v[164:165], v57 offset:0
    v_mfma_f32_32x32x16_bf16 v[108:123], v[176:179], v[104:107], v[108:123]
    buffer_load_dwordx4 v[96:99], v52, s[20:23], s68 offen offset:512 sc1
    ds_read_b64_tr_b16 v[166:167], v57 offset:512
    ds_read_b64_tr_b16 v[168:169], v57 offset:2048
    ds_read_b64_tr_b16 v[170:171], v57 offset:2560
    v_mfma_f32_32x32x16_bf16 v[124:139], v[184:187], v[104:107], v[124:139]
K_TL4:
    s_waitcnt vmcnt(8) lgkmcnt(8)
    v_cmp_u_f32 vcc, v60, v64
    v_and_or_b32 v56, s66, v53, v54
    v_and_or_b32 v57, s66, v53, v55
    s_cbranch_vccnz K_FX5
K_IT5:
    v_mfma_f32_32x32x16_bf16 v[108:123], v[140:143], v[60:63], v[108:123]
    ds_read_b64_tr_b16 v[172:173], v56 offset:0
    ds_read_b64_tr_b16 v[174:175], v56 offset:512
    s_and_b32 s33, s50, s70
    s_cbranch_scc0 K_RF5
K_RB5:
    s_ff1_i32_b32 s51, s33
    ds_read_b64_tr_b16 v[176:177], v56 offset:2048
    v_mfma_f32_32x32x16_bf16 v[124:139], v[148:151], v[60:63], v[124:139]
    s_bitset0_b32 s70, s51
    s_lshl_b32 s69, s51, 12
    buffer_load_dwordx4 v[100:103], v52, s[20:23], s69 offen offset:0 sc1
    ds_read_b64_tr_b16 v[178:179], v56 offset:2560
    ds_read_b64_tr_b16 v[180:181], v57 offset:0
    v_mfma_f32_32x32x16_bf16 v[108:123], v[144:147], v[64:67], v[108:123]
    buffer_load_dwordx4 v[104:107], v52, s[20:23], s69 offen offset:512 sc1
    ds_read_b64_tr_b16 v[182:183], v57 offset:512
    ds_read_b64_tr_b16 v[184:185], v57 offset:2048
    ds_read_b64_tr_b16 v[186:187], v57 offset:2560
    v_mfma_f32_32x32x16_bf16 v[124:139], v[152:155], v[64:67], v[124:139]
K_TL5:
    s_waitcnt vmcnt(8) lgkmcnt(8)
    v_cmp_u_f32 vcc, v68, v72
    v_and_or_b32 v56, s67, v53, v54
    v_and_or_b32 v57, s67, v53, v55
    s_cbranch_vccnz K_FX0
    s_branch K_IT0
K_DR0:
    v_mfma_f32_32x32x16_bf16 v[108:123], v[156:159], v[68:71], v[108:123]
    ds_read_b64_tr_b16 v[140:141], v56 offset:0
    ds_read_b64_tr_b16 v[142:143], v56 offset:512
K_DM0:
    ds_read_b64_tr_b16 v[144:145], v56 offset:2048
    s_mov_b32 s64, -1
    v_mfma_f32_32x32x16_bf16 v[124:139], v[164:167], v[68:71], v[124:139]
    buffer_load_dword v3, v52, s[20:23], s64 offen
    ds_read_b64_tr_b16 v[146:147], v56 offset:2560
    ds_read_b64_tr_b16 v[148:149], v57 offset:0
    v_mfma_f32_32x32x16_bf16 v[108:123], v[160:163], v[72:75], v[108:123]
    buffer_load_dword v3, v52, s[20:23], s64 offen
    ds_read_b64_tr_b16 v[150:151], v57 offset:512
    ds_read_b64_tr_b16 v[152:153], v57 offset:2048
    ds_read_b64_tr_b16 v[154:155], v57 offset:2560
    v_mfma_f32_32x32x16_bf16 v[124:139], v[168:171], v[72:75], v[124:139]
    s_waitcnt vmcnt(8) lgkmcnt(8)
    v_cmp_u_f32 vcc, v76, v80
    v_and_or_b32 v56, s68, v53, v54
    v_and_or_b32 v57, s68, v53, v55
    v_mov_b32 v60, -1
    s_cbranch_vccnz K_DX1
K_DR1:
    v_mfma_f32_32x32x16_bf16 v[108:123], v[172:175], v[76:79], v[108:123]
    ds_read_b64_tr_b16 v[156:157], v56 offset:0
    ds_read_b64_tr_b16 v[158:159], v56 offset:512
K_DM1:
    ds_read_b64_tr_b16 v[160:161], v56 offset:2048
    s_mov_b32 s65, -1
    v_mfma_f32_32x32x16_bf16 v[124:139], v[180:183], v[76:79], v[124:139]
    buffer_load_dword v3, v52, s[20:23], s65 offen
    ds_read_b64_tr_b16 v[162:163], v56 offset:2560
    ds_read_b64_tr_b16 v[164:165], v57 offset:0
    v_mfma_f32_32x32x16_bf16 v[108:123], v[176:179], v[80:83], v[108:123]
    buffer_load_dword v3, v52, s[20:23], s65 offen
    ds_read_b64_tr_b16 v[166:167], v57 offset:512
    ds_read_b64_tr_b16 v[168:169], v57 offset:2048
    ds_read_b64_tr_b16 v[170:171], v57 offset:2560
    v_mfma_f32_32x32x16_bf16 v[124:139], v[184:187], v[80:83], v[124:139]
    s_waitcnt vmcnt(8) lgkmcnt(8)
    v_cmp_u_f32 vcc, v84, v88
    v_and_or_b32 v56, s69, v53, v54
    v_and_or_b32 v57, s69, v53, v55
    v_mov_b32 v68, -1
    s_cbranch_vccnz K_DX2
K_DR2:
    v_mfma_f32_32x32x16_bf16 v[108:123], v[140:143], v[84:87], v[108:123]
    ds_read_b64_tr_b16 v[172:173], v56 offset:0
    ds_read_b64_tr_b16 v[174:175], v56 offset:512
K_DM2:
    ds_read_b64_tr_b16 v[176:177], v56 offset:2048
    s_mov_b32 s66, -1
    v_mfma_f32_32x32x16_bf16 v[124:139], v[148:151], v[84:87], v[124:139]
    buffer_load_dword v3, v52, s[20:23], s66 offen
    ds_read_b64_tr_b16 v[178:179], v56 offset:2560
    ds_read_b64_tr_b16 v[180:181], v57 offset:0
    v_mfma_f32_32x32x16_bf16 v[108:123], v[144:147], v[88:91], v[108:123]
    buffer_load_dword v3, v52, s[20:23], s66 offen
    ds_read_b64_tr_b16 v[182:183], v57 offset:512
    ds_read_b64_tr_b16 v[184:185], v57 offset:2048
    ds_read_b64_tr_b16 v[186:187], v57 offset:2560
    v_mfma_f32_32x32x16_bf16 v[124:139], v[152:155], v[88:91], v[124:139]
    s_waitcnt vmcnt(8) lgkmcnt(8)
    v_cmp_u_f32 vcc, v92, v96
    v_and_or_b32 v56, s64, v53, v54
    v_and_or_b32 v57, s64, v53, v55
    v_mov_b32 v76, -1
    s_cbranch_vccnz K_DX3
K_DR3:
    v_mfma_f32_32x32x16_bf16 v[108:123], v[156:159], v[92:95], v[108:123]
    ds_read_b64_tr_b16 v[140:141], v56 offset:0
    ds_read_b64_tr_b16 v[142:143], v56 offset:512
K_DM3:
    ds_read_b64_tr_b16 v[144:145], v56 offset:2048
    s_mov_b32 s67, -1
    v_mfma_f32_32x32x16_bf16 v[124:139], v[164:167], v[92:95], v[124:139]
    buffer_load_dword v3, v52, s[20:23], s67 offen
    ds_read_b64_tr_b16 v[146:147], v56 offset:2560
    ds_read_b64_tr_b16 v[148:149], v57 offset:0
    v_mfma_f32_32x32x16_bf16 v[108:123], v[160:163], v[96:99], v[108:123]
    buffer_load_dword v3, v52, s[20:23], s67 offen
    ds_read_b64_tr_b16 v[150:151], v57 offset:512
    ds_read_b64_tr_b16 v[152:153], v57 offset:2048
    ds_read_b64_tr_b16 v[154:155], v57 offset:2560
    v_mfma_f32_32x32x16_bf16 v[124:139], v[168:171], v[96:99], v[124:139]
    s_waitcnt vmcnt(8) lgkmcnt(8)
    v_cmp_u_f32 vcc, v100, v104
    v_and_or_b32 v56, s65, v53, v54
    v_and_or_b32 v57, s65, v53, v55
    v_mov_b32 v84, -1
    s_cbranch_vccnz K_DX4
K_DR4:
    v_mfma_f32_32x32x16_bf16 v[108:123], v[172:175], v[100:103], v[108:123]
    ds_read_b64_tr_b16 v[156:157], v56 offset:0
    ds_read_b64_tr_b16 v[158:159], v56 offset:512
K_DM4:
    ds_read_b64_tr_b16 v[160:161], v56 offset:2048
    s_mov_b32 s68, -1
    v_mfma_f32_32x32x16_bf16 v[124:139], v[180:183], v[100:103], v[124:139]
    buffer_load_dword v3, v52, s[20:23], s68 offen
    ds_read_b64_tr_b16 v[162:163], v56 offset:2560
    ds_read_b64_tr_b16 v[164:165], v57 offset:0
    v_mfma_f32_32x32x16_bf16 v[108:123], v[176:179], v[104:107], v[108:123]
    buffer_load_dword v3, v52, s[20:23], s68 offen
    ds_read_b64_tr_b16 v[166:167], v57 offset:512
    ds_read_b64_tr_b16 v[168:169], v57 offset:2048
    ds_read_b64_tr_b16 v[170:171], v57 offset:2560
    v_mfma_f32_32x32x16_bf16 v[124:139], v[184:187], v[104:107], v[124:139]
    s_waitcnt vmcnt(8) lgkmcnt(8)
    v_cmp_u_f32 vcc, v60, v64
    v_and_or_b32 v56, s66, v53, v54
    v_and_or_b32 v57, s66, v53, v55
    v_mov_b32 v92, -1
    s_cbranch_vccnz K_DX5
K_DR5:
    v_mfma_f32_32x32x16_bf16 v[108:123], v[140:143], v[60:63], v[108:123]
    ds_read_b64_tr_b16 v[172:173], v56 offset:0
    ds_read_b64_tr_b16 v[174:175], v56 offset:512
K_DM5:
    ds_read_b64_tr_b16 v[176:177], v56 offset:2048
    s_mov_b32 s69, -1
    v_mfma_f32_32x32x16_bf16 v[124:139], v[148:151], v[60:63], v[124:139]
    buffer_load_dword v3, v52, s[20:23], s69 offen
    ds_read_b64_tr_b16 v[178:179], v56 offset:2560
    ds_read_b64_tr_b16 v[180:181], v57 offset:0
    v_mfma_f32_32x32x16_bf16 v[108:123], v[144:147], v[64:67], v[108:123]
    buffer_load_dword v3, v52, s[20:23], s69 offen
    ds_read_b64_tr_b16 v[182:183], v57 offset:512
    ds_read_b64_tr_b16 v[184:185], v57 offset:2048
    ds_read_b64_tr_b16 v[186:187], v57 offset:2560
    v_mfma_f32_32x32x16_bf16 v[124:139], v[152:155], v[64:67], v[124:139]
    s_waitcnt vmcnt(8) lgkmcnt(8)
    v_cmp_u_f32 vcc, v68, v72
    v_and_or_b32 v56, s67, v53, v54
    v_and_or_b32 v57, s67, v53, v55
    v_mov_b32 v100, -1
    s_cbranch_vccnz K_DX0
    s_branch K_DR0
K_CHA1:
K_STA5:
    s_branch K_STA9
K_CHB1:
K_STB5:
    s_branch K_STB9
K_RF0:
    s_cmp_eq_u32 s70, 0
    s_cbranch_scc1 K_DM0
    ds_read_b32 v59, v58
    s_waitcnt lgkmcnt(0)
    v_readfirstlane_b32 s50, v59
    s_and_b32 s33, s50, s70
    s_cbranch_scc1 K_RB0
K_NV0:
    ds_read_b64_tr_b16 v[144:145], v56 offset:2048
    v_mfma_f32_32x32x16_bf16 v[124:139], v[164:167], v[68:71], v[124:139]
    s_mov_b32 s64, -1
    v_mov_b32 v60, -1
    buffer_load_dword v3, v52, s[20:23], s64 offen
    ds_read_b64_tr_b16 v[146:147], v56 offset:2560
    ds_read_b64_tr_b16 v[148:149], v57 offset:0
    v_mfma_f32_32x32x16_bf16 v[108:123], v[160:163], v[72:75], v[108:123]
    buffer_load_dword v3, v52, s[20:23], s64 offen
    ds_read_b64_tr_b16 v[150:151], v57 offset:512
    ds_read_b64_tr_b16 v[152:153], v57 offset:2048
    ds_read_b64_tr_b16 v[154:155], v57 offset:2560
    v_mfma_f32_32x32x16_bf16 v[124:139], v[168:171], v[72:75], v[124:139]
    s_branch K_TL0
K_DX0:
    s_and_b32 s51, s65, s66
    s_and_b32 s51, s51, s67
    s_and_b32 s51, s51, s68
    s_cmp_lt_i32 s51, 0
    s_cbranch_scc1 K_P2_MM
K_FX0:
    s_cmp_lt_i32 s65, 0
    s_cbranch_scc1 K_SK0
    v_max_u32 v2, v68, v72
    v_cmp_eq_u32 vcc, -1, v2
    s_cbranch_vccz K_IT0
    s_sub_u32 s71, s71, 1
    s_cbranch_scc1 K_IT0
    s_lshr_b32 s51, s65, 12
    s_bitset1_b32 s70, s51
K_SK0:
    s_and_b32 s33, s50, s70
    s_cbranch_scc0 K_NUL0
K_BK0:
    s_ff1_i32_b32 s51, s33
    s_lshl_b32 s64, s51, 12
    buffer_load_dwordx4 v[60:63], v52, s[20:23], s64 offen offset:0 sc1
    buffer_load_dwordx4 v[64:67], v52, s[20:23], s64 offen offset:512 sc1
    s_bitset0_b32 s70, s51
K_RD0:
    ds_read_b64_tr_b16 v[140:141], v56 offset:0
    ds_read_b64_tr_b16 v[142:143], v56 offset:512
    ds_read_b64_tr_b16 v[144:145], v56 offset:2048
    ds_read_b64_tr_b16 v[146:147], v56 offset:2560
    ds_read_b64_tr_b16 v[148:149], v57 offset:0
    ds_read_b64_tr_b16 v[150:151], v57 offset:512
    ds_read_b64_tr_b16 v[152:153], v57 offset:2048
    ds_read_b64_tr_b16 v[154:155], v57 offset:2560
    s_cmp_lt_i32 s66, 0
    s_cbranch_scc0 K_TL0
    v_and_or_b32 v56, s68, v53, v54
    v_and_or_b32 v57, s68, v53, v55
    s_branch K_SK1
K_NUL0:
    s_and_b32 s51, s66, s67
    s_and_b32 s51, s51, s68
    s_and_b32 s51, s51, s69
    s_cmp_lt_i32 s51, 0
    s_cbranch_scc0 K_PC0
    s_cmp_eq_u32 s70, 0
    s_cbranch_scc1 K_P2_MM
    s_branch K_SPN
K_PC0:
    s_cmp_eq_u32 s70, 0
    s_cbranch_scc1 K_NI0
    ds_read_b32 v59, v58
    s_waitcnt lgkmcnt(0)
    v_readfirstlane_b32 s50, v59
    s_and_b32 s33, s50, s70
    s_cbranch_scc1 K_BK0
    ds_read_b32 v59, v58
    s_waitcnt lgkmcnt(0)
    v_readfirstlane_b32 s50, v59
    s_and_b32 s33, s50, s70
    s_cbranch_scc1 K_BK0
K_NI0:
    s_mov_b32 s64, -1
    v_mov_b32 v60, -1
    buffer_load_dword v3, v52, s[20:23], s64 offen
    buffer_load_dword v3, v52, s[20:23], s64 offen
    s_branch K_RD0
K_RF1:
    s_cmp_eq_u32 s70, 0
    s_cbranch_scc1 K_DM1
    ds_read_b32 v59, v58
    s_waitcnt lgkmcnt(0)
    v_readfirstlane_b32 s50, v59
    s_and_b32 s33, s50, s70
    s_cbranch_scc1 K_RB1
K_NV1:
    ds_read_b64_tr_b16 v[160:161], v56 offset:2048
    v_mfma_f32_32x32x16_bf16 v[124:139], v[180:183], v[76:79], v[124:139]
    s_mov_b32 s65, -1
    v_mov_b32 v68, -1
    buffer_load_dword v3, v52, s[20:23], s65 offen
    ds_read_b64_tr_b16 v[162:163], v56 offset:2560
    ds_read_b64_tr_b16 v[164:165], v57 offset:0
    v_mfma_f32_32x32x16_bf16 v[108:123], v[176:179], v[80:83], v[108:123]
    buffer_load_dword v3, v52, s[20:23], s65 offen
    ds_read_b64_tr_b16 v[166:167], v57 offset:512
    ds_read_b64_tr_b16 v[168:169], v57 offset:2048
    ds_read_b64_tr_b16 v[170:171], v57 offset:2560
    v_mfma_f32_32x32x16_bf16 v[124:139], v[184:187], v[80:83], v[124:139]
    s_branch K_TL1
K_CHA2:
K_STA6:
    s_branch K_STA10
K_CHB2:
K_STB6:
    s_branch K_STB10
K_DX1:
    s_and_b32 s51, s66, s67
    s_and_b32 s51, s51, s68
    s_and_b32 s51, s51, s69
    s_cmp_lt_i32 s51, 0
    s_cbranch_scc1 K_P2_MM
K_FX1:
    s_cmp_lt_i32 s66, 0
    s_cbranch_scc1 K_SK1
    v_max_u32 v2, v76, v80
    v_cmp_eq_u32 vcc, -1, v2
    s_cbranch_vccz K_IT1
    s_sub_u32 s71, s71, 1
    s_cbranch_scc1 K_IT1
    s_lshr_b32 s51, s66, 12
    s_bitset1_b32 s70, s51
K_SK1:
    s_and_b32 s33, s50, s70
    s_cbranch_scc0 K_NUL1
K_BK1:
    s_ff1_i32_b32 s51, s33
    s_lshl_b32 s65, s51, 12
    buffer_load_dwordx4 v[68:71], v52, s[20:23], s65 offen offset:0 sc1
    buffer_load_dwordx4 v[72:75], v52, s[20:23], s65 offen offset:512 sc1
    s_bitset0_b32 s70, s51
K_RD1:
    ds_read_b64_tr_b16 v[156:157], v56 offset:0
    ds_read_b64_tr_b16 v[158:159], v56 offset:512
    ds_read_b64_tr_b16 v[160:161], v56 offset:2048
    ds_read_b64_tr_b16 v[162:163], v56 offset:2560
    ds_read_b64_tr_b16 v[164:165], v57 offset:0
    ds_read_b64_tr_b16 v[166:167], v57 offset:512
    ds_read_b64_tr_b16 v[168:169], v57 offset:2048
    ds_read_b64_tr_b16 v[170:171], v57 offset:2560
    s_cmp_lt_i32 s67, 0
    s_cbranch_scc0 K_TL1
    v_and_or_b32 v56, s69, v53, v54
    v_and_or_b32 v57, s69, v53, v55
    s_branch K_SK2
K_NUL1:
    s_and_b32 s51, s64, s67
    s_and_b32 s51, s51, s68
    s_and_b32 s51, s51, s69
    s_cmp_lt_i32 s51, 0
    s_cbranch_scc0 K_PC1
    s_cmp_eq_u32 s70, 0
    s_cbranch_scc1 K_P2_MM
    s_branch K_SPN
K_PC1:
    s_cmp_eq_u32 s70, 0
    s_cbranch_scc1 K_NI1
    ds_read_b32 v59, v58
    s_waitcnt lgkmcnt(0)
    v_readfirstlane_b32 s50, v59
    s_and_b32 s33, s50, s70
    s_cbranch_scc1 K_BK1
    ds_read_b32 v59, v58
    s_waitcnt lgkmcnt(0)
    v_readfirstlane_b32 s50, v59
    s_and_b32 s33, s50, s70
    s_cbranch_scc1 K_BK1
K_NI1:
    s_mov_b32 s65, -1
    v_mov_b32 v68, -1
    buffer_load_dword v3, v52, s[20:23], s65 offen
    buffer_load_dword v3, v52, s[20:23], s65 offen
    s_branch K_RD1
K_RF2:
    s_cmp_eq_u32 s70, 0
    s_cbranch_scc1 K_DM2
    ds_read_b32 v59, v58
    s_waitcnt lgkmcnt(0)
    v_readfirstlane_b32 s50, v59
    s_and_b32 s33, s50, s70
    s_cbranch_scc1 K_RB2
K_NV2:
    ds_read_b64_tr_b16 v[176:177], v56 offset:2048
    v_mfma_f32_32x32x16_bf16 v[124:139], v[148:151], v[84:87], v[124:139]
    s_mov_b32 s66, -1
    v_mov_b32 v76, -1
    buffer_load_dword v3, v52, s[20:23], s66 offen
    ds_read_b64_tr_b16 v[178:179], v56 offset:2560
    ds_read_b64_tr_b16 v[180:181], v57 offset:0
    v_mfma_f32_32x32x16_bf16 v[108:123], v[144:147], v[88:91], v[108:123]
    buffer_load_dword v3, v52, s[20:23], s66 offen
    ds_read_b64_tr_b16 v[182:183], v57 offset:512
    ds_read_b64_tr_b16 v[184:185], v57 offset:2048
    ds_read_b64_tr_b16 v[186:187], v57 offset:2560
    v_mfma_f32_32x32x16_bf16 v[124:139], v[152:155], v[88:91], v[124:139]
    s_branch K_TL2
K_DX2:
    s_and_b32 s51, s64, s67
    s_and_b32 s51, s51, s68
    s_and_b32 s51, s51, s69
    s_cmp_lt_i32 s51, 0
    s_cbranch_scc1 K_P2_MM
K_FX2:
    s_cmp_lt_i32 s67, 0
    s_cbranch_scc1 K_SK2
    v_max_u32 v2, v84, v88
    v_cmp_eq_u32 vcc, -1, v2
    s_cbranch_vccz K_IT2
    s_sub_u32 s71, s71, 1
    s_cbranch_scc1 K_IT2
    s_lshr_b32 s51, s67, 12
    s_bitset1_b32 s70, s51
K_SK2:
    s_and_b32 s33, s50, s70
    s_cbranch_scc0 K_NUL2
K_BK2:
    s_ff1_i32_b32 s51, s33
    s_lshl_b32 s66, s51, 12
    buffer_load_dwordx4 v[76:79], v52, s[20:23], s66 offen offset:0 sc1
    buffer_load_dwordx4 v[80:83], v52, s[20:23], s66 offen offset:512 sc1
    s_bitset0_b32 s70, s51
K_RD2:
    ds_read_b64_tr_b16 v[172:173], v56 offset:0
    ds_read_b64_tr_b16 v[174:175], v56 offset:512
    ds_read_b64_tr_b16 v[176:177], v56 offset:2048
    ds_read_b64_tr_b16 v[178:179], v56 offset:2560
    ds_read_b64_tr_b16 v[180:181], v57 offset:0
    ds_read_b64_tr_b16 v[182:183], v57 offset:512
    s_branch K_PG4
.p2align 12
K_CHA3:
K_STA7:
    s_branch K_STA11
K_CHB3:
K_STB7:
    s_branch K_STB11
K_PG4:
    ds_read_b64_tr_b16 v[184:185], v57 offset:2048
    ds_read_b64_tr_b16 v[186:187], v57 offset:2560
    s_cmp_lt_i32 s68, 0
    s_cbranch_scc0 K_TL2
    v_and_or_b32 v56, s64, v53, v54
    v_and_or_b32 v57, s64, v53, v55
    s_branch K_SK3
K_NUL2:
    s_and_b32 s51, s64, s65
    s_and_b32 s51, s51, s68
    s_and_b32 s51, s51, s69
    s_cmp_lt_i32 s51, 0
    s_cbranch_scc0 K_PC2
    s_cmp_eq_u32 s70, 0
    s_cbranch_scc1 K_P2_MM
    s_branch K_SPN
K_PC2:
    s_cmp_eq_u32 s70, 0
    s_cbranch_scc1 K_NI2
    ds_read_b32 v59, v58
    s_waitcnt lgkmcnt(0)
    v_readfirstlane_b32 s50, v59
    s_and_b32 s33, s50, s70
    s_cbranch_scc1 K_BK2
    ds_read_b32 v59, v58
    s_waitcnt lgkmcnt(0)
    v_readfirstlane_b32 s50, v59
    s_and_b32 s33, s50, s70
    s_cbranch_scc1 K_BK2
K_NI2:
    s_mov_b32 s66, -1
    v_mov_b32 v76, -1
    buffer_load_dword v3, v52, s[20:23], s66 offen
    buffer_load_dword v3, v52, s[20:23], s66 offen
    s_branch K_RD2
K_RF3:
    s_cmp_eq_u32 s70, 0
    s_cbranch_scc1 K_DM3
    ds_read_b32 v59, v58
    s_waitcnt lgkmcnt(0)
    v_readfirstlane_b32 s50, v59
    s_and_b32 s33, s50, s70
    s_cbranch_scc1 K_RB3
K_NV3:
    ds_read_b64_tr_b16 v[144:145], v56 offset:2048
    v_mfma_f32_32x32x16_bf16 v[124:139], v[164:167], v[92:95], v[124:139]
    s_mov_b32 s67, -1
    v_mov_b32 v84, -1
    buffer_load_dword v3, v52, s[20:23], s67 offen
    ds_read_b64_tr_b16 v[146:147], v56 offset:2560
    ds_read_b64_tr_b16 v[148:149], v57 offset:0
    v_mfma_f32_32x32x16_bf16 v[108:123], v[160:163], v[96:99], v[108:123]
    buffer_load_dword v3, v52, s[20:23], s67 offen
    ds_read_b64_tr_b16 v[150:151], v57 offset:512
    ds_read_b64_tr_b16 v[152:153], v57 offset:2048
    ds_read_b64_tr_b16 v[154:155], v57 offset:2560
    v_mfma_f32_32x32x16_bf16 v[124:139], v[168:171], v[96:99], v[124:139]
    s_branch K_TL3
K_DX3:
    s_and_b32 s51, s64, s65
    s_and_b32 s51, s51, s68
    s_and_b32 s51, s51, s69
    s_cmp_lt_i32 s51, 0
    s_cbranch_scc1 K_P2_MM
K_FX3:
    s_cmp_lt_i32 s68, 0
    s_cbranch_scc1 K_SK3
    v_max_u32 v2, v92, v96
    v_cmp_eq_u32 vcc, -1, v2
    s_cbranch_vccz K_IT3
    s_sub_u32 s71, s71, 1
    s_cbranch_scc1 K_IT3
    s_lshr_b32 s51, s68, 12
    s_bitset1_b32 s70, s51
K_SK3:
    s_and_b32 s33, s50, s70
    s_cbranch_scc0 K_NUL3
K_BK3:
    s_ff1_i32_b32 s51, s33
    s_lshl_b32 s67, s51, 12
    buffer_load_dwordx4 v[84:87], v52, s[20:23], s67 offen offset:0 sc1
    buffer_load_dwordx4 v[88:91], v52, s[20:23], s67 offen offset:512 sc1
    s_bitset0_b32 s70, s51
K_RD3:
    ds_read_b64_tr_b16 v[140:141], v56 offset:0
    ds_read_b64_tr_b16 v[142:143], v56 offset:512
    ds_read_b64_tr_b16 v[144:145], v56 offset:2048
    ds_read_b64_tr_b16 v[146:147], v56 offset:2560
    ds_read_b64_tr_b16 v[148:149], v57 offset:0
    ds_read_b64_tr_b16 v[150:151], v57 offset:512
    ds_read_b64_tr_b16 v[152:153], v57 offset:2048
    ds_read_b64_tr_b16 v[154:155], v57 offset:2560
    s_cmp_lt_i32 s69, 0
    s_cbranch_scc0 K_TL3
    v_and_or_b32 v56, s65, v53, v54
    v_and_or_b32 v57, s65, v53, v55
    s_branch K_SK4
K_NUL3:
    s_and_b32 s51, s64, s65
    s_and_b32 s51, s51, s66
    s_and_b32 s51, s51, s69
    s_cmp_lt_i32 s51, 0
    s_cbranch_scc0 K_PC3
    s_cmp_eq_u32 s70, 0
    s_cbranch_scc1 K_P2_MM
    s_branch K_SPN
K_PC3:
    s_cmp_eq_u32 s70, 0
    s_cbranch_scc1 K_NI3
    ds_read_b32 v59, v58
    s_waitcnt lgkmcnt(0)
    v_readfirstlane_b32 s50, v59
    s_and_b32 s33, s50, s70
    s_cbranch_scc1 K_BK3
    ds_read_b32 v59, v58
    s_waitcnt lgkmcnt(0)
    v_readfirstlane_b32 s50, v59
    s_and_b32 s33, s50, s70
    s_cbranch_scc1 K_BK3
K_NI3:
    s_mov_b32 s67, -1
    v_mov_b32 v84, -1
    buffer_load_dword v3, v52, s[20:23], s67 offen
    buffer_load_dword v3, v52, s[20:23], s67 offen
    s_branch K_RD3
K_STA8:
    s_branch K_STA12
K_STB8:
    s_branch K_STB12
K_RF4:
    s_cmp_eq_u32 s70, 0
    s_cbranch_scc1 K_DM4
    ds_read_b32 v59, v58
    s_waitcnt lgkmcnt(0)
    v_readfirstlane_b32 s50, v59
    s_and_b32 s33, s50, s70
    s_cbranch_scc1 K_RB4
K_NV4:
    ds_read_b64_tr_b16 v[160:161], v56 offset:2048
    v_mfma_f32_32x32x16_bf16 v[124:139], v[180:183], v[100:103], v[124:139]
    s_mov_b32 s68, -1
    v_mov_b32 v92, -1
    buffer_load_dword v3, v52, s[20:23], s68 offen
    ds_read_b64_tr_b16 v[162:163], v56 offset:2560
    ds_read_b64_tr_b16 v[164:165], v57 offset:0
    v_mfma_f32_32x32x16_bf16 v[108:123], v[176:179], v[104:107], v[108:123]
    buffer_load_dword v3, v52, s[20:23], s68 offen
    ds_read_b64_tr_b16 v[166:167], v57 offset:512
    ds_read_b64_tr_b16 v[168:169], v57 offset:2048
    ds_read_b64_tr_b16 v[170:171], v57 offset:2560
    v_mfma_f32_32x32x16_bf16 v[124:139], v[184:187], v[104:107], v[124:139]
    s_branch K_TL4
K_DX4:
    s_and_b32 s51, s64, s65
    s_and_b32 s51, s51, s66
    s_and_b32 s51, s51, s69
    s_cmp_lt_i32 s51, 0
    s_cbranch_scc1 K_P2_MM
K_FX4:
    s_cmp_lt_i32 s69, 0
    s_cbranch_scc1 K_SK4
    v_max_u32 v2, v100, v104
    v_cmp_eq_u32 vcc, -1, v2
    s_cbranch_vccz K_IT4
    s_sub_u32 s71, s71, 1
    s_cbranch_scc1 K_IT4
    s_lshr_b32 s51, s69, 12
    s_bitset1_b32 s70, s51
K_SK4:
    s_and_b32 s33, s50, s70
    s_cbranch_scc0 K_NUL4
K_BK4:
    s_ff1_i32_b32 s51, s33
    s_lshl_b32 s68, s51, 12
    buffer_load_dwordx4 v[92:95], v52, s[20:23], s68 offen offset:0 sc1
    buffer_load_dwordx4 v[96:99], v52, s[20:23], s68 offen offset:512 sc1
    s_bitset0_b32 s70, s51
K_RD4:
    ds_read_b64_tr_b16 v[156:157], v56 offset:0
    ds_read_b64_tr_b16 v[158:159], v56 offset:512
    ds_read_b64_tr_b16 v[160:161], v56 offset:2048
    ds_read_b64_tr_b16 v[162:163], v56 offset:2560
    ds_read_b64_tr_b16 v[164:165], v57 offset:0
    ds_read_b64_tr_b16 v[166:167], v57 offset:512
    ds_read_b64_tr_b16 v[168:169], v57 offset:2048
    ds_read_b64_tr_b16 v[170:171], v57 offset:2560
    s_cmp_lt_i32 s64, 0
    s_cbranch_scc0 K_TL4
    v_and_or_b32 v56, s66, v53, v54
    v_and_or_b32 v57, s66, v53, v55
    s_branch K_SK5
K_NUL4:
    s_and_b32 s51, s64, s65
    s_and_b32 s51, s51, s66
    s_and_b32 s51, s51, s67
    s_cmp_lt_i32 s51, 0
    s_cbranch_scc0 K_PC4
    s_cmp_eq_u32 s70, 0
    s_cbranch_scc1 K_P2_MM
    s_branch K_SPN
K_PC4:
    s_cmp_eq_u32 s70, 0
    s_cbranch_scc1 K_NI4
    ds_read_b32 v59, v58
    s_waitcnt lgkmcnt(0)
    v_readfirstlane_b32 s50, v59
    s_and_b32 s33, s50, s70
    s_cbranch_scc1 K_BK4
    ds_read_b32 v59, v58
    s_waitcnt lgkmcnt(0)
    v_readfirstlane_b32 s50, v59
    s_and_b32 s33, s50, s70
    s_cbranch_scc1 K_BK4
K_NI4:
    s_mov_b32 s68, -1
    v_mov_b32 v92, -1
    buffer_load_dword v3, v52, s[20:23], s68 offen
    buffer_load_dword v3, v52, s[20:23], s68 offen
    s_branch K_RD4
K_RF5:
    s_cmp_eq_u32 s70, 0
    s_cbranch_scc1 K_DM5
    ds_read_b32 v59, v58
    s_waitcnt lgkmcnt(0)
    v_readfirstlane_b32 s50, v59
    s_and_b32 s33, s50, s70
    s_cbranch_scc1 K_RB5
K_NV5:
    ds_read_b64_tr_b16 v[176:177], v56 offset:2048
    v_mfma_f32_32x32x16_bf16 v[124:139], v[148:151], v[60:63], v[124:139]
    s_mov_b32 s69, -1
    v_mov_b32 v100, -1
    buffer_load_dword v3, v52, s[20:23], s69 offen
    ds_read_b64_tr_b16 v[178:179], v56 offset:2560
    ds_read_b64_tr_b16 v[180:181], v57 offset:0
    v_mfma_f32_32x32x16_bf16 v[108:123], v[144:147], v[64:67], v[108:123]
    buffer_load_dword v3, v52, s[20:23], s69 offen
    ds_read_b64_tr_b16 v[182:183], v57 offset:512
    ds_read_b64_tr_b16 v[184:185], v57 offset:2048
    ds_read_b64_tr_b16 v[186:187], v57 offset:2560
    v_mfma_f32_32x32x16_bf16 v[124:139], v[152:155], v[64:67], v[124:139]
    s_branch K_TL5
K_STA9:
    s_branch K_STA13
K_STB9:
    s_branch K_STB13
K_DX5:
    s_and_b32 s51, s64, s65
    s_and_b32 s51, s51, s66
    s_and_b32 s51, s51, s67
    s_cmp_lt_i32 s51, 0
    s_cbranch_scc1 K_P2_MM
K_FX5:
    s_cmp_lt_i32 s64, 0
    s_cbranch_scc1 K_SK5
    v_max_u32 v2, v60, v64
    v_cmp_eq_u32 vcc, -1, v2
    s_cbranch_vccz K_IT5
    s_sub_u32 s71, s71, 1
    s_cbranch_scc1 K_IT5
    s_lshr_b32 s51, s64, 12
    s_bitset1_b32 s70, s51
K_SK5:
    s_and_b32 s33, s50, s70
    s_cbranch_scc0 K_NUL5
K_BK5:
    s_ff1_i32_b32 s51, s33
    s_lshl_b32 s69, s51, 12
    buffer_load_dwordx4 v[100:103], v52, s[20:23], s69 offen offset:0 sc1
    buffer_load_dwordx4 v[104:107], v52, s[20:23], s69 offen offset:512 sc1
    s_bitset0_b32 s70, s51
K_RD5:
    ds_read_b64_tr_b16 v[172:173], v56 offset:0
    ds_read_b64_tr_b16 v[174:175], v56 offset:512
    ds_read_b64_tr_b16 v[176:177], v56 offset:2048
    ds_read_b64_tr_b16 v[178:179], v56 offset:2560
    ds_read_b64_tr_b16 v[180:181], v57 offset:0
    ds_read_b64_tr_b16 v[182:183], v57 offset:512
    ds_read_b64_tr_b16 v[184:185], v57 offset:2048
    ds_read_b64_tr_b16 v[186:187], v57 offset:2560
    s_cmp_lt_i32 s65, 0
    s_cbranch_scc0 K_TL5
    v_and_or_b32 v56, s67, v53, v54
    v_and_or_b32 v57, s67, v53, v55
    s_branch K_SK0
K_NUL5:
    s_and_b32 s51, s65, s66
    s_and_b32 s51, s51, s67
    s_and_b32 s51, s51, s68
    s_cmp_lt_i32 s51, 0
    s_cbranch_scc0 K_PC5
    s_cmp_eq_u32 s70, 0
    s_cbranch_scc1 K_P2_MM
    s_branch K_SPN
K_PC5:
    s_cmp_eq_u32 s70, 0
    s_cbranch_scc1 K_NI5
    ds_read_b32 v59, v58
    s_waitcnt lgkmcnt(0)
    v_readfirstlane_b32 s50, v59
    s_and_b32 s33, s50, s70
    s_cbranch_scc1 K_BK5
    ds_read_b32 v59, v58
    s_waitcnt lgkmcnt(0)
    v_readfirstlane_b32 s50, v59
    s_and_b32 s33, s50, s70
    s_cbranch_scc1 K_BK5
K_NI5:
    s_mov_b32 s69, -1
    v_mov_b32 v100, -1
    buffer_load_dword v3, v52, s[20:23], s69 offen
    buffer_load_dword v3, v52, s[20:23], s69 offen
    s_branch K_RD5
K_P2_MM:
    v_cvt_pk_bf16_f32 v188, v108, v109
    v_cvt_pk_bf16_f32 v189, v110, v111
    ds_write_b64 v50, v[188:189] offset:0
    v_cvt_pk_bf16_f32 v190, v112, v113
    v_cvt_pk_bf16_f32 v191, v114, v115
    ds_write_b64 v50, v[190:191] offset:16
    v_cvt_pk_bf16_f32 v192, v116, v117
    v_cvt_pk_bf16_f32 v193, v118, v119
    ds_write_b64 v50, v[192:193] offset:32
    v_cvt_pk_bf16_f32 v194, v120, v121
    v_cvt_pk_bf16_f32 v195, v122, v123
    ds_write_b64 v50, v[194:195] offset:48
    v_cvt_pk_bf16_f32 v188, v124, v125
    v_cvt_pk_bf16_f32 v189, v126, v127
    ds_write_b64 v50, v[188:189] offset:64
    v_cvt_pk_bf16_f32 v190, v128, v129
    v_cvt_pk_bf16_f32 v191, v130, v131
    ds_write_b64 v50, v[190:191] offset:80
    v_cvt_pk_bf16_f32 v192, v132, v133
    v_cvt_pk_bf16_f32 v193, v134, v135
    ds_write_b64 v50, v[192:193] offset:96
    v_cvt_pk_bf16_f32 v194, v136, v137
    v_cvt_pk_bf16_f32 v195, v138, v139
    ds_write_b64 v50, v[194:195] offset:112
K_P2_E2:
    s_waitcnt vmcnt(0) lgkmcnt(0)
    s_lshl_b32 s72, s61, 4
    s_barrier
    ds_read_b64 v[28:29], v15
    ds_read_b64 v[24:25], v11
    ds_read_b128 v[48:51], v14
    ds_read_b64 v[26:27], v11 offset:64
    ds_read_b128 v[52:55], v14 offset:1152
    s_waitcnt lgkmcnt(4)
    v_readfirstlane_b32 s48, v28
    v_readfirstlane_b32 s49, v29
    s_sub_u32 s3, s48, s72
    s_cmp_lt_u32 s3, 16
    s_cbranch_scc1 K_YROW0
K_NOY0:
    s_sub_u32 s3, s49, s72
    s_cmp_lt_u32 s3, 16
    s_cbranch_scc1 K_YROW1
K_NOY1:
    s_waitcnt lgkmcnt(3)
    v_pk_mul_f32 v[32:33], v[32:33], v[24:25] op_sel:[0,1] op_sel_hi:[1,1]
    v_pk_mul_f32 v[34:35], v[34:35], v[24:25] op_sel:[0,1] op_sel_hi:[1,1]
    v_pk_mul_f32 v[36:37], v[36:37], v[24:25] op_sel:[0,1] op_sel_hi:[1,1]
    v_pk_mul_f32 v[38:39], v[38:39], v[24:25] op_sel:[0,1] op_sel_hi:[1,1]
    s_waitcnt lgkmcnt(2)
    v_lshlrev_b32 v68, 16, v48
    v_and_b32 v69, 0xffff0000, v48
    v_pk_fma_f32 v[68:69], v[68:69], v[24:25], v[32:33] op_sel_hi:[1,0,1]
    v_cvt_pk_bf16_f32 v48, v68, v69
    v_lshlrev_b32 v70, 16, v49
    v_and_b32 v71, 0xffff0000, v49
    v_pk_fma_f32 v[70:71], v[70:71], v[24:25], v[34:35] op_sel_hi:[1,0,1]
    v_cvt_pk_bf16_f32 v49, v70, v71
    v_lshlrev_b32 v68, 16, v50
    v_and_b32 v69, 0xffff0000, v50
    v_pk_fma_f32 v[68:69], v[68:69], v[24:25], v[36:37] op_sel_hi:[1,0,1]
    v_cvt_pk_bf16_f32 v50, v68, v69
    v_lshlrev_b32 v70, 16, v51
    v_and_b32 v71, 0xffff0000, v51
    v_pk_fma_f32 v[70:71], v[70:71], v[24:25], v[38:39] op_sel_hi:[1,0,1]
    v_cvt_pk_bf16_f32 v51, v70, v71
    buffer_store_dwordx4 v[48:51], v10, s[56:59], 0 offen sc1
    s_waitcnt lgkmcnt(1)
    v_pk_mul_f32 v[40:41], v[40:41], v[26:27] op_sel:[0,1] op_sel_hi:[1,1]
    v_pk_mul_f32 v[42:43], v[42:43], v[26:27] op_sel:[0,1] op_sel_hi:[1,1]
    v_pk_mul_f32 v[44:45], v[44:45], v[26:27] op_sel:[0,1] op_sel_hi:[1,1]
    v_pk_mul_f32 v[46:47], v[46:47], v[26:27] op_sel:[0,1] op_sel_hi:[1,1]
    s_waitcnt lgkmcnt(0)
    v_lshlrev_b32 v68, 16, v52
    v_and_b32 v69, 0xffff0000, v52
    v_pk_fma_f32 v[68:69], v[68:69], v[26:27], v[40:41] op_sel_hi:[1,0,1]
    v_cvt_pk_bf16_f32 v52, v68, v69
    v_lshlrev_b32 v70, 16, v53
    v_and_b32 v71, 0xffff0000, v53
    v_pk_fma_f32 v[70:71], v[70:71], v[26:27], v[42:43] op_sel_hi:[1,0,1]
    v_cvt_pk_bf16_f32 v53, v70, v71
    v_lshlrev_b32 v68, 16, v54
    v_and_b32 v69, 0xffff0000, v54
    v_pk_fma_f32 v[68:69], v[68:69], v[26:27], v[44:45] op_sel_hi:[1,0,1]
    v_cvt_pk_bf16_f32 v54, v68, v69
    v_lshlrev_b32 v70, 16, v55
    v_and_b32 v71, 0xffff0000, v55
    v_pk_fma_f32 v[70:71], v[70:71], v[26:27], v[46:47] op_sel_hi:[1,0,1]
    v_cvt_pk_bf16_f32 v55, v70, v71
    buffer_store_dwordx4 v[52:55], v10, s[56:59], s63 offen sc1
K_END:
K_EXIT:
    s_endpgm
K_YROW0:
    v_and_b32 v2, 7, v1
    v_lshlrev_b32 v2, 5, v2
    v_add_u32 v2, 158976, v2
    ds_read_b128 v[56:59], v2
    ds_read_b128 v[60:63], v2 offset:16
    s_and_b32 s33, s3, 7
    v_cmp_eq_u32 vcc, s33, v8
    s_cmp_ge_u32 s3, 8
    s_cbranch_scc1 K_YR1_0
    s_waitcnt lgkmcnt(0)
    v_add_f32 v64, v32, v56
    v_cvt_pk_bf16_f32 v64, v64, v64
    v_lshlrev_b32 v64, 16, v64
    v_cndmask_b32 v32, v32, v64, vcc
    v_add_f32 v65, v33, v57
    v_cvt_pk_bf16_f32 v65, v65, v65
    v_lshlrev_b32 v65, 16, v65
    v_cndmask_b32 v33, v33, v65, vcc
    v_add_f32 v66, v34, v58
    v_cvt_pk_bf16_f32 v66, v66, v66
    v_lshlrev_b32 v66, 16, v66
    v_cndmask_b32 v34, v34, v66, vcc
    v_add_f32 v67, v35, v59
    v_cvt_pk_bf16_f32 v67, v67, v67
    v_lshlrev_b32 v67, 16, v67
    v_cndmask_b32 v35, v35, v67, vcc
    v_add_f32 v64, v36, v60
    v_cvt_pk_bf16_f32 v64, v64, v64
    v_lshlrev_b32 v64, 16, v64
    v_cndmask_b32 v36, v36, v64, vcc
    v_add_f32 v65, v37, v61
    v_cvt_pk_bf16_f32 v65, v65, v65
    v_lshlrev_b32 v65, 16, v65
    v_cndmask_b32 v37, v37, v65, vcc
    v_add_f32 v66, v38, v62
    v_cvt_pk_bf16_f32 v66, v66, v66
    v_lshlrev_b32 v66, 16, v66
    v_cndmask_b32 v38, v38, v66, vcc
    v_add_f32 v67, v39, v63
    v_cvt_pk_bf16_f32 v67, v67, v67
    v_lshlrev_b32 v67, 16, v67
    v_cndmask_b32 v39, v39, v67, vcc
    s_branch K_NOY0
K_YR1_0:
    s_waitcnt lgkmcnt(0)
    v_add_f32 v64, v40, v56
    v_cvt_pk_bf16_f32 v64, v64, v64
    v_lshlrev_b32 v64, 16, v64
    v_cndmask_b32 v40, v40, v64, vcc
    v_add_f32 v65, v41, v57
    v_cvt_pk_bf16_f32 v65, v65, v65
    v_lshlrev_b32 v65, 16, v65
    v_cndmask_b32 v41, v41, v65, vcc
    v_add_f32 v66, v42, v58
    v_cvt_pk_bf16_f32 v66, v66, v66
    v_lshlrev_b32 v66, 16, v66
    v_cndmask_b32 v42, v42, v66, vcc
    v_add_f32 v67, v43, v59
    v_cvt_pk_bf16_f32 v67, v67, v67
    v_lshlrev_b32 v67, 16, v67
    v_cndmask_b32 v43, v43, v67, vcc
    v_add_f32 v64, v44, v60
    v_cvt_pk_bf16_f32 v64, v64, v64
    v_lshlrev_b32 v64, 16, v64
    v_cndmask_b32 v44, v44, v64, vcc
    v_add_f32 v65, v45, v61
    v_cvt_pk_bf16_f32 v65, v65, v65
    v_lshlrev_b32 v65, 16, v65
    v_cndmask_b32 v45, v45, v65, vcc
    v_add_f32 v66, v46, v62
    v_cvt_pk_bf16_f32 v66, v66, v66
    v_lshlrev_b32 v66, 16, v66
    v_cndmask_b32 v46, v46, v66, vcc
    v_add_f32 v67, v47, v63
    v_cvt_pk_bf16_f32 v67, v67, v67
    v_lshlrev_b32 v67, 16, v67
    v_cndmask_b32 v47, v47, v67, vcc
    s_branch K_NOY0
K_YROW1:
    v_and_b32 v2, 7, v1
    v_lshlrev_b32 v2, 5, v2
    v_add_u32 v2, 159232, v2
    ds_read_b128 v[56:59], v2
    ds_read_b128 v[60:63], v2 offset:16
    s_and_b32 s33, s3, 7
    v_cmp_eq_u32 vcc, s33, v8
    s_cmp_ge_u32 s3, 8
    s_cbranch_scc1 K_YR1_1
    s_waitcnt lgkmcnt(0)
    v_add_f32 v64, v32, v56
    v_cvt_pk_bf16_f32 v64, v64, v64
    v_lshlrev_b32 v64, 16, v64
    v_cndmask_b32 v32, v32, v64, vcc
    v_add_f32 v65, v33, v57
    v_cvt_pk_bf16_f32 v65, v65, v65
    v_lshlrev_b32 v65, 16, v65
    v_cndmask_b32 v33, v33, v65, vcc
    v_add_f32 v66, v34, v58
    v_cvt_pk_bf16_f32 v66, v66, v66
    v_lshlrev_b32 v66, 16, v66
    v_cndmask_b32 v34, v34, v66, vcc
    v_add_f32 v67, v35, v59
    v_cvt_pk_bf16_f32 v67, v67, v67
    v_lshlrev_b32 v67, 16, v67
    v_cndmask_b32 v35, v35, v67, vcc
    v_add_f32 v64, v36, v60
    v_cvt_pk_bf16_f32 v64, v64, v64
    v_lshlrev_b32 v64, 16, v64
    v_cndmask_b32 v36, v36, v64, vcc
    v_add_f32 v65, v37, v61
    v_cvt_pk_bf16_f32 v65, v65, v65
    v_lshlrev_b32 v65, 16, v65
    v_cndmask_b32 v37, v37, v65, vcc
    v_add_f32 v66, v38, v62
    v_cvt_pk_bf16_f32 v66, v66, v66
    v_lshlrev_b32 v66, 16, v66
    v_cndmask_b32 v38, v38, v66, vcc
    v_add_f32 v67, v39, v63
    v_cvt_pk_bf16_f32 v67, v67, v67
    v_lshlrev_b32 v67, 16, v67
    v_cndmask_b32 v39, v39, v67, vcc
    s_branch K_NOY1
K_YR1_1:
    s_waitcnt lgkmcnt(0)
    v_add_f32 v64, v40, v56
    v_cvt_pk_bf16_f32 v64, v64, v64
    v_lshlrev_b32 v64, 16, v64
    v_cndmask_b32 v40, v40, v64, vcc
    v_add_f32 v65, v41, v57
    v_cvt_pk_bf16_f32 v65, v65, v65
    v_lshlrev_b32 v65, 16, v65
    v_cndmask_b32 v41, v41, v65, vcc
    v_add_f32 v66, v42, v58
    v_cvt_pk_bf16_f32 v66, v66, v66
    v_lshlrev_b32 v66, 16, v66
    v_cndmask_b32 v42, v42, v66, vcc
    v_add_f32 v67, v43, v59
    v_cvt_pk_bf16_f32 v67, v67, v67
    v_lshlrev_b32 v67, 16, v67
    v_cndmask_b32 v43, v43, v67, vcc
    v_add_f32 v64, v44, v60
    v_cvt_pk_bf16_f32 v64, v64, v64
    v_lshlrev_b32 v64, 16, v64
    v_cndmask_b32 v44, v44, v64, vcc
    v_add_f32 v65, v45, v61
    v_cvt_pk_bf16_f32 v65, v65, v65
    v_lshlrev_b32 v65, 16, v65
    v_cndmask_b32 v45, v45, v65, vcc
    v_add_f32 v66, v46, v62
    v_cvt_pk_bf16_f32 v66, v66, v66
    v_lshlrev_b32 v66, 16, v66
    v_cndmask_b32 v46, v46, v66, vcc
    v_add_f32 v67, v47, v63
    v_cvt_pk_bf16_f32 v67, v67, v67
    v_lshlrev_b32 v67, 16, v67
    v_cndmask_b32 v47, v47, v67, vcc
    s_branch K_NOY1
K_STA10:
    s_branch K_STA14
K_STB10:
    s_branch K_STB14
K_P2:
    s_cmp_ge_u32 s30, 4
    s_cbranch_scc1 K_P2_HELP
    s_lshl_b32 s62, s40, 7
    v_lshrrev_b32 v8, 3, v1
    v_lshrrev_b32 v9, 4, v1
    v_mov_b32 v15, 158720
    s_lshl_b32 s61, s40, 3
    s_add_u32 s61, s61, s30
    s_mul_i32 s3, s61, 20480
    s_lshl_b32 s33, s41, 7
    s_add_u32 s3, s3, s33
    v_and_b32 v2, 7, v1
    v_lshlrev_b32 v2, 4, v2
    v_mul_u32_u24 v4, 1280, v8
    v_add3_u32 v10, v2, v4, s3
    s_lshl_b32 s3, s30, 7
    s_add_u32 s3, s3, 159744
    v_lshl_add_u32 v11, v8, 3, s3
    s_mov_b32 s63, 10240
    s_add_u32 s20, s6, 0x100000
    s_addc_u32 s21, s7, 0
    s_mov_b32 s22, 0x280000
    s_mov_b32 s23, 0x20000
    s_mov_b32 s56, s10
    s_mov_b32 s57, s11
    s_mov_b32 s58, 0x280000
    s_mov_b32 s59, 0x20000
    v_mul_u32_u24 v3, 144, v8
    v_add_u32 v3, v2, v3
    s_mul_i32 s3, s30, 2304
    s_add_u32 s3, s3, 140288
    v_add_u32 v14, s3, v3
    buffer_load_dwordx4 v[16:19], v10, s[12:15], 0 offen
    buffer_load_dwordx4 v[20:23], v10, s[12:15], s63 offen
    v_bfe_u32 v48, v1, 2, 2
    v_and_b32 v49, 3, v1
    s_add_u32 s3, s61, s30
    s_lshr_b32 s33, s3, 2
    s_mul_i32 s33, s33, 76
    s_add_u32 s3, s3, s33
    s_lshl_b32 s3, s3, 10
    v_and_b32 v2, 15, v1
    v_lshl_add_u32 v2, v2, 4, s3
    v_lshrrev_b32 v3, 5, v1
    v_lshl_add_u32 v2, v3, 8, v2
    v_and_b32 v4, 1, v9
    v_lshl_add_u32 v52, v4, 10, v2
    v_mov_b32 v53, 0x1f000
    v_lshl_add_u32 v2, v3, 3, v48
    v_lshlrev_b32 v2, 7, v2
    v_lshl_add_u32 v2, v49, 3, v2
    v_lshl_add_u32 v2, v4, 5, v2
    v_lshrrev_b32 v4, 1, v48
    v_lshl_add_u32 v54, v4, 6, v2
    v_xor_b32 v55, 64, v54
    v_mov_b32 v56, v54
    v_mov_b32 v57, v54
    v_and_b32 v2, 31, v1
    v_mul_u32_u24 v2, 144, v2
    v_lshl_add_u32 v2, v3, 3, v2
    s_mul_i32 s3, s30, 4608
    s_add_u32 s3, s3, 140288
    v_add_u32 v50, s3, v2
    s_and_b32 s33, s40, 3
    s_lshl_b32 s33, s33, 2
    s_lshr_b32 s33, 0xf63f, s33
    s_and_b32 s33, s33, 15
    s_lshl1_add_u32 s3, s30, 1
    s_cmp_ge_u32 s3, s33
    s_cselect_b32 s60, 24, 16
    s_cmp_gt_u32 s3, s33
    s_cselect_b32 s60, 20, s60
    v_add_u32 v58, s60, v15
    s_mov_b32 s64, -1
    s_mov_b32 s65, -1
    s_mov_b32 s66, -1
    s_mov_b32 s67, -1
    s_mov_b32 s68, -1
    s_mov_b32 s69, -1
    s_mov_b32 s70, 0xfffff
    s_mov_b32 s71, 131072
    v_mov_b32 v108, 0
    v_mov_b32 v109, 0
    v_mov_b32 v110, 0
    v_mov_b32 v111, 0
    v_mov_b32 v112, 0
    v_mov_b32 v113, 0
    v_mov_b32 v114, 0
    v_mov_b32 v115, 0
    v_mov_b32 v116, 0
    v_mov_b32 v117, 0
    v_mov_b32 v118, 0
    v_mov_b32 v119, 0
    v_mov_b32 v120, 0
    v_mov_b32 v121, 0
    v_mov_b32 v122, 0
    v_mov_b32 v123, 0
    v_mov_b32 v124, 0
    v_mov_b32 v125, 0
    v_mov_b32 v126, 0
    v_mov_b32 v127, 0
    v_mov_b32 v128, 0
    v_mov_b32 v129, 0
    v_mov_b32 v130, 0
    v_mov_b32 v131, 0
    v_mov_b32 v132, 0
    v_mov_b32 v133, 0
    v_mov_b32 v134, 0
    v_mov_b32 v135, 0
    v_mov_b32 v136, 0
    v_mov_b32 v137, 0
    v_mov_b32 v138, 0
    v_mov_b32 v139, 0
K_P2_AUXW:
    v_lshrrev_b32 v2, 3, v1
    v_mul_u32_u24 v2, 1280, v2
    v_lshrrev_b32 v3, 2, v1
    v_and_b32 v3, 4, v3
    v_and_b32 v4, 7, v1
    v_xor_b32 v3, v3, v4
    v_lshl_add_u32 v2, v3, 4, v2
    s_lshl_b32 s33, s41, 7
    v_add_u32 v51, s33, v2
    v_lshrrev_b32 v5, 5, v1
    v_mul_u32_u24 v5, 20480, v5
    v_add_u32 v5, v5, v51
    s_lshl_b32 s52, s30, 2
    s_lshr_b32 s52, 0x7520, s52
    s_and_b32 s52, s52, 7
    s_mul_i32 s52, s52, 51200
    s_lshl_b32 s53, s30, 12
    s_add_u32 s60, s52, 0
    s_add_u32 m0, s53, 0
    s_waitcnt vmcnt(5)
    buffer_load_dwordx4 v51, s[24:27], s60 offen lds
    s_add_u32 s60, s52, 10240
    s_add_u32 m0, s53, 1024
    s_waitcnt vmcnt(5)
    buffer_load_dwordx4 v51, s[24:27], s60 offen lds
    s_add_u32 s60, s52, 25600
    s_add_u32 m0, s53, 2048
    s_waitcnt vmcnt(5)
    buffer_load_dwordx4 v51, s[24:27], s60 offen lds
    s_add_u32 s60, s52, 35840
    s_add_u32 m0, s53, 3072
    s_waitcnt vmcnt(5)
    buffer_load_dwordx4 v51, s[24:27], s60 offen lds
    s_add_u32 s60, s52, 409600
    s_add_u32 m0, s53, 20480
    s_waitcnt vmcnt(5)
    buffer_load_dwordx4 v51, s[24:27], s60 offen lds
    s_add_u32 s60, s52, 419840
    s_add_u32 m0, s53, 21504
    s_waitcnt vmcnt(5)
    buffer_load_dwordx4 v51, s[24:27], s60 offen lds
    v_mov_b32 v3, 1
    s_mov_b64 exec, 1
    ds_add_u32 v15, v3 offset:52
    s_mov_b64 exec, -1
    s_add_u32 s60, s52, 435200
    s_add_u32 m0, s53, 22528
    s_waitcnt vmcnt(5)
    buffer_load_dwordx4 v51, s[24:27], s60 offen lds
    s_add_u32 s60, s52, 445440
    s_add_u32 m0, s53, 23552
    s_waitcnt vmcnt(5)
    buffer_load_dwordx4 v51, s[24:27], s60 offen lds
    s_lshl_b32 s53, s30, 10
    s_add_u32 s60, s52, 20480
    s_add_u32 m0, s53, 16384
    s_waitcnt vmcnt(5)
    buffer_load_dwordx4 v5, s[24:27], s60 offen lds
    s_add_u32 s60, s52, 430080
    s_add_u32 m0, s53, 36864
    s_waitcnt vmcnt(5)
    buffer_load_dwordx4 v5, s[24:27], s60 offen lds
    s_cmp_eq_u32 s30, 0
    s_cbranch_scc1 K_CHA0
    s_cmp_eq_u32 s30, 1
    s_cbranch_scc1 K_CHA1
    s_cmp_eq_u32 s30, 2
    s_cbranch_scc1 K_CHA2
    s_branch K_CHA3
K_WRET_A:
    v_mov_b32 v3, 1
    s_waitcnt vmcnt(0)
    s_mov_b64 exec, 1
    ds_add_u32 v15, v3 offset:44
    s_mov_b64 exec, -1
    s_mov_b32 s3, 1048576
K_P2_GWA:
    ds_read_b32 v2, v15 offset:44
    s_sub_u32 s3, s3, 1
    s_waitcnt lgkmcnt(0)
    v_readfirstlane_b32 s33, v2
    s_nop 3
    s_cselect_b32 s33, 4, s33
    s_cmp_lt_u32 s33, 4
    s_cbranch_scc1 K_P2_GWA
    s_branch K_P2_GEMM
K_STA11:
    s_branch K_STA15
K_STB11:
    s_branch K_STB15
K_P2_HELP:
    s_setprio 3
    s_cmp_eq_u32 s30, 7
    s_cbranch_scc1 K_P2_W7
    s_cmp_eq_u32 s30, 4
    s_cbranch_scc1 K_P2_NL
    s_cmp_ge_u32 s29, 8
    s_cbranch_scc1 K_P2_NL
    s_mov_b32 s24, s8
    s_mov_b32 s25, s9
    s_mov_b32 s26, 0xc8000
    s_mov_b32 s27, 0x20000
    v_lshrrev_b32 v2, 3, v1
    v_mul_u32_u24 v2, 1280, v2
    v_lshrrev_b32 v3, 2, v1
    v_and_b32 v3, 4, v3
    v_and_b32 v4, 7, v1
    v_xor_b32 v3, v3, v4
    v_lshl_add_u32 v2, v3, 4, v2
    s_lshl_b32 s33, s41, 7
    v_add_u32 v12, s33, v2
    v_lshrrev_b32 v5, 5, v1
    v_mul_u32_u24 v5, 20480, v5
    v_add_u32 v5, v5, v12
    s_sub_u32 s61, s30, 5
    s_lshl_b32 s52, s61, 2
    s_lshr_b32 s52, 0x6431, s52
    s_and_b32 s52, s52, 7
    s_mul_i32 s52, s52, 51200
    s_lshl_b32 s53, s61, 12
    s_add_u32 s60, s52, 0
    s_branch K_PG5
.p2align 12
K_STA12:
    s_branch K_WRET_A
K_STB12:
    s_branch K_WRET_B
K_PG5:
    s_add_u32 m0, s53, 40960
    s_nop 0
    buffer_load_dwordx4 v12, s[24:27], s60 offen lds
    s_add_u32 s60, s52, 10240
    s_add_u32 m0, s53, 41984
    s_nop 0
    buffer_load_dwordx4 v12, s[24:27], s60 offen lds
    s_add_u32 s60, s52, 25600
    s_add_u32 m0, s53, 43008
    s_nop 0
    buffer_load_dwordx4 v12, s[24:27], s60 offen lds
    s_add_u32 s60, s52, 35840
    s_add_u32 m0, s53, 44032
    s_nop 0
    buffer_load_dwordx4 v12, s[24:27], s60 offen lds
    s_add_u32 s60, s52, 409600
    s_add_u32 m0, s53, 61440
    s_nop 0
    buffer_load_dwordx4 v12, s[24:27], s60 offen lds
    s_add_u32 s60, s52, 419840
    s_add_u32 m0, s53, 62464
    s_nop 0
    buffer_load_dwordx4 v12, s[24:27], s60 offen lds
    s_add_u32 s60, s52, 435200
    s_add_u32 m0, s53, 63488
    s_nop 0
    buffer_load_dwordx4 v12, s[24:27], s60 offen lds
    s_add_u32 s60, s52, 445440
    s_add_u32 m0, s53, 64512
    s_nop 0
    buffer_load_dwordx4 v12, s[24:27], s60 offen lds
    s_lshl_b32 s53, s61, 10
    s_add_u32 s60, s52, 20480
    s_add_u32 m0, s53, 57344
    s_nop 0
    buffer_load_dwordx4 v5, s[24:27], s60 offen lds
    s_add_u32 s60, s52, 430080
    s_add_u32 m0, s53, 77824
    s_nop 0
    buffer_load_dwordx4 v5, s[24:27], s60 offen lds
    s_add_u32 s61, s61, 2
    s_lshl_b32 s52, s61, 2
    s_lshr_b32 s52, 0x6431, s52
    s_and_b32 s52, s52, 7
    s_mul_i32 s52, s52, 51200
    s_lshl_b32 s53, s61, 12
    s_add_u32 s60, s52, 0
    s_add_u32 m0, s53, 40960
    s_nop 0
    buffer_load_dwordx4 v12, s[24:27], s60 offen lds
    s_add_u32 s60, s52, 10240
    s_add_u32 m0, s53, 41984
    s_nop 0
    buffer_load_dwordx4 v12, s[24:27], s60 offen lds
    s_add_u32 s60, s52, 25600
    s_add_u32 m0, s53, 43008
    s_nop 0
    buffer_load_dwordx4 v12, s[24:27], s60 offen lds
    s_add_u32 s60, s52, 35840
    s_add_u32 m0, s53, 44032
    s_nop 0
    buffer_load_dwordx4 v12, s[24:27], s60 offen lds
    s_add_u32 s60, s52, 409600
    s_add_u32 m0, s53, 61440
    s_nop 0
    buffer_load_dwordx4 v12, s[24:27], s60 offen lds
    s_add_u32 s60, s52, 419840
    s_add_u32 m0, s53, 62464
    s_nop 0
    buffer_load_dwordx4 v12, s[24:27], s60 offen lds
    s_add_u32 s60, s52, 435200
    s_add_u32 m0, s53, 63488
    s_nop 0
    buffer_load_dwordx4 v12, s[24:27], s60 offen lds
    s_add_u32 s60, s52, 445440
    s_add_u32 m0, s53, 64512
    s_nop 0
    buffer_load_dwordx4 v12, s[24:27], s60 offen lds
    s_lshl_b32 s53, s61, 10
    s_add_u32 s60, s52, 20480
    s_add_u32 m0, s53, 57344
    s_nop 0
    buffer_load_dwordx4 v5, s[24:27], s60 offen lds
    s_add_u32 s60, s52, 430080
    s_add_u32 m0, s53, 77824
    s_nop 0
    buffer_load_dwordx4 v5, s[24:27], s60 offen lds
    v_mov_b32 v2, 158720
    v_mov_b32 v3, 1
    s_waitcnt vmcnt(0)
    s_mov_b64 exec, 1
    ds_add_u32 v2, v3 offset:56
    s_mov_b64 exec, -1
K_P2_NL:
    s_lshl_b32 s62, s40, 7
    v_lshrrev_b32 v8, 3, v1
    v_lshrrev_b32 v9, 4, v1
    v_mov_b32 v15, 158720
    s_lshl_b32 s61, s40, 3
    s_add_u32 s61, s61, s30
    s_mul_i32 s3, s61, 20480
    s_lshl_b32 s33, s41, 7
    s_add_u32 s3, s3, s33
    v_and_b32 v2, 7, v1
    v_lshlrev_b32 v2, 4, v2
    v_mul_u32_u24 v4, 1280, v8
    v_add3_u32 v10, v2, v4, s3
    s_lshl_b32 s3, s30, 7
    s_add_u32 s3, s3, 159744
    v_lshl_add_u32 v11, v8, 3, s3
    s_mov_b32 s63, 10240
    s_add_u32 s20, s6, 0x100000
    s_addc_u32 s21, s7, 0
    s_mov_b32 s22, 0x280000
    s_mov_b32 s23, 0x20000
    s_mov_b32 s56, s10
    s_mov_b32 s57, s11
    s_mov_b32 s58, 0x280000
    s_mov_b32 s59, 0x20000
    v_mul_u32_u24 v3, 144, v8
    v_add_u32 v3, v2, v3
    s_mul_i32 s3, s30, 2304
    s_add_u32 s3, s3, 140288
    v_add_u32 v14, s3, v3
    s_add_u32 s44, s6, 0x10000
    s_addc_u32 s45, s7, 0
    s_mov_b32 s46, 0x43800
    s_mov_b32 s47, 0x20000
    v_mov_b32 v108, 1
    buffer_load_dwordx4 v[16:19], v10, s[12:15], 0 offen
    buffer_load_dwordx4 v[20:23], v10, s[12:15], s63 offen
    s_cmp_lg_u32 s30, 6
    s_cbranch_scc1 K_P2_HW
    s_mov_b32 s3, 131072
    s_waitcnt vmcnt(2)
K_P2_DPOLL:
    v_min_u32 v2, v7, v6
    v_cmp_eq_u32 vcc, 0, v2
    s_cbranch_vccz K_P2_DOK
    s_cmp_eq_u32 s3, 131072
    s_cbranch_scc1 K_P2_DNS
    s_sleep 12
K_P2_DNS:
    v_lshl_add_u32 v13, v1, 2, s42
    global_load_dword v7, v13, s[6:7] offset:256 sc1
    v_and_b32 v13, 0xfffffe04, v13
    global_load_dword v6, v13, s[6:7] offset:128 sc1
    s_sub_u32 s3, s3, 1
    s_waitcnt vmcnt(0)
    s_cmp_lg_u32 s3, 0
    s_cbranch_scc1 K_P2_DPOLL
K_P2_DOK:
    v_readlane_b32 s52, v6, 0
    v_readlane_b32 s53, v6, 1
    s_nop 1
    s_and_b32 s3, s52, 0x7ff
    s_sub_u32 s3, 2047, s3
    v_mov_b32 v48, s3
    v_mov_b32 v4, s52
    v_and_b32 v4, 0xffff0000, v4
    v_ashrrev_i32 v5, 31, v4
    v_not_b32 v5, v5
    v_or_b32 v5, 0x80000000, v5
    v_xor_b32 v4, v4, v5
    v_and_b32 v4, 0xffff0000, v4
    v_mul_f32 v5, 0xbfb8aa3b, v4
    v_exp_f32 v5, v5
    s_nop 0
    v_add_f32 v5, 1.0, v5
    v_rcp_f32 v4, v5
    s_nop 0
    v_cvt_pk_bf16_f32 v50, v4, v4
    v_lshlrev_b32 v50, 16, v50
    s_and_b32 s3, s53, 0x7ff
    s_sub_u32 s3, 2047, s3
    v_mov_b32 v49, s3
    v_mov_b32 v4, s53
    v_and_b32 v4, 0xffff0000, v4
    v_ashrrev_i32 v5, 31, v4
    v_not_b32 v5, v5
    v_or_b32 v5, 0x80000000, v5
    v_xor_b32 v4, v4, v5
    v_and_b32 v4, 0xffff0000, v4
    v_mul_f32 v5, 0xbfb8aa3b, v4
    v_exp_f32 v5, v5
    s_nop 0
    v_add_f32 v5, 1.0, v5
    v_rcp_f32 v4, v5
    s_nop 0
    v_cvt_pk_bf16_f32 v51, v4, v4
    v_lshlrev_b32 v51, 16, v51
    ds_write_b128 v15, v[48:51]
    ds_write_b32 v15, v108 offset:40
    v_lshl_add_u32 v13, v1, 4, v15
    v_lshlrev_b32 v52, 16, v7
    v_and_b32 v52, 0x7fff0000, v52
    v_and_b32 v54, 0x7fff0000, v7
    v_sub_f32 v53, 1.0, v52
    v_cvt_pk_bf16_f32 v53, v53, v53
    v_lshlrev_b32 v53, 16, v53
    v_sub_f32 v55, 1.0, v54
    v_cvt_pk_bf16_f32 v55, v55, v55
    v_lshlrev_b32 v55, 16, v55
    ds_write_b128 v13, v[52:55] offset:1024
    s_branch K_P2_E
K_STA13:
    s_branch K_WRET_A
K_STB13:
    s_branch K_WRET_B
K_P2_HW:
    s_mov_b32 s3, 1048576
K_P2_GS2:
    ds_read_b32 v2, v15 offset:40
    s_sleep 1
    s_sub_u32 s3, s3, 1
    s_waitcnt lgkmcnt(0)
    v_readfirstlane_b32 s33, v2
    s_nop 3
    s_cselect_b32 s33, 1, s33
    s_cmp_lt_u32 s33, 1
    s_cbranch_scc1 K_P2_GS2
    ds_read_b128 v[28:31], v15
    s_waitcnt lgkmcnt(0)
    s_cmp_eq_u32 s30, 4
    s_cselect_b64 vcc, -1, 0
    s_nop 1
    v_cndmask_b32 v2, v29, v28, vcc
    v_cndmask_b32 v5, v31, v30, vcc
    s_nop 0
    v_readfirstlane_b32 s52, v2
    s_nop 3
    s_sub_u32 s3, s52, s62
    s_cmp_lt_u32 s3, 128
    s_cbranch_scc0 K_P2_E
    s_mov_b32 s3, 131072
K_P2_YPOLL:
    s_load_dword s33, s[6:7], s42 offset:136 glc
    s_waitcnt lgkmcnt(0)
    s_cmp_lg_u32 s33, 0
    s_cbranch_scc1 K_P2_YGO
    s_sleep 4
    s_sub_u32 s3, s3, 1
    s_cbranch_scc0 K_P2_YPOLL
K_P2_YGO:
    v_and_b32 v2, 15, v1
    v_lshlrev_b32 v2, 4, v2
    v_mul_u32_u24 v4, 5120, v9
    s_sub_u32 s53, s30, 4
    s_mul_i32 s33, s53, 2560
    s_lshl_b32 s3, s41, 8
    s_add_u32 s3, s3, s33
    v_add3_u32 v3, v2, v4, s3
    s_mov_b32 s60, 0
    buffer_load_dwordx4 v[52:55], v3, s[44:47], s60 offen sc1
    s_mov_b32 s60, 20480
    buffer_load_dwordx4 v[56:59], v3, s[44:47], s60 offen sc1
    s_mov_b32 s60, 40960
    buffer_load_dwordx4 v[60:63], v3, s[44:47], s60 offen sc1
    s_mov_b32 s60, 61440
    buffer_load_dwordx4 v[64:67], v3, s[44:47], s60 offen sc1
    s_mov_b32 s60, 81920
    buffer_load_dwordx4 v[68:71], v3, s[44:47], s60 offen sc1
    s_mov_b32 s60, 102400
    buffer_load_dwordx4 v[72:75], v3, s[44:47], s60 offen sc1
    s_mov_b32 s60, 122880
    buffer_load_dwordx4 v[76:79], v3, s[44:47], s60 offen sc1
    s_mov_b32 s60, 143360
    buffer_load_dwordx4 v[80:83], v3, s[44:47], s60 offen sc1
    s_mov_b32 s60, 163840
    buffer_load_dwordx4 v[84:87], v3, s[44:47], s60 offen sc1
    s_mov_b32 s60, 184320
    buffer_load_dwordx4 v[88:91], v3, s[44:47], s60 offen sc1
    s_mov_b32 s60, 204800
    buffer_load_dwordx4 v[92:95], v3, s[44:47], s60 offen sc1
    s_mov_b32 s60, 225280
    buffer_load_dwordx4 v[96:99], v3, s[44:47], s60 offen sc1
    s_mov_b32 s60, 245760
    buffer_load_dwordx4 v[100:103], v3, s[44:47], s60 offen sc1
    s_mov_b32 s60, 266240
    buffer_load_dwordx4 v[104:107], v3, s[44:47], s60 offen sc1
    s_waitcnt vmcnt(12)
    v_add_f32 v48, v52, v56
    v_add_f32 v49, v53, v57
    v_add_f32 v50, v54, v58
    v_add_f32 v51, v55, v59
    s_waitcnt vmcnt(11)
    v_add_f32 v48, v48, v60
    v_add_f32 v49, v49, v61
    v_add_f32 v50, v50, v62
    v_add_f32 v51, v51, v63
    s_waitcnt vmcnt(10)
    v_add_f32 v48, v48, v64
    v_add_f32 v49, v49, v65
    v_add_f32 v50, v50, v66
    v_add_f32 v51, v51, v67
    s_waitcnt vmcnt(9)
    v_add_f32 v48, v48, v68
    v_add_f32 v49, v49, v69
    v_add_f32 v50, v50, v70
    v_add_f32 v51, v51, v71
    s_waitcnt vmcnt(8)
    v_add_f32 v48, v48, v72
    v_add_f32 v49, v49, v73
    v_add_f32 v50, v50, v74
    v_add_f32 v51, v51, v75
    s_waitcnt vmcnt(7)
    v_add_f32 v48, v48, v76
    v_add_f32 v49, v49, v77
    v_add_f32 v50, v50, v78
    v_add_f32 v51, v51, v79
    s_waitcnt vmcnt(6)
    v_add_f32 v48, v48, v80
    v_add_f32 v49, v49, v81
    v_add_f32 v50, v50, v82
    v_add_f32 v51, v51, v83
    s_waitcnt vmcnt(5)
    v_add_f32 v48, v48, v84
    v_add_f32 v49, v49, v85
    v_add_f32 v50, v50, v86
    v_add_f32 v51, v51, v87
    s_waitcnt vmcnt(4)
    v_add_f32 v48, v48, v88
    v_add_f32 v49, v49, v89
    v_add_f32 v50, v50, v90
    v_add_f32 v51, v51, v91
    s_waitcnt vmcnt(3)
    v_add_f32 v48, v48, v92
    v_add_f32 v49, v49, v93
    v_add_f32 v50, v50, v94
    v_add_f32 v51, v51, v95
    s_waitcnt vmcnt(2)
    v_add_f32 v48, v48, v96
    v_add_f32 v49, v49, v97
    v_add_f32 v50, v50, v98
    v_add_f32 v51, v51, v99
    s_waitcnt vmcnt(1)
    v_add_f32 v48, v48, v100
    v_add_f32 v49, v49, v101
    v_add_f32 v50, v50, v102
    v_add_f32 v51, v51, v103
    s_waitcnt vmcnt(0)
    v_add_f32 v48, v48, v104
    v_add_f32 v49, v49, v105
    v_add_f32 v50, v50, v106
    v_add_f32 v51, v51, v107
    v_mov_b32 v52, v48
    v_mov_b32 v53, v49
    v_mov_b32 v54, v50
    v_mov_b32 v55, v51
    s_nop 0
    v_permlane16_swap_b32 v48, v52
    v_permlane16_swap_b32 v49, v53
    v_permlane16_swap_b32 v50, v54
    v_permlane16_swap_b32 v51, v55
    v_add_f32 v48, v48, v52
    v_add_f32 v49, v49, v53
    v_add_f32 v50, v50, v54
    v_add_f32 v51, v51, v55
    v_mov_b32 v52, v48
    v_mov_b32 v53, v49
    v_mov_b32 v54, v50
    v_mov_b32 v55, v51
    s_nop 0
    v_permlane32_swap_b32 v48, v52
    v_permlane32_swap_b32 v49, v53
    v_permlane32_swap_b32 v50, v54
    v_permlane32_swap_b32 v51, v55
    v_add_f32 v48, v48, v52
    v_add_f32 v49, v49, v53
    v_add_f32 v50, v50, v54
    v_add_f32 v51, v51, v55
    v_cvt_pk_bf16_f32 v48, v48, v48
    v_lshlrev_b32 v48, 16, v48
    v_mul_f32 v48, v5, v48
    v_cvt_pk_bf16_f32 v48, v48, v48
    v_lshlrev_b32 v48, 16, v48
    v_cvt_pk_bf16_f32 v49, v49, v49
    v_lshlrev_b32 v49, 16, v49
    v_mul_f32 v49, v5, v49
    v_cvt_pk_bf16_f32 v49, v49, v49
    v_lshlrev_b32 v49, 16, v49
    v_cvt_pk_bf16_f32 v50, v50, v50
    v_lshlrev_b32 v50, 16, v50
    v_mul_f32 v50, v5, v50
    v_cvt_pk_bf16_f32 v50, v50, v50
    v_lshlrev_b32 v50, 16, v50
    v_cvt_pk_bf16_f32 v51, v51, v51
    v_lshlrev_b32 v51, 16, v51
    v_mul_f32 v51, v5, v51
    v_cvt_pk_bf16_f32 v51, v51, v51
    v_lshlrev_b32 v51, 16, v51
    s_lshl_b32 s3, s53, 8
    s_add_u32 s3, s3, 158976
    v_add_u32 v2, s3, v2
    ds_write_b128 v2, v[48:51]
    s_branch K_P2_E
K_STA14:
    s_branch K_WRET_A
K_STB14:
    s_branch K_WRET_B
K_P2_W7:
    s_mov_b32 s37, s42
    s_waitcnt lgkmcnt(0)
    s_load_dwordx2 s[48:49], s[6:7], s37 glc
    s_add_u32 s53, s40, 1
    s_and_b32 s53, s53, 2
    s_mov_b32 s46, 0x84210
    s_mov_b32 s47, s46
    v_mov_b32 v15, 158720
    v_mov_b32 v5, 0
    v_mov_b32 v48, 0x80000000
    s_mov_b64 exec, 1
    ds_or_b32 v15, v48 offset:16
    ds_or_b32 v15, v48 offset:20
    ds_or_b32 v15, v48 offset:24
    s_waitcnt lgkmcnt(0)
    s_cmp_eq_u32 s53, 0
    s_cselect_b32 s49, s48, s49
    s_lshl_b64 s[50:51], s[48:49], 1
    s_and_b64 s[50:51], s[50:51], s[48:49]
    s_lshl_b64 vcc, s[50:51], 2
    s_and_b64 s[50:51], s[50:51], vcc
    s_lshl_b64 s[50:51], s[50:51], 1
    s_and_b64 s[50:51], s[50:51], s[46:47]
    s_or_b64 s[48:49], s[48:49], s[50:51]
    v_readfirstlane_b32 s52, v5
    s_cmp_ge_u32 s52, 2
    s_cselect_b32 s52, -1, 0x3ff
    s_and_b32 s48, s48, s52
    s_and_b32 s49, s49, s52
    s_and_b32 s52, s48, s49
    v_mov_b32 v48, s48
    v_mov_b32 v49, s49
    v_mov_b32 v50, s52
    s_mov_b64 exec, 1
    ds_or_b64 v15, v[48:49] offset:16
    ds_or_b32 v15, v50 offset:24
    s_mov_b64 exec, -1
    s_load_dwordx2 s[48:49], s[6:7], s37 glc
    s_lshl_b32 s62, s40, 7
    v_lshrrev_b32 v8, 3, v1
    v_lshrrev_b32 v9, 4, v1
    v_mov_b32 v15, 158720
    s_lshl_b32 s61, s40, 3
    s_add_u32 s61, s61, s30
    s_mul_i32 s3, s61, 20480
    s_lshl_b32 s33, s41, 7
    s_add_u32 s3, s3, s33
    v_and_b32 v2, 7, v1
    v_lshlrev_b32 v2, 4, v2
    v_mul_u32_u24 v4, 1280, v8
    v_add3_u32 v10, v2, v4, s3
    s_lshl_b32 s3, s30, 7
    s_add_u32 s3, s3, 159744
    v_lshl_add_u32 v11, v8, 3, s3
    s_mov_b32 s63, 10240
    s_add_u32 s20, s6, 0x100000
    s_addc_u32 s21, s7, 0
    s_mov_b32 s22, 0x280000
    s_mov_b32 s23, 0x20000
    s_mov_b32 s56, s10
    s_mov_b32 s57, s11
    s_mov_b32 s58, 0x280000
    s_mov_b32 s59, 0x20000
    v_mul_u32_u24 v3, 144, v8
    v_add_u32 v3, v2, v3
    s_mul_i32 s3, s30, 2304
    s_add_u32 s3, s3, 140288
    v_add_u32 v14, s3, v3
    buffer_load_dwordx4 v[16:19], v10, s[12:15], 0 offen
    buffer_load_dwordx4 v[20:23], v10, s[12:15], s63 offen
    s_mov_b32 s3, 131072
    s_waitcnt lgkmcnt(0)
K_P2_FP:
    s_load_dwordx2 s[44:45], s[6:7], s37 glc
    s_cmp_eq_u32 s53, 0
    s_cselect_b32 s49, s48, s49
    s_lshl_b64 s[50:51], s[48:49], 1
    s_and_b64 s[50:51], s[50:51], s[48:49]
    s_lshl_b64 vcc, s[50:51], 2
    s_and_b64 s[50:51], s[50:51], vcc
    s_lshl_b64 s[50:51], s[50:51], 1
    s_and_b64 s[50:51], s[50:51], s[46:47]
    s_or_b64 s[48:49], s[48:49], s[50:51]
    v_readfirstlane_b32 s52, v5
    s_cmp_ge_u32 s52, 2
    s_cselect_b32 s52, -1, 0x3ff
    s_and_b32 s48, s48, s52
    s_and_b32 s49, s49, s52
    s_and_b32 s52, s48, s49
    v_mov_b32 v48, s48
    v_mov_b32 v49, s49
    v_mov_b32 v50, s52
    s_mov_b64 exec, 1
    ds_or_b64 v15, v[48:49] offset:16
    ds_or_b32 v15, v50 offset:24
    s_mov_b64 exec, -1
    ds_read_b32 v5, v15 offset:56
    s_cmp_eq_u32 s52, 0xfffff
    s_cbranch_scc1 K_P2_FGO
    s_cmp_lg_u64 s[48:49], 0
    s_cbranch_scc1 K_P2_FS2
    s_sleep 8
K_P2_FS2:
    s_sub_u32 s3, s3, 1
    s_waitcnt lgkmcnt(0)
    s_mov_b64 s[48:49], s[44:45]
    s_cbranch_scc0 K_P2_FP
    s_mov_b32 s3, 0
K_P2_FCHK:
    s_cmp_eq_u32 s53, 0
    s_cselect_b32 s49, s48, s49
    s_lshl_b64 s[50:51], s[48:49], 1
    s_and_b64 s[50:51], s[50:51], s[48:49]
    s_lshl_b64 vcc, s[50:51], 2
    s_and_b64 s[50:51], s[50:51], vcc
    s_lshl_b64 s[50:51], s[50:51], 1
    s_and_b64 s[50:51], s[50:51], s[46:47]
    s_or_b64 s[48:49], s[48:49], s[50:51]
    v_readfirstlane_b32 s52, v5
    s_cmp_ge_u32 s52, 2
    s_cselect_b32 s52, -1, 0x3ff
    s_and_b32 s48, s48, s52
    s_and_b32 s49, s49, s52
    s_and_b32 s52, s48, s49
    v_mov_b32 v48, s48
    v_mov_b32 v49, s49
    v_mov_b32 v50, s52
    s_mov_b64 exec, 1
    ds_or_b64 v15, v[48:49] offset:16
    ds_or_b32 v15, v50 offset:24
    s_mov_b64 exec, -1
    s_cmp_eq_u32 s52, 0xfffff
    s_cbranch_scc1 K_P2_FGO
    s_cmp_lg_u64 s[48:49], 0
    s_cbranch_scc1 K_P2_FS
    s_sleep 8
K_P2_FS:
    s_sleep 2
    s_load_dwordx2 s[48:49], s[6:7], s37 glc
    ds_read_b32 v5, v15 offset:56
    s_sub_u32 s3, s3, 1
    s_waitcnt lgkmcnt(0)
    s_cbranch_scc0 K_P2_FCHK
    v_mov_b32 v48, -1
    v_mov_b32 v49, -1
    v_mov_b32 v50, -1
    ds_write_b96 v15, v[48:50] offset:16
K_P2_FGO:
K_P2_E:
    s_setprio 0
    s_waitcnt vmcnt(0)
    v_lshlrev_b32 v32, 16, v16
    v_and_b32 v33, 0xffff0000, v16
    v_lshlrev_b32 v34, 16, v17
    v_and_b32 v35, 0xffff0000, v17
    v_lshlrev_b32 v36, 16, v18
    v_and_b32 v37, 0xffff0000, v18
    v_lshlrev_b32 v38, 16, v19
    v_and_b32 v39, 0xffff0000, v19
    v_lshlrev_b32 v40, 16, v20
    v_and_b32 v41, 0xffff0000, v20
    v_lshlrev_b32 v42, 16, v21
    v_and_b32 v43, 0xffff0000, v21
    v_lshlrev_b32 v44, 16, v22
    v_and_b32 v45, 0xffff0000, v22
    v_lshlrev_b32 v46, 16, v23
    v_and_b32 v47, 0xffff0000, v23
    s_branch K_P2_E2
K_STA15:
    s_branch K_WRET_A
K_STB15:
    s_branch K_WRET_B
K_SPN:
    s_mov_b32 s64, -1
    s_mov_b32 s65, -1
    s_mov_b32 s66, -1
    s_mov_b32 s67, -1
    s_mov_b32 s68, -1
    s_mov_b32 s69, -1
K_SPL:
    ds_read_b32 v59, v58
    s_waitcnt lgkmcnt(0)
    v_readfirstlane_b32 s50, v59
    s_and_b32 s33, s50, s70
    s_cbranch_scc1 K_BK0
    s_cmp_lt_i32 s50, 0
    s_cbranch_scc0 K_SPG
    s_sleep 1
    s_branch K_SPL
K_SPG:
    s_load_dwordx2 s[48:49], s[6:7], s42 glc
    ds_read_b32 v5, v15 offset:56
    s_waitcnt lgkmcnt(0)
    s_cmp_eq_u32 s53, 0
    s_cselect_b32 s49, s48, s49
    s_lshl_b64 s[50:51], s[48:49], 1
    s_and_b64 s[50:51], s[50:51], s[48:49]
    s_lshl_b64 vcc, s[50:51], 2
    s_and_b64 s[50:51], s[50:51], vcc
    s_lshl_b64 s[50:51], s[50:51], 1
    s_and_b64 s[50:51], s[50:51], s[46:47]
    s_or_b64 s[48:49], s[48:49], s[50:51]
    v_readfirstlane_b32 s52, v5
    s_cmp_ge_u32 s52, 2
    s_cselect_b32 s52, -1, 0x3ff
    s_and_b32 s48, s48, s52
    s_and_b32 s49, s49, s52
    s_and_b32 s52, s48, s49
    v_mov_b32 v188, s48
    v_mov_b32 v189, s49
    v_mov_b32 v190, s52
    s_mov_b64 exec, 1
    ds_or_b64 v15, v[188:189] offset:16
    ds_or_b32 v15, v190 offset:24
    s_mov_b64 exec, -1
    ds_read_b32 v59, v58
    s_waitcnt lgkmcnt(0)
    v_readfirstlane_b32 s50, v59
    s_and_b32 s33, s50, s70
    s_cbranch_scc1 K_BK0
    s_sleep 2
    ds_read_b32 v59, v58
    s_waitcnt lgkmcnt(0)
    v_readfirstlane_b32 s50, v59
    s_and_b32 s33, s50, s70
    s_cbranch_scc1 K_BK0
    s_sleep 2
    ds_read_b32 v59, v58
    s_waitcnt lgkmcnt(0)
    v_readfirstlane_b32 s50, v59
    s_and_b32 s33, s50, s70
    s_cbranch_scc1 K_BK0
    s_sleep 2
    ds_read_b32 v59, v58
    s_waitcnt lgkmcnt(0)
    v_readfirstlane_b32 s50, v59
    s_and_b32 s33, s50, s70
    s_cbranch_scc1 K_BK0
    s_branch K_SPL
K_CHEND:
K_AUX:
    s_cmp_ge_u32 s30, 4
    s_cbranch_scc1 K_AUX_L
    s_and_b32 s3, s2, 7
    s_lshr_b32 s70, s2, 3
    s_lshl3_add_u32 s3, s3, s70
    s_lshl_b32 s3, s3, 5
    s_lshl3_add_u32 s3, s30, s3
    v_bfe_u32 v8, v0, 4, 2
    v_add_u32 v8, s3, v8
    v_and_b32 v10, 15, v0
    v_lshlrev_b32 v10, 4, v10
    v_mul_u32_u24 v9, 1280, v8
    v_add_u32 v9, v9, v10
    v_and_b32 v2, 63, v0
    v_lshlrev_b32 v2, 4, v2
    s_lshl_b32 s71, s30, 12
    s_add_u32 s71, s71, 126016
    s_mov_b32 s70, 5120
    s_mov_b32 m0, s71
    s_waitcnt lgkmcnt(0)
    s_mov_b32 s16, s44
    s_mov_b32 s17, s45
    s_mov_b32 s18, 0x500
    s_mov_b32 s19, 0x20000
    s_mov_b32 s20, s52
    s_mov_b32 s21, s53
    s_mov_b32 s22, 0x500
    s_mov_b32 s23, 0x20000
    buffer_load_dwordx4 v2, s[16:19], 0 offen lds
    buffer_load_dwordx4 v2, s[16:19], 0 offen offset:1024 lds
    s_add_u32 m0, s71, 2048
    v_add_u32 v10, s71, v10
    buffer_load_dwordx4 v2, s[20:23], 0 offen lds
    buffer_load_dwordx4 v2, s[20:23], 0 offen offset:1024 lds
    buffer_load_dwordx4 v[16:19], v9, s[12:15], 0 offen offset:0
    buffer_load_dwordx4 v[20:23], v9, s[12:15], s70 offen offset:0
    buffer_load_dwordx4 v[24:27], v9, s[12:15], 0 offen offset:256
    buffer_load_dwordx4 v[28:31], v9, s[12:15], s70 offen offset:256
    buffer_load_dwordx4 v[32:35], v9, s[12:15], 0 offen offset:512
    buffer_load_dwordx4 v[36:39], v9, s[12:15], s70 offen offset:512
    buffer_load_dwordx4 v[40:43], v9, s[12:15], 0 offen offset:768
    buffer_load_dwordx4 v[44:47], v9, s[12:15], s70 offen offset:768
    buffer_load_dwordx4 v[48:51], v9, s[12:15], 0 offen offset:1024
    buffer_load_dwordx4 v[52:55], v9, s[12:15], s70 offen offset:1024
    s_barrier
    v_and_b32 v1, 63, v0
    v_mov_b32 v7, 0
    s_and_b32 s28, s2, 7
    s_lshr_b32 s29, s2, 3
    s_xor_b32 s30, s30, 4
    s_lshr_b32 s34, s29, 3
    s_lshl_b32 s34, s34, 2
    s_and_b32 s3, s29, 3
    s_add_u32 s34, s34, s3
    s_add_u32 s34, s34, 4
    s_bitcmp1_b32 s29, 2
    s_cselect_b32 s34, -1, s34
    s_cmp_lt_u32 s29, 8
    s_cselect_b32 s34, s29, s34
    s_lshl_b32 s40, s28, 1
    s_cmp_ge_u32 s34, 10
    s_addc_u32 s40, s40, 0
    s_sub_u32 s41, s34, 10
    s_cmp_ge_u32 s34, 10
    s_cselect_b32 s41, s41, s34
    s_mul_i32 s42, s28, 20
    s_add_u32 s42, s42, s34
    s_and_b32 s42, s42, 255
    s_lshl_b32 s42, s42, 9
    s_add_u32 s42, s42, 524288
    s_mul_i32 s43, s28, 7
    s_add_u32 s43, s43, s29
    s_sub_u32 s43, s43, 1
    s_cmp_lt_u32 s43, 54
    s_cselect_b32 s43, s43, 63
    s_cmp_eq_u32 s29, 0
    s_cselect_b32 s43, 63, s43
    s_mov_b32 s24, s8
    s_mov_b32 s25, s9
    s_mov_b32 s26, 0xc8000
    s_mov_b32 s27, 0x20000
    s_add_u32 s64, s6, 0x80000
    s_addc_u32 s65, s7, 0
    s_mov_b32 s66, 0x14400
    s_mov_b32 s67, 0x20000
    s_add_u32 s60, s6, 0x10000
    s_addc_u32 s61, s7, 0
    s_mov_b32 s62, 0x43800
    s_mov_b32 s63, 0x20000
    v_mov_b32 v96, 0
    v_mov_b32 v97, 0
    v_mov_b32 v98, 0
    v_mov_b32 v99, 0
    v_mov_b32 v13, 158720
    s_waitcnt vmcnt(10)
    ds_read_b128 v[56:59], v10 offset:0
    ds_read_b128 v[76:79], v10 offset:2048
    ds_read_b128 v[60:63], v10 offset:256
    ds_read_b128 v[80:83], v10 offset:2304
    ds_read_b128 v[64:67], v10 offset:512
    ds_read_b128 v[84:87], v10 offset:2560
    ds_read_b128 v[68:71], v10 offset:768
    ds_read_b128 v[88:91], v10 offset:2816
    ds_read_b128 v[72:75], v10 offset:1024
    ds_read_b128 v[92:95], v10 offset:3072
    s_waitcnt vmcnt(8) lgkmcnt(8)
    v_dot2c_f32_bf16 v96, v16, v56
    v_dot2c_f32_bf16 v98, v16, v76
    v_dot2c_f32_bf16 v97, v20, v56
    v_dot2c_f32_bf16 v99, v20, v76
    v_dot2c_f32_bf16 v96, v17, v57
    v_dot2c_f32_bf16 v98, v17, v77
    v_dot2c_f32_bf16 v97, v21, v57
    v_dot2c_f32_bf16 v99, v21, v77
    v_dot2c_f32_bf16 v96, v18, v58
    v_dot2c_f32_bf16 v98, v18, v78
    v_dot2c_f32_bf16 v97, v22, v58
    v_dot2c_f32_bf16 v99, v22, v78
    v_dot2c_f32_bf16 v96, v19, v59
    v_dot2c_f32_bf16 v98, v19, v79
    v_dot2c_f32_bf16 v97, v23, v59
    v_dot2c_f32_bf16 v99, v23, v79
    s_waitcnt vmcnt(6) lgkmcnt(6)
    v_dot2c_f32_bf16 v96, v24, v60
    v_dot2c_f32_bf16 v98, v24, v80
    v_dot2c_f32_bf16 v97, v28, v60
    v_dot2c_f32_bf16 v99, v28, v80
    v_dot2c_f32_bf16 v96, v25, v61
    v_dot2c_f32_bf16 v98, v25, v81
    v_dot2c_f32_bf16 v97, v29, v61
    v_dot2c_f32_bf16 v99, v29, v81
    v_dot2c_f32_bf16 v96, v26, v62
    v_dot2c_f32_bf16 v98, v26, v82
    v_dot2c_f32_bf16 v97, v30, v62
    v_dot2c_f32_bf16 v99, v30, v82
    v_dot2c_f32_bf16 v96, v27, v63
    v_dot2c_f32_bf16 v98, v27, v83
    v_dot2c_f32_bf16 v97, v31, v63
    v_dot2c_f32_bf16 v99, v31, v83
    s_waitcnt vmcnt(4) lgkmcnt(4)
    v_dot2c_f32_bf16 v96, v32, v64
    v_dot2c_f32_bf16 v98, v32, v84
    v_dot2c_f32_bf16 v97, v36, v64
    s_branch K_PG6
.p2align 12
K_PG6:
    v_dot2c_f32_bf16 v99, v36, v84
    v_dot2c_f32_bf16 v96, v33, v65
    v_dot2c_f32_bf16 v98, v33, v85
    v_dot2c_f32_bf16 v97, v37, v65
    v_dot2c_f32_bf16 v99, v37, v85
    v_dot2c_f32_bf16 v96, v34, v66
    v_dot2c_f32_bf16 v98, v34, v86
    v_dot2c_f32_bf16 v97, v38, v66
    v_dot2c_f32_bf16 v99, v38, v86
    v_dot2c_f32_bf16 v96, v35, v67
    v_dot2c_f32_bf16 v98, v35, v87
    v_dot2c_f32_bf16 v97, v39, v67
    v_dot2c_f32_bf16 v99, v39, v87
    s_waitcnt vmcnt(2) lgkmcnt(2)
    v_dot2c_f32_bf16 v96, v40, v68
    v_dot2c_f32_bf16 v98, v40, v88
    v_dot2c_f32_bf16 v97, v44, v68
    v_dot2c_f32_bf16 v99, v44, v88
    v_dot2c_f32_bf16 v96, v41, v69
    v_dot2c_f32_bf16 v98, v41, v89
    v_dot2c_f32_bf16 v97, v45, v69
    v_dot2c_f32_bf16 v99, v45, v89
    v_dot2c_f32_bf16 v96, v42, v70
    v_dot2c_f32_bf16 v98, v42, v90
    v_dot2c_f32_bf16 v97, v46, v70
    v_dot2c_f32_bf16 v99, v46, v90
    v_dot2c_f32_bf16 v96, v43, v71
    v_dot2c_f32_bf16 v98, v43, v91
    v_dot2c_f32_bf16 v97, v47, v71
    v_dot2c_f32_bf16 v99, v47, v91
    s_waitcnt vmcnt(0) lgkmcnt(0)
    v_dot2c_f32_bf16 v96, v48, v72
    v_dot2c_f32_bf16 v98, v48, v92
    v_dot2c_f32_bf16 v97, v52, v72
    v_dot2c_f32_bf16 v99, v52, v92
    v_dot2c_f32_bf16 v96, v49, v73
    v_dot2c_f32_bf16 v98, v49, v93
    v_dot2c_f32_bf16 v97, v53, v73
    v_dot2c_f32_bf16 v99, v53, v93
    v_dot2c_f32_bf16 v96, v50, v74
    v_dot2c_f32_bf16 v98, v50, v94
    v_dot2c_f32_bf16 v97, v54, v74
    v_dot2c_f32_bf16 v99, v54, v94
    v_dot2c_f32_bf16 v96, v51, v75
    v_dot2c_f32_bf16 v98, v51, v95
    v_dot2c_f32_bf16 v97, v55, v75
    v_dot2c_f32_bf16 v99, v55, v95
    s_nop 2
    v_add_f32_dpp v96, v96, v96 quad_perm:[1,0,3,2] row_mask:0xf bank_mask:0xf
    v_add_f32_dpp v97, v97, v97 quad_perm:[1,0,3,2] row_mask:0xf bank_mask:0xf
    v_add_f32_dpp v98, v98, v98 quad_perm:[1,0,3,2] row_mask:0xf bank_mask:0xf
    v_add_f32_dpp v99, v99, v99 quad_perm:[1,0,3,2] row_mask:0xf bank_mask:0xf
    v_add_f32_dpp v96, v96, v96 quad_perm:[2,3,0,1] row_mask:0xf bank_mask:0xf
    v_add_f32_dpp v97, v97, v97 quad_perm:[2,3,0,1] row_mask:0xf bank_mask:0xf
    v_add_f32_dpp v98, v98, v98 quad_perm:[2,3,0,1] row_mask:0xf bank_mask:0xf
    v_add_f32_dpp v99, v99, v99 quad_perm:[2,3,0,1] row_mask:0xf bank_mask:0xf
    v_add_f32_dpp v96, v96, v96 row_half_mirror row_mask:0xf bank_mask:0xf
    v_add_f32_dpp v97, v97, v97 row_half_mirror row_mask:0xf bank_mask:0xf
    v_add_f32_dpp v98, v98, v98 row_half_mirror row_mask:0xf bank_mask:0xf
    v_add_f32_dpp v99, v99, v99 row_half_mirror row_mask:0xf bank_mask:0xf
    v_add_f32_dpp v96, v96, v96 row_mirror row_mask:0xf bank_mask:0xf
    v_add_f32_dpp v97, v97, v97 row_mirror row_mask:0xf bank_mask:0xf
    v_add_f32_dpp v98, v98, v98 row_mirror row_mask:0xf bank_mask:0xf
    v_add_f32_dpp v99, v99, v99 row_mirror row_mask:0xf bank_mask:0xf
    v_and_b32 v4, 31, v8
    v_lshlrev_b32 v11, 2, v4
    v_add_u32 v11, 122880, v11
    v_lshlrev_b32 v12, 1, v4
    v_add_u32 v12, 123008, v12
    v_cvt_pk_bf16_f32 v2, v96, v96
    v_lshlrev_b32 v2, 16, v2
    v_ashrrev_i32 v3, 31, v2
    v_or_b32 v3, 0x80000000, v3
    v_xor_b32 v2, v2, v3
    v_and_b32 v2, 0xffff0000, v2
    v_sub_u32 v3, 0x87ff, v8
    v_or_b32 v96, v2, v3
    ds_write_b32 v11, v96 offset:0
    v_cvt_pk_bf16_f32 v98, v98, v98
    v_lshlrev_b32 v98, 16, v98
    v_mul_f32 v5, 0xbfb8aa3b, v98
    v_exp_f32 v5, v5
    s_nop 0
    v_add_f32 v5, 1.0, v5
    v_rcp_f32 v98, v5
    s_nop 0
    v_cvt_pk_bf16_f32 v98, v98, v98
    v_or_b32 v98, 0x8000, v98
    ds_write_b16 v12, v98 offset:0
    v_cvt_pk_bf16_f32 v2, v97, v97
    v_lshlrev_b32 v2, 16, v2
    v_ashrrev_i32 v3, 31, v2
    v_or_b32 v3, 0x80000000, v3
    v_xor_b32 v2, v2, v3
    v_and_b32 v2, 0xffff0000, v2
    v_sub_u32 v3, 0x87fb, v8
    v_or_b32 v97, v2, v3
    ds_write_b32 v11, v97 offset:16
    v_cvt_pk_bf16_f32 v99, v99, v99
    v_lshlrev_b32 v99, 16, v99
    v_mul_f32 v5, 0xbfb8aa3b, v99
    v_exp_f32 v5, v5
    s_nop 0
    v_add_f32 v5, 1.0, v5
    v_rcp_f32 v99, v5
    s_nop 0
    v_cvt_pk_bf16_f32 v99, v99, v99
    v_or_b32 v99, 0x8000, v99
    ds_write_b16 v12, v99 offset:8
    v_mov_b32 v3, 1
    s_mov_b64 exec, 1
    ds_add_u32 v13, v3 offset:48
    s_mov_b64 exec, -1
    s_cmp_ge_u32 s30, 6
    s_cbranch_scc1 K_AUX_G1
    s_mov_b32 s3, 1048576
K_FGR:
    ds_read_b32 v2, v13 offset:48
    s_sleep 1
    s_sub_u32 s3, s3, 1
    s_waitcnt lgkmcnt(0)
    v_readfirstlane_b32 s33, v2
    s_nop 3
    s_cselect_b32 s33, 4, s33
    s_cmp_lt_u32 s33, 4
    s_cbranch_scc1 K_FGR
    s_cmp_lg_u32 s30, 4
    s_cbranch_scc1 K_AUX_G0
    v_and_b32 v3, 31, v1
    v_lshlrev_b32 v3, 2, v3
    v_add_u32 v3, 122880, v3
    ds_read_b32 v2, v3
    s_waitcnt lgkmcnt(0)
    s_nop 1
    v_max_u32_dpp v3, v2, v2 quad_perm:[1,0,3,2] row_mask:0xf bank_mask:0xf
    s_nop 1
    v_max_u32_dpp v3, v3, v3 quad_perm:[2,3,0,1] row_mask:0xf bank_mask:0xf
    s_nop 1
    v_max_u32_dpp v3, v3, v3 row_half_mirror row_mask:0xf bank_mask:0xf
    s_nop 1
    v_max_u32_dpp v3, v3, v3 row_mirror row_mask:0xf bank_mask:0xf
    s_nop 1
    v_readlane_b32 s68, v3, 0
    v_readlane_b32 s76, v3, 16
    v_readlane_b32 s77, v3, 32
    v_readlane_b32 s78, v3, 48
    s_nop 3
    s_max_u32 s68, s68, s76
    s_max_u32 s77, s77, s78
    s_max_u32 s68, s68, s77
    v_cmp_ne_u32 vcc, s68, v2
    s_nop 1
    v_cndmask_b32 v2, 0, v2, vcc
    s_nop 1
    v_max_u32_dpp v3, v2, v2 quad_perm:[1,0,3,2] row_mask:0xf bank_mask:0xf
    s_nop 1
    v_max_u32_dpp v3, v3, v3 quad_perm:[2,3,0,1] row_mask:0xf bank_mask:0xf
    s_nop 1
    v_max_u32_dpp v3, v3, v3 row_half_mirror row_mask:0xf bank_mask:0xf
    s_nop 1
    v_max_u32_dpp v3, v3, v3 row_mirror row_mask:0xf bank_mask:0xf
    s_nop 1
    v_readlane_b32 s69, v3, 0
    v_readlane_b32 s76, v3, 16
    v_readlane_b32 s77, v3, 32
    v_readlane_b32 s78, v3, 48
    s_nop 3
    s_max_u32 s69, s69, s76
    s_max_u32 s77, s77, s78
    s_max_u32 s69, s69, s77
    s_load_dword s33, s[4:5], 0
    s_waitcnt lgkmcnt(0)
    s_cmp_ge_u32 s33, 1
    s_cbranch_scc1 K_ZO3
    s_sleep 8
    s_load_dword s33, s[4:5], 64
    s_waitcnt lgkmcnt(0)
    s_cmp_ge_u32 s33, 1
    s_cbranch_scc1 K_ZO3
    s_sleep 8
    s_mov_b32 s3, 16384
K_ZB3:
    v_mov_b32 v4, 0
    global_load_dword v4, v4, s[4:5] sc1
    s_waitcnt vmcnt(0)
    v_readfirstlane_b32 s33, v4
    s_cmp_ge_u32 s33, 1
    s_cbranch_scc1 K_ZO3
    s_sleep 8
    s_sub_u32 s3, s3, 1
    s_cbranch_scc0 K_ZB3
K_ZO3:
    s_lshl_b32 s3, s2, 3
    s_add_u32 s3, s3, 606208
    s_atomic_add_x2 s[68:69], s[6:7], s3
    s_cmp_lg_u32 s2, 63
    s_cbranch_scc1 K_AUX_G1
    s_mov_b32 s70, 81920
    v_lshlrev_b32 v3, 3, v1
    s_mov_b32 s3, 131072
K_AUX_POLL:
    buffer_load_dwordx2 v[176:177], v3, s[64:67], s70 offen sc1
    s_waitcnt vmcnt(0)
    v_min_u32 v2, v176, v177
    v_cmp_eq_u32 vcc, 0, v2
    s_cbranch_vccz K_AUX_GOT
    s_sleep 2
    s_sub_u32 s3, s3, 1
    s_cmp_lg_u32 s3, 0
    s_cbranch_scc1 K_AUX_POLL
K_AUX_GOT:
    s_waitcnt lgkmcnt(0)
    s_nop 1
    v_max_u32_dpp v3, v176, v176 quad_perm:[1,0,3,2] row_mask:0xf bank_mask:0xf
    s_nop 1
    v_max_u32_dpp v3, v3, v3 quad_perm:[2,3,0,1] row_mask:0xf bank_mask:0xf
    s_nop 1
    v_max_u32_dpp v3, v3, v3 row_half_mirror row_mask:0xf bank_mask:0xf
    s_nop 1
    v_max_u32_dpp v3, v3, v3 row_mirror row_mask:0xf bank_mask:0xf
    s_nop 1
    v_readlane_b32 s68, v3, 0
    v_readlane_b32 s76, v3, 16
    v_readlane_b32 s77, v3, 32
    v_readlane_b32 s78, v3, 48
    s_nop 3
    s_max_u32 s68, s68, s76
    s_max_u32 s77, s77, s78
    s_max_u32 s68, s68, s77
    v_cmp_ne_u32 vcc, s68, v176
    s_nop 1
    v_cndmask_b32 v2, v177, v176, vcc
    s_nop 1
    v_max_u32_dpp v3, v2, v2 quad_perm:[1,0,3,2] row_mask:0xf bank_mask:0xf
    s_nop 1
    v_max_u32_dpp v3, v3, v3 quad_perm:[2,3,0,1] row_mask:0xf bank_mask:0xf
    s_nop 1
    v_max_u32_dpp v3, v3, v3 row_half_mirror row_mask:0xf bank_mask:0xf
    s_nop 1
    v_max_u32_dpp v3, v3, v3 row_mirror row_mask:0xf bank_mask:0xf
    s_nop 1
    v_readlane_b32 s69, v3, 0
    v_readlane_b32 s76, v3, 16
    v_readlane_b32 s77, v3, 32
    v_readlane_b32 s78, v3, 48
    s_nop 3
    s_max_u32 s69, s69, s76
    s_max_u32 s77, s77, s78
    s_max_u32 s69, s69, s77
    v_mov_b32 v176, s68
    v_mov_b32 v177, s69
    s_mov_b32 s3, 1048576
K_FGZ:
    ds_read_b32 v2, v13 offset:36
    s_sleep 1
    s_sub_u32 s3, s3, 1
    s_waitcnt lgkmcnt(0)
    v_readfirstlane_b32 s33, v2
    s_nop 3
    s_cselect_b32 s33, 1, s33
    s_cmp_lt_u32 s33, 1
    s_cbranch_scc1 K_FGZ
    v_lshlrev_b32 v3, 9, v1
    s_mov_b32 s66, 81920
    s_mov_b32 s70, 0
    buffer_store_dwordx2 v[176:177], v3, s[64:67], s70 offen offset:128 sc1
    s_mov_b32 s70, 32768
    buffer_store_dwordx2 v[176:177], v3, s[64:67], s70 offen offset:128 sc1
    s_mov_b32 s70, 65536
    buffer_store_dwordx2 v[176:177], v3, s[64:67], s70 offen offset:128 sc1
    v_mov_b32 v3, 16
    ds_write_b32 v13, v3 offset:48
    s_branch K_AUX_G1
K_AUX_G0:
    v_and_b32 v3, 3, v1
    v_lshlrev_b32 v3, 4, v3
    v_add_u32 v2, 123008, v3
    ds_read_b128 v[176:179], v2
    v_lshrrev_b32 v2, 2, v1
    v_lshl_add_u32 v3, v2, 9, v3
    s_sleep 12
    s_load_dword s33, s[4:5], 128
    s_waitcnt lgkmcnt(0)
    s_cmp_ge_u32 s33, 8
    s_cbranch_scc1 K_ZO4
    s_sleep 8
    s_mov_b32 s3, 16384
K_ZB4:
    v_mov_b32 v4, 128
    global_load_dword v4, v4, s[4:5] sc1
    s_waitcnt vmcnt(0)
    v_readfirstlane_b32 s33, v4
    s_cmp_ge_u32 s33, 8
    s_cbranch_scc1 K_ZO4
    s_sleep 8
    s_sub_u32 s3, s3, 1
    s_cbranch_scc0 K_ZB4
K_ZO4:
    v_mov_b32 v2, 1
    ds_write_b32 v13, v2 offset:36
    s_lshr_b32 s3, s29, 2
    s_lshl1_add_u32 s3, s28, s3
    s_mul_i32 s3, s3, 5120
    s_and_b32 s70, s29, 3
    s_lshl_b32 s70, s70, 6
    s_add_u32 s3, s3, s70
    s_mov_b32 exec_hi, 0xff
    s_waitcnt lgkmcnt(0)
    buffer_store_dwordx4 v[176:179], v3, s[64:67], s3 offen offset:256 sc1
    s_mov_b64 exec, -1
K_AUX_G1:
    s_cmp_lg_u32 s43, 63
    s_cbranch_scc1 K_FFN_C
    s_cmp_lg_u32 s29, 0
    s_cbranch_scc1 K_AUX_NT
    s_lshl2_add_u32 s3, s28, s30
    s_sub_u32 s3, s3, 4
    s_mul_i32 s3, s3, 25600
    v_lshlrev_b32 v2, 7, v1
    buffer_load_dword v5, v2, s[24:27], s3 offen
    s_add_u32 s3, s3, 8192
    buffer_load_dword v5, v2, s[24:27], s3 offen
    s_add_u32 s3, s3, 8192
    buffer_load_dword v5, v2, s[24:27], s3 offen
    s_add_u32 s3, s3, 8192
    s_mov_b64 exec, 0xff
    buffer_load_dword v5, v2, s[24:27], s3 offen
    s_add_u32 s3, s3, 8192
    s_mov_b64 exec, -1
K_AUX_NT:
    s_mov_b32 s3, 1048576
K_FGZ2:
    ds_read_b32 v2, v13 offset:36
    s_sleep 1
    s_sub_u32 s3, s3, 1
    s_waitcnt lgkmcnt(0)
    v_readfirstlane_b32 s33, v2
    s_nop 3
    s_cselect_b32 s33, 1, s33
    s_cmp_lt_u32 s33, 1
    s_cbranch_scc1 K_FGZ2
    s_waitcnt vmcnt(0)
    s_branch K_P2
K_AUX_L:
    v_and_b32 v1, 63, v0
    v_mov_b32 v7, 0
    s_and_b32 s28, s2, 7
    s_lshr_b32 s29, s2, 3
    s_xor_b32 s30, s30, 4
    s_lshr_b32 s34, s29, 3
    s_lshl_b32 s34, s34, 2
    s_and_b32 s3, s29, 3
    s_add_u32 s34, s34, s3
    s_add_u32 s34, s34, 4
    s_bitcmp1_b32 s29, 2
    s_cselect_b32 s34, -1, s34
    s_cmp_lt_u32 s29, 8
    s_cselect_b32 s34, s29, s34
    s_lshl_b32 s40, s28, 1
    s_cmp_ge_u32 s34, 10
    s_addc_u32 s40, s40, 0
    s_sub_u32 s41, s34, 10
    s_cmp_ge_u32 s34, 10
    s_cselect_b32 s41, s41, s34
    s_mul_i32 s42, s28, 20
    s_add_u32 s42, s42, s34
    s_and_b32 s42, s42, 255
    s_lshl_b32 s42, s42, 9
    s_add_u32 s42, s42, 524288
    s_mul_i32 s43, s28, 7
    s_add_u32 s43, s43, s29
    s_sub_u32 s43, s43, 1
    s_cmp_lt_u32 s43, 54
    s_cselect_b32 s43, s43, 63
    s_cmp_eq_u32 s29, 0
    s_cselect_b32 s43, 63, s43
    v_mov_b32 v3, 158736
    ds_write2_b32 v3, v7, v7 offset0:0 offset1:1
    ds_write2_b32 v3, v7, v7 offset0:2 offset1:3
    ds_write2_b32 v3, v7, v7 offset0:4 offset1:5
    ds_write2_b32 v3, v7, v7 offset0:6 offset1:7
    ds_write2_b32 v3, v7, v7 offset0:8 offset1:9
    ds_write2_b32 v3, v7, v7 offset0:10 offset1:11
    v_lshrrev_b32 v3, 2, v1
    v_mul_u32_u24 v11, 3456, v3
    v_lshrrev_b32 v3, 4, v1
    v_and_b32 v3, 2, v3
    v_xor_b32 v3, v3, v1
    v_and_b32 v3, 3, v3
    v_lshl_add_u32 v11, v3, 4, v11
    s_mul_i32 s3, s30, 552960
    s_lshl_b32 s70, s43, 6
    s_add_u32 s3, s3, s70
    v_add_u32 v11, s3, v11
    s_mul_i32 s68, s30, 10240
    s_add_u32 s72, s68, 40960
    s_bitcmp1_b32 s43, 0
    s_cselect_b32 s71, s72, s68
    s_cselect_b32 s72, s68, s72
    v_lshlrev_b32 v8, 4, v1
    s_waitcnt lgkmcnt(0)
    s_barrier
    s_mov_b32 s24, s8
    s_mov_b32 s25, s9
    s_mov_b32 s26, 0xc8000
    s_mov_b32 s27, 0x20000
    s_cmp_lg_u32 s43, 63
    s_cbranch_scc1 K_AUX_FFN1
    s_cmp_lg_u32 s30, 0
    s_cbranch_scc1 K_AUX_NR
    s_cmp_eq_u32 s2, 55
    s_cbranch_scc1 K_AUX_NR
    s_cmp_eq_u32 s2, 63
    s_cselect_b32 s70, 0, 128
    s_mov_b32 s3, 1
    s_waitcnt vmcnt(0)
    s_atomic_add s3, s[4:5], s70
    s_atomic_add s3, s[4:5], s70 offset:64
    s_waitcnt lgkmcnt(0)
K_AUX_NR:
    v_mov_b32 v13, 158720
    s_mov_b32 s3, 1048576
K_FGZ3:
    ds_read_b32 v2, v13 offset:36
    s_sleep 1
    s_sub_u32 s3, s3, 1
    s_waitcnt lgkmcnt(0)
    v_readfirstlane_b32 s33, v2
    s_nop 3
    s_cselect_b32 s33, 1, s33
    s_cmp_lt_u32 s33, 1
    s_cbranch_scc1 K_FGZ3
    s_cmp_lg_u32 s2, 63
    s_cbranch_scc1 K_AUX_NH
    s_mov_b32 s3, 1048576
K_FGH:
    ds_read_b32 v2, v13 offset:48
    s_sleep 1
    s_sub_u32 s3, s3, 1
    s_waitcnt lgkmcnt(0)
    v_readfirstlane_b32 s33, v2
    s_nop 3
    s_cselect_b32 s33, 16, s33
    s_cmp_lt_u32 s33, 16
    s_cbranch_scc1 K_FGH
K_AUX_NH:
    s_branch K_P2
K_AUX_FFN1:
    s_bitcmp1_b32 s43, 0
    s_cselect_b64 s[56:57], s[48:49], s[46:47]
    s_cselect_b64 s[60:61], s[46:47], s[48:49]
    s_mov_b32 s58, 2211840
    s_mov_b32 s59, 0x20000
    s_mov_b32 s62, 2211840
    s_mov_b32 s63, 0x20000
    s_add_u32 m0, s71, 0
    s_mov_b32 s70, 0
    buffer_load_dwordx4 v11, s[56:59], s70 offen  lds
    s_add_u32 m0, s71, 1024
    s_mov_b32 s70, 55296
    buffer_load_dwordx4 v11, s[56:59], s70 offen  lds
    s_add_u32 m0, s71, 2048
    s_mov_b32 s70, 110592
    buffer_load_dwordx4 v11, s[56:59], s70 offen  lds
    s_add_u32 m0, s71, 3072
    s_mov_b32 s70, 165888
    buffer_load_dwordx4 v11, s[56:59], s70 offen  lds
    s_add_u32 m0, s71, 4096
    s_mov_b32 s70, 221184
    buffer_load_dwordx4 v11, s[56:59], s70 offen  lds
    s_add_u32 m0, s71, 5120
    s_mov_b32 s70, 276480
    buffer_load_dwordx4 v11, s[56:59], s70 offen  lds
    s_add_u32 m0, s71, 6144
    s_mov_b32 s70, 331776
    buffer_load_dwordx4 v11, s[56:59], s70 offen  lds
    s_add_u32 m0, s71, 7168
    s_mov_b32 s70, 387072
    buffer_load_dwordx4 v11, s[56:59], s70 offen  lds
    s_add_u32 m0, s71, 8192
    s_mov_b32 s70, 442368
    buffer_load_dwordx4 v11, s[56:59], s70 offen  lds
    s_add_u32 m0, s71, 9216
    s_mov_b32 s70, 497664
    buffer_load_dwordx4 v11, s[56:59], s70 offen  lds
    s_add_u32 m0, s72, 0
    s_mov_b32 s70, 0
    buffer_load_dwordx4 v11, s[60:63], s70 offen  lds
    s_add_u32 m0, s72, 1024
    s_mov_b32 s70, 55296
    buffer_load_dwordx4 v11, s[60:63], s70 offen  lds
    s_add_u32 m0, s72, 2048
    s_mov_b32 s70, 110592
    buffer_load_dwordx4 v11, s[60:63], s70 offen  lds
    s_add_u32 m0, s72, 3072
    s_mov_b32 s70, 165888
    buffer_load_dwordx4 v11, s[60:63], s70 offen  lds
    s_add_u32 m0, s72, 4096
    s_mov_b32 s70, 221184
    buffer_load_dwordx4 v11, s[60:63], s70 offen  lds
    s_add_u32 m0, s72, 5120
    s_mov_b32 s70, 276480
    buffer_load_dwordx4 v11, s[60:63], s70 offen  lds
    s_add_u32 m0, s72, 6144
    s_mov_b32 s70, 331776
    buffer_load_dwordx4 v11, s[60:63], s70 offen  lds
    s_add_u32 m0, s72, 7168
    s_mov_b32 s70, 387072
    buffer_load_dwordx4 v11, s[60:63], s70 offen  lds
    s_add_u32 m0, s72, 8192
    s_mov_b32 s70, 442368
    buffer_load_dwordx4 v11, s[60:63], s70 offen  lds
    s_add_u32 m0, s72, 9216
    s_mov_b32 s70, 497664
    buffer_load_dwordx4 v11, s[60:63], s70 offen  lds
    s_mov_b32 s64, s50
    s_mov_b32 s65, s51
    s_mov_b32 s66, 0x21c000
    s_mov_b32 s67, 0x20000
    s_mul_i32 s3, s43, 40960
    s_add_u32 s3, s3, s68
    v_lshrrev_b32 v2, 3, v1
    v_and_b32 v3, 2, v2
    s_lshl_b32 s70, s30, 2
    v_xor_b32 v3, s70, v3
    v_xor_b32 v3, v3, v1
    v_and_b32 v3, 7, v3
    v_mul_u32_u24 v2, 1280, v2
    v_lshl_add_u32 v2, v3, 4, v2
    v_add_u32 v12, s3, v2
    s_add_u32 m0, s68, 81920
    s_mov_b32 s70, 0
    buffer_load_dwordx4 v12, s[64:67], s70 offen  lds
    s_add_u32 m0, s68, 82944
    s_mov_b32 s70, 128
    buffer_load_dwordx4 v12, s[64:67], s70 offen  lds
    s_add_u32 m0, s68, 83968
    s_mov_b32 s70, 256
    buffer_load_dwordx4 v12, s[64:67], s70 offen  lds
    s_add_u32 m0, s68, 84992
    s_mov_b32 s70, 384
    buffer_load_dwordx4 v12, s[64:67], s70 offen  lds
    s_add_u32 m0, s68, 86016
    s_mov_b32 s70, 512
    buffer_load_dwordx4 v12, s[64:67], s70 offen  lds
    s_add_u32 m0, s68, 87040
    s_mov_b32 s70, 640
    buffer_load_dwordx4 v12, s[64:67], s70 offen  lds
    s_add_u32 m0, s68, 88064
    s_mov_b32 s70, 768
    buffer_load_dwordx4 v12, s[64:67], s70 offen  lds
    s_add_u32 m0, s68, 89088
    s_mov_b32 s70, 896
    buffer_load_dwordx4 v12, s[64:67], s70 offen  lds
    s_add_u32 m0, s68, 90112
    s_mov_b32 s70, 1024
    buffer_load_dwordx4 v12, s[64:67], s70 offen  lds
    s_add_u32 m0, s68, 91136
    s_mov_b32 s70, 1152
    buffer_load_dwordx4 v12, s[64:67], s70 offen  lds
    s_waitcnt vmcnt(10)
    s_barrier
    s_branch K_P2_EARLY
K_FFN_C:
    v_lshrrev_b32 v180, 4, v1
    v_bfe_u32 v2, v1, 2, 2
    v_lshl_add_u32 v2, v180, 3, v2
    v_and_b32 v3, 3, v1
    v_lshlrev_b32 v3, 3, v3
    v_lshl_add_u32 v181, v2, 6, v3
    s_bfe_u32 s3, s30, 0x10001
    s_mul_i32 s3, s3, 40960
    v_xor_b32 v4, s30, v180
    v_and_b32 v4, 1, v4
    v_lshl_add_u32 v181, v4, 5, v181
    v_add_u32 v181, s3, v181
    v_bfe_u32 v4, v1, 3, 2
    v_xor_b32 v4, s30, v4
    v_and_b32 v4, 3, v4
    v_lshl_add_u32 v3, v4, 5, v3
    v_and_b32 v2, 3, v2
    v_lshl_add_u32 v3, v2, 7, v3
    v_mul_u32_u24 v182, 10240, v180
    s_mov_b32 s3, 81920
    v_add3_u32 v182, v182, v3, s3
    v_mov_b32 v183, 123904
    s_cmp_lg_u32 s30, 5
    s_cbranch_scc1 K_KW
    s_mov_b32 s3, 131072
K_KPOLL:
    s_load_dwordx2 s[68:69], s[6:7], s42 offset:128 glc
    s_waitcnt lgkmcnt(0)
    s_min_u32 s33, s68, s69
    s_cmp_lg_u32 s33, 0
    s_cbranch_scc1 K_KGOT
    s_sleep 2
    s_sub_u32 s3, s3, 1
    s_cbranch_scc0 K_KPOLL
K_KGOT:
    v_mov_b32 v176, s68
    v_mov_b32 v177, s69
    ds_write_b64 v183, v[176:177]
    v_lshlrev_b32 v2, 4, v1
    s_and_b32 s70, s68, 0x7ff
    s_sub_u32 s70, 2047, s70
    s_mul_i32 s70, s70, 1280
    s_mov_b32 m0, 134208
    s_mov_b64 exec, -1
    buffer_load_dwordx4 v2, s[12:15], s70 offen lds
    s_mov_b64 exec, 0xffff
    buffer_load_dwordx4 v2, s[12:15], s70 offen offset:1024 lds
    s_and_b32 s70, s69, 0x7ff
    s_sub_u32 s70, 2047, s70
    s_mul_i32 s70, s70, 1280
    s_mov_b32 m0, 135552
    s_mov_b64 exec, -1
    buffer_load_dwordx4 v2, s[12:15], s70 offen lds
    s_mov_b64 exec, 0xffff
    buffer_load_dwordx4 v2, s[12:15], s70 offen offset:1024 lds
    s_mov_b64 exec, -1
    v_mov_b32 v3, 16
    s_waitcnt vmcnt(0)
    ds_write_b32 v13, v3 offset:48
    s_branch K_KW2
K_KW:
    s_cmp_lt_u32 s30, 6
    s_cbranch_scc1 K_KW2
    s_cmp_eq_u32 s30, 6
    s_cbranch_scc1 K_CHF0
    s_branch K_CHF1
K_WRET_F:
K_KW2:
    s_branch K_J7da4
K_CHF0:
K_STF16:
    s_branch K_STF18
    s_nop 0
K_J7da4:
    v_and_b32 v2, 1, v1
    v_mul_u32_u24 v9, 1344, v2
    v_lshl_add_u32 v9, v180, 4, v9
    v_add_u32 v9, 134208, v9
    v_and_b32 v2, 1, v1
    v_lshlrev_b32 v192, 6, v2
    v_lshl_add_u32 v192, v180, 4, v192
    s_and_b32 s3, s30, 3
    s_lshl_b32 s3, s3, 7
    v_add3_u32 v193, v192, s3, v183
    v_add_u32 v192, 64, v193
    v_add_u32 v193, 1088, v193
    v_lshrrev_b32 v2, 5, v1
    v_bfe_u32 v3, v1, 4, 1
    v_lshl_add_u32 v3, v3, 1, v2
    v_lshlrev_b32 v3, 6, v3
    v_and_b32 v4, 15, v1
    v_lshl_add_u32 v3, v4, 2, v3
    v_add_u32 v194, 123968, v3
    v_lshlrev_b32 v4, 1, v1
    s_add_u32 s3, s3, 124992
    v_add_u32 v195, s3, v4
    v_and_b32 v2, 1, v1
    v_mul_u32_u24 v2, 2560, v2
    v_lshl_add_u32 v196, v180, 4, v2
    s_lshl_b32 s70, s30, 6
    s_add_u32 s70, s70, 125760
    v_add_u32 v196, s70, v196
    v_mov_b32 v3, 1
    s_mov_b32 s3, 1048576
K_FGK:
    ds_read_b32 v2, v13 offset:48
    s_sleep 1
    s_sub_u32 s3, s3, 1
    s_waitcnt lgkmcnt(0)
    v_readfirstlane_b32 s33, v2
    s_nop 3
    s_cselect_b32 s33, 16, s33
    s_cmp_lt_u32 s33, 16
    s_cbranch_scc1 K_FGK
    ds_read_b128 v[96:99], v9 offset:0
    ds_read_b128 v[100:103], v9 offset:64
    ds_read_b128 v[104:107], v9 offset:128
    ds_read_b128 v[108:111], v9 offset:192
    ds_read_b128 v[112:115], v9 offset:256
    ds_read_b128 v[116:119], v9 offset:320
    ds_read_b128 v[120:123], v9 offset:384
    ds_read_b128 v[124:127], v9 offset:448
    ds_read_b128 v[128:131], v9 offset:512
    ds_read_b128 v[132:135], v9 offset:576
    ds_read_b128 v[136:139], v9 offset:640
    ds_read_b128 v[140:143], v9 offset:704
    ds_read_b128 v[144:147], v9 offset:768
    ds_read_b128 v[148:151], v9 offset:832
    ds_read_b128 v[152:155], v9 offset:896
    ds_read_b128 v[156:159], v9 offset:960
    ds_read_b128 v[160:163], v9 offset:1024
    ds_read_b128 v[164:167], v9 offset:1088
    ds_read_b128 v[168:171], v9 offset:1152
    ds_read_b128 v[172:175], v9 offset:1216
    s_setprio 3
    s_barrier
    ds_read_b64_tr_b16 v[16:17], v181 offset:0
    ds_read_b64_tr_b16 v[18:19], v181 offset:256
    ds_read_b64_tr_b16 v[20:21], v181 offset:2048
    ds_read_b64_tr_b16 v[22:23], v181 offset:2304
    ds_read_b64_tr_b16 v[24:25], v181 offset:4096
    ds_read_b64_tr_b16 v[26:27], v181 offset:4352
    ds_read_b64_tr_b16 v[28:29], v181 offset:6144
    ds_read_b64_tr_b16 v[30:31], v181 offset:6400
    ds_read_b64_tr_b16 v[32:33], v181 offset:8192
    ds_read_b64_tr_b16 v[34:35], v181 offset:8448
    ds_read_b64_tr_b16 v[36:37], v181 offset:10240
    ds_read_b64_tr_b16 v[38:39], v181 offset:10496
    ds_read_b64_tr_b16 v[40:41], v181 offset:12288
    ds_read_b64_tr_b16 v[42:43], v181 offset:12544
    ds_read_b64_tr_b16 v[44:45], v181 offset:14336
    ds_read_b64_tr_b16 v[46:47], v181 offset:14592
    ds_read_b64_tr_b16 v[48:49], v181 offset:16384
    ds_read_b64_tr_b16 v[50:51], v181 offset:16640
    ds_read_b64_tr_b16 v[52:53], v181 offset:18432
    ds_read_b64_tr_b16 v[54:55], v181 offset:18688
    ds_read_b64_tr_b16 v[56:57], v181 offset:20480
    ds_read_b64_tr_b16 v[58:59], v181 offset:20736
    ds_read_b64_tr_b16 v[60:61], v181 offset:22528
    ds_read_b64_tr_b16 v[62:63], v181 offset:22784
    ds_read_b64_tr_b16 v[64:65], v181 offset:24576
    s_branch K_PG7
.p2align 12
K_CHF1:
K_STF17:
    s_branch K_WRET_F
    s_nop 0
K_PG7:
    ds_read_b64_tr_b16 v[66:67], v181 offset:24832
    ds_read_b64_tr_b16 v[68:69], v181 offset:26624
    ds_read_b64_tr_b16 v[70:71], v181 offset:26880
    ds_read_b64_tr_b16 v[72:73], v181 offset:28672
    ds_read_b64_tr_b16 v[74:75], v181 offset:28928
    ds_read_b64_tr_b16 v[76:77], v181 offset:30720
    ds_read_b64_tr_b16 v[78:79], v181 offset:30976
    ds_read_b64_tr_b16 v[80:81], v181 offset:32768
    ds_read_b64_tr_b16 v[82:83], v181 offset:33024
    ds_read_b64_tr_b16 v[84:85], v181 offset:34816
    ds_read_b64_tr_b16 v[86:87], v181 offset:35072
    ds_read_b64_tr_b16 v[88:89], v181 offset:36864
    ds_read_b64_tr_b16 v[90:91], v181 offset:37120
    ds_read_b64_tr_b16 v[92:93], v181 offset:38912
    ds_read_b64_tr_b16 v[94:95], v181 offset:39168
    s_waitcnt lgkmcnt(0)
    s_barrier
    v_mfma_f32_16x16x32_bf16 v[184:187], v[16:19], v[96:99], 0
    v_mfma_f32_16x16x32_bf16 v[188:191], v[20:23], v[100:103], 0
    v_mfma_f32_16x16x32_bf16 v[184:187], v[24:27], v[104:107], v[184:187]
    v_mfma_f32_16x16x32_bf16 v[188:191], v[28:31], v[108:111], v[188:191]
    v_mfma_f32_16x16x32_bf16 v[184:187], v[32:35], v[112:115], v[184:187]
    v_mfma_f32_16x16x32_bf16 v[188:191], v[36:39], v[116:119], v[188:191]
    v_mfma_f32_16x16x32_bf16 v[184:187], v[40:43], v[120:123], v[184:187]
    v_mfma_f32_16x16x32_bf16 v[188:191], v[44:47], v[124:127], v[188:191]
    v_mfma_f32_16x16x32_bf16 v[184:187], v[48:51], v[128:131], v[184:187]
    v_mfma_f32_16x16x32_bf16 v[188:191], v[52:55], v[132:135], v[188:191]
    v_mfma_f32_16x16x32_bf16 v[184:187], v[56:59], v[136:139], v[184:187]
    v_mfma_f32_16x16x32_bf16 v[188:191], v[60:63], v[140:143], v[188:191]
    v_mfma_f32_16x16x32_bf16 v[184:187], v[64:67], v[144:147], v[184:187]
    v_mfma_f32_16x16x32_bf16 v[188:191], v[68:71], v[148:151], v[188:191]
    v_mfma_f32_16x16x32_bf16 v[184:187], v[72:75], v[152:155], v[184:187]
    v_mfma_f32_16x16x32_bf16 v[188:191], v[76:79], v[156:159], v[188:191]
    v_mfma_f32_16x16x32_bf16 v[184:187], v[80:83], v[160:163], v[184:187]
    v_mfma_f32_16x16x32_bf16 v[188:191], v[84:87], v[164:167], v[188:191]
    v_mfma_f32_16x16x32_bf16 v[184:187], v[88:91], v[168:171], v[184:187]
    v_mfma_f32_16x16x32_bf16 v[188:191], v[92:95], v[172:175], v[188:191]
    s_nop 7
    v_add_f32 v184, v184, v188
    v_add_f32 v185, v185, v189
    v_add_f32 v186, v186, v190
    v_add_f32 v187, v187, v191
    s_mov_b32 exec_lo, 0x00030003
    s_mov_b32 exec_hi, 0x00030003
    ds_write_b128 v192, v[184:187]
    s_mov_b64 exec, 1
    ds_add_u32 v13, v3 offset:52
    s_mov_b64 exec, -1
    s_cmp_lg_u32 s30, 6
    s_cbranch_scc1 K_NOS6B
    v_lshl_add_u32 v4, v1, 2, s42
    global_load_dword v7, v4, s[6:7] offset:256 sc1
    v_and_b32 v4, 0xfffffe04, v4
    global_load_dword v6, v4, s[6:7] offset:128 sc1
K_NOS6B:
    s_mov_b32 s3, 1048576
K_FGP:
    ds_read_b32 v2, v13 offset:52
    s_sleep 1
    s_sub_u32 s3, s3, 1
    s_waitcnt lgkmcnt(0)
    v_readfirstlane_b32 s33, v2
    s_nop 3
    s_cselect_b32 s33, 8, s33
    s_cmp_lt_u32 s33, 8
    s_cbranch_scc1 K_FGP
    ds_read_b32 v200, v194
    ds_read_b32 v202, v194 offset:256
    ds_read_b64_tr_b16 v[16:17], v182 offset:0
    ds_read_b64_tr_b16 v[18:19], v182 offset:512
    ds_read_b64_tr_b16 v[20:21], v182 offset:1024
    ds_read_b64_tr_b16 v[22:23], v182 offset:1536
    ds_read_b64_tr_b16 v[24:25], v182 offset:2048
    ds_read_b64_tr_b16 v[26:27], v182 offset:2560
    ds_read_b64_tr_b16 v[28:29], v182 offset:3072
    ds_read_b64_tr_b16 v[30:31], v182 offset:3584
    ds_read_b64_tr_b16 v[32:33], v182 offset:4096
    ds_read_b64_tr_b16 v[34:35], v182 offset:4608
    ds_read_b64_tr_b16 v[36:37], v182 offset:5120
    ds_read_b64_tr_b16 v[38:39], v182 offset:5632
    ds_read_b64_tr_b16 v[40:41], v182 offset:6144
    ds_read_b64_tr_b16 v[42:43], v182 offset:6656
    s_waitcnt lgkmcnt(14)
    v_cvt_pk_bf16_f32 v200, v200, v200
    v_lshlrev_b32 v200, 16, v200
    v_cvt_pk_bf16_f32 v202, v202, v202
    v_lshlrev_b32 v202, 16, v202
    v_mul_f32 v201, 0xbfb8aa3b, v200
    v_exp_f32 v201, v201
    s_nop 0
    v_add_f32 v201, 1.0, v201
    v_rcp_f32 v201, v201
    s_nop 0
    v_mul_f32 v200, v200, v201
    v_cvt_pk_bf16_f32 v200, v200, v200
    v_lshlrev_b32 v200, 16, v200
    v_mul_f32 v200, v200, v202
    v_cvt_pk_bf16_f32 v200, v200, v200
    ds_write_b16 v195, v200
    s_waitcnt lgkmcnt(0)
    ds_read_b128 v[200:203], v193
    ds_read_b64_tr_b16 v[44:45], v182 offset:7168
    ds_read_b64_tr_b16 v[46:47], v182 offset:7680
    ds_read_b64_tr_b16 v[48:49], v182 offset:8192
    ds_read_b64_tr_b16 v[50:51], v182 offset:8704
    ds_read_b64_tr_b16 v[52:53], v182 offset:9216
    ds_read_b64_tr_b16 v[54:55], v182 offset:9728
    s_waitcnt lgkmcnt(6)
    v_mfma_f32_16x16x32_bf16 v[96:99], v[16:19], v[200:203], 0
    v_mfma_f32_16x16x32_bf16 v[100:103], v[20:23], v[200:203], 0
    v_mfma_f32_16x16x32_bf16 v[104:107], v[24:27], v[200:203], 0
    v_mfma_f32_16x16x32_bf16 v[108:111], v[28:31], v[200:203], 0
    v_mfma_f32_16x16x32_bf16 v[112:115], v[32:35], v[200:203], 0
    v_mfma_f32_16x16x32_bf16 v[116:119], v[36:39], v[200:203], 0
    v_mfma_f32_16x16x32_bf16 v[120:123], v[40:43], v[200:203], 0
    s_waitcnt lgkmcnt(4)
    v_mfma_f32_16x16x32_bf16 v[124:127], v[44:47], v[200:203], 0
    s_waitcnt lgkmcnt(2)
    v_mfma_f32_16x16x32_bf16 v[128:131], v[48:51], v[200:203], 0
    s_waitcnt lgkmcnt(0)
    v_mfma_f32_16x16x32_bf16 v[132:135], v[52:55], v[200:203], 0
    s_mov_b32 exec_lo, 0x00030003
    s_mov_b32 exec_hi, 0x00030003
    ds_write_b128 v196, v[96:99] offset:0
    ds_write_b128 v196, v[100:103] offset:256
    ds_write_b128 v196, v[104:107] offset:512
    ds_write_b128 v196, v[108:111] offset:768
    ds_write_b128 v196, v[112:115] offset:1024
    ds_write_b128 v196, v[116:119] offset:1280
    ds_write_b128 v196, v[120:123] offset:1536
    ds_write_b128 v196, v[124:127] offset:1792
    ds_write_b128 v196, v[128:131] offset:2048
    ds_write_b128 v196, v[132:135] offset:2304
    v_mov_b32 v3, 1
    s_mov_b64 exec, 1
    ds_add_u32 v13, v3 offset:52
    s_mov_b64 exec, -1
    s_cmp_lg_u32 s30, 4
    s_cbranch_scc1 K_P2
    v_lshlrev_b32 v3, 4, v1
    v_add_u32 v4, 126016, v3
    s_mul_i32 s70, s43, 5120
    s_add_u32 s71, s70, 4096
    s_branch K_J83cc
K_STF18:
    s_branch K_WRET_F
    s_nop 0
K_J83cc:
    s_mov_b32 s3, 1048576
K_FGQ:
    ds_read_b32 v2, v13 offset:52
    s_sleep 1
    s_sub_u32 s3, s3, 1
    s_waitcnt lgkmcnt(0)
    v_readfirstlane_b32 s33, v2
    s_nop 3
    s_cselect_b32 s33, 12, s33
    s_cmp_lt_u32 s33, 12
    s_cbranch_scc1 K_FGQ
    ds_read_b128 v[16:19], v4 offset:0
    ds_read_b128 v[20:23], v4 offset:1024
    ds_read_b128 v[24:27], v4 offset:2048
    ds_read_b128 v[28:31], v4 offset:3072
    ds_read_b128 v[32:35], v4 offset:4096
    s_waitcnt lgkmcnt(4)
    buffer_store_dwordx4 v[16:19], v3, s[60:63], s70 offen offset:0 sc1
    s_waitcnt lgkmcnt(3)
    buffer_store_dwordx4 v[20:23], v3, s[60:63], s70 offen offset:1024 sc1
    s_waitcnt lgkmcnt(2)
    buffer_store_dwordx4 v[24:27], v3, s[60:63], s70 offen offset:2048 sc1
    s_waitcnt lgkmcnt(1)
    buffer_store_dwordx4 v[28:31], v3, s[60:63], s70 offen offset:3072 sc1
    s_waitcnt lgkmcnt(0)
    buffer_store_dwordx4 v[32:35], v3, s[60:63], s71 offen offset:0 sc1
    s_mov_b32 s3, 1
    s_waitcnt vmcnt(0)
    s_atomic_add s3, s[6:7], 606720 glc
    ds_read_b64 v[176:177], v183
    s_waitcnt lgkmcnt(0)
    s_cmp_lg_u32 s3, 53
    s_cbranch_scc1 K_P2
    v_readfirstlane_b32 s70, v176
    s_and_b32 s70, s70, 0x7ff
    s_sub_u32 s70, 2047, s70
    s_lshr_b32 s70, s70, 7
    s_mul_i32 s70, s70, 5120
    s_atomic_add s3, s[6:7], s70 offset:524424
    s_atomic_add s3, s[6:7], s70 offset:524936
    s_atomic_add s3, s[6:7], s70 offset:525448
    s_atomic_add s3, s[6:7], s70 offset:525960
    s_atomic_add s3, s[6:7], s70 offset:526472
    s_atomic_add s3, s[6:7], s70 offset:526984
    s_atomic_add s3, s[6:7], s70 offset:527496
    s_atomic_add s3, s[6:7], s70 offset:528008
    s_atomic_add s3, s[6:7], s70 offset:528520
    s_atomic_add s3, s[6:7], s70 offset:529032
    v_readfirstlane_b32 s70, v177
    s_and_b32 s70, s70, 0x7ff
    s_sub_u32 s70, 2047, s70
    s_lshr_b32 s70, s70, 7
    s_mul_i32 s70, s70, 5120
    s_atomic_add s3, s[6:7], s70 offset:524424
    s_atomic_add s3, s[6:7], s70 offset:524936
    s_atomic_add s3, s[6:7], s70 offset:525448
    s_atomic_add s3, s[6:7], s70 offset:525960
    s_atomic_add s3, s[6:7], s70 offset:526472
    s_atomic_add s3, s[6:7], s70 offset:526984
    s_atomic_add s3, s[6:7], s70 offset:527496
    s_atomic_add s3, s[6:7], s70 offset:528008
    s_atomic_add s3, s[6:7], s70 offset:528520
    s_atomic_add s3, s[6:7], s70 offset:529032
    s_waitcnt lgkmcnt(0)
    s_branch K_P2
K_CODE_END:
.section .rodata,"a"
.p2align 6
.amdhsa_kernel gated_mix__sliding_local_dilated__moe_arch_mod__prompt_kernel
  .amdhsa_next_free_vgpr 256
  .amdhsa_next_free_sgpr 79
  .amdhsa_accum_offset 256
  .amdhsa_group_segment_fixed_size 0
  .amdhsa_kernarg_size 96
  .amdhsa_user_sgpr_count 2
  .amdhsa_user_sgpr_kernarg_segment_ptr 1
  .amdhsa_system_sgpr_workgroup_id_x 1
.end_amdhsa_kernel
```

```asm
; @launch grid=(256,1,1) block=(512,1,1) lds=163840
.amdgcn_target "amdgcn-amd-amdhsa--gfx950"
.text
K_CPL = 33
.p2align 12
.p2align 8
.globl gated_mix__sliding_local_dilated__moe_arch_mod__prompt_kernel
.type gated_mix__sliding_local_dilated__moe_arch_mod__prompt_kernel,@function
gated_mix__sliding_local_dilated__moe_arch_mod__prompt_kernel:
    s_cmp_ge_u32 s2, 256
    s_cbranch_scc1 K_EXIT
    s_load_dwordx2 s[12:13], s[0:1], 0
    s_load_dwordx2 s[16:17], s[0:1], 8
    s_load_dwordx4 s[4:7], s[0:1], 80
    s_load_dwordx2 s[8:9], s[0:1], 16
    s_load_dwordx2 s[10:11], s[0:1], 72
    v_readfirstlane_b32 s30, v0
    s_mov_b32 s14, 0x280000
    s_mov_b32 s15, 0x20000
    s_lshr_b32 s30, s30, 6
    s_cmp_ge_u32 s2, 64
    s_cbranch_scc1 K_MAIN
    s_load_dwordx8 s[44:51], s[0:1], 32
    s_load_dwordx2 s[52:53], s[0:1], 64
    s_getpc_b64 s[38:39]
K_PC:
    s_lshr_b32 s3, s2, 3
    s_mul_i32 s3, s3, K_CPL
    v_add_u32 v2, s3, v0
    v_lshlrev_b32 v2, 7, v2
    v_min_u32 v2, K_CODE_END-K_PC-4, v2
    v_cmp_gt_u32 vcc, K_CPL, v0
    s_and_saveexec_b64 s[20:21], vcc
    s_cbranch_execz K_NOPF
    global_load_dword v6, v2, s[38:39]
K_NOPF:
    s_mov_b64 exec, -1
    s_cmp_lg_u32 s30, 4
    s_cbranch_scc1 K_AUX
    s_min_u32 s3, s2, 8
    s_mul_i32 s3, s3, 10240
    s_add_u32 s33, s3, 10240
    s_cmp_lt_u32 s2, 8
    s_cbranch_scc1 K_ZS
    s_cmp_lg_u32 s2, 63
    s_cbranch_scc1 K_AUX
    s_mov_b32 s33, 0
K_ZS:
    v_lshlrev_b32 v2, 4, v0
    v_mov_b32 v8, 0
    v_mov_b32 v9, 0
    v_mov_b32 v10, 0
    v_mov_b32 v11, 0
    s_waitcnt lgkmcnt(0)
    s_add_u32 s20, s6, 0x7f000
    s_addc_u32 s21, s7, 0
    s_mov_b32 s22, 0x15400
    s_mov_b32 s23, 0x20000
K_ZL:
    buffer_store_dwordx4 v[8:11], v2, s[20:23], s3 offen sc1
    s_add_u32 s3, s3, 1024
    s_cmp_lt_u32 s3, s33
    s_cbranch_scc1 K_ZL
    s_branch K_AUX
K_MAIN:
    s_cmp_ge_u32 s30, 4
    s_cbranch_scc1 K_CONS
    s_bfe_u32 s3, s2, 0x20001
    s_mul_i32 s44, s3, 655360
    s_add_u32 s14, s44, 655360
    s_lshr_b32 s33, s2, 6
    s_mul_i32 s3, s33, 225280
    s_add_u32 s44, s44, s3
    s_mul_i32 s3, s30, 61440
    s_add_u32 s44, s44, s3
    s_sub_u32 s44, s44, 245760
    v_bfe_u32 v3, v0, 4, 2
    s_lshr_b32 s3, s2, 1
    s_and_b32 s3, s3, 28
    s_or_b32 s3, s3, 0x40000
    v_lshlrev_b32 v2, 1, v3
    v_sub_u32 v2, v0, v2
    s_and_b32 s50, s2, 0xc1
    s_mov_b32 s49, 0x225310
    s_cmpk_eq_u32 s50, 128
    s_cselect_b32 s49, 0x75275526, s49
    s_cmpk_eq_u32 s50, 192
    s_cselect_b32 s49, 0x37750756, s49
    s_cmpk_eq_u32 s50, 65
    s_cselect_b32 s49, 0x225510, s49
    s_cmpk_eq_u32 s50, 129
    s_cselect_b32 s49, 0x75275525, s49
    s_cmpk_eq_u32 s50, 193
    s_cselect_b32 s49, 0x37769756, s49
    s_bfe_u32 s49, s49, s3
    s_bfe_u32 s32, 0x64317520, s3
    v_and_b32 v2, 15, v2
    v_mul_u32_u24 v5, 3840, v3
    s_lshl_b32 s3, s2, 2
    s_lshr_b32 s3, 0x44032335, s3
    s_and_b32 s3, s3, 15
    s_add_u32 s49, s49, s3
    s_mov_b32 s33, 0x00a55a
    v_subrev_u32 v5, 160, v5
    s_sub_u32 s3, s49, 10
    s_cselect_b32 s49, s49, s3
    v_mul_u32_u24 v4, 52, v2
    v_lshrrev_b32 v4, 5, v4
    v_and_b32 v4, 24, v4
    v_bfe_u32 v4, s33, v4, 8
    v_add_u32 v4, v4, v2
    v_lshl_add_u32 v218, v4, 4, v5
    v_add_u32 v4, 1, v2
    v_lshrrev_b32 v4, 4, v4
    v_lshl_add_u32 v218, v4, 28, v218
    v_xor_b32 v2, 8, v2
    v_mul_u32_u24 v4, 52, v2
    v_lshrrev_b32 v4, 5, v4
    v_and_b32 v4, 24, v4
    v_bfe_u32 v4, s33, v4, 8
    v_add_u32 v4, v4, v2
    v_lshl_add_u32 v219, v4, 4, v5
    v_add_u32 v4, 1, v2
    v_lshrrev_b32 v4, 4, v4
    v_lshl_add_u32 v219, v4, 28, v219
    s_bitcmp1_b32 s2, 0
    s_cselect_b32 s3, 8, 0
    s_add_u32 s32, s32, s3
    s_mul_i32 s50, s32, 80
    s_mul_i32 s3, s30, 61440
    s_add_u32 s50, s50, s3
    s_lshl_b32 s46, s30, 12
    s_add_u32 s46, s46, 24576
    s_mul_i32 s45, s30, 6144
    s_mov_b32 s18, 0x258000
    s_mov_b32 s19, 0x20000
    v_xor_b32 v3, v3, v0
    v_and_b32 v3, 7, v3
    v_bfe_u32 v2, v0, 3, 3
    v_mul_u32_u24 v2, 1280, v2
    v_lshl_add_u32 v216, v3, 4, v2
    v_xor_b32 v217, 64, v216
    s_lshl_b32 s47, s49, 7
    s_mul_i32 s48, s49, 245760
    s_add_u32 s51, s44, s47
    s_add_u32 s48, s48, s50
    s_add_u32 s49, s49, 1
    s_cmp_eq_u32 s49, 10
    s_cselect_b32 s49, 0, s49
    s_waitcnt lgkmcnt(0)
    s_add_u32 m0, s46, 81920
    s_add_u32 s52, s48, 0
    buffer_load_dwordx4 v218, s[16:19], s52 offen lds
    s_add_u32 m0, s45, 81920
    s_max_i32 s52, s51, s47
    buffer_load_dwordx4 v216, s[12:15], s52 offen lds
    s_add_u32 m0, s46, 82944
    s_add_u32 s52, s48, 15360
    buffer_load_dwordx4 v218, s[16:19], s52 offen lds
    s_add_u32 m0, s45, 82944
    s_add_u32 s52, s51, 10240
    s_max_i32 s52, s52, s47
    buffer_load_dwordx4 v217, s[12:15], s52 offen lds
    s_add_u32 m0, s45, 83968
    s_add_u32 s52, s51, 20480
    buffer_load_dwordx4 v216, s[12:15], s52 offen lds
    s_add_u32 m0, s46, 83968
    s_add_u32 s52, s48, 30720
    buffer_load_dwordx4 v219, s[16:19], s52 offen lds
    s_add_u32 m0, s45, 84992
    s_add_u32 s52, s51, 30720
    buffer_load_dwordx4 v217, s[12:15], s52 offen lds
    s_add_u32 m0, s46, 84992
    s_add_u32 s52, s48, 46080
    buffer_load_dwordx4 v219, s[16:19], s52 offen lds
    s_add_u32 m0, s45, 86016
    s_add_u32 s52, s51, 40960
    buffer_load_dwordx4 v216, s[12:15], s52 offen lds
    s_add_u32 m0, s45, 87040
    s_add_u32 s52, s51, 51200
    buffer_load_dwordx4 v217, s[12:15], s52 offen lds
    s_lshl_b32 s47, s49, 7
    s_mul_i32 s48, s49, 245760
    s_add_u32 s51, s44, s47
    s_add_u32 s48, s48, s50
    s_add_u32 s49, s49, 1
    s_cmp_eq_u32 s49, 10
    s_cselect_b32 s49, 0, s49
    s_add_u32 m0, s46, 0
    s_add_u32 s52, s48, 0
    buffer_load_dwordx4 v218, s[16:19], s52 offen lds
    s_add_u32 m0, s45, 0
    s_max_i32 s52, s51, s47
    buffer_load_dwordx4 v216, s[12:15], s52 offen lds
    s_add_u32 m0, s46, 1024
    s_add_u32 s52, s48, 15360
    buffer_load_dwordx4 v218, s[16:19], s52 offen lds
    s_add_u32 m0, s45, 1024
    s_add_u32 s52, s51, 10240
    s_max_i32 s52, s52, s47
    buffer_load_dwordx4 v217, s[12:15], s52 offen lds
    s_add_u32 m0, s45, 2048
    s_add_u32 s52, s51, 20480
    buffer_load_dwordx4 v216, s[12:15], s52 offen lds
    s_add_u32 m0, s46, 2048
    s_add_u32 s52, s48, 30720
    buffer_load_dwordx4 v219, s[16:19], s52 offen lds
    s_mov_b32 s43, s30
    v_and_b32 v1, 63, v0
    v_mov_b32 v7, 0
    s_and_b32 s28, s2, 7
    s_lshr_b32 s29, s2, 3
    s_xor_b32 s30, s30, 4
    s_lshr_b32 s34, s29, 3
    s_lshl_b32 s34, s34, 2
    s_and_b32 s3, s29, 3
    s_add_u32 s34, s34, s3
    s_add_u32 s34, s34, 4
    s_bitcmp1_b32 s29, 2
    s_cselect_b32 s34, -1, s34
    s_cmp_lt_u32 s29, 8
    s_cselect_b32 s34, s29, s34
    s_lshl_b32 s40, s28, 1
    s_cmp_ge_u32 s34, 10
    s_addc_u32 s40, s40, 0
    s_sub_u32 s41, s34, 10
    s_cmp_ge_u32 s34, 10
    s_cselect_b32 s41, s41, s34
    s_mul_i32 s42, s28, 20
    s_add_u32 s42, s42, s34
    s_and_b32 s42, s42, 255
    s_lshl_b32 s42, s42, 9
    s_add_u32 s42, s42, 524288
    s_lshr_b32 s31, s28, 1
    s_lshl_b32 s31, s31, 5
    s_lshr_b32 s3, s29, 3
    s_mul_i32 s3, s3, 11
    s_add_u32 s31, s31, s3
    s_sub_u32 s31, s31, 11
    s_and_b32 s32, s28, 1
    s_lshl_b32 s32, s32, 3
    s_and_b32 s3, s29, 7
    s_lshl_b32 s3, s3, 2
    s_lshr_b32 s3, 0x64317520, s3
    s_and_b32 s3, s3, 7
    s_add_u32 s32, s32, s3
    s_and_b32 s35, s29, 3
    s_and_b32 s3, s29, 4
    s_lshl_b32 s3, s3, 1
    s_add_u32 s35, s35, s3
    s_and_b32 s3, s28, 1
    s_lshl_b32 s3, s3, 2
    s_add_u32 s35, s35, s3
K_LOADER:
    s_mov_b32 s24, s8
    s_mov_b32 s25, s9
    s_mov_b32 s26, 0xc8000
    s_mov_b32 s27, 0x20000
    v_and_b32 v8, 15, v1
    v_lshrrev_b32 v9, 4, v1
    v_bfe_u32 v10, v1, 2, 2
    v_and_b32 v11, 3, v1
    s_add_u32 s20, s6, 0x100000
    s_addc_u32 s21, s7, 0
    s_mov_b32 s22, 0x280000
    s_mov_b32 s23, 0x20000
    s_lshr_b32 s53, s35, 2
    s_add_u32 s3, s53, s35
    s_lshl_b32 s3, s3, 12
    s_mul_i32 s33, s53, 19456
    s_lshl_b32 s53, s35, 8
    s_add_u32 s33, s33, s53
    s_add_u32 s33, s33, 16384
    s_lshr_b32 s53, s31, 5
    s_add_u32 s53, s53, 1
    s_mul_i32 s22, s53, 655360
    s_mov_b32 s53, s31
    s_add_u32 s54, s53, s43
    v_mov_b32 v3, s54
    v_lshrrev_b32 v2, 2, v3
    v_mul_u32_u24 v2, 76, v2
    v_add_lshl_u32 v2, v2, v3, 10
    v_lshl_add_u32 v2, v8, 4, v2
    v_add_u32 v220, s3, v2
    v_lshl_add_u32 v220, v9, 8, v220
    s_lshl_b32 s3, s43, 2
    v_add_u32 v4, s3, v9
    v_add_u32 v3, s53, v4
    v_lshrrev_b32 v2, 2, v3
    v_mul_u32_u24 v2, 76, v2
    v_add_lshl_u32 v2, v2, v3, 10
    v_lshl_add_u32 v2, v8, 4, v2
    v_add_u32 v221, s33, v2
    v_mov_b32 v5, 0x10000000
    v_cmp_gt_u32 vcc, 11, v4
    v_mov_b32 v224, -1
    v_mov_b32 v225, -1
    v_mov_b32 v226, -1
    v_mov_b32 v227, -1
    v_cndmask_b32 v221, v5, v221, vcc
    v_lshrrev_b32 v2, 3, v1
    v_mul_u32_u24 v2, 1280, v2
    v_lshrrev_b32 v3, 2, v1
    v_and_b32 v3, 4, v3
    v_and_b32 v4, 7, v1
    v_xor_b32 v3, v3, v4
    v_lshl_add_u32 v2, v3, 4, v2
    s_lshl_b32 s33, s41, 7
    v_add_u32 v222, s33, v2
    v_lshrrev_b32 v5, 5, v1
    v_mul_u32_u24 v5, 20480, v5
    v_add_u32 v5, v5, v222
    s_mov_b32 s30, s43
    s_waitcnt vmcnt(6)
    s_barrier
    s_add_u32 m0, s45, 3072
    s_add_u32 s52, s51, 30720
    buffer_load_dwordx4 v217, s[12:15], s52 offen lds
    s_add_u32 m0, s46, 3072
    s_add_u32 s52, s48, 46080
    buffer_load_dwordx4 v219, s[16:19], s52 offen lds
    s_add_u32 m0, s45, 4096
    s_add_u32 s52, s51, 40960
    buffer_load_dwordx4 v216, s[12:15], s52 offen lds
    s_add_u32 m0, s45, 5120
    s_add_u32 s52, s51, 51200
    buffer_load_dwordx4 v217, s[12:15], s52 offen lds
    s_lshl_b32 s47, s49, 7
    s_mul_i32 s48, s49, 245760
    s_add_u32 s51, s44, s47
    s_add_u32 s48, s48, s50
    s_add_u32 s49, s49, 1
    s_cmp_eq_u32 s49, 10
    s_cselect_b32 s49, 0, s49
    s_add_u32 m0, s46, 40960
    s_add_u32 s52, s48, 0
    buffer_load_dwordx4 v218, s[16:19], s52 offen lds
    s_add_u32 m0, s45, 40960
    s_max_i32 s52, s51, s47
    buffer_load_dwordx4 v216, s[12:15], s52 offen lds
    s_add_u32 m0, s46, 41984
    s_add_u32 s52, s48, 15360
    buffer_load_dwordx4 v218, s[16:19], s52 offen lds
    s_add_u32 m0, s45, 41984
    s_add_u32 s52, s51, 10240
    s_max_i32 s52, s52, s47
    buffer_load_dwordx4 v217, s[12:15], s52 offen lds
    s_add_u32 m0, s45, 43008
    s_add_u32 s52, s51, 20480
    buffer_load_dwordx4 v216, s[12:15], s52 offen lds
    s_add_u32 m0, s46, 43008
    s_add_u32 s52, s48, 30720
    buffer_load_dwordx4 v219, s[16:19], s52 offen lds
    s_waitcnt vmcnt(6)
    s_barrier
    s_add_u32 m0, s45, 44032
    s_add_u32 s52, s51, 30720
    buffer_load_dwordx4 v217, s[12:15], s52 offen lds
    s_add_u32 m0, s46, 44032
    s_add_u32 s52, s48, 46080
    buffer_load_dwordx4 v219, s[16:19], s52 offen lds
    s_add_u32 m0, s45, 45056
    s_add_u32 s52, s51, 40960
    buffer_load_dwordx4 v216, s[12:15], s52 offen lds
    s_add_u32 m0, s45, 46080
    s_add_u32 s52, s51, 51200
    buffer_load_dwordx4 v217, s[12:15], s52 offen lds
    s_lshl_b32 s47, s49, 7
    s_mul_i32 s48, s49, 245760
    s_add_u32 s51, s44, s47
    s_add_u32 s48, s48, s50
    s_add_u32 s49, s49, 1
    s_cmp_eq_u32 s49, 10
    s_cselect_b32 s49, 0, s49
    s_add_u32 m0, s46, 81920
    s_add_u32 s52, s48, 0
    buffer_load_dwordx4 v218, s[16:19], s52 offen lds
    s_add_u32 m0, s45, 81920
    s_max_i32 s52, s51, s47
    buffer_load_dwordx4 v216, s[12:15], s52 offen lds
    s_add_u32 m0, s46, 82944
    s_add_u32 s52, s48, 15360
    buffer_load_dwordx4 v218, s[16:19], s52 offen lds
    s_add_u32 m0, s45, 82944
    s_add_u32 s52, s51, 10240
    s_max_i32 s52, s52, s47
    buffer_load_dwordx4 v217, s[12:15], s52 offen lds
    s_add_u32 m0, s45, 83968
    s_add_u32 s52, s51, 20480
    buffer_load_dwordx4 v216, s[12:15], s52 offen lds
    s_add_u32 m0, s46, 83968
    s_add_u32 s52, s48, 30720
    buffer_load_dwordx4 v219, s[16:19], s52 offen lds
    s_waitcnt vmcnt(6)
    s_barrier
    s_add_u32 m0, s45, 84992
    s_add_u32 s52, s51, 30720
    buffer_load_dwordx4 v217, s[12:15], s52 offen lds
    s_add_u32 m0, s46, 84992
    s_add_u32 s52, s48, 46080
    buffer_load_dwordx4 v219, s[16:19], s52 offen lds
    s_add_u32 m0, s45, 86016
    s_add_u32 s52, s51, 40960
    buffer_load_dwordx4 v216, s[12:15], s52 offen lds
    s_add_u32 m0, s45, 87040
    s_add_u32 s52, s51, 51200
    buffer_load_dwordx4 v217, s[12:15], s52 offen lds
    s_lshl_b32 s47, s49, 7
    s_mul_i32 s48, s49, 245760
    s_add_u32 s51, s44, s47
    s_add_u32 s48, s48, s50
    s_add_u32 s49, s49, 1
    s_cmp_eq_u32 s49, 10
    s_cselect_b32 s49, 0, s49
    s_add_u32 m0, s46, 0
    s_add_u32 s52, s48, 0
    buffer_load_dwordx4 v218, s[16:19], s52 offen lds
    s_add_u32 m0, s45, 0
    s_max_i32 s52, s51, s47
    buffer_load_dwordx4 v216, s[12:15], s52 offen lds
    s_add_u32 m0, s46, 1024
    s_add_u32 s52, s48, 15360
    buffer_load_dwordx4 v218, s[16:19], s52 offen lds
    s_add_u32 m0, s45, 1024
    s_add_u32 s52, s51, 10240
    s_max_i32 s52, s52, s47
    buffer_load_dwordx4 v217, s[12:15], s52 offen lds
    s_add_u32 m0, s45, 2048
    s_add_u32 s52, s51, 20480
    buffer_load_dwordx4 v216, s[12:15], s52 offen lds
    s_add_u32 m0, s46, 2048
    s_add_u32 s52, s48, 30720
    buffer_load_dwordx4 v219, s[16:19], s52 offen lds
    s_waitcnt vmcnt(6)
    s_barrier
    s_add_u32 m0, s45, 3072
    s_add_u32 s52, s51, 30720
    buffer_load_dwordx4 v217, s[12:15], s52 offen lds
    s_add_u32 m0, s46, 3072
    s_add_u32 s52, s48, 46080
    buffer_load_dwordx4 v219, s[16:19], s52 offen lds
    s_add_u32 m0, s45, 4096
    s_add_u32 s52, s51, 40960
    buffer_load_dwordx4 v216, s[12:15], s52 offen lds
    s_add_u32 m0, s45, 5120
    s_add_u32 s52, s51, 51200
    buffer_load_dwordx4 v217, s[12:15], s52 offen lds
    s_lshl_b32 s47, s49, 7
    s_mul_i32 s48, s49, 245760
    s_add_u32 s51, s44, s47
    s_add_u32 s48, s48, s50
    s_add_u32 s49, s49, 1
    s_cmp_eq_u32 s49, 10
    s_cselect_b32 s49, 0, s49
    s_add_u32 m0, s46, 40960
    s_add_u32 s52, s48, 0
    buffer_load_dwordx4 v218, s[16:19], s52 offen lds
    s_add_u32 m0, s45, 40960
    s_max_i32 s52, s51, s47
    buffer_load_dwordx4 v216, s[12:15], s52 offen lds
    s_add_u32 m0, s46, 41984
    s_add_u32 s52, s48, 15360
    buffer_load_dwordx4 v218, s[16:19], s52 offen lds
    s_add_u32 m0, s45, 41984
    s_add_u32 s52, s51, 10240
    s_max_i32 s52, s52, s47
    buffer_load_dwordx4 v217, s[12:15], s52 offen lds
    s_add_u32 m0, s45, 43008
    s_add_u32 s52, s51, 20480
    buffer_load_dwordx4 v216, s[12:15], s52 offen lds
    s_add_u32 m0, s46, 43008
    s_add_u32 s52, s48, 30720
    buffer_load_dwordx4 v219, s[16:19], s52 offen lds
    s_waitcnt vmcnt(6)
    s_barrier
    s_add_u32 m0, s45, 44032
    s_add_u32 s52, s51, 30720
    buffer_load_dwordx4 v217, s[12:15], s52 offen lds
    s_add_u32 m0, s46, 44032
    s_add_u32 s52, s48, 46080
    buffer_load_dwordx4 v219, s[16:19], s52 offen lds
    s_add_u32 m0, s45, 45056
    s_add_u32 s52, s51, 40960
    buffer_load_dwordx4 v216, s[12:15], s52 offen lds
    s_add_u32 m0, s45, 46080
    s_add_u32 s52, s51, 51200
    buffer_load_dwordx4 v217, s[12:15], s52 offen lds
    s_lshl_b32 s47, s49, 7
    s_mul_i32 s48, s49, 245760
    s_add_u32 s51, s44, s47
    s_add_u32 s48, s48, s50
    s_add_u32 s49, s49, 1
    s_cmp_eq_u32 s49, 10
    s_cselect_b32 s49, 0, s49
    s_add_u32 m0, s46, 81920
    s_add_u32 s52, s48, 0
    buffer_load_dwordx4 v218, s[16:19], s52 offen lds
    s_add_u32 m0, s45, 81920
    s_max_i32 s52, s51, s47
    buffer_load_dwordx4 v216, s[12:15], s52 offen lds
    s_add_u32 m0, s46, 82944
    s_add_u32 s52, s48, 15360
    buffer_load_dwordx4 v218, s[16:19], s52 offen lds
    s_add_u32 m0, s45, 82944
    s_add_u32 s52, s51, 10240
    s_max_i32 s52, s52, s47
    buffer_load_dwordx4 v217, s[12:15], s52 offen lds
    s_add_u32 m0, s45, 83968
    s_add_u32 s52, s51, 20480
    buffer_load_dwordx4 v216, s[12:15], s52 offen lds
    s_add_u32 m0, s46, 83968
    s_add_u32 s52, s48, 30720
    buffer_load_dwordx4 v219, s[16:19], s52 offen lds
    s_waitcnt vmcnt(6)
    s_barrier
    s_add_u32 m0, s45, 84992
    s_add_u32 s52, s51, 30720
    buffer_load_dwordx4 v217, s[12:15], s52 offen lds
    s_add_u32 m0, s46, 84992
    s_add_u32 s52, s48, 46080
    buffer_load_dwordx4 v219, s[16:19], s52 offen lds
    s_add_u32 m0, s45, 86016
    s_add_u32 s52, s51, 40960
    buffer_load_dwordx4 v216, s[12:15], s52 offen lds
    s_add_u32 m0, s45, 87040
    s_add_u32 s52, s51, 51200
    buffer_load_dwordx4 v217, s[12:15], s52 offen lds
    s_lshl_b32 s47, s49, 7
    s_mul_i32 s48, s49, 245760
    s_add_u32 s51, s44, s47
    s_add_u32 s48, s48, s50
    s_add_u32 s49, s49, 1
    s_cmp_eq_u32 s49, 10
    s_cselect_b32 s49, 0, s49
    s_add_u32 m0, s46, 0
    s_add_u32 s52, s48, 0
    buffer_load_dwordx4 v218, s[16:19], s52 offen lds
    s_add_u32 m0, s45, 0
    s_max_i32 s52, s51, s47
    buffer_load_dwordx4 v216, s[12:15], s52 offen lds
    s_add_u32 m0, s46, 1024
    s_add_u32 s52, s48, 15360
    buffer_load_dwordx4 v218, s[16:19], s52 offen lds
    s_add_u32 m0, s45, 1024
    s_add_u32 s52, s51, 10240
    s_max_i32 s52, s52, s47
    buffer_load_dwordx4 v217, s[12:15], s52 offen lds
    s_add_u32 m0, s45, 2048
    s_add_u32 s52, s51, 20480
    buffer_load_dwordx4 v216, s[12:15], s52 offen lds
    s_add_u32 m0, s46, 2048
    s_add_u32 s52, s48, 30720
    buffer_load_dwordx4 v219, s[16:19], s52 offen lds
    s_branch K_PG0
.p2align 12
K_CHM0:
K_STM0:
    s_branch K_WRET_M
    s_nop 0
K_PG0:
    s_waitcnt vmcnt(6)
    s_barrier
    s_add_u32 m0, s45, 3072
    s_add_u32 s52, s51, 30720
    buffer_load_dwordx4 v217, s[12:15], s52 offen lds
    s_add_u32 m0, s46, 3072
    s_add_u32 s52, s48, 46080
    buffer_load_dwordx4 v219, s[16:19], s52 offen lds
    s_add_u32 m0, s45, 4096
    s_add_u32 s52, s51, 40960
    buffer_load_dwordx4 v216, s[12:15], s52 offen lds
    s_add_u32 m0, s45, 5120
    s_add_u32 s52, s51, 51200
    buffer_load_dwordx4 v217, s[12:15], s52 offen lds
    s_lshl_b32 s47, s49, 7
    s_mul_i32 s48, s49, 245760
    s_add_u32 s51, s44, s47
    s_add_u32 s48, s48, s50
    s_add_u32 s49, s49, 1
    s_cmp_eq_u32 s49, 10
    s_cselect_b32 s49, 0, s49
    s_add_u32 m0, s46, 40960
    s_add_u32 s52, s48, 0
    buffer_load_dwordx4 v218, s[16:19], s52 offen lds
    s_add_u32 m0, s45, 40960
    s_max_i32 s52, s51, s47
    buffer_load_dwordx4 v216, s[12:15], s52 offen lds
    s_add_u32 m0, s46, 41984
    s_add_u32 s52, s48, 15360
    buffer_load_dwordx4 v218, s[16:19], s52 offen lds
    s_add_u32 m0, s45, 41984
    s_add_u32 s52, s51, 10240
    s_max_i32 s52, s52, s47
    buffer_load_dwordx4 v217, s[12:15], s52 offen lds
    s_add_u32 m0, s45, 43008
    s_add_u32 s52, s51, 20480
    buffer_load_dwordx4 v216, s[12:15], s52 offen lds
    s_add_u32 m0, s46, 43008
    s_add_u32 s52, s48, 30720
    buffer_load_dwordx4 v219, s[16:19], s52 offen lds
    s_waitcnt vmcnt(6)
    s_barrier
    s_add_u32 m0, s45, 44032
    s_add_u32 s52, s51, 30720
    buffer_load_dwordx4 v217, s[12:15], s52 offen lds
    s_add_u32 m0, s46, 44032
    s_add_u32 s52, s48, 46080
    buffer_load_dwordx4 v219, s[16:19], s52 offen lds
    s_add_u32 m0, s45, 45056
    s_add_u32 s52, s51, 40960
    buffer_load_dwordx4 v216, s[12:15], s52 offen lds
    s_add_u32 m0, s45, 46080
    s_add_u32 s52, s51, 51200
    buffer_load_dwordx4 v217, s[12:15], s52 offen lds
    s_lshl_b32 s47, s49, 7
    s_mul_i32 s48, s49, 245760
    s_add_u32 s51, s44, s47
    s_add_u32 s48, s48, s50
    s_add_u32 s49, s49, 1
    s_cmp_eq_u32 s49, 10
    s_cselect_b32 s49, 0, s49
    s_add_u32 m0, s46, 81920
    s_add_u32 s52, s48, 0
    buffer_load_dwordx4 v218, s[16:19], s52 offen lds
    s_add_u32 m0, s45, 81920
    s_max_i32 s52, s51, s47
    buffer_load_dwordx4 v216, s[12:15], s52 offen lds
    s_add_u32 m0, s46, 82944
    s_add_u32 s52, s48, 15360
    buffer_load_dwordx4 v218, s[16:19], s52 offen lds
    s_add_u32 m0, s45, 82944
    s_add_u32 s52, s51, 10240
    s_max_i32 s52, s52, s47
    buffer_load_dwordx4 v217, s[12:15], s52 offen lds
    s_add_u32 m0, s45, 83968
    s_add_u32 s52, s51, 20480
    buffer_load_dwordx4 v216, s[12:15], s52 offen lds
    s_add_u32 m0, s46, 83968
    s_add_u32 s52, s48, 30720
    buffer_load_dwordx4 v219, s[16:19], s52 offen lds
    s_waitcnt vmcnt(6)
    s_barrier
    s_load_dword s54, s[4:5], 192
    s_add_u32 m0, s45, 84992
    s_add_u32 s52, s51, 30720
    buffer_load_dwordx4 v217, s[12:15], s52 offen lds
    s_add_u32 m0, s46, 84992
    s_add_u32 s52, s48, 46080
    buffer_load_dwordx4 v219, s[16:19], s52 offen lds
    s_add_u32 m0, s45, 86016
    s_add_u32 s52, s51, 40960
    buffer_load_dwordx4 v216, s[12:15], s52 offen lds
    s_add_u32 m0, s45, 87040
    s_add_u32 s52, s51, 51200
    buffer_load_dwordx4 v217, s[12:15], s52 offen lds
    s_waitcnt lgkmcnt(0)
    s_cmp_ge_u32 s54, 8
    s_cbranch_scc1 K_ZO0
    s_mov_b32 s3, 16384
K_ZB0:
    v_mov_b32 v4, 192
    global_load_dword v4, v4, s[4:5] sc1
    s_waitcnt vmcnt(0)
    v_readfirstlane_b32 s33, v4
    s_cmp_ge_u32 s33, 8
    s_cbranch_scc1 K_ZO0
    s_sleep 8
    s_sub_u32 s3, s3, 1
    s_cbranch_scc0 K_ZB0
K_ZO0:
    s_cmp_eq_u32 s34, -1
    s_cbranch_scc1 K_NOLT
    s_lshl_b32 s47, s43, 2
    s_lshr_b32 s47, 0x7520, s47
    s_and_b32 s47, s47, 7
    s_mul_i32 s47, s47, 51200
    s_lshl_b32 s48, s43, 12
    s_add_u32 s3, s47, 0
    s_add_u32 m0, s48, 0
    s_nop 0
    buffer_load_dwordx4 v222, s[24:27], s3 offen lds
    s_add_u32 s3, s47, 10240
    s_add_u32 m0, s48, 1024
    s_nop 0
    buffer_load_dwordx4 v222, s[24:27], s3 offen lds
    s_add_u32 s3, s47, 25600
    s_add_u32 m0, s48, 2048
    s_nop 0
    buffer_load_dwordx4 v222, s[24:27], s3 offen lds
    s_add_u32 s3, s47, 35840
    s_add_u32 m0, s48, 3072
    s_nop 0
    buffer_load_dwordx4 v222, s[24:27], s3 offen lds
    s_add_u32 s3, s47, 409600
    s_add_u32 m0, s48, 20480
    s_nop 0
    buffer_load_dwordx4 v222, s[24:27], s3 offen lds
    s_add_u32 s3, s47, 419840
    s_add_u32 m0, s48, 21504
    s_nop 0
    buffer_load_dwordx4 v222, s[24:27], s3 offen lds
    s_add_u32 s3, s47, 435200
    s_add_u32 m0, s48, 22528
    s_nop 0
    buffer_load_dwordx4 v222, s[24:27], s3 offen lds
    s_add_u32 s3, s47, 445440
    s_add_u32 m0, s48, 23552
    s_nop 0
    buffer_load_dwordx4 v222, s[24:27], s3 offen lds
    s_lshl_b32 s48, s43, 10
    s_add_u32 s3, s47, 20480
    s_add_u32 m0, s48, 16384
    s_nop 0
    buffer_load_dwordx4 v5, s[24:27], s3 offen lds
    s_add_u32 s3, s47, 430080
    s_add_u32 m0, s48, 36864
    s_nop 0
    buffer_load_dwordx4 v5, s[24:27], s3 offen lds
    s_waitcnt vmcnt(10)
    s_barrier
    s_mov_b32 s33, 81920
    s_cmp_eq_u32 s43, 3
    s_cselect_b32 s3, 0, 163840
    buffer_store_dwordx4 v[224:227], v220, s[20:23], 0 offen sc1
    buffer_store_dwordx4 v[224:227], v220, s[20:23], s33 offen sc1
    buffer_store_dwordx4 v[224:227], v220, s[20:23], s3 offen sc1
    buffer_store_dwordx4 v[224:227], v221, s[20:23], 0 offen sc1
    v_mov_b32 v2, 158720
    v_mov_b32 v3, 1
    s_waitcnt vmcnt(0)
    s_mov_b64 exec, 1
    ds_add_u32 v2, v3 offset:28
    ds_add_u32 v2, v3 offset:32
    s_mov_b64 exec, -1
    s_lshl_b32 s47, s43, 2
    s_lshr_b32 s47, 0x6431, s47
    s_and_b32 s47, s47, 7
    s_mul_i32 s47, s47, 51200
    s_lshl_b32 s48, s43, 12
    s_add_u32 s3, s47, 0
    s_add_u32 m0, s48, 40960
    s_nop 0
    buffer_load_dwordx4 v222, s[24:27], s3 offen lds
    s_add_u32 s3, s47, 10240
    s_add_u32 m0, s48, 41984
    s_nop 0
    buffer_load_dwordx4 v222, s[24:27], s3 offen lds
    s_add_u32 s3, s47, 25600
    s_add_u32 m0, s48, 43008
    s_nop 0
    buffer_load_dwordx4 v222, s[24:27], s3 offen lds
    s_add_u32 s3, s47, 35840
    s_add_u32 m0, s48, 44032
    s_nop 0
    buffer_load_dwordx4 v222, s[24:27], s3 offen lds
    s_add_u32 s3, s47, 409600
    s_add_u32 m0, s48, 61440
    s_nop 0
    buffer_load_dwordx4 v222, s[24:27], s3 offen lds
    s_add_u32 s3, s47, 419840
    s_add_u32 m0, s48, 62464
    s_nop 0
    buffer_load_dwordx4 v222, s[24:27], s3 offen lds
    s_add_u32 s3, s47, 435200
    s_add_u32 m0, s48, 63488
    s_nop 0
    buffer_load_dwordx4 v222, s[24:27], s3 offen lds
    s_add_u32 s3, s47, 445440
    s_add_u32 m0, s48, 64512
    s_nop 0
    buffer_load_dwordx4 v222, s[24:27], s3 offen lds
    s_lshl_b32 s48, s43, 10
    s_add_u32 s3, s47, 20480
    s_add_u32 m0, s48, 57344
    s_nop 0
    buffer_load_dwordx4 v5, s[24:27], s3 offen lds
    s_add_u32 s3, s47, 430080
    s_add_u32 m0, s48, 77824
    s_nop 0
    buffer_load_dwordx4 v5, s[24:27], s3 offen lds
    s_branch K_P2_GM
K_NOLT:
    s_waitcnt vmcnt(0)
    s_barrier
    s_mov_b32 s33, 81920
    s_cmp_eq_u32 s43, 3
    s_cselect_b32 s3, 0, 163840
    buffer_store_dwordx4 v[224:227], v220, s[20:23], 0 offen sc1
    buffer_store_dwordx4 v[224:227], v220, s[20:23], s33 offen sc1
    buffer_store_dwordx4 v[224:227], v220, s[20:23], s3 offen sc1
    buffer_store_dwordx4 v[224:227], v221, s[20:23], 0 offen sc1
    v_mov_b32 v2, 158720
    v_mov_b32 v3, 1
    s_waitcnt vmcnt(0)
    s_mov_b64 exec, 1
    ds_add_u32 v2, v3 offset:28
    ds_add_u32 v2, v3 offset:32
    s_mov_b64 exec, -1
    s_branch K_END
K_CONS:
    v_and_b32 v1, 63, v0
    v_and_b32 v8, 15, v1
    v_lshrrev_b32 v9, 4, v1
    v_bfe_u32 v10, v1, 2, 2
    v_and_b32 v11, 3, v1
    s_bfe_u32 s54, s30, 0x10001
    s_and_b32 s55, s30, 1
    v_lshrrev_b32 v2, 1, v8
    v_xor_b32 v2, v2, v9
    v_lshlrev_b32 v2, 4, v2
    v_lshl_add_u32 v2, v8, 7, v2
    s_mul_i32 s3, s54, 12288
    v_add_u32 v39, s3, v2
    v_xor_b32 v40, 64, v39
    v_add_u32 v41, 81920, v39
    v_add_u32 v42, 81920, v40
    v_and_b32 v2, 1, v9
    v_lshl_or_b32 v2, v2, 2, v10
    s_mul_i32 s3, s55, 40
    v_lshl_add_u32 v2, v2, 5, s3
    v_lshl_add_u32 v3, v9, 3, v10
    v_lshlrev_b32 v3, 8, v3
    v_add_u32 v3, 24576, v3
    v_lshl_add_u32 v5, v11, 3, v2
    s_mul_i32 s33, s55, 805306368
    s_sub_u32 s33, 0xf870c020, s33
    v_add_u32 v4, 0, v5
    v_and_b32 v4, 255, v4
    v_add_u32 v43, v4, v3
    v_add_u32 v47, 81920, v43
    v_add_u32 v4, 160, v5
    v_and_b32 v4, 255, v4
    v_add_u32 v44, v4, v3
    v_add_u32 v48, 81920, v44
    v_add_u32 v4, 80, v5
    v_and_b32 v4, 255, v4
    v_add_u32 v45, v4, v3
    v_add_u32 v49, 81920, v45
    v_lshlrev_b32 v4, 3, v11
    v_bfe_u32 v4, s33, v4, 8
    v_add_u32 v4, v4, v2
    v_and_b32 v4, 255, v4
    v_add_u32 v46, v4, v3
    v_add_u32 v50, 81920, v46
    v_and_b32 v1, 63, v0
    v_mov_b32 v7, 0
    s_and_b32 s28, s2, 7
    s_lshr_b32 s29, s2, 3
    s_xor_b32 s30, s30, 4
    s_lshr_b32 s34, s29, 3
    s_lshl_b32 s34, s34, 2
    s_and_b32 s3, s29, 3
    s_add_u32 s34, s34, s3
    s_add_u32 s34, s34, 4
    s_bitcmp1_b32 s29, 2
    s_cselect_b32 s34, -1, s34
    s_cmp_lt_u32 s29, 8
    s_cselect_b32 s34, s29, s34
    s_lshl_b32 s40, s28, 1
    s_cmp_ge_u32 s34, 10
    s_addc_u32 s40, s40, 0
    s_sub_u32 s41, s34, 10
    s_cmp_ge_u32 s34, 10
    s_cselect_b32 s41, s41, s34
    s_mul_i32 s42, s28, 20
    s_add_u32 s42, s42, s34
    s_and_b32 s42, s42, 255
    s_lshl_b32 s42, s42, 9
    s_add_u32 s42, s42, 524288
    v_mov_b32 v3, 158736
    ds_write2_b32 v3, v7, v7 offset0:0 offset1:1
    ds_write2_b32 v3, v7, v7 offset0:2 offset1:3
    ds_write2_b32 v3, v7, v7 offset0:4 offset1:5
    ds_write2_b32 v3, v7, v7 offset0:6 offset1:7
    ds_write2_b32 v3, v7, v7 offset0:8 offset1:9
    ds_write2_b32 v3, v7, v7 offset0:10 offset1:11
    s_lshr_b32 s31, s28, 1
    s_lshl_b32 s31, s31, 5
    s_lshr_b32 s3, s29, 3
    s_mul_i32 s3, s3, 11
    s_add_u32 s31, s31, s3
    s_sub_u32 s31, s31, 11
    s_and_b32 s32, s28, 1
    s_lshl_b32 s32, s32, 3
    s_and_b32 s3, s29, 7
    s_lshl_b32 s3, s3, 2
    s_lshr_b32 s3, 0x64317520, s3
    s_and_b32 s3, s3, 7
    s_add_u32 s32, s32, s3
    s_and_b32 s35, s29, 3
    s_and_b32 s3, s29, 4
    s_lshl_b32 s3, s3, 1
    s_add_u32 s35, s35, s3
    s_and_b32 s3, s28, 1
    s_lshl_b32 s3, s3, 2
    s_add_u32 s35, s35, s3
    s_or_b32 s56, s31, s54
    v_mov_b32 v37, 0xf149f2ca
    v_lshlrev_b32 v2, 2, v9
    v_sub_u32 v2, v8, v2
    s_cmp_eq_u32 s56, 0
    s_cselect_b32 s3, 0xf149f2ca, 0
    v_subrev_u32 v3, 0, v2
    v_and_b32 v4, 0x80000001, v3
    v_cmp_eq_u32 vcc, 0, v4
    s_nop 1
    v_cndmask_b32 v16, v37, 0, vcc
    v_cmp_eq_u32 vcc, 0x80000000, v4
    s_nop 1
    v_cndmask_b32 v12, v37, 0, vcc
    v_add_f32 v20, s3, v12
    v_subrev_u32 v3, 1, v2
    v_and_b32 v4, 0x80000001, v3
    v_cmp_eq_u32 vcc, 0, v4
    s_nop 1
    v_cndmask_b32 v17, v37, 0, vcc
    v_cmp_eq_u32 vcc, 0x80000000, v4
    s_nop 1
    v_cndmask_b32 v13, v37, 0, vcc
    v_add_f32 v21, s3, v13
    v_subrev_u32 v3, 2, v2
    v_and_b32 v4, 0x80000001, v3
    v_cmp_eq_u32 vcc, 0, v4
    s_nop 1
    v_cndmask_b32 v18, v37, 0, vcc
    v_cmp_eq_u32 vcc, 0x80000000, v4
    s_nop 1
    v_cndmask_b32 v14, v37, 0, vcc
    v_add_f32 v22, s3, v14
    v_subrev_u32 v3, 3, v2
    v_and_b32 v4, 0x80000001, v3
    v_cmp_eq_u32 vcc, 0, v4
    s_nop 1
    v_cndmask_b32 v19, v37, 0, vcc
    v_cmp_eq_u32 vcc, 0x80000000, v4
    s_nop 1
    v_cndmask_b32 v15, v37, 0, vcc
    v_add_f32 v23, s3, v15
    v_mov_b32 v3, 0x0c0c0c0c
    v_mov_b32 v4, 0xc0c0100
    v_cmp_eq_u32 vcc, 0, v12
    v_mov_b32 v5, 0x1000c0c
    s_nop 0
    v_cndmask_b32 v3, v3, v4, vcc
    v_cmp_eq_u32 vcc, 0, v13
    s_nop 1
    v_cndmask_b32 v24, v3, v5, vcc
    v_mov_b32 v3, 0x0c0c0c0c
    v_mov_b32 v4, 0xc0c0302
    v_cmp_eq_u32 vcc, 0, v14
    v_mov_b32 v5, 0x3020c0c
    s_nop 0
    v_cndmask_b32 v3, v3, v4, vcc
    v_cmp_eq_u32 vcc, 0, v15
    s_nop 1
    v_cndmask_b32 v25, v3, v5, vcc
    v_mov_b32 v3, 0x0c0c0c0c
    v_mov_b32 v4, 0xc0c0100
    v_cmp_eq_u32 vcc, 0, v16
    v_mov_b32 v5, 0x1000c0c
    s_nop 0
    v_cndmask_b32 v3, v3, v4, vcc
    v_cmp_eq_u32 vcc, 0, v17
    s_nop 1
    v_cndmask_b32 v26, v3, v5, vcc
    v_mov_b32 v3, 0x0c0c0c0c
    v_mov_b32 v4, 0xc0c0302
    v_cmp_eq_u32 vcc, 0, v18
    v_mov_b32 v5, 0x3020c0c
    s_nop 0
    v_cndmask_b32 v3, v3, v4, vcc
    v_cmp_eq_u32 vcc, 0, v19
    s_nop 1
    v_cndmask_b32 v27, v3, v5, vcc
    s_mul_i32 s3, s55, 1664
    s_mul_i32 s33, s54, 768
    s_add_u32 s3, s3, s33
    s_add_u32 s3, s3, 125952
    v_lshl_add_u32 v2, v9, 2, v10
    v_lshl_add_u32 v33, v2, 3, s3
    v_lshl_add_u32 v2, v8, 3, s3
    v_lshlrev_b32 v3, 3, v1
    v_add_u32 v3, 129280, v3
    v_cmp_eq_u32 vcc, 2, v9
    s_mul_i32 s3, s55, 1536
    s_add_u32 s3, s3, 122880
    v_cndmask_b32 v32, v3, v2, vcc
    v_lshl_add_u32 v34, v1, 3, s3
    s_mul_i32 s3, s54, 1536
    s_add_u32 s3, s3, 131328
    s_lshl3_add_u32 s33, s55, s3
    v_lshl_add_u32 v35, v8, 4, s33
    v_cmp_eq_u32 vcc, 0, v9
    s_nop 1
    v_cndmask_b32 v35, v3, v35, vcc
    s_mul_i32 s33, s55, 768
    s_add_u32 s3, s3, s33
    v_lshl_add_u32 v36, v1, 4, s3
    v_mov_b32 v38, 158720
    s_waitcnt lgkmcnt(0)
    s_add_u32 s20, s6, 0x100000
    s_addc_u32 s21, s7, 0
    s_mov_b32 s22, 0x280000
    s_mov_b32 s23, 0x20000
    s_lshr_b32 s53, s35, 2
    s_add_u32 s58, s53, s35
    s_lshl_b32 s58, s58, 12
    s_mul_i32 s59, s53, 19456
    s_lshl_b32 s53, s35, 8
    s_add_u32 s59, s59, s53
    s_add_u32 s59, s59, 16384
    s_lshr_b32 s53, s31, 5
    s_add_u32 s53, s53, 1
    s_mul_i32 s22, s53, 655360
    s_mov_b32 s53, s31
    s_mul_i32 s3, s54, 6
    s_add_u32 s53, s53, s3
    s_add_u32 s53, s53, 3
    s_lshl_b32 s3, s55, 9
    s_add_u32 s58, s58, s3
    v_and_b32 v4, 1, v9
    v_lshrrev_b32 v5, 1, v9
    v_add_u32 v3, s53, v4
    v_lshrrev_b32 v2, 2, v3
    v_mul_u32_u24 v2, 76, v2
    v_add_lshl_u32 v2, v2, v3, 10
    v_lshl_add_u32 v2, v8, 4, v2
    v_add_u32 v30, s58, v2
    v_lshl_add_u32 v30, v5, 8, v30
    v_subrev_u32 v3, 2, v3
    v_lshrrev_b32 v2, 2, v3
    v_mul_u32_u24 v2, 76, v2
    v_add_lshl_u32 v2, v2, v3, 10
    v_lshl_add_u32 v2, v8, 4, v2
    v_add_u32 v29, s58, v2
    v_lshl_add_u32 v29, v5, 8, v29
    v_or_b32 v4, s54, v4
    v_cmp_eq_u32 vcc, 0, v4
    v_mov_b32 v5, 0x10000000
    v_subrev_u32 v28, 81920, v30
    v_cndmask_b32 v28, v28, v5, vcc
    s_mul_i32 s3, s55, 3
    s_add_u32 s53, s53, s3
    v_add_u32 v3, s53, v9
    v_lshrrev_b32 v2, 2, v3
    v_mul_u32_u24 v2, 76, v2
    v_add_lshl_u32 v2, v2, v3, 10
    v_lshl_add_u32 v2, v8, 4, v2
    v_add_u32 v31, s59, v2
    v_subrev_u32 v31, 81920, v31
    v_or_b32 v4, s30, v9
    v_cmp_eq_u32 vcc, 0, v4
    s_nop 1
    v_cndmask_b32 v31, v31, v5, vcc
    v_cmp_eq_u32 vcc, 3, v9
    s_nop 1
    v_cndmask_b32 v31, v31, v5, vcc
    s_lshr_b32 s3, s31, 3
    s_mul_i32 s3, s3, 5120
    s_add_u32 s3, s3, 524288
    s_and_b32 s33, s31, 31
    s_cselect_b32 s33, 4, 0
    v_mov_b32 v2, s33
    v_cmp_gt_u32 vcc, 10, v1
    v_lshl_add_u32 v37, v1, 9, s3
    s_mov_b32 s37, 0xfffff
    v_cndmask_b32 v2, 0, v2, vcc
    v_add_u32 v37, v37, v2
    s_lshr_b32 s36, s35, 2
    s_add_u32 s36, s36, s35
    s_lshl_b32 s36, 1, s36
    s_cmp_eq_u32 s30, 0
    s_cselect_b32 s36, s36, 0
    s_mov_b32 s58, 0x3fb8aa3b
    s_mov_b32 s59, s58
    s_mov_b32 s60, 0x3e64f92e
    s_mov_b32 s61, s60
    s_cmp_eq_u32 s30, 0
    s_cbranch_scc1 K_CHM0
    s_cmp_eq_u32 s30, 1
    s_cbranch_scc1 K_CHM1
    s_cmp_eq_u32 s30, 2
    s_cbranch_scc1 K_CHM2
    s_branch K_CHM3
K_WRET_M:
    s_setprio 2
    s_barrier
K_L0:
    ds_read_b64_tr_b16 v[196:197], v47 offset:0
    ds_read_b64_tr_b16 v[198:199], v47 offset:1024
    ds_read_b128 v[148:151], v41 offset:0
    ds_read_b64_tr_b16 v[200:201], v48 offset:0
    ds_read_b64_tr_b16 v[202:203], v48 offset:1024
    ds_read_b128 v[152:155], v41 offset:2048
    ds_read_b64_tr_b16 v[204:205], v49 offset:0
    ds_read_b64_tr_b16 v[206:207], v49 offset:1024
    ds_read_b128 v[156:159], v41 offset:4096
    ds_read_b64_tr_b16 v[208:209], v50 offset:0
    ds_read_b64_tr_b16 v[210:211], v50 offset:1024
    ds_read_b128 v[160:163], v41 offset:6144
    ds_read_b128 v[164:167], v41 offset:8192
    ds_read_b128 v[168:171], v41 offset:10240
    s_waitcnt lgkmcnt(0)
    v_mfma_f32_16x16x32_bf16 v[52:55], v[196:199], v[148:151], 0
    ds_read_b64_tr_b16 v[212:213], v47 offset:8192
    v_mfma_f32_16x16x32_bf16 v[56:59], v[200:203], v[148:151], 0
    ds_read_b64_tr_b16 v[214:215], v47 offset:9216
    v_mfma_f32_16x16x32_bf16 v[60:63], v[148:151], v[204:207], 0
    ds_read_b128 v[172:175], v42 offset:0
    v_mfma_f32_16x16x32_bf16 v[64:67], v[208:211], v[148:151], 0
    ds_read_b64_tr_b16 v[216:217], v48 offset:8192
    v_mfma_f32_16x16x32_bf16 v[80:83], v[208:211], v[152:155], 0
    ds_read_b64_tr_b16 v[218:219], v48 offset:9216
    v_mfma_f32_16x16x32_bf16 v[76:79], v[152:155], v[204:207], 0
    ds_read_b128 v[176:179], v42 offset:2048
    v_mfma_f32_16x16x32_bf16 v[72:75], v[200:203], v[152:155], 0
    ds_read_b64_tr_b16 v[220:221], v49 offset:8192
    v_mfma_f32_16x16x32_bf16 v[68:71], v[196:199], v[152:155], 0
    ds_read_b64_tr_b16 v[222:223], v49 offset:9216
    v_mfma_f32_16x16x32_bf16 v[84:87], v[196:199], v[156:159], 0
    ds_read_b128 v[180:183], v42 offset:4096
    v_mfma_f32_16x16x32_bf16 v[88:91], v[200:203], v[156:159], 0
    ds_read_b64_tr_b16 v[224:225], v50 offset:8192
    v_mfma_f32_16x16x32_bf16 v[92:95], v[156:159], v[204:207], 0
    ds_read_b64_tr_b16 v[226:227], v50 offset:9216
    v_mfma_f32_16x16x32_bf16 v[96:99], v[208:211], v[156:159], 0
    ds_read_b128 v[184:187], v42 offset:6144
    v_mfma_f32_16x16x32_bf16 v[112:115], v[208:211], v[160:163], 0
    ds_read_b128 v[188:191], v42 offset:8192
    v_mfma_f32_16x16x32_bf16 v[108:111], v[160:163], v[204:207], 0
    ds_read_b128 v[192:195], v42 offset:10240
    v_mfma_f32_16x16x32_bf16 v[104:107], v[200:203], v[160:163], 0
    v_mfma_f32_16x16x32_bf16 v[100:103], v[196:199], v[160:163], 0
    v_mfma_f32_16x16x32_bf16 v[116:119], v[196:199], v[164:167], 0
    v_mfma_f32_16x16x32_bf16 v[120:123], v[200:203], v[164:167], 0
    v_mfma_f32_16x16x32_bf16 v[124:127], v[164:167], v[204:207], 0
    v_mfma_f32_16x16x32_bf16 v[128:131], v[208:211], v[164:167], 0
    v_mfma_f32_16x16x32_bf16 v[144:147], v[208:211], v[168:171], 0
    v_mfma_f32_16x16x32_bf16 v[140:143], v[168:171], v[204:207], 0
    v_mfma_f32_16x16x32_bf16 v[136:139], v[200:203], v[168:171], 0
    v_mfma_f32_16x16x32_bf16 v[132:135], v[196:199], v[168:171], 0
    s_waitcnt lgkmcnt(0)
    s_barrier
    v_mfma_f32_16x16x32_bf16 v[52:55], v[212:215], v[172:175], v[52:55]
    ds_read_b64_tr_b16 v[196:197], v43 offset:0
    v_mfma_f32_16x16x32_bf16 v[56:59], v[216:219], v[172:175], v[56:59]
    ds_read_b64_tr_b16 v[198:199], v43 offset:1024
    v_mfma_f32_16x16x32_bf16 v[60:63], v[172:175], v[220:223], v[60:63]
    ds_read_b128 v[148:151], v39 offset:0
    v_mfma_f32_16x16x32_bf16 v[64:67], v[224:227], v[172:175], v[64:67]
    ds_read_b64_tr_b16 v[200:201], v44 offset:0
    v_mfma_f32_16x16x32_bf16 v[80:83], v[224:227], v[176:179], v[80:83]
    ds_read_b64_tr_b16 v[202:203], v44 offset:1024
    v_mfma_f32_16x16x32_bf16 v[76:79], v[176:179], v[220:223], v[76:79]
    ds_read_b128 v[152:155], v39 offset:2048
    v_mfma_f32_16x16x32_bf16 v[72:75], v[216:219], v[176:179], v[72:75]
    ds_read_b64_tr_b16 v[204:205], v45 offset:0
    v_mfma_f32_16x16x32_bf16 v[68:71], v[212:215], v[176:179], v[68:71]
    ds_read_b64_tr_b16 v[206:207], v45 offset:1024
    v_mfma_f32_16x16x32_bf16 v[84:87], v[212:215], v[180:183], v[84:87]
    ds_read_b128 v[156:159], v39 offset:4096
    v_mfma_f32_16x16x32_bf16 v[88:91], v[216:219], v[180:183], v[88:91]
    ds_read_b64_tr_b16 v[208:209], v46 offset:0
    v_mfma_f32_16x16x32_bf16 v[92:95], v[180:183], v[220:223], v[92:95]
    ds_read_b64_tr_b16 v[210:211], v46 offset:1024
    v_mfma_f32_16x16x32_bf16 v[96:99], v[224:227], v[180:183], v[96:99]
    ds_read_b128 v[160:163], v39 offset:6144
    v_mfma_f32_16x16x32_bf16 v[112:115], v[224:227], v[184:187], v[112:115]
    ds_read_b128 v[164:167], v39 offset:8192
    v_mfma_f32_16x16x32_bf16 v[108:111], v[184:187], v[220:223], v[108:111]
    ds_read_b128 v[168:171], v39 offset:10240
    v_mfma_f32_16x16x32_bf16 v[104:107], v[216:219], v[184:187], v[104:107]
    v_mfma_f32_16x16x32_bf16 v[100:103], v[212:215], v[184:187], v[100:103]
    v_mfma_f32_16x16x32_bf16 v[116:119], v[212:215], v[188:191], v[116:119]
    v_mfma_f32_16x16x32_bf16 v[120:123], v[216:219], v[188:191], v[120:123]
    v_mfma_f32_16x16x32_bf16 v[124:127], v[188:191], v[220:223], v[124:127]
    v_mfma_f32_16x16x32_bf16 v[128:131], v[224:227], v[188:191], v[128:131]
    v_mfma_f32_16x16x32_bf16 v[144:147], v[224:227], v[192:195], v[144:147]
    v_mfma_f32_16x16x32_bf16 v[140:143], v[192:195], v[220:223], v[140:143]
    v_mfma_f32_16x16x32_bf16 v[136:139], v[216:219], v[192:195], v[136:139]
    v_mfma_f32_16x16x32_bf16 v[132:135], v[212:215], v[192:195], v[132:135]
    s_waitcnt lgkmcnt(0)
    v_mfma_f32_16x16x32_bf16 v[52:55], v[196:199], v[148:151], v[52:55]
    ds_read_b64_tr_b16 v[212:213], v43 offset:8192
    v_mfma_f32_16x16x32_bf16 v[56:59], v[200:203], v[148:151], v[56:59]
    ds_read_b64_tr_b16 v[214:215], v43 offset:9216
    v_mfma_f32_16x16x32_bf16 v[60:63], v[148:151], v[204:207], v[60:63]
    ds_read_b128 v[172:175], v40 offset:0
    v_mfma_f32_16x16x32_bf16 v[64:67], v[208:211], v[148:151], v[64:67]
    ds_read_b64_tr_b16 v[216:217], v44 offset:8192
    v_mfma_f32_16x16x32_bf16 v[80:83], v[208:211], v[152:155], v[80:83]
    ds_read_b64_tr_b16 v[218:219], v44 offset:9216
    v_mfma_f32_16x16x32_bf16 v[76:79], v[152:155], v[204:207], v[76:79]
    ds_read_b128 v[176:179], v40 offset:2048
    v_mfma_f32_16x16x32_bf16 v[72:75], v[200:203], v[152:155], v[72:75]
    ds_read_b64_tr_b16 v[220:221], v45 offset:8192
    v_mfma_f32_16x16x32_bf16 v[68:71], v[196:199], v[152:155], v[68:71]
    ds_read_b64_tr_b16 v[222:223], v45 offset:9216
    v_mfma_f32_16x16x32_bf16 v[84:87], v[196:199], v[156:159], v[84:87]
    ds_read_b128 v[180:183], v40 offset:4096
    v_mfma_f32_16x16x32_bf16 v[88:91], v[200:203], v[156:159], v[88:91]
    ds_read_b64_tr_b16 v[224:225], v46 offset:8192
    v_mfma_f32_16x16x32_bf16 v[92:95], v[156:159], v[204:207], v[92:95]
    ds_read_b64_tr_b16 v[226:227], v46 offset:9216
    v_mfma_f32_16x16x32_bf16 v[96:99], v[208:211], v[156:159], v[96:99]
    ds_read_b128 v[184:187], v40 offset:6144
    v_mfma_f32_16x16x32_bf16 v[112:115], v[208:211], v[160:163], v[112:115]
    ds_read_b128 v[188:191], v40 offset:8192
    v_mfma_f32_16x16x32_bf16 v[108:111], v[160:163], v[204:207], v[108:111]
    ds_read_b128 v[192:195], v40 offset:10240
    s_branch K_PG1
.p2align 12
K_CHM1:
K_STM1:
    s_branch K_WRET_M
    s_nop 0
K_PG1:
    v_mfma_f32_16x16x32_bf16 v[104:107], v[200:203], v[160:163], v[104:107]
    v_mfma_f32_16x16x32_bf16 v[100:103], v[196:199], v[160:163], v[100:103]
    v_mfma_f32_16x16x32_bf16 v[116:119], v[196:199], v[164:167], v[116:119]
    v_mfma_f32_16x16x32_bf16 v[120:123], v[200:203], v[164:167], v[120:123]
    v_mfma_f32_16x16x32_bf16 v[124:127], v[164:167], v[204:207], v[124:127]
    v_mfma_f32_16x16x32_bf16 v[128:131], v[208:211], v[164:167], v[128:131]
    v_mfma_f32_16x16x32_bf16 v[144:147], v[208:211], v[168:171], v[144:147]
    v_mfma_f32_16x16x32_bf16 v[140:143], v[168:171], v[204:207], v[140:143]
    v_mfma_f32_16x16x32_bf16 v[136:139], v[200:203], v[168:171], v[136:139]
    v_mfma_f32_16x16x32_bf16 v[132:135], v[196:199], v[168:171], v[132:135]
    s_waitcnt lgkmcnt(0)
    s_barrier
    v_mfma_f32_16x16x32_bf16 v[52:55], v[212:215], v[172:175], v[52:55]
    ds_read_b64_tr_b16 v[196:197], v43 offset:40960
    v_mfma_f32_16x16x32_bf16 v[56:59], v[216:219], v[172:175], v[56:59]
    ds_read_b64_tr_b16 v[198:199], v43 offset:41984
    v_mfma_f32_16x16x32_bf16 v[60:63], v[172:175], v[220:223], v[60:63]
    ds_read_b128 v[148:151], v39 offset:40960
    v_mfma_f32_16x16x32_bf16 v[64:67], v[224:227], v[172:175], v[64:67]
    ds_read_b64_tr_b16 v[200:201], v44 offset:40960
    v_mfma_f32_16x16x32_bf16 v[80:83], v[224:227], v[176:179], v[80:83]
    ds_read_b64_tr_b16 v[202:203], v44 offset:41984
    v_mfma_f32_16x16x32_bf16 v[76:79], v[176:179], v[220:223], v[76:79]
    ds_read_b128 v[152:155], v39 offset:43008
    v_mfma_f32_16x16x32_bf16 v[72:75], v[216:219], v[176:179], v[72:75]
    ds_read_b64_tr_b16 v[204:205], v45 offset:40960
    v_mfma_f32_16x16x32_bf16 v[68:71], v[212:215], v[176:179], v[68:71]
    ds_read_b64_tr_b16 v[206:207], v45 offset:41984
    v_mfma_f32_16x16x32_bf16 v[84:87], v[212:215], v[180:183], v[84:87]
    ds_read_b128 v[156:159], v39 offset:45056
    v_mfma_f32_16x16x32_bf16 v[88:91], v[216:219], v[180:183], v[88:91]
    ds_read_b64_tr_b16 v[208:209], v46 offset:40960
    v_mfma_f32_16x16x32_bf16 v[92:95], v[180:183], v[220:223], v[92:95]
    ds_read_b64_tr_b16 v[210:211], v46 offset:41984
    v_mfma_f32_16x16x32_bf16 v[96:99], v[224:227], v[180:183], v[96:99]
    ds_read_b128 v[160:163], v39 offset:47104
    v_mfma_f32_16x16x32_bf16 v[112:115], v[224:227], v[184:187], v[112:115]
    ds_read_b128 v[164:167], v39 offset:49152
    v_mfma_f32_16x16x32_bf16 v[108:111], v[184:187], v[220:223], v[108:111]
    ds_read_b128 v[168:171], v39 offset:51200
    v_mfma_f32_16x16x32_bf16 v[104:107], v[216:219], v[184:187], v[104:107]
    v_mfma_f32_16x16x32_bf16 v[100:103], v[212:215], v[184:187], v[100:103]
    v_mfma_f32_16x16x32_bf16 v[116:119], v[212:215], v[188:191], v[116:119]
    v_mfma_f32_16x16x32_bf16 v[120:123], v[216:219], v[188:191], v[120:123]
    v_mfma_f32_16x16x32_bf16 v[124:127], v[188:191], v[220:223], v[124:127]
    v_mfma_f32_16x16x32_bf16 v[128:131], v[224:227], v[188:191], v[128:131]
    v_mfma_f32_16x16x32_bf16 v[144:147], v[224:227], v[192:195], v[144:147]
    v_mfma_f32_16x16x32_bf16 v[140:143], v[192:195], v[220:223], v[140:143]
    v_mfma_f32_16x16x32_bf16 v[136:139], v[216:219], v[192:195], v[136:139]
    v_mfma_f32_16x16x32_bf16 v[132:135], v[212:215], v[192:195], v[132:135]
    s_waitcnt lgkmcnt(0)
    v_mfma_f32_16x16x32_bf16 v[52:55], v[196:199], v[148:151], v[52:55]
    ds_read_b64_tr_b16 v[212:213], v43 offset:49152
    v_mfma_f32_16x16x32_bf16 v[56:59], v[200:203], v[148:151], v[56:59]
    ds_read_b64_tr_b16 v[214:215], v43 offset:50176
    v_mfma_f32_16x16x32_bf16 v[60:63], v[148:151], v[204:207], v[60:63]
    ds_read_b128 v[172:175], v40 offset:40960
    v_mfma_f32_16x16x32_bf16 v[64:67], v[208:211], v[148:151], v[64:67]
    ds_read_b64_tr_b16 v[216:217], v44 offset:49152
    v_mfma_f32_16x16x32_bf16 v[80:83], v[208:211], v[152:155], v[80:83]
    ds_read_b64_tr_b16 v[218:219], v44 offset:50176
    v_mfma_f32_16x16x32_bf16 v[76:79], v[152:155], v[204:207], v[76:79]
    ds_read_b128 v[176:179], v40 offset:43008
    v_mfma_f32_16x16x32_bf16 v[72:75], v[200:203], v[152:155], v[72:75]
    ds_read_b64_tr_b16 v[220:221], v45 offset:49152
    v_mfma_f32_16x16x32_bf16 v[68:71], v[196:199], v[152:155], v[68:71]
    ds_read_b64_tr_b16 v[222:223], v45 offset:50176
    v_mfma_f32_16x16x32_bf16 v[84:87], v[196:199], v[156:159], v[84:87]
    ds_read_b128 v[180:183], v40 offset:45056
    v_mfma_f32_16x16x32_bf16 v[88:91], v[200:203], v[156:159], v[88:91]
    ds_read_b64_tr_b16 v[224:225], v46 offset:49152
    v_mfma_f32_16x16x32_bf16 v[92:95], v[156:159], v[204:207], v[92:95]
    ds_read_b64_tr_b16 v[226:227], v46 offset:50176
    v_mfma_f32_16x16x32_bf16 v[96:99], v[208:211], v[156:159], v[96:99]
    ds_read_b128 v[184:187], v40 offset:47104
    v_mfma_f32_16x16x32_bf16 v[112:115], v[208:211], v[160:163], v[112:115]
    ds_read_b128 v[188:191], v40 offset:49152
    v_mfma_f32_16x16x32_bf16 v[108:111], v[160:163], v[204:207], v[108:111]
    ds_read_b128 v[192:195], v40 offset:51200
    v_mfma_f32_16x16x32_bf16 v[104:107], v[200:203], v[160:163], v[104:107]
    v_mfma_f32_16x16x32_bf16 v[100:103], v[196:199], v[160:163], v[100:103]
    v_mfma_f32_16x16x32_bf16 v[116:119], v[196:199], v[164:167], v[116:119]
    v_mfma_f32_16x16x32_bf16 v[120:123], v[200:203], v[164:167], v[120:123]
    v_mfma_f32_16x16x32_bf16 v[124:127], v[164:167], v[204:207], v[124:127]
    v_mfma_f32_16x16x32_bf16 v[128:131], v[208:211], v[164:167], v[128:131]
    v_mfma_f32_16x16x32_bf16 v[144:147], v[208:211], v[168:171], v[144:147]
    v_mfma_f32_16x16x32_bf16 v[140:143], v[168:171], v[204:207], v[140:143]
    v_mfma_f32_16x16x32_bf16 v[136:139], v[200:203], v[168:171], v[136:139]
    v_mfma_f32_16x16x32_bf16 v[132:135], v[196:199], v[168:171], v[132:135]
    s_waitcnt lgkmcnt(0)
    s_barrier
    v_mfma_f32_16x16x32_bf16 v[52:55], v[212:215], v[172:175], v[52:55]
    ds_read_b64_tr_b16 v[196:197], v47 offset:0
    v_mfma_f32_16x16x32_bf16 v[56:59], v[216:219], v[172:175], v[56:59]
    ds_read_b64_tr_b16 v[198:199], v47 offset:1024
    v_mfma_f32_16x16x32_bf16 v[60:63], v[172:175], v[220:223], v[60:63]
    ds_read_b128 v[148:151], v41 offset:0
    v_mfma_f32_16x16x32_bf16 v[64:67], v[224:227], v[172:175], v[64:67]
    ds_read_b64_tr_b16 v[200:201], v48 offset:0
    v_mfma_f32_16x16x32_bf16 v[80:83], v[224:227], v[176:179], v[80:83]
    ds_read_b64_tr_b16 v[202:203], v48 offset:1024
    v_mfma_f32_16x16x32_bf16 v[76:79], v[176:179], v[220:223], v[76:79]
    ds_read_b128 v[152:155], v41 offset:2048
    v_mfma_f32_16x16x32_bf16 v[72:75], v[216:219], v[176:179], v[72:75]
    ds_read_b64_tr_b16 v[204:205], v49 offset:0
    v_mfma_f32_16x16x32_bf16 v[68:71], v[212:215], v[176:179], v[68:71]
    ds_read_b64_tr_b16 v[206:207], v49 offset:1024
    v_mfma_f32_16x16x32_bf16 v[84:87], v[212:215], v[180:183], v[84:87]
    ds_read_b128 v[156:159], v41 offset:4096
    v_mfma_f32_16x16x32_bf16 v[88:91], v[216:219], v[180:183], v[88:91]
    ds_read_b64_tr_b16 v[208:209], v50 offset:0
    v_mfma_f32_16x16x32_bf16 v[92:95], v[180:183], v[220:223], v[92:95]
    ds_read_b64_tr_b16 v[210:211], v50 offset:1024
    v_mfma_f32_16x16x32_bf16 v[96:99], v[224:227], v[180:183], v[96:99]
    ds_read_b128 v[160:163], v41 offset:6144
    v_mfma_f32_16x16x32_bf16 v[112:115], v[224:227], v[184:187], v[112:115]
    ds_read_b128 v[164:167], v41 offset:8192
    v_mfma_f32_16x16x32_bf16 v[108:111], v[184:187], v[220:223], v[108:111]
    ds_read_b128 v[168:171], v41 offset:10240
    v_mfma_f32_16x16x32_bf16 v[104:107], v[216:219], v[184:187], v[104:107]
    v_mfma_f32_16x16x32_bf16 v[100:103], v[212:215], v[184:187], v[100:103]
    v_mfma_f32_16x16x32_bf16 v[116:119], v[212:215], v[188:191], v[116:119]
    v_mfma_f32_16x16x32_bf16 v[120:123], v[216:219], v[188:191], v[120:123]
    v_mfma_f32_16x16x32_bf16 v[124:127], v[188:191], v[220:223], v[124:127]
    v_mfma_f32_16x16x32_bf16 v[128:131], v[224:227], v[188:191], v[128:131]
    v_mfma_f32_16x16x32_bf16 v[144:147], v[224:227], v[192:195], v[144:147]
    v_mfma_f32_16x16x32_bf16 v[140:143], v[192:195], v[220:223], v[140:143]
    v_mfma_f32_16x16x32_bf16 v[136:139], v[216:219], v[192:195], v[136:139]
    v_mfma_f32_16x16x32_bf16 v[132:135], v[212:215], v[192:195], v[132:135]
    s_waitcnt lgkmcnt(0)
    v_mfma_f32_16x16x32_bf16 v[52:55], v[196:199], v[148:151], v[52:55]
    ds_read_b64_tr_b16 v[212:213], v47 offset:8192
    v_mfma_f32_16x16x32_bf16 v[56:59], v[200:203], v[148:151], v[56:59]
    ds_read_b64_tr_b16 v[214:215], v47 offset:9216
    v_mfma_f32_16x16x32_bf16 v[60:63], v[148:151], v[204:207], v[60:63]
    ds_read_b128 v[172:175], v42 offset:0
    v_mfma_f32_16x16x32_bf16 v[64:67], v[208:211], v[148:151], v[64:67]
    ds_read_b64_tr_b16 v[216:217], v48 offset:8192
    v_mfma_f32_16x16x32_bf16 v[80:83], v[208:211], v[152:155], v[80:83]
    ds_read_b64_tr_b16 v[218:219], v48 offset:9216
    v_mfma_f32_16x16x32_bf16 v[76:79], v[152:155], v[204:207], v[76:79]
    ds_read_b128 v[176:179], v42 offset:2048
    v_mfma_f32_16x16x32_bf16 v[72:75], v[200:203], v[152:155], v[72:75]
    ds_read_b64_tr_b16 v[220:221], v49 offset:8192
    v_mfma_f32_16x16x32_bf16 v[68:71], v[196:199], v[152:155], v[68:71]
    ds_read_b64_tr_b16 v[222:223], v49 offset:9216
    v_mfma_f32_16x16x32_bf16 v[84:87], v[196:199], v[156:159], v[84:87]
    ds_read_b128 v[180:183], v42 offset:4096
    v_mfma_f32_16x16x32_bf16 v[88:91], v[200:203], v[156:159], v[88:91]
    ds_read_b64_tr_b16 v[224:225], v50 offset:8192
    v_mfma_f32_16x16x32_bf16 v[92:95], v[156:159], v[204:207], v[92:95]
    ds_read_b64_tr_b16 v[226:227], v50 offset:9216
    v_mfma_f32_16x16x32_bf16 v[96:99], v[208:211], v[156:159], v[96:99]
    ds_read_b128 v[184:187], v42 offset:6144
    v_mfma_f32_16x16x32_bf16 v[112:115], v[208:211], v[160:163], v[112:115]
    ds_read_b128 v[188:191], v42 offset:8192
    v_mfma_f32_16x16x32_bf16 v[108:111], v[160:163], v[204:207], v[108:111]
    ds_read_b128 v[192:195], v42 offset:10240
    v_mfma_f32_16x16x32_bf16 v[104:107], v[200:203], v[160:163], v[104:107]
    v_mfma_f32_16x16x32_bf16 v[100:103], v[196:199], v[160:163], v[100:103]
    v_mfma_f32_16x16x32_bf16 v[116:119], v[196:199], v[164:167], v[116:119]
    v_mfma_f32_16x16x32_bf16 v[120:123], v[200:203], v[164:167], v[120:123]
    v_mfma_f32_16x16x32_bf16 v[124:127], v[164:167], v[204:207], v[124:127]
    v_mfma_f32_16x16x32_bf16 v[128:131], v[208:211], v[164:167], v[128:131]
    v_mfma_f32_16x16x32_bf16 v[144:147], v[208:211], v[168:171], v[144:147]
    v_mfma_f32_16x16x32_bf16 v[140:143], v[168:171], v[204:207], v[140:143]
    v_mfma_f32_16x16x32_bf16 v[136:139], v[200:203], v[168:171], v[136:139]
    v_mfma_f32_16x16x32_bf16 v[132:135], v[196:199], v[168:171], v[132:135]
    s_waitcnt lgkmcnt(0)
    s_barrier
    v_mfma_f32_16x16x32_bf16 v[52:55], v[212:215], v[172:175], v[52:55]
    ds_read_b64_tr_b16 v[196:197], v43 offset:0
    v_mfma_f32_16x16x32_bf16 v[56:59], v[216:219], v[172:175], v[56:59]
    ds_read_b64_tr_b16 v[198:199], v43 offset:1024
    v_mfma_f32_16x16x32_bf16 v[60:63], v[172:175], v[220:223], v[60:63]
    ds_read_b128 v[148:151], v39 offset:0
    v_mfma_f32_16x16x32_bf16 v[64:67], v[224:227], v[172:175], v[64:67]
    ds_read_b64_tr_b16 v[200:201], v44 offset:0
    v_mfma_f32_16x16x32_bf16 v[80:83], v[224:227], v[176:179], v[80:83]
    ds_read_b64_tr_b16 v[202:203], v44 offset:1024
    v_mfma_f32_16x16x32_bf16 v[76:79], v[176:179], v[220:223], v[76:79]
    ds_read_b128 v[152:155], v39 offset:2048
    v_mfma_f32_16x16x32_bf16 v[72:75], v[216:219], v[176:179], v[72:75]
    ds_read_b64_tr_b16 v[204:205], v45 offset:0
    v_mfma_f32_16x16x32_bf16 v[68:71], v[212:215], v[176:179], v[68:71]
    ds_read_b64_tr_b16 v[206:207], v45 offset:1024
    v_mfma_f32_16x16x32_bf16 v[84:87], v[212:215], v[180:183], v[84:87]
    ds_read_b128 v[156:159], v39 offset:4096
    v_mfma_f32_16x16x32_bf16 v[88:91], v[216:219], v[180:183], v[88:91]
    ds_read_b64_tr_b16 v[208:209], v46 offset:0
    v_mfma_f32_16x16x32_bf16 v[92:95], v[180:183], v[220:223], v[92:95]
    ds_read_b64_tr_b16 v[210:211], v46 offset:1024
    v_mfma_f32_16x16x32_bf16 v[96:99], v[224:227], v[180:183], v[96:99]
    ds_read_b128 v[160:163], v39 offset:6144
    v_mfma_f32_16x16x32_bf16 v[112:115], v[224:227], v[184:187], v[112:115]
    ds_read_b128 v[164:167], v39 offset:8192
    v_mfma_f32_16x16x32_bf16 v[108:111], v[184:187], v[220:223], v[108:111]
    ds_read_b128 v[168:171], v39 offset:10240
    v_mfma_f32_16x16x32_bf16 v[104:107], v[216:219], v[184:187], v[104:107]
    v_mfma_f32_16x16x32_bf16 v[100:103], v[212:215], v[184:187], v[100:103]
    v_mfma_f32_16x16x32_bf16 v[116:119], v[212:215], v[188:191], v[116:119]
    v_mfma_f32_16x16x32_bf16 v[120:123], v[216:219], v[188:191], v[120:123]
    v_mfma_f32_16x16x32_bf16 v[124:127], v[188:191], v[220:223], v[124:127]
    v_mfma_f32_16x16x32_bf16 v[128:131], v[224:227], v[188:191], v[128:131]
    v_mfma_f32_16x16x32_bf16 v[144:147], v[224:227], v[192:195], v[144:147]
    v_mfma_f32_16x16x32_bf16 v[140:143], v[192:195], v[220:223], v[140:143]
    v_mfma_f32_16x16x32_bf16 v[136:139], v[216:219], v[192:195], v[136:139]
    v_mfma_f32_16x16x32_bf16 v[132:135], v[212:215], v[192:195], v[132:135]
    s_waitcnt lgkmcnt(0)
    v_mfma_f32_16x16x32_bf16 v[52:55], v[196:199], v[148:151], v[52:55]
    ds_read_b64_tr_b16 v[212:213], v43 offset:8192
    v_mfma_f32_16x16x32_bf16 v[56:59], v[200:203], v[148:151], v[56:59]
    ds_read_b64_tr_b16 v[214:215], v43 offset:9216
    v_mfma_f32_16x16x32_bf16 v[60:63], v[148:151], v[204:207], v[60:63]
    ds_read_b128 v[172:175], v40 offset:0
    v_mfma_f32_16x16x32_bf16 v[64:67], v[208:211], v[148:151], v[64:67]
    ds_read_b64_tr_b16 v[216:217], v44 offset:8192
    v_mfma_f32_16x16x32_bf16 v[80:83], v[208:211], v[152:155], v[80:83]
    ds_read_b64_tr_b16 v[218:219], v44 offset:9216
    v_mfma_f32_16x16x32_bf16 v[76:79], v[152:155], v[204:207], v[76:79]
    ds_read_b128 v[176:179], v40 offset:2048
    v_mfma_f32_16x16x32_bf16 v[72:75], v[200:203], v[152:155], v[72:75]
    ds_read_b64_tr_b16 v[220:221], v45 offset:8192
    v_mfma_f32_16x16x32_bf16 v[68:71], v[196:199], v[152:155], v[68:71]
    ds_read_b64_tr_b16 v[222:223], v45 offset:9216
    v_mfma_f32_16x16x32_bf16 v[84:87], v[196:199], v[156:159], v[84:87]
    ds_read_b128 v[180:183], v40 offset:4096
    v_mfma_f32_16x16x32_bf16 v[88:91], v[200:203], v[156:159], v[88:91]
    ds_read_b64_tr_b16 v[224:225], v46 offset:8192
    v_mfma_f32_16x16x32_bf16 v[92:95], v[156:159], v[204:207], v[92:95]
    ds_read_b64_tr_b16 v[226:227], v46 offset:9216
    v_mfma_f32_16x16x32_bf16 v[96:99], v[208:211], v[156:159], v[96:99]
    ds_read_b128 v[184:187], v40 offset:6144
    v_mfma_f32_16x16x32_bf16 v[112:115], v[208:211], v[160:163], v[112:115]
    ds_read_b128 v[188:191], v40 offset:8192
    v_mfma_f32_16x16x32_bf16 v[108:111], v[160:163], v[204:207], v[108:111]
    ds_read_b128 v[192:195], v40 offset:10240
    v_mfma_f32_16x16x32_bf16 v[104:107], v[200:203], v[160:163], v[104:107]
    v_mfma_f32_16x16x32_bf16 v[100:103], v[196:199], v[160:163], v[100:103]
    v_mfma_f32_16x16x32_bf16 v[116:119], v[196:199], v[164:167], v[116:119]
    v_mfma_f32_16x16x32_bf16 v[120:123], v[200:203], v[164:167], v[120:123]
    v_mfma_f32_16x16x32_bf16 v[124:127], v[164:167], v[204:207], v[124:127]
    v_mfma_f32_16x16x32_bf16 v[128:131], v[208:211], v[164:167], v[128:131]
    v_mfma_f32_16x16x32_bf16 v[144:147], v[208:211], v[168:171], v[144:147]
    v_mfma_f32_16x16x32_bf16 v[140:143], v[168:171], v[204:207], v[140:143]
    v_mfma_f32_16x16x32_bf16 v[136:139], v[200:203], v[168:171], v[136:139]
    v_mfma_f32_16x16x32_bf16 v[132:135], v[196:199], v[168:171], v[132:135]
    s_waitcnt lgkmcnt(0)
    s_barrier
    v_mfma_f32_16x16x32_bf16 v[52:55], v[212:215], v[172:175], v[52:55]
    ds_read_b64_tr_b16 v[196:197], v43 offset:40960
    v_mfma_f32_16x16x32_bf16 v[56:59], v[216:219], v[172:175], v[56:59]
    ds_read_b64_tr_b16 v[198:199], v43 offset:41984
    v_mfma_f32_16x16x32_bf16 v[60:63], v[172:175], v[220:223], v[60:63]
    ds_read_b128 v[148:151], v39 offset:40960
    v_mfma_f32_16x16x32_bf16 v[64:67], v[224:227], v[172:175], v[64:67]
    ds_read_b64_tr_b16 v[200:201], v44 offset:40960
    v_mfma_f32_16x16x32_bf16 v[80:83], v[224:227], v[176:179], v[80:83]
    ds_read_b64_tr_b16 v[202:203], v44 offset:41984
    v_mfma_f32_16x16x32_bf16 v[76:79], v[176:179], v[220:223], v[76:79]
    ds_read_b128 v[152:155], v39 offset:43008
    v_mfma_f32_16x16x32_bf16 v[72:75], v[216:219], v[176:179], v[72:75]
    ds_read_b64_tr_b16 v[204:205], v45 offset:40960
    v_mfma_f32_16x16x32_bf16 v[68:71], v[212:215], v[176:179], v[68:71]
    ds_read_b64_tr_b16 v[206:207], v45 offset:41984
    v_mfma_f32_16x16x32_bf16 v[84:87], v[212:215], v[180:183], v[84:87]
    ds_read_b128 v[156:159], v39 offset:45056
    v_mfma_f32_16x16x32_bf16 v[88:91], v[216:219], v[180:183], v[88:91]
    ds_read_b64_tr_b16 v[208:209], v46 offset:40960
    v_mfma_f32_16x16x32_bf16 v[92:95], v[180:183], v[220:223], v[92:95]
    ds_read_b64_tr_b16 v[210:211], v46 offset:41984
    v_mfma_f32_16x16x32_bf16 v[96:99], v[224:227], v[180:183], v[96:99]
    ds_read_b128 v[160:163], v39 offset:47104
    v_mfma_f32_16x16x32_bf16 v[112:115], v[224:227], v[184:187], v[112:115]
    ds_read_b128 v[164:167], v39 offset:49152
    v_mfma_f32_16x16x32_bf16 v[108:111], v[184:187], v[220:223], v[108:111]
    ds_read_b128 v[168:171], v39 offset:51200
    v_mfma_f32_16x16x32_bf16 v[104:107], v[216:219], v[184:187], v[104:107]
    v_mfma_f32_16x16x32_bf16 v[100:103], v[212:215], v[184:187], v[100:103]
    v_mfma_f32_16x16x32_bf16 v[116:119], v[212:215], v[188:191], v[116:119]
    v_mfma_f32_16x16x32_bf16 v[120:123], v[216:219], v[188:191], v[120:123]
    v_mfma_f32_16x16x32_bf16 v[124:127], v[188:191], v[220:223], v[124:127]
    v_mfma_f32_16x16x32_bf16 v[128:131], v[224:227], v[188:191], v[128:131]
    v_mfma_f32_16x16x32_bf16 v[144:147], v[224:227], v[192:195], v[144:147]
    v_mfma_f32_16x16x32_bf16 v[140:143], v[192:195], v[220:223], v[140:143]
    v_mfma_f32_16x16x32_bf16 v[136:139], v[216:219], v[192:195], v[136:139]
    v_mfma_f32_16x16x32_bf16 v[132:135], v[212:215], v[192:195], v[132:135]
    s_waitcnt lgkmcnt(0)
    v_mfma_f32_16x16x32_bf16 v[52:55], v[196:199], v[148:151], v[52:55]
    ds_read_b64_tr_b16 v[212:213], v43 offset:49152
    v_mfma_f32_16x16x32_bf16 v[56:59], v[200:203], v[148:151], v[56:59]
    ds_read_b64_tr_b16 v[214:215], v43 offset:50176
    v_mfma_f32_16x16x32_bf16 v[60:63], v[148:151], v[204:207], v[60:63]
    ds_read_b128 v[172:175], v40 offset:40960
    v_mfma_f32_16x16x32_bf16 v[64:67], v[208:211], v[148:151], v[64:67]
    ds_read_b64_tr_b16 v[216:217], v44 offset:49152
    v_mfma_f32_16x16x32_bf16 v[80:83], v[208:211], v[152:155], v[80:83]
    ds_read_b64_tr_b16 v[218:219], v44 offset:50176
    v_mfma_f32_16x16x32_bf16 v[76:79], v[152:155], v[204:207], v[76:79]
    ds_read_b128 v[176:179], v40 offset:43008
    v_mfma_f32_16x16x32_bf16 v[72:75], v[200:203], v[152:155], v[72:75]
    ds_read_b64_tr_b16 v[220:221], v45 offset:49152
    v_mfma_f32_16x16x32_bf16 v[68:71], v[196:199], v[152:155], v[68:71]
    ds_read_b64_tr_b16 v[222:223], v45 offset:50176
    v_mfma_f32_16x16x32_bf16 v[84:87], v[196:199], v[156:159], v[84:87]
    ds_read_b128 v[180:183], v40 offset:45056
    v_mfma_f32_16x16x32_bf16 v[88:91], v[200:203], v[156:159], v[88:91]
    ds_read_b64_tr_b16 v[224:225], v46 offset:49152
    v_mfma_f32_16x16x32_bf16 v[92:95], v[156:159], v[204:207], v[92:95]
    ds_read_b64_tr_b16 v[226:227], v46 offset:50176
    v_mfma_f32_16x16x32_bf16 v[96:99], v[208:211], v[156:159], v[96:99]
    ds_read_b128 v[184:187], v40 offset:47104
    v_mfma_f32_16x16x32_bf16 v[112:115], v[208:211], v[160:163], v[112:115]
    ds_read_b128 v[188:191], v40 offset:49152
    v_mfma_f32_16x16x32_bf16 v[108:111], v[160:163], v[204:207], v[108:111]
    ds_read_b128 v[192:195], v40 offset:51200
    v_mfma_f32_16x16x32_bf16 v[104:107], v[200:203], v[160:163], v[104:107]
    v_mfma_f32_16x16x32_bf16 v[100:103], v[196:199], v[160:163], v[100:103]
    v_mfma_f32_16x16x32_bf16 v[116:119], v[196:199], v[164:167], v[116:119]
    v_mfma_f32_16x16x32_bf16 v[120:123], v[200:203], v[164:167], v[120:123]
    v_mfma_f32_16x16x32_bf16 v[124:127], v[164:167], v[204:207], v[124:127]
    v_mfma_f32_16x16x32_bf16 v[128:131], v[208:211], v[164:167], v[128:131]
    v_mfma_f32_16x16x32_bf16 v[144:147], v[208:211], v[168:171], v[144:147]
    v_mfma_f32_16x16x32_bf16 v[140:143], v[168:171], v[204:207], v[140:143]
    v_mfma_f32_16x16x32_bf16 v[136:139], v[200:203], v[168:171], v[136:139]
    v_mfma_f32_16x16x32_bf16 v[132:135], v[196:199], v[168:171], v[132:135]
    s_waitcnt lgkmcnt(0)
    s_barrier
    v_mfma_f32_16x16x32_bf16 v[52:55], v[212:215], v[172:175], v[52:55]
    ds_read_b64_tr_b16 v[196:197], v47 offset:0
    v_mfma_f32_16x16x32_bf16 v[56:59], v[216:219], v[172:175], v[56:59]
    ds_read_b64_tr_b16 v[198:199], v47 offset:1024
    v_mfma_f32_16x16x32_bf16 v[60:63], v[172:175], v[220:223], v[60:63]
    ds_read_b128 v[148:151], v41 offset:0
    v_mfma_f32_16x16x32_bf16 v[64:67], v[224:227], v[172:175], v[64:67]
    ds_read_b64_tr_b16 v[200:201], v48 offset:0
    v_mfma_f32_16x16x32_bf16 v[80:83], v[224:227], v[176:179], v[80:83]
    ds_read_b64_tr_b16 v[202:203], v48 offset:1024
    v_mfma_f32_16x16x32_bf16 v[76:79], v[176:179], v[220:223], v[76:79]
    ds_read_b128 v[152:155], v41 offset:2048
    v_mfma_f32_16x16x32_bf16 v[72:75], v[216:219], v[176:179], v[72:75]
    ds_read_b64_tr_b16 v[204:205], v49 offset:0
    v_mfma_f32_16x16x32_bf16 v[68:71], v[212:215], v[176:179], v[68:71]
    ds_read_b64_tr_b16 v[206:207], v49 offset:1024
    v_mfma_f32_16x16x32_bf16 v[84:87], v[212:215], v[180:183], v[84:87]
    ds_read_b128 v[156:159], v41 offset:4096
    v_mfma_f32_16x16x32_bf16 v[88:91], v[216:219], v[180:183], v[88:91]
    ds_read_b64_tr_b16 v[208:209], v50 offset:0
    v_mfma_f32_16x16x32_bf16 v[92:95], v[180:183], v[220:223], v[92:95]
    ds_read_b64_tr_b16 v[210:211], v50 offset:1024
    v_mfma_f32_16x16x32_bf16 v[96:99], v[224:227], v[180:183], v[96:99]
    ds_read_b128 v[160:163], v41 offset:6144
    v_mfma_f32_16x16x32_bf16 v[112:115], v[224:227], v[184:187], v[112:115]
    ds_read_b128 v[164:167], v41 offset:8192
    v_mfma_f32_16x16x32_bf16 v[108:111], v[184:187], v[220:223], v[108:111]
    ds_read_b128 v[168:171], v41 offset:10240
    v_mfma_f32_16x16x32_bf16 v[104:107], v[216:219], v[184:187], v[104:107]
    v_mfma_f32_16x16x32_bf16 v[100:103], v[212:215], v[184:187], v[100:103]
    v_mfma_f32_16x16x32_bf16 v[116:119], v[212:215], v[188:191], v[116:119]
    v_mfma_f32_16x16x32_bf16 v[120:123], v[216:219], v[188:191], v[120:123]
    v_mfma_f32_16x16x32_bf16 v[124:127], v[188:191], v[220:223], v[124:127]
    v_mfma_f32_16x16x32_bf16 v[128:131], v[224:227], v[188:191], v[128:131]
    v_mfma_f32_16x16x32_bf16 v[144:147], v[224:227], v[192:195], v[144:147]
    v_mfma_f32_16x16x32_bf16 v[140:143], v[192:195], v[220:223], v[140:143]
    v_mfma_f32_16x16x32_bf16 v[136:139], v[216:219], v[192:195], v[136:139]
    v_mfma_f32_16x16x32_bf16 v[132:135], v[212:215], v[192:195], v[132:135]
    s_waitcnt lgkmcnt(0)
    v_mfma_f32_16x16x32_bf16 v[52:55], v[196:199], v[148:151], v[52:55]
    ds_read_b64_tr_b16 v[212:213], v47 offset:8192
    v_mfma_f32_16x16x32_bf16 v[56:59], v[200:203], v[148:151], v[56:59]
    ds_read_b64_tr_b16 v[214:215], v47 offset:9216
    v_mfma_f32_16x16x32_bf16 v[60:63], v[148:151], v[204:207], v[60:63]
    ds_read_b128 v[172:175], v42 offset:0
    v_mfma_f32_16x16x32_bf16 v[64:67], v[208:211], v[148:151], v[64:67]
    ds_read_b64_tr_b16 v[216:217], v48 offset:8192
    v_mfma_f32_16x16x32_bf16 v[80:83], v[208:211], v[152:155], v[80:83]
    ds_read_b64_tr_b16 v[218:219], v48 offset:9216
    v_mfma_f32_16x16x32_bf16 v[76:79], v[152:155], v[204:207], v[76:79]
    ds_read_b128 v[176:179], v42 offset:2048
    v_mfma_f32_16x16x32_bf16 v[72:75], v[200:203], v[152:155], v[72:75]
    ds_read_b64_tr_b16 v[220:221], v49 offset:8192
    v_mfma_f32_16x16x32_bf16 v[68:71], v[196:199], v[152:155], v[68:71]
    ds_read_b64_tr_b16 v[222:223], v49 offset:9216
    v_mfma_f32_16x16x32_bf16 v[84:87], v[196:199], v[156:159], v[84:87]
    ds_read_b128 v[180:183], v42 offset:4096
    v_mfma_f32_16x16x32_bf16 v[88:91], v[200:203], v[156:159], v[88:91]
    ds_read_b64_tr_b16 v[224:225], v50 offset:8192
    v_mfma_f32_16x16x32_bf16 v[92:95], v[156:159], v[204:207], v[92:95]
    ds_read_b64_tr_b16 v[226:227], v50 offset:9216
    v_mfma_f32_16x16x32_bf16 v[96:99], v[208:211], v[156:159], v[96:99]
    ds_read_b128 v[184:187], v42 offset:6144
    v_mfma_f32_16x16x32_bf16 v[112:115], v[208:211], v[160:163], v[112:115]
    ds_read_b128 v[188:191], v42 offset:8192
    v_mfma_f32_16x16x32_bf16 v[108:111], v[160:163], v[204:207], v[108:111]
    ds_read_b128 v[192:195], v42 offset:10240
    v_mfma_f32_16x16x32_bf16 v[104:107], v[200:203], v[160:163], v[104:107]
    v_mfma_f32_16x16x32_bf16 v[100:103], v[196:199], v[160:163], v[100:103]
    v_mfma_f32_16x16x32_bf16 v[116:119], v[196:199], v[164:167], v[116:119]
    v_mfma_f32_16x16x32_bf16 v[120:123], v[200:203], v[164:167], v[120:123]
    v_mfma_f32_16x16x32_bf16 v[124:127], v[164:167], v[204:207], v[124:127]
    v_mfma_f32_16x16x32_bf16 v[128:131], v[208:211], v[164:167], v[128:131]
    v_mfma_f32_16x16x32_bf16 v[144:147], v[208:211], v[168:171], v[144:147]
    v_mfma_f32_16x16x32_bf16 v[140:143], v[168:171], v[204:207], v[140:143]
    v_mfma_f32_16x16x32_bf16 v[136:139], v[200:203], v[168:171], v[136:139]
    v_mfma_f32_16x16x32_bf16 v[132:135], v[196:199], v[168:171], v[132:135]
    s_waitcnt lgkmcnt(0)
    s_barrier
    v_mfma_f32_16x16x32_bf16 v[52:55], v[212:215], v[172:175], v[52:55]
    ds_read_b64_tr_b16 v[196:197], v43 offset:0
    v_mfma_f32_16x16x32_bf16 v[56:59], v[216:219], v[172:175], v[56:59]
    ds_read_b64_tr_b16 v[198:199], v43 offset:1024
    v_mfma_f32_16x16x32_bf16 v[60:63], v[172:175], v[220:223], v[60:63]
    ds_read_b128 v[148:151], v39 offset:0
    v_mfma_f32_16x16x32_bf16 v[64:67], v[224:227], v[172:175], v[64:67]
    ds_read_b64_tr_b16 v[200:201], v44 offset:0
    v_mfma_f32_16x16x32_bf16 v[80:83], v[224:227], v[176:179], v[80:83]
    ds_read_b64_tr_b16 v[202:203], v44 offset:1024
    v_mfma_f32_16x16x32_bf16 v[76:79], v[176:179], v[220:223], v[76:79]
    ds_read_b128 v[152:155], v39 offset:2048
    v_mfma_f32_16x16x32_bf16 v[72:75], v[216:219], v[176:179], v[72:75]
    ds_read_b64_tr_b16 v[204:205], v45 offset:0
    v_mfma_f32_16x16x32_bf16 v[68:71], v[212:215], v[176:179], v[68:71]
    ds_read_b64_tr_b16 v[206:207], v45 offset:1024
    v_mfma_f32_16x16x32_bf16 v[84:87], v[212:215], v[180:183], v[84:87]
    ds_read_b128 v[156:159], v39 offset:4096
    v_mfma_f32_16x16x32_bf16 v[88:91], v[216:219], v[180:183], v[88:91]
    ds_read_b64_tr_b16 v[208:209], v46 offset:0
    v_mfma_f32_16x16x32_bf16 v[92:95], v[180:183], v[220:223], v[92:95]
    ds_read_b64_tr_b16 v[210:211], v46 offset:1024
    v_mfma_f32_16x16x32_bf16 v[96:99], v[224:227], v[180:183], v[96:99]
    ds_read_b128 v[160:163], v39 offset:6144
    v_mfma_f32_16x16x32_bf16 v[112:115], v[224:227], v[184:187], v[112:115]
    ds_read_b128 v[164:167], v39 offset:8192
    v_mfma_f32_16x16x32_bf16 v[108:111], v[184:187], v[220:223], v[108:111]
    ds_read_b128 v[168:171], v39 offset:10240
    v_mfma_f32_16x16x32_bf16 v[104:107], v[216:219], v[184:187], v[104:107]
    v_mfma_f32_16x16x32_bf16 v[100:103], v[212:215], v[184:187], v[100:103]
    v_mfma_f32_16x16x32_bf16 v[116:119], v[212:215], v[188:191], v[116:119]
    v_mfma_f32_16x16x32_bf16 v[120:123], v[216:219], v[188:191], v[120:123]
    v_mfma_f32_16x16x32_bf16 v[124:127], v[188:191], v[220:223], v[124:127]
    v_mfma_f32_16x16x32_bf16 v[128:131], v[224:227], v[188:191], v[128:131]
    v_mfma_f32_16x16x32_bf16 v[144:147], v[224:227], v[192:195], v[144:147]
    v_mfma_f32_16x16x32_bf16 v[140:143], v[192:195], v[220:223], v[140:143]
    v_mfma_f32_16x16x32_bf16 v[136:139], v[216:219], v[192:195], v[136:139]
    v_mfma_f32_16x16x32_bf16 v[132:135], v[212:215], v[192:195], v[132:135]
    s_waitcnt lgkmcnt(0)
    v_mfma_f32_16x16x32_bf16 v[52:55], v[196:199], v[148:151], v[52:55]
    ds_read_b64_tr_b16 v[212:213], v43 offset:8192
    v_mfma_f32_16x16x32_bf16 v[56:59], v[200:203], v[148:151], v[56:59]
    ds_read_b64_tr_b16 v[214:215], v43 offset:9216
    v_mfma_f32_16x16x32_bf16 v[60:63], v[148:151], v[204:207], v[60:63]
    ds_read_b128 v[172:175], v40 offset:0
    v_mfma_f32_16x16x32_bf16 v[64:67], v[208:211], v[148:151], v[64:67]
    ds_read_b64_tr_b16 v[216:217], v44 offset:8192
    v_mfma_f32_16x16x32_bf16 v[80:83], v[208:211], v[152:155], v[80:83]
    ds_read_b64_tr_b16 v[218:219], v44 offset:9216
    v_mfma_f32_16x16x32_bf16 v[76:79], v[152:155], v[204:207], v[76:79]
    ds_read_b128 v[176:179], v40 offset:2048
    v_mfma_f32_16x16x32_bf16 v[72:75], v[200:203], v[152:155], v[72:75]
    ds_read_b64_tr_b16 v[220:221], v45 offset:8192
    v_mfma_f32_16x16x32_bf16 v[68:71], v[196:199], v[152:155], v[68:71]
    ds_read_b64_tr_b16 v[222:223], v45 offset:9216
    v_mfma_f32_16x16x32_bf16 v[84:87], v[196:199], v[156:159], v[84:87]
    ds_read_b128 v[180:183], v40 offset:4096
    v_mfma_f32_16x16x32_bf16 v[88:91], v[200:203], v[156:159], v[88:91]
    ds_read_b64_tr_b16 v[224:225], v46 offset:8192
    v_mfma_f32_16x16x32_bf16 v[92:95], v[156:159], v[204:207], v[92:95]
    ds_read_b64_tr_b16 v[226:227], v46 offset:9216
    v_mfma_f32_16x16x32_bf16 v[96:99], v[208:211], v[156:159], v[96:99]
    ds_read_b128 v[184:187], v40 offset:6144
    v_mfma_f32_16x16x32_bf16 v[112:115], v[208:211], v[160:163], v[112:115]
    ds_read_b128 v[188:191], v40 offset:8192
    v_mfma_f32_16x16x32_bf16 v[108:111], v[160:163], v[204:207], v[108:111]
    ds_read_b128 v[192:195], v40 offset:10240
    v_mfma_f32_16x16x32_bf16 v[104:107], v[200:203], v[160:163], v[104:107]
    v_mfma_f32_16x16x32_bf16 v[100:103], v[196:199], v[160:163], v[100:103]
    v_mfma_f32_16x16x32_bf16 v[116:119], v[196:199], v[164:167], v[116:119]
    v_mfma_f32_16x16x32_bf16 v[120:123], v[200:203], v[164:167], v[120:123]
    v_mfma_f32_16x16x32_bf16 v[124:127], v[164:167], v[204:207], v[124:127]
    v_mfma_f32_16x16x32_bf16 v[128:131], v[208:211], v[164:167], v[128:131]
    v_mfma_f32_16x16x32_bf16 v[144:147], v[208:211], v[168:171], v[144:147]
    v_mfma_f32_16x16x32_bf16 v[140:143], v[168:171], v[204:207], v[140:143]
    v_mfma_f32_16x16x32_bf16 v[136:139], v[200:203], v[168:171], v[136:139]
    v_mfma_f32_16x16x32_bf16 v[132:135], v[196:199], v[168:171], v[132:135]
    s_waitcnt lgkmcnt(0)
    s_barrier
    v_mfma_f32_16x16x32_bf16 v[52:55], v[212:215], v[172:175], v[52:55]
    ds_read_b64_tr_b16 v[196:197], v43 offset:40960
    v_mfma_f32_16x16x32_bf16 v[56:59], v[216:219], v[172:175], v[56:59]
    ds_read_b64_tr_b16 v[198:199], v43 offset:41984
    v_mfma_f32_16x16x32_bf16 v[60:63], v[172:175], v[220:223], v[60:63]
    ds_read_b128 v[148:151], v39 offset:40960
    v_mfma_f32_16x16x32_bf16 v[64:67], v[224:227], v[172:175], v[64:67]
    ds_read_b64_tr_b16 v[200:201], v44 offset:40960
    v_mfma_f32_16x16x32_bf16 v[80:83], v[224:227], v[176:179], v[80:83]
    ds_read_b64_tr_b16 v[202:203], v44 offset:41984
    v_mfma_f32_16x16x32_bf16 v[76:79], v[176:179], v[220:223], v[76:79]
    ds_read_b128 v[152:155], v39 offset:43008
    v_mfma_f32_16x16x32_bf16 v[72:75], v[216:219], v[176:179], v[72:75]
    ds_read_b64_tr_b16 v[204:205], v45 offset:40960
    v_mfma_f32_16x16x32_bf16 v[68:71], v[212:215], v[176:179], v[68:71]
    ds_read_b64_tr_b16 v[206:207], v45 offset:41984
    v_mfma_f32_16x16x32_bf16 v[84:87], v[212:215], v[180:183], v[84:87]
    ds_read_b128 v[156:159], v39 offset:45056
    v_mfma_f32_16x16x32_bf16 v[88:91], v[216:219], v[180:183], v[88:91]
    ds_read_b64_tr_b16 v[208:209], v46 offset:40960
    v_mfma_f32_16x16x32_bf16 v[92:95], v[180:183], v[220:223], v[92:95]
    ds_read_b64_tr_b16 v[210:211], v46 offset:41984
    v_mfma_f32_16x16x32_bf16 v[96:99], v[224:227], v[180:183], v[96:99]
    ds_read_b128 v[160:163], v39 offset:47104
    v_mfma_f32_16x16x32_bf16 v[112:115], v[224:227], v[184:187], v[112:115]
    ds_read_b128 v[164:167], v39 offset:49152
    v_mfma_f32_16x16x32_bf16 v[108:111], v[184:187], v[220:223], v[108:111]
    ds_read_b128 v[168:171], v39 offset:51200
    v_mfma_f32_16x16x32_bf16 v[104:107], v[216:219], v[184:187], v[104:107]
    v_mfma_f32_16x16x32_bf16 v[100:103], v[212:215], v[184:187], v[100:103]
    v_mfma_f32_16x16x32_bf16 v[116:119], v[212:215], v[188:191], v[116:119]
    v_mfma_f32_16x16x32_bf16 v[120:123], v[216:219], v[188:191], v[120:123]
    v_mfma_f32_16x16x32_bf16 v[124:127], v[188:191], v[220:223], v[124:127]
    v_mfma_f32_16x16x32_bf16 v[128:131], v[224:227], v[188:191], v[128:131]
    s_branch K_PG2
.p2align 12
K_CHM2:
K_STM2:
    s_branch K_WRET_M
    s_nop 0
K_PG2:
    v_mfma_f32_16x16x32_bf16 v[144:147], v[224:227], v[192:195], v[144:147]
    v_mfma_f32_16x16x32_bf16 v[140:143], v[192:195], v[220:223], v[140:143]
    v_mfma_f32_16x16x32_bf16 v[136:139], v[216:219], v[192:195], v[136:139]
    v_mfma_f32_16x16x32_bf16 v[132:135], v[212:215], v[192:195], v[132:135]
    s_waitcnt lgkmcnt(0)
    v_mfma_f32_16x16x32_bf16 v[52:55], v[196:199], v[148:151], v[52:55]
    ds_read_b64_tr_b16 v[212:213], v43 offset:49152
    v_mfma_f32_16x16x32_bf16 v[56:59], v[200:203], v[148:151], v[56:59]
    ds_read_b64_tr_b16 v[214:215], v43 offset:50176
    v_mfma_f32_16x16x32_bf16 v[60:63], v[148:151], v[204:207], v[60:63]
    ds_read_b128 v[172:175], v40 offset:40960
    v_mfma_f32_16x16x32_bf16 v[64:67], v[208:211], v[148:151], v[64:67]
    ds_read_b64_tr_b16 v[216:217], v44 offset:49152
    v_mfma_f32_16x16x32_bf16 v[80:83], v[208:211], v[152:155], v[80:83]
    ds_read_b64_tr_b16 v[218:219], v44 offset:50176
    v_mfma_f32_16x16x32_bf16 v[76:79], v[152:155], v[204:207], v[76:79]
    ds_read_b128 v[176:179], v40 offset:43008
    v_mfma_f32_16x16x32_bf16 v[72:75], v[200:203], v[152:155], v[72:75]
    ds_read_b64_tr_b16 v[220:221], v45 offset:49152
    v_mfma_f32_16x16x32_bf16 v[68:71], v[196:199], v[152:155], v[68:71]
    ds_read_b64_tr_b16 v[222:223], v45 offset:50176
    v_mfma_f32_16x16x32_bf16 v[84:87], v[196:199], v[156:159], v[84:87]
    ds_read_b128 v[180:183], v40 offset:45056
    v_mfma_f32_16x16x32_bf16 v[88:91], v[200:203], v[156:159], v[88:91]
    ds_read_b64_tr_b16 v[224:225], v46 offset:49152
    v_mfma_f32_16x16x32_bf16 v[92:95], v[156:159], v[204:207], v[92:95]
    ds_read_b64_tr_b16 v[226:227], v46 offset:50176
    v_mfma_f32_16x16x32_bf16 v[96:99], v[208:211], v[156:159], v[96:99]
    ds_read_b128 v[184:187], v40 offset:47104
    v_mfma_f32_16x16x32_bf16 v[112:115], v[208:211], v[160:163], v[112:115]
    ds_read_b128 v[188:191], v40 offset:49152
    v_mfma_f32_16x16x32_bf16 v[108:111], v[160:163], v[204:207], v[108:111]
    ds_read_b128 v[192:195], v40 offset:51200
    v_mfma_f32_16x16x32_bf16 v[104:107], v[200:203], v[160:163], v[104:107]
    v_mfma_f32_16x16x32_bf16 v[100:103], v[196:199], v[160:163], v[100:103]
    v_mfma_f32_16x16x32_bf16 v[116:119], v[196:199], v[164:167], v[116:119]
    v_mfma_f32_16x16x32_bf16 v[120:123], v[200:203], v[164:167], v[120:123]
    v_mfma_f32_16x16x32_bf16 v[124:127], v[164:167], v[204:207], v[124:127]
    v_mfma_f32_16x16x32_bf16 v[128:131], v[208:211], v[164:167], v[128:131]
    v_mfma_f32_16x16x32_bf16 v[144:147], v[208:211], v[168:171], v[144:147]
    v_mfma_f32_16x16x32_bf16 v[140:143], v[168:171], v[204:207], v[140:143]
    v_mfma_f32_16x16x32_bf16 v[136:139], v[200:203], v[168:171], v[136:139]
    v_mfma_f32_16x16x32_bf16 v[132:135], v[196:199], v[168:171], v[132:135]
    s_waitcnt lgkmcnt(0)
    s_barrier
    v_mfma_f32_16x16x32_bf16 v[52:55], v[212:215], v[172:175], v[52:55]
    ds_read_b64_tr_b16 v[196:197], v47 offset:0
    v_mfma_f32_16x16x32_bf16 v[56:59], v[216:219], v[172:175], v[56:59]
    ds_read_b64_tr_b16 v[198:199], v47 offset:1024
    v_mfma_f32_16x16x32_bf16 v[60:63], v[172:175], v[220:223], v[60:63]
    ds_read_b128 v[148:151], v41 offset:0
    v_mfma_f32_16x16x32_bf16 v[64:67], v[224:227], v[172:175], v[64:67]
    ds_read_b64_tr_b16 v[200:201], v48 offset:0
    v_mfma_f32_16x16x32_bf16 v[80:83], v[224:227], v[176:179], v[80:83]
    ds_read_b64_tr_b16 v[202:203], v48 offset:1024
    v_mfma_f32_16x16x32_bf16 v[76:79], v[176:179], v[220:223], v[76:79]
    ds_read_b128 v[152:155], v41 offset:2048
    v_mfma_f32_16x16x32_bf16 v[72:75], v[216:219], v[176:179], v[72:75]
    ds_read_b64_tr_b16 v[204:205], v49 offset:0
    v_mfma_f32_16x16x32_bf16 v[68:71], v[212:215], v[176:179], v[68:71]
    ds_read_b64_tr_b16 v[206:207], v49 offset:1024
    v_mfma_f32_16x16x32_bf16 v[84:87], v[212:215], v[180:183], v[84:87]
    ds_read_b128 v[156:159], v41 offset:4096
    v_mfma_f32_16x16x32_bf16 v[88:91], v[216:219], v[180:183], v[88:91]
    ds_read_b64_tr_b16 v[208:209], v50 offset:0
    v_mfma_f32_16x16x32_bf16 v[92:95], v[180:183], v[220:223], v[92:95]
    ds_read_b64_tr_b16 v[210:211], v50 offset:1024
    v_mfma_f32_16x16x32_bf16 v[96:99], v[224:227], v[180:183], v[96:99]
    ds_read_b128 v[160:163], v41 offset:6144
    v_mfma_f32_16x16x32_bf16 v[112:115], v[224:227], v[184:187], v[112:115]
    ds_read_b128 v[164:167], v41 offset:8192
    v_mfma_f32_16x16x32_bf16 v[108:111], v[184:187], v[220:223], v[108:111]
    ds_read_b128 v[168:171], v41 offset:10240
    v_mfma_f32_16x16x32_bf16 v[104:107], v[216:219], v[184:187], v[104:107]
    v_mfma_f32_16x16x32_bf16 v[100:103], v[212:215], v[184:187], v[100:103]
    v_mfma_f32_16x16x32_bf16 v[116:119], v[212:215], v[188:191], v[116:119]
    v_mfma_f32_16x16x32_bf16 v[120:123], v[216:219], v[188:191], v[120:123]
    v_mfma_f32_16x16x32_bf16 v[124:127], v[188:191], v[220:223], v[124:127]
    v_mfma_f32_16x16x32_bf16 v[128:131], v[224:227], v[188:191], v[128:131]
    v_mfma_f32_16x16x32_bf16 v[144:147], v[224:227], v[192:195], v[144:147]
    v_mfma_f32_16x16x32_bf16 v[140:143], v[192:195], v[220:223], v[140:143]
    v_mfma_f32_16x16x32_bf16 v[136:139], v[216:219], v[192:195], v[136:139]
    v_mfma_f32_16x16x32_bf16 v[132:135], v[212:215], v[192:195], v[132:135]
    s_waitcnt lgkmcnt(0)
    v_mfma_f32_16x16x32_bf16 v[132:135], v[196:199], v[168:171], v[132:135]
    ds_read_b64_tr_b16 v[212:213], v47 offset:8192
    ds_read_b64_tr_b16 v[214:215], v47 offset:9216
    v_mfma_f32_16x16x32_bf16 v[136:139], v[200:203], v[168:171], v[136:139]
    ds_read_b128 v[192:195], v42 offset:10240
    ds_read_b64_tr_b16 v[216:217], v48 offset:8192
    v_mfma_f32_16x16x32_bf16 v[140:143], v[168:171], v[204:207], v[140:143]
    ds_read_b64_tr_b16 v[218:219], v48 offset:9216
    ds_read_b64_tr_b16 v[220:221], v49 offset:8192
    v_mfma_f32_16x16x32_bf16 v[144:147], v[208:211], v[168:171], v[144:147]
    ds_read_b64_tr_b16 v[222:223], v49 offset:9216
    ds_read_b64_tr_b16 v[224:225], v50 offset:8192
    v_mfma_f32_16x16x32_bf16 v[116:119], v[196:199], v[164:167], v[116:119]
    ds_read_b64_tr_b16 v[226:227], v50 offset:9216
    ds_read_b128 v[188:191], v42 offset:8192
    v_mfma_f32_16x16x32_bf16 v[120:123], v[200:203], v[164:167], v[120:123]
    ds_read_b128 v[184:187], v42 offset:6144
    ds_read_b128 v[180:183], v42 offset:4096
    v_mfma_f32_16x16x32_bf16 v[124:127], v[164:167], v[204:207], v[124:127]
    ds_read_b128 v[176:179], v42 offset:2048
    ds_read_b128 v[172:175], v42 offset:0
    v_mfma_f32_16x16x32_bf16 v[128:131], v[208:211], v[164:167], v[128:131]
    s_waitcnt lgkmcnt(11)
    v_mfma_f32_16x16x32_bf16 v[132:135], v[212:215], v[192:195], v[132:135]
    s_waitcnt lgkmcnt(9)
    v_mfma_f32_16x16x32_bf16 v[136:139], v[216:219], v[192:195], v[136:139]
    s_waitcnt lgkmcnt(7)
    v_mfma_f32_16x16x32_bf16 v[140:143], v[192:195], v[220:223], v[140:143]
    s_waitcnt lgkmcnt(5)
    v_mfma_f32_16x16x32_bf16 v[144:147], v[224:227], v[192:195], v[144:147]
    s_waitcnt lgkmcnt(4)
    v_mfma_f32_16x16x32_bf16 v[116:119], v[212:215], v[188:191], v[116:119]
    v_cvt_pk_bf16_f32 v132, v132, v133
    v_cvt_pk_bf16_f32 v133, v134, v135
    v_mfma_f32_16x16x32_bf16 v[120:123], v[216:219], v[188:191], v[120:123]
    v_cvt_pk_bf16_f32 v136, v136, v137
    v_cvt_pk_bf16_f32 v137, v138, v139
    v_mfma_f32_16x16x32_bf16 v[124:127], v[188:191], v[220:223], v[124:127]
    v_mov_b32 v138, 0
    v_mov_b32 v139, 0
    v_mfma_f32_16x16x32_bf16 v[128:131], v[224:227], v[188:191], v[128:131]
    v_cvt_pk_bf16_f32 v134, v144, v145
    v_cvt_pk_bf16_f32 v135, v146, v147
    v_mfma_f32_16x16x32_bf16 v[100:103], v[196:199], v[160:163], v[100:103]
    v_cvt_pk_bf16_f32 v254, v140, v141
    v_cvt_pk_bf16_f32 v255, v142, v143
    v_mfma_f32_16x16x32_bf16 v[104:107], v[200:203], v[160:163], v[104:107]
    v_permlane16_swap_b32 v134, v138
    v_permlane16_swap_b32 v135, v139
    ds_write_b64 v32, v[134:135] offset:768
    v_mfma_f32_16x16x32_bf16 v[108:111], v[160:163], v[204:207], v[108:111]
    ds_read_b64_tr_b16 v[240:241], v33 offset:768
    s_cmp_lg_u32 s54, 0
    s_cbranch_scc1 K_NOX
    ds_write_b64 v34, v[132:133]
    ds_write_b64 v34, v[134:135] offset:512
    ds_write_b64 v34, v[254:255] offset:1024
    v_lshl_add_u32 v2, s55, 2, v38
    ds_write_b16 v2, v38 offset:30
K_NOX:
    v_mfma_f32_16x16x32_bf16 v[112:115], v[208:211], v[160:163], v[112:115]
    v_cvt_pk_bf16_f32 v116, v116, v117
    v_cvt_pk_bf16_f32 v117, v118, v119
    v_mfma_f32_16x16x32_bf16 v[192:195], v[132:135], v[136:139], v[16:19]
    v_cvt_pk_bf16_f32 v120, v120, v121
    v_cvt_pk_bf16_f32 v121, v122, v123
    s_waitcnt lgkmcnt(5)
    v_mfma_f32_16x16x32_bf16 v[100:103], v[212:215], v[184:187], v[100:103]
    v_mov_b32 v122, 0
    v_mov_b32 v123, 0
    v_mfma_f32_16x16x32_bf16 v[104:107], v[216:219], v[184:187], v[104:107]
    v_cvt_pk_bf16_f32 v118, v128, v129
    v_cvt_pk_bf16_f32 v119, v130, v131
    v_mfma_f32_16x16x32_bf16 v[108:111], v[184:187], v[220:223], v[108:111]
    v_cvt_pk_bf16_f32 v252, v124, v125
    v_cvt_pk_bf16_f32 v253, v126, v127
    v_mfma_f32_16x16x32_bf16 v[112:115], v[224:227], v[184:187], v[112:115]
    v_permlane16_swap_b32 v118, v122
    v_permlane16_swap_b32 v119, v123
    ds_write_b64 v32, v[118:119] offset:640
    v_mfma_f32_16x16x32_bf16 v[84:87], v[196:199], v[156:159], v[84:87]
    ds_read_b64_tr_b16 v[238:239], v33 offset:640
    v_cvt_pk_bf16_f32 v100, v100, v101
    v_mfma_f32_16x16x32_bf16 v[88:91], v[200:203], v[156:159], v[88:91]
    v_cvt_pk_bf16_f32 v101, v102, v103
    v_cvt_pk_bf16_f32 v104, v104, v105
    v_mfma_f32_16x16x32_bf16 v[168:171], v[116:119], v[136:139], v[12:15]
    v_cvt_pk_bf16_f32 v105, v106, v107
    v_mov_b32 v106, 0
    v_mfma_f32_16x16x32_bf16 v[92:95], v[156:159], v[204:207], v[92:95]
    v_mov_b32 v107, 0
    v_cvt_pk_bf16_f32 v102, v112, v113
    v_mfma_f32_16x16x32_bf16 v[188:191], v[116:119], v[120:123], v[16:19]
    v_cvt_pk_bf16_f32 v103, v114, v115
    v_cvt_pk_bf16_f32 v250, v108, v109
    v_mfma_f32_16x16x32_bf16 v[96:99], v[208:211], v[156:159], v[96:99]
    v_cvt_pk_bf16_f32 v251, v110, v111
    v_permlane16_swap_b32 v102, v106
    s_waitcnt lgkmcnt(6)
    v_mfma_f32_16x16x32_bf16 v[84:87], v[212:215], v[180:183], v[84:87]
    v_permlane16_swap_b32 v103, v107
    ds_write_b64 v32, v[102:103] offset:512
    v_mfma_f32_16x16x32_bf16 v[88:91], v[216:219], v[180:183], v[88:91]
    ds_read_b64_tr_b16 v[236:237], v33 offset:512
    v_max3_f32 v168, v168, v169, v192
    v_mfma_f32_16x16x32_bf16 v[92:95], v[180:183], v[220:223], v[92:95]
    v_max3_f32 v170, v170, v171, v194
    v_max_f32 v168, v168, v193
    v_mfma_f32_16x16x32_bf16 v[164:167], v[100:103], v[120:123], v[12:15]
    v_max_f32 v169, v170, v195
    v_cvt_pk_bf16_f32 v168, v168, v169
    v_mfma_f32_16x16x32_bf16 v[96:99], v[224:227], v[180:183], v[96:99]
    v_cvt_pk_bf16_f32 v84, v84, v85
    v_cvt_pk_bf16_f32 v85, v86, v87
    v_mfma_f32_16x16x32_bf16 v[184:187], v[100:103], v[104:107], v[16:19]
    v_cvt_pk_bf16_f32 v88, v88, v89
    v_cvt_pk_bf16_f32 v89, v90, v91
    v_mfma_f32_16x16x32_bf16 v[68:71], v[196:199], v[152:155], v[68:71]
    v_mov_b32 v90, 0
    v_mov_b32 v91, 0
    v_mfma_f32_16x16x32_bf16 v[72:75], v[200:203], v[152:155], v[72:75]
    v_max3_f32 v164, v164, v165, v188
    v_max3_f32 v166, v166, v167, v190
    v_mfma_f32_16x16x32_bf16 v[76:79], v[152:155], v[204:207], v[76:79]
    v_max_f32 v164, v164, v189
    v_max_f32 v165, v166, v191
    v_mfma_f32_16x16x32_bf16 v[80:83], v[208:211], v[152:155], v[80:83]
    v_cvt_pk_bf16_f32 v164, v164, v165
    v_cvt_pk_bf16_f32 v86, v96, v97
    s_waitcnt lgkmcnt(7)
    v_mfma_f32_16x16x32_bf16 v[68:71], v[212:215], v[176:179], v[68:71]
    v_cvt_pk_bf16_f32 v87, v98, v99
    v_cvt_pk_bf16_f32 v248, v92, v93
    v_mfma_f32_16x16x32_bf16 v[72:75], v[216:219], v[176:179], v[72:75]
    v_cvt_pk_bf16_f32 v249, v94, v95
    v_permlane16_swap_b32 v86, v90
    v_mfma_f32_16x16x32_bf16 v[76:79], v[176:179], v[220:223], v[76:79]
    v_permlane16_swap_b32 v87, v91
    ds_write_b64 v32, v[86:87] offset:384
    v_mfma_f32_16x16x32_bf16 v[80:83], v[224:227], v[176:179], v[80:83]
    ds_read_b64_tr_b16 v[234:235], v33 offset:384
    v_lshl_add_u32 v2, s55, 2, v38
    v_mfma_f32_16x16x32_bf16 v[52:55], v[196:199], v[148:151], v[52:55]
    ds_read_b32 v3, v2 offset:28
    ds_read_b64 v[144:145], v34
    v_mfma_f32_16x16x32_bf16 v[160:163], v[84:87], v[104:107], v[12:15]
    ds_read_b64 v[146:147], v34 offset:512
    ds_read_b64 v[242:243], v34 offset:1024
    v_mfma_f32_16x16x32_bf16 v[56:59], v[200:203], v[148:151], v[56:59]
    ds_read_b64_tr_b16 v[228:229], v33
    v_cvt_pk_bf16_f32 v68, v68, v69
    v_mfma_f32_16x16x32_bf16 v[180:183], v[84:87], v[88:91], v[16:19]
    v_cvt_pk_bf16_f32 v69, v70, v71
    v_cvt_pk_bf16_f32 v72, v72, v73
    v_mfma_f32_16x16x32_bf16 v[60:63], v[148:151], v[204:207], v[60:63]
    v_cvt_pk_bf16_f32 v73, v74, v75
    v_mov_b32 v74, 0
    v_mfma_f32_16x16x32_bf16 v[64:67], v[208:211], v[148:151], v[64:67]
    v_mov_b32 v75, 0
    v_cvt_pk_bf16_f32 v70, v80, v81
    s_waitcnt lgkmcnt(13)
    v_mfma_f32_16x16x32_bf16 v[52:55], v[212:215], v[172:175], v[52:55]
    v_cvt_pk_bf16_f32 v71, v82, v83
    v_cvt_pk_bf16_f32 v246, v76, v77
    v_mfma_f32_16x16x32_bf16 v[56:59], v[216:219], v[172:175], v[56:59]
    v_cvt_pk_bf16_f32 v247, v78, v79
    v_permlane16_swap_b32 v70, v74
    v_mfma_f32_16x16x32_bf16 v[60:63], v[172:175], v[220:223], v[60:63]
    v_permlane16_swap_b32 v71, v75
    ds_write_b64 v32, v[70:71] offset:256
    v_mfma_f32_16x16x32_bf16 v[64:67], v[224:227], v[172:175], v[64:67]
    ds_read_b64_tr_b16 v[232:233], v33 offset:256
    v_max3_f32 v160, v160, v161, v184
    v_max3_f32 v162, v162, v163, v186
    v_max_f32 v160, v160, v185
    v_max_f32 v161, v162, v187
    v_mfma_f32_16x16x32_bf16 v[156:159], v[68:71], v[88:91], v[12:15]
    v_cvt_pk_bf16_f32 v160, v160, v161
    v_cvt_pk_bf16_f32 v52, v52, v53
    v_cvt_pk_bf16_f32 v53, v54, v55
    v_mfma_f32_16x16x32_bf16 v[176:179], v[68:71], v[72:75], v[16:19]
    v_cvt_pk_bf16_f32 v56, v56, v57
    v_cvt_pk_bf16_f32 v57, v58, v59
    v_mov_b32 v58, 0
    v_mov_b32 v59, 0
    v_cvt_pk_bf16_f32 v54, v64, v65
    v_cvt_pk_bf16_f32 v55, v66, v67
    v_cvt_pk_bf16_f32 v244, v60, v61
    v_cvt_pk_bf16_f32 v245, v62, v63
    v_permlane16_swap_b32 v54, v58
    v_permlane16_swap_b32 v55, v59
    ds_write_b64 v32, v[54:55] offset:128
    ds_read_b64_tr_b16 v[230:231], v33 offset:128
    v_max3_f32 v156, v156, v157, v180
    v_max3_f32 v158, v158, v159, v182
    v_max_f32 v156, v156, v181
    v_mfma_f32_16x16x32_bf16 v[152:155], v[52:55], v[72:75], v[20:23]
    v_max_f32 v157, v158, v183
    v_cvt_pk_bf16_f32 v156, v156, v157
    v_mfma_f32_16x16x32_bf16 v[172:175], v[52:55], v[56:59], v[16:19]
    s_waitcnt lgkmcnt(4)
    v_readfirstlane_b32 s33, v3
    s_cmp_lt_u32 s33, 1811939328
    s_cbranch_scc1 K_XW
K_XR:
    v_mfma_f32_16x16x32_bf16 v[148:151], v[144:147], v[56:59], v[12:15]
    v_max3_f32 v152, v152, v153, v176
    v_max3_f32 v154, v154, v155, v178
    v_max_f32 v152, v152, v177
    v_max_f32 v153, v154, v179
    v_cvt_pk_bf16_f32 v152, v152, v153
    v_permlane16_swap_b32 v164, v168
    v_permlane16_swap_b32 v156, v160
    s_nop 1
    v_max3_f32 v148, v148, v149, v172
    v_max3_f32 v150, v150, v151, v174
    v_max_f32 v148, v148, v173
    v_max_f32 v149, v150, v175
    v_cvt_pk_bf16_f32 v148, v148, v149
    v_permlane32_swap_b32 v156, v164
    v_permlane32_swap_b32 v160, v168
    v_lshlrev_b32 v220, 16, v156
    v_and_b32 v221, 0xffff0000, v156
    v_lshlrev_b32 v224, 16, v164
    v_and_b32 v225, 0xffff0000, v164
    v_lshlrev_b32 v222, 16, v160
    v_and_b32 v223, 0xffff0000, v160
    v_lshlrev_b32 v226, 16, v168
    v_and_b32 v227, 0xffff0000, v168
    v_permlane16_swap_b32 v148, v152
    v_lshlrev_b32 v216, 16, v148
    v_and_b32 v217, 0xffff0000, v148
    v_lshlrev_b32 v218, 16, v152
    v_and_b32 v219, 0xffff0000, v152
    v_pk_mul_f32 v[220:221], v[220:221], s[60:61]
    v_pk_mul_f32 v[224:225], v[224:225], s[60:61]
    v_pk_mul_f32 v[222:223], v[222:223], s[60:61]
    v_pk_mul_f32 v[226:227], v[226:227], s[60:61]
    v_pk_mul_f32 v[216:217], v[216:217], s[60:61]
    v_pk_mul_f32 v[218:219], v[218:219], s[60:61]
    v_cvt_pk_bf16_f32 v156, v220, v221
    v_cvt_pk_bf16_f32 v164, v224, v225
    v_cvt_pk_bf16_f32 v160, v222, v223
    v_cvt_pk_bf16_f32 v168, v226, v227
    v_cvt_pk_bf16_f32 v148, v216, v217
    v_cvt_pk_bf16_f32 v152, v218, v219
    v_lshlrev_b32 v218, 16, v152
    v_and_b32 v219, 0xffff0000, v152
    v_lshlrev_b32 v216, 16, v148
    v_and_b32 v217, 0xffff0000, v148
    v_lshlrev_b32 v226, 16, v168
    v_and_b32 v227, 0xffff0000, v168
    v_lshlrev_b32 v222, 16, v160
    v_and_b32 v223, 0xffff0000, v160
    v_lshlrev_b32 v224, 16, v164
    v_and_b32 v225, 0xffff0000, v164
    v_lshlrev_b32 v220, 16, v156
    v_and_b32 v221, 0xffff0000, v156
    v_max3_f32 v174, v216, v217, v218
    v_max3_f32 v172, v220, v221, v224
    v_max_f32 v174, v174, v219
    v_max3_f32 v172, v172, v225, v222
    v_mov_b32 v176, v174
    v_max3_f32 v172, v172, v223, v226
    v_max_f32 v172, v172, v227
    v_permlane32_swap_b32 v174, v176
    v_mul_f32 v172, s58, v172
    v_max_f32 v174, v174, v176
    v_mul_f32 v174, s58, v174
    v_pk_fma_f32 v[220:221], v[220:221], s[58:59], v[172:173] op_sel_hi:[1,1,0] neg_lo:[0,0,1] neg_hi:[0,0,1]
    v_pk_fma_f32 v[222:223], v[222:223], s[58:59], v[172:173] op_sel_hi:[1,1,0] neg_lo:[0,0,1] neg_hi:[0,0,1]
    v_pk_fma_f32 v[224:225], v[224:225], s[58:59], v[172:173] op_sel_hi:[1,1,0] neg_lo:[0,0,1] neg_hi:[0,0,1]
    v_pk_fma_f32 v[226:227], v[226:227], s[58:59], v[172:173] op_sel_hi:[1,1,0] neg_lo:[0,0,1] neg_hi:[0,0,1]
    v_pk_fma_f32 v[216:217], v[216:217], s[58:59], v[174:175] op_sel_hi:[1,1,0] neg_lo:[0,0,1] neg_hi:[0,0,1]
    v_pk_fma_f32 v[218:219], v[218:219], s[58:59], v[174:175] op_sel_hi:[1,1,0] neg_lo:[0,0,1] neg_hi:[0,0,1]
    v_exp_f32 v216, v216
    v_exp_f32 v217, v217
    v_exp_f32 v218, v218
    v_exp_f32 v219, v219
    v_exp_f32 v220, v220
    v_exp_f32 v221, v221
    v_exp_f32 v222, v222
    v_exp_f32 v223, v223
    v_exp_f32 v224, v224
    v_exp_f32 v225, v225
    v_exp_f32 v226, v226
    v_exp_f32 v227, v227
    ds_read_b32 v3, v2 offset:28
    v_pk_add_f32 v[174:175], v[216:217], v[218:219]
    v_pk_add_f32 v[172:173], v[220:221], v[222:223]
    v_add_f32 v174, v174, v175
    v_pk_add_f32 v[178:179], v[224:225], v[226:227]
    v_mov_b32 v176, v174
    v_pk_add_f32 v[172:173], v[172:173], v[178:179]
    v_add_f32 v172, v172, v173
    v_permlane32_swap_b32 v174, v176
    v_rcp_f32 v172, v172
    v_add_f32 v174, v174, v176
    v_rcp_f32 v174, v174
    v_pk_mul_f32 v[220:221], v[220:221], v[172:173] op_sel_hi:[1,0]
    v_pk_mul_f32 v[222:223], v[222:223], v[172:173] op_sel_hi:[1,0]
    v_pk_mul_f32 v[224:225], v[224:225], v[172:173] op_sel_hi:[1,0]
    v_pk_mul_f32 v[226:227], v[226:227], v[172:173] op_sel_hi:[1,0]
    v_pk_mul_f32 v[216:217], v[216:217], v[174:175] op_sel_hi:[1,0]
    v_pk_mul_f32 v[218:219], v[218:219], v[174:175] op_sel_hi:[1,0]
    v_cvt_pk_bf16_f32 v156, v220, v221
    v_cvt_pk_bf16_f32 v164, v224, v225
    v_cvt_pk_bf16_f32 v160, v222, v223
    v_cvt_pk_bf16_f32 v168, v226, v227
    v_cvt_pk_bf16_f32 v148, v216, v217
    v_cvt_pk_bf16_f32 v152, v218, v219
    v_permlane32_swap_b32 v156, v164
    v_permlane32_swap_b32 v160, v168
    v_permlane16_swap_b32 v148, v152
    s_waitcnt lgkmcnt(0)
    v_permlane16_swap_b32 v156, v160
    v_permlane16_swap_b32 v164, v168
    v_readfirstlane_b32 s33, v3
    s_cmp_lt_u32 s33, 1811939332
    s_cbranch_scc1 K_PW
K_PR:
    s_and_b32 s3, s36, 0xffc00
    s_cbranch_scc0 K_NOHa3
    v_mov_b32 v4, s36
    s_mov_b32 exec_lo, s37
    s_mov_b32 exec_hi, 0
    global_atomic_add v37, v4, s[6:7] sc1
    s_mov_b64 exec, -1
K_NOHa3:
    v_perm_b32 v56, v148, v148, v24
    v_perm_b32 v57, v148, v148, v25
    v_perm_b32 v58, v148, v148, v26
    v_perm_b32 v59, v148, v148, v27
    v_perm_b32 v72, v152, v152, v24
    v_perm_b32 v73, v152, v152, v25
    v_mfma_f32_16x16x32_bf16 v[64:67], v[228:231], v[56:59], 0
    v_perm_b32 v74, v152, v152, v26
    v_perm_b32 v75, v152, v152, v27
    v_mfma_f32_16x16x32_bf16 v[60:63], v[242:245], v[56:59], 0
    v_perm_b32 v88, v156, v156, v24
    v_perm_b32 v89, v156, v156, v25
    v_mfma_f32_16x16x32_bf16 v[80:83], v[230:233], v[72:75], 0
    v_perm_b32 v90, v156, v156, v26
    v_perm_b32 v91, v156, v156, v27
    v_mfma_f32_16x16x32_bf16 v[76:79], v[244:247], v[72:75], 0
    v_perm_b32 v104, v160, v160, v24
    v_perm_b32 v105, v160, v160, v25
    v_mfma_f32_16x16x32_bf16 v[96:99], v[232:235], v[88:91], 0
    v_perm_b32 v106, v160, v160, v26
    v_perm_b32 v107, v160, v160, v27
    v_mfma_f32_16x16x32_bf16 v[92:95], v[246:249], v[88:91], 0
    v_cvt_pk_bf16_f32 v68, v64, v65
    v_cvt_pk_bf16_f32 v69, v66, v67
    ds_write_b64 v35, v[68:69] offset:0
    v_perm_b32 v120, v164, v164, v24
    v_perm_b32 v121, v164, v164, v25
    v_mfma_f32_16x16x32_bf16 v[112:115], v[234:237], v[104:107], 0
    v_perm_b32 v122, v164, v164, v26
    v_perm_b32 v123, v164, v164, v27
    v_mfma_f32_16x16x32_bf16 v[108:111], v[248:251], v[104:107], 0
    v_cvt_pk_bf16_f32 v70, v80, v81
    v_cvt_pk_bf16_f32 v71, v82, v83
    ds_write_b64 v35, v[70:71] offset:256
    v_perm_b32 v136, v168, v168, v24
    v_perm_b32 v137, v168, v168, v25
    v_mfma_f32_16x16x32_bf16 v[128:131], v[236:239], v[120:123], 0
    v_perm_b32 v138, v168, v168, v26
    v_perm_b32 v139, v168, v168, v27
    v_mfma_f32_16x16x32_bf16 v[124:127], v[250:253], v[120:123], 0
    v_cvt_pk_bf16_f32 v100, v96, v97
    v_cvt_pk_bf16_f32 v101, v98, v99
    ds_write_b64 v35, v[100:101] offset:512
    v_mov_b32 v3, 1
    v_mfma_f32_16x16x32_bf16 v[144:147], v[238:241], v[136:139], 0
    s_and_b32 s3, s36, 0x3ff
    s_cbranch_scc0 K_NOHa4
    v_mov_b32 v4, s36
    s_mov_b32 exec_lo, s37
    s_mov_b32 exec_hi, 0
    global_atomic_add v37, v4, s[6:7] sc1
    s_mov_b64 exec, -1
K_NOHa4:
    v_lshl_add_u32 v2, s54, 2, v38
    v_cvt_pk_bf16_f32 v102, v112, v113
    v_cvt_pk_bf16_f32 v103, v114, v115
    ds_write_b64 v35, v[102:103] offset:768
    v_mfma_f32_16x16x32_bf16 v[140:143], v[252:255], v[136:139], 0
    v_cvt_pk_bf16_f32 v132, v128, v129
    v_cvt_pk_bf16_f32 v133, v130, v131
    ds_write_b64 v35, v[132:133] offset:1024
    v_cvt_pk_bf16_f32 v134, v144, v145
    v_cvt_pk_bf16_f32 v135, v146, v147
    ds_write_b64 v35, v[134:135] offset:1280
    s_mov_b64 exec, 1
    ds_add_u32 v2, v3 offset:48
    s_mov_b64 exec, -1
    v_cvt_pk_bf16_f32 v52, v60, v61
    v_cvt_pk_bf16_f32 v54, v76, v77
    v_cvt_pk_bf16_f32 v53, v62, v63
    v_cvt_pk_bf16_f32 v55, v78, v79
    s_nop 0
    v_permlane16_swap_b32 v52, v54
    v_permlane16_swap_b32 v53, v55
    v_min_u32 v52, -2, v52
    buffer_store_dwordx4 v[52:55], v28, s[20:23], 0 offen sc1
    v_cvt_pk_bf16_f32 v84, v92, v93
    v_cvt_pk_bf16_f32 v86, v108, v109
    v_cvt_pk_bf16_f32 v85, v94, v95
    v_cvt_pk_bf16_f32 v87, v110, v111
    s_nop 0
    v_permlane16_swap_b32 v84, v86
    v_permlane16_swap_b32 v85, v87
    v_min_u32 v84, -2, v84
    buffer_store_dwordx4 v[84:87], v29, s[20:23], 0 offen sc1
    ds_read_b32 v3, v2 offset:48
    ds_read_b128 v[196:199], v36
    v_cvt_pk_bf16_f32 v116, v124, v125
    v_cvt_pk_bf16_f32 v118, v140, v141
    v_cvt_pk_bf16_f32 v117, v126, v127
    v_cvt_pk_bf16_f32 v119, v142, v143
    s_nop 0
    v_permlane16_swap_b32 v116, v118
    v_permlane16_swap_b32 v117, v119
    v_min_u32 v116, -2, v116
    buffer_store_dwordx4 v[116:119], v30, s[20:23], 0 offen sc1
    s_waitcnt lgkmcnt(0)
    v_readfirstlane_b32 s33, v3
    s_cmp_lt_u32 s33, 2
    s_cbranch_scc1 K_TW
K_TR:
    v_min_u32 v196, -2, v196
    buffer_store_dwordx4 v[196:199], v31, s[20:23], 0 offen sc1
    s_cmp_eq_u32 s34, -1
    s_cbranch_scc1 K_END
    s_add_u32 s30, s30, 4
    s_branch K_P2_HELP
K_CHM3:
K_STM3:
    s_branch K_WRET_M
    s_nop 0
K_XW:
    s_mov_b32 s3, 1048576
K_CGX:
    ds_read_b32 v3, v2 offset:28
    s_sub_u32 s3, s3, 1
    s_waitcnt lgkmcnt(0)
    v_readfirstlane_b32 s33, v3
    s_cselect_b32 s33, 1811939328, s33
    s_cmp_lt_u32 s33, 1811939328
    s_cbranch_scc1 K_CGX
    ds_read_b64 v[144:145], v34
    ds_read_b64 v[146:147], v34 offset:512
    ds_read_b64 v[242:243], v34 offset:1024
    ds_read_b64_tr_b16 v[228:229], v33
    s_waitcnt lgkmcnt(0)
    s_branch K_XR
K_PW:
    s_mov_b32 s3, 1048576
K_CGP:
    ds_read_b32 v3, v2 offset:28
    s_sub_u32 s3, s3, 1
    s_waitcnt lgkmcnt(0)
    v_readfirstlane_b32 s33, v3
    s_cselect_b32 s33, 1811939332, s33
    s_cmp_lt_u32 s33, 1811939332
    s_cbranch_scc1 K_CGP
    s_branch K_PR
K_TW:
    s_mov_b32 s3, 1048576
K_CGT:
    ds_read_b32 v3, v2 offset:48
    s_sub_u32 s3, s3, 1
    s_waitcnt lgkmcnt(0)
    v_readfirstlane_b32 s33, v3
    s_cselect_b32 s33, 2, s33
    s_cmp_lt_u32 s33, 2
    s_cbranch_scc1 K_CGT
    ds_read_b128 v[196:199], v36
    s_waitcnt lgkmcnt(0)
    s_branch K_TR
K_P2_EARLY:
    s_lshl_b32 s62, s40, 7
    v_lshrrev_b32 v8, 3, v1
    v_lshrrev_b32 v9, 4, v1
    v_mov_b32 v15, 158720
    s_lshl_b32 s61, s40, 3
    s_add_u32 s61, s61, s30
    s_mul_i32 s3, s61, 20480
    s_lshl_b32 s33, s41, 7
    s_add_u32 s3, s3, s33
    v_and_b32 v2, 7, v1
    v_lshlrev_b32 v2, 4, v2
    v_mul_u32_u24 v4, 1280, v8
    v_add3_u32 v10, v2, v4, s3
    s_lshl_b32 s3, s30, 7
    s_add_u32 s3, s3, 159744
    v_lshl_add_u32 v11, v8, 3, s3
    s_mov_b32 s63, 10240
    s_add_u32 s20, s6, 0x100000
    s_addc_u32 s21, s7, 0
    s_mov_b32 s22, 0x280000
    s_mov_b32 s23, 0x20000
    s_mov_b32 s56, s10
    s_mov_b32 s57, s11
    s_mov_b32 s58, 0x280000
    s_mov_b32 s59, 0x20000
    v_mul_u32_u24 v3, 144, v8
    v_add_u32 v3, v2, v3
    s_mul_i32 s3, s30, 2304
    s_add_u32 s3, s3, 140288
    v_add_u32 v14, s3, v3
    buffer_load_dwordx4 v[16:19], v10, s[12:15], 0 offen
    buffer_load_dwordx4 v[20:23], v10, s[12:15], s63 offen
    v_bfe_u32 v48, v1, 2, 2
    v_and_b32 v49, 3, v1
    s_add_u32 s3, s61, s30
    s_lshr_b32 s33, s3, 2
    s_mul_i32 s33, s33, 76
    s_add_u32 s3, s3, s33
    s_lshl_b32 s3, s3, 10
    v_and_b32 v2, 15, v1
    v_lshl_add_u32 v2, v2, 4, s3
    v_lshrrev_b32 v3, 5, v1
    v_lshl_add_u32 v2, v3, 8, v2
    v_and_b32 v4, 1, v9
    v_lshl_add_u32 v52, v4, 10, v2
    v_mov_b32 v53, 0x1f000
    v_lshl_add_u32 v2, v3, 3, v48
    v_lshlrev_b32 v2, 7, v2
    v_lshl_add_u32 v2, v49, 3, v2
    v_lshl_add_u32 v2, v4, 5, v2
    v_lshrrev_b32 v4, 1, v48
    v_lshl_add_u32 v54, v4, 6, v2
    v_xor_b32 v55, 64, v54
    v_mov_b32 v56, v54
    v_mov_b32 v57, v54
    s_branch K_PG3
.p2align 12
K_CHA0:
K_STA4:
    s_branch K_STA8
K_CHB0:
K_STB4:
    s_branch K_STB8
K_PG3:
    v_and_b32 v2, 31, v1
    v_mul_u32_u24 v2, 144, v2
    v_lshl_add_u32 v2, v3, 3, v2
    s_mul_i32 s3, s30, 4608
    s_add_u32 s3, s3, 140288
    v_add_u32 v50, s3, v2
    s_and_b32 s33, s40, 3
    s_lshl_b32 s33, s33, 2
    s_lshr_b32 s33, 0xf63f, s33
    s_and_b32 s33, s33, 15
    s_lshl1_add_u32 s3, s30, 1
    s_cmp_ge_u32 s3, s33
    s_cselect_b32 s60, 24, 16
    s_cmp_gt_u32 s3, s33
    s_cselect_b32 s60, 20, s60
    v_add_u32 v58, s60, v15
    s_mov_b32 s64, -1
    s_mov_b32 s65, -1
    s_mov_b32 s66, -1
    s_mov_b32 s67, -1
    s_mov_b32 s68, -1
    s_mov_b32 s69, -1
    s_mov_b32 s70, 0xfffff
    s_mov_b32 s71, 131072
    v_mov_b32 v108, 0
    v_mov_b32 v109, 0
    v_mov_b32 v110, 0
    v_mov_b32 v111, 0
    v_mov_b32 v112, 0
    v_mov_b32 v113, 0
    v_mov_b32 v114, 0
    v_mov_b32 v115, 0
    v_mov_b32 v116, 0
    v_mov_b32 v117, 0
    v_mov_b32 v118, 0
    v_mov_b32 v119, 0
    v_mov_b32 v120, 0
    v_mov_b32 v121, 0
    v_mov_b32 v122, 0
    v_mov_b32 v123, 0
    v_mov_b32 v124, 0
    v_mov_b32 v125, 0
    v_mov_b32 v126, 0
    v_mov_b32 v127, 0
    v_mov_b32 v128, 0
    v_mov_b32 v129, 0
    v_mov_b32 v130, 0
    v_mov_b32 v131, 0
    v_mov_b32 v132, 0
    v_mov_b32 v133, 0
    v_mov_b32 v134, 0
    v_mov_b32 v135, 0
    v_mov_b32 v136, 0
    v_mov_b32 v137, 0
    v_mov_b32 v138, 0
    v_mov_b32 v139, 0
    s_barrier
    s_branch K_P2_AUXW
K_P2_GM:
    s_lshl_b32 s62, s40, 7
    v_lshrrev_b32 v8, 3, v1
    v_lshrrev_b32 v9, 4, v1
    v_mov_b32 v15, 158720
    s_lshl_b32 s61, s40, 3
    s_add_u32 s61, s61, s30
    s_mul_i32 s3, s61, 20480
    s_lshl_b32 s33, s41, 7
    s_add_u32 s3, s3, s33
    v_and_b32 v2, 7, v1
    v_lshlrev_b32 v2, 4, v2
    v_mul_u32_u24 v4, 1280, v8
    v_add3_u32 v10, v2, v4, s3
    s_lshl_b32 s3, s30, 7
    s_add_u32 s3, s3, 159744
    v_lshl_add_u32 v11, v8, 3, s3
    s_mov_b32 s63, 10240
    s_add_u32 s20, s6, 0x100000
    s_addc_u32 s21, s7, 0
    s_mov_b32 s22, 0x280000
    s_mov_b32 s23, 0x20000
    s_mov_b32 s56, s10
    s_mov_b32 s57, s11
    s_mov_b32 s58, 0x280000
    s_mov_b32 s59, 0x20000
    v_mul_u32_u24 v3, 144, v8
    v_add_u32 v3, v2, v3
    s_mul_i32 s3, s30, 2304
    s_add_u32 s3, s3, 140288
    v_add_u32 v14, s3, v3
    v_bfe_u32 v48, v1, 2, 2
    v_and_b32 v49, 3, v1
    s_add_u32 s3, s61, s30
    s_lshr_b32 s33, s3, 2
    s_mul_i32 s33, s33, 76
    s_add_u32 s3, s3, s33
    s_lshl_b32 s3, s3, 10
    v_and_b32 v2, 15, v1
    v_lshl_add_u32 v2, v2, 4, s3
    v_lshrrev_b32 v3, 5, v1
    v_lshl_add_u32 v2, v3, 8, v2
    v_and_b32 v4, 1, v9
    v_lshl_add_u32 v52, v4, 10, v2
    v_mov_b32 v53, 0x1f000
    v_lshl_add_u32 v2, v3, 3, v48
    v_lshlrev_b32 v2, 7, v2
    v_lshl_add_u32 v2, v49, 3, v2
    v_lshl_add_u32 v2, v4, 5, v2
    v_lshrrev_b32 v4, 1, v48
    v_lshl_add_u32 v54, v4, 6, v2
    v_xor_b32 v55, 64, v54
    v_mov_b32 v56, v54
    v_mov_b32 v57, v54
    v_and_b32 v2, 31, v1
    v_mul_u32_u24 v2, 144, v2
    v_lshl_add_u32 v2, v3, 3, v2
    s_mul_i32 s3, s30, 4608
    s_add_u32 s3, s3, 140288
    v_add_u32 v50, s3, v2
    s_and_b32 s33, s40, 3
    s_lshl_b32 s33, s33, 2
    s_lshr_b32 s33, 0xf63f, s33
    s_and_b32 s33, s33, 15
    s_lshl1_add_u32 s3, s30, 1
    s_cmp_ge_u32 s3, s33
    s_cselect_b32 s60, 24, 16
    s_cmp_gt_u32 s3, s33
    s_cselect_b32 s60, 20, s60
    v_add_u32 v58, s60, v15
    s_mov_b32 s64, -1
    s_mov_b32 s65, -1
    s_mov_b32 s66, -1
    s_mov_b32 s67, -1
    s_mov_b32 s68, -1
    s_mov_b32 s69, -1
    s_mov_b32 s70, 0xfffff
    s_mov_b32 s71, 131072
    v_mov_b32 v108, 0
    v_mov_b32 v109, 0
    v_mov_b32 v110, 0
    v_mov_b32 v111, 0
    v_mov_b32 v112, 0
    v_mov_b32 v113, 0
    v_mov_b32 v114, 0
    v_mov_b32 v115, 0
    v_mov_b32 v116, 0
    v_mov_b32 v117, 0
    v_mov_b32 v118, 0
    v_mov_b32 v119, 0
    v_mov_b32 v120, 0
    v_mov_b32 v121, 0
    v_mov_b32 v122, 0
    v_mov_b32 v123, 0
    v_mov_b32 v124, 0
    v_mov_b32 v125, 0
    v_mov_b32 v126, 0
    v_mov_b32 v127, 0
    v_mov_b32 v128, 0
    v_mov_b32 v129, 0
    v_mov_b32 v130, 0
    v_mov_b32 v131, 0
    v_mov_b32 v132, 0
    v_mov_b32 v133, 0
    v_mov_b32 v134, 0
    v_mov_b32 v135, 0
    v_mov_b32 v136, 0
    v_mov_b32 v137, 0
    v_mov_b32 v138, 0
    v_mov_b32 v139, 0
    buffer_load_dwordx4 v[16:19], v10, s[12:15], 0 offen
    buffer_load_dwordx4 v[20:23], v10, s[12:15], s63 offen
    s_cmp_eq_u32 s30, 0
    s_cbranch_scc1 K_CHB0
    s_cmp_eq_u32 s30, 1
    s_cbranch_scc1 K_CHB1
    s_cmp_eq_u32 s30, 2
    s_cbranch_scc1 K_CHB2
    s_branch K_CHB3
K_WRET_B:
    v_mov_b32 v3, 1
    s_waitcnt vmcnt(2)
    s_mov_b64 exec, 1
    ds_add_u32 v15, v3 offset:44
    s_mov_b64 exec, -1
    s_mov_b32 s3, 1048576
K_P2_GWM:
    ds_read_b32 v2, v15 offset:44
    s_sleep 1
    s_sub_u32 s3, s3, 1
    s_waitcnt lgkmcnt(0)
    v_readfirstlane_b32 s33, v2
    s_nop 3
    s_cselect_b32 s33, 4, s33
    s_cmp_lt_u32 s33, 4
    s_cbranch_scc1 K_P2_GWM
    ds_write_b32 v15, v15 offset:56
K_P2_GEMM:
    s_setprio 1
    s_add_u32 s53, s40, 1
    s_and_b32 s53, s53, 2
    s_mov_b32 s46, 0x84210
    s_mov_b32 s47, s46
    s_waitcnt vmcnt(0)
    v_lshlrev_b32 v32, 16, v16
    v_and_b32 v33, 0xffff0000, v16
    v_lshlrev_b32 v34, 16, v17
    v_and_b32 v35, 0xffff0000, v17
    v_lshlrev_b32 v36, 16, v18
    v_and_b32 v37, 0xffff0000, v18
    v_lshlrev_b32 v38, 16, v19
    v_and_b32 v39, 0xffff0000, v19
    v_lshlrev_b32 v40, 16, v20
    v_and_b32 v41, 0xffff0000, v20
    v_lshlrev_b32 v42, 16, v21
    v_and_b32 v43, 0xffff0000, v21
    v_lshlrev_b32 v44, 16, v22
    v_and_b32 v45, 0xffff0000, v22
    v_lshlrev_b32 v46, 16, v23
    v_and_b32 v47, 0xffff0000, v23
    s_branch K_SPL
    s_nop 0
    s_nop 0
    s_nop 0
K_IT0:
    v_mfma_f32_32x32x16_bf16 v[108:123], v[156:159], v[68:71], v[108:123]
    ds_read_b64_tr_b16 v[140:141], v56 offset:0
    ds_read_b64_tr_b16 v[142:143], v56 offset:512
    s_and_b32 s33, s50, s70
    s_cbranch_scc0 K_RF0
K_RB0:
    s_ff1_i32_b32 s51, s33
    v_mfma_f32_32x32x16_bf16 v[124:139], v[164:167], v[68:71], v[124:139]
    s_bitset0_b32 s70, s51
    s_lshl_b32 s64, s51, 12
    buffer_load_dwordx4 v[60:63], v52, s[20:23], s64 offen offset:0 sc1
    ds_read_b64_tr_b16 v[144:145], v56 offset:2048
    ds_read_b64_tr_b16 v[146:147], v56 offset:2560
    v_mfma_f32_32x32x16_bf16 v[108:123], v[160:163], v[72:75], v[108:123]
    buffer_load_dwordx4 v[64:67], v52, s[20:23], s64 offen offset:512 sc1
    ds_read_b64_tr_b16 v[148:149], v57 offset:0
    ds_read_b64_tr_b16 v[150:151], v57 offset:512
    s_waitcnt vmcnt(8) lgkmcnt(6)
    v_cmp_u_f32 vcc, v76, v80
    v_mfma_f32_32x32x16_bf16 v[124:139], v[168:171], v[72:75], v[124:139]
    ds_read_b64_tr_b16 v[152:153], v57 offset:2048
    ds_read_b64_tr_b16 v[154:155], v57 offset:2560
    v_and_or_b32 v56, s68, v53, v54
    v_and_or_b32 v57, s68, v53, v55
    s_cbranch_vccnz K_FX1
K_IT1:
    v_mfma_f32_32x32x16_bf16 v[108:123], v[172:175], v[76:79], v[108:123]
    ds_read_b64_tr_b16 v[156:157], v56 offset:0
    ds_read_b64_tr_b16 v[158:159], v56 offset:512
    s_and_b32 s33, s50, s70
    s_cbranch_scc0 K_RF1
K_RB1:
    s_ff1_i32_b32 s51, s33
    v_mfma_f32_32x32x16_bf16 v[124:139], v[180:183], v[76:79], v[124:139]
    s_bitset0_b32 s70, s51
    s_lshl_b32 s65, s51, 12
    buffer_load_dwordx4 v[68:71], v52, s[20:23], s65 offen offset:0 sc1
    ds_read_b64_tr_b16 v[160:161], v56 offset:2048
    ds_read_b64_tr_b16 v[162:163], v56 offset:2560
    v_mfma_f32_32x32x16_bf16 v[108:123], v[176:179], v[80:83], v[108:123]
    buffer_load_dwordx4 v[72:75], v52, s[20:23], s65 offen offset:512 sc1
    ds_read_b64_tr_b16 v[164:165], v57 offset:0
    ds_read_b64_tr_b16 v[166:167], v57 offset:512
    s_waitcnt vmcnt(8) lgkmcnt(6)
    v_cmp_u_f32 vcc, v84, v88
    v_mfma_f32_32x32x16_bf16 v[124:139], v[184:187], v[80:83], v[124:139]
    ds_read_b64_tr_b16 v[168:169], v57 offset:2048
    ds_read_b64_tr_b16 v[170:171], v57 offset:2560
    v_and_or_b32 v56, s69, v53, v54
    v_and_or_b32 v57, s69, v53, v55
    s_cbranch_vccnz K_FX2
K_IT2:
    v_mfma_f32_32x32x16_bf16 v[108:123], v[140:143], v[84:87], v[108:123]
    ds_read_b64_tr_b16 v[172:173], v56 offset:0
    ds_read_b64_tr_b16 v[174:175], v56 offset:512
    s_and_b32 s33, s50, s70
    s_cbranch_scc0 K_RF2
K_RB2:
    s_ff1_i32_b32 s51, s33
    v_mfma_f32_32x32x16_bf16 v[124:139], v[148:151], v[84:87], v[124:139]
    s_bitset0_b32 s70, s51
    s_lshl_b32 s66, s51, 12
    buffer_load_dwordx4 v[76:79], v52, s[20:23], s66 offen offset:0 sc1
    ds_read_b64_tr_b16 v[176:177], v56 offset:2048
    ds_read_b64_tr_b16 v[178:179], v56 offset:2560
    v_mfma_f32_32x32x16_bf16 v[108:123], v[144:147], v[88:91], v[108:123]
    buffer_load_dwordx4 v[80:83], v52, s[20:23], s66 offen offset:512 sc1
    ds_read_b64_tr_b16 v[180:181], v57 offset:0
    ds_read_b64_tr_b16 v[182:183], v57 offset:512
    s_waitcnt vmcnt(8) lgkmcnt(6)
    v_cmp_u_f32 vcc, v92, v96
    v_mfma_f32_32x32x16_bf16 v[124:139], v[152:155], v[88:91], v[124:139]
    ds_read_b64_tr_b16 v[184:185], v57 offset:2048
    ds_read_b64_tr_b16 v[186:187], v57 offset:2560
    v_and_or_b32 v56, s64, v53, v54
    v_and_or_b32 v57, s64, v53, v55
    s_cbranch_vccnz K_FX3
K_IT3:
    v_mfma_f32_32x32x16_bf16 v[108:123], v[156:159], v[92:95], v[108:123]
    ds_read_b64_tr_b16 v[140:141], v56 offset:0
    ds_read_b64_tr_b16 v[142:143], v56 offset:512
    s_and_b32 s33, s50, s70
    s_cbranch_scc0 K_RF3
K_RB3:
    s_ff1_i32_b32 s51, s33
    v_mfma_f32_32x32x16_bf16 v[124:139], v[164:167], v[92:95], v[124:139]
    s_bitset0_b32 s70, s51
    s_lshl_b32 s67, s51, 12
    buffer_load_dwordx4 v[84:87], v52, s[20:23], s67 offen offset:0 sc1
    ds_read_b64_tr_b16 v[144:145], v56 offset:2048
    ds_read_b64_tr_b16 v[146:147], v56 offset:2560
    v_mfma_f32_32x32x16_bf16 v[108:123], v[160:163], v[96:99], v[108:123]
    buffer_load_dwordx4 v[88:91], v52, s[20:23], s67 offen offset:512 sc1
    ds_read_b64_tr_b16 v[148:149], v57 offset:0
    ds_read_b64_tr_b16 v[150:151], v57 offset:512
    s_waitcnt vmcnt(8) lgkmcnt(6)
    v_cmp_u_f32 vcc, v100, v104
    v_mfma_f32_32x32x16_bf16 v[124:139], v[168:171], v[96:99], v[124:139]
    ds_read_b64_tr_b16 v[152:153], v57 offset:2048
    ds_read_b64_tr_b16 v[154:155], v57 offset:2560
    v_and_or_b32 v56, s65, v53, v54
    v_and_or_b32 v57, s65, v53, v55
    s_cbranch_vccnz K_FX4
K_IT4:
    v_mfma_f32_32x32x16_bf16 v[108:123], v[172:175], v[100:103], v[108:123]
    ds_read_b64_tr_b16 v[156:157], v56 offset:0
    ds_read_b64_tr_b16 v[158:159], v56 offset:512
    s_and_b32 s33, s50, s70
    s_cbranch_scc0 K_RF4
K_RB4:
    s_ff1_i32_b32 s51, s33
    v_mfma_f32_32x32x16_bf16 v[124:139], v[180:183], v[100:103], v[124:139]
    s_bitset0_b32 s70, s51
    s_lshl_b32 s68, s51, 12
    buffer_load_dwordx4 v[92:95], v52, s[20:23], s68 offen offset:0 sc1
    ds_read_b64_tr_b16 v[160:161], v56 offset:2048
    ds_read_b64_tr_b16 v[162:163], v56 offset:2560
    v_mfma_f32_32x32x16_bf16 v[108:123], v[176:179], v[104:107], v[108:123]
    buffer_load_dwordx4 v[96:99], v52, s[20:23], s68 offen offset:512 sc1
    ds_read_b64_tr_b16 v[164:165], v57 offset:0
    ds_read_b64_tr_b16 v[166:167], v57 offset:512
    s_waitcnt vmcnt(8) lgkmcnt(6)
    v_cmp_u_f32 vcc, v60, v64
    v_mfma_f32_32x32x16_bf16 v[124:139], v[184:187], v[104:107], v[124:139]
    ds_read_b64_tr_b16 v[168:169], v57 offset:2048
    ds_read_b64_tr_b16 v[170:171], v57 offset:2560
    v_and_or_b32 v56, s66, v53, v54
    v_and_or_b32 v57, s66, v53, v55
    s_cbranch_vccnz K_FX5
K_IT5:
    v_mfma_f32_32x32x16_bf16 v[108:123], v[140:143], v[60:63], v[108:123]
    ds_read_b64_tr_b16 v[172:173], v56 offset:0
    ds_read_b64_tr_b16 v[174:175], v56 offset:512
    s_and_b32 s33, s50, s70
    s_cbranch_scc0 K_RF5
K_RB5:
    s_ff1_i32_b32 s51, s33
    v_mfma_f32_32x32x16_bf16 v[124:139], v[148:151], v[60:63], v[124:139]
    s_bitset0_b32 s70, s51
    s_lshl_b32 s69, s51, 12
    buffer_load_dwordx4 v[100:103], v52, s[20:23], s69 offen offset:0 sc1
    ds_read_b64_tr_b16 v[176:177], v56 offset:2048
    ds_read_b64_tr_b16 v[178:179], v56 offset:2560
    v_mfma_f32_32x32x16_bf16 v[108:123], v[144:147], v[64:67], v[108:123]
    buffer_load_dwordx4 v[104:107], v52, s[20:23], s69 offen offset:512 sc1
    ds_read_b64_tr_b16 v[180:181], v57 offset:0
    ds_read_b64_tr_b16 v[182:183], v57 offset:512
    s_waitcnt vmcnt(8) lgkmcnt(6)
    v_cmp_u_f32 vcc, v68, v72
    v_mfma_f32_32x32x16_bf16 v[124:139], v[152:155], v[64:67], v[124:139]
    ds_read_b64_tr_b16 v[184:185], v57 offset:2048
    ds_read_b64_tr_b16 v[186:187], v57 offset:2560
    v_and_or_b32 v56, s67, v53, v54
    v_and_or_b32 v57, s67, v53, v55
    s_cbranch_vccnz K_FX0
    s_branch K_IT0
    s_nop 0
K_DR0:
    v_mfma_f32_32x32x16_bf16 v[108:123], v[156:159], v[68:71], v[108:123]
    ds_read_b64_tr_b16 v[140:141], v56 offset:0
    ds_read_b64_tr_b16 v[142:143], v56 offset:512
K_DM0:
    s_mov_b32 s64, -1
    v_mov_b32 v60, -1
    v_mfma_f32_32x32x16_bf16 v[124:139], v[164:167], v[68:71], v[124:139]
    buffer_load_dword v3, v52, s[20:23], s64 offen
    ds_read_b64_tr_b16 v[144:145], v56 offset:2048
    ds_read_b64_tr_b16 v[146:147], v56 offset:2560
    v_mfma_f32_32x32x16_bf16 v[108:123], v[160:163], v[72:75], v[108:123]
    buffer_load_dword v3, v52, s[20:23], s64 offen
    ds_read_b64_tr_b16 v[148:149], v57 offset:0
    ds_read_b64_tr_b16 v[150:151], v57 offset:512
    s_waitcnt vmcnt(8) lgkmcnt(6)
    v_cmp_u_f32 vcc, v76, v80
    v_mfma_f32_32x32x16_bf16 v[124:139], v[168:171], v[72:75], v[124:139]
    ds_read_b64_tr_b16 v[152:153], v57 offset:2048
    ds_read_b64_tr_b16 v[154:155], v57 offset:2560
    v_and_or_b32 v56, s68, v53, v54
    v_and_or_b32 v57, s68, v53, v55
    s_cbranch_vccnz K_DX1
K_DR1:
    v_mfma_f32_32x32x16_bf16 v[108:123], v[172:175], v[76:79], v[108:123]
    ds_read_b64_tr_b16 v[156:157], v56 offset:0
    ds_read_b64_tr_b16 v[158:159], v56 offset:512
K_DM1:
    s_mov_b32 s65, -1
    v_mov_b32 v68, -1
    v_mfma_f32_32x32x16_bf16 v[124:139], v[180:183], v[76:79], v[124:139]
    buffer_load_dword v3, v52, s[20:23], s65 offen
    ds_read_b64_tr_b16 v[160:161], v56 offset:2048
    ds_read_b64_tr_b16 v[162:163], v56 offset:2560
    v_mfma_f32_32x32x16_bf16 v[108:123], v[176:179], v[80:83], v[108:123]
    buffer_load_dword v3, v52, s[20:23], s65 offen
    ds_read_b64_tr_b16 v[164:165], v57 offset:0
    ds_read_b64_tr_b16 v[166:167], v57 offset:512
    s_waitcnt vmcnt(8) lgkmcnt(6)
    v_cmp_u_f32 vcc, v84, v88
    v_mfma_f32_32x32x16_bf16 v[124:139], v[184:187], v[80:83], v[124:139]
    ds_read_b64_tr_b16 v[168:169], v57 offset:2048
    ds_read_b64_tr_b16 v[170:171], v57 offset:2560
    v_and_or_b32 v56, s69, v53, v54
    v_and_or_b32 v57, s69, v53, v55
    s_cbranch_vccnz K_DX2
K_DR2:
    v_mfma_f32_32x32x16_bf16 v[108:123], v[140:143], v[84:87], v[108:123]
    ds_read_b64_tr_b16 v[172:173], v56 offset:0
    ds_read_b64_tr_b16 v[174:175], v56 offset:512
K_DM2:
    s_mov_b32 s66, -1
    v_mov_b32 v76, -1
    v_mfma_f32_32x32x16_bf16 v[124:139], v[148:151], v[84:87], v[124:139]
    buffer_load_dword v3, v52, s[20:23], s66 offen
    ds_read_b64_tr_b16 v[176:177], v56 offset:2048
    ds_read_b64_tr_b16 v[178:179], v56 offset:2560
    v_mfma_f32_32x32x16_bf16 v[108:123], v[144:147], v[88:91], v[108:123]
    buffer_load_dword v3, v52, s[20:23], s66 offen
    ds_read_b64_tr_b16 v[180:181], v57 offset:0
    ds_read_b64_tr_b16 v[182:183], v57 offset:512
    s_waitcnt vmcnt(8) lgkmcnt(6)
    v_cmp_u_f32 vcc, v92, v96
    v_mfma_f32_32x32x16_bf16 v[124:139], v[152:155], v[88:91], v[124:139]
    ds_read_b64_tr_b16 v[184:185], v57 offset:2048
    ds_read_b64_tr_b16 v[186:187], v57 offset:2560
    v_and_or_b32 v56, s64, v53, v54
    v_and_or_b32 v57, s64, v53, v55
    s_cbranch_vccnz K_DX3
K_DR3:
    v_mfma_f32_32x32x16_bf16 v[108:123], v[156:159], v[92:95], v[108:123]
    ds_read_b64_tr_b16 v[140:141], v56 offset:0
    ds_read_b64_tr_b16 v[142:143], v56 offset:512
K_DM3:
    s_mov_b32 s67, -1
    v_mov_b32 v84, -1
    v_mfma_f32_32x32x16_bf16 v[124:139], v[164:167], v[92:95], v[124:139]
    buffer_load_dword v3, v52, s[20:23], s67 offen
    ds_read_b64_tr_b16 v[144:145], v56 offset:2048
    ds_read_b64_tr_b16 v[146:147], v56 offset:2560
    v_mfma_f32_32x32x16_bf16 v[108:123], v[160:163], v[96:99], v[108:123]
    buffer_load_dword v3, v52, s[20:23], s67 offen
    ds_read_b64_tr_b16 v[148:149], v57 offset:0
    ds_read_b64_tr_b16 v[150:151], v57 offset:512
    s_waitcnt vmcnt(8) lgkmcnt(6)
    v_cmp_u_f32 vcc, v100, v104
    v_mfma_f32_32x32x16_bf16 v[124:139], v[168:171], v[96:99], v[124:139]
    ds_read_b64_tr_b16 v[152:153], v57 offset:2048
    ds_read_b64_tr_b16 v[154:155], v57 offset:2560
    v_and_or_b32 v56, s65, v53, v54
    v_and_or_b32 v57, s65, v53, v55
    s_cbranch_vccnz K_DX4
K_DR4:
    v_mfma_f32_32x32x16_bf16 v[108:123], v[172:175], v[100:103], v[108:123]
    ds_read_b64_tr_b16 v[156:157], v56 offset:0
    ds_read_b64_tr_b16 v[158:159], v56 offset:512
K_DM4:
    s_mov_b32 s68, -1
    v_mov_b32 v92, -1
    v_mfma_f32_32x32x16_bf16 v[124:139], v[180:183], v[100:103], v[124:139]
    buffer_load_dword v3, v52, s[20:23], s68 offen
    ds_read_b64_tr_b16 v[160:161], v56 offset:2048
    ds_read_b64_tr_b16 v[162:163], v56 offset:2560
    v_mfma_f32_32x32x16_bf16 v[108:123], v[176:179], v[104:107], v[108:123]
    buffer_load_dword v3, v52, s[20:23], s68 offen
    ds_read_b64_tr_b16 v[164:165], v57 offset:0
    ds_read_b64_tr_b16 v[166:167], v57 offset:512
    s_waitcnt vmcnt(8) lgkmcnt(6)
    v_cmp_u_f32 vcc, v60, v64
    v_mfma_f32_32x32x16_bf16 v[124:139], v[184:187], v[104:107], v[124:139]
    ds_read_b64_tr_b16 v[168:169], v57 offset:2048
    ds_read_b64_tr_b16 v[170:171], v57 offset:2560
    v_and_or_b32 v56, s66, v53, v54
    v_and_or_b32 v57, s66, v53, v55
    s_cbranch_vccnz K_DX5
K_DR5:
    v_mfma_f32_32x32x16_bf16 v[108:123], v[140:143], v[60:63], v[108:123]
    ds_read_b64_tr_b16 v[172:173], v56 offset:0
    ds_read_b64_tr_b16 v[174:175], v56 offset:512
K_DM5:
    s_mov_b32 s69, -1
    v_mov_b32 v100, -1
    v_mfma_f32_32x32x16_bf16 v[124:139], v[148:151], v[60:63], v[124:139]
    buffer_load_dword v3, v52, s[20:23], s69 offen
    ds_read_b64_tr_b16 v[176:177], v56 offset:2048
    ds_read_b64_tr_b16 v[178:179], v56 offset:2560
    v_mfma_f32_32x32x16_bf16 v[108:123], v[144:147], v[64:67], v[108:123]
    buffer_load_dword v3, v52, s[20:23], s69 offen
    ds_read_b64_tr_b16 v[180:181], v57 offset:0
    ds_read_b64_tr_b16 v[182:183], v57 offset:512
    s_waitcnt vmcnt(8) lgkmcnt(6)
    v_cmp_u_f32 vcc, v68, v72
    v_mfma_f32_32x32x16_bf16 v[124:139], v[152:155], v[64:67], v[124:139]
    ds_read_b64_tr_b16 v[184:185], v57 offset:2048
    ds_read_b64_tr_b16 v[186:187], v57 offset:2560
    v_and_or_b32 v56, s67, v53, v54
    v_and_or_b32 v57, s67, v53, v55
    s_cbranch_vccnz K_DX0
    s_branch K_DR0
K_CHA1:
K_STA5:
    s_branch K_STA9
K_CHB1:
K_STB5:
    s_branch K_STB9
K_RF0:
    s_cmp_eq_u32 s70, 0
    s_cbranch_scc1 K_DM0
    ds_read_b32 v59, v58
    s_waitcnt lgkmcnt(0)
    v_readfirstlane_b32 s50, v59
    s_and_b32 s33, s50, s70
    s_cbranch_scc1 K_RB0
    v_mfma_f32_32x32x16_bf16 v[124:139], v[164:167], v[68:71], v[124:139]
    s_mov_b32 s64, -1
    v_mov_b32 v60, -1
    buffer_load_dword v3, v52, s[20:23], s64 offen
    ds_read_b64_tr_b16 v[144:145], v56 offset:2048
    ds_read_b64_tr_b16 v[146:147], v56 offset:2560
    v_mfma_f32_32x32x16_bf16 v[108:123], v[160:163], v[72:75], v[108:123]
    buffer_load_dword v3, v52, s[20:23], s64 offen
    ds_read_b64_tr_b16 v[148:149], v57 offset:0
    ds_read_b64_tr_b16 v[150:151], v57 offset:512
    s_waitcnt vmcnt(8) lgkmcnt(6)
    v_cmp_u_f32 vcc, v76, v80
    v_mfma_f32_32x32x16_bf16 v[124:139], v[168:171], v[72:75], v[124:139]
    ds_read_b64_tr_b16 v[152:153], v57 offset:2048
    ds_read_b64_tr_b16 v[154:155], v57 offset:2560
    v_and_or_b32 v56, s68, v53, v54
    v_and_or_b32 v57, s68, v53, v55
    s_cbranch_vccz K_IT1
    s_branch K_FX1
K_TL0:
    s_waitcnt vmcnt(8) lgkmcnt(8)
    v_cmp_u_f32 vcc, v76, v80
    v_and_or_b32 v56, s68, v53, v54
    v_and_or_b32 v57, s68, v53, v55
    s_cbranch_vccz K_IT1
    s_branch K_FX1
K_DX0:
    s_and_b32 s51, s65, s66
    s_and_b32 s51, s51, s67
    s_and_b32 s51, s51, s68
    s_cmp_lt_i32 s51, 0
    s_cbranch_scc1 K_P2_MM
K_FX0:
    s_cmp_lt_i32 s65, 0
    s_cbranch_scc1 K_SK0
    v_max_u32 v2, v68, v72
    v_cmp_eq_u32 vcc, -1, v2
    s_cbranch_vccz K_IT0
    s_sub_u32 s71, s71, 1
    s_cbranch_scc1 K_IT0
    s_lshr_b32 s51, s65, 12
    s_bitset1_b32 s70, s51
K_SK0:
    s_and_b32 s33, s50, s70
    s_cbranch_scc0 K_NUL0
K_BK0:
    s_ff1_i32_b32 s51, s33
    s_lshl_b32 s64, s51, 12
    buffer_load_dwordx4 v[60:63], v52, s[20:23], s64 offen offset:0 sc1
    buffer_load_dwordx4 v[64:67], v52, s[20:23], s64 offen offset:512 sc1
    s_bitset0_b32 s70, s51
K_RD0:
    ds_read_b64_tr_b16 v[140:141], v56 offset:0
    ds_read_b64_tr_b16 v[142:143], v56 offset:512
    ds_read_b64_tr_b16 v[144:145], v56 offset:2048
    ds_read_b64_tr_b16 v[146:147], v56 offset:2560
    ds_read_b64_tr_b16 v[148:149], v57 offset:0
    ds_read_b64_tr_b16 v[150:151], v57 offset:512
    ds_read_b64_tr_b16 v[152:153], v57 offset:2048
    ds_read_b64_tr_b16 v[154:155], v57 offset:2560
    s_cmp_lt_i32 s66, 0
    s_cbranch_scc0 K_TL0
    v_and_or_b32 v56, s68, v53, v54
    v_and_or_b32 v57, s68, v53, v55
    s_branch K_SK1
K_NUL0:
    s_and_b32 s51, s66, s67
    s_and_b32 s51, s51, s68
    s_and_b32 s51, s51, s69
    s_cmp_lt_i32 s51, 0
    s_cbranch_scc0 K_PC0
    s_cmp_eq_u32 s70, 0
    s_cbranch_scc1 K_P2_MM
    s_branch K_SPN
K_PC0:
    s_cmp_eq_u32 s70, 0
    s_cbranch_scc1 K_NI0
    ds_read_b32 v59, v58
    s_waitcnt lgkmcnt(0)
    v_readfirstlane_b32 s50, v59
    s_and_b32 s33, s50, s70
    s_cbranch_scc1 K_BK0
    ds_read_b32 v59, v58
    s_waitcnt lgkmcnt(0)
    v_readfirstlane_b32 s50, v59
    s_and_b32 s33, s50, s70
    s_cbranch_scc1 K_BK0
K_NI0:
    s_mov_b32 s64, -1
    v_mov_b32 v60, -1
    buffer_load_dword v3, v52, s[20:23], s64 offen
    buffer_load_dword v3, v52, s[20:23], s64 offen
    s_branch K_RD0
K_RF1:
    s_cmp_eq_u32 s70, 0
    s_cbranch_scc1 K_DM1
    ds_read_b32 v59, v58
    s_waitcnt lgkmcnt(0)
    v_readfirstlane_b32 s50, v59
    s_and_b32 s33, s50, s70
    s_cbranch_scc1 K_RB1
    v_mfma_f32_32x32x16_bf16 v[124:139], v[180:183], v[76:79], v[124:139]
    s_mov_b32 s65, -1
    v_mov_b32 v68, -1
    buffer_load_dword v3, v52, s[20:23], s65 offen
    ds_read_b64_tr_b16 v[160:161], v56 offset:2048
    ds_read_b64_tr_b16 v[162:163], v56 offset:2560
    v_mfma_f32_32x32x16_bf16 v[108:123], v[176:179], v[80:83], v[108:123]
    buffer_load_dword v3, v52, s[20:23], s65 offen
    ds_read_b64_tr_b16 v[164:165], v57 offset:0
    ds_read_b64_tr_b16 v[166:167], v57 offset:512
    s_waitcnt vmcnt(8) lgkmcnt(6)
    v_cmp_u_f32 vcc, v84, v88
    v_mfma_f32_32x32x16_bf16 v[124:139], v[184:187], v[80:83], v[124:139]
    ds_read_b64_tr_b16 v[168:169], v57 offset:2048
    ds_read_b64_tr_b16 v[170:171], v57 offset:2560
    v_and_or_b32 v56, s69, v53, v54
    v_and_or_b32 v57, s69, v53, v55
    s_cbranch_vccz K_IT2
    s_branch K_FX2
K_CHA2:
K_STA6:
    s_branch K_STA10
K_CHB2:
K_STB6:
    s_branch K_STB10
K_TL1:
    s_waitcnt vmcnt(8) lgkmcnt(8)
    v_cmp_u_f32 vcc, v84, v88
    v_and_or_b32 v56, s69, v53, v54
    v_and_or_b32 v57, s69, v53, v55
    s_cbranch_vccz K_IT2
    s_branch K_FX2
K_DX1:
    s_and_b32 s51, s66, s67
    s_and_b32 s51, s51, s68
    s_and_b32 s51, s51, s69
    s_cmp_lt_i32 s51, 0
    s_cbranch_scc1 K_P2_MM
K_FX1:
    s_cmp_lt_i32 s66, 0
    s_cbranch_scc1 K_SK1
    v_max_u32 v2, v76, v80
    v_cmp_eq_u32 vcc, -1, v2
    s_cbranch_vccz K_IT1
    s_sub_u32 s71, s71, 1
    s_cbranch_scc1 K_IT1
    s_lshr_b32 s51, s66, 12
    s_bitset1_b32 s70, s51
K_SK1:
    s_and_b32 s33, s50, s70
    s_cbranch_scc0 K_NUL1
K_BK1:
    s_ff1_i32_b32 s51, s33
    s_lshl_b32 s65, s51, 12
    buffer_load_dwordx4 v[68:71], v52, s[20:23], s65 offen offset:0 sc1
    buffer_load_dwordx4 v[72:75], v52, s[20:23], s65 offen offset:512 sc1
    s_bitset0_b32 s70, s51
K_RD1:
    ds_read_b64_tr_b16 v[156:157], v56 offset:0
    ds_read_b64_tr_b16 v[158:159], v56 offset:512
    ds_read_b64_tr_b16 v[160:161], v56 offset:2048
    ds_read_b64_tr_b16 v[162:163], v56 offset:2560
    ds_read_b64_tr_b16 v[164:165], v57 offset:0
    ds_read_b64_tr_b16 v[166:167], v57 offset:512
    ds_read_b64_tr_b16 v[168:169], v57 offset:2048
    ds_read_b64_tr_b16 v[170:171], v57 offset:2560
    s_cmp_lt_i32 s67, 0
    s_cbranch_scc0 K_TL1
    v_and_or_b32 v56, s69, v53, v54
    v_and_or_b32 v57, s69, v53, v55
    s_branch K_SK2
K_NUL1:
    s_and_b32 s51, s64, s67
    s_and_b32 s51, s51, s68
    s_and_b32 s51, s51, s69
    s_cmp_lt_i32 s51, 0
    s_cbranch_scc0 K_PC1
    s_cmp_eq_u32 s70, 0
    s_cbranch_scc1 K_P2_MM
    s_branch K_SPN
K_PC1:
    s_cmp_eq_u32 s70, 0
    s_cbranch_scc1 K_NI1
    ds_read_b32 v59, v58
    s_waitcnt lgkmcnt(0)
    v_readfirstlane_b32 s50, v59
    s_and_b32 s33, s50, s70
    s_cbranch_scc1 K_BK1
    ds_read_b32 v59, v58
    s_waitcnt lgkmcnt(0)
    v_readfirstlane_b32 s50, v59
    s_and_b32 s33, s50, s70
    s_cbranch_scc1 K_BK1
K_NI1:
    s_mov_b32 s65, -1
    v_mov_b32 v68, -1
    buffer_load_dword v3, v52, s[20:23], s65 offen
    buffer_load_dword v3, v52, s[20:23], s65 offen
    s_branch K_RD1
K_RF2:
    s_cmp_eq_u32 s70, 0
    s_cbranch_scc1 K_DM2
    ds_read_b32 v59, v58
    s_waitcnt lgkmcnt(0)
    v_readfirstlane_b32 s50, v59
    s_and_b32 s33, s50, s70
    s_cbranch_scc1 K_RB2
    v_mfma_f32_32x32x16_bf16 v[124:139], v[148:151], v[84:87], v[124:139]
    s_mov_b32 s66, -1
    v_mov_b32 v76, -1
    buffer_load_dword v3, v52, s[20:23], s66 offen
    ds_read_b64_tr_b16 v[176:177], v56 offset:2048
    ds_read_b64_tr_b16 v[178:179], v56 offset:2560
    v_mfma_f32_32x32x16_bf16 v[108:123], v[144:147], v[88:91], v[108:123]
    buffer_load_dword v3, v52, s[20:23], s66 offen
    ds_read_b64_tr_b16 v[180:181], v57 offset:0
    ds_read_b64_tr_b16 v[182:183], v57 offset:512
    s_waitcnt vmcnt(8) lgkmcnt(6)
    v_cmp_u_f32 vcc, v92, v96
    v_mfma_f32_32x32x16_bf16 v[124:139], v[152:155], v[88:91], v[124:139]
    ds_read_b64_tr_b16 v[184:185], v57 offset:2048
    ds_read_b64_tr_b16 v[186:187], v57 offset:2560
    s_branch K_PG4
.p2align 12
K_CHA3:
K_STA7:
    s_branch K_STA11
K_CHB3:
K_STB7:
    s_branch K_STB11
K_PG4:
    v_and_or_b32 v56, s64, v53, v54
    v_and_or_b32 v57, s64, v53, v55
    s_cbranch_vccz K_IT3
    s_branch K_FX3
K_TL2:
    s_waitcnt vmcnt(8) lgkmcnt(8)
    v_cmp_u_f32 vcc, v92, v96
    v_and_or_b32 v56, s64, v53, v54
    v_and_or_b32 v57, s64, v53, v55
    s_cbranch_vccz K_IT3
    s_branch K_FX3
K_DX2:
    s_and_b32 s51, s64, s67
    s_and_b32 s51, s51, s68
    s_and_b32 s51, s51, s69
    s_cmp_lt_i32 s51, 0
    s_cbranch_scc1 K_P2_MM
K_FX2:
    s_cmp_lt_i32 s67, 0
    s_cbranch_scc1 K_SK2
    v_max_u32 v2, v84, v88
    v_cmp_eq_u32 vcc, -1, v2
    s_cbranch_vccz K_IT2
    s_sub_u32 s71, s71, 1
    s_cbranch_scc1 K_IT2
    s_lshr_b32 s51, s67, 12
    s_bitset1_b32 s70, s51
K_SK2:
    s_and_b32 s33, s50, s70
    s_cbranch_scc0 K_NUL2
K_BK2:
    s_ff1_i32_b32 s51, s33
    s_lshl_b32 s66, s51, 12
    buffer_load_dwordx4 v[76:79], v52, s[20:23], s66 offen offset:0 sc1
    buffer_load_dwordx4 v[80:83], v52, s[20:23], s66 offen offset:512 sc1
    s_bitset0_b32 s70, s51
K_RD2:
    ds_read_b64_tr_b16 v[172:173], v56 offset:0
    ds_read_b64_tr_b16 v[174:175], v56 offset:512
    ds_read_b64_tr_b16 v[176:177], v56 offset:2048
    ds_read_b64_tr_b16 v[178:179], v56 offset:2560
    ds_read_b64_tr_b16 v[180:181], v57 offset:0
    ds_read_b64_tr_b16 v[182:183], v57 offset:512
    ds_read_b64_tr_b16 v[184:185], v57 offset:2048
    ds_read_b64_tr_b16 v[186:187], v57 offset:2560
    s_cmp_lt_i32 s68, 0
    s_cbranch_scc0 K_TL2
    v_and_or_b32 v56, s64, v53, v54
    v_and_or_b32 v57, s64, v53, v55
    s_branch K_SK3
K_NUL2:
    s_and_b32 s51, s64, s65
    s_and_b32 s51, s51, s68
    s_and_b32 s51, s51, s69
    s_cmp_lt_i32 s51, 0
    s_cbranch_scc0 K_PC2
    s_cmp_eq_u32 s70, 0
    s_cbranch_scc1 K_P2_MM
    s_branch K_SPN
K_PC2:
    s_cmp_eq_u32 s70, 0
    s_cbranch_scc1 K_NI2
    ds_read_b32 v59, v58
    s_waitcnt lgkmcnt(0)
    v_readfirstlane_b32 s50, v59
    s_and_b32 s33, s50, s70
    s_cbranch_scc1 K_BK2
    ds_read_b32 v59, v58
    s_waitcnt lgkmcnt(0)
    v_readfirstlane_b32 s50, v59
    s_and_b32 s33, s50, s70
    s_cbranch_scc1 K_BK2
K_NI2:
    s_mov_b32 s66, -1
    v_mov_b32 v76, -1
    buffer_load_dword v3, v52, s[20:23], s66 offen
    buffer_load_dword v3, v52, s[20:23], s66 offen
    s_branch K_RD2
K_RF3:
    s_cmp_eq_u32 s70, 0
    s_cbranch_scc1 K_DM3
    ds_read_b32 v59, v58
    s_waitcnt lgkmcnt(0)
    v_readfirstlane_b32 s50, v59
    s_and_b32 s33, s50, s70
    s_cbranch_scc1 K_RB3
    v_mfma_f32_32x32x16_bf16 v[124:139], v[164:167], v[92:95], v[124:139]
    s_mov_b32 s67, -1
    v_mov_b32 v84, -1
    buffer_load_dword v3, v52, s[20:23], s67 offen
    ds_read_b64_tr_b16 v[144:145], v56 offset:2048
    ds_read_b64_tr_b16 v[146:147], v56 offset:2560
    v_mfma_f32_32x32x16_bf16 v[108:123], v[160:163], v[96:99], v[108:123]
    buffer_load_dword v3, v52, s[20:23], s67 offen
    ds_read_b64_tr_b16 v[148:149], v57 offset:0
    ds_read_b64_tr_b16 v[150:151], v57 offset:512
    s_waitcnt vmcnt(8) lgkmcnt(6)
    v_cmp_u_f32 vcc, v100, v104
    v_mfma_f32_32x32x16_bf16 v[124:139], v[168:171], v[96:99], v[124:139]
    ds_read_b64_tr_b16 v[152:153], v57 offset:2048
    ds_read_b64_tr_b16 v[154:155], v57 offset:2560
    v_and_or_b32 v56, s65, v53, v54
    v_and_or_b32 v57, s65, v53, v55
    s_cbranch_vccz K_IT4
    s_branch K_FX4
K_STA8:
    s_branch K_STA12
K_STB8:
    s_branch K_STB12
K_TL3:
    s_waitcnt vmcnt(8) lgkmcnt(8)
    v_cmp_u_f32 vcc, v100, v104
    v_and_or_b32 v56, s65, v53, v54
    v_and_or_b32 v57, s65, v53, v55
    s_cbranch_vccz K_IT4
    s_branch K_FX4
K_DX3:
    s_and_b32 s51, s64, s65
    s_and_b32 s51, s51, s68
    s_and_b32 s51, s51, s69
    s_cmp_lt_i32 s51, 0
    s_cbranch_scc1 K_P2_MM
K_FX3:
    s_cmp_lt_i32 s68, 0
    s_cbranch_scc1 K_SK3
    v_max_u32 v2, v92, v96
    v_cmp_eq_u32 vcc, -1, v2
    s_cbranch_vccz K_IT3
    s_sub_u32 s71, s71, 1
    s_cbranch_scc1 K_IT3
    s_lshr_b32 s51, s68, 12
    s_bitset1_b32 s70, s51
K_SK3:
    s_and_b32 s33, s50, s70
    s_cbranch_scc0 K_NUL3
K_BK3:
    s_ff1_i32_b32 s51, s33
    s_lshl_b32 s67, s51, 12
    buffer_load_dwordx4 v[84:87], v52, s[20:23], s67 offen offset:0 sc1
    buffer_load_dwordx4 v[88:91], v52, s[20:23], s67 offen offset:512 sc1
    s_bitset0_b32 s70, s51
K_RD3:
    ds_read_b64_tr_b16 v[140:141], v56 offset:0
    ds_read_b64_tr_b16 v[142:143], v56 offset:512
    ds_read_b64_tr_b16 v[144:145], v56 offset:2048
    ds_read_b64_tr_b16 v[146:147], v56 offset:2560
    ds_read_b64_tr_b16 v[148:149], v57 offset:0
    ds_read_b64_tr_b16 v[150:151], v57 offset:512
    ds_read_b64_tr_b16 v[152:153], v57 offset:2048
    ds_read_b64_tr_b16 v[154:155], v57 offset:2560
    s_cmp_lt_i32 s69, 0
    s_cbranch_scc0 K_TL3
    v_and_or_b32 v56, s65, v53, v54
    v_and_or_b32 v57, s65, v53, v55
    s_branch K_SK4
K_NUL3:
    s_and_b32 s51, s64, s65
    s_and_b32 s51, s51, s66
    s_and_b32 s51, s51, s69
    s_cmp_lt_i32 s51, 0
    s_cbranch_scc0 K_PC3
    s_cmp_eq_u32 s70, 0
    s_cbranch_scc1 K_P2_MM
    s_branch K_SPN
K_PC3:
    s_cmp_eq_u32 s70, 0
    s_cbranch_scc1 K_NI3
    ds_read_b32 v59, v58
    s_waitcnt lgkmcnt(0)
    v_readfirstlane_b32 s50, v59
    s_and_b32 s33, s50, s70
    s_cbranch_scc1 K_BK3
    ds_read_b32 v59, v58
    s_waitcnt lgkmcnt(0)
    v_readfirstlane_b32 s50, v59
    s_and_b32 s33, s50, s70
    s_cbranch_scc1 K_BK3
K_NI3:
    s_mov_b32 s67, -1
    v_mov_b32 v84, -1
    buffer_load_dword v3, v52, s[20:23], s67 offen
    buffer_load_dword v3, v52, s[20:23], s67 offen
    s_branch K_RD3
K_RF4:
    s_cmp_eq_u32 s70, 0
    s_cbranch_scc1 K_DM4
    ds_read_b32 v59, v58
    s_waitcnt lgkmcnt(0)
    v_readfirstlane_b32 s50, v59
    s_and_b32 s33, s50, s70
    s_cbranch_scc1 K_RB4
    v_mfma_f32_32x32x16_bf16 v[124:139], v[180:183], v[100:103], v[124:139]
    s_mov_b32 s68, -1
    v_mov_b32 v92, -1
    buffer_load_dword v3, v52, s[20:23], s68 offen
    ds_read_b64_tr_b16 v[160:161], v56 offset:2048
    ds_read_b64_tr_b16 v[162:163], v56 offset:2560
    v_mfma_f32_32x32x16_bf16 v[108:123], v[176:179], v[104:107], v[108:123]
    buffer_load_dword v3, v52, s[20:23], s68 offen
    ds_read_b64_tr_b16 v[164:165], v57 offset:0
    ds_read_b64_tr_b16 v[166:167], v57 offset:512
    s_waitcnt vmcnt(8) lgkmcnt(6)
    v_cmp_u_f32 vcc, v60, v64
    v_mfma_f32_32x32x16_bf16 v[124:139], v[184:187], v[104:107], v[124:139]
    ds_read_b64_tr_b16 v[168:169], v57 offset:2048
    ds_read_b64_tr_b16 v[170:171], v57 offset:2560
    v_and_or_b32 v56, s66, v53, v54
    v_and_or_b32 v57, s66, v53, v55
    s_cbranch_vccz K_IT5
    s_branch K_FX5
K_TL4:
    s_waitcnt vmcnt(8) lgkmcnt(8)
    v_cmp_u_f32 vcc, v60, v64
    v_and_or_b32 v56, s66, v53, v54
    v_and_or_b32 v57, s66, v53, v55
    s_cbranch_vccz K_IT5
    s_branch K_FX5
K_STA9:
    s_branch K_STA13
K_STB9:
    s_branch K_STB13
K_DX4:
    s_and_b32 s51, s64, s65
    s_and_b32 s51, s51, s66
    s_and_b32 s51, s51, s69
    s_cmp_lt_i32 s51, 0
    s_cbranch_scc1 K_P2_MM
K_FX4:
    s_cmp_lt_i32 s69, 0
    s_cbranch_scc1 K_SK4
    v_max_u32 v2, v100, v104
    v_cmp_eq_u32 vcc, -1, v2
    s_cbranch_vccz K_IT4
    s_sub_u32 s71, s71, 1
    s_cbranch_scc1 K_IT4
    s_lshr_b32 s51, s69, 12
    s_bitset1_b32 s70, s51
K_SK4:
    s_and_b32 s33, s50, s70
    s_cbranch_scc0 K_NUL4
K_BK4:
    s_ff1_i32_b32 s51, s33
    s_lshl_b32 s68, s51, 12
    buffer_load_dwordx4 v[92:95], v52, s[20:23], s68 offen offset:0 sc1
    buffer_load_dwordx4 v[96:99], v52, s[20:23], s68 offen offset:512 sc1
    s_bitset0_b32 s70, s51
K_RD4:
    ds_read_b64_tr_b16 v[156:157], v56 offset:0
    ds_read_b64_tr_b16 v[158:159], v56 offset:512
    ds_read_b64_tr_b16 v[160:161], v56 offset:2048
    ds_read_b64_tr_b16 v[162:163], v56 offset:2560
    ds_read_b64_tr_b16 v[164:165], v57 offset:0
    ds_read_b64_tr_b16 v[166:167], v57 offset:512
    ds_read_b64_tr_b16 v[168:169], v57 offset:2048
    ds_read_b64_tr_b16 v[170:171], v57 offset:2560
    s_cmp_lt_i32 s64, 0
    s_cbranch_scc0 K_TL4
    v_and_or_b32 v56, s66, v53, v54
    v_and_or_b32 v57, s66, v53, v55
    s_branch K_SK5
K_NUL4:
    s_and_b32 s51, s64, s65
    s_and_b32 s51, s51, s66
    s_and_b32 s51, s51, s67
    s_cmp_lt_i32 s51, 0
    s_cbranch_scc0 K_PC4
    s_cmp_eq_u32 s70, 0
    s_cbranch_scc1 K_P2_MM
    s_branch K_SPN
K_PC4:
    s_cmp_eq_u32 s70, 0
    s_cbranch_scc1 K_NI4
    ds_read_b32 v59, v58
    s_waitcnt lgkmcnt(0)
    v_readfirstlane_b32 s50, v59
    s_and_b32 s33, s50, s70
    s_cbranch_scc1 K_BK4
    ds_read_b32 v59, v58
    s_waitcnt lgkmcnt(0)
    v_readfirstlane_b32 s50, v59
    s_and_b32 s33, s50, s70
    s_cbranch_scc1 K_BK4
K_NI4:
    s_mov_b32 s68, -1
    v_mov_b32 v92, -1
    buffer_load_dword v3, v52, s[20:23], s68 offen
    buffer_load_dword v3, v52, s[20:23], s68 offen
    s_branch K_RD4
K_RF5:
    s_cmp_eq_u32 s70, 0
    s_cbranch_scc1 K_DM5
    ds_read_b32 v59, v58
    s_waitcnt lgkmcnt(0)
    v_readfirstlane_b32 s50, v59
    s_and_b32 s33, s50, s70
    s_cbranch_scc1 K_RB5
    v_mfma_f32_32x32x16_bf16 v[124:139], v[148:151], v[60:63], v[124:139]
    s_mov_b32 s69, -1
    v_mov_b32 v100, -1
    buffer_load_dword v3, v52, s[20:23], s69 offen
    ds_read_b64_tr_b16 v[176:177], v56 offset:2048
    ds_read_b64_tr_b16 v[178:179], v56 offset:2560
    v_mfma_f32_32x32x16_bf16 v[108:123], v[144:147], v[64:67], v[108:123]
    buffer_load_dword v3, v52, s[20:23], s69 offen
    ds_read_b64_tr_b16 v[180:181], v57 offset:0
    ds_read_b64_tr_b16 v[182:183], v57 offset:512
    s_waitcnt vmcnt(8) lgkmcnt(6)
    v_cmp_u_f32 vcc, v68, v72
    v_mfma_f32_32x32x16_bf16 v[124:139], v[152:155], v[64:67], v[124:139]
    ds_read_b64_tr_b16 v[184:185], v57 offset:2048
    ds_read_b64_tr_b16 v[186:187], v57 offset:2560
    v_and_or_b32 v56, s67, v53, v54
    v_and_or_b32 v57, s67, v53, v55
    s_cbranch_vccz K_IT0
    s_branch K_FX0
K_TL5:
    s_waitcnt vmcnt(8) lgkmcnt(8)
    v_cmp_u_f32 vcc, v68, v72
    v_and_or_b32 v56, s67, v53, v54
    v_and_or_b32 v57, s67, v53, v55
    s_cbranch_vccz K_IT0
    s_branch K_FX0
K_DX5:
    s_and_b32 s51, s64, s65
    s_and_b32 s51, s51, s66
    s_and_b32 s51, s51, s67
    s_cmp_lt_i32 s51, 0
    s_cbranch_scc1 K_P2_MM
K_FX5:
    s_cmp_lt_i32 s64, 0
    s_cbranch_scc1 K_SK5
    v_max_u32 v2, v60, v64
    v_cmp_eq_u32 vcc, -1, v2
    s_cbranch_vccz K_IT5
    s_sub_u32 s71, s71, 1
    s_cbranch_scc1 K_IT5
    s_lshr_b32 s51, s64, 12
    s_bitset1_b32 s70, s51
K_SK5:
    s_and_b32 s33, s50, s70
    s_cbranch_scc0 K_NUL5
K_BK5:
    s_ff1_i32_b32 s51, s33
    s_lshl_b32 s69, s51, 12
    buffer_load_dwordx4 v[100:103], v52, s[20:23], s69 offen offset:0 sc1
    buffer_load_dwordx4 v[104:107], v52, s[20:23], s69 offen offset:512 sc1
    s_bitset0_b32 s70, s51
K_RD5:
    ds_read_b64_tr_b16 v[172:173], v56 offset:0
    ds_read_b64_tr_b16 v[174:175], v56 offset:512
    ds_read_b64_tr_b16 v[176:177], v56 offset:2048
    ds_read_b64_tr_b16 v[178:179], v56 offset:2560
    ds_read_b64_tr_b16 v[180:181], v57 offset:0
    ds_read_b64_tr_b16 v[182:183], v57 offset:512
    ds_read_b64_tr_b16 v[184:185], v57 offset:2048
    ds_read_b64_tr_b16 v[186:187], v57 offset:2560
    s_cmp_lt_i32 s65, 0
    s_cbranch_scc0 K_TL5
    v_and_or_b32 v56, s67, v53, v54
    v_and_or_b32 v57, s67, v53, v55
    s_branch K_SK0
K_STA10:
    s_branch K_STA14
K_STB10:
    s_branch K_STB14
K_NUL5:
    s_and_b32 s51, s65, s66
    s_and_b32 s51, s51, s67
    s_and_b32 s51, s51, s68
    s_cmp_lt_i32 s51, 0
    s_cbranch_scc0 K_PC5
    s_cmp_eq_u32 s70, 0
    s_cbranch_scc1 K_P2_MM
    s_branch K_SPN
K_PC5:
    s_cmp_eq_u32 s70, 0
    s_cbranch_scc1 K_NI5
    ds_read_b32 v59, v58
    s_waitcnt lgkmcnt(0)
    v_readfirstlane_b32 s50, v59
    s_and_b32 s33, s50, s70
    s_cbranch_scc1 K_BK5
    ds_read_b32 v59, v58
    s_waitcnt lgkmcnt(0)
    v_readfirstlane_b32 s50, v59
    s_and_b32 s33, s50, s70
    s_cbranch_scc1 K_BK5
K_NI5:
    s_mov_b32 s69, -1
    v_mov_b32 v100, -1
    buffer_load_dword v3, v52, s[20:23], s69 offen
    buffer_load_dword v3, v52, s[20:23], s69 offen
    s_branch K_RD5
K_P2_MM:
    v_cvt_pk_bf16_f32 v188, v108, v109
    v_cvt_pk_bf16_f32 v189, v110, v111
    ds_write_b64 v50, v[188:189] offset:0
    v_cvt_pk_bf16_f32 v190, v112, v113
    v_cvt_pk_bf16_f32 v191, v114, v115
    ds_write_b64 v50, v[190:191] offset:16
    v_cvt_pk_bf16_f32 v192, v116, v117
    v_cvt_pk_bf16_f32 v193, v118, v119
    ds_write_b64 v50, v[192:193] offset:32
    v_cvt_pk_bf16_f32 v194, v120, v121
    v_cvt_pk_bf16_f32 v195, v122, v123
    ds_write_b64 v50, v[194:195] offset:48
    v_cvt_pk_bf16_f32 v188, v124, v125
    v_cvt_pk_bf16_f32 v189, v126, v127
    ds_write_b64 v50, v[188:189] offset:64
    v_cvt_pk_bf16_f32 v190, v128, v129
    v_cvt_pk_bf16_f32 v191, v130, v131
    ds_write_b64 v50, v[190:191] offset:80
    v_cvt_pk_bf16_f32 v192, v132, v133
    v_cvt_pk_bf16_f32 v193, v134, v135
    ds_write_b64 v50, v[192:193] offset:96
    v_cvt_pk_bf16_f32 v194, v136, v137
    v_cvt_pk_bf16_f32 v195, v138, v139
    ds_write_b64 v50, v[194:195] offset:112
K_P2_E2:
    s_waitcnt vmcnt(0) lgkmcnt(0)
    s_lshl_b32 s72, s61, 4
    s_barrier
    ds_read_b64 v[28:29], v15
    ds_read_b64 v[24:25], v11
    ds_read_b128 v[48:51], v14
    ds_read_b64 v[26:27], v11 offset:64
    ds_read_b128 v[52:55], v14 offset:1152
    s_waitcnt lgkmcnt(4)
    v_readfirstlane_b32 s48, v28
    v_readfirstlane_b32 s49, v29
    s_sub_u32 s3, s48, s72
    s_cmp_lt_u32 s3, 16
    s_cbranch_scc1 K_YROW0
K_NOY0:
    s_sub_u32 s3, s49, s72
    s_cmp_lt_u32 s3, 16
    s_cbranch_scc1 K_YROW1
K_NOY1:
    s_waitcnt lgkmcnt(3)
    v_pk_mul_f32 v[32:33], v[32:33], v[24:25] op_sel:[0,1] op_sel_hi:[1,1]
    v_pk_mul_f32 v[34:35], v[34:35], v[24:25] op_sel:[0,1] op_sel_hi:[1,1]
    v_pk_mul_f32 v[36:37], v[36:37], v[24:25] op_sel:[0,1] op_sel_hi:[1,1]
    v_pk_mul_f32 v[38:39], v[38:39], v[24:25] op_sel:[0,1] op_sel_hi:[1,1]
    s_waitcnt lgkmcnt(2)
    v_lshlrev_b32 v68, 16, v48
    v_and_b32 v69, 0xffff0000, v48
    v_pk_fma_f32 v[68:69], v[68:69], v[24:25], v[32:33] op_sel_hi:[1,0,1]
    v_cvt_pk_bf16_f32 v48, v68, v69
    v_lshlrev_b32 v70, 16, v49
    v_and_b32 v71, 0xffff0000, v49
    v_pk_fma_f32 v[70:71], v[70:71], v[24:25], v[34:35] op_sel_hi:[1,0,1]
    v_cvt_pk_bf16_f32 v49, v70, v71
    v_lshlrev_b32 v68, 16, v50
    v_and_b32 v69, 0xffff0000, v50
    v_pk_fma_f32 v[68:69], v[68:69], v[24:25], v[36:37] op_sel_hi:[1,0,1]
    v_cvt_pk_bf16_f32 v50, v68, v69
    v_lshlrev_b32 v70, 16, v51
    v_and_b32 v71, 0xffff0000, v51
    v_pk_fma_f32 v[70:71], v[70:71], v[24:25], v[38:39] op_sel_hi:[1,0,1]
    v_cvt_pk_bf16_f32 v51, v70, v71
    buffer_store_dwordx4 v[48:51], v10, s[56:59], 0 offen sc1
    s_waitcnt lgkmcnt(1)
    v_pk_mul_f32 v[40:41], v[40:41], v[26:27] op_sel:[0,1] op_sel_hi:[1,1]
    v_pk_mul_f32 v[42:43], v[42:43], v[26:27] op_sel:[0,1] op_sel_hi:[1,1]
    v_pk_mul_f32 v[44:45], v[44:45], v[26:27] op_sel:[0,1] op_sel_hi:[1,1]
    v_pk_mul_f32 v[46:47], v[46:47], v[26:27] op_sel:[0,1] op_sel_hi:[1,1]
    s_waitcnt lgkmcnt(0)
    v_lshlrev_b32 v68, 16, v52
    v_and_b32 v69, 0xffff0000, v52
    v_pk_fma_f32 v[68:69], v[68:69], v[26:27], v[40:41] op_sel_hi:[1,0,1]
    v_cvt_pk_bf16_f32 v52, v68, v69
    v_lshlrev_b32 v70, 16, v53
    v_and_b32 v71, 0xffff0000, v53
    v_pk_fma_f32 v[70:71], v[70:71], v[26:27], v[42:43] op_sel_hi:[1,0,1]
    v_cvt_pk_bf16_f32 v53, v70, v71
    v_lshlrev_b32 v68, 16, v54
    v_and_b32 v69, 0xffff0000, v54
    v_pk_fma_f32 v[68:69], v[68:69], v[26:27], v[44:45] op_sel_hi:[1,0,1]
    v_cvt_pk_bf16_f32 v54, v68, v69
    v_lshlrev_b32 v70, 16, v55
    v_and_b32 v71, 0xffff0000, v55
    v_pk_fma_f32 v[70:71], v[70:71], v[26:27], v[46:47] op_sel_hi:[1,0,1]
    v_cvt_pk_bf16_f32 v55, v70, v71
    buffer_store_dwordx4 v[52:55], v10, s[56:59], s63 offen sc1
K_END:
K_EXIT:
    s_endpgm
K_YROW0:
    v_and_b32 v2, 7, v1
    v_lshlrev_b32 v2, 5, v2
    v_add_u32 v2, 158976, v2
    ds_read_b128 v[56:59], v2
    ds_read_b128 v[60:63], v2 offset:16
    s_and_b32 s33, s3, 7
    v_cmp_eq_u32 vcc, s33, v8
    s_cmp_ge_u32 s3, 8
    s_cbranch_scc1 K_YR1_0
    s_waitcnt lgkmcnt(0)
    v_add_f32 v64, v32, v56
    v_cvt_pk_bf16_f32 v64, v64, v64
    v_lshlrev_b32 v64, 16, v64
    v_cndmask_b32 v32, v32, v64, vcc
    v_add_f32 v65, v33, v57
    v_cvt_pk_bf16_f32 v65, v65, v65
    v_lshlrev_b32 v65, 16, v65
    v_cndmask_b32 v33, v33, v65, vcc
    v_add_f32 v66, v34, v58
    v_cvt_pk_bf16_f32 v66, v66, v66
    v_lshlrev_b32 v66, 16, v66
    v_cndmask_b32 v34, v34, v66, vcc
    v_add_f32 v67, v35, v59
    v_cvt_pk_bf16_f32 v67, v67, v67
    v_lshlrev_b32 v67, 16, v67
    v_cndmask_b32 v35, v35, v67, vcc
    v_add_f32 v64, v36, v60
    v_cvt_pk_bf16_f32 v64, v64, v64
    v_lshlrev_b32 v64, 16, v64
    v_cndmask_b32 v36, v36, v64, vcc
    v_add_f32 v65, v37, v61
    v_cvt_pk_bf16_f32 v65, v65, v65
    v_lshlrev_b32 v65, 16, v65
    v_cndmask_b32 v37, v37, v65, vcc
    v_add_f32 v66, v38, v62
    v_cvt_pk_bf16_f32 v66, v66, v66
    v_lshlrev_b32 v66, 16, v66
    v_cndmask_b32 v38, v38, v66, vcc
    v_add_f32 v67, v39, v63
    v_cvt_pk_bf16_f32 v67, v67, v67
    v_lshlrev_b32 v67, 16, v67
    v_cndmask_b32 v39, v39, v67, vcc
    s_branch K_NOY0
K_YR1_0:
    s_waitcnt lgkmcnt(0)
    v_add_f32 v64, v40, v56
    v_cvt_pk_bf16_f32 v64, v64, v64
    v_lshlrev_b32 v64, 16, v64
    v_cndmask_b32 v40, v40, v64, vcc
    v_add_f32 v65, v41, v57
    v_cvt_pk_bf16_f32 v65, v65, v65
    v_lshlrev_b32 v65, 16, v65
    v_cndmask_b32 v41, v41, v65, vcc
    v_add_f32 v66, v42, v58
    v_cvt_pk_bf16_f32 v66, v66, v66
    v_lshlrev_b32 v66, 16, v66
    v_cndmask_b32 v42, v42, v66, vcc
    v_add_f32 v67, v43, v59
    v_cvt_pk_bf16_f32 v67, v67, v67
    v_lshlrev_b32 v67, 16, v67
    v_cndmask_b32 v43, v43, v67, vcc
    v_add_f32 v64, v44, v60
    v_cvt_pk_bf16_f32 v64, v64, v64
    v_lshlrev_b32 v64, 16, v64
    v_cndmask_b32 v44, v44, v64, vcc
    v_add_f32 v65, v45, v61
    v_cvt_pk_bf16_f32 v65, v65, v65
    v_lshlrev_b32 v65, 16, v65
    v_cndmask_b32 v45, v45, v65, vcc
    v_add_f32 v66, v46, v62
    v_cvt_pk_bf16_f32 v66, v66, v66
    v_lshlrev_b32 v66, 16, v66
    v_cndmask_b32 v46, v46, v66, vcc
    v_add_f32 v67, v47, v63
    v_cvt_pk_bf16_f32 v67, v67, v67
    v_lshlrev_b32 v67, 16, v67
    v_cndmask_b32 v47, v47, v67, vcc
    s_branch K_NOY0
K_YROW1:
    v_and_b32 v2, 7, v1
    v_lshlrev_b32 v2, 5, v2
    v_add_u32 v2, 159232, v2
    ds_read_b128 v[56:59], v2
    ds_read_b128 v[60:63], v2 offset:16
    s_and_b32 s33, s3, 7
    v_cmp_eq_u32 vcc, s33, v8
    s_cmp_ge_u32 s3, 8
    s_cbranch_scc1 K_YR1_1
    s_waitcnt lgkmcnt(0)
    v_add_f32 v64, v32, v56
    v_cvt_pk_bf16_f32 v64, v64, v64
    v_lshlrev_b32 v64, 16, v64
    v_cndmask_b32 v32, v32, v64, vcc
    v_add_f32 v65, v33, v57
    v_cvt_pk_bf16_f32 v65, v65, v65
    v_lshlrev_b32 v65, 16, v65
    v_cndmask_b32 v33, v33, v65, vcc
    v_add_f32 v66, v34, v58
    v_cvt_pk_bf16_f32 v66, v66, v66
    v_lshlrev_b32 v66, 16, v66
    v_cndmask_b32 v34, v34, v66, vcc
    v_add_f32 v67, v35, v59
    v_cvt_pk_bf16_f32 v67, v67, v67
    v_lshlrev_b32 v67, 16, v67
    v_cndmask_b32 v35, v35, v67, vcc
    v_add_f32 v64, v36, v60
    v_cvt_pk_bf16_f32 v64, v64, v64
    v_lshlrev_b32 v64, 16, v64
    v_cndmask_b32 v36, v36, v64, vcc
    v_add_f32 v65, v37, v61
    v_cvt_pk_bf16_f32 v65, v65, v65
    v_lshlrev_b32 v65, 16, v65
    v_cndmask_b32 v37, v37, v65, vcc
    v_add_f32 v66, v38, v62
    v_cvt_pk_bf16_f32 v66, v66, v66
    v_lshlrev_b32 v66, 16, v66
    v_cndmask_b32 v38, v38, v66, vcc
    v_add_f32 v67, v39, v63
    v_cvt_pk_bf16_f32 v67, v67, v67
    v_lshlrev_b32 v67, 16, v67
    v_cndmask_b32 v39, v39, v67, vcc
    s_branch K_NOY1
K_YR1_1:
    s_waitcnt lgkmcnt(0)
    v_add_f32 v64, v40, v56
    v_cvt_pk_bf16_f32 v64, v64, v64
    v_lshlrev_b32 v64, 16, v64
    v_cndmask_b32 v40, v40, v64, vcc
    v_add_f32 v65, v41, v57
    v_cvt_pk_bf16_f32 v65, v65, v65
    v_lshlrev_b32 v65, 16, v65
    v_cndmask_b32 v41, v41, v65, vcc
    v_add_f32 v66, v42, v58
    v_cvt_pk_bf16_f32 v66, v66, v66
    v_lshlrev_b32 v66, 16, v66
    v_cndmask_b32 v42, v42, v66, vcc
    v_add_f32 v67, v43, v59
    v_cvt_pk_bf16_f32 v67, v67, v67
    v_lshlrev_b32 v67, 16, v67
    v_cndmask_b32 v43, v43, v67, vcc
    v_add_f32 v64, v44, v60
    v_cvt_pk_bf16_f32 v64, v64, v64
    v_lshlrev_b32 v64, 16, v64
    v_cndmask_b32 v44, v44, v64, vcc
    v_add_f32 v65, v45, v61
    v_cvt_pk_bf16_f32 v65, v65, v65
    v_lshlrev_b32 v65, 16, v65
    v_cndmask_b32 v45, v45, v65, vcc
    v_add_f32 v66, v46, v62
    v_cvt_pk_bf16_f32 v66, v66, v66
    v_lshlrev_b32 v66, 16, v66
    v_cndmask_b32 v46, v46, v66, vcc
    v_add_f32 v67, v47, v63
    v_cvt_pk_bf16_f32 v67, v67, v67
    v_lshlrev_b32 v67, 16, v67
    v_cndmask_b32 v47, v47, v67, vcc
    s_branch K_NOY1
K_STA11:
    s_branch K_STA15
K_STB11:
    s_branch K_STB15
K_P2:
    s_cmp_ge_u32 s30, 4
    s_cbranch_scc1 K_P2_HELP
    s_lshl_b32 s62, s40, 7
    v_lshrrev_b32 v8, 3, v1
    v_lshrrev_b32 v9, 4, v1
    v_mov_b32 v15, 158720
    s_lshl_b32 s61, s40, 3
    s_add_u32 s61, s61, s30
    s_mul_i32 s3, s61, 20480
    s_lshl_b32 s33, s41, 7
    s_add_u32 s3, s3, s33
    v_and_b32 v2, 7, v1
    v_lshlrev_b32 v2, 4, v2
    v_mul_u32_u24 v4, 1280, v8
    v_add3_u32 v10, v2, v4, s3
    s_lshl_b32 s3, s30, 7
    s_add_u32 s3, s3, 159744
    v_lshl_add_u32 v11, v8, 3, s3
    s_mov_b32 s63, 10240
    s_add_u32 s20, s6, 0x100000
    s_addc_u32 s21, s7, 0
    s_mov_b32 s22, 0x280000
    s_mov_b32 s23, 0x20000
    s_mov_b32 s56, s10
    s_mov_b32 s57, s11
    s_mov_b32 s58, 0x280000
    s_mov_b32 s59, 0x20000
    v_mul_u32_u24 v3, 144, v8
    v_add_u32 v3, v2, v3
    s_mul_i32 s3, s30, 2304
    s_add_u32 s3, s3, 140288
    v_add_u32 v14, s3, v3
    buffer_load_dwordx4 v[16:19], v10, s[12:15], 0 offen
    buffer_load_dwordx4 v[20:23], v10, s[12:15], s63 offen
    v_bfe_u32 v48, v1, 2, 2
    v_and_b32 v49, 3, v1
    s_add_u32 s3, s61, s30
    s_lshr_b32 s33, s3, 2
    s_mul_i32 s33, s33, 76
    s_add_u32 s3, s3, s33
    s_lshl_b32 s3, s3, 10
    v_and_b32 v2, 15, v1
    v_lshl_add_u32 v2, v2, 4, s3
    v_lshrrev_b32 v3, 5, v1
    v_lshl_add_u32 v2, v3, 8, v2
    v_and_b32 v4, 1, v9
    v_lshl_add_u32 v52, v4, 10, v2
    v_mov_b32 v53, 0x1f000
    v_lshl_add_u32 v2, v3, 3, v48
    v_lshlrev_b32 v2, 7, v2
    v_lshl_add_u32 v2, v49, 3, v2
    v_lshl_add_u32 v2, v4, 5, v2
    v_lshrrev_b32 v4, 1, v48
    v_lshl_add_u32 v54, v4, 6, v2
    v_xor_b32 v55, 64, v54
    v_mov_b32 v56, v54
    v_mov_b32 v57, v54
    v_and_b32 v2, 31, v1
    v_mul_u32_u24 v2, 144, v2
    v_lshl_add_u32 v2, v3, 3, v2
    s_mul_i32 s3, s30, 4608
    s_add_u32 s3, s3, 140288
    v_add_u32 v50, s3, v2
    s_and_b32 s33, s40, 3
    s_lshl_b32 s33, s33, 2
    s_lshr_b32 s33, 0xf63f, s33
    s_and_b32 s33, s33, 15
    s_lshl1_add_u32 s3, s30, 1
    s_cmp_ge_u32 s3, s33
    s_cselect_b32 s60, 24, 16
    s_cmp_gt_u32 s3, s33
    s_cselect_b32 s60, 20, s60
    v_add_u32 v58, s60, v15
    s_mov_b32 s64, -1
    s_mov_b32 s65, -1
    s_mov_b32 s66, -1
    s_mov_b32 s67, -1
    s_mov_b32 s68, -1
    s_mov_b32 s69, -1
    s_mov_b32 s70, 0xfffff
    s_mov_b32 s71, 131072
    v_mov_b32 v108, 0
    v_mov_b32 v109, 0
    v_mov_b32 v110, 0
    v_mov_b32 v111, 0
    v_mov_b32 v112, 0
    v_mov_b32 v113, 0
    v_mov_b32 v114, 0
    v_mov_b32 v115, 0
    v_mov_b32 v116, 0
    v_mov_b32 v117, 0
    v_mov_b32 v118, 0
    v_mov_b32 v119, 0
    v_mov_b32 v120, 0
    v_mov_b32 v121, 0
    v_mov_b32 v122, 0
    v_mov_b32 v123, 0
    v_mov_b32 v124, 0
    v_mov_b32 v125, 0
    v_mov_b32 v126, 0
    v_mov_b32 v127, 0
    v_mov_b32 v128, 0
    v_mov_b32 v129, 0
    v_mov_b32 v130, 0
    v_mov_b32 v131, 0
    v_mov_b32 v132, 0
    v_mov_b32 v133, 0
    v_mov_b32 v134, 0
    v_mov_b32 v135, 0
    v_mov_b32 v136, 0
    v_mov_b32 v137, 0
    v_mov_b32 v138, 0
    v_mov_b32 v139, 0
K_P2_AUXW:
    v_lshrrev_b32 v2, 3, v1
    v_mul_u32_u24 v2, 1280, v2
    v_lshrrev_b32 v3, 2, v1
    v_and_b32 v3, 4, v3
    v_and_b32 v4, 7, v1
    v_xor_b32 v3, v3, v4
    v_lshl_add_u32 v2, v3, 4, v2
    s_lshl_b32 s33, s41, 7
    v_add_u32 v51, s33, v2
    v_lshrrev_b32 v5, 5, v1
    v_mul_u32_u24 v5, 20480, v5
    v_add_u32 v5, v5, v51
    s_lshl_b32 s52, s30, 2
    s_lshr_b32 s52, 0x7520, s52
    s_and_b32 s52, s52, 7
    s_mul_i32 s52, s52, 51200
    s_lshl_b32 s53, s30, 12
    s_add_u32 s60, s52, 0
    s_add_u32 m0, s53, 0
    s_waitcnt vmcnt(5)
    buffer_load_dwordx4 v51, s[24:27], s60 offen lds
    s_add_u32 s60, s52, 10240
    s_add_u32 m0, s53, 1024
    s_waitcnt vmcnt(5)
    buffer_load_dwordx4 v51, s[24:27], s60 offen lds
    s_add_u32 s60, s52, 25600
    s_add_u32 m0, s53, 2048
    s_waitcnt vmcnt(5)
    buffer_load_dwordx4 v51, s[24:27], s60 offen lds
    s_add_u32 s60, s52, 35840
    s_add_u32 m0, s53, 3072
    s_waitcnt vmcnt(5)
    buffer_load_dwordx4 v51, s[24:27], s60 offen lds
    s_add_u32 s60, s52, 409600
    s_add_u32 m0, s53, 20480
    s_waitcnt vmcnt(5)
    buffer_load_dwordx4 v51, s[24:27], s60 offen lds
    s_add_u32 s60, s52, 419840
    s_add_u32 m0, s53, 21504
    s_waitcnt vmcnt(5)
    buffer_load_dwordx4 v51, s[24:27], s60 offen lds
    v_mov_b32 v3, 1
    s_mov_b64 exec, 1
    s_branch K_PG5
.p2align 12
K_STA12:
    s_branch K_WRET_A
K_STB12:
    s_branch K_WRET_B
K_PG5:
    ds_add_u32 v15, v3 offset:52
    s_mov_b64 exec, -1
    s_add_u32 s60, s52, 435200
    s_add_u32 m0, s53, 22528
    s_waitcnt vmcnt(5)
    buffer_load_dwordx4 v51, s[24:27], s60 offen lds
    s_add_u32 s60, s52, 445440
    s_add_u32 m0, s53, 23552
    s_waitcnt vmcnt(5)
    buffer_load_dwordx4 v51, s[24:27], s60 offen lds
    s_lshl_b32 s53, s30, 10
    s_add_u32 s60, s52, 20480
    s_add_u32 m0, s53, 16384
    s_waitcnt vmcnt(5)
    buffer_load_dwordx4 v5, s[24:27], s60 offen lds
    s_add_u32 s60, s52, 430080
    s_add_u32 m0, s53, 36864
    s_waitcnt vmcnt(5)
    buffer_load_dwordx4 v5, s[24:27], s60 offen lds
    s_cmp_eq_u32 s30, 0
    s_cbranch_scc1 K_CHA0
    s_cmp_eq_u32 s30, 1
    s_cbranch_scc1 K_CHA1
    s_cmp_eq_u32 s30, 2
    s_cbranch_scc1 K_CHA2
    s_branch K_CHA3
K_WRET_A:
    v_mov_b32 v3, 1
    s_waitcnt vmcnt(0)
    s_mov_b64 exec, 1
    ds_add_u32 v15, v3 offset:44
    s_mov_b64 exec, -1
    s_mov_b32 s3, 1048576
K_P2_GWA:
    ds_read_b32 v2, v15 offset:44
    s_sub_u32 s3, s3, 1
    s_waitcnt lgkmcnt(0)
    v_readfirstlane_b32 s33, v2
    s_nop 3
    s_cselect_b32 s33, 4, s33
    s_cmp_lt_u32 s33, 4
    s_cbranch_scc1 K_P2_GWA
    s_branch K_P2_GEMM
K_P2_HELP:
    s_setprio 3
    s_cmp_eq_u32 s30, 7
    s_cbranch_scc1 K_P2_W7
    s_cmp_eq_u32 s30, 4
    s_cbranch_scc1 K_P2_NL
    s_cmp_ge_u32 s29, 8
    s_cbranch_scc1 K_P2_NL
    s_mov_b32 s24, s8
    s_mov_b32 s25, s9
    s_mov_b32 s26, 0xc8000
    s_mov_b32 s27, 0x20000
    v_lshrrev_b32 v2, 3, v1
    v_mul_u32_u24 v2, 1280, v2
    v_lshrrev_b32 v3, 2, v1
    v_and_b32 v3, 4, v3
    v_and_b32 v4, 7, v1
    v_xor_b32 v3, v3, v4
    v_lshl_add_u32 v2, v3, 4, v2
    s_lshl_b32 s33, s41, 7
    v_add_u32 v12, s33, v2
    v_lshrrev_b32 v5, 5, v1
    v_mul_u32_u24 v5, 20480, v5
    v_add_u32 v5, v5, v12
    s_sub_u32 s61, s30, 5
    s_lshl_b32 s52, s61, 2
    s_lshr_b32 s52, 0x6431, s52
    s_and_b32 s52, s52, 7
    s_mul_i32 s52, s52, 51200
    s_lshl_b32 s53, s61, 12
    s_add_u32 s60, s52, 0
    s_add_u32 m0, s53, 40960
    s_nop 0
    buffer_load_dwordx4 v12, s[24:27], s60 offen lds
    s_add_u32 s60, s52, 10240
    s_add_u32 m0, s53, 41984
    s_nop 0
    buffer_load_dwordx4 v12, s[24:27], s60 offen lds
    s_add_u32 s60, s52, 25600
    s_add_u32 m0, s53, 43008
    s_nop 0
    buffer_load_dwordx4 v12, s[24:27], s60 offen lds
    s_add_u32 s60, s52, 35840
    s_add_u32 m0, s53, 44032
    s_nop 0
    buffer_load_dwordx4 v12, s[24:27], s60 offen lds
    s_add_u32 s60, s52, 409600
    s_add_u32 m0, s53, 61440
    s_nop 0
    buffer_load_dwordx4 v12, s[24:27], s60 offen lds
    s_add_u32 s60, s52, 419840
    s_add_u32 m0, s53, 62464
    s_nop 0
    buffer_load_dwordx4 v12, s[24:27], s60 offen lds
    s_add_u32 s60, s52, 435200
    s_add_u32 m0, s53, 63488
    s_nop 0
    buffer_load_dwordx4 v12, s[24:27], s60 offen lds
    s_add_u32 s60, s52, 445440
    s_add_u32 m0, s53, 64512
    s_nop 0
    buffer_load_dwordx4 v12, s[24:27], s60 offen lds
    s_lshl_b32 s53, s61, 10
    s_add_u32 s60, s52, 20480
    s_add_u32 m0, s53, 57344
    s_nop 0
    buffer_load_dwordx4 v5, s[24:27], s60 offen lds
    s_add_u32 s60, s52, 430080
    s_add_u32 m0, s53, 77824
    s_nop 0
    buffer_load_dwordx4 v5, s[24:27], s60 offen lds
    s_add_u32 s61, s61, 2
    s_lshl_b32 s52, s61, 2
    s_lshr_b32 s52, 0x6431, s52
    s_and_b32 s52, s52, 7
    s_mul_i32 s52, s52, 51200
    s_lshl_b32 s53, s61, 12
    s_add_u32 s60, s52, 0
    s_add_u32 m0, s53, 40960
    s_nop 0
    buffer_load_dwordx4 v12, s[24:27], s60 offen lds
    s_add_u32 s60, s52, 10240
    s_add_u32 m0, s53, 41984
    s_nop 0
    buffer_load_dwordx4 v12, s[24:27], s60 offen lds
    s_add_u32 s60, s52, 25600
    s_add_u32 m0, s53, 43008
    s_nop 0
    buffer_load_dwordx4 v12, s[24:27], s60 offen lds
    s_add_u32 s60, s52, 35840
    s_add_u32 m0, s53, 44032
    s_nop 0
    buffer_load_dwordx4 v12, s[24:27], s60 offen lds
    s_add_u32 s60, s52, 409600
    s_add_u32 m0, s53, 61440
    s_nop 0
    buffer_load_dwordx4 v12, s[24:27], s60 offen lds
    s_add_u32 s60, s52, 419840
    s_add_u32 m0, s53, 62464
    s_nop 0
    buffer_load_dwordx4 v12, s[24:27], s60 offen lds
    s_add_u32 s60, s52, 435200
    s_add_u32 m0, s53, 63488
    s_nop 0
    buffer_load_dwordx4 v12, s[24:27], s60 offen lds
    s_add_u32 s60, s52, 445440
    s_add_u32 m0, s53, 64512
    s_nop 0
    buffer_load_dwordx4 v12, s[24:27], s60 offen lds
    s_lshl_b32 s53, s61, 10
    s_add_u32 s60, s52, 20480
    s_add_u32 m0, s53, 57344
    s_nop 0
    buffer_load_dwordx4 v5, s[24:27], s60 offen lds
    s_add_u32 s60, s52, 430080
    s_add_u32 m0, s53, 77824
    s_nop 0
    buffer_load_dwordx4 v5, s[24:27], s60 offen lds
    v_mov_b32 v2, 158720
    v_mov_b32 v3, 1
    s_waitcnt vmcnt(0)
    s_mov_b64 exec, 1
    ds_add_u32 v2, v3 offset:56
    s_mov_b64 exec, -1
K_P2_NL:
    s_lshl_b32 s62, s40, 7
    v_lshrrev_b32 v8, 3, v1
    v_lshrrev_b32 v9, 4, v1
    v_mov_b32 v15, 158720
    s_lshl_b32 s61, s40, 3
    s_add_u32 s61, s61, s30
    s_mul_i32 s3, s61, 20480
    s_lshl_b32 s33, s41, 7
    s_add_u32 s3, s3, s33
    v_and_b32 v2, 7, v1
    v_lshlrev_b32 v2, 4, v2
    v_mul_u32_u24 v4, 1280, v8
    v_add3_u32 v10, v2, v4, s3
    s_lshl_b32 s3, s30, 7
    s_add_u32 s3, s3, 159744
    v_lshl_add_u32 v11, v8, 3, s3
    s_mov_b32 s63, 10240
    s_add_u32 s20, s6, 0x100000
    s_addc_u32 s21, s7, 0
    s_mov_b32 s22, 0x280000
    s_mov_b32 s23, 0x20000
    s_mov_b32 s56, s10
    s_mov_b32 s57, s11
    s_mov_b32 s58, 0x280000
    s_mov_b32 s59, 0x20000
    v_mul_u32_u24 v3, 144, v8
    v_add_u32 v3, v2, v3
    s_mul_i32 s3, s30, 2304
    s_add_u32 s3, s3, 140288
    v_add_u32 v14, s3, v3
    s_add_u32 s44, s6, 0x10000
    s_addc_u32 s45, s7, 0
    s_mov_b32 s46, 0x43800
    s_mov_b32 s47, 0x20000
    v_mov_b32 v108, 1
    buffer_load_dwordx4 v[16:19], v10, s[12:15], 0 offen
    buffer_load_dwordx4 v[20:23], v10, s[12:15], s63 offen
    s_cmp_lg_u32 s30, 6
    s_cbranch_scc1 K_P2_HW
    s_mov_b32 s3, 131072
    s_waitcnt vmcnt(2)
K_P2_DPOLL:
    v_min_u32 v2, v7, v6
    v_cmp_eq_u32 vcc, 0, v2
    s_cbranch_vccz K_P2_DOK
    s_cmp_eq_u32 s3, 131072
    s_cbranch_scc1 K_P2_DNS
    s_sleep 12
K_P2_DNS:
    v_lshl_add_u32 v13, v1, 2, s42
    global_load_dword v7, v13, s[6:7] offset:256 sc1
    v_and_b32 v13, 0xfffffe04, v13
    global_load_dword v6, v13, s[6:7] offset:128 sc1
    s_sub_u32 s3, s3, 1
    s_waitcnt vmcnt(0)
    s_cmp_lg_u32 s3, 0
    s_cbranch_scc1 K_P2_DPOLL
K_P2_DOK:
    v_readlane_b32 s52, v6, 0
    v_readlane_b32 s53, v6, 1
    s_nop 1
    s_and_b32 s3, s52, 0x7ff
    s_sub_u32 s3, 2047, s3
    v_mov_b32 v48, s3
    v_mov_b32 v4, s52
    v_and_b32 v4, 0xffff0000, v4
    v_ashrrev_i32 v5, 31, v4
    v_not_b32 v5, v5
    v_or_b32 v5, 0x80000000, v5
    v_xor_b32 v4, v4, v5
    v_and_b32 v4, 0xffff0000, v4
    v_mul_f32 v5, 0xbfb8aa3b, v4
    v_exp_f32 v5, v5
    s_nop 0
    v_add_f32 v5, 1.0, v5
    v_rcp_f32 v4, v5
    s_nop 0
    v_cvt_pk_bf16_f32 v50, v4, v4
    v_lshlrev_b32 v50, 16, v50
    s_and_b32 s3, s53, 0x7ff
    s_sub_u32 s3, 2047, s3
    v_mov_b32 v49, s3
    v_mov_b32 v4, s53
    v_and_b32 v4, 0xffff0000, v4
    v_ashrrev_i32 v5, 31, v4
    v_not_b32 v5, v5
    v_or_b32 v5, 0x80000000, v5
    v_xor_b32 v4, v4, v5
    v_and_b32 v4, 0xffff0000, v4
    v_mul_f32 v5, 0xbfb8aa3b, v4
    v_exp_f32 v5, v5
    s_nop 0
    v_add_f32 v5, 1.0, v5
    v_rcp_f32 v4, v5
    s_nop 0
    v_cvt_pk_bf16_f32 v51, v4, v4
    v_lshlrev_b32 v51, 16, v51
    ds_write_b128 v15, v[48:51]
    ds_write_b32 v15, v108 offset:40
    v_lshl_add_u32 v13, v1, 4, v15
    v_lshlrev_b32 v52, 16, v7
    v_and_b32 v52, 0x7fff0000, v52
    v_and_b32 v54, 0x7fff0000, v7
    v_sub_f32 v53, 1.0, v52
    v_cvt_pk_bf16_f32 v53, v53, v53
    v_lshlrev_b32 v53, 16, v53
    v_sub_f32 v55, 1.0, v54
    v_cvt_pk_bf16_f32 v55, v55, v55
    v_lshlrev_b32 v55, 16, v55
    ds_write_b128 v13, v[52:55] offset:1024
    s_branch K_P2_E
K_STA13:
    s_branch K_WRET_A
K_STB13:
    s_branch K_WRET_B
K_P2_HW:
    s_mov_b32 s3, 1048576
K_P2_GS2:
    ds_read_b32 v2, v15 offset:40
    s_sleep 1
    s_sub_u32 s3, s3, 1
    s_waitcnt lgkmcnt(0)
    v_readfirstlane_b32 s33, v2
    s_nop 3
    s_cselect_b32 s33, 1, s33
    s_cmp_lt_u32 s33, 1
    s_cbranch_scc1 K_P2_GS2
    ds_read_b128 v[28:31], v15
    s_waitcnt lgkmcnt(0)
    s_cmp_eq_u32 s30, 4
    s_cselect_b64 vcc, -1, 0
    s_nop 1
    v_cndmask_b32 v2, v29, v28, vcc
    v_cndmask_b32 v5, v31, v30, vcc
    s_nop 0
    v_readfirstlane_b32 s52, v2
    s_nop 3
    s_sub_u32 s3, s52, s62
    s_cmp_lt_u32 s3, 128
    s_cbranch_scc0 K_P2_E
    s_mov_b32 s3, 131072
K_P2_YPOLL:
    s_load_dword s33, s[6:7], s42 offset:136 glc
    s_waitcnt lgkmcnt(0)
    s_cmp_lg_u32 s33, 0
    s_cbranch_scc1 K_P2_YGO
    s_sleep 4
    s_sub_u32 s3, s3, 1
    s_cbranch_scc0 K_P2_YPOLL
K_P2_YGO:
    v_and_b32 v2, 15, v1
    v_lshlrev_b32 v2, 4, v2
    v_mul_u32_u24 v4, 5120, v9
    s_sub_u32 s53, s30, 4
    s_mul_i32 s33, s53, 2560
    s_lshl_b32 s3, s41, 8
    s_add_u32 s3, s3, s33
    v_add3_u32 v3, v2, v4, s3
    s_mov_b32 s60, 0
    buffer_load_dwordx4 v[52:55], v3, s[44:47], s60 offen sc1
    s_mov_b32 s60, 20480
    buffer_load_dwordx4 v[56:59], v3, s[44:47], s60 offen sc1
    s_mov_b32 s60, 40960
    buffer_load_dwordx4 v[60:63], v3, s[44:47], s60 offen sc1
    s_mov_b32 s60, 61440
    buffer_load_dwordx4 v[64:67], v3, s[44:47], s60 offen sc1
    s_mov_b32 s60, 81920
    buffer_load_dwordx4 v[68:71], v3, s[44:47], s60 offen sc1
    s_mov_b32 s60, 102400
    buffer_load_dwordx4 v[72:75], v3, s[44:47], s60 offen sc1
    s_mov_b32 s60, 122880
    buffer_load_dwordx4 v[76:79], v3, s[44:47], s60 offen sc1
    s_mov_b32 s60, 143360
    buffer_load_dwordx4 v[80:83], v3, s[44:47], s60 offen sc1
    s_mov_b32 s60, 163840
    buffer_load_dwordx4 v[84:87], v3, s[44:47], s60 offen sc1
    s_mov_b32 s60, 184320
    buffer_load_dwordx4 v[88:91], v3, s[44:47], s60 offen sc1
    s_mov_b32 s60, 204800
    buffer_load_dwordx4 v[92:95], v3, s[44:47], s60 offen sc1
    s_mov_b32 s60, 225280
    buffer_load_dwordx4 v[96:99], v3, s[44:47], s60 offen sc1
    s_mov_b32 s60, 245760
    buffer_load_dwordx4 v[100:103], v3, s[44:47], s60 offen sc1
    s_mov_b32 s60, 266240
    buffer_load_dwordx4 v[104:107], v3, s[44:47], s60 offen sc1
    s_waitcnt vmcnt(12)
    v_add_f32 v48, v52, v56
    v_add_f32 v49, v53, v57
    v_add_f32 v50, v54, v58
    v_add_f32 v51, v55, v59
    s_waitcnt vmcnt(11)
    v_add_f32 v48, v48, v60
    v_add_f32 v49, v49, v61
    v_add_f32 v50, v50, v62
    v_add_f32 v51, v51, v63
    s_waitcnt vmcnt(10)
    v_add_f32 v48, v48, v64
    v_add_f32 v49, v49, v65
    v_add_f32 v50, v50, v66
    v_add_f32 v51, v51, v67
    s_waitcnt vmcnt(9)
    v_add_f32 v48, v48, v68
    v_add_f32 v49, v49, v69
    v_add_f32 v50, v50, v70
    v_add_f32 v51, v51, v71
    s_waitcnt vmcnt(8)
    v_add_f32 v48, v48, v72
    v_add_f32 v49, v49, v73
    v_add_f32 v50, v50, v74
    v_add_f32 v51, v51, v75
    s_waitcnt vmcnt(7)
    v_add_f32 v48, v48, v76
    v_add_f32 v49, v49, v77
    v_add_f32 v50, v50, v78
    v_add_f32 v51, v51, v79
    s_waitcnt vmcnt(6)
    v_add_f32 v48, v48, v80
    v_add_f32 v49, v49, v81
    v_add_f32 v50, v50, v82
    v_add_f32 v51, v51, v83
    s_waitcnt vmcnt(5)
    v_add_f32 v48, v48, v84
    v_add_f32 v49, v49, v85
    v_add_f32 v50, v50, v86
    v_add_f32 v51, v51, v87
    s_waitcnt vmcnt(4)
    v_add_f32 v48, v48, v88
    v_add_f32 v49, v49, v89
    v_add_f32 v50, v50, v90
    v_add_f32 v51, v51, v91
    s_waitcnt vmcnt(3)
    v_add_f32 v48, v48, v92
    v_add_f32 v49, v49, v93
    v_add_f32 v50, v50, v94
    v_add_f32 v51, v51, v95
    s_waitcnt vmcnt(2)
    v_add_f32 v48, v48, v96
    v_add_f32 v49, v49, v97
    v_add_f32 v50, v50, v98
    v_add_f32 v51, v51, v99
    s_waitcnt vmcnt(1)
    v_add_f32 v48, v48, v100
    v_add_f32 v49, v49, v101
    v_add_f32 v50, v50, v102
    v_add_f32 v51, v51, v103
    s_waitcnt vmcnt(0)
    v_add_f32 v48, v48, v104
    v_add_f32 v49, v49, v105
    v_add_f32 v50, v50, v106
    v_add_f32 v51, v51, v107
    v_mov_b32 v52, v48
    v_mov_b32 v53, v49
    v_mov_b32 v54, v50
    v_mov_b32 v55, v51
    s_nop 0
    v_permlane16_swap_b32 v48, v52
    v_permlane16_swap_b32 v49, v53
    v_permlane16_swap_b32 v50, v54
    v_permlane16_swap_b32 v51, v55
    v_add_f32 v48, v48, v52
    v_add_f32 v49, v49, v53
    v_add_f32 v50, v50, v54
    v_add_f32 v51, v51, v55
    v_mov_b32 v52, v48
    v_mov_b32 v53, v49
    v_mov_b32 v54, v50
    v_mov_b32 v55, v51
    s_nop 0
    v_permlane32_swap_b32 v48, v52
    v_permlane32_swap_b32 v49, v53
    v_permlane32_swap_b32 v50, v54
    v_permlane32_swap_b32 v51, v55
    v_add_f32 v48, v48, v52
    v_add_f32 v49, v49, v53
    v_add_f32 v50, v50, v54
    v_add_f32 v51, v51, v55
    v_cvt_pk_bf16_f32 v48, v48, v48
    v_lshlrev_b32 v48, 16, v48
    v_mul_f32 v48, v5, v48
    v_cvt_pk_bf16_f32 v48, v48, v48
    v_lshlrev_b32 v48, 16, v48
    v_cvt_pk_bf16_f32 v49, v49, v49
    v_lshlrev_b32 v49, 16, v49
    v_mul_f32 v49, v5, v49
    v_cvt_pk_bf16_f32 v49, v49, v49
    v_lshlrev_b32 v49, 16, v49
    v_cvt_pk_bf16_f32 v50, v50, v50
    v_lshlrev_b32 v50, 16, v50
    v_mul_f32 v50, v5, v50
    v_cvt_pk_bf16_f32 v50, v50, v50
    v_lshlrev_b32 v50, 16, v50
    v_cvt_pk_bf16_f32 v51, v51, v51
    v_lshlrev_b32 v51, 16, v51
    v_mul_f32 v51, v5, v51
    v_cvt_pk_bf16_f32 v51, v51, v51
    v_lshlrev_b32 v51, 16, v51
    s_lshl_b32 s3, s53, 8
    s_add_u32 s3, s3, 158976
    v_add_u32 v2, s3, v2
    ds_write_b128 v2, v[48:51]
    s_branch K_P2_E
K_STA14:
    s_branch K_WRET_A
K_STB14:
    s_branch K_WRET_B
K_P2_W7:
    s_mov_b32 s37, s42
    s_waitcnt lgkmcnt(0)
    s_load_dwordx2 s[48:49], s[6:7], s37 glc
    s_add_u32 s53, s40, 1
    s_and_b32 s53, s53, 2
    s_mov_b32 s46, 0x84210
    s_mov_b32 s47, s46
    v_mov_b32 v15, 158720
    v_mov_b32 v5, 0
    v_mov_b32 v48, 0x80000000
    s_mov_b64 exec, 1
    ds_or_b32 v15, v48 offset:16
    ds_or_b32 v15, v48 offset:20
    ds_or_b32 v15, v48 offset:24
    s_waitcnt lgkmcnt(0)
    s_cmp_eq_u32 s53, 0
    s_cselect_b32 s49, s48, s49
    s_lshl_b64 s[50:51], s[48:49], 1
    s_and_b64 s[50:51], s[50:51], s[48:49]
    s_lshl_b64 vcc, s[50:51], 2
    s_and_b64 s[50:51], s[50:51], vcc
    s_lshl_b64 s[50:51], s[50:51], 1
    s_and_b64 s[50:51], s[50:51], s[46:47]
    s_or_b64 s[48:49], s[48:49], s[50:51]
    v_readfirstlane_b32 s52, v5
    s_cmp_ge_u32 s52, 2
    s_cselect_b32 s52, -1, 0x3ff
    s_and_b32 s48, s48, s52
    s_and_b32 s49, s49, s52
    s_and_b32 s52, s48, s49
    v_mov_b32 v48, s48
    v_mov_b32 v49, s49
    v_mov_b32 v50, s52
    s_mov_b64 exec, 1
    ds_or_b64 v15, v[48:49] offset:16
    ds_or_b32 v15, v50 offset:24
    s_mov_b64 exec, -1
    s_load_dwordx2 s[48:49], s[6:7], s37 glc
    s_lshl_b32 s62, s40, 7
    v_lshrrev_b32 v8, 3, v1
    v_lshrrev_b32 v9, 4, v1
    v_mov_b32 v15, 158720
    s_lshl_b32 s61, s40, 3
    s_add_u32 s61, s61, s30
    s_mul_i32 s3, s61, 20480
    s_lshl_b32 s33, s41, 7
    s_add_u32 s3, s3, s33
    v_and_b32 v2, 7, v1
    v_lshlrev_b32 v2, 4, v2
    v_mul_u32_u24 v4, 1280, v8
    v_add3_u32 v10, v2, v4, s3
    s_lshl_b32 s3, s30, 7
    s_add_u32 s3, s3, 159744
    v_lshl_add_u32 v11, v8, 3, s3
    s_mov_b32 s63, 10240
    s_add_u32 s20, s6, 0x100000
    s_addc_u32 s21, s7, 0
    s_mov_b32 s22, 0x280000
    s_mov_b32 s23, 0x20000
    s_mov_b32 s56, s10
    s_mov_b32 s57, s11
    s_mov_b32 s58, 0x280000
    s_mov_b32 s59, 0x20000
    v_mul_u32_u24 v3, 144, v8
    v_add_u32 v3, v2, v3
    s_mul_i32 s3, s30, 2304
    s_add_u32 s3, s3, 140288
    v_add_u32 v14, s3, v3
    buffer_load_dwordx4 v[16:19], v10, s[12:15], 0 offen
    buffer_load_dwordx4 v[20:23], v10, s[12:15], s63 offen
    s_mov_b32 s3, 131072
    s_waitcnt lgkmcnt(0)
K_P2_FP:
    s_load_dwordx2 s[44:45], s[6:7], s37 glc
    s_cmp_eq_u32 s53, 0
    s_cselect_b32 s49, s48, s49
    s_lshl_b64 s[50:51], s[48:49], 1
    s_and_b64 s[50:51], s[50:51], s[48:49]
    s_lshl_b64 vcc, s[50:51], 2
    s_and_b64 s[50:51], s[50:51], vcc
    s_lshl_b64 s[50:51], s[50:51], 1
    s_and_b64 s[50:51], s[50:51], s[46:47]
    s_or_b64 s[48:49], s[48:49], s[50:51]
    v_readfirstlane_b32 s52, v5
    s_cmp_ge_u32 s52, 2
    s_cselect_b32 s52, -1, 0x3ff
    s_and_b32 s48, s48, s52
    s_and_b32 s49, s49, s52
    s_and_b32 s52, s48, s49
    v_mov_b32 v48, s48
    v_mov_b32 v49, s49
    v_mov_b32 v50, s52
    s_mov_b64 exec, 1
    ds_or_b64 v15, v[48:49] offset:16
    ds_or_b32 v15, v50 offset:24
    s_mov_b64 exec, -1
    ds_read_b32 v5, v15 offset:56
    s_cmp_eq_u32 s52, 0xfffff
    s_cbranch_scc1 K_P2_FGO
    s_cmp_lg_u64 s[48:49], 0
    s_cbranch_scc1 K_P2_FS2
    s_sleep 8
K_P2_FS2:
    s_sub_u32 s3, s3, 1
    s_waitcnt lgkmcnt(0)
    s_mov_b64 s[48:49], s[44:45]
    s_cbranch_scc0 K_P2_FP
    s_mov_b32 s3, 0
K_P2_FCHK:
    s_cmp_eq_u32 s53, 0
    s_cselect_b32 s49, s48, s49
    s_lshl_b64 s[50:51], s[48:49], 1
    s_and_b64 s[50:51], s[50:51], s[48:49]
    s_lshl_b64 vcc, s[50:51], 2
    s_and_b64 s[50:51], s[50:51], vcc
    s_lshl_b64 s[50:51], s[50:51], 1
    s_and_b64 s[50:51], s[50:51], s[46:47]
    s_or_b64 s[48:49], s[48:49], s[50:51]
    v_readfirstlane_b32 s52, v5
    s_cmp_ge_u32 s52, 2
    s_cselect_b32 s52, -1, 0x3ff
    s_and_b32 s48, s48, s52
    s_and_b32 s49, s49, s52
    s_and_b32 s52, s48, s49
    v_mov_b32 v48, s48
    v_mov_b32 v49, s49
    v_mov_b32 v50, s52
    s_mov_b64 exec, 1
    ds_or_b64 v15, v[48:49] offset:16
    ds_or_b32 v15, v50 offset:24
    s_mov_b64 exec, -1
    s_cmp_eq_u32 s52, 0xfffff
    s_cbranch_scc1 K_P2_FGO
    s_cmp_lg_u64 s[48:49], 0
    s_cbranch_scc1 K_P2_FS
    s_sleep 8
K_P2_FS:
    s_sleep 2
    s_load_dwordx2 s[48:49], s[6:7], s37 glc
    ds_read_b32 v5, v15 offset:56
    s_sub_u32 s3, s3, 1
    s_waitcnt lgkmcnt(0)
    s_cbranch_scc0 K_P2_FCHK
    v_mov_b32 v48, -1
    v_mov_b32 v49, -1
    v_mov_b32 v50, -1
    ds_write_b96 v15, v[48:50] offset:16
K_P2_FGO:
K_P2_E:
    s_setprio 0
    s_waitcnt vmcnt(0)
    v_lshlrev_b32 v32, 16, v16
    v_and_b32 v33, 0xffff0000, v16
    v_lshlrev_b32 v34, 16, v17
    v_and_b32 v35, 0xffff0000, v17
    v_lshlrev_b32 v36, 16, v18
    v_and_b32 v37, 0xffff0000, v18
    v_lshlrev_b32 v38, 16, v19
    v_and_b32 v39, 0xffff0000, v19
    v_lshlrev_b32 v40, 16, v20
    v_and_b32 v41, 0xffff0000, v20
    v_lshlrev_b32 v42, 16, v21
    v_and_b32 v43, 0xffff0000, v21
    v_lshlrev_b32 v44, 16, v22
    v_and_b32 v45, 0xffff0000, v22
    v_lshlrev_b32 v46, 16, v23
    v_and_b32 v47, 0xffff0000, v23
    s_branch K_P2_E2
K_STA15:
    s_branch K_WRET_A
K_STB15:
    s_branch K_WRET_B
K_SPN:
    s_mov_b32 s64, -1
    s_mov_b32 s65, -1
    s_mov_b32 s66, -1
    s_mov_b32 s67, -1
    s_mov_b32 s68, -1
    s_mov_b32 s69, -1
K_SPL:
    ds_read_b32 v59, v58
    s_waitcnt lgkmcnt(0)
    v_readfirstlane_b32 s50, v59
    s_and_b32 s33, s50, s70
    s_cbranch_scc1 K_BK0
    s_cmp_lt_i32 s50, 0
    s_cbranch_scc0 K_SPG
    s_sleep 1
    s_branch K_SPL
K_SPG:
    s_load_dwordx2 s[48:49], s[6:7], s42 glc
    ds_read_b32 v5, v15 offset:56
    s_waitcnt lgkmcnt(0)
    s_cmp_eq_u32 s53, 0
    s_cselect_b32 s49, s48, s49
    s_lshl_b64 s[50:51], s[48:49], 1
    s_and_b64 s[50:51], s[50:51], s[48:49]
    s_lshl_b64 vcc, s[50:51], 2
    s_and_b64 s[50:51], s[50:51], vcc
    s_lshl_b64 s[50:51], s[50:51], 1
    s_and_b64 s[50:51], s[50:51], s[46:47]
    s_or_b64 s[48:49], s[48:49], s[50:51]
    v_readfirstlane_b32 s52, v5
    s_cmp_ge_u32 s52, 2
    s_cselect_b32 s52, -1, 0x3ff
    s_and_b32 s48, s48, s52
    s_and_b32 s49, s49, s52
    s_and_b32 s52, s48, s49
    v_mov_b32 v188, s48
    v_mov_b32 v189, s49
    v_mov_b32 v190, s52
    s_mov_b64 exec, 1
    ds_or_b64 v15, v[188:189] offset:16
    ds_or_b32 v15, v190 offset:24
    s_mov_b64 exec, -1
    ds_read_b32 v59, v58
    s_waitcnt lgkmcnt(0)
    v_readfirstlane_b32 s50, v59
    s_and_b32 s33, s50, s70
    s_cbranch_scc1 K_BK0
    s_sleep 2
    ds_read_b32 v59, v58
    s_waitcnt lgkmcnt(0)
    v_readfirstlane_b32 s50, v59
    s_and_b32 s33, s50, s70
    s_cbranch_scc1 K_BK0
    s_sleep 2
    ds_read_b32 v59, v58
    s_waitcnt lgkmcnt(0)
    v_readfirstlane_b32 s50, v59
    s_and_b32 s33, s50, s70
    s_cbranch_scc1 K_BK0
    s_sleep 2
    ds_read_b32 v59, v58
    s_waitcnt lgkmcnt(0)
    v_readfirstlane_b32 s50, v59
    s_and_b32 s33, s50, s70
    s_cbranch_scc1 K_BK0
    s_branch K_SPL
K_CHEND:
K_AUX:
    s_cmp_ge_u32 s30, 4
    s_cbranch_scc1 K_AUX_L
    s_and_b32 s3, s2, 7
    s_lshr_b32 s70, s2, 3
    s_lshl3_add_u32 s3, s3, s70
    s_lshl_b32 s3, s3, 5
    s_lshl3_add_u32 s3, s30, s3
    v_bfe_u32 v8, v0, 4, 2
    v_add_u32 v8, s3, v8
    v_and_b32 v10, 15, v0
    v_lshlrev_b32 v10, 4, v10
    v_mul_u32_u24 v9, 1280, v8
    v_add_u32 v9, v9, v10
    v_and_b32 v2, 63, v0
    v_lshlrev_b32 v2, 4, v2
    s_lshl_b32 s71, s30, 12
    s_add_u32 s71, s71, 126016
    s_mov_b32 s70, 5120
    s_mov_b32 m0, s71
    s_waitcnt lgkmcnt(0)
    s_mov_b32 s16, s44
    s_mov_b32 s17, s45
    s_mov_b32 s18, 0x500
    s_mov_b32 s19, 0x20000
    s_mov_b32 s20, s52
    s_mov_b32 s21, s53
    s_mov_b32 s22, 0x500
    s_mov_b32 s23, 0x20000
    buffer_load_dwordx4 v2, s[16:19], 0 offen lds
    buffer_load_dwordx4 v2, s[16:19], 0 offen offset:1024 lds
    s_add_u32 m0, s71, 2048
    v_add_u32 v10, s71, v10
    buffer_load_dwordx4 v2, s[20:23], 0 offen lds
    buffer_load_dwordx4 v2, s[20:23], 0 offen offset:1024 lds
    buffer_load_dwordx4 v[16:19], v9, s[12:15], 0 offen offset:0
    buffer_load_dwordx4 v[20:23], v9, s[12:15], s70 offen offset:0
    buffer_load_dwordx4 v[24:27], v9, s[12:15], 0 offen offset:256
    buffer_load_dwordx4 v[28:31], v9, s[12:15], s70 offen offset:256
    buffer_load_dwordx4 v[32:35], v9, s[12:15], 0 offen offset:512
    buffer_load_dwordx4 v[36:39], v9, s[12:15], s70 offen offset:512
    buffer_load_dwordx4 v[40:43], v9, s[12:15], 0 offen offset:768
    buffer_load_dwordx4 v[44:47], v9, s[12:15], s70 offen offset:768
    buffer_load_dwordx4 v[48:51], v9, s[12:15], 0 offen offset:1024
    buffer_load_dwordx4 v[52:55], v9, s[12:15], s70 offen offset:1024
    s_barrier
    v_and_b32 v1, 63, v0
    v_mov_b32 v7, 0
    s_and_b32 s28, s2, 7
    s_lshr_b32 s29, s2, 3
    s_xor_b32 s30, s30, 4
    s_lshr_b32 s34, s29, 3
    s_lshl_b32 s34, s34, 2
    s_and_b32 s3, s29, 3
    s_add_u32 s34, s34, s3
    s_add_u32 s34, s34, 4
    s_bitcmp1_b32 s29, 2
    s_cselect_b32 s34, -1, s34
    s_cmp_lt_u32 s29, 8
    s_cselect_b32 s34, s29, s34
    s_lshl_b32 s40, s28, 1
    s_cmp_ge_u32 s34, 10
    s_addc_u32 s40, s40, 0
    s_sub_u32 s41, s34, 10
    s_cmp_ge_u32 s34, 10
    s_cselect_b32 s41, s41, s34
    s_mul_i32 s42, s28, 20
    s_add_u32 s42, s42, s34
    s_and_b32 s42, s42, 255
    s_lshl_b32 s42, s42, 9
    s_branch K_PG6
.p2align 12
K_PG6:
    s_add_u32 s42, s42, 524288
    s_mul_i32 s43, s28, 7
    s_add_u32 s43, s43, s29
    s_sub_u32 s43, s43, 1
    s_cmp_lt_u32 s43, 54
    s_cselect_b32 s43, s43, 63
    s_cmp_eq_u32 s29, 0
    s_cselect_b32 s43, 63, s43
    s_mov_b32 s24, s8
    s_mov_b32 s25, s9
    s_mov_b32 s26, 0xc8000
    s_mov_b32 s27, 0x20000
    s_add_u32 s64, s6, 0x80000
    s_addc_u32 s65, s7, 0
    s_mov_b32 s66, 0x14400
    s_mov_b32 s67, 0x20000
    s_add_u32 s60, s6, 0x10000
    s_addc_u32 s61, s7, 0
    s_mov_b32 s62, 0x43800
    s_mov_b32 s63, 0x20000
    v_mov_b32 v96, 0
    v_mov_b32 v97, 0
    v_mov_b32 v98, 0
    v_mov_b32 v99, 0
    v_mov_b32 v13, 158720
    s_waitcnt vmcnt(10)
    ds_read_b128 v[56:59], v10 offset:0
    ds_read_b128 v[76:79], v10 offset:2048
    ds_read_b128 v[60:63], v10 offset:256
    ds_read_b128 v[80:83], v10 offset:2304
    ds_read_b128 v[64:67], v10 offset:512
    ds_read_b128 v[84:87], v10 offset:2560
    ds_read_b128 v[68:71], v10 offset:768
    ds_read_b128 v[88:91], v10 offset:2816
    ds_read_b128 v[72:75], v10 offset:1024
    ds_read_b128 v[92:95], v10 offset:3072
    s_waitcnt vmcnt(8) lgkmcnt(8)
    v_dot2c_f32_bf16 v96, v16, v56
    v_dot2c_f32_bf16 v98, v16, v76
    v_dot2c_f32_bf16 v97, v20, v56
    v_dot2c_f32_bf16 v99, v20, v76
    v_dot2c_f32_bf16 v96, v17, v57
    v_dot2c_f32_bf16 v98, v17, v77
    v_dot2c_f32_bf16 v97, v21, v57
    v_dot2c_f32_bf16 v99, v21, v77
    v_dot2c_f32_bf16 v96, v18, v58
    v_dot2c_f32_bf16 v98, v18, v78
    v_dot2c_f32_bf16 v97, v22, v58
    v_dot2c_f32_bf16 v99, v22, v78
    v_dot2c_f32_bf16 v96, v19, v59
    v_dot2c_f32_bf16 v98, v19, v79
    v_dot2c_f32_bf16 v97, v23, v59
    v_dot2c_f32_bf16 v99, v23, v79
    s_waitcnt vmcnt(6) lgkmcnt(6)
    v_dot2c_f32_bf16 v96, v24, v60
    v_dot2c_f32_bf16 v98, v24, v80
    v_dot2c_f32_bf16 v97, v28, v60
    v_dot2c_f32_bf16 v99, v28, v80
    v_dot2c_f32_bf16 v96, v25, v61
    v_dot2c_f32_bf16 v98, v25, v81
    v_dot2c_f32_bf16 v97, v29, v61
    v_dot2c_f32_bf16 v99, v29, v81
    v_dot2c_f32_bf16 v96, v26, v62
    v_dot2c_f32_bf16 v98, v26, v82
    v_dot2c_f32_bf16 v97, v30, v62
    v_dot2c_f32_bf16 v99, v30, v82
    v_dot2c_f32_bf16 v96, v27, v63
    v_dot2c_f32_bf16 v98, v27, v83
    v_dot2c_f32_bf16 v97, v31, v63
    v_dot2c_f32_bf16 v99, v31, v83
    s_waitcnt vmcnt(4) lgkmcnt(4)
    v_dot2c_f32_bf16 v96, v32, v64
    v_dot2c_f32_bf16 v98, v32, v84
    v_dot2c_f32_bf16 v97, v36, v64
    v_dot2c_f32_bf16 v99, v36, v84
    v_dot2c_f32_bf16 v96, v33, v65
    v_dot2c_f32_bf16 v98, v33, v85
    v_dot2c_f32_bf16 v97, v37, v65
    v_dot2c_f32_bf16 v99, v37, v85
    v_dot2c_f32_bf16 v96, v34, v66
    v_dot2c_f32_bf16 v98, v34, v86
    v_dot2c_f32_bf16 v97, v38, v66
    v_dot2c_f32_bf16 v99, v38, v86
    v_dot2c_f32_bf16 v96, v35, v67
    v_dot2c_f32_bf16 v98, v35, v87
    v_dot2c_f32_bf16 v97, v39, v67
    v_dot2c_f32_bf16 v99, v39, v87
    s_waitcnt vmcnt(2) lgkmcnt(2)
    v_dot2c_f32_bf16 v96, v40, v68
    v_dot2c_f32_bf16 v98, v40, v88
    v_dot2c_f32_bf16 v97, v44, v68
    v_dot2c_f32_bf16 v99, v44, v88
    v_dot2c_f32_bf16 v96, v41, v69
    v_dot2c_f32_bf16 v98, v41, v89
    v_dot2c_f32_bf16 v97, v45, v69
    v_dot2c_f32_bf16 v99, v45, v89
    v_dot2c_f32_bf16 v96, v42, v70
    v_dot2c_f32_bf16 v98, v42, v90
    v_dot2c_f32_bf16 v97, v46, v70
    v_dot2c_f32_bf16 v99, v46, v90
    v_dot2c_f32_bf16 v96, v43, v71
    v_dot2c_f32_bf16 v98, v43, v91
    v_dot2c_f32_bf16 v97, v47, v71
    v_dot2c_f32_bf16 v99, v47, v91
    s_waitcnt vmcnt(0) lgkmcnt(0)
    v_dot2c_f32_bf16 v96, v48, v72
    v_dot2c_f32_bf16 v98, v48, v92
    v_dot2c_f32_bf16 v97, v52, v72
    v_dot2c_f32_bf16 v99, v52, v92
    v_dot2c_f32_bf16 v96, v49, v73
    v_dot2c_f32_bf16 v98, v49, v93
    v_dot2c_f32_bf16 v97, v53, v73
    v_dot2c_f32_bf16 v99, v53, v93
    v_dot2c_f32_bf16 v96, v50, v74
    v_dot2c_f32_bf16 v98, v50, v94
    v_dot2c_f32_bf16 v97, v54, v74
    v_dot2c_f32_bf16 v99, v54, v94
    v_dot2c_f32_bf16 v96, v51, v75
    v_dot2c_f32_bf16 v98, v51, v95
    v_dot2c_f32_bf16 v97, v55, v75
    v_dot2c_f32_bf16 v99, v55, v95
    s_nop 2
    v_add_f32_dpp v96, v96, v96 quad_perm:[1,0,3,2] row_mask:0xf bank_mask:0xf
    v_add_f32_dpp v97, v97, v97 quad_perm:[1,0,3,2] row_mask:0xf bank_mask:0xf
    v_add_f32_dpp v98, v98, v98 quad_perm:[1,0,3,2] row_mask:0xf bank_mask:0xf
    v_add_f32_dpp v99, v99, v99 quad_perm:[1,0,3,2] row_mask:0xf bank_mask:0xf
    v_add_f32_dpp v96, v96, v96 quad_perm:[2,3,0,1] row_mask:0xf bank_mask:0xf
    v_add_f32_dpp v97, v97, v97 quad_perm:[2,3,0,1] row_mask:0xf bank_mask:0xf
    v_add_f32_dpp v98, v98, v98 quad_perm:[2,3,0,1] row_mask:0xf bank_mask:0xf
    v_add_f32_dpp v99, v99, v99 quad_perm:[2,3,0,1] row_mask:0xf bank_mask:0xf
    v_add_f32_dpp v96, v96, v96 row_half_mirror row_mask:0xf bank_mask:0xf
    v_add_f32_dpp v97, v97, v97 row_half_mirror row_mask:0xf bank_mask:0xf
    v_add_f32_dpp v98, v98, v98 row_half_mirror row_mask:0xf bank_mask:0xf
    v_add_f32_dpp v99, v99, v99 row_half_mirror row_mask:0xf bank_mask:0xf
    v_add_f32_dpp v96, v96, v96 row_mirror row_mask:0xf bank_mask:0xf
    v_add_f32_dpp v97, v97, v97 row_mirror row_mask:0xf bank_mask:0xf
    v_add_f32_dpp v98, v98, v98 row_mirror row_mask:0xf bank_mask:0xf
    v_add_f32_dpp v99, v99, v99 row_mirror row_mask:0xf bank_mask:0xf
    v_and_b32 v4, 31, v8
    v_lshlrev_b32 v11, 2, v4
    v_add_u32 v11, 122880, v11
    v_lshlrev_b32 v12, 1, v4
    v_add_u32 v12, 123008, v12
    v_cvt_pk_bf16_f32 v2, v96, v96
    v_lshlrev_b32 v2, 16, v2
    v_ashrrev_i32 v3, 31, v2
    v_or_b32 v3, 0x80000000, v3
    v_xor_b32 v2, v2, v3
    v_and_b32 v2, 0xffff0000, v2
    v_sub_u32 v3, 0x87ff, v8
    v_or_b32 v96, v2, v3
    ds_write_b32 v11, v96 offset:0
    v_cvt_pk_bf16_f32 v98, v98, v98
    v_lshlrev_b32 v98, 16, v98
    v_mul_f32 v5, 0xbfb8aa3b, v98
    v_exp_f32 v5, v5
    s_nop 0
    v_add_f32 v5, 1.0, v5
    v_rcp_f32 v98, v5
    s_nop 0
    v_cvt_pk_bf16_f32 v98, v98, v98
    v_or_b32 v98, 0x8000, v98
    ds_write_b16 v12, v98 offset:0
    v_cvt_pk_bf16_f32 v2, v97, v97
    v_lshlrev_b32 v2, 16, v2
    v_ashrrev_i32 v3, 31, v2
    v_or_b32 v3, 0x80000000, v3
    v_xor_b32 v2, v2, v3
    v_and_b32 v2, 0xffff0000, v2
    v_sub_u32 v3, 0x87fb, v8
    v_or_b32 v97, v2, v3
    ds_write_b32 v11, v97 offset:16
    v_cvt_pk_bf16_f32 v99, v99, v99
    v_lshlrev_b32 v99, 16, v99
    v_mul_f32 v5, 0xbfb8aa3b, v99
    v_exp_f32 v5, v5
    s_nop 0
    v_add_f32 v5, 1.0, v5
    v_rcp_f32 v99, v5
    s_nop 0
    v_cvt_pk_bf16_f32 v99, v99, v99
    v_or_b32 v99, 0x8000, v99
    ds_write_b16 v12, v99 offset:8
    v_mov_b32 v3, 1
    s_mov_b64 exec, 1
    ds_add_u32 v13, v3 offset:48
    s_mov_b64 exec, -1
    s_cmp_ge_u32 s30, 6
    s_cbranch_scc1 K_AUX_G1
    s_mov_b32 s3, 1048576
K_FGR:
    ds_read_b32 v2, v13 offset:48
    s_sleep 1
    s_sub_u32 s3, s3, 1
    s_waitcnt lgkmcnt(0)
    v_readfirstlane_b32 s33, v2
    s_nop 3
    s_cselect_b32 s33, 4, s33
    s_cmp_lt_u32 s33, 4
    s_cbranch_scc1 K_FGR
    s_cmp_lg_u32 s30, 4
    s_cbranch_scc1 K_AUX_G0
    v_and_b32 v3, 31, v1
    v_lshlrev_b32 v3, 2, v3
    v_add_u32 v3, 122880, v3
    ds_read_b32 v2, v3
    s_waitcnt lgkmcnt(0)
    s_nop 1
    v_max_u32_dpp v3, v2, v2 quad_perm:[1,0,3,2] row_mask:0xf bank_mask:0xf
    s_nop 1
    v_max_u32_dpp v3, v3, v3 quad_perm:[2,3,0,1] row_mask:0xf bank_mask:0xf
    s_nop 1
    v_max_u32_dpp v3, v3, v3 row_half_mirror row_mask:0xf bank_mask:0xf
    s_nop 1
    v_max_u32_dpp v3, v3, v3 row_mirror row_mask:0xf bank_mask:0xf
    s_nop 1
    v_readlane_b32 s68, v3, 0
    v_readlane_b32 s76, v3, 16
    v_readlane_b32 s77, v3, 32
    v_readlane_b32 s78, v3, 48
    s_nop 3
    s_max_u32 s68, s68, s76
    s_max_u32 s77, s77, s78
    s_max_u32 s68, s68, s77
    v_cmp_ne_u32 vcc, s68, v2
    s_nop 1
    v_cndmask_b32 v2, 0, v2, vcc
    s_nop 1
    v_max_u32_dpp v3, v2, v2 quad_perm:[1,0,3,2] row_mask:0xf bank_mask:0xf
    s_nop 1
    v_max_u32_dpp v3, v3, v3 quad_perm:[2,3,0,1] row_mask:0xf bank_mask:0xf
    s_nop 1
    v_max_u32_dpp v3, v3, v3 row_half_mirror row_mask:0xf bank_mask:0xf
    s_nop 1
    v_max_u32_dpp v3, v3, v3 row_mirror row_mask:0xf bank_mask:0xf
    s_nop 1
    v_readlane_b32 s69, v3, 0
    v_readlane_b32 s76, v3, 16
    v_readlane_b32 s77, v3, 32
    v_readlane_b32 s78, v3, 48
    s_nop 3
    s_max_u32 s69, s69, s76
    s_max_u32 s77, s77, s78
    s_max_u32 s69, s69, s77
    s_load_dword s33, s[4:5], 0
    s_waitcnt lgkmcnt(0)
    s_cmp_ge_u32 s33, 1
    s_cbranch_scc1 K_ZO3
    s_sleep 8
    s_load_dword s33, s[4:5], 64
    s_waitcnt lgkmcnt(0)
    s_cmp_ge_u32 s33, 1
    s_cbranch_scc1 K_ZO3
    s_sleep 8
    s_mov_b32 s3, 16384
K_ZB3:
    v_mov_b32 v4, 0
    global_load_dword v4, v4, s[4:5] sc1
    s_waitcnt vmcnt(0)
    v_readfirstlane_b32 s33, v4
    s_cmp_ge_u32 s33, 1
    s_cbranch_scc1 K_ZO3
    s_sleep 8
    s_sub_u32 s3, s3, 1
    s_cbranch_scc0 K_ZB3
K_ZO3:
    s_lshl_b32 s3, s2, 3
    s_add_u32 s3, s3, 606208
    s_atomic_add_x2 s[68:69], s[6:7], s3
    s_cmp_lg_u32 s2, 63
    s_cbranch_scc1 K_AUX_G1
    s_mov_b32 s70, 81920
    v_lshlrev_b32 v3, 3, v1
    s_mov_b32 s3, 131072
K_AUX_POLL:
    buffer_load_dwordx2 v[176:177], v3, s[64:67], s70 offen sc1
    s_waitcnt vmcnt(0)
    v_min_u32 v2, v176, v177
    v_cmp_eq_u32 vcc, 0, v2
    s_cbranch_vccz K_AUX_GOT
    s_sleep 2
    s_sub_u32 s3, s3, 1
    s_cmp_lg_u32 s3, 0
    s_cbranch_scc1 K_AUX_POLL
K_AUX_GOT:
    s_waitcnt lgkmcnt(0)
    s_nop 1
    v_max_u32_dpp v3, v176, v176 quad_perm:[1,0,3,2] row_mask:0xf bank_mask:0xf
    s_nop 1
    v_max_u32_dpp v3, v3, v3 quad_perm:[2,3,0,1] row_mask:0xf bank_mask:0xf
    s_nop 1
    v_max_u32_dpp v3, v3, v3 row_half_mirror row_mask:0xf bank_mask:0xf
    s_nop 1
    v_max_u32_dpp v3, v3, v3 row_mirror row_mask:0xf bank_mask:0xf
    s_nop 1
    v_readlane_b32 s68, v3, 0
    v_readlane_b32 s76, v3, 16
    v_readlane_b32 s77, v3, 32
    v_readlane_b32 s78, v3, 48
    s_nop 3
    s_max_u32 s68, s68, s76
    s_max_u32 s77, s77, s78
    s_max_u32 s68, s68, s77
    v_cmp_ne_u32 vcc, s68, v176
    s_nop 1
    v_cndmask_b32 v2, v177, v176, vcc
    s_nop 1
    v_max_u32_dpp v3, v2, v2 quad_perm:[1,0,3,2] row_mask:0xf bank_mask:0xf
    s_nop 1
    v_max_u32_dpp v3, v3, v3 quad_perm:[2,3,0,1] row_mask:0xf bank_mask:0xf
    s_nop 1
    v_max_u32_dpp v3, v3, v3 row_half_mirror row_mask:0xf bank_mask:0xf
    s_nop 1
    v_max_u32_dpp v3, v3, v3 row_mirror row_mask:0xf bank_mask:0xf
    s_nop 1
    v_readlane_b32 s69, v3, 0
    v_readlane_b32 s76, v3, 16
    v_readlane_b32 s77, v3, 32
    v_readlane_b32 s78, v3, 48
    s_nop 3
    s_max_u32 s69, s69, s76
    s_max_u32 s77, s77, s78
    s_max_u32 s69, s69, s77
    v_mov_b32 v176, s68
    v_mov_b32 v177, s69
    s_mov_b32 s3, 1048576
K_FGZ:
    ds_read_b32 v2, v13 offset:36
    s_sleep 1
    s_sub_u32 s3, s3, 1
    s_waitcnt lgkmcnt(0)
    v_readfirstlane_b32 s33, v2
    s_nop 3
    s_cselect_b32 s33, 1, s33
    s_cmp_lt_u32 s33, 1
    s_cbranch_scc1 K_FGZ
    v_lshlrev_b32 v3, 9, v1
    s_mov_b32 s66, 81920
    s_mov_b32 s70, 0
    buffer_store_dwordx2 v[176:177], v3, s[64:67], s70 offen offset:128 sc1
    s_mov_b32 s70, 32768
    buffer_store_dwordx2 v[176:177], v3, s[64:67], s70 offen offset:128 sc1
    s_mov_b32 s70, 65536
    buffer_store_dwordx2 v[176:177], v3, s[64:67], s70 offen offset:128 sc1
    v_mov_b32 v3, 16
    ds_write_b32 v13, v3 offset:48
    s_branch K_AUX_G1
K_AUX_G0:
    v_and_b32 v3, 3, v1
    v_lshlrev_b32 v3, 4, v3
    v_add_u32 v2, 123008, v3
    ds_read_b128 v[176:179], v2
    v_lshrrev_b32 v2, 2, v1
    v_lshl_add_u32 v3, v2, 9, v3
    s_sleep 12
    s_load_dword s33, s[4:5], 128
    s_waitcnt lgkmcnt(0)
    s_cmp_ge_u32 s33, 8
    s_cbranch_scc1 K_ZO4
    s_sleep 8
    s_mov_b32 s3, 16384
K_ZB4:
    v_mov_b32 v4, 128
    global_load_dword v4, v4, s[4:5] sc1
    s_waitcnt vmcnt(0)
    v_readfirstlane_b32 s33, v4
    s_cmp_ge_u32 s33, 8
    s_cbranch_scc1 K_ZO4
    s_sleep 8
    s_sub_u32 s3, s3, 1
    s_cbranch_scc0 K_ZB4
K_ZO4:
    v_mov_b32 v2, 1
    ds_write_b32 v13, v2 offset:36
    s_lshr_b32 s3, s29, 2
    s_lshl1_add_u32 s3, s28, s3
    s_mul_i32 s3, s3, 5120
    s_and_b32 s70, s29, 3
    s_lshl_b32 s70, s70, 6
    s_add_u32 s3, s3, s70
    s_mov_b32 exec_hi, 0xff
    s_waitcnt lgkmcnt(0)
    buffer_store_dwordx4 v[176:179], v3, s[64:67], s3 offen offset:256 sc1
    s_mov_b64 exec, -1
K_AUX_G1:
    s_cmp_lg_u32 s43, 63
    s_cbranch_scc1 K_FFN_C
    s_cmp_lg_u32 s29, 0
    s_cbranch_scc1 K_AUX_NT
    s_lshl2_add_u32 s3, s28, s30
    s_sub_u32 s3, s3, 4
    s_mul_i32 s3, s3, 25600
    v_lshlrev_b32 v2, 7, v1
    buffer_load_dword v5, v2, s[24:27], s3 offen
    s_add_u32 s3, s3, 8192
    buffer_load_dword v5, v2, s[24:27], s3 offen
    s_add_u32 s3, s3, 8192
    buffer_load_dword v5, v2, s[24:27], s3 offen
    s_add_u32 s3, s3, 8192
    s_mov_b64 exec, 0xff
    buffer_load_dword v5, v2, s[24:27], s3 offen
    s_add_u32 s3, s3, 8192
    s_mov_b64 exec, -1
K_AUX_NT:
    s_mov_b32 s3, 1048576
K_FGZ2:
    ds_read_b32 v2, v13 offset:36
    s_sleep 1
    s_sub_u32 s3, s3, 1
    s_waitcnt lgkmcnt(0)
    v_readfirstlane_b32 s33, v2
    s_nop 3
    s_cselect_b32 s33, 1, s33
    s_cmp_lt_u32 s33, 1
    s_cbranch_scc1 K_FGZ2
    s_waitcnt vmcnt(0)
    s_branch K_P2
K_AUX_L:
    v_and_b32 v1, 63, v0
    v_mov_b32 v7, 0
    s_and_b32 s28, s2, 7
    s_lshr_b32 s29, s2, 3
    s_xor_b32 s30, s30, 4
    s_lshr_b32 s34, s29, 3
    s_lshl_b32 s34, s34, 2
    s_and_b32 s3, s29, 3
    s_add_u32 s34, s34, s3
    s_add_u32 s34, s34, 4
    s_bitcmp1_b32 s29, 2
    s_cselect_b32 s34, -1, s34
    s_cmp_lt_u32 s29, 8
    s_cselect_b32 s34, s29, s34
    s_lshl_b32 s40, s28, 1
    s_cmp_ge_u32 s34, 10
    s_addc_u32 s40, s40, 0
    s_sub_u32 s41, s34, 10
    s_cmp_ge_u32 s34, 10
    s_cselect_b32 s41, s41, s34
    s_mul_i32 s42, s28, 20
    s_add_u32 s42, s42, s34
    s_and_b32 s42, s42, 255
    s_lshl_b32 s42, s42, 9
    s_add_u32 s42, s42, 524288
    s_mul_i32 s43, s28, 7
    s_add_u32 s43, s43, s29
    s_sub_u32 s43, s43, 1
    s_cmp_lt_u32 s43, 54
    s_cselect_b32 s43, s43, 63
    s_cmp_eq_u32 s29, 0
    s_cselect_b32 s43, 63, s43
    v_mov_b32 v3, 158736
    ds_write2_b32 v3, v7, v7 offset0:0 offset1:1
    ds_write2_b32 v3, v7, v7 offset0:2 offset1:3
    ds_write2_b32 v3, v7, v7 offset0:4 offset1:5
    ds_write2_b32 v3, v7, v7 offset0:6 offset1:7
    ds_write2_b32 v3, v7, v7 offset0:8 offset1:9
    ds_write2_b32 v3, v7, v7 offset0:10 offset1:11
    v_lshrrev_b32 v3, 2, v1
    v_mul_u32_u24 v11, 3456, v3
    v_lshrrev_b32 v3, 4, v1
    v_and_b32 v3, 2, v3
    v_xor_b32 v3, v3, v1
    v_and_b32 v3, 3, v3
    v_lshl_add_u32 v11, v3, 4, v11
    s_mul_i32 s3, s30, 552960
    s_lshl_b32 s70, s43, 6
    s_add_u32 s3, s3, s70
    v_add_u32 v11, s3, v11
    s_mul_i32 s68, s30, 10240
    s_add_u32 s72, s68, 40960
    s_bitcmp1_b32 s43, 0
    s_cselect_b32 s71, s72, s68
    s_cselect_b32 s72, s68, s72
    v_lshlrev_b32 v8, 4, v1
    s_waitcnt lgkmcnt(0)
    s_barrier
    s_mov_b32 s24, s8
    s_mov_b32 s25, s9
    s_mov_b32 s26, 0xc8000
    s_mov_b32 s27, 0x20000
    s_cmp_lg_u32 s43, 63
    s_cbranch_scc1 K_AUX_FFN1
    s_cmp_lg_u32 s30, 0
    s_cbranch_scc1 K_AUX_NR
    s_cmp_eq_u32 s2, 55
    s_cbranch_scc1 K_AUX_NR
    s_cmp_eq_u32 s2, 63
    s_cselect_b32 s70, 0, 128
    s_mov_b32 s3, 1
    s_waitcnt vmcnt(0)
    s_atomic_add s3, s[4:5], s70
    s_atomic_add s3, s[4:5], s70 offset:64
    s_waitcnt lgkmcnt(0)
K_AUX_NR:
    v_mov_b32 v13, 158720
    s_mov_b32 s3, 1048576
K_FGZ3:
    ds_read_b32 v2, v13 offset:36
    s_sleep 1
    s_sub_u32 s3, s3, 1
    s_waitcnt lgkmcnt(0)
    v_readfirstlane_b32 s33, v2
    s_nop 3
    s_cselect_b32 s33, 1, s33
    s_cmp_lt_u32 s33, 1
    s_cbranch_scc1 K_FGZ3
    s_cmp_lg_u32 s2, 63
    s_cbranch_scc1 K_AUX_NH
    s_mov_b32 s3, 1048576
K_FGH:
    ds_read_b32 v2, v13 offset:48
    s_sleep 1
    s_sub_u32 s3, s3, 1
    s_waitcnt lgkmcnt(0)
    v_readfirstlane_b32 s33, v2
    s_nop 3
    s_cselect_b32 s33, 16, s33
    s_cmp_lt_u32 s33, 16
    s_cbranch_scc1 K_FGH
K_AUX_NH:
    s_branch K_P2
K_AUX_FFN1:
    s_bitcmp1_b32 s43, 0
    s_cselect_b64 s[56:57], s[48:49], s[46:47]
    s_cselect_b64 s[60:61], s[46:47], s[48:49]
    s_mov_b32 s58, 2211840
    s_mov_b32 s59, 0x20000
    s_mov_b32 s62, 2211840
    s_mov_b32 s63, 0x20000
    s_add_u32 m0, s71, 0
    s_mov_b32 s70, 0
    buffer_load_dwordx4 v11, s[56:59], s70 offen  lds
    s_add_u32 m0, s71, 1024
    s_mov_b32 s70, 55296
    buffer_load_dwordx4 v11, s[56:59], s70 offen  lds
    s_add_u32 m0, s71, 2048
    s_mov_b32 s70, 110592
    buffer_load_dwordx4 v11, s[56:59], s70 offen  lds
    s_add_u32 m0, s71, 3072
    s_mov_b32 s70, 165888
    buffer_load_dwordx4 v11, s[56:59], s70 offen  lds
    s_add_u32 m0, s71, 4096
    s_mov_b32 s70, 221184
    buffer_load_dwordx4 v11, s[56:59], s70 offen  lds
    s_add_u32 m0, s71, 5120
    s_mov_b32 s70, 276480
    buffer_load_dwordx4 v11, s[56:59], s70 offen  lds
    s_add_u32 m0, s71, 6144
    s_mov_b32 s70, 331776
    buffer_load_dwordx4 v11, s[56:59], s70 offen  lds
    s_add_u32 m0, s71, 7168
    s_mov_b32 s70, 387072
    buffer_load_dwordx4 v11, s[56:59], s70 offen  lds
    s_add_u32 m0, s71, 8192
    s_mov_b32 s70, 442368
    buffer_load_dwordx4 v11, s[56:59], s70 offen  lds
    s_add_u32 m0, s71, 9216
    s_mov_b32 s70, 497664
    buffer_load_dwordx4 v11, s[56:59], s70 offen  lds
    s_add_u32 m0, s72, 0
    s_mov_b32 s70, 0
    buffer_load_dwordx4 v11, s[60:63], s70 offen  lds
    s_add_u32 m0, s72, 1024
    s_mov_b32 s70, 55296
    buffer_load_dwordx4 v11, s[60:63], s70 offen  lds
    s_add_u32 m0, s72, 2048
    s_mov_b32 s70, 110592
    buffer_load_dwordx4 v11, s[60:63], s70 offen  lds
    s_add_u32 m0, s72, 3072
    s_mov_b32 s70, 165888
    buffer_load_dwordx4 v11, s[60:63], s70 offen  lds
    s_add_u32 m0, s72, 4096
    s_mov_b32 s70, 221184
    buffer_load_dwordx4 v11, s[60:63], s70 offen  lds
    s_add_u32 m0, s72, 5120
    s_mov_b32 s70, 276480
    buffer_load_dwordx4 v11, s[60:63], s70 offen  lds
    s_add_u32 m0, s72, 6144
    s_mov_b32 s70, 331776
    buffer_load_dwordx4 v11, s[60:63], s70 offen  lds
    s_add_u32 m0, s72, 7168
    s_mov_b32 s70, 387072
    buffer_load_dwordx4 v11, s[60:63], s70 offen  lds
    s_add_u32 m0, s72, 8192
    s_mov_b32 s70, 442368
    buffer_load_dwordx4 v11, s[60:63], s70 offen  lds
    s_add_u32 m0, s72, 9216
    s_mov_b32 s70, 497664
    buffer_load_dwordx4 v11, s[60:63], s70 offen  lds
    s_mov_b32 s64, s50
    s_mov_b32 s65, s51
    s_mov_b32 s66, 0x21c000
    s_mov_b32 s67, 0x20000
    s_mul_i32 s3, s43, 40960
    s_add_u32 s3, s3, s68
    v_lshrrev_b32 v2, 3, v1
    v_and_b32 v3, 2, v2
    s_lshl_b32 s70, s30, 2
    v_xor_b32 v3, s70, v3
    v_xor_b32 v3, v3, v1
    v_and_b32 v3, 7, v3
    v_mul_u32_u24 v2, 1280, v2
    v_lshl_add_u32 v2, v3, 4, v2
    v_add_u32 v12, s3, v2
    s_add_u32 m0, s68, 81920
    s_mov_b32 s70, 0
    buffer_load_dwordx4 v12, s[64:67], s70 offen  lds
    s_add_u32 m0, s68, 82944
    s_mov_b32 s70, 128
    buffer_load_dwordx4 v12, s[64:67], s70 offen  lds
    s_add_u32 m0, s68, 83968
    s_mov_b32 s70, 256
    buffer_load_dwordx4 v12, s[64:67], s70 offen  lds
    s_add_u32 m0, s68, 84992
    s_mov_b32 s70, 384
    buffer_load_dwordx4 v12, s[64:67], s70 offen  lds
    s_add_u32 m0, s68, 86016
    s_mov_b32 s70, 512
    buffer_load_dwordx4 v12, s[64:67], s70 offen  lds
    s_add_u32 m0, s68, 87040
    s_mov_b32 s70, 640
    buffer_load_dwordx4 v12, s[64:67], s70 offen  lds
    s_add_u32 m0, s68, 88064
    s_mov_b32 s70, 768
    buffer_load_dwordx4 v12, s[64:67], s70 offen  lds
    s_add_u32 m0, s68, 89088
    s_mov_b32 s70, 896
    buffer_load_dwordx4 v12, s[64:67], s70 offen  lds
    s_add_u32 m0, s68, 90112
    s_mov_b32 s70, 1024
    buffer_load_dwordx4 v12, s[64:67], s70 offen  lds
    s_add_u32 m0, s68, 91136
    s_mov_b32 s70, 1152
    buffer_load_dwordx4 v12, s[64:67], s70 offen  lds
    s_waitcnt vmcnt(10)
    s_barrier
    s_branch K_P2_EARLY
K_FFN_C:
    v_lshrrev_b32 v180, 4, v1
    v_bfe_u32 v2, v1, 2, 2
    v_lshl_add_u32 v2, v180, 3, v2
    v_and_b32 v3, 3, v1
    v_lshlrev_b32 v3, 3, v3
    v_lshl_add_u32 v181, v2, 6, v3
    s_bfe_u32 s3, s30, 0x10001
    s_mul_i32 s3, s3, 40960
    v_xor_b32 v4, s30, v180
    v_and_b32 v4, 1, v4
    v_lshl_add_u32 v181, v4, 5, v181
    v_add_u32 v181, s3, v181
    v_bfe_u32 v4, v1, 3, 2
    v_xor_b32 v4, s30, v4
    v_and_b32 v4, 3, v4
    v_lshl_add_u32 v3, v4, 5, v3
    v_and_b32 v2, 3, v2
    v_lshl_add_u32 v3, v2, 7, v3
    v_mul_u32_u24 v182, 10240, v180
    s_mov_b32 s3, 81920
    v_add3_u32 v182, v182, v3, s3
    v_mov_b32 v183, 123904
    s_cmp_lg_u32 s30, 5
    s_cbranch_scc1 K_KW
    s_mov_b32 s3, 131072
K_KPOLL:
    s_load_dwordx2 s[68:69], s[6:7], s42 offset:128 glc
    s_waitcnt lgkmcnt(0)
    s_min_u32 s33, s68, s69
    s_cmp_lg_u32 s33, 0
    s_cbranch_scc1 K_KGOT
    s_sleep 2
    s_sub_u32 s3, s3, 1
    s_cbranch_scc0 K_KPOLL
K_KGOT:
    v_mov_b32 v176, s68
    v_mov_b32 v177, s69
    ds_write_b64 v183, v[176:177]
    v_lshlrev_b32 v2, 4, v1
    s_and_b32 s70, s68, 0x7ff
    s_sub_u32 s70, 2047, s70
    s_mul_i32 s70, s70, 1280
    s_mov_b32 m0, 134208
    s_mov_b64 exec, -1
    buffer_load_dwordx4 v2, s[12:15], s70 offen lds
    s_mov_b64 exec, 0xffff
    buffer_load_dwordx4 v2, s[12:15], s70 offen offset:1024 lds
    s_and_b32 s70, s69, 0x7ff
    s_sub_u32 s70, 2047, s70
    s_mul_i32 s70, s70, 1280
    s_mov_b32 m0, 135552
    s_mov_b64 exec, -1
    buffer_load_dwordx4 v2, s[12:15], s70 offen lds
    s_mov_b64 exec, 0xffff
    buffer_load_dwordx4 v2, s[12:15], s70 offen offset:1024 lds
    s_mov_b64 exec, -1
    v_mov_b32 v3, 16
    s_waitcnt vmcnt(0)
    ds_write_b32 v13, v3 offset:48
    s_branch K_KW2
K_KW:
    s_cmp_lt_u32 s30, 6
    s_cbranch_scc1 K_KW2
    s_cmp_eq_u32 s30, 6
    s_cbranch_scc1 K_CHF0
    s_branch K_CHF1
K_WRET_F:
K_KW2:
    s_branch K_J7f1c
K_CHF0:
K_STF16:
    s_branch K_STF18
    s_nop 0
K_J7f1c:
    v_and_b32 v2, 1, v1
    v_mul_u32_u24 v9, 1344, v2
    v_lshl_add_u32 v9, v180, 4, v9
    v_add_u32 v9, 134208, v9
    v_and_b32 v2, 1, v1
    v_lshlrev_b32 v192, 6, v2
    v_lshl_add_u32 v192, v180, 4, v192
    s_and_b32 s3, s30, 3
    s_lshl_b32 s3, s3, 7
    v_add3_u32 v193, v192, s3, v183
    v_add_u32 v192, 64, v193
    v_add_u32 v193, 1088, v193
    v_lshrrev_b32 v2, 5, v1
    v_bfe_u32 v3, v1, 4, 1
    v_lshl_add_u32 v3, v3, 1, v2
    v_lshlrev_b32 v3, 6, v3
    v_and_b32 v4, 15, v1
    v_lshl_add_u32 v3, v4, 2, v3
    v_add_u32 v194, 123968, v3
    v_lshlrev_b32 v4, 1, v1
    s_add_u32 s3, s3, 124992
    v_add_u32 v195, s3, v4
    v_and_b32 v2, 1, v1
    v_mul_u32_u24 v2, 2560, v2
    v_lshl_add_u32 v196, v180, 4, v2
    s_lshl_b32 s70, s30, 6
    s_add_u32 s70, s70, 125760
    v_add_u32 v196, s70, v196
    v_mov_b32 v3, 1
    s_mov_b32 s3, 1048576
K_FGK:
    ds_read_b32 v2, v13 offset:48
    s_sleep 1
    s_sub_u32 s3, s3, 1
    s_waitcnt lgkmcnt(0)
    v_readfirstlane_b32 s33, v2
    s_nop 3
    s_cselect_b32 s33, 16, s33
    s_branch K_PG7
.p2align 12
K_CHF1:
K_STF17:
    s_branch K_WRET_F
    s_nop 0
K_PG7:
    s_cmp_lt_u32 s33, 16
    s_cbranch_scc1 K_FGK
    ds_read_b128 v[96:99], v9 offset:0
    ds_read_b128 v[100:103], v9 offset:64
    ds_read_b128 v[104:107], v9 offset:128
    ds_read_b128 v[108:111], v9 offset:192
    ds_read_b128 v[112:115], v9 offset:256
    ds_read_b128 v[116:119], v9 offset:320
    ds_read_b128 v[120:123], v9 offset:384
    ds_read_b128 v[124:127], v9 offset:448
    ds_read_b128 v[128:131], v9 offset:512
    ds_read_b128 v[132:135], v9 offset:576
    ds_read_b128 v[136:139], v9 offset:640
    ds_read_b128 v[140:143], v9 offset:704
    ds_read_b128 v[144:147], v9 offset:768
    ds_read_b128 v[148:151], v9 offset:832
    ds_read_b128 v[152:155], v9 offset:896
    ds_read_b128 v[156:159], v9 offset:960
    ds_read_b128 v[160:163], v9 offset:1024
    ds_read_b128 v[164:167], v9 offset:1088
    ds_read_b128 v[168:171], v9 offset:1152
    ds_read_b128 v[172:175], v9 offset:1216
    s_setprio 3
    s_barrier
    ds_read_b64_tr_b16 v[16:17], v181 offset:0
    ds_read_b64_tr_b16 v[18:19], v181 offset:256
    ds_read_b64_tr_b16 v[20:21], v181 offset:2048
    ds_read_b64_tr_b16 v[22:23], v181 offset:2304
    ds_read_b64_tr_b16 v[24:25], v181 offset:4096
    ds_read_b64_tr_b16 v[26:27], v181 offset:4352
    ds_read_b64_tr_b16 v[28:29], v181 offset:6144
    ds_read_b64_tr_b16 v[30:31], v181 offset:6400
    ds_read_b64_tr_b16 v[32:33], v181 offset:8192
    ds_read_b64_tr_b16 v[34:35], v181 offset:8448
    ds_read_b64_tr_b16 v[36:37], v181 offset:10240
    ds_read_b64_tr_b16 v[38:39], v181 offset:10496
    ds_read_b64_tr_b16 v[40:41], v181 offset:12288
    ds_read_b64_tr_b16 v[42:43], v181 offset:12544
    ds_read_b64_tr_b16 v[44:45], v181 offset:14336
    ds_read_b64_tr_b16 v[46:47], v181 offset:14592
    ds_read_b64_tr_b16 v[48:49], v181 offset:16384
    ds_read_b64_tr_b16 v[50:51], v181 offset:16640
    ds_read_b64_tr_b16 v[52:53], v181 offset:18432
    ds_read_b64_tr_b16 v[54:55], v181 offset:18688
    ds_read_b64_tr_b16 v[56:57], v181 offset:20480
    ds_read_b64_tr_b16 v[58:59], v181 offset:20736
    ds_read_b64_tr_b16 v[60:61], v181 offset:22528
    ds_read_b64_tr_b16 v[62:63], v181 offset:22784
    ds_read_b64_tr_b16 v[64:65], v181 offset:24576
    ds_read_b64_tr_b16 v[66:67], v181 offset:24832
    ds_read_b64_tr_b16 v[68:69], v181 offset:26624
    ds_read_b64_tr_b16 v[70:71], v181 offset:26880
    ds_read_b64_tr_b16 v[72:73], v181 offset:28672
    ds_read_b64_tr_b16 v[74:75], v181 offset:28928
    ds_read_b64_tr_b16 v[76:77], v181 offset:30720
    ds_read_b64_tr_b16 v[78:79], v181 offset:30976
    ds_read_b64_tr_b16 v[80:81], v181 offset:32768
    ds_read_b64_tr_b16 v[82:83], v181 offset:33024
    ds_read_b64_tr_b16 v[84:85], v181 offset:34816
    ds_read_b64_tr_b16 v[86:87], v181 offset:35072
    ds_read_b64_tr_b16 v[88:89], v181 offset:36864
    ds_read_b64_tr_b16 v[90:91], v181 offset:37120
    ds_read_b64_tr_b16 v[92:93], v181 offset:38912
    ds_read_b64_tr_b16 v[94:95], v181 offset:39168
    s_waitcnt lgkmcnt(0)
    s_barrier
    v_mfma_f32_16x16x32_bf16 v[184:187], v[16:19], v[96:99], 0
    v_mfma_f32_16x16x32_bf16 v[188:191], v[20:23], v[100:103], 0
    v_mfma_f32_16x16x32_bf16 v[184:187], v[24:27], v[104:107], v[184:187]
    v_mfma_f32_16x16x32_bf16 v[188:191], v[28:31], v[108:111], v[188:191]
    v_mfma_f32_16x16x32_bf16 v[184:187], v[32:35], v[112:115], v[184:187]
    v_mfma_f32_16x16x32_bf16 v[188:191], v[36:39], v[116:119], v[188:191]
    v_mfma_f32_16x16x32_bf16 v[184:187], v[40:43], v[120:123], v[184:187]
    v_mfma_f32_16x16x32_bf16 v[188:191], v[44:47], v[124:127], v[188:191]
    v_mfma_f32_16x16x32_bf16 v[184:187], v[48:51], v[128:131], v[184:187]
    v_mfma_f32_16x16x32_bf16 v[188:191], v[52:55], v[132:135], v[188:191]
    v_mfma_f32_16x16x32_bf16 v[184:187], v[56:59], v[136:139], v[184:187]
    v_mfma_f32_16x16x32_bf16 v[188:191], v[60:63], v[140:143], v[188:191]
    v_mfma_f32_16x16x32_bf16 v[184:187], v[64:67], v[144:147], v[184:187]
    v_mfma_f32_16x16x32_bf16 v[188:191], v[68:71], v[148:151], v[188:191]
    v_mfma_f32_16x16x32_bf16 v[184:187], v[72:75], v[152:155], v[184:187]
    v_mfma_f32_16x16x32_bf16 v[188:191], v[76:79], v[156:159], v[188:191]
    v_mfma_f32_16x16x32_bf16 v[184:187], v[80:83], v[160:163], v[184:187]
    v_mfma_f32_16x16x32_bf16 v[188:191], v[84:87], v[164:167], v[188:191]
    v_mfma_f32_16x16x32_bf16 v[184:187], v[88:91], v[168:171], v[184:187]
    v_mfma_f32_16x16x32_bf16 v[188:191], v[92:95], v[172:175], v[188:191]
    s_nop 7
    v_add_f32 v184, v184, v188
    v_add_f32 v185, v185, v189
    v_add_f32 v186, v186, v190
    v_add_f32 v187, v187, v191
    s_mov_b32 exec_lo, 0x00030003
    s_mov_b32 exec_hi, 0x00030003
    ds_write_b128 v192, v[184:187]
    s_mov_b64 exec, 1
    ds_add_u32 v13, v3 offset:52
    s_mov_b64 exec, -1
    s_cmp_lg_u32 s30, 6
    s_cbranch_scc1 K_NOS6B
    v_lshl_add_u32 v4, v1, 2, s42
    global_load_dword v7, v4, s[6:7] offset:256 sc1
    v_and_b32 v4, 0xfffffe04, v4
    global_load_dword v6, v4, s[6:7] offset:128 sc1
K_NOS6B:
    s_mov_b32 s3, 1048576
K_FGP:
    ds_read_b32 v2, v13 offset:52
    s_sleep 1
    s_sub_u32 s3, s3, 1
    s_waitcnt lgkmcnt(0)
    v_readfirstlane_b32 s33, v2
    s_nop 3
    s_cselect_b32 s33, 8, s33
    s_cmp_lt_u32 s33, 8
    s_cbranch_scc1 K_FGP
    ds_read_b32 v200, v194
    ds_read_b32 v202, v194 offset:256
    ds_read_b64_tr_b16 v[16:17], v182 offset:0
    ds_read_b64_tr_b16 v[18:19], v182 offset:512
    ds_read_b64_tr_b16 v[20:21], v182 offset:1024
    ds_read_b64_tr_b16 v[22:23], v182 offset:1536
    ds_read_b64_tr_b16 v[24:25], v182 offset:2048
    ds_read_b64_tr_b16 v[26:27], v182 offset:2560
    ds_read_b64_tr_b16 v[28:29], v182 offset:3072
    ds_read_b64_tr_b16 v[30:31], v182 offset:3584
    ds_read_b64_tr_b16 v[32:33], v182 offset:4096
    ds_read_b64_tr_b16 v[34:35], v182 offset:4608
    ds_read_b64_tr_b16 v[36:37], v182 offset:5120
    ds_read_b64_tr_b16 v[38:39], v182 offset:5632
    ds_read_b64_tr_b16 v[40:41], v182 offset:6144
    ds_read_b64_tr_b16 v[42:43], v182 offset:6656
    s_waitcnt lgkmcnt(14)
    v_cvt_pk_bf16_f32 v200, v200, v200
    v_lshlrev_b32 v200, 16, v200
    v_cvt_pk_bf16_f32 v202, v202, v202
    s_branch K_J83cc
K_STF18:
    s_branch K_WRET_F
    s_nop 0
K_J83cc:
    v_lshlrev_b32 v202, 16, v202
    v_mul_f32 v201, 0xbfb8aa3b, v200
    v_exp_f32 v201, v201
    s_nop 0
    v_add_f32 v201, 1.0, v201
    v_rcp_f32 v201, v201
    s_nop 0
    v_mul_f32 v200, v200, v201
    v_cvt_pk_bf16_f32 v200, v200, v200
    v_lshlrev_b32 v200, 16, v200
    v_mul_f32 v200, v200, v202
    v_cvt_pk_bf16_f32 v200, v200, v200
    ds_write_b16 v195, v200
    s_waitcnt lgkmcnt(0)
    ds_read_b128 v[200:203], v193
    ds_read_b64_tr_b16 v[44:45], v182 offset:7168
    ds_read_b64_tr_b16 v[46:47], v182 offset:7680
    ds_read_b64_tr_b16 v[48:49], v182 offset:8192
    ds_read_b64_tr_b16 v[50:51], v182 offset:8704
    ds_read_b64_tr_b16 v[52:53], v182 offset:9216
    ds_read_b64_tr_b16 v[54:55], v182 offset:9728
    s_waitcnt lgkmcnt(6)
    v_mfma_f32_16x16x32_bf16 v[96:99], v[16:19], v[200:203], 0
    v_mfma_f32_16x16x32_bf16 v[100:103], v[20:23], v[200:203], 0
    v_mfma_f32_16x16x32_bf16 v[104:107], v[24:27], v[200:203], 0
    v_mfma_f32_16x16x32_bf16 v[108:111], v[28:31], v[200:203], 0
    v_mfma_f32_16x16x32_bf16 v[112:115], v[32:35], v[200:203], 0
    v_mfma_f32_16x16x32_bf16 v[116:119], v[36:39], v[200:203], 0
    v_mfma_f32_16x16x32_bf16 v[120:123], v[40:43], v[200:203], 0
    s_waitcnt lgkmcnt(4)
    v_mfma_f32_16x16x32_bf16 v[124:127], v[44:47], v[200:203], 0
    s_waitcnt lgkmcnt(2)
    v_mfma_f32_16x16x32_bf16 v[128:131], v[48:51], v[200:203], 0
    s_waitcnt lgkmcnt(0)
    v_mfma_f32_16x16x32_bf16 v[132:135], v[52:55], v[200:203], 0
    s_mov_b32 exec_lo, 0x00030003
    s_mov_b32 exec_hi, 0x00030003
    ds_write_b128 v196, v[96:99] offset:0
    ds_write_b128 v196, v[100:103] offset:256
    ds_write_b128 v196, v[104:107] offset:512
    ds_write_b128 v196, v[108:111] offset:768
    ds_write_b128 v196, v[112:115] offset:1024
    ds_write_b128 v196, v[116:119] offset:1280
    ds_write_b128 v196, v[120:123] offset:1536
    ds_write_b128 v196, v[124:127] offset:1792
    ds_write_b128 v196, v[128:131] offset:2048
    ds_write_b128 v196, v[132:135] offset:2304
    v_mov_b32 v3, 1
    s_mov_b64 exec, 1
    ds_add_u32 v13, v3 offset:52
    s_mov_b64 exec, -1
    s_cmp_lg_u32 s30, 4
    s_cbranch_scc1 K_P2
    v_lshlrev_b32 v3, 4, v1
    v_add_u32 v4, 126016, v3
    s_mul_i32 s70, s43, 5120
    s_add_u32 s71, s70, 4096
    s_mov_b32 s3, 1048576
K_FGQ:
    ds_read_b32 v2, v13 offset:52
    s_sleep 1
    s_sub_u32 s3, s3, 1
    s_waitcnt lgkmcnt(0)
    v_readfirstlane_b32 s33, v2
    s_nop 3
    s_cselect_b32 s33, 12, s33
    s_cmp_lt_u32 s33, 12
    s_cbranch_scc1 K_FGQ
    ds_read_b128 v[16:19], v4 offset:0
    ds_read_b128 v[20:23], v4 offset:1024
    ds_read_b128 v[24:27], v4 offset:2048
    ds_read_b128 v[28:31], v4 offset:3072
    ds_read_b128 v[32:35], v4 offset:4096
    s_waitcnt lgkmcnt(4)
    buffer_store_dwordx4 v[16:19], v3, s[60:63], s70 offen offset:0 sc1
    s_waitcnt lgkmcnt(3)
    buffer_store_dwordx4 v[20:23], v3, s[60:63], s70 offen offset:1024 sc1
    s_waitcnt lgkmcnt(2)
    buffer_store_dwordx4 v[24:27], v3, s[60:63], s70 offen offset:2048 sc1
    s_waitcnt lgkmcnt(1)
    buffer_store_dwordx4 v[28:31], v3, s[60:63], s70 offen offset:3072 sc1
    s_waitcnt lgkmcnt(0)
    buffer_store_dwordx4 v[32:35], v3, s[60:63], s71 offen offset:0 sc1
    s_mov_b32 s3, 1
    s_waitcnt vmcnt(0)
    s_atomic_add s3, s[6:7], 606720 glc
    ds_read_b64 v[176:177], v183
    s_waitcnt lgkmcnt(0)
    s_cmp_lg_u32 s3, 53
    s_cbranch_scc1 K_P2
    v_readfirstlane_b32 s70, v176
    s_and_b32 s70, s70, 0x7ff
    s_sub_u32 s70, 2047, s70
    s_lshr_b32 s70, s70, 7
    s_mul_i32 s70, s70, 5120
    s_atomic_add s3, s[6:7], s70 offset:524424
    s_atomic_add s3, s[6:7], s70 offset:524936
    s_atomic_add s3, s[6:7], s70 offset:525448
    s_atomic_add s3, s[6:7], s70 offset:525960
    s_atomic_add s3, s[6:7], s70 offset:526472
    s_atomic_add s3, s[6:7], s70 offset:526984
    s_atomic_add s3, s[6:7], s70 offset:527496
    s_atomic_add s3, s[6:7], s70 offset:528008
    s_atomic_add s3, s[6:7], s70 offset:528520
    s_atomic_add s3, s[6:7], s70 offset:529032
    v_readfirstlane_b32 s70, v177
    s_and_b32 s70, s70, 0x7ff
    s_sub_u32 s70, 2047, s70
    s_lshr_b32 s70, s70, 7
    s_mul_i32 s70, s70, 5120
    s_atomic_add s3, s[6:7], s70 offset:524424
    s_atomic_add s3, s[6:7], s70 offset:524936
    s_atomic_add s3, s[6:7], s70 offset:525448
    s_atomic_add s3, s[6:7], s70 offset:525960
    s_atomic_add s3, s[6:7], s70 offset:526472
    s_atomic_add s3, s[6:7], s70 offset:526984
    s_atomic_add s3, s[6:7], s70 offset:527496
    s_atomic_add s3, s[6:7], s70 offset:528008
    s_atomic_add s3, s[6:7], s70 offset:528520
    s_atomic_add s3, s[6:7], s70 offset:529032
    s_waitcnt lgkmcnt(0)
    s_branch K_P2
K_CODE_END:
.section .rodata,"a"
.p2align 6
.amdhsa_kernel gated_mix__sliding_local_dilated__moe_arch_mod__prompt_kernel
  .amdhsa_next_free_vgpr 256
  .amdhsa_next_free_sgpr 79
  .amdhsa_accum_offset 256
  .amdhsa_group_segment_fixed_size 0
  .amdhsa_kernarg_size 96
  .amdhsa_user_sgpr_count 2
  .amdhsa_user_sgpr_kernarg_segment_ptr 1
  .amdhsa_system_sgpr_workgroup_id_x 1
.end_amdhsa_kernel
```

```asm
; @launch grid=(256,1,1) block=(512,1,1) lds=163840
.amdgcn_target "amdgcn-amd-amdhsa--gfx950"
.text
K_CPL = 33
.p2align 12
.p2align 8
.globl gated_mix__sliding_local_dilated__moe_arch_mod__prompt_kernel
.type gated_mix__sliding_local_dilated__moe_arch_mod__prompt_kernel,@function
gated_mix__sliding_local_dilated__moe_arch_mod__prompt_kernel:
    s_cmp_ge_u32 s2, 256
    s_cbranch_scc1 K_EXIT
    s_load_dwordx2 s[12:13], s[0:1], 0
    s_load_dwordx2 s[16:17], s[0:1], 8
    s_load_dwordx4 s[4:7], s[0:1], 80
    s_load_dwordx2 s[8:9], s[0:1], 16
    s_load_dwordx2 s[10:11], s[0:1], 72
    v_readfirstlane_b32 s30, v0
    s_mov_b32 s14, 0x280000
    s_mov_b32 s15, 0x20000
    s_lshr_b32 s30, s30, 6
    s_cmp_ge_u32 s2, 64
    s_cbranch_scc1 K_MAIN
    s_load_dwordx8 s[44:51], s[0:1], 32
    s_load_dwordx2 s[52:53], s[0:1], 64
    s_getpc_b64 s[38:39]
K_PC:
    s_lshr_b32 s3, s2, 3
    s_mul_i32 s3, s3, K_CPL
    v_add_u32 v2, s3, v0
    v_lshlrev_b32 v2, 7, v2
    v_min_u32 v2, K_CODE_END-K_PC-4, v2
    v_cmp_gt_u32 vcc, K_CPL, v0
    s_and_saveexec_b64 s[20:21], vcc
    s_cbranch_execz K_NOPF
    global_load_dword v6, v2, s[38:39]
K_NOPF:
    s_mov_b64 exec, -1
    s_cmp_lg_u32 s30, 4
    s_cbranch_scc1 K_AUX
    s_min_u32 s3, s2, 8
    s_mul_i32 s3, s3, 10240
    s_add_u32 s33, s3, 10240
    s_cmp_lt_u32 s2, 8
    s_cbranch_scc1 K_ZS
    s_cmp_lg_u32 s2, 63
    s_cbranch_scc1 K_AUX
    s_mov_b32 s33, 0
K_ZS:
    v_lshlrev_b32 v2, 4, v0
    v_mov_b32 v8, 0
    v_mov_b32 v9, 0
    v_mov_b32 v10, 0
    v_mov_b32 v11, 0
    s_waitcnt lgkmcnt(0)
    s_add_u32 s20, s6, 0x7f000
    s_addc_u32 s21, s7, 0
    s_mov_b32 s22, 0x15400
    s_mov_b32 s23, 0x20000
K_ZL:
    buffer_store_dwordx4 v[8:11], v2, s[20:23], s3 offen sc1
    s_add_u32 s3, s3, 1024
    s_cmp_lt_u32 s3, s33
    s_cbranch_scc1 K_ZL
    s_branch K_AUX
K_MAIN:
    s_cmp_ge_u32 s30, 4
    s_cbranch_scc1 K_CONS
    s_bfe_u32 s3, s2, 0x20001
    s_mul_i32 s44, s3, 655360
    s_add_u32 s14, s44, 655360
    s_lshr_b32 s33, s2, 6
    s_mul_i32 s3, s33, 225280
    s_add_u32 s44, s44, s3
    s_mul_i32 s3, s30, 61440
    s_add_u32 s44, s44, s3
    s_sub_u32 s44, s44, 245760
    v_bfe_u32 v3, v0, 4, 2
    s_lshr_b32 s3, s2, 1
    s_and_b32 s3, s3, 28
    s_or_b32 s3, s3, 0x40000
    v_lshlrev_b32 v2, 1, v3
    v_sub_u32 v2, v0, v2
    s_and_b32 s50, s2, 0xc1
    s_mov_b32 s49, 0x225310
    s_cmpk_eq_u32 s50, 128
    s_cselect_b32 s49, 0x75275526, s49
    s_cmpk_eq_u32 s50, 192
    s_cselect_b32 s49, 0x37750756, s49
    s_cmpk_eq_u32 s50, 65
    s_cselect_b32 s49, 0x225510, s49
    s_cmpk_eq_u32 s50, 129
    s_cselect_b32 s49, 0x75275525, s49
    s_cmpk_eq_u32 s50, 193
    s_cselect_b32 s49, 0x37769756, s49
    s_bfe_u32 s49, s49, s3
    s_bfe_u32 s32, 0x64317520, s3
    v_and_b32 v2, 15, v2
    v_mul_u32_u24 v5, 3840, v3
    s_lshl_b32 s3, s2, 2
    s_lshr_b32 s3, 0x44032335, s3
    s_and_b32 s3, s3, 15
    s_add_u32 s49, s49, s3
    s_mov_b32 s33, 0x00a55a
    v_subrev_u32 v5, 160, v5
    s_sub_u32 s3, s49, 10
    s_cselect_b32 s49, s49, s3
    v_mul_u32_u24 v4, 52, v2
    v_lshrrev_b32 v4, 5, v4
    v_and_b32 v4, 24, v4
    v_bfe_u32 v4, s33, v4, 8
    v_add_u32 v4, v4, v2
    v_lshl_add_u32 v218, v4, 4, v5
    v_add_u32 v4, 1, v2
    v_lshrrev_b32 v4, 4, v4
    v_lshl_add_u32 v218, v4, 28, v218
    v_xor_b32 v2, 8, v2
    v_mul_u32_u24 v4, 52, v2
    v_lshrrev_b32 v4, 5, v4
    v_and_b32 v4, 24, v4
    v_bfe_u32 v4, s33, v4, 8
    v_add_u32 v4, v4, v2
    v_lshl_add_u32 v219, v4, 4, v5
    v_add_u32 v4, 1, v2
    v_lshrrev_b32 v4, 4, v4
    v_lshl_add_u32 v219, v4, 28, v219
    s_bitcmp1_b32 s2, 0
    s_cselect_b32 s3, 8, 0
    s_add_u32 s32, s32, s3
    s_mul_i32 s50, s32, 80
    s_mul_i32 s3, s30, 61440
    s_add_u32 s50, s50, s3
    s_lshl_b32 s46, s30, 12
    s_add_u32 s46, s46, 24576
    s_mul_i32 s45, s30, 6144
    s_mov_b32 s18, 0x258000
    s_mov_b32 s19, 0x20000
    v_xor_b32 v3, v3, v0
    v_and_b32 v3, 7, v3
    v_bfe_u32 v2, v0, 3, 3
    v_mul_u32_u24 v2, 1280, v2
    v_lshl_add_u32 v216, v3, 4, v2
    v_xor_b32 v217, 64, v216
    s_lshl_b32 s47, s49, 7
    s_mul_i32 s48, s49, 245760
    s_add_u32 s51, s44, s47
    s_add_u32 s48, s48, s50
    s_add_u32 s49, s49, 1
    s_cmp_eq_u32 s49, 10
    s_cselect_b32 s49, 0, s49
    s_waitcnt lgkmcnt(0)
    s_add_u32 m0, s46, 81920
    s_add_u32 s52, s48, 0
    buffer_load_dwordx4 v218, s[16:19], s52 offen lds
    s_add_u32 m0, s45, 81920
    s_max_i32 s52, s51, s47
    buffer_load_dwordx4 v216, s[12:15], s52 offen lds
    s_add_u32 m0, s46, 82944
    s_add_u32 s52, s48, 15360
    buffer_load_dwordx4 v218, s[16:19], s52 offen lds
    s_add_u32 m0, s45, 82944
    s_add_u32 s52, s51, 10240
    s_max_i32 s52, s52, s47
    buffer_load_dwordx4 v217, s[12:15], s52 offen lds
    s_add_u32 m0, s45, 83968
    s_add_u32 s52, s51, 20480
    buffer_load_dwordx4 v216, s[12:15], s52 offen lds
    s_add_u32 m0, s46, 83968
    s_add_u32 s52, s48, 30720
    buffer_load_dwordx4 v219, s[16:19], s52 offen lds
    s_add_u32 m0, s45, 84992
    s_add_u32 s52, s51, 30720
    buffer_load_dwordx4 v217, s[12:15], s52 offen lds
    s_add_u32 m0, s46, 84992
    s_add_u32 s52, s48, 46080
    buffer_load_dwordx4 v219, s[16:19], s52 offen lds
    s_add_u32 m0, s45, 86016
    s_add_u32 s52, s51, 40960
    buffer_load_dwordx4 v216, s[12:15], s52 offen lds
    s_add_u32 m0, s45, 87040
    s_add_u32 s52, s51, 51200
    buffer_load_dwordx4 v217, s[12:15], s52 offen lds
    s_lshl_b32 s47, s49, 7
    s_mul_i32 s48, s49, 245760
    s_add_u32 s51, s44, s47
    s_add_u32 s48, s48, s50
    s_add_u32 s49, s49, 1
    s_cmp_eq_u32 s49, 10
    s_cselect_b32 s49, 0, s49
    s_add_u32 m0, s46, 0
    s_add_u32 s52, s48, 0
    buffer_load_dwordx4 v218, s[16:19], s52 offen lds
    s_add_u32 m0, s45, 0
    s_max_i32 s52, s51, s47
    buffer_load_dwordx4 v216, s[12:15], s52 offen lds
    s_add_u32 m0, s46, 1024
    s_add_u32 s52, s48, 15360
    buffer_load_dwordx4 v218, s[16:19], s52 offen lds
    s_add_u32 m0, s45, 1024
    s_add_u32 s52, s51, 10240
    s_max_i32 s52, s52, s47
    buffer_load_dwordx4 v217, s[12:15], s52 offen lds
    s_add_u32 m0, s45, 2048
    s_add_u32 s52, s51, 20480
    buffer_load_dwordx4 v216, s[12:15], s52 offen lds
    s_add_u32 m0, s46, 2048
    s_add_u32 s52, s48, 30720
    buffer_load_dwordx4 v219, s[16:19], s52 offen lds
    s_mov_b32 s43, s30
    v_and_b32 v1, 63, v0
    v_mov_b32 v7, 0
    s_and_b32 s28, s2, 7
    s_lshr_b32 s29, s2, 3
    s_xor_b32 s30, s30, 4
    s_lshr_b32 s34, s29, 3
    s_lshl_b32 s34, s34, 2
    s_and_b32 s3, s29, 3
    s_add_u32 s34, s34, s3
    s_add_u32 s34, s34, 4
    s_bitcmp1_b32 s29, 2
    s_cselect_b32 s34, -1, s34
    s_cmp_lt_u32 s29, 8
    s_cselect_b32 s34, s29, s34
    s_lshl_b32 s40, s28, 1
    s_cmp_ge_u32 s34, 10
    s_addc_u32 s40, s40, 0
    s_sub_u32 s41, s34, 10
    s_cmp_ge_u32 s34, 10
    s_cselect_b32 s41, s41, s34
    s_mul_i32 s42, s28, 20
    s_add_u32 s42, s42, s34
    s_and_b32 s42, s42, 255
    s_lshl_b32 s42, s42, 9
    s_add_u32 s42, s42, 524288
    s_lshr_b32 s31, s28, 1
    s_lshl_b32 s31, s31, 5
    s_lshr_b32 s3, s29, 3
    s_mul_i32 s3, s3, 11
    s_add_u32 s31, s31, s3
    s_sub_u32 s31, s31, 11
    s_and_b32 s32, s28, 1
    s_lshl_b32 s32, s32, 3
    s_and_b32 s3, s29, 7
    s_lshl_b32 s3, s3, 2
    s_lshr_b32 s3, 0x64317520, s3
    s_and_b32 s3, s3, 7
    s_add_u32 s32, s32, s3
    s_and_b32 s35, s29, 3
    s_and_b32 s3, s29, 4
    s_lshl_b32 s3, s3, 1
    s_add_u32 s35, s35, s3
    s_and_b32 s3, s28, 1
    s_lshl_b32 s3, s3, 2
    s_add_u32 s35, s35, s3
K_LOADER:
    s_mov_b32 s24, s8
    s_mov_b32 s25, s9
    s_mov_b32 s26, 0xc8000
    s_mov_b32 s27, 0x20000
    v_and_b32 v8, 15, v1
    v_lshrrev_b32 v9, 4, v1
    v_bfe_u32 v10, v1, 2, 2
    v_and_b32 v11, 3, v1
    s_add_u32 s20, s6, 0x100000
    s_addc_u32 s21, s7, 0
    s_mov_b32 s22, 0x280000
    s_mov_b32 s23, 0x20000
    s_lshr_b32 s53, s35, 2
    s_add_u32 s3, s53, s35
    s_lshl_b32 s3, s3, 12
    s_mul_i32 s33, s53, 19456
    s_lshl_b32 s53, s35, 8
    s_add_u32 s33, s33, s53
    s_add_u32 s33, s33, 16384
    s_lshr_b32 s53, s31, 5
    s_add_u32 s53, s53, 1
    s_mul_i32 s22, s53, 655360
    s_mov_b32 s53, s31
    s_add_u32 s54, s53, s43
    v_mov_b32 v3, s54
    v_lshrrev_b32 v2, 2, v3
    v_mul_u32_u24 v2, 76, v2
    v_add_lshl_u32 v2, v2, v3, 10
    v_lshl_add_u32 v2, v8, 4, v2
    v_add_u32 v220, s3, v2
    v_lshl_add_u32 v220, v9, 8, v220
    s_lshl_b32 s3, s43, 2
    v_add_u32 v4, s3, v9
    v_add_u32 v3, s53, v4
    v_lshrrev_b32 v2, 2, v3
    v_mul_u32_u24 v2, 76, v2
    v_add_lshl_u32 v2, v2, v3, 10
    v_lshl_add_u32 v2, v8, 4, v2
    v_add_u32 v221, s33, v2
    v_mov_b32 v5, 0x10000000
    v_cmp_gt_u32 vcc, 11, v4
    v_mov_b32 v224, -1
    v_mov_b32 v225, -1
    v_mov_b32 v226, -1
    v_mov_b32 v227, -1
    v_cndmask_b32 v221, v5, v221, vcc
    v_lshrrev_b32 v2, 3, v1
    v_mul_u32_u24 v2, 1280, v2
    v_lshrrev_b32 v3, 2, v1
    v_and_b32 v3, 4, v3
    v_and_b32 v4, 7, v1
    v_xor_b32 v3, v3, v4
    v_lshl_add_u32 v2, v3, 4, v2
    s_lshl_b32 s33, s41, 7
    v_add_u32 v222, s33, v2
    v_lshrrev_b32 v5, 5, v1
    v_mul_u32_u24 v5, 20480, v5
    v_add_u32 v5, v5, v222
    s_mov_b32 s30, s43
    s_waitcnt vmcnt(6)
    s_barrier
    s_add_u32 m0, s45, 3072
    s_add_u32 s52, s51, 30720
    buffer_load_dwordx4 v217, s[12:15], s52 offen lds
    s_add_u32 m0, s46, 3072
    s_add_u32 s52, s48, 46080
    buffer_load_dwordx4 v219, s[16:19], s52 offen lds
    s_add_u32 m0, s45, 4096
    s_add_u32 s52, s51, 40960
    buffer_load_dwordx4 v216, s[12:15], s52 offen lds
    s_add_u32 m0, s45, 5120
    s_add_u32 s52, s51, 51200
    buffer_load_dwordx4 v217, s[12:15], s52 offen lds
    s_lshl_b32 s47, s49, 7
    s_mul_i32 s48, s49, 245760
    s_add_u32 s51, s44, s47
    s_add_u32 s48, s48, s50
    s_add_u32 s49, s49, 1
    s_cmp_eq_u32 s49, 10
    s_cselect_b32 s49, 0, s49
    s_add_u32 m0, s46, 40960
    s_add_u32 s52, s48, 0
    buffer_load_dwordx4 v218, s[16:19], s52 offen lds
    s_add_u32 m0, s45, 40960
    s_max_i32 s52, s51, s47
    buffer_load_dwordx4 v216, s[12:15], s52 offen lds
    s_add_u32 m0, s46, 41984
    s_add_u32 s52, s48, 15360
    buffer_load_dwordx4 v218, s[16:19], s52 offen lds
    s_add_u32 m0, s45, 41984
    s_add_u32 s52, s51, 10240
    s_max_i32 s52, s52, s47
    buffer_load_dwordx4 v217, s[12:15], s52 offen lds
    s_add_u32 m0, s45, 43008
    s_add_u32 s52, s51, 20480
    buffer_load_dwordx4 v216, s[12:15], s52 offen lds
    s_add_u32 m0, s46, 43008
    s_add_u32 s52, s48, 30720
    buffer_load_dwordx4 v219, s[16:19], s52 offen lds
    s_waitcnt vmcnt(6)
    s_barrier
    s_add_u32 m0, s45, 44032
    s_add_u32 s52, s51, 30720
    buffer_load_dwordx4 v217, s[12:15], s52 offen lds
    s_add_u32 m0, s46, 44032
    s_add_u32 s52, s48, 46080
    buffer_load_dwordx4 v219, s[16:19], s52 offen lds
    s_add_u32 m0, s45, 45056
    s_add_u32 s52, s51, 40960
    buffer_load_dwordx4 v216, s[12:15], s52 offen lds
    s_add_u32 m0, s45, 46080
    s_add_u32 s52, s51, 51200
    buffer_load_dwordx4 v217, s[12:15], s52 offen lds
    s_lshl_b32 s47, s49, 7
    s_mul_i32 s48, s49, 245760
    s_add_u32 s51, s44, s47
    s_add_u32 s48, s48, s50
    s_add_u32 s49, s49, 1
    s_cmp_eq_u32 s49, 10
    s_cselect_b32 s49, 0, s49
    s_add_u32 m0, s46, 81920
    s_add_u32 s52, s48, 0
    buffer_load_dwordx4 v218, s[16:19], s52 offen lds
    s_add_u32 m0, s45, 81920
    s_max_i32 s52, s51, s47
    buffer_load_dwordx4 v216, s[12:15], s52 offen lds
    s_add_u32 m0, s46, 82944
    s_add_u32 s52, s48, 15360
    buffer_load_dwordx4 v218, s[16:19], s52 offen lds
    s_add_u32 m0, s45, 82944
    s_add_u32 s52, s51, 10240
    s_max_i32 s52, s52, s47
    buffer_load_dwordx4 v217, s[12:15], s52 offen lds
    s_add_u32 m0, s45, 83968
    s_add_u32 s52, s51, 20480
    buffer_load_dwordx4 v216, s[12:15], s52 offen lds
    s_add_u32 m0, s46, 83968
    s_add_u32 s52, s48, 30720
    buffer_load_dwordx4 v219, s[16:19], s52 offen lds
    s_waitcnt vmcnt(6)
    s_barrier
    s_add_u32 m0, s45, 84992
    s_add_u32 s52, s51, 30720
    buffer_load_dwordx4 v217, s[12:15], s52 offen lds
    s_add_u32 m0, s46, 84992
    s_add_u32 s52, s48, 46080
    buffer_load_dwordx4 v219, s[16:19], s52 offen lds
    s_add_u32 m0, s45, 86016
    s_add_u32 s52, s51, 40960
    buffer_load_dwordx4 v216, s[12:15], s52 offen lds
    s_add_u32 m0, s45, 87040
    s_add_u32 s52, s51, 51200
    buffer_load_dwordx4 v217, s[12:15], s52 offen lds
    s_lshl_b32 s47, s49, 7
    s_mul_i32 s48, s49, 245760
    s_add_u32 s51, s44, s47
    s_add_u32 s48, s48, s50
    s_add_u32 s49, s49, 1
    s_cmp_eq_u32 s49, 10
    s_cselect_b32 s49, 0, s49
    s_add_u32 m0, s46, 0
    s_add_u32 s52, s48, 0
    buffer_load_dwordx4 v218, s[16:19], s52 offen lds
    s_add_u32 m0, s45, 0
    s_max_i32 s52, s51, s47
    buffer_load_dwordx4 v216, s[12:15], s52 offen lds
    s_add_u32 m0, s46, 1024
    s_add_u32 s52, s48, 15360
    buffer_load_dwordx4 v218, s[16:19], s52 offen lds
    s_add_u32 m0, s45, 1024
    s_add_u32 s52, s51, 10240
    s_max_i32 s52, s52, s47
    buffer_load_dwordx4 v217, s[12:15], s52 offen lds
    s_add_u32 m0, s45, 2048
    s_add_u32 s52, s51, 20480
    buffer_load_dwordx4 v216, s[12:15], s52 offen lds
    s_add_u32 m0, s46, 2048
    s_add_u32 s52, s48, 30720
    buffer_load_dwordx4 v219, s[16:19], s52 offen lds
    s_waitcnt vmcnt(6)
    s_barrier
    s_add_u32 m0, s45, 3072
    s_add_u32 s52, s51, 30720
    buffer_load_dwordx4 v217, s[12:15], s52 offen lds
    s_add_u32 m0, s46, 3072
    s_add_u32 s52, s48, 46080
    buffer_load_dwordx4 v219, s[16:19], s52 offen lds
    s_add_u32 m0, s45, 4096
    s_add_u32 s52, s51, 40960
    buffer_load_dwordx4 v216, s[12:15], s52 offen lds
    s_add_u32 m0, s45, 5120
    s_add_u32 s52, s51, 51200
    buffer_load_dwordx4 v217, s[12:15], s52 offen lds
    s_lshl_b32 s47, s49, 7
    s_mul_i32 s48, s49, 245760
    s_add_u32 s51, s44, s47
    s_add_u32 s48, s48, s50
    s_add_u32 s49, s49, 1
    s_cmp_eq_u32 s49, 10
    s_cselect_b32 s49, 0, s49
    s_add_u32 m0, s46, 40960
    s_add_u32 s52, s48, 0
    buffer_load_dwordx4 v218, s[16:19], s52 offen lds
    s_add_u32 m0, s45, 40960
    s_max_i32 s52, s51, s47
    buffer_load_dwordx4 v216, s[12:15], s52 offen lds
    s_add_u32 m0, s46, 41984
    s_add_u32 s52, s48, 15360
    buffer_load_dwordx4 v218, s[16:19], s52 offen lds
    s_add_u32 m0, s45, 41984
    s_add_u32 s52, s51, 10240
    s_max_i32 s52, s52, s47
    buffer_load_dwordx4 v217, s[12:15], s52 offen lds
    s_add_u32 m0, s45, 43008
    s_add_u32 s52, s51, 20480
    buffer_load_dwordx4 v216, s[12:15], s52 offen lds
    s_add_u32 m0, s46, 43008
    s_add_u32 s52, s48, 30720
    buffer_load_dwordx4 v219, s[16:19], s52 offen lds
    s_waitcnt vmcnt(6)
    s_barrier
    s_add_u32 m0, s45, 44032
    s_add_u32 s52, s51, 30720
    buffer_load_dwordx4 v217, s[12:15], s52 offen lds
    s_add_u32 m0, s46, 44032
    s_add_u32 s52, s48, 46080
    buffer_load_dwordx4 v219, s[16:19], s52 offen lds
    s_add_u32 m0, s45, 45056
    s_add_u32 s52, s51, 40960
    buffer_load_dwordx4 v216, s[12:15], s52 offen lds
    s_add_u32 m0, s45, 46080
    s_add_u32 s52, s51, 51200
    buffer_load_dwordx4 v217, s[12:15], s52 offen lds
    s_lshl_b32 s47, s49, 7
    s_mul_i32 s48, s49, 245760
    s_add_u32 s51, s44, s47
    s_add_u32 s48, s48, s50
    s_add_u32 s49, s49, 1
    s_cmp_eq_u32 s49, 10
    s_cselect_b32 s49, 0, s49
    s_add_u32 m0, s46, 81920
    s_add_u32 s52, s48, 0
    buffer_load_dwordx4 v218, s[16:19], s52 offen lds
    s_add_u32 m0, s45, 81920
    s_max_i32 s52, s51, s47
    buffer_load_dwordx4 v216, s[12:15], s52 offen lds
    s_add_u32 m0, s46, 82944
    s_add_u32 s52, s48, 15360
    buffer_load_dwordx4 v218, s[16:19], s52 offen lds
    s_add_u32 m0, s45, 82944
    s_add_u32 s52, s51, 10240
    s_max_i32 s52, s52, s47
    buffer_load_dwordx4 v217, s[12:15], s52 offen lds
    s_add_u32 m0, s45, 83968
    s_add_u32 s52, s51, 20480
    buffer_load_dwordx4 v216, s[12:15], s52 offen lds
    s_add_u32 m0, s46, 83968
    s_add_u32 s52, s48, 30720
    buffer_load_dwordx4 v219, s[16:19], s52 offen lds
    s_waitcnt vmcnt(6)
    s_barrier
    s_add_u32 m0, s45, 84992
    s_add_u32 s52, s51, 30720
    buffer_load_dwordx4 v217, s[12:15], s52 offen lds
    s_add_u32 m0, s46, 84992
    s_add_u32 s52, s48, 46080
    buffer_load_dwordx4 v219, s[16:19], s52 offen lds
    s_add_u32 m0, s45, 86016
    s_add_u32 s52, s51, 40960
    buffer_load_dwordx4 v216, s[12:15], s52 offen lds
    s_add_u32 m0, s45, 87040
    s_add_u32 s52, s51, 51200
    buffer_load_dwordx4 v217, s[12:15], s52 offen lds
    s_lshl_b32 s47, s49, 7
    s_mul_i32 s48, s49, 245760
    s_add_u32 s51, s44, s47
    s_add_u32 s48, s48, s50
    s_add_u32 s49, s49, 1
    s_cmp_eq_u32 s49, 10
    s_cselect_b32 s49, 0, s49
    s_add_u32 m0, s46, 0
    s_add_u32 s52, s48, 0
    buffer_load_dwordx4 v218, s[16:19], s52 offen lds
    s_add_u32 m0, s45, 0
    s_max_i32 s52, s51, s47
    buffer_load_dwordx4 v216, s[12:15], s52 offen lds
    s_add_u32 m0, s46, 1024
    s_add_u32 s52, s48, 15360
    buffer_load_dwordx4 v218, s[16:19], s52 offen lds
    s_add_u32 m0, s45, 1024
    s_add_u32 s52, s51, 10240
    s_max_i32 s52, s52, s47
    buffer_load_dwordx4 v217, s[12:15], s52 offen lds
    s_add_u32 m0, s45, 2048
    s_add_u32 s52, s51, 20480
    buffer_load_dwordx4 v216, s[12:15], s52 offen lds
    s_add_u32 m0, s46, 2048
    s_add_u32 s52, s48, 30720
    buffer_load_dwordx4 v219, s[16:19], s52 offen lds
    s_branch K_PG0
.p2align 12
K_CHM0:
K_STM0:
    s_branch K_WRET_M
    s_nop 0
K_PG0:
    s_waitcnt vmcnt(6)
    s_barrier
    s_add_u32 m0, s45, 3072
    s_add_u32 s52, s51, 30720
    buffer_load_dwordx4 v217, s[12:15], s52 offen lds
    s_add_u32 m0, s46, 3072
    s_add_u32 s52, s48, 46080
    buffer_load_dwordx4 v219, s[16:19], s52 offen lds
    s_add_u32 m0, s45, 4096
    s_add_u32 s52, s51, 40960
    buffer_load_dwordx4 v216, s[12:15], s52 offen lds
    s_add_u32 m0, s45, 5120
    s_add_u32 s52, s51, 51200
    buffer_load_dwordx4 v217, s[12:15], s52 offen lds
    s_lshl_b32 s47, s49, 7
    s_mul_i32 s48, s49, 245760
    s_add_u32 s51, s44, s47
    s_add_u32 s48, s48, s50
    s_add_u32 s49, s49, 1
    s_cmp_eq_u32 s49, 10
    s_cselect_b32 s49, 0, s49
    s_add_u32 m0, s46, 40960
    s_add_u32 s52, s48, 0
    buffer_load_dwordx4 v218, s[16:19], s52 offen lds
    s_add_u32 m0, s45, 40960
    s_max_i32 s52, s51, s47
    buffer_load_dwordx4 v216, s[12:15], s52 offen lds
    s_add_u32 m0, s46, 41984
    s_add_u32 s52, s48, 15360
    buffer_load_dwordx4 v218, s[16:19], s52 offen lds
    s_add_u32 m0, s45, 41984
    s_add_u32 s52, s51, 10240
    s_max_i32 s52, s52, s47
    buffer_load_dwordx4 v217, s[12:15], s52 offen lds
    s_add_u32 m0, s45, 43008
    s_add_u32 s52, s51, 20480
    buffer_load_dwordx4 v216, s[12:15], s52 offen lds
    s_add_u32 m0, s46, 43008
    s_add_u32 s52, s48, 30720
    buffer_load_dwordx4 v219, s[16:19], s52 offen lds
    s_waitcnt vmcnt(6)
    s_barrier
    s_add_u32 m0, s45, 44032
    s_add_u32 s52, s51, 30720
    buffer_load_dwordx4 v217, s[12:15], s52 offen lds
    s_add_u32 m0, s46, 44032
    s_add_u32 s52, s48, 46080
    buffer_load_dwordx4 v219, s[16:19], s52 offen lds
    s_add_u32 m0, s45, 45056
    s_add_u32 s52, s51, 40960
    buffer_load_dwordx4 v216, s[12:15], s52 offen lds
    s_add_u32 m0, s45, 46080
    s_add_u32 s52, s51, 51200
    buffer_load_dwordx4 v217, s[12:15], s52 offen lds
    s_lshl_b32 s47, s49, 7
    s_mul_i32 s48, s49, 245760
    s_add_u32 s51, s44, s47
    s_add_u32 s48, s48, s50
    s_add_u32 s49, s49, 1
    s_cmp_eq_u32 s49, 10
    s_cselect_b32 s49, 0, s49
    s_add_u32 m0, s46, 81920
    s_add_u32 s52, s48, 0
    buffer_load_dwordx4 v218, s[16:19], s52 offen lds
    s_add_u32 m0, s45, 81920
    s_max_i32 s52, s51, s47
    buffer_load_dwordx4 v216, s[12:15], s52 offen lds
    s_add_u32 m0, s46, 82944
    s_add_u32 s52, s48, 15360
    buffer_load_dwordx4 v218, s[16:19], s52 offen lds
    s_add_u32 m0, s45, 82944
    s_add_u32 s52, s51, 10240
    s_max_i32 s52, s52, s47
    buffer_load_dwordx4 v217, s[12:15], s52 offen lds
    s_add_u32 m0, s45, 83968
    s_add_u32 s52, s51, 20480
    buffer_load_dwordx4 v216, s[12:15], s52 offen lds
    s_add_u32 m0, s46, 83968
    s_add_u32 s52, s48, 30720
    buffer_load_dwordx4 v219, s[16:19], s52 offen lds
    s_waitcnt vmcnt(6)
    s_barrier
    s_load_dword s54, s[4:5], 192
    s_add_u32 m0, s45, 84992
    s_add_u32 s52, s51, 30720
    buffer_load_dwordx4 v217, s[12:15], s52 offen lds
    s_add_u32 m0, s46, 84992
    s_add_u32 s52, s48, 46080
    buffer_load_dwordx4 v219, s[16:19], s52 offen lds
    s_add_u32 m0, s45, 86016
    s_add_u32 s52, s51, 40960
    buffer_load_dwordx4 v216, s[12:15], s52 offen lds
    s_add_u32 m0, s45, 87040
    s_add_u32 s52, s51, 51200
    buffer_load_dwordx4 v217, s[12:15], s52 offen lds
    s_waitcnt lgkmcnt(0)
    s_cmp_ge_u32 s54, 8
    s_cbranch_scc1 K_ZO0
    s_mov_b32 s3, 16384
K_ZB0:
    v_mov_b32 v4, 192
    global_load_dword v4, v4, s[4:5] sc1
    s_waitcnt vmcnt(0)
    v_readfirstlane_b32 s33, v4
    s_cmp_ge_u32 s33, 8
    s_cbranch_scc1 K_ZO0
    s_sleep 8
    s_sub_u32 s3, s3, 1
    s_cbranch_scc0 K_ZB0
K_ZO0:
    s_cmp_eq_u32 s34, -1
    s_cbranch_scc1 K_NOLT
    s_lshl_b32 s47, s43, 2
    s_lshr_b32 s47, 0x7520, s47
    s_and_b32 s47, s47, 7
    s_mul_i32 s47, s47, 51200
    s_lshl_b32 s48, s43, 12
    s_add_u32 s3, s47, 0
    s_add_u32 m0, s48, 0
    s_nop 0
    buffer_load_dwordx4 v222, s[24:27], s3 offen lds
    s_add_u32 s3, s47, 10240
    s_add_u32 m0, s48, 1024
    s_nop 0
    buffer_load_dwordx4 v222, s[24:27], s3 offen lds
    s_add_u32 s3, s47, 25600
    s_add_u32 m0, s48, 2048
    s_nop 0
    buffer_load_dwordx4 v222, s[24:27], s3 offen lds
    s_add_u32 s3, s47, 35840
    s_add_u32 m0, s48, 3072
    s_nop 0
    buffer_load_dwordx4 v222, s[24:27], s3 offen lds
    s_add_u32 s3, s47, 409600
    s_add_u32 m0, s48, 20480
    s_nop 0
    buffer_load_dwordx4 v222, s[24:27], s3 offen lds
    s_add_u32 s3, s47, 419840
    s_add_u32 m0, s48, 21504
    s_nop 0
    buffer_load_dwordx4 v222, s[24:27], s3 offen lds
    s_add_u32 s3, s47, 435200
    s_add_u32 m0, s48, 22528
    s_nop 0
    buffer_load_dwordx4 v222, s[24:27], s3 offen lds
    s_add_u32 s3, s47, 445440
    s_add_u32 m0, s48, 23552
    s_nop 0
    buffer_load_dwordx4 v222, s[24:27], s3 offen lds
    s_lshl_b32 s48, s43, 10
    s_add_u32 s3, s47, 20480
    s_add_u32 m0, s48, 16384
    s_nop 0
    buffer_load_dwordx4 v5, s[24:27], s3 offen lds
    s_add_u32 s3, s47, 430080
    s_add_u32 m0, s48, 36864
    s_nop 0
    buffer_load_dwordx4 v5, s[24:27], s3 offen lds
    s_waitcnt vmcnt(10)
    s_barrier
    s_mov_b32 s33, 81920
    s_cmp_eq_u32 s43, 3
    s_cselect_b32 s3, 0, 163840
    buffer_store_dwordx4 v[224:227], v220, s[20:23], 0 offen sc1
    buffer_store_dwordx4 v[224:227], v220, s[20:23], s33 offen sc1
    buffer_store_dwordx4 v[224:227], v220, s[20:23], s3 offen sc1
    buffer_store_dwordx4 v[224:227], v221, s[20:23], 0 offen sc1
    v_mov_b32 v2, 158720
    v_mov_b32 v3, 1
    s_waitcnt vmcnt(0)
    s_mov_b64 exec, 1
    ds_add_u32 v2, v3 offset:28
    ds_add_u32 v2, v3 offset:32
    s_mov_b64 exec, -1
    s_lshl_b32 s47, s43, 2
    s_lshr_b32 s47, 0x6431, s47
    s_and_b32 s47, s47, 7
    s_mul_i32 s47, s47, 51200
    s_lshl_b32 s48, s43, 12
    s_add_u32 s3, s47, 0
    s_add_u32 m0, s48, 40960
    s_nop 0
    buffer_load_dwordx4 v222, s[24:27], s3 offen lds
    s_add_u32 s3, s47, 10240
    s_add_u32 m0, s48, 41984
    s_nop 0
    buffer_load_dwordx4 v222, s[24:27], s3 offen lds
    s_add_u32 s3, s47, 25600
    s_add_u32 m0, s48, 43008
    s_nop 0
    buffer_load_dwordx4 v222, s[24:27], s3 offen lds
    s_add_u32 s3, s47, 35840
    s_add_u32 m0, s48, 44032
    s_nop 0
    buffer_load_dwordx4 v222, s[24:27], s3 offen lds
    s_add_u32 s3, s47, 409600
    s_add_u32 m0, s48, 61440
    s_nop 0
    buffer_load_dwordx4 v222, s[24:27], s3 offen lds
    s_add_u32 s3, s47, 419840
    s_add_u32 m0, s48, 62464
    s_nop 0
    buffer_load_dwordx4 v222, s[24:27], s3 offen lds
    s_add_u32 s3, s47, 435200
    s_add_u32 m0, s48, 63488
    s_nop 0
    buffer_load_dwordx4 v222, s[24:27], s3 offen lds
    s_add_u32 s3, s47, 445440
    s_add_u32 m0, s48, 64512
    s_nop 0
    buffer_load_dwordx4 v222, s[24:27], s3 offen lds
    s_lshl_b32 s48, s43, 10
    s_add_u32 s3, s47, 20480
    s_add_u32 m0, s48, 57344
    s_nop 0
    buffer_load_dwordx4 v5, s[24:27], s3 offen lds
    s_add_u32 s3, s47, 430080
    s_add_u32 m0, s48, 77824
    s_nop 0
    buffer_load_dwordx4 v5, s[24:27], s3 offen lds
    s_branch K_P2_GM
K_NOLT:
    s_waitcnt vmcnt(0)
    s_barrier
    s_mov_b32 s33, 81920
    s_cmp_eq_u32 s43, 3
    s_cselect_b32 s3, 0, 163840
    buffer_store_dwordx4 v[224:227], v220, s[20:23], 0 offen sc1
    buffer_store_dwordx4 v[224:227], v220, s[20:23], s33 offen sc1
    buffer_store_dwordx4 v[224:227], v220, s[20:23], s3 offen sc1
    buffer_store_dwordx4 v[224:227], v221, s[20:23], 0 offen sc1
    v_mov_b32 v2, 158720
    v_mov_b32 v3, 1
    s_waitcnt vmcnt(0)
    s_mov_b64 exec, 1
    ds_add_u32 v2, v3 offset:28
    ds_add_u32 v2, v3 offset:32
    s_mov_b64 exec, -1
    s_branch K_END
K_CONS:
    v_and_b32 v1, 63, v0
    v_and_b32 v8, 15, v1
    v_lshrrev_b32 v9, 4, v1
    v_bfe_u32 v10, v1, 2, 2
    v_and_b32 v11, 3, v1
    s_bfe_u32 s54, s30, 0x10001
    s_and_b32 s55, s30, 1
    v_lshrrev_b32 v2, 1, v8
    v_xor_b32 v2, v2, v9
    v_lshlrev_b32 v2, 4, v2
    v_lshl_add_u32 v2, v8, 7, v2
    s_mul_i32 s3, s54, 12288
    v_add_u32 v39, s3, v2
    v_xor_b32 v40, 64, v39
    v_add_u32 v41, 81920, v39
    v_add_u32 v42, 81920, v40
    v_and_b32 v2, 1, v9
    v_lshl_or_b32 v2, v2, 2, v10
    s_mul_i32 s3, s55, 40
    v_lshl_add_u32 v2, v2, 5, s3
    v_lshl_add_u32 v3, v9, 3, v10
    v_lshlrev_b32 v3, 8, v3
    v_add_u32 v3, 24576, v3
    v_lshl_add_u32 v5, v11, 3, v2
    s_mul_i32 s33, s55, 805306368
    s_sub_u32 s33, 0xf870c020, s33
    v_add_u32 v4, 0, v5
    v_and_b32 v4, 255, v4
    v_add_u32 v43, v4, v3
    v_add_u32 v47, 81920, v43
    v_add_u32 v4, 160, v5
    v_and_b32 v4, 255, v4
    v_add_u32 v44, v4, v3
    v_add_u32 v48, 81920, v44
    v_add_u32 v4, 80, v5
    v_and_b32 v4, 255, v4
    v_add_u32 v45, v4, v3
    v_add_u32 v49, 81920, v45
    v_lshlrev_b32 v4, 3, v11
    v_bfe_u32 v4, s33, v4, 8
    v_add_u32 v4, v4, v2
    v_and_b32 v4, 255, v4
    v_add_u32 v46, v4, v3
    v_add_u32 v50, 81920, v46
    v_and_b32 v1, 63, v0
    v_mov_b32 v7, 0
    s_and_b32 s28, s2, 7
    s_lshr_b32 s29, s2, 3
    s_xor_b32 s30, s30, 4
    s_lshr_b32 s34, s29, 3
    s_lshl_b32 s34, s34, 2
    s_and_b32 s3, s29, 3
    s_add_u32 s34, s34, s3
    s_add_u32 s34, s34, 4
    s_bitcmp1_b32 s29, 2
    s_cselect_b32 s34, -1, s34
    s_cmp_lt_u32 s29, 8
    s_cselect_b32 s34, s29, s34
    s_lshl_b32 s40, s28, 1
    s_cmp_ge_u32 s34, 10
    s_addc_u32 s40, s40, 0
    s_sub_u32 s41, s34, 10
    s_cmp_ge_u32 s34, 10
    s_cselect_b32 s41, s41, s34
    s_mul_i32 s42, s28, 20
    s_add_u32 s42, s42, s34
    s_and_b32 s42, s42, 255
    s_lshl_b32 s42, s42, 9
    s_add_u32 s42, s42, 524288
    v_mov_b32 v3, 158736
    ds_write2_b32 v3, v7, v7 offset0:0 offset1:1
    ds_write2_b32 v3, v7, v7 offset0:2 offset1:3
    ds_write2_b32 v3, v7, v7 offset0:4 offset1:5
    ds_write2_b32 v3, v7, v7 offset0:6 offset1:7
    ds_write2_b32 v3, v7, v7 offset0:8 offset1:9
    ds_write2_b32 v3, v7, v7 offset0:10 offset1:11
    s_lshr_b32 s31, s28, 1
    s_lshl_b32 s31, s31, 5
    s_lshr_b32 s3, s29, 3
    s_mul_i32 s3, s3, 11
    s_add_u32 s31, s31, s3
    s_sub_u32 s31, s31, 11
    s_and_b32 s32, s28, 1
    s_lshl_b32 s32, s32, 3
    s_and_b32 s3, s29, 7
    s_lshl_b32 s3, s3, 2
    s_lshr_b32 s3, 0x64317520, s3
    s_and_b32 s3, s3, 7
    s_add_u32 s32, s32, s3
    s_and_b32 s35, s29, 3
    s_and_b32 s3, s29, 4
    s_lshl_b32 s3, s3, 1
    s_add_u32 s35, s35, s3
    s_and_b32 s3, s28, 1
    s_lshl_b32 s3, s3, 2
    s_add_u32 s35, s35, s3
    s_or_b32 s56, s31, s54
    v_mov_b32 v37, 0xf149f2ca
    v_lshlrev_b32 v2, 2, v9
    v_sub_u32 v2, v8, v2
    s_cmp_eq_u32 s56, 0
    s_cselect_b32 s3, 0xf149f2ca, 0
    v_subrev_u32 v3, 0, v2
    v_and_b32 v4, 0x80000001, v3
    v_cmp_eq_u32 vcc, 0, v4
    s_nop 1
    v_cndmask_b32 v16, v37, 0, vcc
    v_cmp_eq_u32 vcc, 0x80000000, v4
    s_nop 1
    v_cndmask_b32 v12, v37, 0, vcc
    v_add_f32 v20, s3, v12
    v_subrev_u32 v3, 1, v2
    v_and_b32 v4, 0x80000001, v3
    v_cmp_eq_u32 vcc, 0, v4
    s_nop 1
    v_cndmask_b32 v17, v37, 0, vcc
    v_cmp_eq_u32 vcc, 0x80000000, v4
    s_nop 1
    v_cndmask_b32 v13, v37, 0, vcc
    v_add_f32 v21, s3, v13
    v_subrev_u32 v3, 2, v2
    v_and_b32 v4, 0x80000001, v3
    v_cmp_eq_u32 vcc, 0, v4
    s_nop 1
    v_cndmask_b32 v18, v37, 0, vcc
    v_cmp_eq_u32 vcc, 0x80000000, v4
    s_nop 1
    v_cndmask_b32 v14, v37, 0, vcc
    v_add_f32 v22, s3, v14
    v_subrev_u32 v3, 3, v2
    v_and_b32 v4, 0x80000001, v3
    v_cmp_eq_u32 vcc, 0, v4
    s_nop 1
    v_cndmask_b32 v19, v37, 0, vcc
    v_cmp_eq_u32 vcc, 0x80000000, v4
    s_nop 1
    v_cndmask_b32 v15, v37, 0, vcc
    v_add_f32 v23, s3, v15
    v_mov_b32 v3, 0x0c0c0c0c
    v_mov_b32 v4, 0xc0c0100
    v_cmp_eq_u32 vcc, 0, v12
    v_mov_b32 v5, 0x1000c0c
    s_nop 0
    v_cndmask_b32 v3, v3, v4, vcc
    v_cmp_eq_u32 vcc, 0, v13
    s_nop 1
    v_cndmask_b32 v24, v3, v5, vcc
    v_mov_b32 v3, 0x0c0c0c0c
    v_mov_b32 v4, 0xc0c0302
    v_cmp_eq_u32 vcc, 0, v14
    v_mov_b32 v5, 0x3020c0c
    s_nop 0
    v_cndmask_b32 v3, v3, v4, vcc
    v_cmp_eq_u32 vcc, 0, v15
    s_nop 1
    v_cndmask_b32 v25, v3, v5, vcc
    v_mov_b32 v3, 0x0c0c0c0c
    v_mov_b32 v4, 0xc0c0100
    v_cmp_eq_u32 vcc, 0, v16
    v_mov_b32 v5, 0x1000c0c
    s_nop 0
    v_cndmask_b32 v3, v3, v4, vcc
    v_cmp_eq_u32 vcc, 0, v17
    s_nop 1
    v_cndmask_b32 v26, v3, v5, vcc
    v_mov_b32 v3, 0x0c0c0c0c
    v_mov_b32 v4, 0xc0c0302
    v_cmp_eq_u32 vcc, 0, v18
    v_mov_b32 v5, 0x3020c0c
    s_nop 0
    v_cndmask_b32 v3, v3, v4, vcc
    v_cmp_eq_u32 vcc, 0, v19
    s_nop 1
    v_cndmask_b32 v27, v3, v5, vcc
    s_mul_i32 s3, s55, 1664
    s_mul_i32 s33, s54, 768
    s_add_u32 s3, s3, s33
    s_add_u32 s3, s3, 125952
    v_lshl_add_u32 v2, v9, 2, v10
    v_lshl_add_u32 v33, v2, 3, s3
    v_lshl_add_u32 v2, v8, 3, s3
    v_lshlrev_b32 v3, 3, v1
    v_add_u32 v3, 129280, v3
    v_cmp_eq_u32 vcc, 2, v9
    s_mul_i32 s3, s55, 1536
    s_add_u32 s3, s3, 122880
    v_cndmask_b32 v32, v3, v2, vcc
    v_lshl_add_u32 v34, v1, 3, s3
    s_mul_i32 s3, s54, 1536
    s_add_u32 s3, s3, 131328
    s_lshl3_add_u32 s33, s55, s3
    v_lshl_add_u32 v35, v8, 4, s33
    v_cmp_eq_u32 vcc, 0, v9
    s_nop 1
    v_cndmask_b32 v35, v3, v35, vcc
    s_mul_i32 s33, s55, 768
    s_add_u32 s3, s3, s33
    v_lshl_add_u32 v36, v1, 4, s3
    v_mov_b32 v38, 158720
    s_waitcnt lgkmcnt(0)
    s_add_u32 s20, s6, 0x100000
    s_addc_u32 s21, s7, 0
    s_mov_b32 s22, 0x280000
    s_mov_b32 s23, 0x20000
    s_lshr_b32 s53, s35, 2
    s_add_u32 s58, s53, s35
    s_lshl_b32 s58, s58, 12
    s_mul_i32 s59, s53, 19456
    s_lshl_b32 s53, s35, 8
    s_add_u32 s59, s59, s53
    s_add_u32 s59, s59, 16384
    s_lshr_b32 s53, s31, 5
    s_add_u32 s53, s53, 1
    s_mul_i32 s22, s53, 655360
    s_mov_b32 s53, s31
    s_mul_i32 s3, s54, 6
    s_add_u32 s53, s53, s3
    s_add_u32 s53, s53, 3
    s_lshl_b32 s3, s55, 9
    s_add_u32 s58, s58, s3
    v_and_b32 v4, 1, v9
    v_lshrrev_b32 v5, 1, v9
    v_add_u32 v3, s53, v4
    v_lshrrev_b32 v2, 2, v3
    v_mul_u32_u24 v2, 76, v2
    v_add_lshl_u32 v2, v2, v3, 10
    v_lshl_add_u32 v2, v8, 4, v2
    v_add_u32 v30, s58, v2
    v_lshl_add_u32 v30, v5, 8, v30
    v_subrev_u32 v3, 2, v3
    v_lshrrev_b32 v2, 2, v3
    v_mul_u32_u24 v2, 76, v2
    v_add_lshl_u32 v2, v2, v3, 10
    v_lshl_add_u32 v2, v8, 4, v2
    v_add_u32 v29, s58, v2
    v_lshl_add_u32 v29, v5, 8, v29
    v_or_b32 v4, s54, v4
    v_cmp_eq_u32 vcc, 0, v4
    v_mov_b32 v5, 0x10000000
    v_subrev_u32 v28, 81920, v30
    v_cndmask_b32 v28, v28, v5, vcc
    s_mul_i32 s3, s55, 3
    s_add_u32 s53, s53, s3
    v_add_u32 v3, s53, v9
    v_lshrrev_b32 v2, 2, v3
    v_mul_u32_u24 v2, 76, v2
    v_add_lshl_u32 v2, v2, v3, 10
    v_lshl_add_u32 v2, v8, 4, v2
    v_add_u32 v31, s59, v2
    v_subrev_u32 v31, 81920, v31
    v_or_b32 v4, s30, v9
    v_cmp_eq_u32 vcc, 0, v4
    s_nop 1
    v_cndmask_b32 v31, v31, v5, vcc
    v_cmp_eq_u32 vcc, 3, v9
    s_nop 1
    v_cndmask_b32 v31, v31, v5, vcc
    s_lshr_b32 s3, s31, 3
    s_mul_i32 s3, s3, 5120
    s_add_u32 s3, s3, 524288
    s_and_b32 s33, s31, 31
    s_cselect_b32 s33, 4, 0
    v_mov_b32 v2, s33
    v_cmp_gt_u32 vcc, 10, v1
    v_lshl_add_u32 v37, v1, 9, s3
    s_mov_b32 s37, 0xfffff
    v_cndmask_b32 v2, 0, v2, vcc
    v_add_u32 v37, v37, v2
    s_lshr_b32 s36, s35, 2
    s_add_u32 s36, s36, s35
    s_lshl_b32 s36, 1, s36
    s_cmp_eq_u32 s30, 0
    s_cselect_b32 s36, s36, 0
    s_mov_b32 s58, 0x3fb8aa3b
    s_mov_b32 s59, s58
    s_mov_b32 s60, 0x3e64f92e
    s_mov_b32 s61, s60
    s_cmp_eq_u32 s30, 0
    s_cbranch_scc1 K_CHM0
    s_cmp_eq_u32 s30, 1
    s_cbranch_scc1 K_CHM1
    s_cmp_eq_u32 s30, 2
    s_cbranch_scc1 K_CHM2
    s_branch K_CHM3
K_WRET_M:
    s_setprio 2
    s_barrier
K_L0:
    ds_read_b64_tr_b16 v[196:197], v47 offset:0
    ds_read_b64_tr_b16 v[198:199], v47 offset:1024
    ds_read_b128 v[148:151], v41 offset:0
    ds_read_b64_tr_b16 v[200:201], v48 offset:0
    ds_read_b64_tr_b16 v[202:203], v48 offset:1024
    ds_read_b128 v[152:155], v41 offset:2048
    ds_read_b64_tr_b16 v[204:205], v49 offset:0
    ds_read_b64_tr_b16 v[206:207], v49 offset:1024
    ds_read_b128 v[156:159], v41 offset:4096
    ds_read_b64_tr_b16 v[208:209], v50 offset:0
    ds_read_b64_tr_b16 v[210:211], v50 offset:1024
    ds_read_b128 v[160:163], v41 offset:6144
    ds_read_b128 v[164:167], v41 offset:8192
    ds_read_b128 v[168:171], v41 offset:10240
    s_waitcnt lgkmcnt(0)
    v_mfma_f32_16x16x32_bf16 v[52:55], v[196:199], v[148:151], 0
    ds_read_b64_tr_b16 v[212:213], v47 offset:8192
    v_mfma_f32_16x16x32_bf16 v[56:59], v[200:203], v[148:151], 0
    ds_read_b64_tr_b16 v[214:215], v47 offset:9216
    v_mfma_f32_16x16x32_bf16 v[60:63], v[148:151], v[204:207], 0
    ds_read_b128 v[172:175], v42 offset:0
    v_mfma_f32_16x16x32_bf16 v[64:67], v[208:211], v[148:151], 0
    ds_read_b64_tr_b16 v[216:217], v48 offset:8192
    v_mfma_f32_16x16x32_bf16 v[80:83], v[208:211], v[152:155], 0
    ds_read_b64_tr_b16 v[218:219], v48 offset:9216
    v_mfma_f32_16x16x32_bf16 v[76:79], v[152:155], v[204:207], 0
    ds_read_b128 v[176:179], v42 offset:2048
    v_mfma_f32_16x16x32_bf16 v[72:75], v[200:203], v[152:155], 0
    ds_read_b64_tr_b16 v[220:221], v49 offset:8192
    v_mfma_f32_16x16x32_bf16 v[68:71], v[196:199], v[152:155], 0
    ds_read_b64_tr_b16 v[222:223], v49 offset:9216
    v_mfma_f32_16x16x32_bf16 v[84:87], v[196:199], v[156:159], 0
    ds_read_b128 v[180:183], v42 offset:4096
    v_mfma_f32_16x16x32_bf16 v[88:91], v[200:203], v[156:159], 0
    ds_read_b64_tr_b16 v[224:225], v50 offset:8192
    v_mfma_f32_16x16x32_bf16 v[92:95], v[156:159], v[204:207], 0
    ds_read_b64_tr_b16 v[226:227], v50 offset:9216
    v_mfma_f32_16x16x32_bf16 v[96:99], v[208:211], v[156:159], 0
    ds_read_b128 v[184:187], v42 offset:6144
    v_mfma_f32_16x16x32_bf16 v[112:115], v[208:211], v[160:163], 0
    ds_read_b128 v[188:191], v42 offset:8192
    v_mfma_f32_16x16x32_bf16 v[108:111], v[160:163], v[204:207], 0
    ds_read_b128 v[192:195], v42 offset:10240
    v_mfma_f32_16x16x32_bf16 v[104:107], v[200:203], v[160:163], 0
    v_mfma_f32_16x16x32_bf16 v[100:103], v[196:199], v[160:163], 0
    v_mfma_f32_16x16x32_bf16 v[116:119], v[196:199], v[164:167], 0
    v_mfma_f32_16x16x32_bf16 v[120:123], v[200:203], v[164:167], 0
    v_mfma_f32_16x16x32_bf16 v[124:127], v[164:167], v[204:207], 0
    v_mfma_f32_16x16x32_bf16 v[128:131], v[208:211], v[164:167], 0
    v_mfma_f32_16x16x32_bf16 v[144:147], v[208:211], v[168:171], 0
    v_mfma_f32_16x16x32_bf16 v[140:143], v[168:171], v[204:207], 0
    v_mfma_f32_16x16x32_bf16 v[136:139], v[200:203], v[168:171], 0
    v_mfma_f32_16x16x32_bf16 v[132:135], v[196:199], v[168:171], 0
    s_waitcnt lgkmcnt(0)
    s_barrier
    v_mfma_f32_16x16x32_bf16 v[52:55], v[212:215], v[172:175], v[52:55]
    ds_read_b64_tr_b16 v[196:197], v43 offset:0
    v_mfma_f32_16x16x32_bf16 v[56:59], v[216:219], v[172:175], v[56:59]
    ds_read_b64_tr_b16 v[198:199], v43 offset:1024
    v_mfma_f32_16x16x32_bf16 v[60:63], v[172:175], v[220:223], v[60:63]
    ds_read_b128 v[148:151], v39 offset:0
    v_mfma_f32_16x16x32_bf16 v[64:67], v[224:227], v[172:175], v[64:67]
    ds_read_b64_tr_b16 v[200:201], v44 offset:0
    v_mfma_f32_16x16x32_bf16 v[80:83], v[224:227], v[176:179], v[80:83]
    ds_read_b64_tr_b16 v[202:203], v44 offset:1024
    v_mfma_f32_16x16x32_bf16 v[76:79], v[176:179], v[220:223], v[76:79]
    ds_read_b128 v[152:155], v39 offset:2048
    v_mfma_f32_16x16x32_bf16 v[72:75], v[216:219], v[176:179], v[72:75]
    ds_read_b64_tr_b16 v[204:205], v45 offset:0
    v_mfma_f32_16x16x32_bf16 v[68:71], v[212:215], v[176:179], v[68:71]
    ds_read_b64_tr_b16 v[206:207], v45 offset:1024
    v_mfma_f32_16x16x32_bf16 v[84:87], v[212:215], v[180:183], v[84:87]
    ds_read_b128 v[156:159], v39 offset:4096
    v_mfma_f32_16x16x32_bf16 v[88:91], v[216:219], v[180:183], v[88:91]
    ds_read_b64_tr_b16 v[208:209], v46 offset:0
    v_mfma_f32_16x16x32_bf16 v[92:95], v[180:183], v[220:223], v[92:95]
    ds_read_b64_tr_b16 v[210:211], v46 offset:1024
    v_mfma_f32_16x16x32_bf16 v[96:99], v[224:227], v[180:183], v[96:99]
    ds_read_b128 v[160:163], v39 offset:6144
    v_mfma_f32_16x16x32_bf16 v[112:115], v[224:227], v[184:187], v[112:115]
    ds_read_b128 v[164:167], v39 offset:8192
    v_mfma_f32_16x16x32_bf16 v[108:111], v[184:187], v[220:223], v[108:111]
    ds_read_b128 v[168:171], v39 offset:10240
    v_mfma_f32_16x16x32_bf16 v[104:107], v[216:219], v[184:187], v[104:107]
    v_mfma_f32_16x16x32_bf16 v[100:103], v[212:215], v[184:187], v[100:103]
    v_mfma_f32_16x16x32_bf16 v[116:119], v[212:215], v[188:191], v[116:119]
    v_mfma_f32_16x16x32_bf16 v[120:123], v[216:219], v[188:191], v[120:123]
    v_mfma_f32_16x16x32_bf16 v[124:127], v[188:191], v[220:223], v[124:127]
    v_mfma_f32_16x16x32_bf16 v[128:131], v[224:227], v[188:191], v[128:131]
    v_mfma_f32_16x16x32_bf16 v[144:147], v[224:227], v[192:195], v[144:147]
    v_mfma_f32_16x16x32_bf16 v[140:143], v[192:195], v[220:223], v[140:143]
    v_mfma_f32_16x16x32_bf16 v[136:139], v[216:219], v[192:195], v[136:139]
    v_mfma_f32_16x16x32_bf16 v[132:135], v[212:215], v[192:195], v[132:135]
    s_waitcnt lgkmcnt(0)
    v_mfma_f32_16x16x32_bf16 v[52:55], v[196:199], v[148:151], v[52:55]
    ds_read_b64_tr_b16 v[212:213], v43 offset:8192
    v_mfma_f32_16x16x32_bf16 v[56:59], v[200:203], v[148:151], v[56:59]
    ds_read_b64_tr_b16 v[214:215], v43 offset:9216
    v_mfma_f32_16x16x32_bf16 v[60:63], v[148:151], v[204:207], v[60:63]
    ds_read_b128 v[172:175], v40 offset:0
    v_mfma_f32_16x16x32_bf16 v[64:67], v[208:211], v[148:151], v[64:67]
    ds_read_b64_tr_b16 v[216:217], v44 offset:8192
    v_mfma_f32_16x16x32_bf16 v[80:83], v[208:211], v[152:155], v[80:83]
    ds_read_b64_tr_b16 v[218:219], v44 offset:9216
    v_mfma_f32_16x16x32_bf16 v[76:79], v[152:155], v[204:207], v[76:79]
    ds_read_b128 v[176:179], v40 offset:2048
    v_mfma_f32_16x16x32_bf16 v[72:75], v[200:203], v[152:155], v[72:75]
    ds_read_b64_tr_b16 v[220:221], v45 offset:8192
    v_mfma_f32_16x16x32_bf16 v[68:71], v[196:199], v[152:155], v[68:71]
    ds_read_b64_tr_b16 v[222:223], v45 offset:9216
    v_mfma_f32_16x16x32_bf16 v[84:87], v[196:199], v[156:159], v[84:87]
    ds_read_b128 v[180:183], v40 offset:4096
    v_mfma_f32_16x16x32_bf16 v[88:91], v[200:203], v[156:159], v[88:91]
    ds_read_b64_tr_b16 v[224:225], v46 offset:8192
    v_mfma_f32_16x16x32_bf16 v[92:95], v[156:159], v[204:207], v[92:95]
    ds_read_b64_tr_b16 v[226:227], v46 offset:9216
    v_mfma_f32_16x16x32_bf16 v[96:99], v[208:211], v[156:159], v[96:99]
    ds_read_b128 v[184:187], v40 offset:6144
    v_mfma_f32_16x16x32_bf16 v[112:115], v[208:211], v[160:163], v[112:115]
    ds_read_b128 v[188:191], v40 offset:8192
    v_mfma_f32_16x16x32_bf16 v[108:111], v[160:163], v[204:207], v[108:111]
    ds_read_b128 v[192:195], v40 offset:10240
    s_branch K_PG1
.p2align 12
K_CHM1:
K_STM1:
    s_branch K_WRET_M
    s_nop 0
K_PG1:
    v_mfma_f32_16x16x32_bf16 v[104:107], v[200:203], v[160:163], v[104:107]
    v_mfma_f32_16x16x32_bf16 v[100:103], v[196:199], v[160:163], v[100:103]
    v_mfma_f32_16x16x32_bf16 v[116:119], v[196:199], v[164:167], v[116:119]
    v_mfma_f32_16x16x32_bf16 v[120:123], v[200:203], v[164:167], v[120:123]
    v_mfma_f32_16x16x32_bf16 v[124:127], v[164:167], v[204:207], v[124:127]
    v_mfma_f32_16x16x32_bf16 v[128:131], v[208:211], v[164:167], v[128:131]
    v_mfma_f32_16x16x32_bf16 v[144:147], v[208:211], v[168:171], v[144:147]
    v_mfma_f32_16x16x32_bf16 v[140:143], v[168:171], v[204:207], v[140:143]
    v_mfma_f32_16x16x32_bf16 v[136:139], v[200:203], v[168:171], v[136:139]
    v_mfma_f32_16x16x32_bf16 v[132:135], v[196:199], v[168:171], v[132:135]
    s_waitcnt lgkmcnt(0)
    s_barrier
    v_mfma_f32_16x16x32_bf16 v[52:55], v[212:215], v[172:175], v[52:55]
    ds_read_b64_tr_b16 v[196:197], v43 offset:40960
    v_mfma_f32_16x16x32_bf16 v[56:59], v[216:219], v[172:175], v[56:59]
    ds_read_b64_tr_b16 v[198:199], v43 offset:41984
    v_mfma_f32_16x16x32_bf16 v[60:63], v[172:175], v[220:223], v[60:63]
    ds_read_b128 v[148:151], v39 offset:40960
    v_mfma_f32_16x16x32_bf16 v[64:67], v[224:227], v[172:175], v[64:67]
    ds_read_b64_tr_b16 v[200:201], v44 offset:40960
    v_mfma_f32_16x16x32_bf16 v[80:83], v[224:227], v[176:179], v[80:83]
    ds_read_b64_tr_b16 v[202:203], v44 offset:41984
    v_mfma_f32_16x16x32_bf16 v[76:79], v[176:179], v[220:223], v[76:79]
    ds_read_b128 v[152:155], v39 offset:43008
    v_mfma_f32_16x16x32_bf16 v[72:75], v[216:219], v[176:179], v[72:75]
    ds_read_b64_tr_b16 v[204:205], v45 offset:40960
    v_mfma_f32_16x16x32_bf16 v[68:71], v[212:215], v[176:179], v[68:71]
    ds_read_b64_tr_b16 v[206:207], v45 offset:41984
    v_mfma_f32_16x16x32_bf16 v[84:87], v[212:215], v[180:183], v[84:87]
    ds_read_b128 v[156:159], v39 offset:45056
    v_mfma_f32_16x16x32_bf16 v[88:91], v[216:219], v[180:183], v[88:91]
    ds_read_b64_tr_b16 v[208:209], v46 offset:40960
    v_mfma_f32_16x16x32_bf16 v[92:95], v[180:183], v[220:223], v[92:95]
    ds_read_b64_tr_b16 v[210:211], v46 offset:41984
    v_mfma_f32_16x16x32_bf16 v[96:99], v[224:227], v[180:183], v[96:99]
    ds_read_b128 v[160:163], v39 offset:47104
    v_mfma_f32_16x16x32_bf16 v[112:115], v[224:227], v[184:187], v[112:115]
    ds_read_b128 v[164:167], v39 offset:49152
    v_mfma_f32_16x16x32_bf16 v[108:111], v[184:187], v[220:223], v[108:111]
    ds_read_b128 v[168:171], v39 offset:51200
    v_mfma_f32_16x16x32_bf16 v[104:107], v[216:219], v[184:187], v[104:107]
    v_mfma_f32_16x16x32_bf16 v[100:103], v[212:215], v[184:187], v[100:103]
    v_mfma_f32_16x16x32_bf16 v[116:119], v[212:215], v[188:191], v[116:119]
    v_mfma_f32_16x16x32_bf16 v[120:123], v[216:219], v[188:191], v[120:123]
    v_mfma_f32_16x16x32_bf16 v[124:127], v[188:191], v[220:223], v[124:127]
    v_mfma_f32_16x16x32_bf16 v[128:131], v[224:227], v[188:191], v[128:131]
    v_mfma_f32_16x16x32_bf16 v[144:147], v[224:227], v[192:195], v[144:147]
    v_mfma_f32_16x16x32_bf16 v[140:143], v[192:195], v[220:223], v[140:143]
    v_mfma_f32_16x16x32_bf16 v[136:139], v[216:219], v[192:195], v[136:139]
    v_mfma_f32_16x16x32_bf16 v[132:135], v[212:215], v[192:195], v[132:135]
    s_waitcnt lgkmcnt(0)
    v_mfma_f32_16x16x32_bf16 v[52:55], v[196:199], v[148:151], v[52:55]
    ds_read_b64_tr_b16 v[212:213], v43 offset:49152
    v_mfma_f32_16x16x32_bf16 v[56:59], v[200:203], v[148:151], v[56:59]
    ds_read_b64_tr_b16 v[214:215], v43 offset:50176
    v_mfma_f32_16x16x32_bf16 v[60:63], v[148:151], v[204:207], v[60:63]
    ds_read_b128 v[172:175], v40 offset:40960
    v_mfma_f32_16x16x32_bf16 v[64:67], v[208:211], v[148:151], v[64:67]
    ds_read_b64_tr_b16 v[216:217], v44 offset:49152
    v_mfma_f32_16x16x32_bf16 v[80:83], v[208:211], v[152:155], v[80:83]
    ds_read_b64_tr_b16 v[218:219], v44 offset:50176
    v_mfma_f32_16x16x32_bf16 v[76:79], v[152:155], v[204:207], v[76:79]
    ds_read_b128 v[176:179], v40 offset:43008
    v_mfma_f32_16x16x32_bf16 v[72:75], v[200:203], v[152:155], v[72:75]
    ds_read_b64_tr_b16 v[220:221], v45 offset:49152
    v_mfma_f32_16x16x32_bf16 v[68:71], v[196:199], v[152:155], v[68:71]
    ds_read_b64_tr_b16 v[222:223], v45 offset:50176
    v_mfma_f32_16x16x32_bf16 v[84:87], v[196:199], v[156:159], v[84:87]
    ds_read_b128 v[180:183], v40 offset:45056
    v_mfma_f32_16x16x32_bf16 v[88:91], v[200:203], v[156:159], v[88:91]
    ds_read_b64_tr_b16 v[224:225], v46 offset:49152
    v_mfma_f32_16x16x32_bf16 v[92:95], v[156:159], v[204:207], v[92:95]
    ds_read_b64_tr_b16 v[226:227], v46 offset:50176
    v_mfma_f32_16x16x32_bf16 v[96:99], v[208:211], v[156:159], v[96:99]
    ds_read_b128 v[184:187], v40 offset:47104
    v_mfma_f32_16x16x32_bf16 v[112:115], v[208:211], v[160:163], v[112:115]
    ds_read_b128 v[188:191], v40 offset:49152
    v_mfma_f32_16x16x32_bf16 v[108:111], v[160:163], v[204:207], v[108:111]
    ds_read_b128 v[192:195], v40 offset:51200
    v_mfma_f32_16x16x32_bf16 v[104:107], v[200:203], v[160:163], v[104:107]
    v_mfma_f32_16x16x32_bf16 v[100:103], v[196:199], v[160:163], v[100:103]
    v_mfma_f32_16x16x32_bf16 v[116:119], v[196:199], v[164:167], v[116:119]
    v_mfma_f32_16x16x32_bf16 v[120:123], v[200:203], v[164:167], v[120:123]
    v_mfma_f32_16x16x32_bf16 v[124:127], v[164:167], v[204:207], v[124:127]
    v_mfma_f32_16x16x32_bf16 v[128:131], v[208:211], v[164:167], v[128:131]
    v_mfma_f32_16x16x32_bf16 v[144:147], v[208:211], v[168:171], v[144:147]
    v_mfma_f32_16x16x32_bf16 v[140:143], v[168:171], v[204:207], v[140:143]
    v_mfma_f32_16x16x32_bf16 v[136:139], v[200:203], v[168:171], v[136:139]
    v_mfma_f32_16x16x32_bf16 v[132:135], v[196:199], v[168:171], v[132:135]
    s_waitcnt lgkmcnt(0)
    s_barrier
    v_mfma_f32_16x16x32_bf16 v[52:55], v[212:215], v[172:175], v[52:55]
    ds_read_b64_tr_b16 v[196:197], v47 offset:0
    v_mfma_f32_16x16x32_bf16 v[56:59], v[216:219], v[172:175], v[56:59]
    ds_read_b64_tr_b16 v[198:199], v47 offset:1024
    v_mfma_f32_16x16x32_bf16 v[60:63], v[172:175], v[220:223], v[60:63]
    ds_read_b128 v[148:151], v41 offset:0
    v_mfma_f32_16x16x32_bf16 v[64:67], v[224:227], v[172:175], v[64:67]
    ds_read_b64_tr_b16 v[200:201], v48 offset:0
    v_mfma_f32_16x16x32_bf16 v[80:83], v[224:227], v[176:179], v[80:83]
    ds_read_b64_tr_b16 v[202:203], v48 offset:1024
    v_mfma_f32_16x16x32_bf16 v[76:79], v[176:179], v[220:223], v[76:79]
    ds_read_b128 v[152:155], v41 offset:2048
    v_mfma_f32_16x16x32_bf16 v[72:75], v[216:219], v[176:179], v[72:75]
    ds_read_b64_tr_b16 v[204:205], v49 offset:0
    v_mfma_f32_16x16x32_bf16 v[68:71], v[212:215], v[176:179], v[68:71]
    ds_read_b64_tr_b16 v[206:207], v49 offset:1024
    v_mfma_f32_16x16x32_bf16 v[84:87], v[212:215], v[180:183], v[84:87]
    ds_read_b128 v[156:159], v41 offset:4096
    v_mfma_f32_16x16x32_bf16 v[88:91], v[216:219], v[180:183], v[88:91]
    ds_read_b64_tr_b16 v[208:209], v50 offset:0
    v_mfma_f32_16x16x32_bf16 v[92:95], v[180:183], v[220:223], v[92:95]
    ds_read_b64_tr_b16 v[210:211], v50 offset:1024
    v_mfma_f32_16x16x32_bf16 v[96:99], v[224:227], v[180:183], v[96:99]
    ds_read_b128 v[160:163], v41 offset:6144
    v_mfma_f32_16x16x32_bf16 v[112:115], v[224:227], v[184:187], v[112:115]
    ds_read_b128 v[164:167], v41 offset:8192
    v_mfma_f32_16x16x32_bf16 v[108:111], v[184:187], v[220:223], v[108:111]
    ds_read_b128 v[168:171], v41 offset:10240
    v_mfma_f32_16x16x32_bf16 v[104:107], v[216:219], v[184:187], v[104:107]
    v_mfma_f32_16x16x32_bf16 v[100:103], v[212:215], v[184:187], v[100:103]
    v_mfma_f32_16x16x32_bf16 v[116:119], v[212:215], v[188:191], v[116:119]
    v_mfma_f32_16x16x32_bf16 v[120:123], v[216:219], v[188:191], v[120:123]
    v_mfma_f32_16x16x32_bf16 v[124:127], v[188:191], v[220:223], v[124:127]
    v_mfma_f32_16x16x32_bf16 v[128:131], v[224:227], v[188:191], v[128:131]
    v_mfma_f32_16x16x32_bf16 v[144:147], v[224:227], v[192:195], v[144:147]
    v_mfma_f32_16x16x32_bf16 v[140:143], v[192:195], v[220:223], v[140:143]
    v_mfma_f32_16x16x32_bf16 v[136:139], v[216:219], v[192:195], v[136:139]
    v_mfma_f32_16x16x32_bf16 v[132:135], v[212:215], v[192:195], v[132:135]
    s_waitcnt lgkmcnt(0)
    v_mfma_f32_16x16x32_bf16 v[52:55], v[196:199], v[148:151], v[52:55]
    ds_read_b64_tr_b16 v[212:213], v47 offset:8192
    v_mfma_f32_16x16x32_bf16 v[56:59], v[200:203], v[148:151], v[56:59]
    ds_read_b64_tr_b16 v[214:215], v47 offset:9216
    v_mfma_f32_16x16x32_bf16 v[60:63], v[148:151], v[204:207], v[60:63]
    ds_read_b128 v[172:175], v42 offset:0
    v_mfma_f32_16x16x32_bf16 v[64:67], v[208:211], v[148:151], v[64:67]
    ds_read_b64_tr_b16 v[216:217], v48 offset:8192
    v_mfma_f32_16x16x32_bf16 v[80:83], v[208:211], v[152:155], v[80:83]
    ds_read_b64_tr_b16 v[218:219], v48 offset:9216
    v_mfma_f32_16x16x32_bf16 v[76:79], v[152:155], v[204:207], v[76:79]
    ds_read_b128 v[176:179], v42 offset:2048
    v_mfma_f32_16x16x32_bf16 v[72:75], v[200:203], v[152:155], v[72:75]
    ds_read_b64_tr_b16 v[220:221], v49 offset:8192
    v_mfma_f32_16x16x32_bf16 v[68:71], v[196:199], v[152:155], v[68:71]
    ds_read_b64_tr_b16 v[222:223], v49 offset:9216
    v_mfma_f32_16x16x32_bf16 v[84:87], v[196:199], v[156:159], v[84:87]
    ds_read_b128 v[180:183], v42 offset:4096
    v_mfma_f32_16x16x32_bf16 v[88:91], v[200:203], v[156:159], v[88:91]
    ds_read_b64_tr_b16 v[224:225], v50 offset:8192
    v_mfma_f32_16x16x32_bf16 v[92:95], v[156:159], v[204:207], v[92:95]
    ds_read_b64_tr_b16 v[226:227], v50 offset:9216
    v_mfma_f32_16x16x32_bf16 v[96:99], v[208:211], v[156:159], v[96:99]
    ds_read_b128 v[184:187], v42 offset:6144
    v_mfma_f32_16x16x32_bf16 v[112:115], v[208:211], v[160:163], v[112:115]
    ds_read_b128 v[188:191], v42 offset:8192
    v_mfma_f32_16x16x32_bf16 v[108:111], v[160:163], v[204:207], v[108:111]
    ds_read_b128 v[192:195], v42 offset:10240
    v_mfma_f32_16x16x32_bf16 v[104:107], v[200:203], v[160:163], v[104:107]
    v_mfma_f32_16x16x32_bf16 v[100:103], v[196:199], v[160:163], v[100:103]
    v_mfma_f32_16x16x32_bf16 v[116:119], v[196:199], v[164:167], v[116:119]
    v_mfma_f32_16x16x32_bf16 v[120:123], v[200:203], v[164:167], v[120:123]
    v_mfma_f32_16x16x32_bf16 v[124:127], v[164:167], v[204:207], v[124:127]
    v_mfma_f32_16x16x32_bf16 v[128:131], v[208:211], v[164:167], v[128:131]
    v_mfma_f32_16x16x32_bf16 v[144:147], v[208:211], v[168:171], v[144:147]
    v_mfma_f32_16x16x32_bf16 v[140:143], v[168:171], v[204:207], v[140:143]
    v_mfma_f32_16x16x32_bf16 v[136:139], v[200:203], v[168:171], v[136:139]
    v_mfma_f32_16x16x32_bf16 v[132:135], v[196:199], v[168:171], v[132:135]
    s_waitcnt lgkmcnt(0)
    s_barrier
    v_mfma_f32_16x16x32_bf16 v[52:55], v[212:215], v[172:175], v[52:55]
    ds_read_b64_tr_b16 v[196:197], v43 offset:0
    v_mfma_f32_16x16x32_bf16 v[56:59], v[216:219], v[172:175], v[56:59]
    ds_read_b64_tr_b16 v[198:199], v43 offset:1024
    v_mfma_f32_16x16x32_bf16 v[60:63], v[172:175], v[220:223], v[60:63]
    ds_read_b128 v[148:151], v39 offset:0
    v_mfma_f32_16x16x32_bf16 v[64:67], v[224:227], v[172:175], v[64:67]
    ds_read_b64_tr_b16 v[200:201], v44 offset:0
    v_mfma_f32_16x16x32_bf16 v[80:83], v[224:227], v[176:179], v[80:83]
    ds_read_b64_tr_b16 v[202:203], v44 offset:1024
    v_mfma_f32_16x16x32_bf16 v[76:79], v[176:179], v[220:223], v[76:79]
    ds_read_b128 v[152:155], v39 offset:2048
    v_mfma_f32_16x16x32_bf16 v[72:75], v[216:219], v[176:179], v[72:75]
    ds_read_b64_tr_b16 v[204:205], v45 offset:0
    v_mfma_f32_16x16x32_bf16 v[68:71], v[212:215], v[176:179], v[68:71]
    ds_read_b64_tr_b16 v[206:207], v45 offset:1024
    v_mfma_f32_16x16x32_bf16 v[84:87], v[212:215], v[180:183], v[84:87]
    ds_read_b128 v[156:159], v39 offset:4096
    v_mfma_f32_16x16x32_bf16 v[88:91], v[216:219], v[180:183], v[88:91]
    ds_read_b64_tr_b16 v[208:209], v46 offset:0
    v_mfma_f32_16x16x32_bf16 v[92:95], v[180:183], v[220:223], v[92:95]
    ds_read_b64_tr_b16 v[210:211], v46 offset:1024
    v_mfma_f32_16x16x32_bf16 v[96:99], v[224:227], v[180:183], v[96:99]
    ds_read_b128 v[160:163], v39 offset:6144
    v_mfma_f32_16x16x32_bf16 v[112:115], v[224:227], v[184:187], v[112:115]
    ds_read_b128 v[164:167], v39 offset:8192
    v_mfma_f32_16x16x32_bf16 v[108:111], v[184:187], v[220:223], v[108:111]
    ds_read_b128 v[168:171], v39 offset:10240
    v_mfma_f32_16x16x32_bf16 v[104:107], v[216:219], v[184:187], v[104:107]
    v_mfma_f32_16x16x32_bf16 v[100:103], v[212:215], v[184:187], v[100:103]
    v_mfma_f32_16x16x32_bf16 v[116:119], v[212:215], v[188:191], v[116:119]
    v_mfma_f32_16x16x32_bf16 v[120:123], v[216:219], v[188:191], v[120:123]
    v_mfma_f32_16x16x32_bf16 v[124:127], v[188:191], v[220:223], v[124:127]
    v_mfma_f32_16x16x32_bf16 v[128:131], v[224:227], v[188:191], v[128:131]
    v_mfma_f32_16x16x32_bf16 v[144:147], v[224:227], v[192:195], v[144:147]
    v_mfma_f32_16x16x32_bf16 v[140:143], v[192:195], v[220:223], v[140:143]
    v_mfma_f32_16x16x32_bf16 v[136:139], v[216:219], v[192:195], v[136:139]
    v_mfma_f32_16x16x32_bf16 v[132:135], v[212:215], v[192:195], v[132:135]
    s_waitcnt lgkmcnt(0)
    v_mfma_f32_16x16x32_bf16 v[52:55], v[196:199], v[148:151], v[52:55]
    ds_read_b64_tr_b16 v[212:213], v43 offset:8192
    v_mfma_f32_16x16x32_bf16 v[56:59], v[200:203], v[148:151], v[56:59]
    ds_read_b64_tr_b16 v[214:215], v43 offset:9216
    v_mfma_f32_16x16x32_bf16 v[60:63], v[148:151], v[204:207], v[60:63]
    ds_read_b128 v[172:175], v40 offset:0
    v_mfma_f32_16x16x32_bf16 v[64:67], v[208:211], v[148:151], v[64:67]
    ds_read_b64_tr_b16 v[216:217], v44 offset:8192
    v_mfma_f32_16x16x32_bf16 v[80:83], v[208:211], v[152:155], v[80:83]
    ds_read_b64_tr_b16 v[218:219], v44 offset:9216
    v_mfma_f32_16x16x32_bf16 v[76:79], v[152:155], v[204:207], v[76:79]
    ds_read_b128 v[176:179], v40 offset:2048
    v_mfma_f32_16x16x32_bf16 v[72:75], v[200:203], v[152:155], v[72:75]
    ds_read_b64_tr_b16 v[220:221], v45 offset:8192
    v_mfma_f32_16x16x32_bf16 v[68:71], v[196:199], v[152:155], v[68:71]
    ds_read_b64_tr_b16 v[222:223], v45 offset:9216
    v_mfma_f32_16x16x32_bf16 v[84:87], v[196:199], v[156:159], v[84:87]
    ds_read_b128 v[180:183], v40 offset:4096
    v_mfma_f32_16x16x32_bf16 v[88:91], v[200:203], v[156:159], v[88:91]
    ds_read_b64_tr_b16 v[224:225], v46 offset:8192
    v_mfma_f32_16x16x32_bf16 v[92:95], v[156:159], v[204:207], v[92:95]
    ds_read_b64_tr_b16 v[226:227], v46 offset:9216
    v_mfma_f32_16x16x32_bf16 v[96:99], v[208:211], v[156:159], v[96:99]
    ds_read_b128 v[184:187], v40 offset:6144
    v_mfma_f32_16x16x32_bf16 v[112:115], v[208:211], v[160:163], v[112:115]
    ds_read_b128 v[188:191], v40 offset:8192
    v_mfma_f32_16x16x32_bf16 v[108:111], v[160:163], v[204:207], v[108:111]
    ds_read_b128 v[192:195], v40 offset:10240
    v_mfma_f32_16x16x32_bf16 v[104:107], v[200:203], v[160:163], v[104:107]
    v_mfma_f32_16x16x32_bf16 v[100:103], v[196:199], v[160:163], v[100:103]
    v_mfma_f32_16x16x32_bf16 v[116:119], v[196:199], v[164:167], v[116:119]
    v_mfma_f32_16x16x32_bf16 v[120:123], v[200:203], v[164:167], v[120:123]
    v_mfma_f32_16x16x32_bf16 v[124:127], v[164:167], v[204:207], v[124:127]
    v_mfma_f32_16x16x32_bf16 v[128:131], v[208:211], v[164:167], v[128:131]
    v_mfma_f32_16x16x32_bf16 v[144:147], v[208:211], v[168:171], v[144:147]
    v_mfma_f32_16x16x32_bf16 v[140:143], v[168:171], v[204:207], v[140:143]
    v_mfma_f32_16x16x32_bf16 v[136:139], v[200:203], v[168:171], v[136:139]
    v_mfma_f32_16x16x32_bf16 v[132:135], v[196:199], v[168:171], v[132:135]
    s_waitcnt lgkmcnt(0)
    s_barrier
    v_mfma_f32_16x16x32_bf16 v[52:55], v[212:215], v[172:175], v[52:55]
    ds_read_b64_tr_b16 v[196:197], v43 offset:40960
    v_mfma_f32_16x16x32_bf16 v[56:59], v[216:219], v[172:175], v[56:59]
    ds_read_b64_tr_b16 v[198:199], v43 offset:41984
    v_mfma_f32_16x16x32_bf16 v[60:63], v[172:175], v[220:223], v[60:63]
    ds_read_b128 v[148:151], v39 offset:40960
    v_mfma_f32_16x16x32_bf16 v[64:67], v[224:227], v[172:175], v[64:67]
    ds_read_b64_tr_b16 v[200:201], v44 offset:40960
    v_mfma_f32_16x16x32_bf16 v[80:83], v[224:227], v[176:179], v[80:83]
    ds_read_b64_tr_b16 v[202:203], v44 offset:41984
    v_mfma_f32_16x16x32_bf16 v[76:79], v[176:179], v[220:223], v[76:79]
    ds_read_b128 v[152:155], v39 offset:43008
    v_mfma_f32_16x16x32_bf16 v[72:75], v[216:219], v[176:179], v[72:75]
    ds_read_b64_tr_b16 v[204:205], v45 offset:40960
    v_mfma_f32_16x16x32_bf16 v[68:71], v[212:215], v[176:179], v[68:71]
    ds_read_b64_tr_b16 v[206:207], v45 offset:41984
    v_mfma_f32_16x16x32_bf16 v[84:87], v[212:215], v[180:183], v[84:87]
    ds_read_b128 v[156:159], v39 offset:45056
    v_mfma_f32_16x16x32_bf16 v[88:91], v[216:219], v[180:183], v[88:91]
    ds_read_b64_tr_b16 v[208:209], v46 offset:40960
    v_mfma_f32_16x16x32_bf16 v[92:95], v[180:183], v[220:223], v[92:95]
    ds_read_b64_tr_b16 v[210:211], v46 offset:41984
    v_mfma_f32_16x16x32_bf16 v[96:99], v[224:227], v[180:183], v[96:99]
    ds_read_b128 v[160:163], v39 offset:47104
    v_mfma_f32_16x16x32_bf16 v[112:115], v[224:227], v[184:187], v[112:115]
    ds_read_b128 v[164:167], v39 offset:49152
    v_mfma_f32_16x16x32_bf16 v[108:111], v[184:187], v[220:223], v[108:111]
    ds_read_b128 v[168:171], v39 offset:51200
    v_mfma_f32_16x16x32_bf16 v[104:107], v[216:219], v[184:187], v[104:107]
    v_mfma_f32_16x16x32_bf16 v[100:103], v[212:215], v[184:187], v[100:103]
    v_mfma_f32_16x16x32_bf16 v[116:119], v[212:215], v[188:191], v[116:119]
    v_mfma_f32_16x16x32_bf16 v[120:123], v[216:219], v[188:191], v[120:123]
    v_mfma_f32_16x16x32_bf16 v[124:127], v[188:191], v[220:223], v[124:127]
    v_mfma_f32_16x16x32_bf16 v[128:131], v[224:227], v[188:191], v[128:131]
    v_mfma_f32_16x16x32_bf16 v[144:147], v[224:227], v[192:195], v[144:147]
    v_mfma_f32_16x16x32_bf16 v[140:143], v[192:195], v[220:223], v[140:143]
    v_mfma_f32_16x16x32_bf16 v[136:139], v[216:219], v[192:195], v[136:139]
    v_mfma_f32_16x16x32_bf16 v[132:135], v[212:215], v[192:195], v[132:135]
    s_waitcnt lgkmcnt(0)
    v_mfma_f32_16x16x32_bf16 v[52:55], v[196:199], v[148:151], v[52:55]
    ds_read_b64_tr_b16 v[212:213], v43 offset:49152
    v_mfma_f32_16x16x32_bf16 v[56:59], v[200:203], v[148:151], v[56:59]
    ds_read_b64_tr_b16 v[214:215], v43 offset:50176
    v_mfma_f32_16x16x32_bf16 v[60:63], v[148:151], v[204:207], v[60:63]
    ds_read_b128 v[172:175], v40 offset:40960
    v_mfma_f32_16x16x32_bf16 v[64:67], v[208:211], v[148:151], v[64:67]
    ds_read_b64_tr_b16 v[216:217], v44 offset:49152
    v_mfma_f32_16x16x32_bf16 v[80:83], v[208:211], v[152:155], v[80:83]
    ds_read_b64_tr_b16 v[218:219], v44 offset:50176
    v_mfma_f32_16x16x32_bf16 v[76:79], v[152:155], v[204:207], v[76:79]
    ds_read_b128 v[176:179], v40 offset:43008
    v_mfma_f32_16x16x32_bf16 v[72:75], v[200:203], v[152:155], v[72:75]
    ds_read_b64_tr_b16 v[220:221], v45 offset:49152
    v_mfma_f32_16x16x32_bf16 v[68:71], v[196:199], v[152:155], v[68:71]
    ds_read_b64_tr_b16 v[222:223], v45 offset:50176
    v_mfma_f32_16x16x32_bf16 v[84:87], v[196:199], v[156:159], v[84:87]
    ds_read_b128 v[180:183], v40 offset:45056
    v_mfma_f32_16x16x32_bf16 v[88:91], v[200:203], v[156:159], v[88:91]
    ds_read_b64_tr_b16 v[224:225], v46 offset:49152
    v_mfma_f32_16x16x32_bf16 v[92:95], v[156:159], v[204:207], v[92:95]
    ds_read_b64_tr_b16 v[226:227], v46 offset:50176
    v_mfma_f32_16x16x32_bf16 v[96:99], v[208:211], v[156:159], v[96:99]
    ds_read_b128 v[184:187], v40 offset:47104
    v_mfma_f32_16x16x32_bf16 v[112:115], v[208:211], v[160:163], v[112:115]
    ds_read_b128 v[188:191], v40 offset:49152
    v_mfma_f32_16x16x32_bf16 v[108:111], v[160:163], v[204:207], v[108:111]
    ds_read_b128 v[192:195], v40 offset:51200
    v_mfma_f32_16x16x32_bf16 v[104:107], v[200:203], v[160:163], v[104:107]
    v_mfma_f32_16x16x32_bf16 v[100:103], v[196:199], v[160:163], v[100:103]
    v_mfma_f32_16x16x32_bf16 v[116:119], v[196:199], v[164:167], v[116:119]
    v_mfma_f32_16x16x32_bf16 v[120:123], v[200:203], v[164:167], v[120:123]
    v_mfma_f32_16x16x32_bf16 v[124:127], v[164:167], v[204:207], v[124:127]
    v_mfma_f32_16x16x32_bf16 v[128:131], v[208:211], v[164:167], v[128:131]
    v_mfma_f32_16x16x32_bf16 v[144:147], v[208:211], v[168:171], v[144:147]
    v_mfma_f32_16x16x32_bf16 v[140:143], v[168:171], v[204:207], v[140:143]
    v_mfma_f32_16x16x32_bf16 v[136:139], v[200:203], v[168:171], v[136:139]
    v_mfma_f32_16x16x32_bf16 v[132:135], v[196:199], v[168:171], v[132:135]
    s_waitcnt lgkmcnt(0)
    s_barrier
    v_mfma_f32_16x16x32_bf16 v[52:55], v[212:215], v[172:175], v[52:55]
    ds_read_b64_tr_b16 v[196:197], v47 offset:0
    v_mfma_f32_16x16x32_bf16 v[56:59], v[216:219], v[172:175], v[56:59]
    ds_read_b64_tr_b16 v[198:199], v47 offset:1024
    v_mfma_f32_16x16x32_bf16 v[60:63], v[172:175], v[220:223], v[60:63]
    ds_read_b128 v[148:151], v41 offset:0
    v_mfma_f32_16x16x32_bf16 v[64:67], v[224:227], v[172:175], v[64:67]
    ds_read_b64_tr_b16 v[200:201], v48 offset:0
    v_mfma_f32_16x16x32_bf16 v[80:83], v[224:227], v[176:179], v[80:83]
    ds_read_b64_tr_b16 v[202:203], v48 offset:1024
    v_mfma_f32_16x16x32_bf16 v[76:79], v[176:179], v[220:223], v[76:79]
    ds_read_b128 v[152:155], v41 offset:2048
    v_mfma_f32_16x16x32_bf16 v[72:75], v[216:219], v[176:179], v[72:75]
    ds_read_b64_tr_b16 v[204:205], v49 offset:0
    v_mfma_f32_16x16x32_bf16 v[68:71], v[212:215], v[176:179], v[68:71]
    ds_read_b64_tr_b16 v[206:207], v49 offset:1024
    v_mfma_f32_16x16x32_bf16 v[84:87], v[212:215], v[180:183], v[84:87]
    ds_read_b128 v[156:159], v41 offset:4096
    v_mfma_f32_16x16x32_bf16 v[88:91], v[216:219], v[180:183], v[88:91]
    ds_read_b64_tr_b16 v[208:209], v50 offset:0
    v_mfma_f32_16x16x32_bf16 v[92:95], v[180:183], v[220:223], v[92:95]
    ds_read_b64_tr_b16 v[210:211], v50 offset:1024
    v_mfma_f32_16x16x32_bf16 v[96:99], v[224:227], v[180:183], v[96:99]
    ds_read_b128 v[160:163], v41 offset:6144
    v_mfma_f32_16x16x32_bf16 v[112:115], v[224:227], v[184:187], v[112:115]
    ds_read_b128 v[164:167], v41 offset:8192
    v_mfma_f32_16x16x32_bf16 v[108:111], v[184:187], v[220:223], v[108:111]
    ds_read_b128 v[168:171], v41 offset:10240
    v_mfma_f32_16x16x32_bf16 v[104:107], v[216:219], v[184:187], v[104:107]
    v_mfma_f32_16x16x32_bf16 v[100:103], v[212:215], v[184:187], v[100:103]
    v_mfma_f32_16x16x32_bf16 v[116:119], v[212:215], v[188:191], v[116:119]
    v_mfma_f32_16x16x32_bf16 v[120:123], v[216:219], v[188:191], v[120:123]
    v_mfma_f32_16x16x32_bf16 v[124:127], v[188:191], v[220:223], v[124:127]
    v_mfma_f32_16x16x32_bf16 v[128:131], v[224:227], v[188:191], v[128:131]
    v_mfma_f32_16x16x32_bf16 v[144:147], v[224:227], v[192:195], v[144:147]
    v_mfma_f32_16x16x32_bf16 v[140:143], v[192:195], v[220:223], v[140:143]
    v_mfma_f32_16x16x32_bf16 v[136:139], v[216:219], v[192:195], v[136:139]
    v_mfma_f32_16x16x32_bf16 v[132:135], v[212:215], v[192:195], v[132:135]
    s_waitcnt lgkmcnt(0)
    v_mfma_f32_16x16x32_bf16 v[52:55], v[196:199], v[148:151], v[52:55]
    ds_read_b64_tr_b16 v[212:213], v47 offset:8192
    v_mfma_f32_16x16x32_bf16 v[56:59], v[200:203], v[148:151], v[56:59]
    ds_read_b64_tr_b16 v[214:215], v47 offset:9216
    v_mfma_f32_16x16x32_bf16 v[60:63], v[148:151], v[204:207], v[60:63]
    ds_read_b128 v[172:175], v42 offset:0
    v_mfma_f32_16x16x32_bf16 v[64:67], v[208:211], v[148:151], v[64:67]
    ds_read_b64_tr_b16 v[216:217], v48 offset:8192
    v_mfma_f32_16x16x32_bf16 v[80:83], v[208:211], v[152:155], v[80:83]
    ds_read_b64_tr_b16 v[218:219], v48 offset:9216
    v_mfma_f32_16x16x32_bf16 v[76:79], v[152:155], v[204:207], v[76:79]
    ds_read_b128 v[176:179], v42 offset:2048
    v_mfma_f32_16x16x32_bf16 v[72:75], v[200:203], v[152:155], v[72:75]
    ds_read_b64_tr_b16 v[220:221], v49 offset:8192
    v_mfma_f32_16x16x32_bf16 v[68:71], v[196:199], v[152:155], v[68:71]
    ds_read_b64_tr_b16 v[222:223], v49 offset:9216
    v_mfma_f32_16x16x32_bf16 v[84:87], v[196:199], v[156:159], v[84:87]
    ds_read_b128 v[180:183], v42 offset:4096
    v_mfma_f32_16x16x32_bf16 v[88:91], v[200:203], v[156:159], v[88:91]
    ds_read_b64_tr_b16 v[224:225], v50 offset:8192
    v_mfma_f32_16x16x32_bf16 v[92:95], v[156:159], v[204:207], v[92:95]
    ds_read_b64_tr_b16 v[226:227], v50 offset:9216
    v_mfma_f32_16x16x32_bf16 v[96:99], v[208:211], v[156:159], v[96:99]
    ds_read_b128 v[184:187], v42 offset:6144
    v_mfma_f32_16x16x32_bf16 v[112:115], v[208:211], v[160:163], v[112:115]
    ds_read_b128 v[188:191], v42 offset:8192
    v_mfma_f32_16x16x32_bf16 v[108:111], v[160:163], v[204:207], v[108:111]
    ds_read_b128 v[192:195], v42 offset:10240
    v_mfma_f32_16x16x32_bf16 v[104:107], v[200:203], v[160:163], v[104:107]
    v_mfma_f32_16x16x32_bf16 v[100:103], v[196:199], v[160:163], v[100:103]
    v_mfma_f32_16x16x32_bf16 v[116:119], v[196:199], v[164:167], v[116:119]
    v_mfma_f32_16x16x32_bf16 v[120:123], v[200:203], v[164:167], v[120:123]
    v_mfma_f32_16x16x32_bf16 v[124:127], v[164:167], v[204:207], v[124:127]
    v_mfma_f32_16x16x32_bf16 v[128:131], v[208:211], v[164:167], v[128:131]
    v_mfma_f32_16x16x32_bf16 v[144:147], v[208:211], v[168:171], v[144:147]
    v_mfma_f32_16x16x32_bf16 v[140:143], v[168:171], v[204:207], v[140:143]
    v_mfma_f32_16x16x32_bf16 v[136:139], v[200:203], v[168:171], v[136:139]
    v_mfma_f32_16x16x32_bf16 v[132:135], v[196:199], v[168:171], v[132:135]
    s_waitcnt lgkmcnt(0)
    s_barrier
    v_mfma_f32_16x16x32_bf16 v[52:55], v[212:215], v[172:175], v[52:55]
    ds_read_b64_tr_b16 v[196:197], v43 offset:0
    v_mfma_f32_16x16x32_bf16 v[56:59], v[216:219], v[172:175], v[56:59]
    ds_read_b64_tr_b16 v[198:199], v43 offset:1024
    v_mfma_f32_16x16x32_bf16 v[60:63], v[172:175], v[220:223], v[60:63]
    ds_read_b128 v[148:151], v39 offset:0
    v_mfma_f32_16x16x32_bf16 v[64:67], v[224:227], v[172:175], v[64:67]
    ds_read_b64_tr_b16 v[200:201], v44 offset:0
    v_mfma_f32_16x16x32_bf16 v[80:83], v[224:227], v[176:179], v[80:83]
    ds_read_b64_tr_b16 v[202:203], v44 offset:1024
    v_mfma_f32_16x16x32_bf16 v[76:79], v[176:179], v[220:223], v[76:79]
    ds_read_b128 v[152:155], v39 offset:2048
    v_mfma_f32_16x16x32_bf16 v[72:75], v[216:219], v[176:179], v[72:75]
    ds_read_b64_tr_b16 v[204:205], v45 offset:0
    v_mfma_f32_16x16x32_bf16 v[68:71], v[212:215], v[176:179], v[68:71]
    ds_read_b64_tr_b16 v[206:207], v45 offset:1024
    v_mfma_f32_16x16x32_bf16 v[84:87], v[212:215], v[180:183], v[84:87]
    ds_read_b128 v[156:159], v39 offset:4096
    v_mfma_f32_16x16x32_bf16 v[88:91], v[216:219], v[180:183], v[88:91]
    ds_read_b64_tr_b16 v[208:209], v46 offset:0
    v_mfma_f32_16x16x32_bf16 v[92:95], v[180:183], v[220:223], v[92:95]
    ds_read_b64_tr_b16 v[210:211], v46 offset:1024
    v_mfma_f32_16x16x32_bf16 v[96:99], v[224:227], v[180:183], v[96:99]
    ds_read_b128 v[160:163], v39 offset:6144
    v_mfma_f32_16x16x32_bf16 v[112:115], v[224:227], v[184:187], v[112:115]
    ds_read_b128 v[164:167], v39 offset:8192
    v_mfma_f32_16x16x32_bf16 v[108:111], v[184:187], v[220:223], v[108:111]
    ds_read_b128 v[168:171], v39 offset:10240
    v_mfma_f32_16x16x32_bf16 v[104:107], v[216:219], v[184:187], v[104:107]
    v_mfma_f32_16x16x32_bf16 v[100:103], v[212:215], v[184:187], v[100:103]
    v_mfma_f32_16x16x32_bf16 v[116:119], v[212:215], v[188:191], v[116:119]
    v_mfma_f32_16x16x32_bf16 v[120:123], v[216:219], v[188:191], v[120:123]
    v_mfma_f32_16x16x32_bf16 v[124:127], v[188:191], v[220:223], v[124:127]
    v_mfma_f32_16x16x32_bf16 v[128:131], v[224:227], v[188:191], v[128:131]
    v_mfma_f32_16x16x32_bf16 v[144:147], v[224:227], v[192:195], v[144:147]
    v_mfma_f32_16x16x32_bf16 v[140:143], v[192:195], v[220:223], v[140:143]
    v_mfma_f32_16x16x32_bf16 v[136:139], v[216:219], v[192:195], v[136:139]
    v_mfma_f32_16x16x32_bf16 v[132:135], v[212:215], v[192:195], v[132:135]
    s_waitcnt lgkmcnt(0)
    v_mfma_f32_16x16x32_bf16 v[52:55], v[196:199], v[148:151], v[52:55]
    ds_read_b64_tr_b16 v[212:213], v43 offset:8192
    v_mfma_f32_16x16x32_bf16 v[56:59], v[200:203], v[148:151], v[56:59]
    ds_read_b64_tr_b16 v[214:215], v43 offset:9216
    v_mfma_f32_16x16x32_bf16 v[60:63], v[148:151], v[204:207], v[60:63]
    ds_read_b128 v[172:175], v40 offset:0
    v_mfma_f32_16x16x32_bf16 v[64:67], v[208:211], v[148:151], v[64:67]
    ds_read_b64_tr_b16 v[216:217], v44 offset:8192
    v_mfma_f32_16x16x32_bf16 v[80:83], v[208:211], v[152:155], v[80:83]
    ds_read_b64_tr_b16 v[218:219], v44 offset:9216
    v_mfma_f32_16x16x32_bf16 v[76:79], v[152:155], v[204:207], v[76:79]
    ds_read_b128 v[176:179], v40 offset:2048
    v_mfma_f32_16x16x32_bf16 v[72:75], v[200:203], v[152:155], v[72:75]
    ds_read_b64_tr_b16 v[220:221], v45 offset:8192
    v_mfma_f32_16x16x32_bf16 v[68:71], v[196:199], v[152:155], v[68:71]
    ds_read_b64_tr_b16 v[222:223], v45 offset:9216
    v_mfma_f32_16x16x32_bf16 v[84:87], v[196:199], v[156:159], v[84:87]
    ds_read_b128 v[180:183], v40 offset:4096
    v_mfma_f32_16x16x32_bf16 v[88:91], v[200:203], v[156:159], v[88:91]
    ds_read_b64_tr_b16 v[224:225], v46 offset:8192
    v_mfma_f32_16x16x32_bf16 v[92:95], v[156:159], v[204:207], v[92:95]
    ds_read_b64_tr_b16 v[226:227], v46 offset:9216
    v_mfma_f32_16x16x32_bf16 v[96:99], v[208:211], v[156:159], v[96:99]
    ds_read_b128 v[184:187], v40 offset:6144
    v_mfma_f32_16x16x32_bf16 v[112:115], v[208:211], v[160:163], v[112:115]
    ds_read_b128 v[188:191], v40 offset:8192
    v_mfma_f32_16x16x32_bf16 v[108:111], v[160:163], v[204:207], v[108:111]
    ds_read_b128 v[192:195], v40 offset:10240
    v_mfma_f32_16x16x32_bf16 v[104:107], v[200:203], v[160:163], v[104:107]
    v_mfma_f32_16x16x32_bf16 v[100:103], v[196:199], v[160:163], v[100:103]
    v_mfma_f32_16x16x32_bf16 v[116:119], v[196:199], v[164:167], v[116:119]
    v_mfma_f32_16x16x32_bf16 v[120:123], v[200:203], v[164:167], v[120:123]
    v_mfma_f32_16x16x32_bf16 v[124:127], v[164:167], v[204:207], v[124:127]
    v_mfma_f32_16x16x32_bf16 v[128:131], v[208:211], v[164:167], v[128:131]
    v_mfma_f32_16x16x32_bf16 v[144:147], v[208:211], v[168:171], v[144:147]
    v_mfma_f32_16x16x32_bf16 v[140:143], v[168:171], v[204:207], v[140:143]
    v_mfma_f32_16x16x32_bf16 v[136:139], v[200:203], v[168:171], v[136:139]
    v_mfma_f32_16x16x32_bf16 v[132:135], v[196:199], v[168:171], v[132:135]
    s_waitcnt lgkmcnt(0)
    s_barrier
    v_mfma_f32_16x16x32_bf16 v[52:55], v[212:215], v[172:175], v[52:55]
    ds_read_b64_tr_b16 v[196:197], v43 offset:40960
    v_mfma_f32_16x16x32_bf16 v[56:59], v[216:219], v[172:175], v[56:59]
    ds_read_b64_tr_b16 v[198:199], v43 offset:41984
    v_mfma_f32_16x16x32_bf16 v[60:63], v[172:175], v[220:223], v[60:63]
    ds_read_b128 v[148:151], v39 offset:40960
    v_mfma_f32_16x16x32_bf16 v[64:67], v[224:227], v[172:175], v[64:67]
    ds_read_b64_tr_b16 v[200:201], v44 offset:40960
    v_mfma_f32_16x16x32_bf16 v[80:83], v[224:227], v[176:179], v[80:83]
    ds_read_b64_tr_b16 v[202:203], v44 offset:41984
    v_mfma_f32_16x16x32_bf16 v[76:79], v[176:179], v[220:223], v[76:79]
    ds_read_b128 v[152:155], v39 offset:43008
    v_mfma_f32_16x16x32_bf16 v[72:75], v[216:219], v[176:179], v[72:75]
    ds_read_b64_tr_b16 v[204:205], v45 offset:40960
    v_mfma_f32_16x16x32_bf16 v[68:71], v[212:215], v[176:179], v[68:71]
    ds_read_b64_tr_b16 v[206:207], v45 offset:41984
    v_mfma_f32_16x16x32_bf16 v[84:87], v[212:215], v[180:183], v[84:87]
    ds_read_b128 v[156:159], v39 offset:45056
    v_mfma_f32_16x16x32_bf16 v[88:91], v[216:219], v[180:183], v[88:91]
    ds_read_b64_tr_b16 v[208:209], v46 offset:40960
    v_mfma_f32_16x16x32_bf16 v[92:95], v[180:183], v[220:223], v[92:95]
    ds_read_b64_tr_b16 v[210:211], v46 offset:41984
    v_mfma_f32_16x16x32_bf16 v[96:99], v[224:227], v[180:183], v[96:99]
    ds_read_b128 v[160:163], v39 offset:47104
    v_mfma_f32_16x16x32_bf16 v[112:115], v[224:227], v[184:187], v[112:115]
    ds_read_b128 v[164:167], v39 offset:49152
    v_mfma_f32_16x16x32_bf16 v[108:111], v[184:187], v[220:223], v[108:111]
    ds_read_b128 v[168:171], v39 offset:51200
    v_mfma_f32_16x16x32_bf16 v[104:107], v[216:219], v[184:187], v[104:107]
    v_mfma_f32_16x16x32_bf16 v[100:103], v[212:215], v[184:187], v[100:103]
    v_mfma_f32_16x16x32_bf16 v[116:119], v[212:215], v[188:191], v[116:119]
    v_mfma_f32_16x16x32_bf16 v[120:123], v[216:219], v[188:191], v[120:123]
    v_mfma_f32_16x16x32_bf16 v[124:127], v[188:191], v[220:223], v[124:127]
    v_mfma_f32_16x16x32_bf16 v[128:131], v[224:227], v[188:191], v[128:131]
    s_branch K_PG2
.p2align 12
K_CHM2:
K_STM2:
    s_branch K_WRET_M
    s_nop 0
K_PG2:
    v_mfma_f32_16x16x32_bf16 v[144:147], v[224:227], v[192:195], v[144:147]
    v_mfma_f32_16x16x32_bf16 v[140:143], v[192:195], v[220:223], v[140:143]
    v_mfma_f32_16x16x32_bf16 v[136:139], v[216:219], v[192:195], v[136:139]
    v_mfma_f32_16x16x32_bf16 v[132:135], v[212:215], v[192:195], v[132:135]
    s_waitcnt lgkmcnt(0)
    v_mfma_f32_16x16x32_bf16 v[52:55], v[196:199], v[148:151], v[52:55]
    ds_read_b64_tr_b16 v[212:213], v43 offset:49152
    v_mfma_f32_16x16x32_bf16 v[56:59], v[200:203], v[148:151], v[56:59]
    ds_read_b64_tr_b16 v[214:215], v43 offset:50176
    v_mfma_f32_16x16x32_bf16 v[60:63], v[148:151], v[204:207], v[60:63]
    ds_read_b128 v[172:175], v40 offset:40960
    v_mfma_f32_16x16x32_bf16 v[64:67], v[208:211], v[148:151], v[64:67]
    ds_read_b64_tr_b16 v[216:217], v44 offset:49152
    v_mfma_f32_16x16x32_bf16 v[80:83], v[208:211], v[152:155], v[80:83]
    ds_read_b64_tr_b16 v[218:219], v44 offset:50176
    v_mfma_f32_16x16x32_bf16 v[76:79], v[152:155], v[204:207], v[76:79]
    ds_read_b128 v[176:179], v40 offset:43008
    v_mfma_f32_16x16x32_bf16 v[72:75], v[200:203], v[152:155], v[72:75]
    ds_read_b64_tr_b16 v[220:221], v45 offset:49152
    v_mfma_f32_16x16x32_bf16 v[68:71], v[196:199], v[152:155], v[68:71]
    ds_read_b64_tr_b16 v[222:223], v45 offset:50176
    v_mfma_f32_16x16x32_bf16 v[84:87], v[196:199], v[156:159], v[84:87]
    ds_read_b128 v[180:183], v40 offset:45056
    v_mfma_f32_16x16x32_bf16 v[88:91], v[200:203], v[156:159], v[88:91]
    ds_read_b64_tr_b16 v[224:225], v46 offset:49152
    v_mfma_f32_16x16x32_bf16 v[92:95], v[156:159], v[204:207], v[92:95]
    ds_read_b64_tr_b16 v[226:227], v46 offset:50176
    v_mfma_f32_16x16x32_bf16 v[96:99], v[208:211], v[156:159], v[96:99]
    ds_read_b128 v[184:187], v40 offset:47104
    v_mfma_f32_16x16x32_bf16 v[112:115], v[208:211], v[160:163], v[112:115]
    ds_read_b128 v[188:191], v40 offset:49152
    v_mfma_f32_16x16x32_bf16 v[108:111], v[160:163], v[204:207], v[108:111]
    ds_read_b128 v[192:195], v40 offset:51200
    v_mfma_f32_16x16x32_bf16 v[104:107], v[200:203], v[160:163], v[104:107]
    v_mfma_f32_16x16x32_bf16 v[100:103], v[196:199], v[160:163], v[100:103]
    v_mfma_f32_16x16x32_bf16 v[116:119], v[196:199], v[164:167], v[116:119]
    v_mfma_f32_16x16x32_bf16 v[120:123], v[200:203], v[164:167], v[120:123]
    v_mfma_f32_16x16x32_bf16 v[124:127], v[164:167], v[204:207], v[124:127]
    v_mfma_f32_16x16x32_bf16 v[128:131], v[208:211], v[164:167], v[128:131]
    v_mfma_f32_16x16x32_bf16 v[144:147], v[208:211], v[168:171], v[144:147]
    v_mfma_f32_16x16x32_bf16 v[140:143], v[168:171], v[204:207], v[140:143]
    v_mfma_f32_16x16x32_bf16 v[136:139], v[200:203], v[168:171], v[136:139]
    v_mfma_f32_16x16x32_bf16 v[132:135], v[196:199], v[168:171], v[132:135]
    s_waitcnt lgkmcnt(0)
    s_barrier
    v_mfma_f32_16x16x32_bf16 v[52:55], v[212:215], v[172:175], v[52:55]
    ds_read_b64_tr_b16 v[196:197], v47 offset:0
    v_mfma_f32_16x16x32_bf16 v[56:59], v[216:219], v[172:175], v[56:59]
    ds_read_b64_tr_b16 v[198:199], v47 offset:1024
    v_mfma_f32_16x16x32_bf16 v[60:63], v[172:175], v[220:223], v[60:63]
    ds_read_b128 v[148:151], v41 offset:0
    v_mfma_f32_16x16x32_bf16 v[64:67], v[224:227], v[172:175], v[64:67]
    ds_read_b64_tr_b16 v[200:201], v48 offset:0
    v_mfma_f32_16x16x32_bf16 v[80:83], v[224:227], v[176:179], v[80:83]
    ds_read_b64_tr_b16 v[202:203], v48 offset:1024
    v_mfma_f32_16x16x32_bf16 v[76:79], v[176:179], v[220:223], v[76:79]
    ds_read_b128 v[152:155], v41 offset:2048
    v_mfma_f32_16x16x32_bf16 v[72:75], v[216:219], v[176:179], v[72:75]
    ds_read_b64_tr_b16 v[204:205], v49 offset:0
    v_mfma_f32_16x16x32_bf16 v[68:71], v[212:215], v[176:179], v[68:71]
    ds_read_b64_tr_b16 v[206:207], v49 offset:1024
    v_mfma_f32_16x16x32_bf16 v[84:87], v[212:215], v[180:183], v[84:87]
    ds_read_b128 v[156:159], v41 offset:4096
    v_mfma_f32_16x16x32_bf16 v[88:91], v[216:219], v[180:183], v[88:91]
    ds_read_b64_tr_b16 v[208:209], v50 offset:0
    v_mfma_f32_16x16x32_bf16 v[92:95], v[180:183], v[220:223], v[92:95]
    ds_read_b64_tr_b16 v[210:211], v50 offset:1024
    v_mfma_f32_16x16x32_bf16 v[96:99], v[224:227], v[180:183], v[96:99]
    ds_read_b128 v[160:163], v41 offset:6144
    v_mfma_f32_16x16x32_bf16 v[112:115], v[224:227], v[184:187], v[112:115]
    ds_read_b128 v[164:167], v41 offset:8192
    v_mfma_f32_16x16x32_bf16 v[108:111], v[184:187], v[220:223], v[108:111]
    ds_read_b128 v[168:171], v41 offset:10240
    v_mfma_f32_16x16x32_bf16 v[104:107], v[216:219], v[184:187], v[104:107]
    v_mfma_f32_16x16x32_bf16 v[100:103], v[212:215], v[184:187], v[100:103]
    v_mfma_f32_16x16x32_bf16 v[116:119], v[212:215], v[188:191], v[116:119]
    v_mfma_f32_16x16x32_bf16 v[120:123], v[216:219], v[188:191], v[120:123]
    v_mfma_f32_16x16x32_bf16 v[124:127], v[188:191], v[220:223], v[124:127]
    v_mfma_f32_16x16x32_bf16 v[128:131], v[224:227], v[188:191], v[128:131]
    v_mfma_f32_16x16x32_bf16 v[144:147], v[224:227], v[192:195], v[144:147]
    v_mfma_f32_16x16x32_bf16 v[140:143], v[192:195], v[220:223], v[140:143]
    v_mfma_f32_16x16x32_bf16 v[136:139], v[216:219], v[192:195], v[136:139]
    v_mfma_f32_16x16x32_bf16 v[132:135], v[212:215], v[192:195], v[132:135]
    s_waitcnt lgkmcnt(0)
    v_mfma_f32_16x16x32_bf16 v[132:135], v[196:199], v[168:171], v[132:135]
    ds_read_b64_tr_b16 v[212:213], v47 offset:8192
    ds_read_b64_tr_b16 v[214:215], v47 offset:9216
    v_mfma_f32_16x16x32_bf16 v[136:139], v[200:203], v[168:171], v[136:139]
    ds_read_b128 v[192:195], v42 offset:10240
    ds_read_b64_tr_b16 v[216:217], v48 offset:8192
    v_mfma_f32_16x16x32_bf16 v[140:143], v[168:171], v[204:207], v[140:143]
    ds_read_b64_tr_b16 v[218:219], v48 offset:9216
    ds_read_b64_tr_b16 v[220:221], v49 offset:8192
    v_mfma_f32_16x16x32_bf16 v[144:147], v[208:211], v[168:171], v[144:147]
    ds_read_b64_tr_b16 v[222:223], v49 offset:9216
    ds_read_b64_tr_b16 v[224:225], v50 offset:8192
    v_mfma_f32_16x16x32_bf16 v[116:119], v[196:199], v[164:167], v[116:119]
    ds_read_b64_tr_b16 v[226:227], v50 offset:9216
    ds_read_b128 v[188:191], v42 offset:8192
    v_mfma_f32_16x16x32_bf16 v[120:123], v[200:203], v[164:167], v[120:123]
    ds_read_b128 v[184:187], v42 offset:6144
    ds_read_b128 v[180:183], v42 offset:4096
    v_mfma_f32_16x16x32_bf16 v[124:127], v[164:167], v[204:207], v[124:127]
    ds_read_b128 v[176:179], v42 offset:2048
    ds_read_b128 v[172:175], v42 offset:0
    v_mfma_f32_16x16x32_bf16 v[128:131], v[208:211], v[164:167], v[128:131]
    s_waitcnt lgkmcnt(11)
    v_mfma_f32_16x16x32_bf16 v[132:135], v[212:215], v[192:195], v[132:135]
    s_waitcnt lgkmcnt(9)
    v_mfma_f32_16x16x32_bf16 v[136:139], v[216:219], v[192:195], v[136:139]
    s_waitcnt lgkmcnt(7)
    v_mfma_f32_16x16x32_bf16 v[140:143], v[192:195], v[220:223], v[140:143]
    s_waitcnt lgkmcnt(5)
    v_mfma_f32_16x16x32_bf16 v[144:147], v[224:227], v[192:195], v[144:147]
    s_waitcnt lgkmcnt(4)
    v_mfma_f32_16x16x32_bf16 v[116:119], v[212:215], v[188:191], v[116:119]
    v_cvt_pk_bf16_f32 v132, v132, v133
    v_cvt_pk_bf16_f32 v133, v134, v135
    v_mfma_f32_16x16x32_bf16 v[120:123], v[216:219], v[188:191], v[120:123]
    v_cvt_pk_bf16_f32 v136, v136, v137
    v_cvt_pk_bf16_f32 v137, v138, v139
    v_mfma_f32_16x16x32_bf16 v[124:127], v[188:191], v[220:223], v[124:127]
    v_mov_b32 v138, 0
    v_mov_b32 v139, 0
    v_mfma_f32_16x16x32_bf16 v[128:131], v[224:227], v[188:191], v[128:131]
    v_cvt_pk_bf16_f32 v134, v144, v145
    v_cvt_pk_bf16_f32 v135, v146, v147
    v_mfma_f32_16x16x32_bf16 v[100:103], v[196:199], v[160:163], v[100:103]
    v_cvt_pk_bf16_f32 v254, v140, v141
    v_cvt_pk_bf16_f32 v255, v142, v143
    v_mfma_f32_16x16x32_bf16 v[104:107], v[200:203], v[160:163], v[104:107]
    v_permlane16_swap_b32 v134, v138
    v_permlane16_swap_b32 v135, v139
    ds_write_b64 v32, v[134:135] offset:768
    v_mfma_f32_16x16x32_bf16 v[108:111], v[160:163], v[204:207], v[108:111]
    ds_read_b64_tr_b16 v[240:241], v33 offset:768
    s_cmp_lg_u32 s54, 0
    s_cbranch_scc1 K_NOX
    ds_write_b64 v34, v[132:133]
    ds_write_b64 v34, v[134:135] offset:512
    ds_write_b64 v34, v[254:255] offset:1024
    v_lshl_add_u32 v2, s55, 2, v38
    ds_write_b16 v2, v38 offset:30
K_NOX:
    v_mfma_f32_16x16x32_bf16 v[112:115], v[208:211], v[160:163], v[112:115]
    v_cvt_pk_bf16_f32 v116, v116, v117
    v_cvt_pk_bf16_f32 v117, v118, v119
    v_mfma_f32_16x16x32_bf16 v[192:195], v[132:135], v[136:139], v[16:19]
    v_cvt_pk_bf16_f32 v120, v120, v121
    v_cvt_pk_bf16_f32 v121, v122, v123
    s_waitcnt lgkmcnt(5)
    v_mfma_f32_16x16x32_bf16 v[100:103], v[212:215], v[184:187], v[100:103]
    v_mov_b32 v122, 0
    v_mov_b32 v123, 0
    v_mfma_f32_16x16x32_bf16 v[104:107], v[216:219], v[184:187], v[104:107]
    v_cvt_pk_bf16_f32 v118, v128, v129
    v_cvt_pk_bf16_f32 v119, v130, v131
    v_mfma_f32_16x16x32_bf16 v[108:111], v[184:187], v[220:223], v[108:111]
    v_cvt_pk_bf16_f32 v252, v124, v125
    v_cvt_pk_bf16_f32 v253, v126, v127
    v_mfma_f32_16x16x32_bf16 v[112:115], v[224:227], v[184:187], v[112:115]
    v_permlane16_swap_b32 v118, v122
    v_permlane16_swap_b32 v119, v123
    ds_write_b64 v32, v[118:119] offset:640
    v_mfma_f32_16x16x32_bf16 v[84:87], v[196:199], v[156:159], v[84:87]
    ds_read_b64_tr_b16 v[238:239], v33 offset:640
    v_cvt_pk_bf16_f32 v100, v100, v101
    v_mfma_f32_16x16x32_bf16 v[88:91], v[200:203], v[156:159], v[88:91]
    v_cvt_pk_bf16_f32 v101, v102, v103
    v_cvt_pk_bf16_f32 v104, v104, v105
    v_mfma_f32_16x16x32_bf16 v[168:171], v[116:119], v[136:139], v[12:15]
    v_cvt_pk_bf16_f32 v105, v106, v107
    v_mov_b32 v106, 0
    v_mfma_f32_16x16x32_bf16 v[92:95], v[156:159], v[204:207], v[92:95]
    v_mov_b32 v107, 0
    v_cvt_pk_bf16_f32 v102, v112, v113
    v_mfma_f32_16x16x32_bf16 v[188:191], v[116:119], v[120:123], v[16:19]
    v_cvt_pk_bf16_f32 v103, v114, v115
    v_cvt_pk_bf16_f32 v250, v108, v109
    v_mfma_f32_16x16x32_bf16 v[96:99], v[208:211], v[156:159], v[96:99]
    v_cvt_pk_bf16_f32 v251, v110, v111
    v_permlane16_swap_b32 v102, v106
    s_waitcnt lgkmcnt(6)
    v_mfma_f32_16x16x32_bf16 v[84:87], v[212:215], v[180:183], v[84:87]
    v_permlane16_swap_b32 v103, v107
    ds_write_b64 v32, v[102:103] offset:512
    v_mfma_f32_16x16x32_bf16 v[88:91], v[216:219], v[180:183], v[88:91]
    ds_read_b64_tr_b16 v[236:237], v33 offset:512
    v_max3_f32 v168, v168, v169, v192
    v_mfma_f32_16x16x32_bf16 v[92:95], v[180:183], v[220:223], v[92:95]
    v_max3_f32 v170, v170, v171, v194
    v_max_f32 v168, v168, v193
    v_mfma_f32_16x16x32_bf16 v[164:167], v[100:103], v[120:123], v[12:15]
    v_max_f32 v169, v170, v195
    v_cvt_pk_bf16_f32 v168, v168, v169
    v_mfma_f32_16x16x32_bf16 v[96:99], v[224:227], v[180:183], v[96:99]
    v_cvt_pk_bf16_f32 v84, v84, v85
    v_cvt_pk_bf16_f32 v85, v86, v87
    v_mfma_f32_16x16x32_bf16 v[184:187], v[100:103], v[104:107], v[16:19]
    v_cvt_pk_bf16_f32 v88, v88, v89
    v_cvt_pk_bf16_f32 v89, v90, v91
    v_mfma_f32_16x16x32_bf16 v[68:71], v[196:199], v[152:155], v[68:71]
    v_mov_b32 v90, 0
    v_mov_b32 v91, 0
    v_mfma_f32_16x16x32_bf16 v[72:75], v[200:203], v[152:155], v[72:75]
    v_max3_f32 v164, v164, v165, v188
    v_max3_f32 v166, v166, v167, v190
    v_mfma_f32_16x16x32_bf16 v[76:79], v[152:155], v[204:207], v[76:79]
    v_max_f32 v164, v164, v189
    v_max_f32 v165, v166, v191
    v_mfma_f32_16x16x32_bf16 v[80:83], v[208:211], v[152:155], v[80:83]
    v_cvt_pk_bf16_f32 v164, v164, v165
    v_cvt_pk_bf16_f32 v86, v96, v97
    s_waitcnt lgkmcnt(7)
    v_mfma_f32_16x16x32_bf16 v[68:71], v[212:215], v[176:179], v[68:71]
    v_cvt_pk_bf16_f32 v87, v98, v99
    v_cvt_pk_bf16_f32 v248, v92, v93
    v_mfma_f32_16x16x32_bf16 v[72:75], v[216:219], v[176:179], v[72:75]
    v_cvt_pk_bf16_f32 v249, v94, v95
    v_permlane16_swap_b32 v86, v90
    v_mfma_f32_16x16x32_bf16 v[76:79], v[176:179], v[220:223], v[76:79]
    v_permlane16_swap_b32 v87, v91
    ds_write_b64 v32, v[86:87] offset:384
    v_mfma_f32_16x16x32_bf16 v[80:83], v[224:227], v[176:179], v[80:83]
    ds_read_b64_tr_b16 v[234:235], v33 offset:384
    v_lshl_add_u32 v2, s55, 2, v38
    v_mfma_f32_16x16x32_bf16 v[52:55], v[196:199], v[148:151], v[52:55]
    ds_read_b32 v3, v2 offset:28
    ds_read_b64 v[144:145], v34
    v_mfma_f32_16x16x32_bf16 v[160:163], v[84:87], v[104:107], v[12:15]
    ds_read_b64 v[146:147], v34 offset:512
    ds_read_b64 v[242:243], v34 offset:1024
    v_mfma_f32_16x16x32_bf16 v[56:59], v[200:203], v[148:151], v[56:59]
    ds_read_b64_tr_b16 v[228:229], v33
    v_cvt_pk_bf16_f32 v68, v68, v69
    v_mfma_f32_16x16x32_bf16 v[180:183], v[84:87], v[88:91], v[16:19]
    v_cvt_pk_bf16_f32 v69, v70, v71
    v_cvt_pk_bf16_f32 v72, v72, v73
    v_mfma_f32_16x16x32_bf16 v[60:63], v[148:151], v[204:207], v[60:63]
    v_cvt_pk_bf16_f32 v73, v74, v75
    v_mov_b32 v74, 0
    v_mfma_f32_16x16x32_bf16 v[64:67], v[208:211], v[148:151], v[64:67]
    v_mov_b32 v75, 0
    v_cvt_pk_bf16_f32 v70, v80, v81
    s_waitcnt lgkmcnt(13)
    v_mfma_f32_16x16x32_bf16 v[52:55], v[212:215], v[172:175], v[52:55]
    v_cvt_pk_bf16_f32 v71, v82, v83
    v_cvt_pk_bf16_f32 v246, v76, v77
    v_mfma_f32_16x16x32_bf16 v[56:59], v[216:219], v[172:175], v[56:59]
    v_cvt_pk_bf16_f32 v247, v78, v79
    v_permlane16_swap_b32 v70, v74
    v_mfma_f32_16x16x32_bf16 v[60:63], v[172:175], v[220:223], v[60:63]
    v_permlane16_swap_b32 v71, v75
    ds_write_b64 v32, v[70:71] offset:256
    v_mfma_f32_16x16x32_bf16 v[64:67], v[224:227], v[172:175], v[64:67]
    ds_read_b64_tr_b16 v[232:233], v33 offset:256
    v_max3_f32 v160, v160, v161, v184
    v_max3_f32 v162, v162, v163, v186
    v_max_f32 v160, v160, v185
    v_max_f32 v161, v162, v187
    v_mfma_f32_16x16x32_bf16 v[156:159], v[68:71], v[88:91], v[12:15]
    v_cvt_pk_bf16_f32 v160, v160, v161
    v_cvt_pk_bf16_f32 v52, v52, v53
    v_cvt_pk_bf16_f32 v53, v54, v55
    v_mfma_f32_16x16x32_bf16 v[176:179], v[68:71], v[72:75], v[16:19]
    v_cvt_pk_bf16_f32 v56, v56, v57
    v_cvt_pk_bf16_f32 v57, v58, v59
    v_mov_b32 v58, 0
    v_mov_b32 v59, 0
    v_cvt_pk_bf16_f32 v54, v64, v65
    v_cvt_pk_bf16_f32 v55, v66, v67
    v_cvt_pk_bf16_f32 v244, v60, v61
    v_cvt_pk_bf16_f32 v245, v62, v63
    v_permlane16_swap_b32 v54, v58
    v_permlane16_swap_b32 v55, v59
    ds_write_b64 v32, v[54:55] offset:128
    ds_read_b64_tr_b16 v[230:231], v33 offset:128
    v_max3_f32 v156, v156, v157, v180
    v_max3_f32 v158, v158, v159, v182
    v_max_f32 v156, v156, v181
    v_mfma_f32_16x16x32_bf16 v[152:155], v[52:55], v[72:75], v[20:23]
    v_max_f32 v157, v158, v183
    v_cvt_pk_bf16_f32 v156, v156, v157
    v_mfma_f32_16x16x32_bf16 v[172:175], v[52:55], v[56:59], v[16:19]
    s_waitcnt lgkmcnt(4)
    v_readfirstlane_b32 s33, v3
    s_cmp_lt_u32 s33, 1811939328
    s_cbranch_scc1 K_XW
K_XR:
    v_mfma_f32_16x16x32_bf16 v[148:151], v[144:147], v[56:59], v[12:15]
    v_max3_f32 v152, v152, v153, v176
    v_max3_f32 v154, v154, v155, v178
    v_max_f32 v152, v152, v177
    v_max_f32 v153, v154, v179
    v_cvt_pk_bf16_f32 v152, v152, v153
    v_permlane16_swap_b32 v164, v168
    v_permlane16_swap_b32 v156, v160
    s_nop 1
    v_max3_f32 v148, v148, v149, v172
    v_max3_f32 v150, v150, v151, v174
    v_max_f32 v148, v148, v173
    v_max_f32 v149, v150, v175
    v_cvt_pk_bf16_f32 v148, v148, v149
    v_permlane32_swap_b32 v156, v164
    v_permlane32_swap_b32 v160, v168
    v_lshlrev_b32 v220, 16, v156
    v_and_b32 v221, 0xffff0000, v156
    v_lshlrev_b32 v224, 16, v164
    v_and_b32 v225, 0xffff0000, v164
    v_lshlrev_b32 v222, 16, v160
    v_and_b32 v223, 0xffff0000, v160
    v_lshlrev_b32 v226, 16, v168
    v_and_b32 v227, 0xffff0000, v168
    v_permlane16_swap_b32 v148, v152
    v_lshlrev_b32 v216, 16, v148
    v_and_b32 v217, 0xffff0000, v148
    v_lshlrev_b32 v218, 16, v152
    v_and_b32 v219, 0xffff0000, v152
    v_pk_mul_f32 v[220:221], v[220:221], s[60:61]
    v_pk_mul_f32 v[224:225], v[224:225], s[60:61]
    v_pk_mul_f32 v[222:223], v[222:223], s[60:61]
    v_pk_mul_f32 v[226:227], v[226:227], s[60:61]
    v_pk_mul_f32 v[216:217], v[216:217], s[60:61]
    v_pk_mul_f32 v[218:219], v[218:219], s[60:61]
    v_cvt_pk_bf16_f32 v156, v220, v221
    v_cvt_pk_bf16_f32 v164, v224, v225
    v_cvt_pk_bf16_f32 v160, v222, v223
    v_cvt_pk_bf16_f32 v168, v226, v227
    v_cvt_pk_bf16_f32 v148, v216, v217
    v_cvt_pk_bf16_f32 v152, v218, v219
    v_lshlrev_b32 v218, 16, v152
    v_and_b32 v219, 0xffff0000, v152
    v_lshlrev_b32 v216, 16, v148
    v_and_b32 v217, 0xffff0000, v148
    v_lshlrev_b32 v226, 16, v168
    v_and_b32 v227, 0xffff0000, v168
    v_lshlrev_b32 v222, 16, v160
    v_and_b32 v223, 0xffff0000, v160
    v_lshlrev_b32 v224, 16, v164
    v_and_b32 v225, 0xffff0000, v164
    v_lshlrev_b32 v220, 16, v156
    v_and_b32 v221, 0xffff0000, v156
    v_max3_f32 v174, v216, v217, v218
    v_max3_f32 v172, v220, v221, v224
    v_max_f32 v174, v174, v219
    v_max3_f32 v172, v172, v225, v222
    v_mov_b32 v176, v174
    v_max3_f32 v172, v172, v223, v226
    v_max_f32 v172, v172, v227
    v_permlane32_swap_b32 v174, v176
    v_mul_f32 v172, s58, v172
    v_max_f32 v174, v174, v176
    v_mul_f32 v174, s58, v174
    v_pk_fma_f32 v[220:221], v[220:221], s[58:59], v[172:173] op_sel_hi:[1,1,0] neg_lo:[0,0,1] neg_hi:[0,0,1]
    v_pk_fma_f32 v[222:223], v[222:223], s[58:59], v[172:173] op_sel_hi:[1,1,0] neg_lo:[0,0,1] neg_hi:[0,0,1]
    v_pk_fma_f32 v[224:225], v[224:225], s[58:59], v[172:173] op_sel_hi:[1,1,0] neg_lo:[0,0,1] neg_hi:[0,0,1]
    v_pk_fma_f32 v[226:227], v[226:227], s[58:59], v[172:173] op_sel_hi:[1,1,0] neg_lo:[0,0,1] neg_hi:[0,0,1]
    v_pk_fma_f32 v[216:217], v[216:217], s[58:59], v[174:175] op_sel_hi:[1,1,0] neg_lo:[0,0,1] neg_hi:[0,0,1]
    v_pk_fma_f32 v[218:219], v[218:219], s[58:59], v[174:175] op_sel_hi:[1,1,0] neg_lo:[0,0,1] neg_hi:[0,0,1]
    v_exp_f32 v216, v216
    v_exp_f32 v217, v217
    v_exp_f32 v218, v218
    v_exp_f32 v219, v219
    v_exp_f32 v220, v220
    v_exp_f32 v221, v221
    v_exp_f32 v222, v222
    v_exp_f32 v223, v223
    v_exp_f32 v224, v224
    v_exp_f32 v225, v225
    v_exp_f32 v226, v226
    v_exp_f32 v227, v227
    ds_read_b32 v3, v2 offset:28
    v_pk_add_f32 v[174:175], v[216:217], v[218:219]
    v_pk_add_f32 v[172:173], v[220:221], v[222:223]
    v_add_f32 v174, v174, v175
    v_pk_add_f32 v[178:179], v[224:225], v[226:227]
    v_mov_b32 v176, v174
    v_pk_add_f32 v[172:173], v[172:173], v[178:179]
    v_add_f32 v172, v172, v173
    v_permlane32_swap_b32 v174, v176
    v_rcp_f32 v172, v172
    v_add_f32 v174, v174, v176
    v_rcp_f32 v174, v174
    v_pk_mul_f32 v[220:221], v[220:221], v[172:173] op_sel_hi:[1,0]
    v_pk_mul_f32 v[222:223], v[222:223], v[172:173] op_sel_hi:[1,0]
    v_pk_mul_f32 v[224:225], v[224:225], v[172:173] op_sel_hi:[1,0]
    v_pk_mul_f32 v[226:227], v[226:227], v[172:173] op_sel_hi:[1,0]
    v_pk_mul_f32 v[216:217], v[216:217], v[174:175] op_sel_hi:[1,0]
    v_pk_mul_f32 v[218:219], v[218:219], v[174:175] op_sel_hi:[1,0]
    v_cvt_pk_bf16_f32 v156, v220, v221
    v_cvt_pk_bf16_f32 v164, v224, v225
    v_cvt_pk_bf16_f32 v160, v222, v223
    v_cvt_pk_bf16_f32 v168, v226, v227
    v_cvt_pk_bf16_f32 v148, v216, v217
    v_cvt_pk_bf16_f32 v152, v218, v219
    v_permlane32_swap_b32 v156, v164
    v_permlane32_swap_b32 v160, v168
    v_permlane16_swap_b32 v148, v152
    s_waitcnt lgkmcnt(0)
    v_permlane16_swap_b32 v156, v160
    v_permlane16_swap_b32 v164, v168
    v_readfirstlane_b32 s33, v3
    s_cmp_lt_u32 s33, 1811939332
    s_cbranch_scc1 K_PW
K_PR:
    v_perm_b32 v56, v148, v148, v24
    v_perm_b32 v57, v148, v148, v25
    v_perm_b32 v58, v148, v148, v26
    v_perm_b32 v59, v148, v148, v27
    v_perm_b32 v72, v152, v152, v24
    v_perm_b32 v73, v152, v152, v25
    v_mfma_f32_16x16x32_bf16 v[64:67], v[228:231], v[56:59], 0
    v_perm_b32 v74, v152, v152, v26
    v_perm_b32 v75, v152, v152, v27
    v_mfma_f32_16x16x32_bf16 v[60:63], v[242:245], v[56:59], 0
    s_and_b32 s3, s36, 0xffc00
    s_cbranch_scc0 K_NOHb1
    v_mov_b32 v4, s36
    s_mov_b32 exec_lo, s37
    s_mov_b32 exec_hi, 0
    global_atomic_add v37, v4, s[6:7] sc1
    s_mov_b64 exec, -1
K_NOHb1:
    v_perm_b32 v88, v156, v156, v24
    v_perm_b32 v89, v156, v156, v25
    v_mfma_f32_16x16x32_bf16 v[80:83], v[230:233], v[72:75], 0
    v_perm_b32 v90, v156, v156, v26
    v_perm_b32 v91, v156, v156, v27
    v_mfma_f32_16x16x32_bf16 v[76:79], v[244:247], v[72:75], 0
    v_perm_b32 v104, v160, v160, v24
    v_perm_b32 v105, v160, v160, v25
    v_mfma_f32_16x16x32_bf16 v[96:99], v[232:235], v[88:91], 0
    v_perm_b32 v106, v160, v160, v26
    v_perm_b32 v107, v160, v160, v27
    v_mfma_f32_16x16x32_bf16 v[92:95], v[246:249], v[88:91], 0
    v_cvt_pk_bf16_f32 v68, v64, v65
    v_cvt_pk_bf16_f32 v69, v66, v67
    ds_write_b64 v35, v[68:69] offset:0
    v_perm_b32 v120, v164, v164, v24
    v_perm_b32 v121, v164, v164, v25
    v_mfma_f32_16x16x32_bf16 v[112:115], v[234:237], v[104:107], 0
    v_perm_b32 v122, v164, v164, v26
    v_perm_b32 v123, v164, v164, v27
    v_mfma_f32_16x16x32_bf16 v[108:111], v[248:251], v[104:107], 0
    v_cvt_pk_bf16_f32 v70, v80, v81
    v_cvt_pk_bf16_f32 v71, v82, v83
    ds_write_b64 v35, v[70:71] offset:256
    v_perm_b32 v136, v168, v168, v24
    v_perm_b32 v137, v168, v168, v25
    v_mfma_f32_16x16x32_bf16 v[128:131], v[236:239], v[120:123], 0
    v_perm_b32 v138, v168, v168, v26
    v_perm_b32 v139, v168, v168, v27
    v_mfma_f32_16x16x32_bf16 v[124:127], v[250:253], v[120:123], 0
    v_cvt_pk_bf16_f32 v100, v96, v97
    v_cvt_pk_bf16_f32 v101, v98, v99
    ds_write_b64 v35, v[100:101] offset:512
    v_mov_b32 v3, 1
    v_mfma_f32_16x16x32_bf16 v[144:147], v[238:241], v[136:139], 0
    v_lshl_add_u32 v2, s54, 2, v38
    v_cvt_pk_bf16_f32 v102, v112, v113
    v_cvt_pk_bf16_f32 v103, v114, v115
    ds_write_b64 v35, v[102:103] offset:768
    v_mfma_f32_16x16x32_bf16 v[140:143], v[252:255], v[136:139], 0
    v_cvt_pk_bf16_f32 v132, v128, v129
    v_cvt_pk_bf16_f32 v133, v130, v131
    ds_write_b64 v35, v[132:133] offset:1024
    v_cvt_pk_bf16_f32 v134, v144, v145
    v_cvt_pk_bf16_f32 v135, v146, v147
    ds_write_b64 v35, v[134:135] offset:1280
    s_mov_b64 exec, 1
    ds_add_u32 v2, v3 offset:48
    s_mov_b64 exec, -1
    v_cvt_pk_bf16_f32 v52, v60, v61
    v_cvt_pk_bf16_f32 v54, v76, v77
    v_cvt_pk_bf16_f32 v53, v62, v63
    v_cvt_pk_bf16_f32 v55, v78, v79
    s_nop 0
    v_permlane16_swap_b32 v52, v54
    v_permlane16_swap_b32 v53, v55
    v_min_u32 v52, -2, v52
    buffer_store_dwordx4 v[52:55], v28, s[20:23], 0 offen sc1
    v_cvt_pk_bf16_f32 v84, v92, v93
    v_cvt_pk_bf16_f32 v86, v108, v109
    v_cvt_pk_bf16_f32 v85, v94, v95
    v_cvt_pk_bf16_f32 v87, v110, v111
    s_nop 0
    v_permlane16_swap_b32 v84, v86
    v_permlane16_swap_b32 v85, v87
    v_min_u32 v84, -2, v84
    buffer_store_dwordx4 v[84:87], v29, s[20:23], 0 offen sc1
    ds_read_b32 v3, v2 offset:48
    ds_read_b128 v[196:199], v36
    s_and_b32 s3, s36, 0x3ff
    s_cbranch_scc0 K_NOHa5
    v_mov_b32 v4, s36
    s_mov_b32 exec_lo, s37
    s_mov_b32 exec_hi, 0
    global_atomic_add v37, v4, s[6:7] sc1
    s_mov_b64 exec, -1
K_NOHa5:
    v_cvt_pk_bf16_f32 v116, v124, v125
    v_cvt_pk_bf16_f32 v118, v140, v141
    v_cvt_pk_bf16_f32 v117, v126, v127
    v_cvt_pk_bf16_f32 v119, v142, v143
    s_nop 0
    v_permlane16_swap_b32 v116, v118
    v_permlane16_swap_b32 v117, v119
    v_min_u32 v116, -2, v116
    buffer_store_dwordx4 v[116:119], v30, s[20:23], 0 offen sc1
    s_waitcnt lgkmcnt(0)
    v_readfirstlane_b32 s33, v3
    s_cmp_lt_u32 s33, 2
    s_cbranch_scc1 K_TW
K_TR:
    v_min_u32 v196, -2, v196
    buffer_store_dwordx4 v[196:199], v31, s[20:23], 0 offen sc1
    s_cmp_eq_u32 s34, -1
    s_cbranch_scc1 K_END
    s_add_u32 s30, s30, 4
    s_branch K_P2_HELP
K_CHM3:
K_STM3:
    s_branch K_WRET_M
    s_nop 0
K_XW:
    s_mov_b32 s3, 1048576
K_CGX:
    ds_read_b32 v3, v2 offset:28
    s_sub_u32 s3, s3, 1
    s_waitcnt lgkmcnt(0)
    v_readfirstlane_b32 s33, v3
    s_cselect_b32 s33, 1811939328, s33
    s_cmp_lt_u32 s33, 1811939328
    s_cbranch_scc1 K_CGX
    ds_read_b64 v[144:145], v34
    ds_read_b64 v[146:147], v34 offset:512
    ds_read_b64 v[242:243], v34 offset:1024
    ds_read_b64_tr_b16 v[228:229], v33
    s_waitcnt lgkmcnt(0)
    s_branch K_XR
K_PW:
    s_mov_b32 s3, 1048576
K_CGP:
    ds_read_b32 v3, v2 offset:28
    s_sub_u32 s3, s3, 1
    s_waitcnt lgkmcnt(0)
    v_readfirstlane_b32 s33, v3
    s_cselect_b32 s33, 1811939332, s33
    s_cmp_lt_u32 s33, 1811939332
    s_cbranch_scc1 K_CGP
    s_branch K_PR
K_TW:
    s_mov_b32 s3, 1048576
K_CGT:
    ds_read_b32 v3, v2 offset:48
    s_sub_u32 s3, s3, 1
    s_waitcnt lgkmcnt(0)
    v_readfirstlane_b32 s33, v3
    s_cselect_b32 s33, 2, s33
    s_cmp_lt_u32 s33, 2
    s_cbranch_scc1 K_CGT
    ds_read_b128 v[196:199], v36
    s_waitcnt lgkmcnt(0)
    s_branch K_TR
K_P2_EARLY:
    s_lshl_b32 s62, s40, 7
    v_lshrrev_b32 v8, 3, v1
    v_lshrrev_b32 v9, 4, v1
    v_mov_b32 v15, 158720
    s_lshl_b32 s61, s40, 3
    s_add_u32 s61, s61, s30
    s_mul_i32 s3, s61, 20480
    s_lshl_b32 s33, s41, 7
    s_add_u32 s3, s3, s33
    v_and_b32 v2, 7, v1
    v_lshlrev_b32 v2, 4, v2
    v_mul_u32_u24 v4, 1280, v8
    v_add3_u32 v10, v2, v4, s3
    s_lshl_b32 s3, s30, 7
    s_add_u32 s3, s3, 159744
    v_lshl_add_u32 v11, v8, 3, s3
    s_mov_b32 s63, 10240
    s_add_u32 s20, s6, 0x100000
    s_addc_u32 s21, s7, 0
    s_mov_b32 s22, 0x280000
    s_mov_b32 s23, 0x20000
    s_mov_b32 s56, s10
    s_mov_b32 s57, s11
    s_mov_b32 s58, 0x280000
    s_mov_b32 s59, 0x20000
    v_mul_u32_u24 v3, 144, v8
    v_add_u32 v3, v2, v3
    s_mul_i32 s3, s30, 2304
    s_add_u32 s3, s3, 140288
    v_add_u32 v14, s3, v3
    buffer_load_dwordx4 v[16:19], v10, s[12:15], 0 offen
    buffer_load_dwordx4 v[20:23], v10, s[12:15], s63 offen
    v_bfe_u32 v48, v1, 2, 2
    v_and_b32 v49, 3, v1
    s_add_u32 s3, s61, s30
    s_lshr_b32 s33, s3, 2
    s_mul_i32 s33, s33, 76
    s_add_u32 s3, s3, s33
    s_lshl_b32 s3, s3, 10
    v_and_b32 v2, 15, v1
    v_lshl_add_u32 v2, v2, 4, s3
    v_lshrrev_b32 v3, 5, v1
    v_lshl_add_u32 v2, v3, 8, v2
    v_and_b32 v4, 1, v9
    v_lshl_add_u32 v52, v4, 10, v2
    v_mov_b32 v53, 0x1f000
    v_lshl_add_u32 v2, v3, 3, v48
    v_lshlrev_b32 v2, 7, v2
    v_lshl_add_u32 v2, v49, 3, v2
    v_lshl_add_u32 v2, v4, 5, v2
    v_lshrrev_b32 v4, 1, v48
    v_lshl_add_u32 v54, v4, 6, v2
    v_xor_b32 v55, 64, v54
    v_mov_b32 v56, v54
    v_mov_b32 v57, v54
    s_branch K_PG3
.p2align 12
K_CHA0:
K_STA4:
    s_branch K_STA8
K_CHB0:
K_STB4:
    s_branch K_STB8
K_PG3:
    v_and_b32 v2, 31, v1
    v_mul_u32_u24 v2, 144, v2
    v_lshl_add_u32 v2, v3, 3, v2
    s_mul_i32 s3, s30, 4608
    s_add_u32 s3, s3, 140288
    v_add_u32 v50, s3, v2
    s_and_b32 s33, s40, 3
    s_lshl_b32 s33, s33, 2
    s_lshr_b32 s33, 0xf63f, s33
    s_and_b32 s33, s33, 15
    s_lshl1_add_u32 s3, s30, 1
    s_cmp_ge_u32 s3, s33
    s_cselect_b32 s60, 24, 16
    s_cmp_gt_u32 s3, s33
    s_cselect_b32 s60, 20, s60
    v_add_u32 v58, s60, v15
    s_mov_b32 s64, -1
    s_mov_b32 s65, -1
    s_mov_b32 s66, -1
    s_mov_b32 s67, -1
    s_mov_b32 s68, -1
    s_mov_b32 s69, -1
    s_mov_b32 s70, 0xfffff
    s_mov_b32 s71, 131072
    v_mov_b32 v108, 0
    v_mov_b32 v109, 0
    v_mov_b32 v110, 0
    v_mov_b32 v111, 0
    v_mov_b32 v112, 0
    v_mov_b32 v113, 0
    v_mov_b32 v114, 0
    v_mov_b32 v115, 0
    v_mov_b32 v116, 0
    v_mov_b32 v117, 0
    v_mov_b32 v118, 0
    v_mov_b32 v119, 0
    v_mov_b32 v120, 0
    v_mov_b32 v121, 0
    v_mov_b32 v122, 0
    v_mov_b32 v123, 0
    v_mov_b32 v124, 0
    v_mov_b32 v125, 0
    v_mov_b32 v126, 0
    v_mov_b32 v127, 0
    v_mov_b32 v128, 0
    v_mov_b32 v129, 0
    v_mov_b32 v130, 0
    v_mov_b32 v131, 0
    v_mov_b32 v132, 0
    v_mov_b32 v133, 0
    v_mov_b32 v134, 0
    v_mov_b32 v135, 0
    v_mov_b32 v136, 0
    v_mov_b32 v137, 0
    v_mov_b32 v138, 0
    v_mov_b32 v139, 0
    s_barrier
    s_branch K_P2_AUXW
K_P2_GM:
    s_lshl_b32 s62, s40, 7
    v_lshrrev_b32 v8, 3, v1
    v_lshrrev_b32 v9, 4, v1
    v_mov_b32 v15, 158720
    s_lshl_b32 s61, s40, 3
    s_add_u32 s61, s61, s30
    s_mul_i32 s3, s61, 20480
    s_lshl_b32 s33, s41, 7
    s_add_u32 s3, s3, s33
    v_and_b32 v2, 7, v1
    v_lshlrev_b32 v2, 4, v2
    v_mul_u32_u24 v4, 1280, v8
    v_add3_u32 v10, v2, v4, s3
    s_lshl_b32 s3, s30, 7
    s_add_u32 s3, s3, 159744
    v_lshl_add_u32 v11, v8, 3, s3
    s_mov_b32 s63, 10240
    s_add_u32 s20, s6, 0x100000
    s_addc_u32 s21, s7, 0
    s_mov_b32 s22, 0x280000
    s_mov_b32 s23, 0x20000
    s_mov_b32 s56, s10
    s_mov_b32 s57, s11
    s_mov_b32 s58, 0x280000
    s_mov_b32 s59, 0x20000
    v_mul_u32_u24 v3, 144, v8
    v_add_u32 v3, v2, v3
    s_mul_i32 s3, s30, 2304
    s_add_u32 s3, s3, 140288
    v_add_u32 v14, s3, v3
    v_bfe_u32 v48, v1, 2, 2
    v_and_b32 v49, 3, v1
    s_add_u32 s3, s61, s30
    s_lshr_b32 s33, s3, 2
    s_mul_i32 s33, s33, 76
    s_add_u32 s3, s3, s33
    s_lshl_b32 s3, s3, 10
    v_and_b32 v2, 15, v1
    v_lshl_add_u32 v2, v2, 4, s3
    v_lshrrev_b32 v3, 5, v1
    v_lshl_add_u32 v2, v3, 8, v2
    v_and_b32 v4, 1, v9
    v_lshl_add_u32 v52, v4, 10, v2
    v_mov_b32 v53, 0x1f000
    v_lshl_add_u32 v2, v3, 3, v48
    v_lshlrev_b32 v2, 7, v2
    v_lshl_add_u32 v2, v49, 3, v2
    v_lshl_add_u32 v2, v4, 5, v2
    v_lshrrev_b32 v4, 1, v48
    v_lshl_add_u32 v54, v4, 6, v2
    v_xor_b32 v55, 64, v54
    v_mov_b32 v56, v54
    v_mov_b32 v57, v54
    v_and_b32 v2, 31, v1
    v_mul_u32_u24 v2, 144, v2
    v_lshl_add_u32 v2, v3, 3, v2
    s_mul_i32 s3, s30, 4608
    s_add_u32 s3, s3, 140288
    v_add_u32 v50, s3, v2
    s_and_b32 s33, s40, 3
    s_lshl_b32 s33, s33, 2
    s_lshr_b32 s33, 0xf63f, s33
    s_and_b32 s33, s33, 15
    s_lshl1_add_u32 s3, s30, 1
    s_cmp_ge_u32 s3, s33
    s_cselect_b32 s60, 24, 16
    s_cmp_gt_u32 s3, s33
    s_cselect_b32 s60, 20, s60
    v_add_u32 v58, s60, v15
    s_mov_b32 s64, -1
    s_mov_b32 s65, -1
    s_mov_b32 s66, -1
    s_mov_b32 s67, -1
    s_mov_b32 s68, -1
    s_mov_b32 s69, -1
    s_mov_b32 s70, 0xfffff
    s_mov_b32 s71, 131072
    v_mov_b32 v108, 0
    v_mov_b32 v109, 0
    v_mov_b32 v110, 0
    v_mov_b32 v111, 0
    v_mov_b32 v112, 0
    v_mov_b32 v113, 0
    v_mov_b32 v114, 0
    v_mov_b32 v115, 0
    v_mov_b32 v116, 0
    v_mov_b32 v117, 0
    v_mov_b32 v118, 0
    v_mov_b32 v119, 0
    v_mov_b32 v120, 0
    v_mov_b32 v121, 0
    v_mov_b32 v122, 0
    v_mov_b32 v123, 0
    v_mov_b32 v124, 0
    v_mov_b32 v125, 0
    v_mov_b32 v126, 0
    v_mov_b32 v127, 0
    v_mov_b32 v128, 0
    v_mov_b32 v129, 0
    v_mov_b32 v130, 0
    v_mov_b32 v131, 0
    v_mov_b32 v132, 0
    v_mov_b32 v133, 0
    v_mov_b32 v134, 0
    v_mov_b32 v135, 0
    v_mov_b32 v136, 0
    v_mov_b32 v137, 0
    v_mov_b32 v138, 0
    v_mov_b32 v139, 0
    buffer_load_dwordx4 v[16:19], v10, s[12:15], 0 offen
    buffer_load_dwordx4 v[20:23], v10, s[12:15], s63 offen
    s_cmp_eq_u32 s30, 0
    s_cbranch_scc1 K_CHB0
    s_cmp_eq_u32 s30, 1
    s_cbranch_scc1 K_CHB1
    s_cmp_eq_u32 s30, 2
    s_cbranch_scc1 K_CHB2
    s_branch K_CHB3
K_WRET_B:
    v_mov_b32 v3, 1
    s_waitcnt vmcnt(2)
    s_mov_b64 exec, 1
    ds_add_u32 v15, v3 offset:44
    s_mov_b64 exec, -1
    s_mov_b32 s3, 1048576
K_P2_GWM:
    ds_read_b32 v2, v15 offset:44
    s_sleep 1
    s_sub_u32 s3, s3, 1
    s_waitcnt lgkmcnt(0)
    v_readfirstlane_b32 s33, v2
    s_nop 3
    s_cselect_b32 s33, 4, s33
    s_cmp_lt_u32 s33, 4
    s_cbranch_scc1 K_P2_GWM
    ds_write_b32 v15, v15 offset:56
K_P2_GEMM:
    s_setprio 1
    s_add_u32 s53, s40, 1
    s_and_b32 s53, s53, 2
    s_mov_b32 s46, 0x84210
    s_mov_b32 s47, s46
    s_waitcnt vmcnt(0)
    v_lshlrev_b32 v32, 16, v16
    v_and_b32 v33, 0xffff0000, v16
    v_lshlrev_b32 v34, 16, v17
    v_and_b32 v35, 0xffff0000, v17
    v_lshlrev_b32 v36, 16, v18
    v_and_b32 v37, 0xffff0000, v18
    v_lshlrev_b32 v38, 16, v19
    v_and_b32 v39, 0xffff0000, v19
    v_lshlrev_b32 v40, 16, v20
    v_and_b32 v41, 0xffff0000, v20
    v_lshlrev_b32 v42, 16, v21
    v_and_b32 v43, 0xffff0000, v21
    v_lshlrev_b32 v44, 16, v22
    v_and_b32 v45, 0xffff0000, v22
    v_lshlrev_b32 v46, 16, v23
    v_and_b32 v47, 0xffff0000, v23
    s_branch K_SPL
    s_nop 0
    s_nop 0
    s_nop 0
K_IT0:
    v_mfma_f32_32x32x16_bf16 v[108:123], v[156:159], v[68:71], v[108:123]
    ds_read_b64_tr_b16 v[140:141], v56 offset:0
    ds_read_b64_tr_b16 v[142:143], v56 offset:512
    s_and_b32 s33, s50, s70
    s_cbranch_scc0 K_RF0
K_RB0:
    s_ff1_i32_b32 s51, s33
    v_mfma_f32_32x32x16_bf16 v[124:139], v[164:167], v[68:71], v[124:139]
    s_bitset0_b32 s70, s51
    s_lshl_b32 s64, s51, 12
    buffer_load_dwordx4 v[60:63], v52, s[20:23], s64 offen offset:0 sc1
    ds_read_b64_tr_b16 v[144:145], v56 offset:2048
    ds_read_b64_tr_b16 v[146:147], v56 offset:2560
    v_mfma_f32_32x32x16_bf16 v[108:123], v[160:163], v[72:75], v[108:123]
    buffer_load_dwordx4 v[64:67], v52, s[20:23], s64 offen offset:512 sc1
    ds_read_b64_tr_b16 v[148:149], v57 offset:0
    ds_read_b64_tr_b16 v[150:151], v57 offset:512
    s_waitcnt vmcnt(8) lgkmcnt(6)
    v_cmp_u_f32 vcc, v76, v80
    v_mfma_f32_32x32x16_bf16 v[124:139], v[168:171], v[72:75], v[124:139]
    ds_read_b64_tr_b16 v[152:153], v57 offset:2048
    ds_read_b64_tr_b16 v[154:155], v57 offset:2560
    v_and_or_b32 v56, s68, v53, v54
    v_and_or_b32 v57, s68, v53, v55
    s_cbranch_vccnz K_FX1
K_IT1:
    v_mfma_f32_32x32x16_bf16 v[108:123], v[172:175], v[76:79], v[108:123]
    ds_read_b64_tr_b16 v[156:157], v56 offset:0
    ds_read_b64_tr_b16 v[158:159], v56 offset:512
    s_and_b32 s33, s50, s70
    s_cbranch_scc0 K_RF1
K_RB1:
    s_ff1_i32_b32 s51, s33
    v_mfma_f32_32x32x16_bf16 v[124:139], v[180:183], v[76:79], v[124:139]
    s_bitset0_b32 s70, s51
    s_lshl_b32 s65, s51, 12
    buffer_load_dwordx4 v[68:71], v52, s[20:23], s65 offen offset:0 sc1
    ds_read_b64_tr_b16 v[160:161], v56 offset:2048
    ds_read_b64_tr_b16 v[162:163], v56 offset:2560
    v_mfma_f32_32x32x16_bf16 v[108:123], v[176:179], v[80:83], v[108:123]
    buffer_load_dwordx4 v[72:75], v52, s[20:23], s65 offen offset:512 sc1
    ds_read_b64_tr_b16 v[164:165], v57 offset:0
    ds_read_b64_tr_b16 v[166:167], v57 offset:512
    s_waitcnt vmcnt(8) lgkmcnt(6)
    v_cmp_u_f32 vcc, v84, v88
    v_mfma_f32_32x32x16_bf16 v[124:139], v[184:187], v[80:83], v[124:139]
    ds_read_b64_tr_b16 v[168:169], v57 offset:2048
    ds_read_b64_tr_b16 v[170:171], v57 offset:2560
    v_and_or_b32 v56, s69, v53, v54
    v_and_or_b32 v57, s69, v53, v55
    s_cbranch_vccnz K_FX2
K_IT2:
    v_mfma_f32_32x32x16_bf16 v[108:123], v[140:143], v[84:87], v[108:123]
    ds_read_b64_tr_b16 v[172:173], v56 offset:0
    ds_read_b64_tr_b16 v[174:175], v56 offset:512
    s_and_b32 s33, s50, s70
    s_cbranch_scc0 K_RF2
K_RB2:
    s_ff1_i32_b32 s51, s33
    v_mfma_f32_32x32x16_bf16 v[124:139], v[148:151], v[84:87], v[124:139]
    s_bitset0_b32 s70, s51
    s_lshl_b32 s66, s51, 12
    buffer_load_dwordx4 v[76:79], v52, s[20:23], s66 offen offset:0 sc1
    ds_read_b64_tr_b16 v[176:177], v56 offset:2048
    ds_read_b64_tr_b16 v[178:179], v56 offset:2560
    v_mfma_f32_32x32x16_bf16 v[108:123], v[144:147], v[88:91], v[108:123]
    buffer_load_dwordx4 v[80:83], v52, s[20:23], s66 offen offset:512 sc1
    ds_read_b64_tr_b16 v[180:181], v57 offset:0
    ds_read_b64_tr_b16 v[182:183], v57 offset:512
    s_waitcnt vmcnt(8) lgkmcnt(6)
    v_cmp_u_f32 vcc, v92, v96
    v_mfma_f32_32x32x16_bf16 v[124:139], v[152:155], v[88:91], v[124:139]
    ds_read_b64_tr_b16 v[184:185], v57 offset:2048
    ds_read_b64_tr_b16 v[186:187], v57 offset:2560
    v_and_or_b32 v56, s64, v53, v54
    v_and_or_b32 v57, s64, v53, v55
    s_cbranch_vccnz K_FX3
K_IT3:
    v_mfma_f32_32x32x16_bf16 v[108:123], v[156:159], v[92:95], v[108:123]
    ds_read_b64_tr_b16 v[140:141], v56 offset:0
    ds_read_b64_tr_b16 v[142:143], v56 offset:512
    s_and_b32 s33, s50, s70
    s_cbranch_scc0 K_RF3
K_RB3:
    s_ff1_i32_b32 s51, s33
    v_mfma_f32_32x32x16_bf16 v[124:139], v[164:167], v[92:95], v[124:139]
    s_bitset0_b32 s70, s51
    s_lshl_b32 s67, s51, 12
    buffer_load_dwordx4 v[84:87], v52, s[20:23], s67 offen offset:0 sc1
    ds_read_b64_tr_b16 v[144:145], v56 offset:2048
    ds_read_b64_tr_b16 v[146:147], v56 offset:2560
    v_mfma_f32_32x32x16_bf16 v[108:123], v[160:163], v[96:99], v[108:123]
    buffer_load_dwordx4 v[88:91], v52, s[20:23], s67 offen offset:512 sc1
    ds_read_b64_tr_b16 v[148:149], v57 offset:0
    ds_read_b64_tr_b16 v[150:151], v57 offset:512
    s_waitcnt vmcnt(8) lgkmcnt(6)
    v_cmp_u_f32 vcc, v100, v104
    v_mfma_f32_32x32x16_bf16 v[124:139], v[168:171], v[96:99], v[124:139]
    ds_read_b64_tr_b16 v[152:153], v57 offset:2048
    ds_read_b64_tr_b16 v[154:155], v57 offset:2560
    v_and_or_b32 v56, s65, v53, v54
    v_and_or_b32 v57, s65, v53, v55
    s_cbranch_vccnz K_FX4
K_IT4:
    v_mfma_f32_32x32x16_bf16 v[108:123], v[172:175], v[100:103], v[108:123]
    ds_read_b64_tr_b16 v[156:157], v56 offset:0
    ds_read_b64_tr_b16 v[158:159], v56 offset:512
    s_and_b32 s33, s50, s70
    s_cbranch_scc0 K_RF4
K_RB4:
    s_ff1_i32_b32 s51, s33
    v_mfma_f32_32x32x16_bf16 v[124:139], v[180:183], v[100:103], v[124:139]
    s_bitset0_b32 s70, s51
    s_lshl_b32 s68, s51, 12
    buffer_load_dwordx4 v[92:95], v52, s[20:23], s68 offen offset:0 sc1
    ds_read_b64_tr_b16 v[160:161], v56 offset:2048
    ds_read_b64_tr_b16 v[162:163], v56 offset:2560
    v_mfma_f32_32x32x16_bf16 v[108:123], v[176:179], v[104:107], v[108:123]
    buffer_load_dwordx4 v[96:99], v52, s[20:23], s68 offen offset:512 sc1
    ds_read_b64_tr_b16 v[164:165], v57 offset:0
    ds_read_b64_tr_b16 v[166:167], v57 offset:512
    s_waitcnt vmcnt(8) lgkmcnt(6)
    v_cmp_u_f32 vcc, v60, v64
    v_mfma_f32_32x32x16_bf16 v[124:139], v[184:187], v[104:107], v[124:139]
    ds_read_b64_tr_b16 v[168:169], v57 offset:2048
    ds_read_b64_tr_b16 v[170:171], v57 offset:2560
    v_and_or_b32 v56, s66, v53, v54
    v_and_or_b32 v57, s66, v53, v55
    s_cbranch_vccnz K_FX5
K_IT5:
    v_mfma_f32_32x32x16_bf16 v[108:123], v[140:143], v[60:63], v[108:123]
    ds_read_b64_tr_b16 v[172:173], v56 offset:0
    ds_read_b64_tr_b16 v[174:175], v56 offset:512
    s_and_b32 s33, s50, s70
    s_cbranch_scc0 K_RF5
K_RB5:
    s_ff1_i32_b32 s51, s33
    v_mfma_f32_32x32x16_bf16 v[124:139], v[148:151], v[60:63], v[124:139]
    s_bitset0_b32 s70, s51
    s_lshl_b32 s69, s51, 12
    buffer_load_dwordx4 v[100:103], v52, s[20:23], s69 offen offset:0 sc1
    ds_read_b64_tr_b16 v[176:177], v56 offset:2048
    ds_read_b64_tr_b16 v[178:179], v56 offset:2560
    v_mfma_f32_32x32x16_bf16 v[108:123], v[144:147], v[64:67], v[108:123]
    buffer_load_dwordx4 v[104:107], v52, s[20:23], s69 offen offset:512 sc1
    ds_read_b64_tr_b16 v[180:181], v57 offset:0
    ds_read_b64_tr_b16 v[182:183], v57 offset:512
    s_waitcnt vmcnt(8) lgkmcnt(6)
    v_cmp_u_f32 vcc, v68, v72
    v_mfma_f32_32x32x16_bf16 v[124:139], v[152:155], v[64:67], v[124:139]
    ds_read_b64_tr_b16 v[184:185], v57 offset:2048
    ds_read_b64_tr_b16 v[186:187], v57 offset:2560
    v_and_or_b32 v56, s67, v53, v54
    v_and_or_b32 v57, s67, v53, v55
    s_cbranch_vccnz K_FX0
    s_branch K_IT0
    s_nop 0
K_DR0:
    v_mfma_f32_32x32x16_bf16 v[108:123], v[156:159], v[68:71], v[108:123]
    ds_read_b64_tr_b16 v[140:141], v56 offset:0
    ds_read_b64_tr_b16 v[142:143], v56 offset:512
K_DM0:
    s_mov_b32 s64, -1
    v_mov_b32 v60, -1
    v_mfma_f32_32x32x16_bf16 v[124:139], v[164:167], v[68:71], v[124:139]
    buffer_load_dword v3, v52, s[20:23], s64 offen
    ds_read_b64_tr_b16 v[144:145], v56 offset:2048
    ds_read_b64_tr_b16 v[146:147], v56 offset:2560
    v_mfma_f32_32x32x16_bf16 v[108:123], v[160:163], v[72:75], v[108:123]
    buffer_load_dword v3, v52, s[20:23], s64 offen
    ds_read_b64_tr_b16 v[148:149], v57 offset:0
    ds_read_b64_tr_b16 v[150:151], v57 offset:512
    s_waitcnt vmcnt(8) lgkmcnt(6)
    v_cmp_u_f32 vcc, v76, v80
    v_mfma_f32_32x32x16_bf16 v[124:139], v[168:171], v[72:75], v[124:139]
    ds_read_b64_tr_b16 v[152:153], v57 offset:2048
    ds_read_b64_tr_b16 v[154:155], v57 offset:2560
    v_and_or_b32 v56, s68, v53, v54
    v_and_or_b32 v57, s68, v53, v55
    s_cbranch_vccnz K_DX1
K_DR1:
    v_mfma_f32_32x32x16_bf16 v[108:123], v[172:175], v[76:79], v[108:123]
    ds_read_b64_tr_b16 v[156:157], v56 offset:0
    ds_read_b64_tr_b16 v[158:159], v56 offset:512
K_DM1:
    s_mov_b32 s65, -1
    v_mov_b32 v68, -1
    v_mfma_f32_32x32x16_bf16 v[124:139], v[180:183], v[76:79], v[124:139]
    buffer_load_dword v3, v52, s[20:23], s65 offen
    ds_read_b64_tr_b16 v[160:161], v56 offset:2048
    ds_read_b64_tr_b16 v[162:163], v56 offset:2560
    v_mfma_f32_32x32x16_bf16 v[108:123], v[176:179], v[80:83], v[108:123]
    buffer_load_dword v3, v52, s[20:23], s65 offen
    ds_read_b64_tr_b16 v[164:165], v57 offset:0
    ds_read_b64_tr_b16 v[166:167], v57 offset:512
    s_waitcnt vmcnt(8) lgkmcnt(6)
    v_cmp_u_f32 vcc, v84, v88
    v_mfma_f32_32x32x16_bf16 v[124:139], v[184:187], v[80:83], v[124:139]
    ds_read_b64_tr_b16 v[168:169], v57 offset:2048
    ds_read_b64_tr_b16 v[170:171], v57 offset:2560
    v_and_or_b32 v56, s69, v53, v54
    v_and_or_b32 v57, s69, v53, v55
    s_cbranch_vccnz K_DX2
K_DR2:
    v_mfma_f32_32x32x16_bf16 v[108:123], v[140:143], v[84:87], v[108:123]
    ds_read_b64_tr_b16 v[172:173], v56 offset:0
    ds_read_b64_tr_b16 v[174:175], v56 offset:512
K_DM2:
    s_mov_b32 s66, -1
    v_mov_b32 v76, -1
    v_mfma_f32_32x32x16_bf16 v[124:139], v[148:151], v[84:87], v[124:139]
    buffer_load_dword v3, v52, s[20:23], s66 offen
    ds_read_b64_tr_b16 v[176:177], v56 offset:2048
    ds_read_b64_tr_b16 v[178:179], v56 offset:2560
    v_mfma_f32_32x32x16_bf16 v[108:123], v[144:147], v[88:91], v[108:123]
    buffer_load_dword v3, v52, s[20:23], s66 offen
    ds_read_b64_tr_b16 v[180:181], v57 offset:0
    ds_read_b64_tr_b16 v[182:183], v57 offset:512
    s_waitcnt vmcnt(8) lgkmcnt(6)
    v_cmp_u_f32 vcc, v92, v96
    v_mfma_f32_32x32x16_bf16 v[124:139], v[152:155], v[88:91], v[124:139]
    ds_read_b64_tr_b16 v[184:185], v57 offset:2048
    ds_read_b64_tr_b16 v[186:187], v57 offset:2560
    v_and_or_b32 v56, s64, v53, v54
    v_and_or_b32 v57, s64, v53, v55
    s_cbranch_vccnz K_DX3
K_DR3:
    v_mfma_f32_32x32x16_bf16 v[108:123], v[156:159], v[92:95], v[108:123]
    ds_read_b64_tr_b16 v[140:141], v56 offset:0
    ds_read_b64_tr_b16 v[142:143], v56 offset:512
K_DM3:
    s_mov_b32 s67, -1
    v_mov_b32 v84, -1
    v_mfma_f32_32x32x16_bf16 v[124:139], v[164:167], v[92:95], v[124:139]
    buffer_load_dword v3, v52, s[20:23], s67 offen
    ds_read_b64_tr_b16 v[144:145], v56 offset:2048
    ds_read_b64_tr_b16 v[146:147], v56 offset:2560
    v_mfma_f32_32x32x16_bf16 v[108:123], v[160:163], v[96:99], v[108:123]
    buffer_load_dword v3, v52, s[20:23], s67 offen
    ds_read_b64_tr_b16 v[148:149], v57 offset:0
    ds_read_b64_tr_b16 v[150:151], v57 offset:512
    s_waitcnt vmcnt(8) lgkmcnt(6)
    v_cmp_u_f32 vcc, v100, v104
    v_mfma_f32_32x32x16_bf16 v[124:139], v[168:171], v[96:99], v[124:139]
    ds_read_b64_tr_b16 v[152:153], v57 offset:2048
    ds_read_b64_tr_b16 v[154:155], v57 offset:2560
    v_and_or_b32 v56, s65, v53, v54
    v_and_or_b32 v57, s65, v53, v55
    s_cbranch_vccnz K_DX4
K_DR4:
    v_mfma_f32_32x32x16_bf16 v[108:123], v[172:175], v[100:103], v[108:123]
    ds_read_b64_tr_b16 v[156:157], v56 offset:0
    ds_read_b64_tr_b16 v[158:159], v56 offset:512
K_DM4:
    s_mov_b32 s68, -1
    v_mov_b32 v92, -1
    v_mfma_f32_32x32x16_bf16 v[124:139], v[180:183], v[100:103], v[124:139]
    buffer_load_dword v3, v52, s[20:23], s68 offen
    ds_read_b64_tr_b16 v[160:161], v56 offset:2048
    ds_read_b64_tr_b16 v[162:163], v56 offset:2560
    v_mfma_f32_32x32x16_bf16 v[108:123], v[176:179], v[104:107], v[108:123]
    buffer_load_dword v3, v52, s[20:23], s68 offen
    ds_read_b64_tr_b16 v[164:165], v57 offset:0
    ds_read_b64_tr_b16 v[166:167], v57 offset:512
    s_waitcnt vmcnt(8) lgkmcnt(6)
    v_cmp_u_f32 vcc, v60, v64
    v_mfma_f32_32x32x16_bf16 v[124:139], v[184:187], v[104:107], v[124:139]
    ds_read_b64_tr_b16 v[168:169], v57 offset:2048
    ds_read_b64_tr_b16 v[170:171], v57 offset:2560
    v_and_or_b32 v56, s66, v53, v54
    v_and_or_b32 v57, s66, v53, v55
    s_cbranch_vccnz K_DX5
K_DR5:
    v_mfma_f32_32x32x16_bf16 v[108:123], v[140:143], v[60:63], v[108:123]
    ds_read_b64_tr_b16 v[172:173], v56 offset:0
    ds_read_b64_tr_b16 v[174:175], v56 offset:512
K_DM5:
    s_mov_b32 s69, -1
    v_mov_b32 v100, -1
    v_mfma_f32_32x32x16_bf16 v[124:139], v[148:151], v[60:63], v[124:139]
    buffer_load_dword v3, v52, s[20:23], s69 offen
    ds_read_b64_tr_b16 v[176:177], v56 offset:2048
    ds_read_b64_tr_b16 v[178:179], v56 offset:2560
    v_mfma_f32_32x32x16_bf16 v[108:123], v[144:147], v[64:67], v[108:123]
    buffer_load_dword v3, v52, s[20:23], s69 offen
    ds_read_b64_tr_b16 v[180:181], v57 offset:0
    ds_read_b64_tr_b16 v[182:183], v57 offset:512
    s_waitcnt vmcnt(8) lgkmcnt(6)
    v_cmp_u_f32 vcc, v68, v72
    v_mfma_f32_32x32x16_bf16 v[124:139], v[152:155], v[64:67], v[124:139]
    ds_read_b64_tr_b16 v[184:185], v57 offset:2048
    ds_read_b64_tr_b16 v[186:187], v57 offset:2560
    v_and_or_b32 v56, s67, v53, v54
    v_and_or_b32 v57, s67, v53, v55
    s_cbranch_vccnz K_DX0
    s_branch K_DR0
K_CHA1:
K_STA5:
    s_branch K_STA9
K_CHB1:
K_STB5:
    s_branch K_STB9
K_RF0:
    s_cmp_eq_u32 s70, 0
    s_cbranch_scc1 K_DM0
    ds_read_b32 v59, v58
    s_waitcnt lgkmcnt(0)
    v_readfirstlane_b32 s50, v59
    s_and_b32 s33, s50, s70
    s_cbranch_scc1 K_RB0
    v_mfma_f32_32x32x16_bf16 v[124:139], v[164:167], v[68:71], v[124:139]
    s_mov_b32 s64, -1
    v_mov_b32 v60, -1
    buffer_load_dword v3, v52, s[20:23], s64 offen
    ds_read_b64_tr_b16 v[144:145], v56 offset:2048
    ds_read_b64_tr_b16 v[146:147], v56 offset:2560
    v_mfma_f32_32x32x16_bf16 v[108:123], v[160:163], v[72:75], v[108:123]
    buffer_load_dword v3, v52, s[20:23], s64 offen
    ds_read_b64_tr_b16 v[148:149], v57 offset:0
    ds_read_b64_tr_b16 v[150:151], v57 offset:512
    s_waitcnt vmcnt(8) lgkmcnt(6)
    v_cmp_u_f32 vcc, v76, v80
    v_mfma_f32_32x32x16_bf16 v[124:139], v[168:171], v[72:75], v[124:139]
    ds_read_b64_tr_b16 v[152:153], v57 offset:2048
    ds_read_b64_tr_b16 v[154:155], v57 offset:2560
    v_and_or_b32 v56, s68, v53, v54
    v_and_or_b32 v57, s68, v53, v55
    s_cbranch_vccz K_IT1
    s_branch K_FX1
K_TL0:
    s_waitcnt vmcnt(8) lgkmcnt(8)
    v_cmp_u_f32 vcc, v76, v80
    v_and_or_b32 v56, s68, v53, v54
    v_and_or_b32 v57, s68, v53, v55
    s_cbranch_vccz K_IT1
    s_branch K_FX1
K_DX0:
    s_and_b32 s51, s65, s66
    s_and_b32 s51, s51, s67
    s_and_b32 s51, s51, s68
    s_cmp_lt_i32 s51, 0
    s_cbranch_scc1 K_P2_MM
K_FX0:
    s_cmp_lt_i32 s65, 0
    s_cbranch_scc1 K_SK0
    v_max_u32 v2, v68, v72
    v_cmp_eq_u32 vcc, -1, v2
    s_cbranch_vccz K_IT0
    s_sub_u32 s71, s71, 1
    s_cbranch_scc1 K_IT0
    s_lshr_b32 s51, s65, 12
    s_bitset1_b32 s70, s51
K_SK0:
    s_and_b32 s33, s50, s70
    s_cbranch_scc0 K_NUL0
K_BK0:
    s_ff1_i32_b32 s51, s33
    s_lshl_b32 s64, s51, 12
    buffer_load_dwordx4 v[60:63], v52, s[20:23], s64 offen offset:0 sc1
    buffer_load_dwordx4 v[64:67], v52, s[20:23], s64 offen offset:512 sc1
    s_bitset0_b32 s70, s51
K_RD0:
    ds_read_b64_tr_b16 v[140:141], v56 offset:0
    ds_read_b64_tr_b16 v[142:143], v56 offset:512
    ds_read_b64_tr_b16 v[144:145], v56 offset:2048
    ds_read_b64_tr_b16 v[146:147], v56 offset:2560
    ds_read_b64_tr_b16 v[148:149], v57 offset:0
    ds_read_b64_tr_b16 v[150:151], v57 offset:512
    ds_read_b64_tr_b16 v[152:153], v57 offset:2048
    ds_read_b64_tr_b16 v[154:155], v57 offset:2560
    s_cmp_lt_i32 s66, 0
    s_cbranch_scc0 K_TL0
    v_and_or_b32 v56, s68, v53, v54
    v_and_or_b32 v57, s68, v53, v55
    s_branch K_SK1
K_NUL0:
    s_and_b32 s51, s66, s67
    s_and_b32 s51, s51, s68
    s_and_b32 s51, s51, s69
    s_cmp_lt_i32 s51, 0
    s_cbranch_scc0 K_PC0
    s_cmp_eq_u32 s70, 0
    s_cbranch_scc1 K_P2_MM
    s_branch K_SPN
K_PC0:
    s_cmp_eq_u32 s70, 0
    s_cbranch_scc1 K_NI0
    ds_read_b32 v59, v58
    s_waitcnt lgkmcnt(0)
    v_readfirstlane_b32 s50, v59
    s_and_b32 s33, s50, s70
    s_cbranch_scc1 K_BK0
    ds_read_b32 v59, v58
    s_waitcnt lgkmcnt(0)
    v_readfirstlane_b32 s50, v59
    s_and_b32 s33, s50, s70
    s_cbranch_scc1 K_BK0
K_NI0:
    s_mov_b32 s64, -1
    v_mov_b32 v60, -1
    buffer_load_dword v3, v52, s[20:23], s64 offen
    buffer_load_dword v3, v52, s[20:23], s64 offen
    s_branch K_RD0
K_RF1:
    s_cmp_eq_u32 s70, 0
    s_cbranch_scc1 K_DM1
    ds_read_b32 v59, v58
    s_waitcnt lgkmcnt(0)
    v_readfirstlane_b32 s50, v59
    s_and_b32 s33, s50, s70
    s_cbranch_scc1 K_RB1
    v_mfma_f32_32x32x16_bf16 v[124:139], v[180:183], v[76:79], v[124:139]
    s_mov_b32 s65, -1
    v_mov_b32 v68, -1
    buffer_load_dword v3, v52, s[20:23], s65 offen
    ds_read_b64_tr_b16 v[160:161], v56 offset:2048
    ds_read_b64_tr_b16 v[162:163], v56 offset:2560
    v_mfma_f32_32x32x16_bf16 v[108:123], v[176:179], v[80:83], v[108:123]
    buffer_load_dword v3, v52, s[20:23], s65 offen
    ds_read_b64_tr_b16 v[164:165], v57 offset:0
    ds_read_b64_tr_b16 v[166:167], v57 offset:512
    s_waitcnt vmcnt(8) lgkmcnt(6)
    v_cmp_u_f32 vcc, v84, v88
    v_mfma_f32_32x32x16_bf16 v[124:139], v[184:187], v[80:83], v[124:139]
    ds_read_b64_tr_b16 v[168:169], v57 offset:2048
    ds_read_b64_tr_b16 v[170:171], v57 offset:2560
    v_and_or_b32 v56, s69, v53, v54
    v_and_or_b32 v57, s69, v53, v55
    s_cbranch_vccz K_IT2
    s_branch K_FX2
K_CHA2:
K_STA6:
    s_branch K_STA10
K_CHB2:
K_STB6:
    s_branch K_STB10
K_TL1:
    s_waitcnt vmcnt(8) lgkmcnt(8)
    v_cmp_u_f32 vcc, v84, v88
    v_and_or_b32 v56, s69, v53, v54
    v_and_or_b32 v57, s69, v53, v55
    s_cbranch_vccz K_IT2
    s_branch K_FX2
K_DX1:
    s_and_b32 s51, s66, s67
    s_and_b32 s51, s51, s68
    s_and_b32 s51, s51, s69
    s_cmp_lt_i32 s51, 0
    s_cbranch_scc1 K_P2_MM
K_FX1:
    s_cmp_lt_i32 s66, 0
    s_cbranch_scc1 K_SK1
    v_max_u32 v2, v76, v80
    v_cmp_eq_u32 vcc, -1, v2
    s_cbranch_vccz K_IT1
    s_sub_u32 s71, s71, 1
    s_cbranch_scc1 K_IT1
    s_lshr_b32 s51, s66, 12
    s_bitset1_b32 s70, s51
K_SK1:
    s_and_b32 s33, s50, s70
    s_cbranch_scc0 K_NUL1
K_BK1:
    s_ff1_i32_b32 s51, s33
    s_lshl_b32 s65, s51, 12
    buffer_load_dwordx4 v[68:71], v52, s[20:23], s65 offen offset:0 sc1
    buffer_load_dwordx4 v[72:75], v52, s[20:23], s65 offen offset:512 sc1
    s_bitset0_b32 s70, s51
K_RD1:
    ds_read_b64_tr_b16 v[156:157], v56 offset:0
    ds_read_b64_tr_b16 v[158:159], v56 offset:512
    ds_read_b64_tr_b16 v[160:161], v56 offset:2048
    ds_read_b64_tr_b16 v[162:163], v56 offset:2560
    ds_read_b64_tr_b16 v[164:165], v57 offset:0
    ds_read_b64_tr_b16 v[166:167], v57 offset:512
    ds_read_b64_tr_b16 v[168:169], v57 offset:2048
    ds_read_b64_tr_b16 v[170:171], v57 offset:2560
    s_cmp_lt_i32 s67, 0
    s_cbranch_scc0 K_TL1
    v_and_or_b32 v56, s69, v53, v54
    v_and_or_b32 v57, s69, v53, v55
    s_branch K_SK2
K_NUL1:
    s_and_b32 s51, s64, s67
    s_and_b32 s51, s51, s68
    s_and_b32 s51, s51, s69
    s_cmp_lt_i32 s51, 0
    s_cbranch_scc0 K_PC1
    s_cmp_eq_u32 s70, 0
    s_cbranch_scc1 K_P2_MM
    s_branch K_SPN
K_PC1:
    s_cmp_eq_u32 s70, 0
    s_cbranch_scc1 K_NI1
    ds_read_b32 v59, v58
    s_waitcnt lgkmcnt(0)
    v_readfirstlane_b32 s50, v59
    s_and_b32 s33, s50, s70
    s_cbranch_scc1 K_BK1
    ds_read_b32 v59, v58
    s_waitcnt lgkmcnt(0)
    v_readfirstlane_b32 s50, v59
    s_and_b32 s33, s50, s70
    s_cbranch_scc1 K_BK1
K_NI1:
    s_mov_b32 s65, -1
    v_mov_b32 v68, -1
    buffer_load_dword v3, v52, s[20:23], s65 offen
    buffer_load_dword v3, v52, s[20:23], s65 offen
    s_branch K_RD1
K_RF2:
    s_cmp_eq_u32 s70, 0
    s_cbranch_scc1 K_DM2
    ds_read_b32 v59, v58
    s_waitcnt lgkmcnt(0)
    v_readfirstlane_b32 s50, v59
    s_and_b32 s33, s50, s70
    s_cbranch_scc1 K_RB2
    v_mfma_f32_32x32x16_bf16 v[124:139], v[148:151], v[84:87], v[124:139]
    s_mov_b32 s66, -1
    v_mov_b32 v76, -1
    buffer_load_dword v3, v52, s[20:23], s66 offen
    ds_read_b64_tr_b16 v[176:177], v56 offset:2048
    ds_read_b64_tr_b16 v[178:179], v56 offset:2560
    v_mfma_f32_32x32x16_bf16 v[108:123], v[144:147], v[88:91], v[108:123]
    buffer_load_dword v3, v52, s[20:23], s66 offen
    ds_read_b64_tr_b16 v[180:181], v57 offset:0
    ds_read_b64_tr_b16 v[182:183], v57 offset:512
    s_waitcnt vmcnt(8) lgkmcnt(6)
    v_cmp_u_f32 vcc, v92, v96
    v_mfma_f32_32x32x16_bf16 v[124:139], v[152:155], v[88:91], v[124:139]
    ds_read_b64_tr_b16 v[184:185], v57 offset:2048
    ds_read_b64_tr_b16 v[186:187], v57 offset:2560
    s_branch K_PG4
.p2align 12
K_CHA3:
K_STA7:
    s_branch K_STA11
K_CHB3:
K_STB7:
    s_branch K_STB11
K_PG4:
    v_and_or_b32 v56, s64, v53, v54
    v_and_or_b32 v57, s64, v53, v55
    s_cbranch_vccz K_IT3
    s_branch K_FX3
K_TL2:
    s_waitcnt vmcnt(8) lgkmcnt(8)
    v_cmp_u_f32 vcc, v92, v96
    v_and_or_b32 v56, s64, v53, v54
    v_and_or_b32 v57, s64, v53, v55
    s_cbranch_vccz K_IT3
    s_branch K_FX3
K_DX2:
    s_and_b32 s51, s64, s67
    s_and_b32 s51, s51, s68
    s_and_b32 s51, s51, s69
    s_cmp_lt_i32 s51, 0
    s_cbranch_scc1 K_P2_MM
K_FX2:
    s_cmp_lt_i32 s67, 0
    s_cbranch_scc1 K_SK2
    v_max_u32 v2, v84, v88
    v_cmp_eq_u32 vcc, -1, v2
    s_cbranch_vccz K_IT2
    s_sub_u32 s71, s71, 1
    s_cbranch_scc1 K_IT2
    s_lshr_b32 s51, s67, 12
    s_bitset1_b32 s70, s51
K_SK2:
    s_and_b32 s33, s50, s70
    s_cbranch_scc0 K_NUL2
K_BK2:
    s_ff1_i32_b32 s51, s33
    s_lshl_b32 s66, s51, 12
    buffer_load_dwordx4 v[76:79], v52, s[20:23], s66 offen offset:0 sc1
    buffer_load_dwordx4 v[80:83], v52, s[20:23], s66 offen offset:512 sc1
    s_bitset0_b32 s70, s51
K_RD2:
    ds_read_b64_tr_b16 v[172:173], v56 offset:0
    ds_read_b64_tr_b16 v[174:175], v56 offset:512
    ds_read_b64_tr_b16 v[176:177], v56 offset:2048
    ds_read_b64_tr_b16 v[178:179], v56 offset:2560
    ds_read_b64_tr_b16 v[180:181], v57 offset:0
    ds_read_b64_tr_b16 v[182:183], v57 offset:512
    ds_read_b64_tr_b16 v[184:185], v57 offset:2048
    ds_read_b64_tr_b16 v[186:187], v57 offset:2560
    s_cmp_lt_i32 s68, 0
    s_cbranch_scc0 K_TL2
    v_and_or_b32 v56, s64, v53, v54
    v_and_or_b32 v57, s64, v53, v55
    s_branch K_SK3
K_NUL2:
    s_and_b32 s51, s64, s65
    s_and_b32 s51, s51, s68
    s_and_b32 s51, s51, s69
    s_cmp_lt_i32 s51, 0
    s_cbranch_scc0 K_PC2
    s_cmp_eq_u32 s70, 0
    s_cbranch_scc1 K_P2_MM
    s_branch K_SPN
K_PC2:
    s_cmp_eq_u32 s70, 0
    s_cbranch_scc1 K_NI2
    ds_read_b32 v59, v58
    s_waitcnt lgkmcnt(0)
    v_readfirstlane_b32 s50, v59
    s_and_b32 s33, s50, s70
    s_cbranch_scc1 K_BK2
    ds_read_b32 v59, v58
    s_waitcnt lgkmcnt(0)
    v_readfirstlane_b32 s50, v59
    s_and_b32 s33, s50, s70
    s_cbranch_scc1 K_BK2
K_NI2:
    s_mov_b32 s66, -1
    v_mov_b32 v76, -1
    buffer_load_dword v3, v52, s[20:23], s66 offen
    buffer_load_dword v3, v52, s[20:23], s66 offen
    s_branch K_RD2
K_RF3:
    s_cmp_eq_u32 s70, 0
    s_cbranch_scc1 K_DM3
    ds_read_b32 v59, v58
    s_waitcnt lgkmcnt(0)
    v_readfirstlane_b32 s50, v59
    s_and_b32 s33, s50, s70
    s_cbranch_scc1 K_RB3
    v_mfma_f32_32x32x16_bf16 v[124:139], v[164:167], v[92:95], v[124:139]
    s_mov_b32 s67, -1
    v_mov_b32 v84, -1
    buffer_load_dword v3, v52, s[20:23], s67 offen
    ds_read_b64_tr_b16 v[144:145], v56 offset:2048
    ds_read_b64_tr_b16 v[146:147], v56 offset:2560
    v_mfma_f32_32x32x16_bf16 v[108:123], v[160:163], v[96:99], v[108:123]
    buffer_load_dword v3, v52, s[20:23], s67 offen
    ds_read_b64_tr_b16 v[148:149], v57 offset:0
    ds_read_b64_tr_b16 v[150:151], v57 offset:512
    s_waitcnt vmcnt(8) lgkmcnt(6)
    v_cmp_u_f32 vcc, v100, v104
    v_mfma_f32_32x32x16_bf16 v[124:139], v[168:171], v[96:99], v[124:139]
    ds_read_b64_tr_b16 v[152:153], v57 offset:2048
    ds_read_b64_tr_b16 v[154:155], v57 offset:2560
    v_and_or_b32 v56, s65, v53, v54
    v_and_or_b32 v57, s65, v53, v55
    s_cbranch_vccz K_IT4
    s_branch K_FX4
K_STA8:
    s_branch K_STA12
K_STB8:
    s_branch K_STB12
K_TL3:
    s_waitcnt vmcnt(8) lgkmcnt(8)
    v_cmp_u_f32 vcc, v100, v104
    v_and_or_b32 v56, s65, v53, v54
    v_and_or_b32 v57, s65, v53, v55
    s_cbranch_vccz K_IT4
    s_branch K_FX4
K_DX3:
    s_and_b32 s51, s64, s65
    s_and_b32 s51, s51, s68
    s_and_b32 s51, s51, s69
    s_cmp_lt_i32 s51, 0
    s_cbranch_scc1 K_P2_MM
K_FX3:
    s_cmp_lt_i32 s68, 0
    s_cbranch_scc1 K_SK3
    v_max_u32 v2, v92, v96
    v_cmp_eq_u32 vcc, -1, v2
    s_cbranch_vccz K_IT3
    s_sub_u32 s71, s71, 1
    s_cbranch_scc1 K_IT3
    s_lshr_b32 s51, s68, 12
    s_bitset1_b32 s70, s51
K_SK3:
    s_and_b32 s33, s50, s70
    s_cbranch_scc0 K_NUL3
K_BK3:
    s_ff1_i32_b32 s51, s33
    s_lshl_b32 s67, s51, 12
    buffer_load_dwordx4 v[84:87], v52, s[20:23], s67 offen offset:0 sc1
    buffer_load_dwordx4 v[88:91], v52, s[20:23], s67 offen offset:512 sc1
    s_bitset0_b32 s70, s51
K_RD3:
    ds_read_b64_tr_b16 v[140:141], v56 offset:0
    ds_read_b64_tr_b16 v[142:143], v56 offset:512
    ds_read_b64_tr_b16 v[144:145], v56 offset:2048
    ds_read_b64_tr_b16 v[146:147], v56 offset:2560
    ds_read_b64_tr_b16 v[148:149], v57 offset:0
    ds_read_b64_tr_b16 v[150:151], v57 offset:512
    ds_read_b64_tr_b16 v[152:153], v57 offset:2048
    ds_read_b64_tr_b16 v[154:155], v57 offset:2560
    s_cmp_lt_i32 s69, 0
    s_cbranch_scc0 K_TL3
    v_and_or_b32 v56, s65, v53, v54
    v_and_or_b32 v57, s65, v53, v55
    s_branch K_SK4
K_NUL3:
    s_and_b32 s51, s64, s65
    s_and_b32 s51, s51, s66
    s_and_b32 s51, s51, s69
    s_cmp_lt_i32 s51, 0
    s_cbranch_scc0 K_PC3
    s_cmp_eq_u32 s70, 0
    s_cbranch_scc1 K_P2_MM
    s_branch K_SPN
K_PC3:
    s_cmp_eq_u32 s70, 0
    s_cbranch_scc1 K_NI3
    ds_read_b32 v59, v58
    s_waitcnt lgkmcnt(0)
    v_readfirstlane_b32 s50, v59
    s_and_b32 s33, s50, s70
    s_cbranch_scc1 K_BK3
    ds_read_b32 v59, v58
    s_waitcnt lgkmcnt(0)
    v_readfirstlane_b32 s50, v59
    s_and_b32 s33, s50, s70
    s_cbranch_scc1 K_BK3
K_NI3:
    s_mov_b32 s67, -1
    v_mov_b32 v84, -1
    buffer_load_dword v3, v52, s[20:23], s67 offen
    buffer_load_dword v3, v52, s[20:23], s67 offen
    s_branch K_RD3
K_RF4:
    s_cmp_eq_u32 s70, 0
    s_cbranch_scc1 K_DM4
    ds_read_b32 v59, v58
    s_waitcnt lgkmcnt(0)
    v_readfirstlane_b32 s50, v59
    s_and_b32 s33, s50, s70
    s_cbranch_scc1 K_RB4
    v_mfma_f32_32x32x16_bf16 v[124:139], v[180:183], v[100:103], v[124:139]
    s_mov_b32 s68, -1
    v_mov_b32 v92, -1
    buffer_load_dword v3, v52, s[20:23], s68 offen
    ds_read_b64_tr_b16 v[160:161], v56 offset:2048
    ds_read_b64_tr_b16 v[162:163], v56 offset:2560
    v_mfma_f32_32x32x16_bf16 v[108:123], v[176:179], v[104:107], v[108:123]
    buffer_load_dword v3, v52, s[20:23], s68 offen
    ds_read_b64_tr_b16 v[164:165], v57 offset:0
    ds_read_b64_tr_b16 v[166:167], v57 offset:512
    s_waitcnt vmcnt(8) lgkmcnt(6)
    v_cmp_u_f32 vcc, v60, v64
    v_mfma_f32_32x32x16_bf16 v[124:139], v[184:187], v[104:107], v[124:139]
    ds_read_b64_tr_b16 v[168:169], v57 offset:2048
    ds_read_b64_tr_b16 v[170:171], v57 offset:2560
    v_and_or_b32 v56, s66, v53, v54
    v_and_or_b32 v57, s66, v53, v55
    s_cbranch_vccz K_IT5
    s_branch K_FX5
K_TL4:
    s_waitcnt vmcnt(8) lgkmcnt(8)
    v_cmp_u_f32 vcc, v60, v64
    v_and_or_b32 v56, s66, v53, v54
    v_and_or_b32 v57, s66, v53, v55
    s_cbranch_vccz K_IT5
    s_branch K_FX5
K_STA9:
    s_branch K_STA13
K_STB9:
    s_branch K_STB13
K_DX4:
    s_and_b32 s51, s64, s65
    s_and_b32 s51, s51, s66
    s_and_b32 s51, s51, s69
    s_cmp_lt_i32 s51, 0
    s_cbranch_scc1 K_P2_MM
K_FX4:
    s_cmp_lt_i32 s69, 0
    s_cbranch_scc1 K_SK4
    v_max_u32 v2, v100, v104
    v_cmp_eq_u32 vcc, -1, v2
    s_cbranch_vccz K_IT4
    s_sub_u32 s71, s71, 1
    s_cbranch_scc1 K_IT4
    s_lshr_b32 s51, s69, 12
    s_bitset1_b32 s70, s51
K_SK4:
    s_and_b32 s33, s50, s70
    s_cbranch_scc0 K_NUL4
K_BK4:
    s_ff1_i32_b32 s51, s33
    s_lshl_b32 s68, s51, 12
    buffer_load_dwordx4 v[92:95], v52, s[20:23], s68 offen offset:0 sc1
    buffer_load_dwordx4 v[96:99], v52, s[20:23], s68 offen offset:512 sc1
    s_bitset0_b32 s70, s51
K_RD4:
    ds_read_b64_tr_b16 v[156:157], v56 offset:0
    ds_read_b64_tr_b16 v[158:159], v56 offset:512
    ds_read_b64_tr_b16 v[160:161], v56 offset:2048
    ds_read_b64_tr_b16 v[162:163], v56 offset:2560
    ds_read_b64_tr_b16 v[164:165], v57 offset:0
    ds_read_b64_tr_b16 v[166:167], v57 offset:512
    ds_read_b64_tr_b16 v[168:169], v57 offset:2048
    ds_read_b64_tr_b16 v[170:171], v57 offset:2560
    s_cmp_lt_i32 s64, 0
    s_cbranch_scc0 K_TL4
    v_and_or_b32 v56, s66, v53, v54
    v_and_or_b32 v57, s66, v53, v55
    s_branch K_SK5
K_NUL4:
    s_and_b32 s51, s64, s65
    s_and_b32 s51, s51, s66
    s_and_b32 s51, s51, s67
    s_cmp_lt_i32 s51, 0
    s_cbranch_scc0 K_PC4
    s_cmp_eq_u32 s70, 0
    s_cbranch_scc1 K_P2_MM
    s_branch K_SPN
K_PC4:
    s_cmp_eq_u32 s70, 0
    s_cbranch_scc1 K_NI4
    ds_read_b32 v59, v58
    s_waitcnt lgkmcnt(0)
    v_readfirstlane_b32 s50, v59
    s_and_b32 s33, s50, s70
    s_cbranch_scc1 K_BK4
    ds_read_b32 v59, v58
    s_waitcnt lgkmcnt(0)
    v_readfirstlane_b32 s50, v59
    s_and_b32 s33, s50, s70
    s_cbranch_scc1 K_BK4
K_NI4:
    s_mov_b32 s68, -1
    v_mov_b32 v92, -1
    buffer_load_dword v3, v52, s[20:23], s68 offen
    buffer_load_dword v3, v52, s[20:23], s68 offen
    s_branch K_RD4
K_RF5:
    s_cmp_eq_u32 s70, 0
    s_cbranch_scc1 K_DM5
    ds_read_b32 v59, v58
    s_waitcnt lgkmcnt(0)
    v_readfirstlane_b32 s50, v59
    s_and_b32 s33, s50, s70
    s_cbranch_scc1 K_RB5
    v_mfma_f32_32x32x16_bf16 v[124:139], v[148:151], v[60:63], v[124:139]
    s_mov_b32 s69, -1
    v_mov_b32 v100, -1
    buffer_load_dword v3, v52, s[20:23], s69 offen
    ds_read_b64_tr_b16 v[176:177], v56 offset:2048
    ds_read_b64_tr_b16 v[178:179], v56 offset:2560
    v_mfma_f32_32x32x16_bf16 v[108:123], v[144:147], v[64:67], v[108:123]
    buffer_load_dword v3, v52, s[20:23], s69 offen
    ds_read_b64_tr_b16 v[180:181], v57 offset:0
    ds_read_b64_tr_b16 v[182:183], v57 offset:512
    s_waitcnt vmcnt(8) lgkmcnt(6)
    v_cmp_u_f32 vcc, v68, v72
    v_mfma_f32_32x32x16_bf16 v[124:139], v[152:155], v[64:67], v[124:139]
    ds_read_b64_tr_b16 v[184:185], v57 offset:2048
    ds_read_b64_tr_b16 v[186:187], v57 offset:2560
    v_and_or_b32 v56, s67, v53, v54
    v_and_or_b32 v57, s67, v53, v55
    s_cbranch_vccz K_IT0
    s_branch K_FX0
K_TL5:
    s_waitcnt vmcnt(8) lgkmcnt(8)
    v_cmp_u_f32 vcc, v68, v72
    v_and_or_b32 v56, s67, v53, v54
    v_and_or_b32 v57, s67, v53, v55
    s_cbranch_vccz K_IT0
    s_branch K_FX0
K_DX5:
    s_and_b32 s51, s64, s65
    s_and_b32 s51, s51, s66
    s_and_b32 s51, s51, s67
    s_cmp_lt_i32 s51, 0
    s_cbranch_scc1 K_P2_MM
K_FX5:
    s_cmp_lt_i32 s64, 0
    s_cbranch_scc1 K_SK5
    v_max_u32 v2, v60, v64
    v_cmp_eq_u32 vcc, -1, v2
    s_cbranch_vccz K_IT5
    s_sub_u32 s71, s71, 1
    s_cbranch_scc1 K_IT5
    s_lshr_b32 s51, s64, 12
    s_bitset1_b32 s70, s51
K_SK5:
    s_and_b32 s33, s50, s70
    s_cbranch_scc0 K_NUL5
K_BK5:
    s_ff1_i32_b32 s51, s33
    s_lshl_b32 s69, s51, 12
    buffer_load_dwordx4 v[100:103], v52, s[20:23], s69 offen offset:0 sc1
    buffer_load_dwordx4 v[104:107], v52, s[20:23], s69 offen offset:512 sc1
    s_bitset0_b32 s70, s51
K_RD5:
    ds_read_b64_tr_b16 v[172:173], v56 offset:0
    ds_read_b64_tr_b16 v[174:175], v56 offset:512
    ds_read_b64_tr_b16 v[176:177], v56 offset:2048
    ds_read_b64_tr_b16 v[178:179], v56 offset:2560
    ds_read_b64_tr_b16 v[180:181], v57 offset:0
    ds_read_b64_tr_b16 v[182:183], v57 offset:512
    ds_read_b64_tr_b16 v[184:185], v57 offset:2048
    ds_read_b64_tr_b16 v[186:187], v57 offset:2560
    s_cmp_lt_i32 s65, 0
    s_cbranch_scc0 K_TL5
    v_and_or_b32 v56, s67, v53, v54
    v_and_or_b32 v57, s67, v53, v55
    s_branch K_SK0
K_STA10:
    s_branch K_STA14
K_STB10:
    s_branch K_STB14
K_NUL5:
    s_and_b32 s51, s65, s66
    s_and_b32 s51, s51, s67
    s_and_b32 s51, s51, s68
    s_cmp_lt_i32 s51, 0
    s_cbranch_scc0 K_PC5
    s_cmp_eq_u32 s70, 0
    s_cbranch_scc1 K_P2_MM
    s_branch K_SPN
K_PC5:
    s_cmp_eq_u32 s70, 0
    s_cbranch_scc1 K_NI5
    ds_read_b32 v59, v58
    s_waitcnt lgkmcnt(0)
    v_readfirstlane_b32 s50, v59
    s_and_b32 s33, s50, s70
    s_cbranch_scc1 K_BK5
    ds_read_b32 v59, v58
    s_waitcnt lgkmcnt(0)
    v_readfirstlane_b32 s50, v59
    s_and_b32 s33, s50, s70
    s_cbranch_scc1 K_BK5
K_NI5:
    s_mov_b32 s69, -1
    v_mov_b32 v100, -1
    buffer_load_dword v3, v52, s[20:23], s69 offen
    buffer_load_dword v3, v52, s[20:23], s69 offen
    s_branch K_RD5
K_P2_MM:
    v_cvt_pk_bf16_f32 v188, v108, v109
    v_cvt_pk_bf16_f32 v189, v110, v111
    ds_write_b64 v50, v[188:189] offset:0
    v_cvt_pk_bf16_f32 v190, v112, v113
    v_cvt_pk_bf16_f32 v191, v114, v115
    ds_write_b64 v50, v[190:191] offset:16
    v_cvt_pk_bf16_f32 v192, v116, v117
    v_cvt_pk_bf16_f32 v193, v118, v119
    ds_write_b64 v50, v[192:193] offset:32
    v_cvt_pk_bf16_f32 v194, v120, v121
    v_cvt_pk_bf16_f32 v195, v122, v123
    ds_write_b64 v50, v[194:195] offset:48
    v_cvt_pk_bf16_f32 v188, v124, v125
    v_cvt_pk_bf16_f32 v189, v126, v127
    ds_write_b64 v50, v[188:189] offset:64
    v_cvt_pk_bf16_f32 v190, v128, v129
    v_cvt_pk_bf16_f32 v191, v130, v131
    ds_write_b64 v50, v[190:191] offset:80
    v_cvt_pk_bf16_f32 v192, v132, v133
    v_cvt_pk_bf16_f32 v193, v134, v135
    ds_write_b64 v50, v[192:193] offset:96
    v_cvt_pk_bf16_f32 v194, v136, v137
    v_cvt_pk_bf16_f32 v195, v138, v139
    ds_write_b64 v50, v[194:195] offset:112
K_P2_E2:
    s_waitcnt vmcnt(0) lgkmcnt(0)
    s_lshl_b32 s72, s61, 4
    s_barrier
    ds_read_b64 v[28:29], v15
    ds_read_b64 v[24:25], v11
    ds_read_b128 v[48:51], v14
    ds_read_b64 v[26:27], v11 offset:64
    ds_read_b128 v[52:55], v14 offset:1152
    s_waitcnt lgkmcnt(4)
    v_readfirstlane_b32 s48, v28
    v_readfirstlane_b32 s49, v29
    s_sub_u32 s3, s48, s72
    s_cmp_lt_u32 s3, 16
    s_cbranch_scc1 K_YROW0
K_NOY0:
    s_sub_u32 s3, s49, s72
    s_cmp_lt_u32 s3, 16
    s_cbranch_scc1 K_YROW1
K_NOY1:
    s_waitcnt lgkmcnt(3)
    v_pk_mul_f32 v[32:33], v[32:33], v[24:25] op_sel:[0,1] op_sel_hi:[1,1]
    v_pk_mul_f32 v[34:35], v[34:35], v[24:25] op_sel:[0,1] op_sel_hi:[1,1]
    v_pk_mul_f32 v[36:37], v[36:37], v[24:25] op_sel:[0,1] op_sel_hi:[1,1]
    v_pk_mul_f32 v[38:39], v[38:39], v[24:25] op_sel:[0,1] op_sel_hi:[1,1]
    s_waitcnt lgkmcnt(2)
    v_lshlrev_b32 v68, 16, v48
    v_and_b32 v69, 0xffff0000, v48
    v_pk_fma_f32 v[68:69], v[68:69], v[24:25], v[32:33] op_sel_hi:[1,0,1]
    v_cvt_pk_bf16_f32 v48, v68, v69
    v_lshlrev_b32 v70, 16, v49
    v_and_b32 v71, 0xffff0000, v49
    v_pk_fma_f32 v[70:71], v[70:71], v[24:25], v[34:35] op_sel_hi:[1,0,1]
    v_cvt_pk_bf16_f32 v49, v70, v71
    v_lshlrev_b32 v68, 16, v50
    v_and_b32 v69, 0xffff0000, v50
    v_pk_fma_f32 v[68:69], v[68:69], v[24:25], v[36:37] op_sel_hi:[1,0,1]
    v_cvt_pk_bf16_f32 v50, v68, v69
    v_lshlrev_b32 v70, 16, v51
    v_and_b32 v71, 0xffff0000, v51
    v_pk_fma_f32 v[70:71], v[70:71], v[24:25], v[38:39] op_sel_hi:[1,0,1]
    v_cvt_pk_bf16_f32 v51, v70, v71
    buffer_store_dwordx4 v[48:51], v10, s[56:59], 0 offen sc1
    s_waitcnt lgkmcnt(1)
    v_pk_mul_f32 v[40:41], v[40:41], v[26:27] op_sel:[0,1] op_sel_hi:[1,1]
    v_pk_mul_f32 v[42:43], v[42:43], v[26:27] op_sel:[0,1] op_sel_hi:[1,1]
    v_pk_mul_f32 v[44:45], v[44:45], v[26:27] op_sel:[0,1] op_sel_hi:[1,1]
    v_pk_mul_f32 v[46:47], v[46:47], v[26:27] op_sel:[0,1] op_sel_hi:[1,1]
    s_waitcnt lgkmcnt(0)
    v_lshlrev_b32 v68, 16, v52
    v_and_b32 v69, 0xffff0000, v52
    v_pk_fma_f32 v[68:69], v[68:69], v[26:27], v[40:41] op_sel_hi:[1,0,1]
    v_cvt_pk_bf16_f32 v52, v68, v69
    v_lshlrev_b32 v70, 16, v53
    v_and_b32 v71, 0xffff0000, v53
    v_pk_fma_f32 v[70:71], v[70:71], v[26:27], v[42:43] op_sel_hi:[1,0,1]
    v_cvt_pk_bf16_f32 v53, v70, v71
    v_lshlrev_b32 v68, 16, v54
    v_and_b32 v69, 0xffff0000, v54
    v_pk_fma_f32 v[68:69], v[68:69], v[26:27], v[44:45] op_sel_hi:[1,0,1]
    v_cvt_pk_bf16_f32 v54, v68, v69
    v_lshlrev_b32 v70, 16, v55
    v_and_b32 v71, 0xffff0000, v55
    v_pk_fma_f32 v[70:71], v[70:71], v[26:27], v[46:47] op_sel_hi:[1,0,1]
    v_cvt_pk_bf16_f32 v55, v70, v71
    buffer_store_dwordx4 v[52:55], v10, s[56:59], s63 offen sc1
K_END:
K_EXIT:
    s_endpgm
K_YROW0:
    v_and_b32 v2, 7, v1
    v_lshlrev_b32 v2, 5, v2
    v_add_u32 v2, 158976, v2
    ds_read_b128 v[56:59], v2
    ds_read_b128 v[60:63], v2 offset:16
    s_and_b32 s33, s3, 7
    v_cmp_eq_u32 vcc, s33, v8
    s_cmp_ge_u32 s3, 8
    s_cbranch_scc1 K_YR1_0
    s_waitcnt lgkmcnt(0)
    v_add_f32 v64, v32, v56
    v_cvt_pk_bf16_f32 v64, v64, v64
    v_lshlrev_b32 v64, 16, v64
    v_cndmask_b32 v32, v32, v64, vcc
    v_add_f32 v65, v33, v57
    v_cvt_pk_bf16_f32 v65, v65, v65
    v_lshlrev_b32 v65, 16, v65
    v_cndmask_b32 v33, v33, v65, vcc
    v_add_f32 v66, v34, v58
    v_cvt_pk_bf16_f32 v66, v66, v66
    v_lshlrev_b32 v66, 16, v66
    v_cndmask_b32 v34, v34, v66, vcc
    v_add_f32 v67, v35, v59
    v_cvt_pk_bf16_f32 v67, v67, v67
    v_lshlrev_b32 v67, 16, v67
    v_cndmask_b32 v35, v35, v67, vcc
    v_add_f32 v64, v36, v60
    v_cvt_pk_bf16_f32 v64, v64, v64
    v_lshlrev_b32 v64, 16, v64
    v_cndmask_b32 v36, v36, v64, vcc
    v_add_f32 v65, v37, v61
    v_cvt_pk_bf16_f32 v65, v65, v65
    v_lshlrev_b32 v65, 16, v65
    v_cndmask_b32 v37, v37, v65, vcc
    v_add_f32 v66, v38, v62
    v_cvt_pk_bf16_f32 v66, v66, v66
    v_lshlrev_b32 v66, 16, v66
    v_cndmask_b32 v38, v38, v66, vcc
    v_add_f32 v67, v39, v63
    v_cvt_pk_bf16_f32 v67, v67, v67
    v_lshlrev_b32 v67, 16, v67
    v_cndmask_b32 v39, v39, v67, vcc
    s_branch K_NOY0
K_YR1_0:
    s_waitcnt lgkmcnt(0)
    v_add_f32 v64, v40, v56
    v_cvt_pk_bf16_f32 v64, v64, v64
    v_lshlrev_b32 v64, 16, v64
    v_cndmask_b32 v40, v40, v64, vcc
    v_add_f32 v65, v41, v57
    v_cvt_pk_bf16_f32 v65, v65, v65
    v_lshlrev_b32 v65, 16, v65
    v_cndmask_b32 v41, v41, v65, vcc
    v_add_f32 v66, v42, v58
    v_cvt_pk_bf16_f32 v66, v66, v66
    v_lshlrev_b32 v66, 16, v66
    v_cndmask_b32 v42, v42, v66, vcc
    v_add_f32 v67, v43, v59
    v_cvt_pk_bf16_f32 v67, v67, v67
    v_lshlrev_b32 v67, 16, v67
    v_cndmask_b32 v43, v43, v67, vcc
    v_add_f32 v64, v44, v60
    v_cvt_pk_bf16_f32 v64, v64, v64
    v_lshlrev_b32 v64, 16, v64
    v_cndmask_b32 v44, v44, v64, vcc
    v_add_f32 v65, v45, v61
    v_cvt_pk_bf16_f32 v65, v65, v65
    v_lshlrev_b32 v65, 16, v65
    v_cndmask_b32 v45, v45, v65, vcc
    v_add_f32 v66, v46, v62
    v_cvt_pk_bf16_f32 v66, v66, v66
    v_lshlrev_b32 v66, 16, v66
    v_cndmask_b32 v46, v46, v66, vcc
    v_add_f32 v67, v47, v63
    v_cvt_pk_bf16_f32 v67, v67, v67
    v_lshlrev_b32 v67, 16, v67
    v_cndmask_b32 v47, v47, v67, vcc
    s_branch K_NOY0
K_YROW1:
    v_and_b32 v2, 7, v1
    v_lshlrev_b32 v2, 5, v2
    v_add_u32 v2, 159232, v2
    ds_read_b128 v[56:59], v2
    ds_read_b128 v[60:63], v2 offset:16
    s_and_b32 s33, s3, 7
    v_cmp_eq_u32 vcc, s33, v8
    s_cmp_ge_u32 s3, 8
    s_cbranch_scc1 K_YR1_1
    s_waitcnt lgkmcnt(0)
    v_add_f32 v64, v32, v56
    v_cvt_pk_bf16_f32 v64, v64, v64
    v_lshlrev_b32 v64, 16, v64
    v_cndmask_b32 v32, v32, v64, vcc
    v_add_f32 v65, v33, v57
    v_cvt_pk_bf16_f32 v65, v65, v65
    v_lshlrev_b32 v65, 16, v65
    v_cndmask_b32 v33, v33, v65, vcc
    v_add_f32 v66, v34, v58
    v_cvt_pk_bf16_f32 v66, v66, v66
    v_lshlrev_b32 v66, 16, v66
    v_cndmask_b32 v34, v34, v66, vcc
    v_add_f32 v67, v35, v59
    v_cvt_pk_bf16_f32 v67, v67, v67
    v_lshlrev_b32 v67, 16, v67
    v_cndmask_b32 v35, v35, v67, vcc
    v_add_f32 v64, v36, v60
    v_cvt_pk_bf16_f32 v64, v64, v64
    v_lshlrev_b32 v64, 16, v64
    v_cndmask_b32 v36, v36, v64, vcc
    v_add_f32 v65, v37, v61
    v_cvt_pk_bf16_f32 v65, v65, v65
    v_lshlrev_b32 v65, 16, v65
    v_cndmask_b32 v37, v37, v65, vcc
    v_add_f32 v66, v38, v62
    v_cvt_pk_bf16_f32 v66, v66, v66
    v_lshlrev_b32 v66, 16, v66
    v_cndmask_b32 v38, v38, v66, vcc
    v_add_f32 v67, v39, v63
    v_cvt_pk_bf16_f32 v67, v67, v67
    v_lshlrev_b32 v67, 16, v67
    v_cndmask_b32 v39, v39, v67, vcc
    s_branch K_NOY1
K_YR1_1:
    s_waitcnt lgkmcnt(0)
    v_add_f32 v64, v40, v56
    v_cvt_pk_bf16_f32 v64, v64, v64
    v_lshlrev_b32 v64, 16, v64
    v_cndmask_b32 v40, v40, v64, vcc
    v_add_f32 v65, v41, v57
    v_cvt_pk_bf16_f32 v65, v65, v65
    v_lshlrev_b32 v65, 16, v65
    v_cndmask_b32 v41, v41, v65, vcc
    v_add_f32 v66, v42, v58
    v_cvt_pk_bf16_f32 v66, v66, v66
    v_lshlrev_b32 v66, 16, v66
    v_cndmask_b32 v42, v42, v66, vcc
    v_add_f32 v67, v43, v59
    v_cvt_pk_bf16_f32 v67, v67, v67
    v_lshlrev_b32 v67, 16, v67
    v_cndmask_b32 v43, v43, v67, vcc
    v_add_f32 v64, v44, v60
    v_cvt_pk_bf16_f32 v64, v64, v64
    v_lshlrev_b32 v64, 16, v64
    v_cndmask_b32 v44, v44, v64, vcc
    v_add_f32 v65, v45, v61
    v_cvt_pk_bf16_f32 v65, v65, v65
    v_lshlrev_b32 v65, 16, v65
    v_cndmask_b32 v45, v45, v65, vcc
    v_add_f32 v66, v46, v62
    v_cvt_pk_bf16_f32 v66, v66, v66
    v_lshlrev_b32 v66, 16, v66
    v_cndmask_b32 v46, v46, v66, vcc
    v_add_f32 v67, v47, v63
    v_cvt_pk_bf16_f32 v67, v67, v67
    v_lshlrev_b32 v67, 16, v67
    v_cndmask_b32 v47, v47, v67, vcc
    s_branch K_NOY1
K_STA11:
    s_branch K_STA15
K_STB11:
    s_branch K_STB15
K_P2:
    s_cmp_ge_u32 s30, 4
    s_cbranch_scc1 K_P2_HELP
    s_lshl_b32 s62, s40, 7
    v_lshrrev_b32 v8, 3, v1
    v_lshrrev_b32 v9, 4, v1
    v_mov_b32 v15, 158720
    s_lshl_b32 s61, s40, 3
    s_add_u32 s61, s61, s30
    s_mul_i32 s3, s61, 20480
    s_lshl_b32 s33, s41, 7
    s_add_u32 s3, s3, s33
    v_and_b32 v2, 7, v1
    v_lshlrev_b32 v2, 4, v2
    v_mul_u32_u24 v4, 1280, v8
    v_add3_u32 v10, v2, v4, s3
    s_lshl_b32 s3, s30, 7
    s_add_u32 s3, s3, 159744
    v_lshl_add_u32 v11, v8, 3, s3
    s_mov_b32 s63, 10240
    s_add_u32 s20, s6, 0x100000
    s_addc_u32 s21, s7, 0
    s_mov_b32 s22, 0x280000
    s_mov_b32 s23, 0x20000
    s_mov_b32 s56, s10
    s_mov_b32 s57, s11
    s_mov_b32 s58, 0x280000
    s_mov_b32 s59, 0x20000
    v_mul_u32_u24 v3, 144, v8
    v_add_u32 v3, v2, v3
    s_mul_i32 s3, s30, 2304
    s_add_u32 s3, s3, 140288
    v_add_u32 v14, s3, v3
    buffer_load_dwordx4 v[16:19], v10, s[12:15], 0 offen
    buffer_load_dwordx4 v[20:23], v10, s[12:15], s63 offen
    v_bfe_u32 v48, v1, 2, 2
    v_and_b32 v49, 3, v1
    s_add_u32 s3, s61, s30
    s_lshr_b32 s33, s3, 2
    s_mul_i32 s33, s33, 76
    s_add_u32 s3, s3, s33
    s_lshl_b32 s3, s3, 10
    v_and_b32 v2, 15, v1
    v_lshl_add_u32 v2, v2, 4, s3
    v_lshrrev_b32 v3, 5, v1
    v_lshl_add_u32 v2, v3, 8, v2
    v_and_b32 v4, 1, v9
    v_lshl_add_u32 v52, v4, 10, v2
    v_mov_b32 v53, 0x1f000
    v_lshl_add_u32 v2, v3, 3, v48
    v_lshlrev_b32 v2, 7, v2
    v_lshl_add_u32 v2, v49, 3, v2
    v_lshl_add_u32 v2, v4, 5, v2
    v_lshrrev_b32 v4, 1, v48
    v_lshl_add_u32 v54, v4, 6, v2
    v_xor_b32 v55, 64, v54
    v_mov_b32 v56, v54
    v_mov_b32 v57, v54
    v_and_b32 v2, 31, v1
    v_mul_u32_u24 v2, 144, v2
    v_lshl_add_u32 v2, v3, 3, v2
    s_mul_i32 s3, s30, 4608
    s_add_u32 s3, s3, 140288
    v_add_u32 v50, s3, v2
    s_and_b32 s33, s40, 3
    s_lshl_b32 s33, s33, 2
    s_lshr_b32 s33, 0xf63f, s33
    s_and_b32 s33, s33, 15
    s_lshl1_add_u32 s3, s30, 1
    s_cmp_ge_u32 s3, s33
    s_cselect_b32 s60, 24, 16
    s_cmp_gt_u32 s3, s33
    s_cselect_b32 s60, 20, s60
    v_add_u32 v58, s60, v15
    s_mov_b32 s64, -1
    s_mov_b32 s65, -1
    s_mov_b32 s66, -1
    s_mov_b32 s67, -1
    s_mov_b32 s68, -1
    s_mov_b32 s69, -1
    s_mov_b32 s70, 0xfffff
    s_mov_b32 s71, 131072
    v_mov_b32 v108, 0
    v_mov_b32 v109, 0
    v_mov_b32 v110, 0
    v_mov_b32 v111, 0
    v_mov_b32 v112, 0
    v_mov_b32 v113, 0
    v_mov_b32 v114, 0
    v_mov_b32 v115, 0
    v_mov_b32 v116, 0
    v_mov_b32 v117, 0
    v_mov_b32 v118, 0
    v_mov_b32 v119, 0
    v_mov_b32 v120, 0
    v_mov_b32 v121, 0
    v_mov_b32 v122, 0
    v_mov_b32 v123, 0
    v_mov_b32 v124, 0
    v_mov_b32 v125, 0
    v_mov_b32 v126, 0
    v_mov_b32 v127, 0
    v_mov_b32 v128, 0
    v_mov_b32 v129, 0
    v_mov_b32 v130, 0
    v_mov_b32 v131, 0
    v_mov_b32 v132, 0
    v_mov_b32 v133, 0
    v_mov_b32 v134, 0
    v_mov_b32 v135, 0
    v_mov_b32 v136, 0
    v_mov_b32 v137, 0
    v_mov_b32 v138, 0
    v_mov_b32 v139, 0
K_P2_AUXW:
    v_lshrrev_b32 v2, 3, v1
    v_mul_u32_u24 v2, 1280, v2
    v_lshrrev_b32 v3, 2, v1
    v_and_b32 v3, 4, v3
    v_and_b32 v4, 7, v1
    v_xor_b32 v3, v3, v4
    v_lshl_add_u32 v2, v3, 4, v2
    s_lshl_b32 s33, s41, 7
    v_add_u32 v51, s33, v2
    v_lshrrev_b32 v5, 5, v1
    v_mul_u32_u24 v5, 20480, v5
    v_add_u32 v5, v5, v51
    s_lshl_b32 s52, s30, 2
    s_lshr_b32 s52, 0x7520, s52
    s_and_b32 s52, s52, 7
    s_mul_i32 s52, s52, 51200
    s_lshl_b32 s53, s30, 12
    s_add_u32 s60, s52, 0
    s_add_u32 m0, s53, 0
    s_waitcnt vmcnt(5)
    buffer_load_dwordx4 v51, s[24:27], s60 offen lds
    s_add_u32 s60, s52, 10240
    s_add_u32 m0, s53, 1024
    s_waitcnt vmcnt(5)
    buffer_load_dwordx4 v51, s[24:27], s60 offen lds
    s_add_u32 s60, s52, 25600
    s_add_u32 m0, s53, 2048
    s_waitcnt vmcnt(5)
    buffer_load_dwordx4 v51, s[24:27], s60 offen lds
    s_add_u32 s60, s52, 35840
    s_add_u32 m0, s53, 3072
    s_waitcnt vmcnt(5)
    buffer_load_dwordx4 v51, s[24:27], s60 offen lds
    s_add_u32 s60, s52, 409600
    s_add_u32 m0, s53, 20480
    s_waitcnt vmcnt(5)
    buffer_load_dwordx4 v51, s[24:27], s60 offen lds
    s_add_u32 s60, s52, 419840
    s_add_u32 m0, s53, 21504
    s_waitcnt vmcnt(5)
    buffer_load_dwordx4 v51, s[24:27], s60 offen lds
    v_mov_b32 v3, 1
    s_mov_b64 exec, 1
    s_branch K_PG5
.p2align 12
K_STA12:
    s_branch K_WRET_A
K_STB12:
    s_branch K_WRET_B
K_PG5:
    ds_add_u32 v15, v3 offset:52
    s_mov_b64 exec, -1
    s_add_u32 s60, s52, 435200
    s_add_u32 m0, s53, 22528
    s_waitcnt vmcnt(5)
    buffer_load_dwordx4 v51, s[24:27], s60 offen lds
    s_add_u32 s60, s52, 445440
    s_add_u32 m0, s53, 23552
    s_waitcnt vmcnt(5)
    buffer_load_dwordx4 v51, s[24:27], s60 offen lds
    s_lshl_b32 s53, s30, 10
    s_add_u32 s60, s52, 20480
    s_add_u32 m0, s53, 16384
    s_waitcnt vmcnt(5)
    buffer_load_dwordx4 v5, s[24:27], s60 offen lds
    s_add_u32 s60, s52, 430080
    s_add_u32 m0, s53, 36864
    s_waitcnt vmcnt(5)
    buffer_load_dwordx4 v5, s[24:27], s60 offen lds
    s_cmp_eq_u32 s30, 0
    s_cbranch_scc1 K_CHA0
    s_cmp_eq_u32 s30, 1
    s_cbranch_scc1 K_CHA1
    s_cmp_eq_u32 s30, 2
    s_cbranch_scc1 K_CHA2
    s_branch K_CHA3
K_WRET_A:
    v_mov_b32 v3, 1
    s_waitcnt vmcnt(0)
    s_mov_b64 exec, 1
    ds_add_u32 v15, v3 offset:44
    s_mov_b64 exec, -1
    s_mov_b32 s3, 1048576
K_P2_GWA:
    ds_read_b32 v2, v15 offset:44
    s_sub_u32 s3, s3, 1
    s_waitcnt lgkmcnt(0)
    v_readfirstlane_b32 s33, v2
    s_nop 3
    s_cselect_b32 s33, 4, s33
    s_cmp_lt_u32 s33, 4
    s_cbranch_scc1 K_P2_GWA
    s_branch K_P2_GEMM
K_P2_HELP:
    s_setprio 3
    s_cmp_eq_u32 s30, 7
    s_cbranch_scc1 K_P2_W7
    s_cmp_eq_u32 s30, 4
    s_cbranch_scc1 K_P2_NL
    s_cmp_ge_u32 s29, 8
    s_cbranch_scc1 K_P2_NL
    s_mov_b32 s24, s8
    s_mov_b32 s25, s9
    s_mov_b32 s26, 0xc8000
    s_mov_b32 s27, 0x20000
    v_lshrrev_b32 v2, 3, v1
    v_mul_u32_u24 v2, 1280, v2
    v_lshrrev_b32 v3, 2, v1
    v_and_b32 v3, 4, v3
    v_and_b32 v4, 7, v1
    v_xor_b32 v3, v3, v4
    v_lshl_add_u32 v2, v3, 4, v2
    s_lshl_b32 s33, s41, 7
    v_add_u32 v12, s33, v2
    v_lshrrev_b32 v5, 5, v1
    v_mul_u32_u24 v5, 20480, v5
    v_add_u32 v5, v5, v12
    s_sub_u32 s61, s30, 5
    s_lshl_b32 s52, s61, 2
    s_lshr_b32 s52, 0x6431, s52
    s_and_b32 s52, s52, 7
    s_mul_i32 s52, s52, 51200
    s_lshl_b32 s53, s61, 12
    s_add_u32 s60, s52, 0
    s_add_u32 m0, s53, 40960
    s_nop 0
    buffer_load_dwordx4 v12, s[24:27], s60 offen lds
    s_add_u32 s60, s52, 10240
    s_add_u32 m0, s53, 41984
    s_nop 0
    buffer_load_dwordx4 v12, s[24:27], s60 offen lds
    s_add_u32 s60, s52, 25600
    s_add_u32 m0, s53, 43008
    s_nop 0
    buffer_load_dwordx4 v12, s[24:27], s60 offen lds
    s_add_u32 s60, s52, 35840
    s_add_u32 m0, s53, 44032
    s_nop 0
    buffer_load_dwordx4 v12, s[24:27], s60 offen lds
    s_add_u32 s60, s52, 409600
    s_add_u32 m0, s53, 61440
    s_nop 0
    buffer_load_dwordx4 v12, s[24:27], s60 offen lds
    s_add_u32 s60, s52, 419840
    s_add_u32 m0, s53, 62464
    s_nop 0
    buffer_load_dwordx4 v12, s[24:27], s60 offen lds
    s_add_u32 s60, s52, 435200
    s_add_u32 m0, s53, 63488
    s_nop 0
    buffer_load_dwordx4 v12, s[24:27], s60 offen lds
    s_add_u32 s60, s52, 445440
    s_add_u32 m0, s53, 64512
    s_nop 0
    buffer_load_dwordx4 v12, s[24:27], s60 offen lds
    s_lshl_b32 s53, s61, 10
    s_add_u32 s60, s52, 20480
    s_add_u32 m0, s53, 57344
    s_nop 0
    buffer_load_dwordx4 v5, s[24:27], s60 offen lds
    s_add_u32 s60, s52, 430080
    s_add_u32 m0, s53, 77824
    s_nop 0
    buffer_load_dwordx4 v5, s[24:27], s60 offen lds
    s_add_u32 s61, s61, 2
    s_lshl_b32 s52, s61, 2
    s_lshr_b32 s52, 0x6431, s52
    s_and_b32 s52, s52, 7
    s_mul_i32 s52, s52, 51200
    s_lshl_b32 s53, s61, 12
    s_add_u32 s60, s52, 0
    s_add_u32 m0, s53, 40960
    s_nop 0
    buffer_load_dwordx4 v12, s[24:27], s60 offen lds
    s_add_u32 s60, s52, 10240
    s_add_u32 m0, s53, 41984
    s_nop 0
    buffer_load_dwordx4 v12, s[24:27], s60 offen lds
    s_add_u32 s60, s52, 25600
    s_add_u32 m0, s53, 43008
    s_nop 0
    buffer_load_dwordx4 v12, s[24:27], s60 offen lds
    s_add_u32 s60, s52, 35840
    s_add_u32 m0, s53, 44032
    s_nop 0
    buffer_load_dwordx4 v12, s[24:27], s60 offen lds
    s_add_u32 s60, s52, 409600
    s_add_u32 m0, s53, 61440
    s_nop 0
    buffer_load_dwordx4 v12, s[24:27], s60 offen lds
    s_add_u32 s60, s52, 419840
    s_add_u32 m0, s53, 62464
    s_nop 0
    buffer_load_dwordx4 v12, s[24:27], s60 offen lds
    s_add_u32 s60, s52, 435200
    s_add_u32 m0, s53, 63488
    s_nop 0
    buffer_load_dwordx4 v12, s[24:27], s60 offen lds
    s_add_u32 s60, s52, 445440
    s_add_u32 m0, s53, 64512
    s_nop 0
    buffer_load_dwordx4 v12, s[24:27], s60 offen lds
    s_lshl_b32 s53, s61, 10
    s_add_u32 s60, s52, 20480
    s_add_u32 m0, s53, 57344
    s_nop 0
    buffer_load_dwordx4 v5, s[24:27], s60 offen lds
    s_add_u32 s60, s52, 430080
    s_add_u32 m0, s53, 77824
    s_nop 0
    buffer_load_dwordx4 v5, s[24:27], s60 offen lds
    v_mov_b32 v2, 158720
    v_mov_b32 v3, 1
    s_waitcnt vmcnt(0)
    s_mov_b64 exec, 1
    ds_add_u32 v2, v3 offset:56
    s_mov_b64 exec, -1
K_P2_NL:
    s_lshl_b32 s62, s40, 7
    v_lshrrev_b32 v8, 3, v1
    v_lshrrev_b32 v9, 4, v1
    v_mov_b32 v15, 158720
    s_lshl_b32 s61, s40, 3
    s_add_u32 s61, s61, s30
    s_mul_i32 s3, s61, 20480
    s_lshl_b32 s33, s41, 7
    s_add_u32 s3, s3, s33
    v_and_b32 v2, 7, v1
    v_lshlrev_b32 v2, 4, v2
    v_mul_u32_u24 v4, 1280, v8
    v_add3_u32 v10, v2, v4, s3
    s_lshl_b32 s3, s30, 7
    s_add_u32 s3, s3, 159744
    v_lshl_add_u32 v11, v8, 3, s3
    s_mov_b32 s63, 10240
    s_add_u32 s20, s6, 0x100000
    s_addc_u32 s21, s7, 0
    s_mov_b32 s22, 0x280000
    s_mov_b32 s23, 0x20000
    s_mov_b32 s56, s10
    s_mov_b32 s57, s11
    s_mov_b32 s58, 0x280000
    s_mov_b32 s59, 0x20000
    v_mul_u32_u24 v3, 144, v8
    v_add_u32 v3, v2, v3
    s_mul_i32 s3, s30, 2304
    s_add_u32 s3, s3, 140288
    v_add_u32 v14, s3, v3
    s_add_u32 s44, s6, 0x10000
    s_addc_u32 s45, s7, 0
    s_mov_b32 s46, 0x43800
    s_mov_b32 s47, 0x20000
    v_mov_b32 v108, 1
    buffer_load_dwordx4 v[16:19], v10, s[12:15], 0 offen
    buffer_load_dwordx4 v[20:23], v10, s[12:15], s63 offen
    s_cmp_lg_u32 s30, 6
    s_cbranch_scc1 K_P2_HW
    s_mov_b32 s3, 131072
    s_waitcnt vmcnt(2)
K_P2_DPOLL:
    v_min_u32 v2, v7, v6
    v_cmp_eq_u32 vcc, 0, v2
    s_cbranch_vccz K_P2_DOK
    s_cmp_eq_u32 s3, 131072
    s_cbranch_scc1 K_P2_DNS
    s_sleep 12
K_P2_DNS:
    v_lshl_add_u32 v13, v1, 2, s42
    global_load_dword v7, v13, s[6:7] offset:256 sc1
    v_and_b32 v13, 0xfffffe04, v13
    global_load_dword v6, v13, s[6:7] offset:128 sc1
    s_sub_u32 s3, s3, 1
    s_waitcnt vmcnt(0)
    s_cmp_lg_u32 s3, 0
    s_cbranch_scc1 K_P2_DPOLL
K_P2_DOK:
    v_readlane_b32 s52, v6, 0
    v_readlane_b32 s53, v6, 1
    s_nop 1
    s_and_b32 s3, s52, 0x7ff
    s_sub_u32 s3, 2047, s3
    v_mov_b32 v48, s3
    v_mov_b32 v4, s52
    v_and_b32 v4, 0xffff0000, v4
    v_ashrrev_i32 v5, 31, v4
    v_not_b32 v5, v5
    v_or_b32 v5, 0x80000000, v5
    v_xor_b32 v4, v4, v5
    v_and_b32 v4, 0xffff0000, v4
    v_mul_f32 v5, 0xbfb8aa3b, v4
    v_exp_f32 v5, v5
    s_nop 0
    v_add_f32 v5, 1.0, v5
    v_rcp_f32 v4, v5
    s_nop 0
    v_cvt_pk_bf16_f32 v50, v4, v4
    v_lshlrev_b32 v50, 16, v50
    s_and_b32 s3, s53, 0x7ff
    s_sub_u32 s3, 2047, s3
    v_mov_b32 v49, s3
    v_mov_b32 v4, s53
    v_and_b32 v4, 0xffff0000, v4
    v_ashrrev_i32 v5, 31, v4
    v_not_b32 v5, v5
    v_or_b32 v5, 0x80000000, v5
    v_xor_b32 v4, v4, v5
    v_and_b32 v4, 0xffff0000, v4
    v_mul_f32 v5, 0xbfb8aa3b, v4
    v_exp_f32 v5, v5
    s_nop 0
    v_add_f32 v5, 1.0, v5
    v_rcp_f32 v4, v5
    s_nop 0
    v_cvt_pk_bf16_f32 v51, v4, v4
    v_lshlrev_b32 v51, 16, v51
    ds_write_b128 v15, v[48:51]
    ds_write_b32 v15, v108 offset:40
    v_lshl_add_u32 v13, v1, 4, v15
    v_lshlrev_b32 v52, 16, v7
    v_and_b32 v52, 0x7fff0000, v52
    v_and_b32 v54, 0x7fff0000, v7
    v_sub_f32 v53, 1.0, v52
    v_cvt_pk_bf16_f32 v53, v53, v53
    v_lshlrev_b32 v53, 16, v53
    v_sub_f32 v55, 1.0, v54
    v_cvt_pk_bf16_f32 v55, v55, v55
    v_lshlrev_b32 v55, 16, v55
    ds_write_b128 v13, v[52:55] offset:1024
    s_branch K_P2_E
K_STA13:
    s_branch K_WRET_A
K_STB13:
    s_branch K_WRET_B
K_P2_HW:
    s_mov_b32 s3, 1048576
K_P2_GS2:
    ds_read_b32 v2, v15 offset:40
    s_sleep 1
    s_sub_u32 s3, s3, 1
    s_waitcnt lgkmcnt(0)
    v_readfirstlane_b32 s33, v2
    s_nop 3
    s_cselect_b32 s33, 1, s33
    s_cmp_lt_u32 s33, 1
    s_cbranch_scc1 K_P2_GS2
    ds_read_b128 v[28:31], v15
    s_waitcnt lgkmcnt(0)
    s_cmp_eq_u32 s30, 4
    s_cselect_b64 vcc, -1, 0
    s_nop 1
    v_cndmask_b32 v2, v29, v28, vcc
    v_cndmask_b32 v5, v31, v30, vcc
    s_nop 0
    v_readfirstlane_b32 s52, v2
    s_nop 3
    s_sub_u32 s3, s52, s62
    s_cmp_lt_u32 s3, 128
    s_cbranch_scc0 K_P2_E
    s_mov_b32 s3, 131072
K_P2_YPOLL:
    s_load_dword s33, s[6:7], s42 offset:136 glc
    s_waitcnt lgkmcnt(0)
    s_cmp_lg_u32 s33, 0
    s_cbranch_scc1 K_P2_YGO
    s_sleep 4
    s_sub_u32 s3, s3, 1
    s_cbranch_scc0 K_P2_YPOLL
K_P2_YGO:
    v_and_b32 v2, 15, v1
    v_lshlrev_b32 v2, 4, v2
    v_mul_u32_u24 v4, 5120, v9
    s_sub_u32 s53, s30, 4
    s_mul_i32 s33, s53, 2560
    s_lshl_b32 s3, s41, 8
    s_add_u32 s3, s3, s33
    v_add3_u32 v3, v2, v4, s3
    s_mov_b32 s60, 0
    buffer_load_dwordx4 v[52:55], v3, s[44:47], s60 offen sc1
    s_mov_b32 s60, 20480
    buffer_load_dwordx4 v[56:59], v3, s[44:47], s60 offen sc1
    s_mov_b32 s60, 40960
    buffer_load_dwordx4 v[60:63], v3, s[44:47], s60 offen sc1
    s_mov_b32 s60, 61440
    buffer_load_dwordx4 v[64:67], v3, s[44:47], s60 offen sc1
    s_mov_b32 s60, 81920
    buffer_load_dwordx4 v[68:71], v3, s[44:47], s60 offen sc1
    s_mov_b32 s60, 102400
    buffer_load_dwordx4 v[72:75], v3, s[44:47], s60 offen sc1
    s_mov_b32 s60, 122880
    buffer_load_dwordx4 v[76:79], v3, s[44:47], s60 offen sc1
    s_mov_b32 s60, 143360
    buffer_load_dwordx4 v[80:83], v3, s[44:47], s60 offen sc1
    s_mov_b32 s60, 163840
    buffer_load_dwordx4 v[84:87], v3, s[44:47], s60 offen sc1
    s_mov_b32 s60, 184320
    buffer_load_dwordx4 v[88:91], v3, s[44:47], s60 offen sc1
    s_mov_b32 s60, 204800
    buffer_load_dwordx4 v[92:95], v3, s[44:47], s60 offen sc1
    s_mov_b32 s60, 225280
    buffer_load_dwordx4 v[96:99], v3, s[44:47], s60 offen sc1
    s_mov_b32 s60, 245760
    buffer_load_dwordx4 v[100:103], v3, s[44:47], s60 offen sc1
    s_mov_b32 s60, 266240
    buffer_load_dwordx4 v[104:107], v3, s[44:47], s60 offen sc1
    s_waitcnt vmcnt(12)
    v_add_f32 v48, v52, v56
    v_add_f32 v49, v53, v57
    v_add_f32 v50, v54, v58
    v_add_f32 v51, v55, v59
    s_waitcnt vmcnt(11)
    v_add_f32 v48, v48, v60
    v_add_f32 v49, v49, v61
    v_add_f32 v50, v50, v62
    v_add_f32 v51, v51, v63
    s_waitcnt vmcnt(10)
    v_add_f32 v48, v48, v64
    v_add_f32 v49, v49, v65
    v_add_f32 v50, v50, v66
    v_add_f32 v51, v51, v67
    s_waitcnt vmcnt(9)
    v_add_f32 v48, v48, v68
    v_add_f32 v49, v49, v69
    v_add_f32 v50, v50, v70
    v_add_f32 v51, v51, v71
    s_waitcnt vmcnt(8)
    v_add_f32 v48, v48, v72
    v_add_f32 v49, v49, v73
    v_add_f32 v50, v50, v74
    v_add_f32 v51, v51, v75
    s_waitcnt vmcnt(7)
    v_add_f32 v48, v48, v76
    v_add_f32 v49, v49, v77
    v_add_f32 v50, v50, v78
    v_add_f32 v51, v51, v79
    s_waitcnt vmcnt(6)
    v_add_f32 v48, v48, v80
    v_add_f32 v49, v49, v81
    v_add_f32 v50, v50, v82
    v_add_f32 v51, v51, v83
    s_waitcnt vmcnt(5)
    v_add_f32 v48, v48, v84
    v_add_f32 v49, v49, v85
    v_add_f32 v50, v50, v86
    v_add_f32 v51, v51, v87
    s_waitcnt vmcnt(4)
    v_add_f32 v48, v48, v88
    v_add_f32 v49, v49, v89
    v_add_f32 v50, v50, v90
    v_add_f32 v51, v51, v91
    s_waitcnt vmcnt(3)
    v_add_f32 v48, v48, v92
    v_add_f32 v49, v49, v93
    v_add_f32 v50, v50, v94
    v_add_f32 v51, v51, v95
    s_waitcnt vmcnt(2)
    v_add_f32 v48, v48, v96
    v_add_f32 v49, v49, v97
    v_add_f32 v50, v50, v98
    v_add_f32 v51, v51, v99
    s_waitcnt vmcnt(1)
    v_add_f32 v48, v48, v100
    v_add_f32 v49, v49, v101
    v_add_f32 v50, v50, v102
    v_add_f32 v51, v51, v103
    s_waitcnt vmcnt(0)
    v_add_f32 v48, v48, v104
    v_add_f32 v49, v49, v105
    v_add_f32 v50, v50, v106
    v_add_f32 v51, v51, v107
    v_mov_b32 v52, v48
    v_mov_b32 v53, v49
    v_mov_b32 v54, v50
    v_mov_b32 v55, v51
    s_nop 0
    v_permlane16_swap_b32 v48, v52
    v_permlane16_swap_b32 v49, v53
    v_permlane16_swap_b32 v50, v54
    v_permlane16_swap_b32 v51, v55
    v_add_f32 v48, v48, v52
    v_add_f32 v49, v49, v53
    v_add_f32 v50, v50, v54
    v_add_f32 v51, v51, v55
    v_mov_b32 v52, v48
    v_mov_b32 v53, v49
    v_mov_b32 v54, v50
    v_mov_b32 v55, v51
    s_nop 0
    v_permlane32_swap_b32 v48, v52
    v_permlane32_swap_b32 v49, v53
    v_permlane32_swap_b32 v50, v54
    v_permlane32_swap_b32 v51, v55
    v_add_f32 v48, v48, v52
    v_add_f32 v49, v49, v53
    v_add_f32 v50, v50, v54
    v_add_f32 v51, v51, v55
    v_cvt_pk_bf16_f32 v48, v48, v48
    v_lshlrev_b32 v48, 16, v48
    v_mul_f32 v48, v5, v48
    v_cvt_pk_bf16_f32 v48, v48, v48
    v_lshlrev_b32 v48, 16, v48
    v_cvt_pk_bf16_f32 v49, v49, v49
    v_lshlrev_b32 v49, 16, v49
    v_mul_f32 v49, v5, v49
    v_cvt_pk_bf16_f32 v49, v49, v49
    v_lshlrev_b32 v49, 16, v49
    v_cvt_pk_bf16_f32 v50, v50, v50
    v_lshlrev_b32 v50, 16, v50
    v_mul_f32 v50, v5, v50
    v_cvt_pk_bf16_f32 v50, v50, v50
    v_lshlrev_b32 v50, 16, v50
    v_cvt_pk_bf16_f32 v51, v51, v51
    v_lshlrev_b32 v51, 16, v51
    v_mul_f32 v51, v5, v51
    v_cvt_pk_bf16_f32 v51, v51, v51
    v_lshlrev_b32 v51, 16, v51
    s_lshl_b32 s3, s53, 8
    s_add_u32 s3, s3, 158976
    v_add_u32 v2, s3, v2
    ds_write_b128 v2, v[48:51]
    s_branch K_P2_E
K_STA14:
    s_branch K_WRET_A
K_STB14:
    s_branch K_WRET_B
K_P2_W7:
    s_mov_b32 s37, s42
    s_waitcnt lgkmcnt(0)
    s_load_dwordx2 s[48:49], s[6:7], s37 glc
    s_add_u32 s53, s40, 1
    s_and_b32 s53, s53, 2
    s_mov_b32 s46, 0x84210
    s_mov_b32 s47, s46
    v_mov_b32 v15, 158720
    v_mov_b32 v5, 0
    v_mov_b32 v48, 0x80000000
    s_mov_b64 exec, 1
    ds_or_b32 v15, v48 offset:16
    ds_or_b32 v15, v48 offset:20
    ds_or_b32 v15, v48 offset:24
    s_waitcnt lgkmcnt(0)
    s_cmp_eq_u32 s53, 0
    s_cselect_b32 s49, s48, s49
    s_lshl_b64 s[50:51], s[48:49], 1
    s_and_b64 s[50:51], s[50:51], s[48:49]
    s_lshl_b64 vcc, s[50:51], 2
    s_and_b64 s[50:51], s[50:51], vcc
    s_lshl_b64 s[50:51], s[50:51], 1
    s_and_b64 s[50:51], s[50:51], s[46:47]
    s_or_b64 s[48:49], s[48:49], s[50:51]
    v_readfirstlane_b32 s52, v5
    s_cmp_ge_u32 s52, 2
    s_cselect_b32 s52, -1, 0x3ff
    s_and_b32 s48, s48, s52
    s_and_b32 s49, s49, s52
    s_and_b32 s52, s48, s49
    v_mov_b32 v48, s48
    v_mov_b32 v49, s49
    v_mov_b32 v50, s52
    s_mov_b64 exec, 1
    ds_or_b64 v15, v[48:49] offset:16
    ds_or_b32 v15, v50 offset:24
    s_mov_b64 exec, -1
    s_load_dwordx2 s[48:49], s[6:7], s37 glc
    s_lshl_b32 s62, s40, 7
    v_lshrrev_b32 v8, 3, v1
    v_lshrrev_b32 v9, 4, v1
    v_mov_b32 v15, 158720
    s_lshl_b32 s61, s40, 3
    s_add_u32 s61, s61, s30
    s_mul_i32 s3, s61, 20480
    s_lshl_b32 s33, s41, 7
    s_add_u32 s3, s3, s33
    v_and_b32 v2, 7, v1
    v_lshlrev_b32 v2, 4, v2
    v_mul_u32_u24 v4, 1280, v8
    v_add3_u32 v10, v2, v4, s3
    s_lshl_b32 s3, s30, 7
    s_add_u32 s3, s3, 159744
    v_lshl_add_u32 v11, v8, 3, s3
    s_mov_b32 s63, 10240
    s_add_u32 s20, s6, 0x100000
    s_addc_u32 s21, s7, 0
    s_mov_b32 s22, 0x280000
    s_mov_b32 s23, 0x20000
    s_mov_b32 s56, s10
    s_mov_b32 s57, s11
    s_mov_b32 s58, 0x280000
    s_mov_b32 s59, 0x20000
    v_mul_u32_u24 v3, 144, v8
    v_add_u32 v3, v2, v3
    s_mul_i32 s3, s30, 2304
    s_add_u32 s3, s3, 140288
    v_add_u32 v14, s3, v3
    buffer_load_dwordx4 v[16:19], v10, s[12:15], 0 offen
    buffer_load_dwordx4 v[20:23], v10, s[12:15], s63 offen
    s_mov_b32 s3, 131072
    s_waitcnt lgkmcnt(0)
K_P2_FP:
    s_load_dwordx2 s[44:45], s[6:7], s37 glc
    s_cmp_eq_u32 s53, 0
    s_cselect_b32 s49, s48, s49
    s_lshl_b64 s[50:51], s[48:49], 1
    s_and_b64 s[50:51], s[50:51], s[48:49]
    s_lshl_b64 vcc, s[50:51], 2
    s_and_b64 s[50:51], s[50:51], vcc
    s_lshl_b64 s[50:51], s[50:51], 1
    s_and_b64 s[50:51], s[50:51], s[46:47]
    s_or_b64 s[48:49], s[48:49], s[50:51]
    v_readfirstlane_b32 s52, v5
    s_cmp_ge_u32 s52, 2
    s_cselect_b32 s52, -1, 0x3ff
    s_and_b32 s48, s48, s52
    s_and_b32 s49, s49, s52
    s_and_b32 s52, s48, s49
    v_mov_b32 v48, s48
    v_mov_b32 v49, s49
    v_mov_b32 v50, s52
    s_mov_b64 exec, 1
    ds_or_b64 v15, v[48:49] offset:16
    ds_or_b32 v15, v50 offset:24
    s_mov_b64 exec, -1
    ds_read_b32 v5, v15 offset:56
    s_cmp_eq_u32 s52, 0xfffff
    s_cbranch_scc1 K_P2_FGO
    s_cmp_lg_u64 s[48:49], 0
    s_cbranch_scc1 K_P2_FS2
    s_sleep 8
K_P2_FS2:
    s_sub_u32 s3, s3, 1
    s_waitcnt lgkmcnt(0)
    s_mov_b64 s[48:49], s[44:45]
    s_cbranch_scc0 K_P2_FP
    s_mov_b32 s3, 0
K_P2_FCHK:
    s_cmp_eq_u32 s53, 0
    s_cselect_b32 s49, s48, s49
    s_lshl_b64 s[50:51], s[48:49], 1
    s_and_b64 s[50:51], s[50:51], s[48:49]
    s_lshl_b64 vcc, s[50:51], 2
    s_and_b64 s[50:51], s[50:51], vcc
    s_lshl_b64 s[50:51], s[50:51], 1
    s_and_b64 s[50:51], s[50:51], s[46:47]
    s_or_b64 s[48:49], s[48:49], s[50:51]
    v_readfirstlane_b32 s52, v5
    s_cmp_ge_u32 s52, 2
    s_cselect_b32 s52, -1, 0x3ff
    s_and_b32 s48, s48, s52
    s_and_b32 s49, s49, s52
    s_and_b32 s52, s48, s49
    v_mov_b32 v48, s48
    v_mov_b32 v49, s49
    v_mov_b32 v50, s52
    s_mov_b64 exec, 1
    ds_or_b64 v15, v[48:49] offset:16
    ds_or_b32 v15, v50 offset:24
    s_mov_b64 exec, -1
    s_cmp_eq_u32 s52, 0xfffff
    s_cbranch_scc1 K_P2_FGO
    s_cmp_lg_u64 s[48:49], 0
    s_cbranch_scc1 K_P2_FS
    s_sleep 8
K_P2_FS:
    s_sleep 2
    s_load_dwordx2 s[48:49], s[6:7], s37 glc
    ds_read_b32 v5, v15 offset:56
    s_sub_u32 s3, s3, 1
    s_waitcnt lgkmcnt(0)
    s_cbranch_scc0 K_P2_FCHK
    v_mov_b32 v48, -1
    v_mov_b32 v49, -1
    v_mov_b32 v50, -1
    ds_write_b96 v15, v[48:50] offset:16
K_P2_FGO:
K_P2_E:
    s_setprio 0
    s_waitcnt vmcnt(0)
    v_lshlrev_b32 v32, 16, v16
    v_and_b32 v33, 0xffff0000, v16
    v_lshlrev_b32 v34, 16, v17
    v_and_b32 v35, 0xffff0000, v17
    v_lshlrev_b32 v36, 16, v18
    v_and_b32 v37, 0xffff0000, v18
    v_lshlrev_b32 v38, 16, v19
    v_and_b32 v39, 0xffff0000, v19
    v_lshlrev_b32 v40, 16, v20
    v_and_b32 v41, 0xffff0000, v20
    v_lshlrev_b32 v42, 16, v21
    v_and_b32 v43, 0xffff0000, v21
    v_lshlrev_b32 v44, 16, v22
    v_and_b32 v45, 0xffff0000, v22
    v_lshlrev_b32 v46, 16, v23
    v_and_b32 v47, 0xffff0000, v23
    s_branch K_P2_E2
K_STA15:
    s_branch K_WRET_A
K_STB15:
    s_branch K_WRET_B
K_SPN:
    s_mov_b32 s64, -1
    s_mov_b32 s65, -1
    s_mov_b32 s66, -1
    s_mov_b32 s67, -1
    s_mov_b32 s68, -1
    s_mov_b32 s69, -1
K_SPL:
    ds_read_b32 v59, v58
    s_waitcnt lgkmcnt(0)
    v_readfirstlane_b32 s50, v59
    s_and_b32 s33, s50, s70
    s_cbranch_scc1 K_BK0
    s_cmp_lt_i32 s50, 0
    s_cbranch_scc0 K_SPG
    s_sleep 1
    s_branch K_SPL
K_SPG:
    s_load_dwordx2 s[48:49], s[6:7], s42 glc
    ds_read_b32 v5, v15 offset:56
    s_waitcnt lgkmcnt(0)
    s_cmp_eq_u32 s53, 0
    s_cselect_b32 s49, s48, s49
    s_lshl_b64 s[50:51], s[48:49], 1
    s_and_b64 s[50:51], s[50:51], s[48:49]
    s_lshl_b64 vcc, s[50:51], 2
    s_and_b64 s[50:51], s[50:51], vcc
    s_lshl_b64 s[50:51], s[50:51], 1
    s_and_b64 s[50:51], s[50:51], s[46:47]
    s_or_b64 s[48:49], s[48:49], s[50:51]
    v_readfirstlane_b32 s52, v5
    s_cmp_ge_u32 s52, 2
    s_cselect_b32 s52, -1, 0x3ff
    s_and_b32 s48, s48, s52
    s_and_b32 s49, s49, s52
    s_and_b32 s52, s48, s49
    v_mov_b32 v188, s48
    v_mov_b32 v189, s49
    v_mov_b32 v190, s52
    s_mov_b64 exec, 1
    ds_or_b64 v15, v[188:189] offset:16
    ds_or_b32 v15, v190 offset:24
    s_mov_b64 exec, -1
    ds_read_b32 v59, v58
    s_waitcnt lgkmcnt(0)
    v_readfirstlane_b32 s50, v59
    s_and_b32 s33, s50, s70
    s_cbranch_scc1 K_BK0
    s_sleep 2
    ds_read_b32 v59, v58
    s_waitcnt lgkmcnt(0)
    v_readfirstlane_b32 s50, v59
    s_and_b32 s33, s50, s70
    s_cbranch_scc1 K_BK0
    s_sleep 2
    ds_read_b32 v59, v58
    s_waitcnt lgkmcnt(0)
    v_readfirstlane_b32 s50, v59
    s_and_b32 s33, s50, s70
    s_cbranch_scc1 K_BK0
    s_sleep 2
    ds_read_b32 v59, v58
    s_waitcnt lgkmcnt(0)
    v_readfirstlane_b32 s50, v59
    s_and_b32 s33, s50, s70
    s_cbranch_scc1 K_BK0
    s_branch K_SPL
K_CHEND:
K_AUX:
    s_cmp_ge_u32 s30, 4
    s_cbranch_scc1 K_AUX_L
    s_and_b32 s3, s2, 7
    s_lshr_b32 s70, s2, 3
    s_lshl3_add_u32 s3, s3, s70
    s_lshl_b32 s3, s3, 5
    s_lshl3_add_u32 s3, s30, s3
    v_bfe_u32 v8, v0, 4, 2
    v_add_u32 v8, s3, v8
    v_and_b32 v10, 15, v0
    v_lshlrev_b32 v10, 4, v10
    v_mul_u32_u24 v9, 1280, v8
    v_add_u32 v9, v9, v10
    v_and_b32 v2, 63, v0
    v_lshlrev_b32 v2, 4, v2
    s_lshl_b32 s71, s30, 12
    s_add_u32 s71, s71, 126016
    s_mov_b32 s70, 5120
    s_mov_b32 m0, s71
    s_waitcnt lgkmcnt(0)
    s_mov_b32 s16, s44
    s_mov_b32 s17, s45
    s_mov_b32 s18, 0x500
    s_mov_b32 s19, 0x20000
    s_mov_b32 s20, s52
    s_mov_b32 s21, s53
    s_mov_b32 s22, 0x500
    s_mov_b32 s23, 0x20000
    buffer_load_dwordx4 v2, s[16:19], 0 offen lds
    buffer_load_dwordx4 v2, s[16:19], 0 offen offset:1024 lds
    s_add_u32 m0, s71, 2048
    v_add_u32 v10, s71, v10
    buffer_load_dwordx4 v2, s[20:23], 0 offen lds
    buffer_load_dwordx4 v2, s[20:23], 0 offen offset:1024 lds
    buffer_load_dwordx4 v[16:19], v9, s[12:15], 0 offen offset:0
    buffer_load_dwordx4 v[20:23], v9, s[12:15], s70 offen offset:0
    buffer_load_dwordx4 v[24:27], v9, s[12:15], 0 offen offset:256
    buffer_load_dwordx4 v[28:31], v9, s[12:15], s70 offen offset:256
    buffer_load_dwordx4 v[32:35], v9, s[12:15], 0 offen offset:512
    buffer_load_dwordx4 v[36:39], v9, s[12:15], s70 offen offset:512
    buffer_load_dwordx4 v[40:43], v9, s[12:15], 0 offen offset:768
    buffer_load_dwordx4 v[44:47], v9, s[12:15], s70 offen offset:768
    buffer_load_dwordx4 v[48:51], v9, s[12:15], 0 offen offset:1024
    buffer_load_dwordx4 v[52:55], v9, s[12:15], s70 offen offset:1024
    s_barrier
    v_and_b32 v1, 63, v0
    v_mov_b32 v7, 0
    s_and_b32 s28, s2, 7
    s_lshr_b32 s29, s2, 3
    s_xor_b32 s30, s30, 4
    s_lshr_b32 s34, s29, 3
    s_lshl_b32 s34, s34, 2
    s_and_b32 s3, s29, 3
    s_add_u32 s34, s34, s3
    s_add_u32 s34, s34, 4
    s_bitcmp1_b32 s29, 2
    s_cselect_b32 s34, -1, s34
    s_cmp_lt_u32 s29, 8
    s_cselect_b32 s34, s29, s34
    s_lshl_b32 s40, s28, 1
    s_cmp_ge_u32 s34, 10
    s_addc_u32 s40, s40, 0
    s_sub_u32 s41, s34, 10
    s_cmp_ge_u32 s34, 10
    s_cselect_b32 s41, s41, s34
    s_mul_i32 s42, s28, 20
    s_add_u32 s42, s42, s34
    s_and_b32 s42, s42, 255
    s_lshl_b32 s42, s42, 9
    s_branch K_PG6
.p2align 12
K_PG6:
    s_add_u32 s42, s42, 524288
    s_mul_i32 s43, s28, 7
    s_add_u32 s43, s43, s29
    s_sub_u32 s43, s43, 1
    s_cmp_lt_u32 s43, 54
    s_cselect_b32 s43, s43, 63
    s_cmp_eq_u32 s29, 0
    s_cselect_b32 s43, 63, s43
    s_mov_b32 s24, s8
    s_mov_b32 s25, s9
    s_mov_b32 s26, 0xc8000
    s_mov_b32 s27, 0x20000
    s_add_u32 s64, s6, 0x80000
    s_addc_u32 s65, s7, 0
    s_mov_b32 s66, 0x14400
    s_mov_b32 s67, 0x20000
    s_add_u32 s60, s6, 0x10000
    s_addc_u32 s61, s7, 0
    s_mov_b32 s62, 0x43800
    s_mov_b32 s63, 0x20000
    v_mov_b32 v96, 0
    v_mov_b32 v97, 0
    v_mov_b32 v98, 0
    v_mov_b32 v99, 0
    v_mov_b32 v13, 158720
    s_waitcnt vmcnt(10)
    ds_read_b128 v[56:59], v10 offset:0
    ds_read_b128 v[76:79], v10 offset:2048
    ds_read_b128 v[60:63], v10 offset:256
    ds_read_b128 v[80:83], v10 offset:2304
    ds_read_b128 v[64:67], v10 offset:512
    ds_read_b128 v[84:87], v10 offset:2560
    ds_read_b128 v[68:71], v10 offset:768
    ds_read_b128 v[88:91], v10 offset:2816
    ds_read_b128 v[72:75], v10 offset:1024
    ds_read_b128 v[92:95], v10 offset:3072
    s_waitcnt vmcnt(8) lgkmcnt(8)
    v_dot2c_f32_bf16 v96, v16, v56
    v_dot2c_f32_bf16 v98, v16, v76
    v_dot2c_f32_bf16 v97, v20, v56
    v_dot2c_f32_bf16 v99, v20, v76
    v_dot2c_f32_bf16 v96, v17, v57
    v_dot2c_f32_bf16 v98, v17, v77
    v_dot2c_f32_bf16 v97, v21, v57
    v_dot2c_f32_bf16 v99, v21, v77
    v_dot2c_f32_bf16 v96, v18, v58
    v_dot2c_f32_bf16 v98, v18, v78
    v_dot2c_f32_bf16 v97, v22, v58
    v_dot2c_f32_bf16 v99, v22, v78
    v_dot2c_f32_bf16 v96, v19, v59
    v_dot2c_f32_bf16 v98, v19, v79
    v_dot2c_f32_bf16 v97, v23, v59
    v_dot2c_f32_bf16 v99, v23, v79
    s_waitcnt vmcnt(6) lgkmcnt(6)
    v_dot2c_f32_bf16 v96, v24, v60
    v_dot2c_f32_bf16 v98, v24, v80
    v_dot2c_f32_bf16 v97, v28, v60
    v_dot2c_f32_bf16 v99, v28, v80
    v_dot2c_f32_bf16 v96, v25, v61
    v_dot2c_f32_bf16 v98, v25, v81
    v_dot2c_f32_bf16 v97, v29, v61
    v_dot2c_f32_bf16 v99, v29, v81
    v_dot2c_f32_bf16 v96, v26, v62
    v_dot2c_f32_bf16 v98, v26, v82
    v_dot2c_f32_bf16 v97, v30, v62
    v_dot2c_f32_bf16 v99, v30, v82
    v_dot2c_f32_bf16 v96, v27, v63
    v_dot2c_f32_bf16 v98, v27, v83
    v_dot2c_f32_bf16 v97, v31, v63
    v_dot2c_f32_bf16 v99, v31, v83
    s_waitcnt vmcnt(4) lgkmcnt(4)
    v_dot2c_f32_bf16 v96, v32, v64
    v_dot2c_f32_bf16 v98, v32, v84
    v_dot2c_f32_bf16 v97, v36, v64
    v_dot2c_f32_bf16 v99, v36, v84
    v_dot2c_f32_bf16 v96, v33, v65
    v_dot2c_f32_bf16 v98, v33, v85
    v_dot2c_f32_bf16 v97, v37, v65
    v_dot2c_f32_bf16 v99, v37, v85
    v_dot2c_f32_bf16 v96, v34, v66
    v_dot2c_f32_bf16 v98, v34, v86
    v_dot2c_f32_bf16 v97, v38, v66
    v_dot2c_f32_bf16 v99, v38, v86
    v_dot2c_f32_bf16 v96, v35, v67
    v_dot2c_f32_bf16 v98, v35, v87
    v_dot2c_f32_bf16 v97, v39, v67
    v_dot2c_f32_bf16 v99, v39, v87
    s_waitcnt vmcnt(2) lgkmcnt(2)
    v_dot2c_f32_bf16 v96, v40, v68
    v_dot2c_f32_bf16 v98, v40, v88
    v_dot2c_f32_bf16 v97, v44, v68
    v_dot2c_f32_bf16 v99, v44, v88
    v_dot2c_f32_bf16 v96, v41, v69
    v_dot2c_f32_bf16 v98, v41, v89
    v_dot2c_f32_bf16 v97, v45, v69
    v_dot2c_f32_bf16 v99, v45, v89
    v_dot2c_f32_bf16 v96, v42, v70
    v_dot2c_f32_bf16 v98, v42, v90
    v_dot2c_f32_bf16 v97, v46, v70
    v_dot2c_f32_bf16 v99, v46, v90
    v_dot2c_f32_bf16 v96, v43, v71
    v_dot2c_f32_bf16 v98, v43, v91
    v_dot2c_f32_bf16 v97, v47, v71
    v_dot2c_f32_bf16 v99, v47, v91
    s_waitcnt vmcnt(0) lgkmcnt(0)
    v_dot2c_f32_bf16 v96, v48, v72
    v_dot2c_f32_bf16 v98, v48, v92
    v_dot2c_f32_bf16 v97, v52, v72
    v_dot2c_f32_bf16 v99, v52, v92
    v_dot2c_f32_bf16 v96, v49, v73
    v_dot2c_f32_bf16 v98, v49, v93
    v_dot2c_f32_bf16 v97, v53, v73
    v_dot2c_f32_bf16 v99, v53, v93
    v_dot2c_f32_bf16 v96, v50, v74
    v_dot2c_f32_bf16 v98, v50, v94
    v_dot2c_f32_bf16 v97, v54, v74
    v_dot2c_f32_bf16 v99, v54, v94
    v_dot2c_f32_bf16 v96, v51, v75
    v_dot2c_f32_bf16 v98, v51, v95
    v_dot2c_f32_bf16 v97, v55, v75
    v_dot2c_f32_bf16 v99, v55, v95
    s_nop 2
    v_add_f32_dpp v96, v96, v96 quad_perm:[1,0,3,2] row_mask:0xf bank_mask:0xf
    v_add_f32_dpp v97, v97, v97 quad_perm:[1,0,3,2] row_mask:0xf bank_mask:0xf
    v_add_f32_dpp v98, v98, v98 quad_perm:[1,0,3,2] row_mask:0xf bank_mask:0xf
    v_add_f32_dpp v99, v99, v99 quad_perm:[1,0,3,2] row_mask:0xf bank_mask:0xf
    v_add_f32_dpp v96, v96, v96 quad_perm:[2,3,0,1] row_mask:0xf bank_mask:0xf
    v_add_f32_dpp v97, v97, v97 quad_perm:[2,3,0,1] row_mask:0xf bank_mask:0xf
    v_add_f32_dpp v98, v98, v98 quad_perm:[2,3,0,1] row_mask:0xf bank_mask:0xf
    v_add_f32_dpp v99, v99, v99 quad_perm:[2,3,0,1] row_mask:0xf bank_mask:0xf
    v_add_f32_dpp v96, v96, v96 row_half_mirror row_mask:0xf bank_mask:0xf
    v_add_f32_dpp v97, v97, v97 row_half_mirror row_mask:0xf bank_mask:0xf
    v_add_f32_dpp v98, v98, v98 row_half_mirror row_mask:0xf bank_mask:0xf
    v_add_f32_dpp v99, v99, v99 row_half_mirror row_mask:0xf bank_mask:0xf
    v_add_f32_dpp v96, v96, v96 row_mirror row_mask:0xf bank_mask:0xf
    v_add_f32_dpp v97, v97, v97 row_mirror row_mask:0xf bank_mask:0xf
    v_add_f32_dpp v98, v98, v98 row_mirror row_mask:0xf bank_mask:0xf
    v_add_f32_dpp v99, v99, v99 row_mirror row_mask:0xf bank_mask:0xf
    v_and_b32 v4, 31, v8
    v_lshlrev_b32 v11, 2, v4
    v_add_u32 v11, 122880, v11
    v_lshlrev_b32 v12, 1, v4
    v_add_u32 v12, 123008, v12
    v_cvt_pk_bf16_f32 v2, v96, v96
    v_lshlrev_b32 v2, 16, v2
    v_ashrrev_i32 v3, 31, v2
    v_or_b32 v3, 0x80000000, v3
    v_xor_b32 v2, v2, v3
    v_and_b32 v2, 0xffff0000, v2
    v_sub_u32 v3, 0x87ff, v8
    v_or_b32 v96, v2, v3
    ds_write_b32 v11, v96 offset:0
    v_cvt_pk_bf16_f32 v98, v98, v98
    v_lshlrev_b32 v98, 16, v98
    v_mul_f32 v5, 0xbfb8aa3b, v98
    v_exp_f32 v5, v5
    s_nop 0
    v_add_f32 v5, 1.0, v5
    v_rcp_f32 v98, v5
    s_nop 0
    v_cvt_pk_bf16_f32 v98, v98, v98
    v_or_b32 v98, 0x8000, v98
    ds_write_b16 v12, v98 offset:0
    v_cvt_pk_bf16_f32 v2, v97, v97
    v_lshlrev_b32 v2, 16, v2
    v_ashrrev_i32 v3, 31, v2
    v_or_b32 v3, 0x80000000, v3
    v_xor_b32 v2, v2, v3
    v_and_b32 v2, 0xffff0000, v2
    v_sub_u32 v3, 0x87fb, v8
    v_or_b32 v97, v2, v3
    ds_write_b32 v11, v97 offset:16
    v_cvt_pk_bf16_f32 v99, v99, v99
    v_lshlrev_b32 v99, 16, v99
    v_mul_f32 v5, 0xbfb8aa3b, v99
    v_exp_f32 v5, v5
    s_nop 0
    v_add_f32 v5, 1.0, v5
    v_rcp_f32 v99, v5
    s_nop 0
    v_cvt_pk_bf16_f32 v99, v99, v99
    v_or_b32 v99, 0x8000, v99
    ds_write_b16 v12, v99 offset:8
    v_mov_b32 v3, 1
    s_mov_b64 exec, 1
    ds_add_u32 v13, v3 offset:48
    s_mov_b64 exec, -1
    s_cmp_ge_u32 s30, 6
    s_cbranch_scc1 K_AUX_G1
    s_mov_b32 s3, 1048576
K_FGR:
    ds_read_b32 v2, v13 offset:48
    s_sleep 1
    s_sub_u32 s3, s3, 1
    s_waitcnt lgkmcnt(0)
    v_readfirstlane_b32 s33, v2
    s_nop 3
    s_cselect_b32 s33, 4, s33
    s_cmp_lt_u32 s33, 4
    s_cbranch_scc1 K_FGR
    s_cmp_lg_u32 s30, 4
    s_cbranch_scc1 K_AUX_G0
    v_and_b32 v3, 31, v1
    v_lshlrev_b32 v3, 2, v3
    v_add_u32 v3, 122880, v3
    ds_read_b32 v2, v3
    s_waitcnt lgkmcnt(0)
    s_nop 1
    v_max_u32_dpp v3, v2, v2 quad_perm:[1,0,3,2] row_mask:0xf bank_mask:0xf
    s_nop 1
    v_max_u32_dpp v3, v3, v3 quad_perm:[2,3,0,1] row_mask:0xf bank_mask:0xf
    s_nop 1
    v_max_u32_dpp v3, v3, v3 row_half_mirror row_mask:0xf bank_mask:0xf
    s_nop 1
    v_max_u32_dpp v3, v3, v3 row_mirror row_mask:0xf bank_mask:0xf
    s_nop 1
    v_readlane_b32 s68, v3, 0
    v_readlane_b32 s76, v3, 16
    v_readlane_b32 s77, v3, 32
    v_readlane_b32 s78, v3, 48
    s_nop 3
    s_max_u32 s68, s68, s76
    s_max_u32 s77, s77, s78
    s_max_u32 s68, s68, s77
    v_cmp_ne_u32 vcc, s68, v2
    s_nop 1
    v_cndmask_b32 v2, 0, v2, vcc
    s_nop 1
    v_max_u32_dpp v3, v2, v2 quad_perm:[1,0,3,2] row_mask:0xf bank_mask:0xf
    s_nop 1
    v_max_u32_dpp v3, v3, v3 quad_perm:[2,3,0,1] row_mask:0xf bank_mask:0xf
    s_nop 1
    v_max_u32_dpp v3, v3, v3 row_half_mirror row_mask:0xf bank_mask:0xf
    s_nop 1
    v_max_u32_dpp v3, v3, v3 row_mirror row_mask:0xf bank_mask:0xf
    s_nop 1
    v_readlane_b32 s69, v3, 0
    v_readlane_b32 s76, v3, 16
    v_readlane_b32 s77, v3, 32
    v_readlane_b32 s78, v3, 48
    s_nop 3
    s_max_u32 s69, s69, s76
    s_max_u32 s77, s77, s78
    s_max_u32 s69, s69, s77
    s_load_dword s33, s[4:5], 0
    s_waitcnt lgkmcnt(0)
    s_cmp_ge_u32 s33, 1
    s_cbranch_scc1 K_ZO3
    s_sleep 8
    s_load_dword s33, s[4:5], 64
    s_waitcnt lgkmcnt(0)
    s_cmp_ge_u32 s33, 1
    s_cbranch_scc1 K_ZO3
    s_sleep 8
    s_mov_b32 s3, 16384
K_ZB3:
    v_mov_b32 v4, 0
    global_load_dword v4, v4, s[4:5] sc1
    s_waitcnt vmcnt(0)
    v_readfirstlane_b32 s33, v4
    s_cmp_ge_u32 s33, 1
    s_cbranch_scc1 K_ZO3
    s_sleep 8
    s_sub_u32 s3, s3, 1
    s_cbranch_scc0 K_ZB3
K_ZO3:
    s_lshl_b32 s3, s2, 3
    s_add_u32 s3, s3, 606208
    s_atomic_add_x2 s[68:69], s[6:7], s3
    s_cmp_lg_u32 s2, 63
    s_cbranch_scc1 K_AUX_G1
    s_mov_b32 s70, 81920
    v_lshlrev_b32 v3, 3, v1
    s_mov_b32 s3, 131072
K_AUX_POLL:
    buffer_load_dwordx2 v[176:177], v3, s[64:67], s70 offen sc1
    s_waitcnt vmcnt(0)
    v_min_u32 v2, v176, v177
    v_cmp_eq_u32 vcc, 0, v2
    s_cbranch_vccz K_AUX_GOT
    s_sleep 2
    s_sub_u32 s3, s3, 1
    s_cmp_lg_u32 s3, 0
    s_cbranch_scc1 K_AUX_POLL
K_AUX_GOT:
    s_waitcnt lgkmcnt(0)
    s_nop 1
    v_max_u32_dpp v3, v176, v176 quad_perm:[1,0,3,2] row_mask:0xf bank_mask:0xf
    s_nop 1
    v_max_u32_dpp v3, v3, v3 quad_perm:[2,3,0,1] row_mask:0xf bank_mask:0xf
    s_nop 1
    v_max_u32_dpp v3, v3, v3 row_half_mirror row_mask:0xf bank_mask:0xf
    s_nop 1
    v_max_u32_dpp v3, v3, v3 row_mirror row_mask:0xf bank_mask:0xf
    s_nop 1
    v_readlane_b32 s68, v3, 0
    v_readlane_b32 s76, v3, 16
    v_readlane_b32 s77, v3, 32
    v_readlane_b32 s78, v3, 48
    s_nop 3
    s_max_u32 s68, s68, s76
    s_max_u32 s77, s77, s78
    s_max_u32 s68, s68, s77
    v_cmp_ne_u32 vcc, s68, v176
    s_nop 1
    v_cndmask_b32 v2, v177, v176, vcc
    s_nop 1
    v_max_u32_dpp v3, v2, v2 quad_perm:[1,0,3,2] row_mask:0xf bank_mask:0xf
    s_nop 1
    v_max_u32_dpp v3, v3, v3 quad_perm:[2,3,0,1] row_mask:0xf bank_mask:0xf
    s_nop 1
    v_max_u32_dpp v3, v3, v3 row_half_mirror row_mask:0xf bank_mask:0xf
    s_nop 1
    v_max_u32_dpp v3, v3, v3 row_mirror row_mask:0xf bank_mask:0xf
    s_nop 1
    v_readlane_b32 s69, v3, 0
    v_readlane_b32 s76, v3, 16
    v_readlane_b32 s77, v3, 32
    v_readlane_b32 s78, v3, 48
    s_nop 3
    s_max_u32 s69, s69, s76
    s_max_u32 s77, s77, s78
    s_max_u32 s69, s69, s77
    v_mov_b32 v176, s68
    v_mov_b32 v177, s69
    s_mov_b32 s3, 1048576
K_FGZ:
    ds_read_b32 v2, v13 offset:36
    s_sleep 1
    s_sub_u32 s3, s3, 1
    s_waitcnt lgkmcnt(0)
    v_readfirstlane_b32 s33, v2
    s_nop 3
    s_cselect_b32 s33, 1, s33
    s_cmp_lt_u32 s33, 1
    s_cbranch_scc1 K_FGZ
    v_lshlrev_b32 v3, 9, v1
    s_mov_b32 s66, 81920
    s_mov_b32 s70, 0
    buffer_store_dwordx2 v[176:177], v3, s[64:67], s70 offen offset:128 sc1
    s_mov_b32 s70, 32768
    buffer_store_dwordx2 v[176:177], v3, s[64:67], s70 offen offset:128 sc1
    s_mov_b32 s70, 65536
    buffer_store_dwordx2 v[176:177], v3, s[64:67], s70 offen offset:128 sc1
    v_mov_b32 v3, 16
    ds_write_b32 v13, v3 offset:48
    s_branch K_AUX_G1
K_AUX_G0:
    v_and_b32 v3, 3, v1
    v_lshlrev_b32 v3, 4, v3
    v_add_u32 v2, 123008, v3
    ds_read_b128 v[176:179], v2
    v_lshrrev_b32 v2, 2, v1
    v_lshl_add_u32 v3, v2, 9, v3
    s_sleep 12
    s_load_dword s33, s[4:5], 128
    s_waitcnt lgkmcnt(0)
    s_cmp_ge_u32 s33, 8
    s_cbranch_scc1 K_ZO4
    s_sleep 8
    s_mov_b32 s3, 16384
K_ZB4:
    v_mov_b32 v4, 128
    global_load_dword v4, v4, s[4:5] sc1
    s_waitcnt vmcnt(0)
    v_readfirstlane_b32 s33, v4
    s_cmp_ge_u32 s33, 8
    s_cbranch_scc1 K_ZO4
    s_sleep 8
    s_sub_u32 s3, s3, 1
    s_cbranch_scc0 K_ZB4
K_ZO4:
    v_mov_b32 v2, 1
    ds_write_b32 v13, v2 offset:36
    s_lshr_b32 s3, s29, 2
    s_lshl1_add_u32 s3, s28, s3
    s_mul_i32 s3, s3, 5120
    s_and_b32 s70, s29, 3
    s_lshl_b32 s70, s70, 6
    s_add_u32 s3, s3, s70
    s_mov_b32 exec_hi, 0xff
    s_waitcnt lgkmcnt(0)
    buffer_store_dwordx4 v[176:179], v3, s[64:67], s3 offen offset:256 sc1
    s_mov_b64 exec, -1
K_AUX_G1:
    s_cmp_lg_u32 s43, 63
    s_cbranch_scc1 K_FFN_C
    s_cmp_lg_u32 s29, 0
    s_cbranch_scc1 K_AUX_NT
    s_lshl2_add_u32 s3, s28, s30
    s_sub_u32 s3, s3, 4
    s_mul_i32 s3, s3, 25600
    v_lshlrev_b32 v2, 7, v1
    buffer_load_dword v5, v2, s[24:27], s3 offen
    s_add_u32 s3, s3, 8192
    buffer_load_dword v5, v2, s[24:27], s3 offen
    s_add_u32 s3, s3, 8192
    buffer_load_dword v5, v2, s[24:27], s3 offen
    s_add_u32 s3, s3, 8192
    s_mov_b64 exec, 0xff
    buffer_load_dword v5, v2, s[24:27], s3 offen
    s_add_u32 s3, s3, 8192
    s_mov_b64 exec, -1
K_AUX_NT:
    s_mov_b32 s3, 1048576
K_FGZ2:
    ds_read_b32 v2, v13 offset:36
    s_sleep 1
    s_sub_u32 s3, s3, 1
    s_waitcnt lgkmcnt(0)
    v_readfirstlane_b32 s33, v2
    s_nop 3
    s_cselect_b32 s33, 1, s33
    s_cmp_lt_u32 s33, 1
    s_cbranch_scc1 K_FGZ2
    s_waitcnt vmcnt(0)
    s_branch K_P2
K_AUX_L:
    v_and_b32 v1, 63, v0
    v_mov_b32 v7, 0
    s_and_b32 s28, s2, 7
    s_lshr_b32 s29, s2, 3
    s_xor_b32 s30, s30, 4
    s_lshr_b32 s34, s29, 3
    s_lshl_b32 s34, s34, 2
    s_and_b32 s3, s29, 3
    s_add_u32 s34, s34, s3
    s_add_u32 s34, s34, 4
    s_bitcmp1_b32 s29, 2
    s_cselect_b32 s34, -1, s34
    s_cmp_lt_u32 s29, 8
    s_cselect_b32 s34, s29, s34
    s_lshl_b32 s40, s28, 1
    s_cmp_ge_u32 s34, 10
    s_addc_u32 s40, s40, 0
    s_sub_u32 s41, s34, 10
    s_cmp_ge_u32 s34, 10
    s_cselect_b32 s41, s41, s34
    s_mul_i32 s42, s28, 20
    s_add_u32 s42, s42, s34
    s_and_b32 s42, s42, 255
    s_lshl_b32 s42, s42, 9
    s_add_u32 s42, s42, 524288
    s_mul_i32 s43, s28, 7
    s_add_u32 s43, s43, s29
    s_sub_u32 s43, s43, 1
    s_cmp_lt_u32 s43, 54
    s_cselect_b32 s43, s43, 63
    s_cmp_eq_u32 s29, 0
    s_cselect_b32 s43, 63, s43
    v_mov_b32 v3, 158736
    ds_write2_b32 v3, v7, v7 offset0:0 offset1:1
    ds_write2_b32 v3, v7, v7 offset0:2 offset1:3
    ds_write2_b32 v3, v7, v7 offset0:4 offset1:5
    ds_write2_b32 v3, v7, v7 offset0:6 offset1:7
    ds_write2_b32 v3, v7, v7 offset0:8 offset1:9
    ds_write2_b32 v3, v7, v7 offset0:10 offset1:11
    v_lshrrev_b32 v3, 2, v1
    v_mul_u32_u24 v11, 3456, v3
    v_lshrrev_b32 v3, 4, v1
    v_and_b32 v3, 2, v3
    v_xor_b32 v3, v3, v1
    v_and_b32 v3, 3, v3
    v_lshl_add_u32 v11, v3, 4, v11
    s_mul_i32 s3, s30, 552960
    s_lshl_b32 s70, s43, 6
    s_add_u32 s3, s3, s70
    v_add_u32 v11, s3, v11
    s_mul_i32 s68, s30, 10240
    s_add_u32 s72, s68, 40960
    s_bitcmp1_b32 s43, 0
    s_cselect_b32 s71, s72, s68
    s_cselect_b32 s72, s68, s72
    v_lshlrev_b32 v8, 4, v1
    s_waitcnt lgkmcnt(0)
    s_barrier
    s_mov_b32 s24, s8
    s_mov_b32 s25, s9
    s_mov_b32 s26, 0xc8000
    s_mov_b32 s27, 0x20000
    s_cmp_lg_u32 s43, 63
    s_cbranch_scc1 K_AUX_FFN1
    s_cmp_lg_u32 s30, 0
    s_cbranch_scc1 K_AUX_NR
    s_cmp_eq_u32 s2, 55
    s_cbranch_scc1 K_AUX_NR
    s_cmp_eq_u32 s2, 63
    s_cselect_b32 s70, 0, 128
    s_mov_b32 s3, 1
    s_waitcnt vmcnt(0)
    s_atomic_add s3, s[4:5], s70
    s_atomic_add s3, s[4:5], s70 offset:64
    s_waitcnt lgkmcnt(0)
K_AUX_NR:
    v_mov_b32 v13, 158720
    s_mov_b32 s3, 1048576
K_FGZ3:
    ds_read_b32 v2, v13 offset:36
    s_sleep 1
    s_sub_u32 s3, s3, 1
    s_waitcnt lgkmcnt(0)
    v_readfirstlane_b32 s33, v2
    s_nop 3
    s_cselect_b32 s33, 1, s33
    s_cmp_lt_u32 s33, 1
    s_cbranch_scc1 K_FGZ3
    s_cmp_lg_u32 s2, 63
    s_cbranch_scc1 K_AUX_NH
    s_mov_b32 s3, 1048576
K_FGH:
    ds_read_b32 v2, v13 offset:48
    s_sleep 1
    s_sub_u32 s3, s3, 1
    s_waitcnt lgkmcnt(0)
    v_readfirstlane_b32 s33, v2
    s_nop 3
    s_cselect_b32 s33, 16, s33
    s_cmp_lt_u32 s33, 16
    s_cbranch_scc1 K_FGH
K_AUX_NH:
    s_branch K_P2
K_AUX_FFN1:
    s_bitcmp1_b32 s43, 0
    s_cselect_b64 s[56:57], s[48:49], s[46:47]
    s_cselect_b64 s[60:61], s[46:47], s[48:49]
    s_mov_b32 s58, 2211840
    s_mov_b32 s59, 0x20000
    s_mov_b32 s62, 2211840
    s_mov_b32 s63, 0x20000
    s_add_u32 m0, s71, 0
    s_mov_b32 s70, 0
    buffer_load_dwordx4 v11, s[56:59], s70 offen  lds
    s_add_u32 m0, s71, 1024
    s_mov_b32 s70, 55296
    buffer_load_dwordx4 v11, s[56:59], s70 offen  lds
    s_add_u32 m0, s71, 2048
    s_mov_b32 s70, 110592
    buffer_load_dwordx4 v11, s[56:59], s70 offen  lds
    s_add_u32 m0, s71, 3072
    s_mov_b32 s70, 165888
    buffer_load_dwordx4 v11, s[56:59], s70 offen  lds
    s_add_u32 m0, s71, 4096
    s_mov_b32 s70, 221184
    buffer_load_dwordx4 v11, s[56:59], s70 offen  lds
    s_add_u32 m0, s71, 5120
    s_mov_b32 s70, 276480
    buffer_load_dwordx4 v11, s[56:59], s70 offen  lds
    s_add_u32 m0, s71, 6144
    s_mov_b32 s70, 331776
    buffer_load_dwordx4 v11, s[56:59], s70 offen  lds
    s_add_u32 m0, s71, 7168
    s_mov_b32 s70, 387072
    buffer_load_dwordx4 v11, s[56:59], s70 offen  lds
    s_add_u32 m0, s71, 8192
    s_mov_b32 s70, 442368
    buffer_load_dwordx4 v11, s[56:59], s70 offen  lds
    s_add_u32 m0, s71, 9216
    s_mov_b32 s70, 497664
    buffer_load_dwordx4 v11, s[56:59], s70 offen  lds
    s_add_u32 m0, s72, 0
    s_mov_b32 s70, 0
    buffer_load_dwordx4 v11, s[60:63], s70 offen  lds
    s_add_u32 m0, s72, 1024
    s_mov_b32 s70, 55296
    buffer_load_dwordx4 v11, s[60:63], s70 offen  lds
    s_add_u32 m0, s72, 2048
    s_mov_b32 s70, 110592
    buffer_load_dwordx4 v11, s[60:63], s70 offen  lds
    s_add_u32 m0, s72, 3072
    s_mov_b32 s70, 165888
    buffer_load_dwordx4 v11, s[60:63], s70 offen  lds
    s_add_u32 m0, s72, 4096
    s_mov_b32 s70, 221184
    buffer_load_dwordx4 v11, s[60:63], s70 offen  lds
    s_add_u32 m0, s72, 5120
    s_mov_b32 s70, 276480
    buffer_load_dwordx4 v11, s[60:63], s70 offen  lds
    s_add_u32 m0, s72, 6144
    s_mov_b32 s70, 331776
    buffer_load_dwordx4 v11, s[60:63], s70 offen  lds
    s_add_u32 m0, s72, 7168
    s_mov_b32 s70, 387072
    buffer_load_dwordx4 v11, s[60:63], s70 offen  lds
    s_add_u32 m0, s72, 8192
    s_mov_b32 s70, 442368
    buffer_load_dwordx4 v11, s[60:63], s70 offen  lds
    s_add_u32 m0, s72, 9216
    s_mov_b32 s70, 497664
    buffer_load_dwordx4 v11, s[60:63], s70 offen  lds
    s_mov_b32 s64, s50
    s_mov_b32 s65, s51
    s_mov_b32 s66, 0x21c000
    s_mov_b32 s67, 0x20000
    s_mul_i32 s3, s43, 40960
    s_add_u32 s3, s3, s68
    v_lshrrev_b32 v2, 3, v1
    v_and_b32 v3, 2, v2
    s_lshl_b32 s70, s30, 2
    v_xor_b32 v3, s70, v3
    v_xor_b32 v3, v3, v1
    v_and_b32 v3, 7, v3
    v_mul_u32_u24 v2, 1280, v2
    v_lshl_add_u32 v2, v3, 4, v2
    v_add_u32 v12, s3, v2
    s_add_u32 m0, s68, 81920
    s_mov_b32 s70, 0
    buffer_load_dwordx4 v12, s[64:67], s70 offen  lds
    s_add_u32 m0, s68, 82944
    s_mov_b32 s70, 128
    buffer_load_dwordx4 v12, s[64:67], s70 offen  lds
    s_add_u32 m0, s68, 83968
    s_mov_b32 s70, 256
    buffer_load_dwordx4 v12, s[64:67], s70 offen  lds
    s_add_u32 m0, s68, 84992
    s_mov_b32 s70, 384
    buffer_load_dwordx4 v12, s[64:67], s70 offen  lds
    s_add_u32 m0, s68, 86016
    s_mov_b32 s70, 512
    buffer_load_dwordx4 v12, s[64:67], s70 offen  lds
    s_add_u32 m0, s68, 87040
    s_mov_b32 s70, 640
    buffer_load_dwordx4 v12, s[64:67], s70 offen  lds
    s_add_u32 m0, s68, 88064
    s_mov_b32 s70, 768
    buffer_load_dwordx4 v12, s[64:67], s70 offen  lds
    s_add_u32 m0, s68, 89088
    s_mov_b32 s70, 896
    buffer_load_dwordx4 v12, s[64:67], s70 offen  lds
    s_add_u32 m0, s68, 90112
    s_mov_b32 s70, 1024
    buffer_load_dwordx4 v12, s[64:67], s70 offen  lds
    s_add_u32 m0, s68, 91136
    s_mov_b32 s70, 1152
    buffer_load_dwordx4 v12, s[64:67], s70 offen  lds
    s_waitcnt vmcnt(10)
    s_barrier
    s_branch K_P2_EARLY
K_FFN_C:
    v_lshrrev_b32 v180, 4, v1
    v_bfe_u32 v2, v1, 2, 2
    v_lshl_add_u32 v2, v180, 3, v2
    v_and_b32 v3, 3, v1
    v_lshlrev_b32 v3, 3, v3
    v_lshl_add_u32 v181, v2, 6, v3
    s_bfe_u32 s3, s30, 0x10001
    s_mul_i32 s3, s3, 40960
    v_xor_b32 v4, s30, v180
    v_and_b32 v4, 1, v4
    v_lshl_add_u32 v181, v4, 5, v181
    v_add_u32 v181, s3, v181
    v_bfe_u32 v4, v1, 3, 2
    v_xor_b32 v4, s30, v4
    v_and_b32 v4, 3, v4
    v_lshl_add_u32 v3, v4, 5, v3
    v_and_b32 v2, 3, v2
    v_lshl_add_u32 v3, v2, 7, v3
    v_mul_u32_u24 v182, 10240, v180
    s_mov_b32 s3, 81920
    v_add3_u32 v182, v182, v3, s3
    v_mov_b32 v183, 123904
    s_cmp_lg_u32 s30, 5
    s_cbranch_scc1 K_KW
    s_mov_b32 s3, 131072
K_KPOLL:
    s_load_dwordx2 s[68:69], s[6:7], s42 offset:128 glc
    s_waitcnt lgkmcnt(0)
    s_min_u32 s33, s68, s69
    s_cmp_lg_u32 s33, 0
    s_cbranch_scc1 K_KGOT
    s_sleep 2
    s_sub_u32 s3, s3, 1
    s_cbranch_scc0 K_KPOLL
K_KGOT:
    v_mov_b32 v176, s68
    v_mov_b32 v177, s69
    ds_write_b64 v183, v[176:177]
    v_lshlrev_b32 v2, 4, v1
    s_and_b32 s70, s68, 0x7ff
    s_sub_u32 s70, 2047, s70
    s_mul_i32 s70, s70, 1280
    s_mov_b32 m0, 134208
    s_mov_b64 exec, -1
    buffer_load_dwordx4 v2, s[12:15], s70 offen lds
    s_mov_b64 exec, 0xffff
    buffer_load_dwordx4 v2, s[12:15], s70 offen offset:1024 lds
    s_and_b32 s70, s69, 0x7ff
    s_sub_u32 s70, 2047, s70
    s_mul_i32 s70, s70, 1280
    s_mov_b32 m0, 135552
    s_mov_b64 exec, -1
    buffer_load_dwordx4 v2, s[12:15], s70 offen lds
    s_mov_b64 exec, 0xffff
    buffer_load_dwordx4 v2, s[12:15], s70 offen offset:1024 lds
    s_mov_b64 exec, -1
    v_mov_b32 v3, 16
    s_waitcnt vmcnt(0)
    ds_write_b32 v13, v3 offset:48
    s_branch K_KW2
K_KW:
    s_cmp_lt_u32 s30, 6
    s_cbranch_scc1 K_KW2
    s_cmp_eq_u32 s30, 6
    s_cbranch_scc1 K_CHF0
    s_branch K_CHF1
K_WRET_F:
K_KW2:
    s_branch K_J7f1c
K_CHF0:
K_STF16:
    s_branch K_STF18
    s_nop 0
K_J7f1c:
    v_and_b32 v2, 1, v1
    v_mul_u32_u24 v9, 1344, v2
    v_lshl_add_u32 v9, v180, 4, v9
    v_add_u32 v9, 134208, v9
    v_and_b32 v2, 1, v1
    v_lshlrev_b32 v192, 6, v2
    v_lshl_add_u32 v192, v180, 4, v192
    s_and_b32 s3, s30, 3
    s_lshl_b32 s3, s3, 7
    v_add3_u32 v193, v192, s3, v183
    v_add_u32 v192, 64, v193
    v_add_u32 v193, 1088, v193
    v_lshrrev_b32 v2, 5, v1
    v_bfe_u32 v3, v1, 4, 1
    v_lshl_add_u32 v3, v3, 1, v2
    v_lshlrev_b32 v3, 6, v3
    v_and_b32 v4, 15, v1
    v_lshl_add_u32 v3, v4, 2, v3
    v_add_u32 v194, 123968, v3
    v_lshlrev_b32 v4, 1, v1
    s_add_u32 s3, s3, 124992
    v_add_u32 v195, s3, v4
    v_and_b32 v2, 1, v1
    v_mul_u32_u24 v2, 2560, v2
    v_lshl_add_u32 v196, v180, 4, v2
    s_lshl_b32 s70, s30, 6
    s_add_u32 s70, s70, 125760
    v_add_u32 v196, s70, v196
    v_mov_b32 v3, 1
    s_mov_b32 s3, 1048576
K_FGK:
    ds_read_b32 v2, v13 offset:48
    s_sleep 1
    s_sub_u32 s3, s3, 1
    s_waitcnt lgkmcnt(0)
    v_readfirstlane_b32 s33, v2
    s_nop 3
    s_cselect_b32 s33, 16, s33
    s_branch K_PG7
.p2align 12
K_CHF1:
K_STF17:
    s_branch K_WRET_F
    s_nop 0
K_PG7:
    s_cmp_lt_u32 s33, 16
    s_cbranch_scc1 K_FGK
    ds_read_b128 v[96:99], v9 offset:0
    ds_read_b128 v[100:103], v9 offset:64
    ds_read_b128 v[104:107], v9 offset:128
    ds_read_b128 v[108:111], v9 offset:192
    ds_read_b128 v[112:115], v9 offset:256
    ds_read_b128 v[116:119], v9 offset:320
    ds_read_b128 v[120:123], v9 offset:384
    ds_read_b128 v[124:127], v9 offset:448
    ds_read_b128 v[128:131], v9 offset:512
    ds_read_b128 v[132:135], v9 offset:576
    ds_read_b128 v[136:139], v9 offset:640
    ds_read_b128 v[140:143], v9 offset:704
    ds_read_b128 v[144:147], v9 offset:768
    ds_read_b128 v[148:151], v9 offset:832
    ds_read_b128 v[152:155], v9 offset:896
    ds_read_b128 v[156:159], v9 offset:960
    ds_read_b128 v[160:163], v9 offset:1024
    ds_read_b128 v[164:167], v9 offset:1088
    ds_read_b128 v[168:171], v9 offset:1152
    ds_read_b128 v[172:175], v9 offset:1216
    s_setprio 3
    s_barrier
    ds_read_b64_tr_b16 v[16:17], v181 offset:0
    ds_read_b64_tr_b16 v[18:19], v181 offset:256
    ds_read_b64_tr_b16 v[20:21], v181 offset:2048
    ds_read_b64_tr_b16 v[22:23], v181 offset:2304
    ds_read_b64_tr_b16 v[24:25], v181 offset:4096
    ds_read_b64_tr_b16 v[26:27], v181 offset:4352
    ds_read_b64_tr_b16 v[28:29], v181 offset:6144
    ds_read_b64_tr_b16 v[30:31], v181 offset:6400
    ds_read_b64_tr_b16 v[32:33], v181 offset:8192
    ds_read_b64_tr_b16 v[34:35], v181 offset:8448
    ds_read_b64_tr_b16 v[36:37], v181 offset:10240
    ds_read_b64_tr_b16 v[38:39], v181 offset:10496
    ds_read_b64_tr_b16 v[40:41], v181 offset:12288
    ds_read_b64_tr_b16 v[42:43], v181 offset:12544
    ds_read_b64_tr_b16 v[44:45], v181 offset:14336
    ds_read_b64_tr_b16 v[46:47], v181 offset:14592
    ds_read_b64_tr_b16 v[48:49], v181 offset:16384
    ds_read_b64_tr_b16 v[50:51], v181 offset:16640
    ds_read_b64_tr_b16 v[52:53], v181 offset:18432
    ds_read_b64_tr_b16 v[54:55], v181 offset:18688
    ds_read_b64_tr_b16 v[56:57], v181 offset:20480
    ds_read_b64_tr_b16 v[58:59], v181 offset:20736
    ds_read_b64_tr_b16 v[60:61], v181 offset:22528
    ds_read_b64_tr_b16 v[62:63], v181 offset:22784
    ds_read_b64_tr_b16 v[64:65], v181 offset:24576
    ds_read_b64_tr_b16 v[66:67], v181 offset:24832
    ds_read_b64_tr_b16 v[68:69], v181 offset:26624
    ds_read_b64_tr_b16 v[70:71], v181 offset:26880
    ds_read_b64_tr_b16 v[72:73], v181 offset:28672
    ds_read_b64_tr_b16 v[74:75], v181 offset:28928
    ds_read_b64_tr_b16 v[76:77], v181 offset:30720
    ds_read_b64_tr_b16 v[78:79], v181 offset:30976
    ds_read_b64_tr_b16 v[80:81], v181 offset:32768
    ds_read_b64_tr_b16 v[82:83], v181 offset:33024
    ds_read_b64_tr_b16 v[84:85], v181 offset:34816
    ds_read_b64_tr_b16 v[86:87], v181 offset:35072
    ds_read_b64_tr_b16 v[88:89], v181 offset:36864
    ds_read_b64_tr_b16 v[90:91], v181 offset:37120
    ds_read_b64_tr_b16 v[92:93], v181 offset:38912
    ds_read_b64_tr_b16 v[94:95], v181 offset:39168
    s_waitcnt lgkmcnt(0)
    s_barrier
    v_mfma_f32_16x16x32_bf16 v[184:187], v[16:19], v[96:99], 0
    v_mfma_f32_16x16x32_bf16 v[188:191], v[20:23], v[100:103], 0
    v_mfma_f32_16x16x32_bf16 v[184:187], v[24:27], v[104:107], v[184:187]
    v_mfma_f32_16x16x32_bf16 v[188:191], v[28:31], v[108:111], v[188:191]
    v_mfma_f32_16x16x32_bf16 v[184:187], v[32:35], v[112:115], v[184:187]
    v_mfma_f32_16x16x32_bf16 v[188:191], v[36:39], v[116:119], v[188:191]
    v_mfma_f32_16x16x32_bf16 v[184:187], v[40:43], v[120:123], v[184:187]
    v_mfma_f32_16x16x32_bf16 v[188:191], v[44:47], v[124:127], v[188:191]
    v_mfma_f32_16x16x32_bf16 v[184:187], v[48:51], v[128:131], v[184:187]
    v_mfma_f32_16x16x32_bf16 v[188:191], v[52:55], v[132:135], v[188:191]
    v_mfma_f32_16x16x32_bf16 v[184:187], v[56:59], v[136:139], v[184:187]
    v_mfma_f32_16x16x32_bf16 v[188:191], v[60:63], v[140:143], v[188:191]
    v_mfma_f32_16x16x32_bf16 v[184:187], v[64:67], v[144:147], v[184:187]
    v_mfma_f32_16x16x32_bf16 v[188:191], v[68:71], v[148:151], v[188:191]
    v_mfma_f32_16x16x32_bf16 v[184:187], v[72:75], v[152:155], v[184:187]
    v_mfma_f32_16x16x32_bf16 v[188:191], v[76:79], v[156:159], v[188:191]
    v_mfma_f32_16x16x32_bf16 v[184:187], v[80:83], v[160:163], v[184:187]
    v_mfma_f32_16x16x32_bf16 v[188:191], v[84:87], v[164:167], v[188:191]
    v_mfma_f32_16x16x32_bf16 v[184:187], v[88:91], v[168:171], v[184:187]
    v_mfma_f32_16x16x32_bf16 v[188:191], v[92:95], v[172:175], v[188:191]
    s_nop 7
    v_add_f32 v184, v184, v188
    v_add_f32 v185, v185, v189
    v_add_f32 v186, v186, v190
    v_add_f32 v187, v187, v191
    s_mov_b32 exec_lo, 0x00030003
    s_mov_b32 exec_hi, 0x00030003
    ds_write_b128 v192, v[184:187]
    s_mov_b64 exec, 1
    ds_add_u32 v13, v3 offset:52
    s_mov_b64 exec, -1
    s_cmp_lg_u32 s30, 6
    s_cbranch_scc1 K_NOS6B
    v_lshl_add_u32 v4, v1, 2, s42
    global_load_dword v7, v4, s[6:7] offset:256 sc1
    v_and_b32 v4, 0xfffffe04, v4
    global_load_dword v6, v4, s[6:7] offset:128 sc1
K_NOS6B:
    s_mov_b32 s3, 1048576
K_FGP:
    ds_read_b32 v2, v13 offset:52
    s_sleep 1
    s_sub_u32 s3, s3, 1
    s_waitcnt lgkmcnt(0)
    v_readfirstlane_b32 s33, v2
    s_nop 3
    s_cselect_b32 s33, 8, s33
    s_cmp_lt_u32 s33, 8
    s_cbranch_scc1 K_FGP
    ds_read_b32 v200, v194
    ds_read_b32 v202, v194 offset:256
    ds_read_b64_tr_b16 v[16:17], v182 offset:0
    ds_read_b64_tr_b16 v[18:19], v182 offset:512
    ds_read_b64_tr_b16 v[20:21], v182 offset:1024
    ds_read_b64_tr_b16 v[22:23], v182 offset:1536
    ds_read_b64_tr_b16 v[24:25], v182 offset:2048
    ds_read_b64_tr_b16 v[26:27], v182 offset:2560
    ds_read_b64_tr_b16 v[28:29], v182 offset:3072
    ds_read_b64_tr_b16 v[30:31], v182 offset:3584
    ds_read_b64_tr_b16 v[32:33], v182 offset:4096
    ds_read_b64_tr_b16 v[34:35], v182 offset:4608
    ds_read_b64_tr_b16 v[36:37], v182 offset:5120
    ds_read_b64_tr_b16 v[38:39], v182 offset:5632
    ds_read_b64_tr_b16 v[40:41], v182 offset:6144
    ds_read_b64_tr_b16 v[42:43], v182 offset:6656
    s_waitcnt lgkmcnt(14)
    v_cvt_pk_bf16_f32 v200, v200, v200
    v_lshlrev_b32 v200, 16, v200
    v_cvt_pk_bf16_f32 v202, v202, v202
    s_branch K_J83cc
K_STF18:
    s_branch K_WRET_F
    s_nop 0
K_J83cc:
    v_lshlrev_b32 v202, 16, v202
    v_mul_f32 v201, 0xbfb8aa3b, v200
    v_exp_f32 v201, v201
    s_nop 0
    v_add_f32 v201, 1.0, v201
    v_rcp_f32 v201, v201
    s_nop 0
    v_mul_f32 v200, v200, v201
    v_cvt_pk_bf16_f32 v200, v200, v200
    v_lshlrev_b32 v200, 16, v200
    v_mul_f32 v200, v200, v202
    v_cvt_pk_bf16_f32 v200, v200, v200
    ds_write_b16 v195, v200
    s_waitcnt lgkmcnt(0)
    ds_read_b128 v[200:203], v193
    ds_read_b64_tr_b16 v[44:45], v182 offset:7168
    ds_read_b64_tr_b16 v[46:47], v182 offset:7680
    ds_read_b64_tr_b16 v[48:49], v182 offset:8192
    ds_read_b64_tr_b16 v[50:51], v182 offset:8704
    ds_read_b64_tr_b16 v[52:53], v182 offset:9216
    ds_read_b64_tr_b16 v[54:55], v182 offset:9728
    s_waitcnt lgkmcnt(6)
    v_mfma_f32_16x16x32_bf16 v[96:99], v[16:19], v[200:203], 0
    v_mfma_f32_16x16x32_bf16 v[100:103], v[20:23], v[200:203], 0
    v_mfma_f32_16x16x32_bf16 v[104:107], v[24:27], v[200:203], 0
    v_mfma_f32_16x16x32_bf16 v[108:111], v[28:31], v[200:203], 0
    v_mfma_f32_16x16x32_bf16 v[112:115], v[32:35], v[200:203], 0
    v_mfma_f32_16x16x32_bf16 v[116:119], v[36:39], v[200:203], 0
    v_mfma_f32_16x16x32_bf16 v[120:123], v[40:43], v[200:203], 0
    s_waitcnt lgkmcnt(4)
    v_mfma_f32_16x16x32_bf16 v[124:127], v[44:47], v[200:203], 0
    s_waitcnt lgkmcnt(2)
    v_mfma_f32_16x16x32_bf16 v[128:131], v[48:51], v[200:203], 0
    s_waitcnt lgkmcnt(0)
    v_mfma_f32_16x16x32_bf16 v[132:135], v[52:55], v[200:203], 0
    s_mov_b32 exec_lo, 0x00030003
    s_mov_b32 exec_hi, 0x00030003
    ds_write_b128 v196, v[96:99] offset:0
    ds_write_b128 v196, v[100:103] offset:256
    ds_write_b128 v196, v[104:107] offset:512
    ds_write_b128 v196, v[108:111] offset:768
    ds_write_b128 v196, v[112:115] offset:1024
    ds_write_b128 v196, v[116:119] offset:1280
    ds_write_b128 v196, v[120:123] offset:1536
    ds_write_b128 v196, v[124:127] offset:1792
    ds_write_b128 v196, v[128:131] offset:2048
    ds_write_b128 v196, v[132:135] offset:2304
    v_mov_b32 v3, 1
    s_mov_b64 exec, 1
    ds_add_u32 v13, v3 offset:52
    s_mov_b64 exec, -1
    s_cmp_lg_u32 s30, 4
    s_cbranch_scc1 K_P2
    v_lshlrev_b32 v3, 4, v1
    v_add_u32 v4, 126016, v3
    s_mul_i32 s70, s43, 5120
    s_add_u32 s71, s70, 4096
    s_mov_b32 s3, 1048576
K_FGQ:
    ds_read_b32 v2, v13 offset:52
    s_sleep 1
    s_sub_u32 s3, s3, 1
    s_waitcnt lgkmcnt(0)
    v_readfirstlane_b32 s33, v2
    s_nop 3
    s_cselect_b32 s33, 12, s33
    s_cmp_lt_u32 s33, 12
    s_cbranch_scc1 K_FGQ
    ds_read_b128 v[16:19], v4 offset:0
    ds_read_b128 v[20:23], v4 offset:1024
    ds_read_b128 v[24:27], v4 offset:2048
    ds_read_b128 v[28:31], v4 offset:3072
    ds_read_b128 v[32:35], v4 offset:4096
    s_waitcnt lgkmcnt(4)
    buffer_store_dwordx4 v[16:19], v3, s[60:63], s70 offen offset:0 sc1
    s_waitcnt lgkmcnt(3)
    buffer_store_dwordx4 v[20:23], v3, s[60:63], s70 offen offset:1024 sc1
    s_waitcnt lgkmcnt(2)
    buffer_store_dwordx4 v[24:27], v3, s[60:63], s70 offen offset:2048 sc1
    s_waitcnt lgkmcnt(1)
    buffer_store_dwordx4 v[28:31], v3, s[60:63], s70 offen offset:3072 sc1
    s_waitcnt lgkmcnt(0)
    buffer_store_dwordx4 v[32:35], v3, s[60:63], s71 offen offset:0 sc1
    s_mov_b32 s3, 1
    s_waitcnt vmcnt(0)
    s_atomic_add s3, s[6:7], 606720 glc
    ds_read_b64 v[176:177], v183
    s_waitcnt lgkmcnt(0)
    s_cmp_lg_u32 s3, 53
    s_cbranch_scc1 K_P2
    v_readfirstlane_b32 s70, v176
    s_and_b32 s70, s70, 0x7ff
    s_sub_u32 s70, 2047, s70
    s_lshr_b32 s70, s70, 7
    s_mul_i32 s70, s70, 5120
    s_atomic_add s3, s[6:7], s70 offset:524424
    s_atomic_add s3, s[6:7], s70 offset:524936
    s_atomic_add s3, s[6:7], s70 offset:525448
    s_atomic_add s3, s[6:7], s70 offset:525960
    s_atomic_add s3, s[6:7], s70 offset:526472
    s_atomic_add s3, s[6:7], s70 offset:526984
    s_atomic_add s3, s[6:7], s70 offset:527496
    s_atomic_add s3, s[6:7], s70 offset:528008
    s_atomic_add s3, s[6:7], s70 offset:528520
    s_atomic_add s3, s[6:7], s70 offset:529032
    v_readfirstlane_b32 s70, v177
    s_and_b32 s70, s70, 0x7ff
    s_sub_u32 s70, 2047, s70
    s_lshr_b32 s70, s70, 7
    s_mul_i32 s70, s70, 5120
    s_atomic_add s3, s[6:7], s70 offset:524424
    s_atomic_add s3, s[6:7], s70 offset:524936
    s_atomic_add s3, s[6:7], s70 offset:525448
    s_atomic_add s3, s[6:7], s70 offset:525960
    s_atomic_add s3, s[6:7], s70 offset:526472
    s_atomic_add s3, s[6:7], s70 offset:526984
    s_atomic_add s3, s[6:7], s70 offset:527496
    s_atomic_add s3, s[6:7], s70 offset:528008
    s_atomic_add s3, s[6:7], s70 offset:528520
    s_atomic_add s3, s[6:7], s70 offset:529032
    s_waitcnt lgkmcnt(0)
    s_branch K_P2
K_CODE_END:
.section .rodata,"a"
.p2align 6
.amdhsa_kernel gated_mix__sliding_local_dilated__moe_arch_mod__prompt_kernel
  .amdhsa_next_free_vgpr 256
  .amdhsa_next_free_sgpr 79
  .amdhsa_accum_offset 256
  .amdhsa_group_segment_fixed_size 0
  .amdhsa_kernarg_size 96
  .amdhsa_user_sgpr_count 2
  .amdhsa_user_sgpr_kernarg_segment_ptr 1
  .amdhsa_system_sgpr_workgroup_id_x 1
.end_amdhsa_kernel
```

```asm
; @launch grid=(256,1,1) block=(512,1,1) lds=163840
.amdgcn_target "amdgcn-amd-amdhsa--gfx950"
.text
K_CPL = 34
.p2align 12
.p2align 8
.globl gated_mix__sliding_local_dilated__moe_arch_mod__prompt_kernel
.type gated_mix__sliding_local_dilated__moe_arch_mod__prompt_kernel,@function
gated_mix__sliding_local_dilated__moe_arch_mod__prompt_kernel:
    s_cmp_ge_u32 s2, 256
    s_cbranch_scc1 K_EXIT
    s_load_dwordx2 s[12:13], s[0:1], 0
    s_load_dwordx2 s[16:17], s[0:1], 8
    s_load_dwordx4 s[4:7], s[0:1], 80
    s_load_dwordx2 s[8:9], s[0:1], 16
    s_load_dwordx2 s[10:11], s[0:1], 72
    v_readfirstlane_b32 s30, v0
    s_mov_b32 s14, 0x280000
    s_mov_b32 s15, 0x20000
    s_lshr_b32 s30, s30, 6
    s_cmp_ge_u32 s2, 64
    s_cbranch_scc1 K_MAIN
    s_load_dwordx8 s[44:51], s[0:1], 32
    s_load_dwordx2 s[52:53], s[0:1], 64
    s_getpc_b64 s[38:39]
K_PC:
    s_lshr_b32 s3, s2, 3
    s_mul_i32 s3, s3, K_CPL
    v_add_u32 v2, s3, v0
    v_lshlrev_b32 v2, 7, v2
    v_min_u32 v2, K_CODE_END-K_PC-4, v2
    v_cmp_gt_u32 vcc, K_CPL, v0
    s_and_saveexec_b64 s[20:21], vcc
    s_cbranch_execz K_NOPF
    global_load_dword v6, v2, s[38:39]
K_NOPF:
    s_mov_b64 exec, -1
    s_cmp_lg_u32 s30, 4
    s_cbranch_scc1 K_AUX
    s_min_u32 s3, s2, 8
    s_mul_i32 s3, s3, 10240
    s_add_u32 s33, s3, 10240
    s_cmp_lt_u32 s2, 8
    s_cbranch_scc1 K_ZS
    s_cmp_lg_u32 s2, 63
    s_cbranch_scc1 K_AUX
    s_mov_b32 s33, 0
K_ZS:
    v_lshlrev_b32 v2, 4, v0
    v_mov_b32 v8, 0
    v_mov_b32 v9, 0
    v_mov_b32 v10, 0
    v_mov_b32 v11, 0
    s_waitcnt lgkmcnt(0)
    s_add_u32 s20, s6, 0x7f000
    s_addc_u32 s21, s7, 0
    s_mov_b32 s22, 0x15400
    s_mov_b32 s23, 0x20000
K_ZL:
    buffer_store_dwordx4 v[8:11], v2, s[20:23], s3 offen sc1
    s_add_u32 s3, s3, 1024
    s_cmp_lt_u32 s3, s33
    s_cbranch_scc1 K_ZL
    s_branch K_AUX
K_MAIN:
    s_cmp_ge_u32 s30, 4
    s_cbranch_scc1 K_CONS
    s_bfe_u32 s3, s2, 0x20001
    s_mul_i32 s44, s3, 655360
    s_add_u32 s14, s44, 655360
    s_lshr_b32 s33, s2, 6
    s_mul_i32 s3, s33, 225280
    s_add_u32 s44, s44, s3
    s_mul_i32 s3, s30, 61440
    s_add_u32 s44, s44, s3
    s_sub_u32 s44, s44, 245760
    v_bfe_u32 v3, v0, 4, 2
    s_lshr_b32 s3, s2, 1
    s_and_b32 s3, s3, 28
    s_or_b32 s3, s3, 0x40000
    v_lshlrev_b32 v2, 1, v3
    v_sub_u32 v2, v0, v2
    s_and_b32 s50, s2, 0xc1
    s_mov_b32 s49, 0x225310
    s_cmpk_eq_u32 s50, 128
    s_cselect_b32 s49, 0x75275526, s49
    s_cmpk_eq_u32 s50, 192
    s_cselect_b32 s49, 0x37750756, s49
    s_cmpk_eq_u32 s50, 65
    s_cselect_b32 s49, 0x225510, s49
    s_cmpk_eq_u32 s50, 129
    s_cselect_b32 s49, 0x75275525, s49
    s_cmpk_eq_u32 s50, 193
    s_cselect_b32 s49, 0x37769756, s49
    s_bfe_u32 s49, s49, s3
    s_bfe_u32 s32, 0x64317520, s3
    v_and_b32 v2, 15, v2
    v_mul_u32_u24 v5, 3840, v3
    s_lshl_b32 s3, s2, 2
    s_lshr_b32 s3, 0x44032335, s3
    s_and_b32 s3, s3, 15
    s_add_u32 s49, s49, s3
    s_mov_b32 s33, 0x00a55a
    v_subrev_u32 v5, 160, v5
    s_sub_u32 s3, s49, 10
    s_cselect_b32 s49, s49, s3
    v_mul_u32_u24 v4, 52, v2
    v_lshrrev_b32 v4, 5, v4
    v_and_b32 v4, 24, v4
    v_bfe_u32 v4, s33, v4, 8
    v_add_u32 v4, v4, v2
    v_lshl_add_u32 v218, v4, 4, v5
    v_add_u32 v4, 1, v2
    v_lshrrev_b32 v4, 4, v4
    v_lshl_add_u32 v218, v4, 28, v218
    v_xor_b32 v2, 8, v2
    v_mul_u32_u24 v4, 52, v2
    v_lshrrev_b32 v4, 5, v4
    v_and_b32 v4, 24, v4
    v_bfe_u32 v4, s33, v4, 8
    v_add_u32 v4, v4, v2
    v_lshl_add_u32 v219, v4, 4, v5
    v_add_u32 v4, 1, v2
    v_lshrrev_b32 v4, 4, v4
    v_lshl_add_u32 v219, v4, 28, v219
    s_bitcmp1_b32 s2, 0
    s_cselect_b32 s3, 8, 0
    s_add_u32 s32, s32, s3
    s_mul_i32 s50, s32, 80
    s_mul_i32 s3, s30, 61440
    s_add_u32 s50, s50, s3
    s_lshl_b32 s46, s30, 12
    s_add_u32 s46, s46, 24576
    s_mul_i32 s45, s30, 6144
    s_mov_b32 s18, 0x258000
    s_mov_b32 s19, 0x20000
    v_xor_b32 v3, v3, v0
    v_and_b32 v3, 7, v3
    v_bfe_u32 v2, v0, 3, 3
    v_mul_u32_u24 v2, 1280, v2
    v_lshl_add_u32 v216, v3, 4, v2
    v_xor_b32 v217, 64, v216
    s_lshl_b32 s47, s49, 7
    s_mul_i32 s48, s49, 245760
    s_add_u32 s51, s44, s47
    s_add_u32 s48, s48, s50
    s_add_u32 s49, s49, 1
    s_cmp_eq_u32 s49, 10
    s_cselect_b32 s49, 0, s49
    s_waitcnt lgkmcnt(0)
    s_add_u32 m0, s46, 81920
    s_add_u32 s52, s48, 0
    buffer_load_dwordx4 v218, s[16:19], s52 offen lds
    s_add_u32 m0, s45, 81920
    s_max_i32 s52, s51, s47
    buffer_load_dwordx4 v216, s[12:15], s52 offen lds
    s_add_u32 m0, s46, 82944
    s_add_u32 s52, s48, 15360
    buffer_load_dwordx4 v218, s[16:19], s52 offen lds
    s_add_u32 m0, s45, 82944
    s_add_u32 s52, s51, 10240
    s_max_i32 s52, s52, s47
    buffer_load_dwordx4 v217, s[12:15], s52 offen lds
    s_add_u32 m0, s45, 83968
    s_add_u32 s52, s51, 20480
    buffer_load_dwordx4 v216, s[12:15], s52 offen lds
    s_add_u32 m0, s46, 83968
    s_add_u32 s52, s48, 30720
    buffer_load_dwordx4 v219, s[16:19], s52 offen lds
    s_add_u32 m0, s45, 84992
    s_add_u32 s52, s51, 30720
    buffer_load_dwordx4 v217, s[12:15], s52 offen lds
    s_add_u32 m0, s46, 84992
    s_add_u32 s52, s48, 46080
    buffer_load_dwordx4 v219, s[16:19], s52 offen lds
    s_add_u32 m0, s45, 86016
    s_add_u32 s52, s51, 40960
    buffer_load_dwordx4 v216, s[12:15], s52 offen lds
    s_add_u32 m0, s45, 87040
    s_add_u32 s52, s51, 51200
    buffer_load_dwordx4 v217, s[12:15], s52 offen lds
    s_lshl_b32 s47, s49, 7
    s_mul_i32 s48, s49, 245760
    s_add_u32 s51, s44, s47
    s_add_u32 s48, s48, s50
    s_add_u32 s49, s49, 1
    s_cmp_eq_u32 s49, 10
    s_cselect_b32 s49, 0, s49
    s_add_u32 m0, s46, 0
    s_add_u32 s52, s48, 0
    buffer_load_dwordx4 v218, s[16:19], s52 offen lds
    s_add_u32 m0, s45, 0
    s_max_i32 s52, s51, s47
    buffer_load_dwordx4 v216, s[12:15], s52 offen lds
    s_add_u32 m0, s46, 1024
    s_add_u32 s52, s48, 15360
    buffer_load_dwordx4 v218, s[16:19], s52 offen lds
    s_add_u32 m0, s45, 1024
    s_add_u32 s52, s51, 10240
    s_max_i32 s52, s52, s47
    buffer_load_dwordx4 v217, s[12:15], s52 offen lds
    s_add_u32 m0, s45, 2048
    s_add_u32 s52, s51, 20480
    buffer_load_dwordx4 v216, s[12:15], s52 offen lds
    s_add_u32 m0, s46, 2048
    s_add_u32 s52, s48, 30720
    buffer_load_dwordx4 v219, s[16:19], s52 offen lds
    s_mov_b32 s43, s30
    v_and_b32 v1, 63, v0
    v_mov_b32 v7, 0
    s_and_b32 s28, s2, 7
    s_lshr_b32 s29, s2, 3
    s_xor_b32 s30, s30, 4
    s_lshr_b32 s34, s29, 3
    s_lshl_b32 s34, s34, 2
    s_and_b32 s3, s29, 3
    s_add_u32 s34, s34, s3
    s_add_u32 s34, s34, 4
    s_bitcmp1_b32 s29, 2
    s_cselect_b32 s34, -1, s34
    s_cmp_lt_u32 s29, 8
    s_cselect_b32 s34, s29, s34
    s_lshl_b32 s40, s28, 1
    s_cmp_ge_u32 s34, 10
    s_addc_u32 s40, s40, 0
    s_sub_u32 s41, s34, 10
    s_cmp_ge_u32 s34, 10
    s_cselect_b32 s41, s41, s34
    s_mul_i32 s42, s28, 20
    s_add_u32 s42, s42, s34
    s_and_b32 s42, s42, 255
    s_lshl_b32 s42, s42, 9
    s_add_u32 s42, s42, 524288
    s_lshr_b32 s31, s28, 1
    s_lshl_b32 s31, s31, 5
    s_lshr_b32 s3, s29, 3
    s_mul_i32 s3, s3, 11
    s_add_u32 s31, s31, s3
    s_sub_u32 s31, s31, 11
    s_and_b32 s32, s28, 1
    s_lshl_b32 s32, s32, 3
    s_and_b32 s3, s29, 7
    s_lshl_b32 s3, s3, 2
    s_lshr_b32 s3, 0x64317520, s3
    s_and_b32 s3, s3, 7
    s_add_u32 s32, s32, s3
    s_and_b32 s35, s29, 3
    s_and_b32 s3, s29, 4
    s_lshl_b32 s3, s3, 1
    s_add_u32 s35, s35, s3
    s_and_b32 s3, s28, 1
    s_lshl_b32 s3, s3, 2
    s_add_u32 s35, s35, s3
K_LOADER:
    s_mov_b32 s24, s8
    s_mov_b32 s25, s9
    s_mov_b32 s26, 0xc8000
    s_mov_b32 s27, 0x20000
    v_and_b32 v8, 15, v1
    v_lshrrev_b32 v9, 4, v1
    v_bfe_u32 v10, v1, 2, 2
    v_and_b32 v11, 3, v1
    s_add_u32 s20, s6, 0x100000
    s_addc_u32 s21, s7, 0
    s_mov_b32 s22, 0x280000
    s_mov_b32 s23, 0x20000
    s_lshr_b32 s53, s35, 2
    s_add_u32 s3, s53, s35
    s_lshl_b32 s3, s3, 12
    s_mul_i32 s33, s53, 19456
    s_lshl_b32 s53, s35, 8
    s_add_u32 s33, s33, s53
    s_add_u32 s33, s33, 16384
    s_lshr_b32 s53, s31, 5
    s_add_u32 s53, s53, 1
    s_mul_i32 s22, s53, 655360
    s_mov_b32 s53, s31
    s_add_u32 s54, s53, s43
    v_mov_b32 v3, s54
    v_lshrrev_b32 v2, 2, v3
    v_mul_u32_u24 v2, 76, v2
    v_add_lshl_u32 v2, v2, v3, 10
    v_lshl_add_u32 v2, v8, 4, v2
    v_add_u32 v220, s3, v2
    v_lshl_add_u32 v220, v9, 8, v220
    s_lshl_b32 s3, s43, 2
    v_add_u32 v4, s3, v9
    v_add_u32 v3, s53, v4
    v_lshrrev_b32 v2, 2, v3
    v_mul_u32_u24 v2, 76, v2
    v_add_lshl_u32 v2, v2, v3, 10
    v_lshl_add_u32 v2, v8, 4, v2
    v_add_u32 v221, s33, v2
    v_mov_b32 v5, 0x10000000
    v_cmp_gt_u32 vcc, 11, v4
    v_mov_b32 v224, -1
    v_mov_b32 v225, -1
    v_mov_b32 v226, -1
    v_mov_b32 v227, -1
    v_cndmask_b32 v221, v5, v221, vcc
    v_lshrrev_b32 v2, 3, v1
    v_mul_u32_u24 v2, 1280, v2
    v_lshrrev_b32 v3, 2, v1
    v_and_b32 v3, 4, v3
    v_and_b32 v4, 7, v1
    v_xor_b32 v3, v3, v4
    v_lshl_add_u32 v2, v3, 4, v2
    s_lshl_b32 s33, s41, 7
    v_add_u32 v222, s33, v2
    v_lshrrev_b32 v5, 5, v1
    v_mul_u32_u24 v5, 20480, v5
    v_add_u32 v5, v5, v222
    s_mov_b32 s30, s43
    s_waitcnt vmcnt(6)
    s_barrier
    s_add_u32 m0, s45, 3072
    s_add_u32 s52, s51, 30720
    buffer_load_dwordx4 v217, s[12:15], s52 offen lds
    s_add_u32 m0, s46, 3072
    s_add_u32 s52, s48, 46080
    buffer_load_dwordx4 v219, s[16:19], s52 offen lds
    s_add_u32 m0, s45, 4096
    s_add_u32 s52, s51, 40960
    buffer_load_dwordx4 v216, s[12:15], s52 offen lds
    s_add_u32 m0, s45, 5120
    s_add_u32 s52, s51, 51200
    buffer_load_dwordx4 v217, s[12:15], s52 offen lds
    s_lshl_b32 s47, s49, 7
    s_mul_i32 s48, s49, 245760
    s_add_u32 s51, s44, s47
    s_add_u32 s48, s48, s50
    s_add_u32 s49, s49, 1
    s_cmp_eq_u32 s49, 10
    s_cselect_b32 s49, 0, s49
    s_add_u32 m0, s46, 40960
    s_add_u32 s52, s48, 0
    buffer_load_dwordx4 v218, s[16:19], s52 offen lds
    s_add_u32 m0, s45, 40960
    s_max_i32 s52, s51, s47
    buffer_load_dwordx4 v216, s[12:15], s52 offen lds
    s_add_u32 m0, s46, 41984
    s_add_u32 s52, s48, 15360
    buffer_load_dwordx4 v218, s[16:19], s52 offen lds
    s_add_u32 m0, s45, 41984
    s_add_u32 s52, s51, 10240
    s_max_i32 s52, s52, s47
    buffer_load_dwordx4 v217, s[12:15], s52 offen lds
    s_add_u32 m0, s45, 43008
    s_add_u32 s52, s51, 20480
    buffer_load_dwordx4 v216, s[12:15], s52 offen lds
    s_add_u32 m0, s46, 43008
    s_add_u32 s52, s48, 30720
    buffer_load_dwordx4 v219, s[16:19], s52 offen lds
    s_waitcnt vmcnt(6)
    s_barrier
    s_add_u32 m0, s45, 44032
    s_add_u32 s52, s51, 30720
    buffer_load_dwordx4 v217, s[12:15], s52 offen lds
    s_add_u32 m0, s46, 44032
    s_add_u32 s52, s48, 46080
    buffer_load_dwordx4 v219, s[16:19], s52 offen lds
    s_add_u32 m0, s45, 45056
    s_add_u32 s52, s51, 40960
    buffer_load_dwordx4 v216, s[12:15], s52 offen lds
    s_add_u32 m0, s45, 46080
    s_add_u32 s52, s51, 51200
    buffer_load_dwordx4 v217, s[12:15], s52 offen lds
    s_lshl_b32 s47, s49, 7
    s_mul_i32 s48, s49, 245760
    s_add_u32 s51, s44, s47
    s_add_u32 s48, s48, s50
    s_add_u32 s49, s49, 1
    s_cmp_eq_u32 s49, 10
    s_cselect_b32 s49, 0, s49
    s_add_u32 m0, s46, 81920
    s_add_u32 s52, s48, 0
    buffer_load_dwordx4 v218, s[16:19], s52 offen lds
    s_add_u32 m0, s45, 81920
    s_max_i32 s52, s51, s47
    buffer_load_dwordx4 v216, s[12:15], s52 offen lds
    s_add_u32 m0, s46, 82944
    s_add_u32 s52, s48, 15360
    buffer_load_dwordx4 v218, s[16:19], s52 offen lds
    s_add_u32 m0, s45, 82944
    s_add_u32 s52, s51, 10240
    s_max_i32 s52, s52, s47
    buffer_load_dwordx4 v217, s[12:15], s52 offen lds
    s_add_u32 m0, s45, 83968
    s_add_u32 s52, s51, 20480
    buffer_load_dwordx4 v216, s[12:15], s52 offen lds
    s_add_u32 m0, s46, 83968
    s_add_u32 s52, s48, 30720
    buffer_load_dwordx4 v219, s[16:19], s52 offen lds
    s_waitcnt vmcnt(6)
    s_barrier
    s_add_u32 m0, s45, 84992
    s_add_u32 s52, s51, 30720
    buffer_load_dwordx4 v217, s[12:15], s52 offen lds
    s_add_u32 m0, s46, 84992
    s_add_u32 s52, s48, 46080
    buffer_load_dwordx4 v219, s[16:19], s52 offen lds
    s_add_u32 m0, s45, 86016
    s_add_u32 s52, s51, 40960
    buffer_load_dwordx4 v216, s[12:15], s52 offen lds
    s_add_u32 m0, s45, 87040
    s_add_u32 s52, s51, 51200
    buffer_load_dwordx4 v217, s[12:15], s52 offen lds
    s_lshl_b32 s47, s49, 7
    s_mul_i32 s48, s49, 245760
    s_add_u32 s51, s44, s47
    s_add_u32 s48, s48, s50
    s_add_u32 s49, s49, 1
    s_cmp_eq_u32 s49, 10
    s_cselect_b32 s49, 0, s49
    s_add_u32 m0, s46, 0
    s_add_u32 s52, s48, 0
    buffer_load_dwordx4 v218, s[16:19], s52 offen lds
    s_add_u32 m0, s45, 0
    s_max_i32 s52, s51, s47
    buffer_load_dwordx4 v216, s[12:15], s52 offen lds
    s_add_u32 m0, s46, 1024
    s_add_u32 s52, s48, 15360
    buffer_load_dwordx4 v218, s[16:19], s52 offen lds
    s_add_u32 m0, s45, 1024
    s_add_u32 s52, s51, 10240
    s_max_i32 s52, s52, s47
    buffer_load_dwordx4 v217, s[12:15], s52 offen lds
    s_add_u32 m0, s45, 2048
    s_add_u32 s52, s51, 20480
    buffer_load_dwordx4 v216, s[12:15], s52 offen lds
    s_add_u32 m0, s46, 2048
    s_add_u32 s52, s48, 30720
    buffer_load_dwordx4 v219, s[16:19], s52 offen lds
    s_waitcnt vmcnt(6)
    s_barrier
    s_add_u32 m0, s45, 3072
    s_add_u32 s52, s51, 30720
    buffer_load_dwordx4 v217, s[12:15], s52 offen lds
    s_add_u32 m0, s46, 3072
    s_add_u32 s52, s48, 46080
    buffer_load_dwordx4 v219, s[16:19], s52 offen lds
    s_add_u32 m0, s45, 4096
    s_add_u32 s52, s51, 40960
    buffer_load_dwordx4 v216, s[12:15], s52 offen lds
    s_add_u32 m0, s45, 5120
    s_add_u32 s52, s51, 51200
    buffer_load_dwordx4 v217, s[12:15], s52 offen lds
    s_lshl_b32 s47, s49, 7
    s_mul_i32 s48, s49, 245760
    s_add_u32 s51, s44, s47
    s_add_u32 s48, s48, s50
    s_add_u32 s49, s49, 1
    s_cmp_eq_u32 s49, 10
    s_cselect_b32 s49, 0, s49
    s_add_u32 m0, s46, 40960
    s_add_u32 s52, s48, 0
    buffer_load_dwordx4 v218, s[16:19], s52 offen lds
    s_add_u32 m0, s45, 40960
    s_max_i32 s52, s51, s47
    buffer_load_dwordx4 v216, s[12:15], s52 offen lds
    s_add_u32 m0, s46, 41984
    s_add_u32 s52, s48, 15360
    buffer_load_dwordx4 v218, s[16:19], s52 offen lds
    s_add_u32 m0, s45, 41984
    s_add_u32 s52, s51, 10240
    s_max_i32 s52, s52, s47
    buffer_load_dwordx4 v217, s[12:15], s52 offen lds
    s_add_u32 m0, s45, 43008
    s_add_u32 s52, s51, 20480
    buffer_load_dwordx4 v216, s[12:15], s52 offen lds
    s_add_u32 m0, s46, 43008
    s_add_u32 s52, s48, 30720
    buffer_load_dwordx4 v219, s[16:19], s52 offen lds
    s_waitcnt vmcnt(6)
    s_barrier
    s_add_u32 m0, s45, 44032
    s_add_u32 s52, s51, 30720
    buffer_load_dwordx4 v217, s[12:15], s52 offen lds
    s_add_u32 m0, s46, 44032
    s_add_u32 s52, s48, 46080
    buffer_load_dwordx4 v219, s[16:19], s52 offen lds
    s_add_u32 m0, s45, 45056
    s_add_u32 s52, s51, 40960
    buffer_load_dwordx4 v216, s[12:15], s52 offen lds
    s_add_u32 m0, s45, 46080
    s_add_u32 s52, s51, 51200
    buffer_load_dwordx4 v217, s[12:15], s52 offen lds
    s_lshl_b32 s47, s49, 7
    s_mul_i32 s48, s49, 245760
    s_add_u32 s51, s44, s47
    s_add_u32 s48, s48, s50
    s_add_u32 s49, s49, 1
    s_cmp_eq_u32 s49, 10
    s_cselect_b32 s49, 0, s49
    s_add_u32 m0, s46, 81920
    s_add_u32 s52, s48, 0
    buffer_load_dwordx4 v218, s[16:19], s52 offen lds
    s_add_u32 m0, s45, 81920
    s_max_i32 s52, s51, s47
    buffer_load_dwordx4 v216, s[12:15], s52 offen lds
    s_add_u32 m0, s46, 82944
    s_add_u32 s52, s48, 15360
    buffer_load_dwordx4 v218, s[16:19], s52 offen lds
    s_add_u32 m0, s45, 82944
    s_add_u32 s52, s51, 10240
    s_max_i32 s52, s52, s47
    buffer_load_dwordx4 v217, s[12:15], s52 offen lds
    s_add_u32 m0, s45, 83968
    s_add_u32 s52, s51, 20480
    buffer_load_dwordx4 v216, s[12:15], s52 offen lds
    s_add_u32 m0, s46, 83968
    s_add_u32 s52, s48, 30720
    buffer_load_dwordx4 v219, s[16:19], s52 offen lds
    s_waitcnt vmcnt(6)
    s_barrier
    s_add_u32 m0, s45, 84992
    s_add_u32 s52, s51, 30720
    buffer_load_dwordx4 v217, s[12:15], s52 offen lds
    s_add_u32 m0, s46, 84992
    s_add_u32 s52, s48, 46080
    buffer_load_dwordx4 v219, s[16:19], s52 offen lds
    s_add_u32 m0, s45, 86016
    s_add_u32 s52, s51, 40960
    buffer_load_dwordx4 v216, s[12:15], s52 offen lds
    s_add_u32 m0, s45, 87040
    s_add_u32 s52, s51, 51200
    buffer_load_dwordx4 v217, s[12:15], s52 offen lds
    s_lshl_b32 s47, s49, 7
    s_mul_i32 s48, s49, 245760
    s_add_u32 s51, s44, s47
    s_add_u32 s48, s48, s50
    s_add_u32 s49, s49, 1
    s_cmp_eq_u32 s49, 10
    s_cselect_b32 s49, 0, s49
    s_add_u32 m0, s46, 0
    s_add_u32 s52, s48, 0
    buffer_load_dwordx4 v218, s[16:19], s52 offen lds
    s_add_u32 m0, s45, 0
    s_max_i32 s52, s51, s47
    buffer_load_dwordx4 v216, s[12:15], s52 offen lds
    s_add_u32 m0, s46, 1024
    s_add_u32 s52, s48, 15360
    buffer_load_dwordx4 v218, s[16:19], s52 offen lds
    s_add_u32 m0, s45, 1024
    s_add_u32 s52, s51, 10240
    s_max_i32 s52, s52, s47
    buffer_load_dwordx4 v217, s[12:15], s52 offen lds
    s_add_u32 m0, s45, 2048
    s_add_u32 s52, s51, 20480
    buffer_load_dwordx4 v216, s[12:15], s52 offen lds
    s_add_u32 m0, s46, 2048
    s_add_u32 s52, s48, 30720
    buffer_load_dwordx4 v219, s[16:19], s52 offen lds
    s_branch K_PG0
.p2align 12
K_CHM0:
K_STM0:
    s_branch K_WRET_M
    s_nop 0
K_PG0:
    s_waitcnt vmcnt(6)
    s_barrier
    s_add_u32 m0, s45, 3072
    s_add_u32 s52, s51, 30720
    buffer_load_dwordx4 v217, s[12:15], s52 offen lds
    s_add_u32 m0, s46, 3072
    s_add_u32 s52, s48, 46080
    buffer_load_dwordx4 v219, s[16:19], s52 offen lds
    s_add_u32 m0, s45, 4096
    s_add_u32 s52, s51, 40960
    buffer_load_dwordx4 v216, s[12:15], s52 offen lds
    s_add_u32 m0, s45, 5120
    s_add_u32 s52, s51, 51200
    buffer_load_dwordx4 v217, s[12:15], s52 offen lds
    s_lshl_b32 s47, s49, 7
    s_mul_i32 s48, s49, 245760
    s_add_u32 s51, s44, s47
    s_add_u32 s48, s48, s50
    s_add_u32 s49, s49, 1
    s_cmp_eq_u32 s49, 10
    s_cselect_b32 s49, 0, s49
    s_add_u32 m0, s46, 40960
    s_add_u32 s52, s48, 0
    buffer_load_dwordx4 v218, s[16:19], s52 offen lds
    s_add_u32 m0, s45, 40960
    s_max_i32 s52, s51, s47
    buffer_load_dwordx4 v216, s[12:15], s52 offen lds
    s_add_u32 m0, s46, 41984
    s_add_u32 s52, s48, 15360
    buffer_load_dwordx4 v218, s[16:19], s52 offen lds
    s_add_u32 m0, s45, 41984
    s_add_u32 s52, s51, 10240
    s_max_i32 s52, s52, s47
    buffer_load_dwordx4 v217, s[12:15], s52 offen lds
    s_add_u32 m0, s45, 43008
    s_add_u32 s52, s51, 20480
    buffer_load_dwordx4 v216, s[12:15], s52 offen lds
    s_add_u32 m0, s46, 43008
    s_add_u32 s52, s48, 30720
    buffer_load_dwordx4 v219, s[16:19], s52 offen lds
    s_waitcnt vmcnt(6)
    s_barrier
    s_add_u32 m0, s45, 44032
    s_add_u32 s52, s51, 30720
    buffer_load_dwordx4 v217, s[12:15], s52 offen lds
    s_add_u32 m0, s46, 44032
    s_add_u32 s52, s48, 46080
    buffer_load_dwordx4 v219, s[16:19], s52 offen lds
    s_add_u32 m0, s45, 45056
    s_add_u32 s52, s51, 40960
    buffer_load_dwordx4 v216, s[12:15], s52 offen lds
    s_add_u32 m0, s45, 46080
    s_add_u32 s52, s51, 51200
    buffer_load_dwordx4 v217, s[12:15], s52 offen lds
    s_lshl_b32 s47, s49, 7
    s_mul_i32 s48, s49, 245760
    s_add_u32 s51, s44, s47
    s_add_u32 s48, s48, s50
    s_add_u32 s49, s49, 1
    s_cmp_eq_u32 s49, 10
    s_cselect_b32 s49, 0, s49
    s_add_u32 m0, s46, 81920
    s_add_u32 s52, s48, 0
    buffer_load_dwordx4 v218, s[16:19], s52 offen lds
    s_add_u32 m0, s45, 81920
    s_max_i32 s52, s51, s47
    buffer_load_dwordx4 v216, s[12:15], s52 offen lds
    s_add_u32 m0, s46, 82944
    s_add_u32 s52, s48, 15360
    buffer_load_dwordx4 v218, s[16:19], s52 offen lds
    s_add_u32 m0, s45, 82944
    s_add_u32 s52, s51, 10240
    s_max_i32 s52, s52, s47
    buffer_load_dwordx4 v217, s[12:15], s52 offen lds
    s_add_u32 m0, s45, 83968
    s_add_u32 s52, s51, 20480
    buffer_load_dwordx4 v216, s[12:15], s52 offen lds
    s_add_u32 m0, s46, 83968
    s_add_u32 s52, s48, 30720
    buffer_load_dwordx4 v219, s[16:19], s52 offen lds
    s_waitcnt vmcnt(6)
    s_barrier
    s_load_dword s54, s[4:5], 192
    s_add_u32 m0, s45, 84992
    s_add_u32 s52, s51, 30720
    buffer_load_dwordx4 v217, s[12:15], s52 offen lds
    s_add_u32 m0, s46, 84992
    s_add_u32 s52, s48, 46080
    buffer_load_dwordx4 v219, s[16:19], s52 offen lds
    s_add_u32 m0, s45, 86016
    s_add_u32 s52, s51, 40960
    buffer_load_dwordx4 v216, s[12:15], s52 offen lds
    s_add_u32 m0, s45, 87040
    s_add_u32 s52, s51, 51200
    buffer_load_dwordx4 v217, s[12:15], s52 offen lds
    s_waitcnt lgkmcnt(0)
    s_cmp_ge_u32 s54, 8
    s_cbranch_scc1 K_ZO0
    s_mov_b32 s3, 16384
K_ZB0:
    v_mov_b32 v4, 192
    global_load_dword v4, v4, s[4:5] sc1
    s_waitcnt vmcnt(0)
    v_readfirstlane_b32 s33, v4
    s_cmp_ge_u32 s33, 8
    s_cbranch_scc1 K_ZO0
    s_sleep 8
    s_sub_u32 s3, s3, 1
    s_cbranch_scc0 K_ZB0
K_ZO0:
    s_cmp_eq_u32 s34, -1
    s_cbranch_scc1 K_NOLT
    s_lshl_b32 s47, s43, 2
    s_lshr_b32 s47, 0x7520, s47
    s_and_b32 s47, s47, 7
    s_mul_i32 s47, s47, 51200
    s_lshl_b32 s48, s43, 12
    s_add_u32 s3, s47, 0
    s_add_u32 m0, s48, 0
    s_nop 0
    buffer_load_dwordx4 v222, s[24:27], s3 offen lds
    s_add_u32 s3, s47, 10240
    s_add_u32 m0, s48, 1024
    s_nop 0
    buffer_load_dwordx4 v222, s[24:27], s3 offen lds
    s_add_u32 s3, s47, 25600
    s_add_u32 m0, s48, 2048
    s_nop 0
    buffer_load_dwordx4 v222, s[24:27], s3 offen lds
    s_add_u32 s3, s47, 35840
    s_add_u32 m0, s48, 3072
    s_nop 0
    buffer_load_dwordx4 v222, s[24:27], s3 offen lds
    s_add_u32 s3, s47, 409600
    s_add_u32 m0, s48, 20480
    s_nop 0
    buffer_load_dwordx4 v222, s[24:27], s3 offen lds
    s_add_u32 s3, s47, 419840
    s_add_u32 m0, s48, 21504
    s_nop 0
    buffer_load_dwordx4 v222, s[24:27], s3 offen lds
    s_add_u32 s3, s47, 435200
    s_add_u32 m0, s48, 22528
    s_nop 0
    buffer_load_dwordx4 v222, s[24:27], s3 offen lds
    s_add_u32 s3, s47, 445440
    s_add_u32 m0, s48, 23552
    s_nop 0
    buffer_load_dwordx4 v222, s[24:27], s3 offen lds
    s_lshl_b32 s48, s43, 10
    s_add_u32 s3, s47, 20480
    s_add_u32 m0, s48, 16384
    s_nop 0
    buffer_load_dwordx4 v5, s[24:27], s3 offen lds
    s_add_u32 s3, s47, 430080
    s_add_u32 m0, s48, 36864
    s_nop 0
    buffer_load_dwordx4 v5, s[24:27], s3 offen lds
    s_waitcnt vmcnt(10)
    s_barrier
    s_mov_b32 s33, 81920
    s_cmp_eq_u32 s43, 3
    s_cselect_b32 s3, 0, 163840
    buffer_store_dwordx4 v[224:227], v220, s[20:23], 0 offen sc1
    buffer_store_dwordx4 v[224:227], v220, s[20:23], s33 offen sc1
    buffer_store_dwordx4 v[224:227], v220, s[20:23], s3 offen sc1
    buffer_store_dwordx4 v[224:227], v221, s[20:23], 0 offen sc1
    v_mov_b32 v2, 158720
    v_mov_b32 v3, 1
    s_waitcnt vmcnt(0)
    s_mov_b64 exec, 1
    ds_add_u32 v2, v3 offset:28
    ds_add_u32 v2, v3 offset:32
    s_mov_b64 exec, -1
    s_lshl_b32 s47, s43, 2
    s_lshr_b32 s47, 0x6431, s47
    s_and_b32 s47, s47, 7
    s_mul_i32 s47, s47, 51200
    s_lshl_b32 s48, s43, 12
    s_add_u32 s3, s47, 0
    s_add_u32 m0, s48, 40960
    s_nop 0
    buffer_load_dwordx4 v222, s[24:27], s3 offen lds
    s_add_u32 s3, s47, 10240
    s_add_u32 m0, s48, 41984
    s_nop 0
    buffer_load_dwordx4 v222, s[24:27], s3 offen lds
    s_add_u32 s3, s47, 25600
    s_add_u32 m0, s48, 43008
    s_nop 0
    buffer_load_dwordx4 v222, s[24:27], s3 offen lds
    s_add_u32 s3, s47, 35840
    s_add_u32 m0, s48, 44032
    s_nop 0
    buffer_load_dwordx4 v222, s[24:27], s3 offen lds
    s_add_u32 s3, s47, 409600
    s_add_u32 m0, s48, 61440
    s_nop 0
    buffer_load_dwordx4 v222, s[24:27], s3 offen lds
    s_add_u32 s3, s47, 419840
    s_add_u32 m0, s48, 62464
    s_nop 0
    buffer_load_dwordx4 v222, s[24:27], s3 offen lds
    s_add_u32 s3, s47, 435200
    s_add_u32 m0, s48, 63488
    s_nop 0
    buffer_load_dwordx4 v222, s[24:27], s3 offen lds
    s_add_u32 s3, s47, 445440
    s_add_u32 m0, s48, 64512
    s_nop 0
    buffer_load_dwordx4 v222, s[24:27], s3 offen lds
    s_lshl_b32 s48, s43, 10
    s_add_u32 s3, s47, 20480
    s_add_u32 m0, s48, 57344
    s_nop 0
    buffer_load_dwordx4 v5, s[24:27], s3 offen lds
    s_add_u32 s3, s47, 430080
    s_add_u32 m0, s48, 77824
    s_nop 0
    buffer_load_dwordx4 v5, s[24:27], s3 offen lds
    s_branch K_P2_GM
K_NOLT:
    s_waitcnt vmcnt(0)
    s_barrier
    s_mov_b32 s33, 81920
    s_cmp_eq_u32 s43, 3
    s_cselect_b32 s3, 0, 163840
    buffer_store_dwordx4 v[224:227], v220, s[20:23], 0 offen sc1
    buffer_store_dwordx4 v[224:227], v220, s[20:23], s33 offen sc1
    buffer_store_dwordx4 v[224:227], v220, s[20:23], s3 offen sc1
    buffer_store_dwordx4 v[224:227], v221, s[20:23], 0 offen sc1
    v_mov_b32 v2, 158720
    v_mov_b32 v3, 1
    s_waitcnt vmcnt(0)
    s_mov_b64 exec, 1
    ds_add_u32 v2, v3 offset:28
    ds_add_u32 v2, v3 offset:32
    s_mov_b64 exec, -1
    s_branch K_END
K_CONS:
    v_and_b32 v1, 63, v0
    v_and_b32 v8, 15, v1
    v_lshrrev_b32 v9, 4, v1
    v_bfe_u32 v10, v1, 2, 2
    v_and_b32 v11, 3, v1
    s_bfe_u32 s54, s30, 0x10001
    s_and_b32 s55, s30, 1
    v_lshrrev_b32 v2, 1, v8
    v_xor_b32 v2, v2, v9
    v_lshlrev_b32 v2, 4, v2
    v_lshl_add_u32 v2, v8, 7, v2
    s_mul_i32 s3, s54, 12288
    v_add_u32 v39, s3, v2
    v_xor_b32 v40, 64, v39
    v_add_u32 v41, 81920, v39
    v_add_u32 v42, 81920, v40
    v_and_b32 v2, 1, v9
    v_lshl_or_b32 v2, v2, 2, v10
    s_mul_i32 s3, s55, 40
    v_lshl_add_u32 v2, v2, 5, s3
    v_lshl_add_u32 v3, v9, 3, v10
    v_lshlrev_b32 v3, 8, v3
    v_add_u32 v3, 24576, v3
    v_lshl_add_u32 v5, v11, 3, v2
    s_mul_i32 s33, s55, 805306368
    s_sub_u32 s33, 0xf870c020, s33
    v_add_u32 v4, 0, v5
    v_and_b32 v4, 255, v4
    v_add_u32 v43, v4, v3
    v_add_u32 v47, 81920, v43
    v_add_u32 v4, 160, v5
    v_and_b32 v4, 255, v4
    v_add_u32 v44, v4, v3
    v_add_u32 v48, 81920, v44
    v_add_u32 v4, 80, v5
    v_and_b32 v4, 255, v4
    v_add_u32 v45, v4, v3
    v_add_u32 v49, 81920, v45
    v_lshlrev_b32 v4, 3, v11
    v_bfe_u32 v4, s33, v4, 8
    v_add_u32 v4, v4, v2
    v_and_b32 v4, 255, v4
    v_add_u32 v46, v4, v3
    v_add_u32 v50, 81920, v46
    v_and_b32 v1, 63, v0
    v_mov_b32 v7, 0
    s_and_b32 s28, s2, 7
    s_lshr_b32 s29, s2, 3
    s_xor_b32 s30, s30, 4
    s_lshr_b32 s34, s29, 3
    s_lshl_b32 s34, s34, 2
    s_and_b32 s3, s29, 3
    s_add_u32 s34, s34, s3
    s_add_u32 s34, s34, 4
    s_bitcmp1_b32 s29, 2
    s_cselect_b32 s34, -1, s34
    s_cmp_lt_u32 s29, 8
    s_cselect_b32 s34, s29, s34
    s_lshl_b32 s40, s28, 1
    s_cmp_ge_u32 s34, 10
    s_addc_u32 s40, s40, 0
    s_sub_u32 s41, s34, 10
    s_cmp_ge_u32 s34, 10
    s_cselect_b32 s41, s41, s34
    s_mul_i32 s42, s28, 20
    s_add_u32 s42, s42, s34
    s_and_b32 s42, s42, 255
    s_lshl_b32 s42, s42, 9
    s_add_u32 s42, s42, 524288
    v_mov_b32 v3, 158736
    ds_write2_b32 v3, v7, v7 offset0:0 offset1:1
    ds_write2_b32 v3, v7, v7 offset0:2 offset1:3
    ds_write2_b32 v3, v7, v7 offset0:4 offset1:5
    ds_write2_b32 v3, v7, v7 offset0:6 offset1:7
    ds_write2_b32 v3, v7, v7 offset0:8 offset1:9
    ds_write2_b32 v3, v7, v7 offset0:10 offset1:11
    s_lshr_b32 s31, s28, 1
    s_lshl_b32 s31, s31, 5
    s_lshr_b32 s3, s29, 3
    s_mul_i32 s3, s3, 11
    s_add_u32 s31, s31, s3
    s_sub_u32 s31, s31, 11
    s_and_b32 s32, s28, 1
    s_lshl_b32 s32, s32, 3
    s_and_b32 s3, s29, 7
    s_lshl_b32 s3, s3, 2
    s_lshr_b32 s3, 0x64317520, s3
    s_and_b32 s3, s3, 7
    s_add_u32 s32, s32, s3
    s_and_b32 s35, s29, 3
    s_and_b32 s3, s29, 4
    s_lshl_b32 s3, s3, 1
    s_add_u32 s35, s35, s3
    s_and_b32 s3, s28, 1
    s_lshl_b32 s3, s3, 2
    s_add_u32 s35, s35, s3
    s_or_b32 s56, s31, s54
    v_mov_b32 v37, 0xf149f2ca
    v_lshlrev_b32 v2, 2, v9
    v_sub_u32 v2, v8, v2
    s_cmp_eq_u32 s56, 0
    s_cselect_b32 s3, 0xf149f2ca, 0
    v_subrev_u32 v3, 0, v2
    v_and_b32 v4, 0x80000001, v3
    v_cmp_eq_u32 vcc, 0, v4
    s_nop 1
    v_cndmask_b32 v16, v37, 0, vcc
    v_cmp_eq_u32 vcc, 0x80000000, v4
    s_nop 1
    v_cndmask_b32 v12, v37, 0, vcc
    v_add_f32 v20, s3, v12
    v_subrev_u32 v3, 1, v2
    v_and_b32 v4, 0x80000001, v3
    v_cmp_eq_u32 vcc, 0, v4
    s_nop 1
    v_cndmask_b32 v17, v37, 0, vcc
    v_cmp_eq_u32 vcc, 0x80000000, v4
    s_nop 1
    v_cndmask_b32 v13, v37, 0, vcc
    v_add_f32 v21, s3, v13
    v_subrev_u32 v3, 2, v2
    v_and_b32 v4, 0x80000001, v3
    v_cmp_eq_u32 vcc, 0, v4
    s_nop 1
    v_cndmask_b32 v18, v37, 0, vcc
    v_cmp_eq_u32 vcc, 0x80000000, v4
    s_nop 1
    v_cndmask_b32 v14, v37, 0, vcc
    v_add_f32 v22, s3, v14
    v_subrev_u32 v3, 3, v2
    v_and_b32 v4, 0x80000001, v3
    v_cmp_eq_u32 vcc, 0, v4
    s_nop 1
    v_cndmask_b32 v19, v37, 0, vcc
    v_cmp_eq_u32 vcc, 0x80000000, v4
    s_nop 1
    v_cndmask_b32 v15, v37, 0, vcc
    v_add_f32 v23, s3, v15
    v_mov_b32 v3, 0x0c0c0c0c
    v_mov_b32 v4, 0xc0c0100
    v_cmp_eq_u32 vcc, 0, v12
    v_mov_b32 v5, 0x1000c0c
    s_nop 0
    v_cndmask_b32 v3, v3, v4, vcc
    v_cmp_eq_u32 vcc, 0, v13
    s_nop 1
    v_cndmask_b32 v24, v3, v5, vcc
    v_mov_b32 v3, 0x0c0c0c0c
    v_mov_b32 v4, 0xc0c0302
    v_cmp_eq_u32 vcc, 0, v14
    v_mov_b32 v5, 0x3020c0c
    s_nop 0
    v_cndmask_b32 v3, v3, v4, vcc
    v_cmp_eq_u32 vcc, 0, v15
    s_nop 1
    v_cndmask_b32 v25, v3, v5, vcc
    v_mov_b32 v3, 0x0c0c0c0c
    v_mov_b32 v4, 0xc0c0100
    v_cmp_eq_u32 vcc, 0, v16
    v_mov_b32 v5, 0x1000c0c
    s_nop 0
    v_cndmask_b32 v3, v3, v4, vcc
    v_cmp_eq_u32 vcc, 0, v17
    s_nop 1
    v_cndmask_b32 v26, v3, v5, vcc
    v_mov_b32 v3, 0x0c0c0c0c
    v_mov_b32 v4, 0xc0c0302
    v_cmp_eq_u32 vcc, 0, v18
    v_mov_b32 v5, 0x3020c0c
    s_nop 0
    v_cndmask_b32 v3, v3, v4, vcc
    v_cmp_eq_u32 vcc, 0, v19
    s_nop 1
    v_cndmask_b32 v27, v3, v5, vcc
    s_mul_i32 s3, s55, 1664
    s_mul_i32 s33, s54, 768
    s_add_u32 s3, s3, s33
    s_add_u32 s3, s3, 125952
    v_lshl_add_u32 v2, v9, 2, v10
    v_lshl_add_u32 v33, v2, 3, s3
    v_lshl_add_u32 v2, v8, 3, s3
    v_lshlrev_b32 v3, 3, v1
    v_add_u32 v3, 129280, v3
    v_cmp_eq_u32 vcc, 2, v9
    s_mul_i32 s3, s55, 1536
    s_add_u32 s3, s3, 122880
    v_cndmask_b32 v32, v3, v2, vcc
    v_lshl_add_u32 v34, v1, 3, s3
    s_mul_i32 s3, s54, 1536
    s_add_u32 s3, s3, 131328
    s_lshl3_add_u32 s33, s55, s3
    v_lshl_add_u32 v35, v8, 4, s33
    v_lshl_add_u32 v35, v9, 8, v35
    s_mul_i32 s33, s55, 768
    s_add_u32 s3, s3, s33
    v_lshl_add_u32 v36, v1, 4, s3
    v_mov_b32 v38, 158720
    s_waitcnt lgkmcnt(0)
    s_add_u32 s20, s6, 0x100000
    s_addc_u32 s21, s7, 0
    s_mov_b32 s22, 0x280000
    s_mov_b32 s23, 0x20000
    s_lshr_b32 s53, s35, 2
    s_add_u32 s58, s53, s35
    s_lshl_b32 s58, s58, 12
    s_mul_i32 s59, s53, 19456
    s_lshl_b32 s53, s35, 8
    s_add_u32 s59, s59, s53
    s_add_u32 s59, s59, 16384
    s_lshr_b32 s53, s31, 5
    s_add_u32 s53, s53, 1
    s_mul_i32 s22, s53, 655360
    s_mov_b32 s53, s31
    s_mul_i32 s3, s54, 6
    s_add_u32 s53, s53, s3
    s_add_u32 s53, s53, 3
    s_lshl_b32 s3, s55, 9
    s_add_u32 s58, s58, s3
    v_and_b32 v4, 1, v9
    v_lshrrev_b32 v5, 1, v9
    v_add_u32 v3, s53, v4
    v_lshrrev_b32 v2, 2, v3
    v_mul_u32_u24 v2, 76, v2
    v_add_lshl_u32 v2, v2, v3, 10
    v_lshl_add_u32 v2, v8, 4, v2
    v_add_u32 v30, s58, v2
    v_lshl_add_u32 v30, v5, 8, v30
    v_subrev_u32 v3, 2, v3
    v_lshrrev_b32 v2, 2, v3
    v_mul_u32_u24 v2, 76, v2
    v_add_lshl_u32 v2, v2, v3, 10
    v_lshl_add_u32 v2, v8, 4, v2
    v_add_u32 v29, s58, v2
    v_lshl_add_u32 v29, v5, 8, v29
    v_or_b32 v4, s54, v4
    v_cmp_eq_u32 vcc, 0, v4
    v_mov_b32 v5, 0x10000000
    v_subrev_u32 v28, 81920, v30
    v_cndmask_b32 v28, v28, v5, vcc
    s_mul_i32 s3, s55, 3
    s_add_u32 s53, s53, s3
    v_add_u32 v3, s53, v9
    v_lshrrev_b32 v2, 2, v3
    v_mul_u32_u24 v2, 76, v2
    v_add_lshl_u32 v2, v2, v3, 10
    v_lshl_add_u32 v2, v8, 4, v2
    v_add_u32 v31, s59, v2
    v_subrev_u32 v31, 81920, v31
    v_or_b32 v4, s30, v9
    v_cmp_eq_u32 vcc, 0, v4
    s_nop 1
    v_cndmask_b32 v31, v31, v5, vcc
    v_cmp_eq_u32 vcc, 3, v9
    s_nop 1
    v_cndmask_b32 v31, v31, v5, vcc
    s_lshr_b32 s3, s31, 3
    s_mul_i32 s3, s3, 5120
    s_add_u32 s3, s3, 524288
    s_and_b32 s33, s31, 31
    s_cselect_b32 s33, 4, 0
    v_mov_b32 v2, s33
    v_cmp_gt_u32 vcc, 10, v1
    v_lshl_add_u32 v37, v1, 9, s3
    s_mov_b32 s37, 0xfffff
    v_cndmask_b32 v2, 0, v2, vcc
    v_add_u32 v37, v37, v2
    s_lshr_b32 s36, s35, 2
    s_add_u32 s36, s36, s35
    s_lshl_b32 s36, 1, s36
    s_cmp_eq_u32 s30, 0
    s_cselect_b32 s36, s36, 0
    s_mov_b32 s62, 1811939332
    s_cmp_ge_u32 s36, 0x400
    s_cselect_b32 s62, -1, s62
    s_and_b32 s3, s36, 0x3ff
    s_cselect_b32 s63, -1, 2
    s_mov_b32 s58, 0x3fb8aa3b
    s_mov_b32 s59, s58
    s_mov_b32 s60, 0x3e64f92e
    s_mov_b32 s61, s60
    s_cmp_eq_u32 s30, 0
    s_cbranch_scc1 K_CHM0
    s_cmp_eq_u32 s30, 1
    s_cbranch_scc1 K_CHM1
    s_cmp_eq_u32 s30, 2
    s_cbranch_scc1 K_CHM2
    s_branch K_CHM3
K_WRET_M:
    s_setprio 2
    s_barrier
K_L0:
    ds_read_b64_tr_b16 v[196:197], v47 offset:0
    ds_read_b64_tr_b16 v[198:199], v47 offset:1024
    ds_read_b128 v[148:151], v41 offset:0
    ds_read_b64_tr_b16 v[200:201], v48 offset:0
    ds_read_b64_tr_b16 v[202:203], v48 offset:1024
    ds_read_b128 v[152:155], v41 offset:2048
    ds_read_b64_tr_b16 v[204:205], v49 offset:0
    ds_read_b64_tr_b16 v[206:207], v49 offset:1024
    ds_read_b128 v[156:159], v41 offset:4096
    ds_read_b64_tr_b16 v[208:209], v50 offset:0
    ds_read_b64_tr_b16 v[210:211], v50 offset:1024
    ds_read_b128 v[160:163], v41 offset:6144
    ds_read_b128 v[164:167], v41 offset:8192
    ds_read_b128 v[168:171], v41 offset:10240
    s_waitcnt lgkmcnt(0)
    v_mfma_f32_16x16x32_bf16 v[52:55], v[196:199], v[148:151], 0
    ds_read_b64_tr_b16 v[212:213], v47 offset:8192
    v_mfma_f32_16x16x32_bf16 v[56:59], v[200:203], v[148:151], 0
    ds_read_b64_tr_b16 v[214:215], v47 offset:9216
    v_mfma_f32_16x16x32_bf16 v[60:63], v[148:151], v[204:207], 0
    ds_read_b128 v[172:175], v42 offset:0
    v_mfma_f32_16x16x32_bf16 v[64:67], v[208:211], v[148:151], 0
    ds_read_b64_tr_b16 v[216:217], v48 offset:8192
    v_mfma_f32_16x16x32_bf16 v[80:83], v[208:211], v[152:155], 0
    ds_read_b64_tr_b16 v[218:219], v48 offset:9216
    v_mfma_f32_16x16x32_bf16 v[76:79], v[152:155], v[204:207], 0
    ds_read_b128 v[176:179], v42 offset:2048
    v_mfma_f32_16x16x32_bf16 v[72:75], v[200:203], v[152:155], 0
    ds_read_b64_tr_b16 v[220:221], v49 offset:8192
    v_mfma_f32_16x16x32_bf16 v[68:71], v[196:199], v[152:155], 0
    ds_read_b64_tr_b16 v[222:223], v49 offset:9216
    v_mfma_f32_16x16x32_bf16 v[84:87], v[196:199], v[156:159], 0
    ds_read_b128 v[180:183], v42 offset:4096
    v_mfma_f32_16x16x32_bf16 v[88:91], v[200:203], v[156:159], 0
    ds_read_b64_tr_b16 v[224:225], v50 offset:8192
    v_mfma_f32_16x16x32_bf16 v[92:95], v[156:159], v[204:207], 0
    ds_read_b64_tr_b16 v[226:227], v50 offset:9216
    v_mfma_f32_16x16x32_bf16 v[96:99], v[208:211], v[156:159], 0
    ds_read_b128 v[184:187], v42 offset:6144
    v_mfma_f32_16x16x32_bf16 v[112:115], v[208:211], v[160:163], 0
    ds_read_b128 v[188:191], v42 offset:8192
    v_mfma_f32_16x16x32_bf16 v[108:111], v[160:163], v[204:207], 0
    ds_read_b128 v[192:195], v42 offset:10240
    v_mfma_f32_16x16x32_bf16 v[104:107], v[200:203], v[160:163], 0
    v_mfma_f32_16x16x32_bf16 v[100:103], v[196:199], v[160:163], 0
    v_mfma_f32_16x16x32_bf16 v[116:119], v[196:199], v[164:167], 0
    v_mfma_f32_16x16x32_bf16 v[120:123], v[200:203], v[164:167], 0
    v_mfma_f32_16x16x32_bf16 v[124:127], v[164:167], v[204:207], 0
    v_mfma_f32_16x16x32_bf16 v[128:131], v[208:211], v[164:167], 0
    v_mfma_f32_16x16x32_bf16 v[144:147], v[208:211], v[168:171], 0
    v_mfma_f32_16x16x32_bf16 v[140:143], v[168:171], v[204:207], 0
    v_mfma_f32_16x16x32_bf16 v[136:139], v[200:203], v[168:171], 0
    v_mfma_f32_16x16x32_bf16 v[132:135], v[196:199], v[168:171], 0
    s_waitcnt lgkmcnt(0)
    s_barrier
    v_mfma_f32_16x16x32_bf16 v[52:55], v[212:215], v[172:175], v[52:55]
    ds_read_b64_tr_b16 v[196:197], v43 offset:0
    v_mfma_f32_16x16x32_bf16 v[56:59], v[216:219], v[172:175], v[56:59]
    ds_read_b64_tr_b16 v[198:199], v43 offset:1024
    v_mfma_f32_16x16x32_bf16 v[60:63], v[172:175], v[220:223], v[60:63]
    ds_read_b128 v[148:151], v39 offset:0
    v_mfma_f32_16x16x32_bf16 v[64:67], v[224:227], v[172:175], v[64:67]
    ds_read_b64_tr_b16 v[200:201], v44 offset:0
    v_mfma_f32_16x16x32_bf16 v[80:83], v[224:227], v[176:179], v[80:83]
    ds_read_b64_tr_b16 v[202:203], v44 offset:1024
    v_mfma_f32_16x16x32_bf16 v[76:79], v[176:179], v[220:223], v[76:79]
    ds_read_b128 v[152:155], v39 offset:2048
    v_mfma_f32_16x16x32_bf16 v[72:75], v[216:219], v[176:179], v[72:75]
    ds_read_b64_tr_b16 v[204:205], v45 offset:0
    v_mfma_f32_16x16x32_bf16 v[68:71], v[212:215], v[176:179], v[68:71]
    ds_read_b64_tr_b16 v[206:207], v45 offset:1024
    v_mfma_f32_16x16x32_bf16 v[84:87], v[212:215], v[180:183], v[84:87]
    ds_read_b128 v[156:159], v39 offset:4096
    v_mfma_f32_16x16x32_bf16 v[88:91], v[216:219], v[180:183], v[88:91]
    ds_read_b64_tr_b16 v[208:209], v46 offset:0
    v_mfma_f32_16x16x32_bf16 v[92:95], v[180:183], v[220:223], v[92:95]
    ds_read_b64_tr_b16 v[210:211], v46 offset:1024
    v_mfma_f32_16x16x32_bf16 v[96:99], v[224:227], v[180:183], v[96:99]
    ds_read_b128 v[160:163], v39 offset:6144
    v_mfma_f32_16x16x32_bf16 v[112:115], v[224:227], v[184:187], v[112:115]
    ds_read_b128 v[164:167], v39 offset:8192
    v_mfma_f32_16x16x32_bf16 v[108:111], v[184:187], v[220:223], v[108:111]
    ds_read_b128 v[168:171], v39 offset:10240
    v_mfma_f32_16x16x32_bf16 v[104:107], v[216:219], v[184:187], v[104:107]
    v_mfma_f32_16x16x32_bf16 v[100:103], v[212:215], v[184:187], v[100:103]
    v_mfma_f32_16x16x32_bf16 v[116:119], v[212:215], v[188:191], v[116:119]
    v_mfma_f32_16x16x32_bf16 v[120:123], v[216:219], v[188:191], v[120:123]
    v_mfma_f32_16x16x32_bf16 v[124:127], v[188:191], v[220:223], v[124:127]
    v_mfma_f32_16x16x32_bf16 v[128:131], v[224:227], v[188:191], v[128:131]
    v_mfma_f32_16x16x32_bf16 v[144:147], v[224:227], v[192:195], v[144:147]
    v_mfma_f32_16x16x32_bf16 v[140:143], v[192:195], v[220:223], v[140:143]
    v_mfma_f32_16x16x32_bf16 v[136:139], v[216:219], v[192:195], v[136:139]
    v_mfma_f32_16x16x32_bf16 v[132:135], v[212:215], v[192:195], v[132:135]
    s_waitcnt lgkmcnt(0)
    v_mfma_f32_16x16x32_bf16 v[52:55], v[196:199], v[148:151], v[52:55]
    ds_read_b64_tr_b16 v[212:213], v43 offset:8192
    v_mfma_f32_16x16x32_bf16 v[56:59], v[200:203], v[148:151], v[56:59]
    ds_read_b64_tr_b16 v[214:215], v43 offset:9216
    v_mfma_f32_16x16x32_bf16 v[60:63], v[148:151], v[204:207], v[60:63]
    ds_read_b128 v[172:175], v40 offset:0
    v_mfma_f32_16x16x32_bf16 v[64:67], v[208:211], v[148:151], v[64:67]
    ds_read_b64_tr_b16 v[216:217], v44 offset:8192
    v_mfma_f32_16x16x32_bf16 v[80:83], v[208:211], v[152:155], v[80:83]
    ds_read_b64_tr_b16 v[218:219], v44 offset:9216
    v_mfma_f32_16x16x32_bf16 v[76:79], v[152:155], v[204:207], v[76:79]
    ds_read_b128 v[176:179], v40 offset:2048
    v_mfma_f32_16x16x32_bf16 v[72:75], v[200:203], v[152:155], v[72:75]
    ds_read_b64_tr_b16 v[220:221], v45 offset:8192
    v_mfma_f32_16x16x32_bf16 v[68:71], v[196:199], v[152:155], v[68:71]
    ds_read_b64_tr_b16 v[222:223], v45 offset:9216
    v_mfma_f32_16x16x32_bf16 v[84:87], v[196:199], v[156:159], v[84:87]
    ds_read_b128 v[180:183], v40 offset:4096
    v_mfma_f32_16x16x32_bf16 v[88:91], v[200:203], v[156:159], v[88:91]
    ds_read_b64_tr_b16 v[224:225], v46 offset:8192
    v_mfma_f32_16x16x32_bf16 v[92:95], v[156:159], v[204:207], v[92:95]
    ds_read_b64_tr_b16 v[226:227], v46 offset:9216
    v_mfma_f32_16x16x32_bf16 v[96:99], v[208:211], v[156:159], v[96:99]
    ds_read_b128 v[184:187], v40 offset:6144
    s_branch K_PG1
.p2align 12
K_CHM1:
K_STM1:
    s_branch K_WRET_M
    s_nop 0
K_PG1:
    v_mfma_f32_16x16x32_bf16 v[112:115], v[208:211], v[160:163], v[112:115]
    ds_read_b128 v[188:191], v40 offset:8192
    v_mfma_f32_16x16x32_bf16 v[108:111], v[160:163], v[204:207], v[108:111]
    ds_read_b128 v[192:195], v40 offset:10240
    v_mfma_f32_16x16x32_bf16 v[104:107], v[200:203], v[160:163], v[104:107]
    v_mfma_f32_16x16x32_bf16 v[100:103], v[196:199], v[160:163], v[100:103]
    v_mfma_f32_16x16x32_bf16 v[116:119], v[196:199], v[164:167], v[116:119]
    v_mfma_f32_16x16x32_bf16 v[120:123], v[200:203], v[164:167], v[120:123]
    v_mfma_f32_16x16x32_bf16 v[124:127], v[164:167], v[204:207], v[124:127]
    v_mfma_f32_16x16x32_bf16 v[128:131], v[208:211], v[164:167], v[128:131]
    v_mfma_f32_16x16x32_bf16 v[144:147], v[208:211], v[168:171], v[144:147]
    v_mfma_f32_16x16x32_bf16 v[140:143], v[168:171], v[204:207], v[140:143]
    v_mfma_f32_16x16x32_bf16 v[136:139], v[200:203], v[168:171], v[136:139]
    v_mfma_f32_16x16x32_bf16 v[132:135], v[196:199], v[168:171], v[132:135]
    s_waitcnt lgkmcnt(0)
    s_barrier
    v_mfma_f32_16x16x32_bf16 v[52:55], v[212:215], v[172:175], v[52:55]
    ds_read_b64_tr_b16 v[196:197], v43 offset:40960
    v_mfma_f32_16x16x32_bf16 v[56:59], v[216:219], v[172:175], v[56:59]
    ds_read_b64_tr_b16 v[198:199], v43 offset:41984
    v_mfma_f32_16x16x32_bf16 v[60:63], v[172:175], v[220:223], v[60:63]
    ds_read_b128 v[148:151], v39 offset:40960
    v_mfma_f32_16x16x32_bf16 v[64:67], v[224:227], v[172:175], v[64:67]
    ds_read_b64_tr_b16 v[200:201], v44 offset:40960
    v_mfma_f32_16x16x32_bf16 v[80:83], v[224:227], v[176:179], v[80:83]
    ds_read_b64_tr_b16 v[202:203], v44 offset:41984
    v_mfma_f32_16x16x32_bf16 v[76:79], v[176:179], v[220:223], v[76:79]
    ds_read_b128 v[152:155], v39 offset:43008
    v_mfma_f32_16x16x32_bf16 v[72:75], v[216:219], v[176:179], v[72:75]
    ds_read_b64_tr_b16 v[204:205], v45 offset:40960
    v_mfma_f32_16x16x32_bf16 v[68:71], v[212:215], v[176:179], v[68:71]
    ds_read_b64_tr_b16 v[206:207], v45 offset:41984
    v_mfma_f32_16x16x32_bf16 v[84:87], v[212:215], v[180:183], v[84:87]
    ds_read_b128 v[156:159], v39 offset:45056
    v_mfma_f32_16x16x32_bf16 v[88:91], v[216:219], v[180:183], v[88:91]
    ds_read_b64_tr_b16 v[208:209], v46 offset:40960
    v_mfma_f32_16x16x32_bf16 v[92:95], v[180:183], v[220:223], v[92:95]
    ds_read_b64_tr_b16 v[210:211], v46 offset:41984
    v_mfma_f32_16x16x32_bf16 v[96:99], v[224:227], v[180:183], v[96:99]
    ds_read_b128 v[160:163], v39 offset:47104
    v_mfma_f32_16x16x32_bf16 v[112:115], v[224:227], v[184:187], v[112:115]
    ds_read_b128 v[164:167], v39 offset:49152
    v_mfma_f32_16x16x32_bf16 v[108:111], v[184:187], v[220:223], v[108:111]
    ds_read_b128 v[168:171], v39 offset:51200
    v_mfma_f32_16x16x32_bf16 v[104:107], v[216:219], v[184:187], v[104:107]
    v_mfma_f32_16x16x32_bf16 v[100:103], v[212:215], v[184:187], v[100:103]
    v_mfma_f32_16x16x32_bf16 v[116:119], v[212:215], v[188:191], v[116:119]
    v_mfma_f32_16x16x32_bf16 v[120:123], v[216:219], v[188:191], v[120:123]
    v_mfma_f32_16x16x32_bf16 v[124:127], v[188:191], v[220:223], v[124:127]
    v_mfma_f32_16x16x32_bf16 v[128:131], v[224:227], v[188:191], v[128:131]
    v_mfma_f32_16x16x32_bf16 v[144:147], v[224:227], v[192:195], v[144:147]
    v_mfma_f32_16x16x32_bf16 v[140:143], v[192:195], v[220:223], v[140:143]
    v_mfma_f32_16x16x32_bf16 v[136:139], v[216:219], v[192:195], v[136:139]
    v_mfma_f32_16x16x32_bf16 v[132:135], v[212:215], v[192:195], v[132:135]
    s_waitcnt lgkmcnt(0)
    v_mfma_f32_16x16x32_bf16 v[52:55], v[196:199], v[148:151], v[52:55]
    ds_read_b64_tr_b16 v[212:213], v43 offset:49152
    v_mfma_f32_16x16x32_bf16 v[56:59], v[200:203], v[148:151], v[56:59]
    ds_read_b64_tr_b16 v[214:215], v43 offset:50176
    v_mfma_f32_16x16x32_bf16 v[60:63], v[148:151], v[204:207], v[60:63]
    ds_read_b128 v[172:175], v40 offset:40960
    v_mfma_f32_16x16x32_bf16 v[64:67], v[208:211], v[148:151], v[64:67]
    ds_read_b64_tr_b16 v[216:217], v44 offset:49152
    v_mfma_f32_16x16x32_bf16 v[80:83], v[208:211], v[152:155], v[80:83]
    ds_read_b64_tr_b16 v[218:219], v44 offset:50176
    v_mfma_f32_16x16x32_bf16 v[76:79], v[152:155], v[204:207], v[76:79]
    ds_read_b128 v[176:179], v40 offset:43008
    v_mfma_f32_16x16x32_bf16 v[72:75], v[200:203], v[152:155], v[72:75]
    ds_read_b64_tr_b16 v[220:221], v45 offset:49152
    v_mfma_f32_16x16x32_bf16 v[68:71], v[196:199], v[152:155], v[68:71]
    ds_read_b64_tr_b16 v[222:223], v45 offset:50176
    v_mfma_f32_16x16x32_bf16 v[84:87], v[196:199], v[156:159], v[84:87]
    ds_read_b128 v[180:183], v40 offset:45056
    v_mfma_f32_16x16x32_bf16 v[88:91], v[200:203], v[156:159], v[88:91]
    ds_read_b64_tr_b16 v[224:225], v46 offset:49152
    v_mfma_f32_16x16x32_bf16 v[92:95], v[156:159], v[204:207], v[92:95]
    ds_read_b64_tr_b16 v[226:227], v46 offset:50176
    v_mfma_f32_16x16x32_bf16 v[96:99], v[208:211], v[156:159], v[96:99]
    ds_read_b128 v[184:187], v40 offset:47104
    v_mfma_f32_16x16x32_bf16 v[112:115], v[208:211], v[160:163], v[112:115]
    ds_read_b128 v[188:191], v40 offset:49152
    v_mfma_f32_16x16x32_bf16 v[108:111], v[160:163], v[204:207], v[108:111]
    ds_read_b128 v[192:195], v40 offset:51200
    v_mfma_f32_16x16x32_bf16 v[104:107], v[200:203], v[160:163], v[104:107]
    v_mfma_f32_16x16x32_bf16 v[100:103], v[196:199], v[160:163], v[100:103]
    v_mfma_f32_16x16x32_bf16 v[116:119], v[196:199], v[164:167], v[116:119]
    v_mfma_f32_16x16x32_bf16 v[120:123], v[200:203], v[164:167], v[120:123]
    v_mfma_f32_16x16x32_bf16 v[124:127], v[164:167], v[204:207], v[124:127]
    v_mfma_f32_16x16x32_bf16 v[128:131], v[208:211], v[164:167], v[128:131]
    v_mfma_f32_16x16x32_bf16 v[144:147], v[208:211], v[168:171], v[144:147]
    v_mfma_f32_16x16x32_bf16 v[140:143], v[168:171], v[204:207], v[140:143]
    v_mfma_f32_16x16x32_bf16 v[136:139], v[200:203], v[168:171], v[136:139]
    v_mfma_f32_16x16x32_bf16 v[132:135], v[196:199], v[168:171], v[132:135]
    s_waitcnt lgkmcnt(0)
    s_barrier
    v_mfma_f32_16x16x32_bf16 v[52:55], v[212:215], v[172:175], v[52:55]
    ds_read_b64_tr_b16 v[196:197], v47 offset:0
    v_mfma_f32_16x16x32_bf16 v[56:59], v[216:219], v[172:175], v[56:59]
    ds_read_b64_tr_b16 v[198:199], v47 offset:1024
    v_mfma_f32_16x16x32_bf16 v[60:63], v[172:175], v[220:223], v[60:63]
    ds_read_b128 v[148:151], v41 offset:0
    v_mfma_f32_16x16x32_bf16 v[64:67], v[224:227], v[172:175], v[64:67]
    ds_read_b64_tr_b16 v[200:201], v48 offset:0
    v_mfma_f32_16x16x32_bf16 v[80:83], v[224:227], v[176:179], v[80:83]
    ds_read_b64_tr_b16 v[202:203], v48 offset:1024
    v_mfma_f32_16x16x32_bf16 v[76:79], v[176:179], v[220:223], v[76:79]
    ds_read_b128 v[152:155], v41 offset:2048
    v_mfma_f32_16x16x32_bf16 v[72:75], v[216:219], v[176:179], v[72:75]
    ds_read_b64_tr_b16 v[204:205], v49 offset:0
    v_mfma_f32_16x16x32_bf16 v[68:71], v[212:215], v[176:179], v[68:71]
    ds_read_b64_tr_b16 v[206:207], v49 offset:1024
    v_mfma_f32_16x16x32_bf16 v[84:87], v[212:215], v[180:183], v[84:87]
    ds_read_b128 v[156:159], v41 offset:4096
    v_mfma_f32_16x16x32_bf16 v[88:91], v[216:219], v[180:183], v[88:91]
    ds_read_b64_tr_b16 v[208:209], v50 offset:0
    v_mfma_f32_16x16x32_bf16 v[92:95], v[180:183], v[220:223], v[92:95]
    ds_read_b64_tr_b16 v[210:211], v50 offset:1024
    v_mfma_f32_16x16x32_bf16 v[96:99], v[224:227], v[180:183], v[96:99]
    ds_read_b128 v[160:163], v41 offset:6144
    v_mfma_f32_16x16x32_bf16 v[112:115], v[224:227], v[184:187], v[112:115]
    ds_read_b128 v[164:167], v41 offset:8192
    v_mfma_f32_16x16x32_bf16 v[108:111], v[184:187], v[220:223], v[108:111]
    ds_read_b128 v[168:171], v41 offset:10240
    v_mfma_f32_16x16x32_bf16 v[104:107], v[216:219], v[184:187], v[104:107]
    v_mfma_f32_16x16x32_bf16 v[100:103], v[212:215], v[184:187], v[100:103]
    v_mfma_f32_16x16x32_bf16 v[116:119], v[212:215], v[188:191], v[116:119]
    v_mfma_f32_16x16x32_bf16 v[120:123], v[216:219], v[188:191], v[120:123]
    v_mfma_f32_16x16x32_bf16 v[124:127], v[188:191], v[220:223], v[124:127]
    v_mfma_f32_16x16x32_bf16 v[128:131], v[224:227], v[188:191], v[128:131]
    v_mfma_f32_16x16x32_bf16 v[144:147], v[224:227], v[192:195], v[144:147]
    v_mfma_f32_16x16x32_bf16 v[140:143], v[192:195], v[220:223], v[140:143]
    v_mfma_f32_16x16x32_bf16 v[136:139], v[216:219], v[192:195], v[136:139]
    v_mfma_f32_16x16x32_bf16 v[132:135], v[212:215], v[192:195], v[132:135]
    s_waitcnt lgkmcnt(0)
    v_mfma_f32_16x16x32_bf16 v[52:55], v[196:199], v[148:151], v[52:55]
    ds_read_b64_tr_b16 v[212:213], v47 offset:8192
    v_mfma_f32_16x16x32_bf16 v[56:59], v[200:203], v[148:151], v[56:59]
    ds_read_b64_tr_b16 v[214:215], v47 offset:9216
    v_mfma_f32_16x16x32_bf16 v[60:63], v[148:151], v[204:207], v[60:63]
    ds_read_b128 v[172:175], v42 offset:0
    v_mfma_f32_16x16x32_bf16 v[64:67], v[208:211], v[148:151], v[64:67]
    ds_read_b64_tr_b16 v[216:217], v48 offset:8192
    v_mfma_f32_16x16x32_bf16 v[80:83], v[208:211], v[152:155], v[80:83]
    ds_read_b64_tr_b16 v[218:219], v48 offset:9216
    v_mfma_f32_16x16x32_bf16 v[76:79], v[152:155], v[204:207], v[76:79]
    ds_read_b128 v[176:179], v42 offset:2048
    v_mfma_f32_16x16x32_bf16 v[72:75], v[200:203], v[152:155], v[72:75]
    ds_read_b64_tr_b16 v[220:221], v49 offset:8192
    v_mfma_f32_16x16x32_bf16 v[68:71], v[196:199], v[152:155], v[68:71]
    ds_read_b64_tr_b16 v[222:223], v49 offset:9216
    v_mfma_f32_16x16x32_bf16 v[84:87], v[196:199], v[156:159], v[84:87]
    ds_read_b128 v[180:183], v42 offset:4096
    v_mfma_f32_16x16x32_bf16 v[88:91], v[200:203], v[156:159], v[88:91]
    ds_read_b64_tr_b16 v[224:225], v50 offset:8192
    v_mfma_f32_16x16x32_bf16 v[92:95], v[156:159], v[204:207], v[92:95]
    ds_read_b64_tr_b16 v[226:227], v50 offset:9216
    v_mfma_f32_16x16x32_bf16 v[96:99], v[208:211], v[156:159], v[96:99]
    ds_read_b128 v[184:187], v42 offset:6144
    v_mfma_f32_16x16x32_bf16 v[112:115], v[208:211], v[160:163], v[112:115]
    ds_read_b128 v[188:191], v42 offset:8192
    v_mfma_f32_16x16x32_bf16 v[108:111], v[160:163], v[204:207], v[108:111]
    ds_read_b128 v[192:195], v42 offset:10240
    v_mfma_f32_16x16x32_bf16 v[104:107], v[200:203], v[160:163], v[104:107]
    v_mfma_f32_16x16x32_bf16 v[100:103], v[196:199], v[160:163], v[100:103]
    v_mfma_f32_16x16x32_bf16 v[116:119], v[196:199], v[164:167], v[116:119]
    v_mfma_f32_16x16x32_bf16 v[120:123], v[200:203], v[164:167], v[120:123]
    v_mfma_f32_16x16x32_bf16 v[124:127], v[164:167], v[204:207], v[124:127]
    v_mfma_f32_16x16x32_bf16 v[128:131], v[208:211], v[164:167], v[128:131]
    v_mfma_f32_16x16x32_bf16 v[144:147], v[208:211], v[168:171], v[144:147]
    v_mfma_f32_16x16x32_bf16 v[140:143], v[168:171], v[204:207], v[140:143]
    v_mfma_f32_16x16x32_bf16 v[136:139], v[200:203], v[168:171], v[136:139]
    v_mfma_f32_16x16x32_bf16 v[132:135], v[196:199], v[168:171], v[132:135]
    s_waitcnt lgkmcnt(0)
    s_barrier
    v_mfma_f32_16x16x32_bf16 v[52:55], v[212:215], v[172:175], v[52:55]
    ds_read_b64_tr_b16 v[196:197], v43 offset:0
    v_mfma_f32_16x16x32_bf16 v[56:59], v[216:219], v[172:175], v[56:59]
    ds_read_b64_tr_b16 v[198:199], v43 offset:1024
    v_mfma_f32_16x16x32_bf16 v[60:63], v[172:175], v[220:223], v[60:63]
    ds_read_b128 v[148:151], v39 offset:0
    v_mfma_f32_16x16x32_bf16 v[64:67], v[224:227], v[172:175], v[64:67]
    ds_read_b64_tr_b16 v[200:201], v44 offset:0
    v_mfma_f32_16x16x32_bf16 v[80:83], v[224:227], v[176:179], v[80:83]
    ds_read_b64_tr_b16 v[202:203], v44 offset:1024
    v_mfma_f32_16x16x32_bf16 v[76:79], v[176:179], v[220:223], v[76:79]
    ds_read_b128 v[152:155], v39 offset:2048
    v_mfma_f32_16x16x32_bf16 v[72:75], v[216:219], v[176:179], v[72:75]
    ds_read_b64_tr_b16 v[204:205], v45 offset:0
    v_mfma_f32_16x16x32_bf16 v[68:71], v[212:215], v[176:179], v[68:71]
    ds_read_b64_tr_b16 v[206:207], v45 offset:1024
    v_mfma_f32_16x16x32_bf16 v[84:87], v[212:215], v[180:183], v[84:87]
    ds_read_b128 v[156:159], v39 offset:4096
    v_mfma_f32_16x16x32_bf16 v[88:91], v[216:219], v[180:183], v[88:91]
    ds_read_b64_tr_b16 v[208:209], v46 offset:0
    v_mfma_f32_16x16x32_bf16 v[92:95], v[180:183], v[220:223], v[92:95]
    ds_read_b64_tr_b16 v[210:211], v46 offset:1024
    v_mfma_f32_16x16x32_bf16 v[96:99], v[224:227], v[180:183], v[96:99]
    ds_read_b128 v[160:163], v39 offset:6144
    v_mfma_f32_16x16x32_bf16 v[112:115], v[224:227], v[184:187], v[112:115]
    ds_read_b128 v[164:167], v39 offset:8192
    v_mfma_f32_16x16x32_bf16 v[108:111], v[184:187], v[220:223], v[108:111]
    ds_read_b128 v[168:171], v39 offset:10240
    v_mfma_f32_16x16x32_bf16 v[104:107], v[216:219], v[184:187], v[104:107]
    v_mfma_f32_16x16x32_bf16 v[100:103], v[212:215], v[184:187], v[100:103]
    v_mfma_f32_16x16x32_bf16 v[116:119], v[212:215], v[188:191], v[116:119]
    v_mfma_f32_16x16x32_bf16 v[120:123], v[216:219], v[188:191], v[120:123]
    v_mfma_f32_16x16x32_bf16 v[124:127], v[188:191], v[220:223], v[124:127]
    v_mfma_f32_16x16x32_bf16 v[128:131], v[224:227], v[188:191], v[128:131]
    v_mfma_f32_16x16x32_bf16 v[144:147], v[224:227], v[192:195], v[144:147]
    v_mfma_f32_16x16x32_bf16 v[140:143], v[192:195], v[220:223], v[140:143]
    v_mfma_f32_16x16x32_bf16 v[136:139], v[216:219], v[192:195], v[136:139]
    v_mfma_f32_16x16x32_bf16 v[132:135], v[212:215], v[192:195], v[132:135]
    s_waitcnt lgkmcnt(0)
    v_mfma_f32_16x16x32_bf16 v[52:55], v[196:199], v[148:151], v[52:55]
    ds_read_b64_tr_b16 v[212:213], v43 offset:8192
    v_mfma_f32_16x16x32_bf16 v[56:59], v[200:203], v[148:151], v[56:59]
    ds_read_b64_tr_b16 v[214:215], v43 offset:9216
    v_mfma_f32_16x16x32_bf16 v[60:63], v[148:151], v[204:207], v[60:63]
    ds_read_b128 v[172:175], v40 offset:0
    v_mfma_f32_16x16x32_bf16 v[64:67], v[208:211], v[148:151], v[64:67]
    ds_read_b64_tr_b16 v[216:217], v44 offset:8192
    v_mfma_f32_16x16x32_bf16 v[80:83], v[208:211], v[152:155], v[80:83]
    ds_read_b64_tr_b16 v[218:219], v44 offset:9216
    v_mfma_f32_16x16x32_bf16 v[76:79], v[152:155], v[204:207], v[76:79]
    ds_read_b128 v[176:179], v40 offset:2048
    v_mfma_f32_16x16x32_bf16 v[72:75], v[200:203], v[152:155], v[72:75]
    ds_read_b64_tr_b16 v[220:221], v45 offset:8192
    v_mfma_f32_16x16x32_bf16 v[68:71], v[196:199], v[152:155], v[68:71]
    ds_read_b64_tr_b16 v[222:223], v45 offset:9216
    v_mfma_f32_16x16x32_bf16 v[84:87], v[196:199], v[156:159], v[84:87]
    ds_read_b128 v[180:183], v40 offset:4096
    v_mfma_f32_16x16x32_bf16 v[88:91], v[200:203], v[156:159], v[88:91]
    ds_read_b64_tr_b16 v[224:225], v46 offset:8192
    v_mfma_f32_16x16x32_bf16 v[92:95], v[156:159], v[204:207], v[92:95]
    ds_read_b64_tr_b16 v[226:227], v46 offset:9216
    v_mfma_f32_16x16x32_bf16 v[96:99], v[208:211], v[156:159], v[96:99]
    ds_read_b128 v[184:187], v40 offset:6144
    v_mfma_f32_16x16x32_bf16 v[112:115], v[208:211], v[160:163], v[112:115]
    ds_read_b128 v[188:191], v40 offset:8192
    v_mfma_f32_16x16x32_bf16 v[108:111], v[160:163], v[204:207], v[108:111]
    ds_read_b128 v[192:195], v40 offset:10240
    v_mfma_f32_16x16x32_bf16 v[104:107], v[200:203], v[160:163], v[104:107]
    v_mfma_f32_16x16x32_bf16 v[100:103], v[196:199], v[160:163], v[100:103]
    v_mfma_f32_16x16x32_bf16 v[116:119], v[196:199], v[164:167], v[116:119]
    v_mfma_f32_16x16x32_bf16 v[120:123], v[200:203], v[164:167], v[120:123]
    v_mfma_f32_16x16x32_bf16 v[124:127], v[164:167], v[204:207], v[124:127]
    v_mfma_f32_16x16x32_bf16 v[128:131], v[208:211], v[164:167], v[128:131]
    v_mfma_f32_16x16x32_bf16 v[144:147], v[208:211], v[168:171], v[144:147]
    v_mfma_f32_16x16x32_bf16 v[140:143], v[168:171], v[204:207], v[140:143]
    v_mfma_f32_16x16x32_bf16 v[136:139], v[200:203], v[168:171], v[136:139]
    v_mfma_f32_16x16x32_bf16 v[132:135], v[196:199], v[168:171], v[132:135]
    s_waitcnt lgkmcnt(0)
    s_barrier
    v_mfma_f32_16x16x32_bf16 v[52:55], v[212:215], v[172:175], v[52:55]
    ds_read_b64_tr_b16 v[196:197], v43 offset:40960
    v_mfma_f32_16x16x32_bf16 v[56:59], v[216:219], v[172:175], v[56:59]
    ds_read_b64_tr_b16 v[198:199], v43 offset:41984
    v_mfma_f32_16x16x32_bf16 v[60:63], v[172:175], v[220:223], v[60:63]
    ds_read_b128 v[148:151], v39 offset:40960
    v_mfma_f32_16x16x32_bf16 v[64:67], v[224:227], v[172:175], v[64:67]
    ds_read_b64_tr_b16 v[200:201], v44 offset:40960
    v_mfma_f32_16x16x32_bf16 v[80:83], v[224:227], v[176:179], v[80:83]
    ds_read_b64_tr_b16 v[202:203], v44 offset:41984
    v_mfma_f32_16x16x32_bf16 v[76:79], v[176:179], v[220:223], v[76:79]
    ds_read_b128 v[152:155], v39 offset:43008
    v_mfma_f32_16x16x32_bf16 v[72:75], v[216:219], v[176:179], v[72:75]
    ds_read_b64_tr_b16 v[204:205], v45 offset:40960
    v_mfma_f32_16x16x32_bf16 v[68:71], v[212:215], v[176:179], v[68:71]
    ds_read_b64_tr_b16 v[206:207], v45 offset:41984
    v_mfma_f32_16x16x32_bf16 v[84:87], v[212:215], v[180:183], v[84:87]
    ds_read_b128 v[156:159], v39 offset:45056
    v_mfma_f32_16x16x32_bf16 v[88:91], v[216:219], v[180:183], v[88:91]
    ds_read_b64_tr_b16 v[208:209], v46 offset:40960
    v_mfma_f32_16x16x32_bf16 v[92:95], v[180:183], v[220:223], v[92:95]
    ds_read_b64_tr_b16 v[210:211], v46 offset:41984
    v_mfma_f32_16x16x32_bf16 v[96:99], v[224:227], v[180:183], v[96:99]
    ds_read_b128 v[160:163], v39 offset:47104
    v_mfma_f32_16x16x32_bf16 v[112:115], v[224:227], v[184:187], v[112:115]
    ds_read_b128 v[164:167], v39 offset:49152
    v_mfma_f32_16x16x32_bf16 v[108:111], v[184:187], v[220:223], v[108:111]
    ds_read_b128 v[168:171], v39 offset:51200
    v_mfma_f32_16x16x32_bf16 v[104:107], v[216:219], v[184:187], v[104:107]
    v_mfma_f32_16x16x32_bf16 v[100:103], v[212:215], v[184:187], v[100:103]
    v_mfma_f32_16x16x32_bf16 v[116:119], v[212:215], v[188:191], v[116:119]
    v_mfma_f32_16x16x32_bf16 v[120:123], v[216:219], v[188:191], v[120:123]
    v_mfma_f32_16x16x32_bf16 v[124:127], v[188:191], v[220:223], v[124:127]
    v_mfma_f32_16x16x32_bf16 v[128:131], v[224:227], v[188:191], v[128:131]
    v_mfma_f32_16x16x32_bf16 v[144:147], v[224:227], v[192:195], v[144:147]
    v_mfma_f32_16x16x32_bf16 v[140:143], v[192:195], v[220:223], v[140:143]
    v_mfma_f32_16x16x32_bf16 v[136:139], v[216:219], v[192:195], v[136:139]
    v_mfma_f32_16x16x32_bf16 v[132:135], v[212:215], v[192:195], v[132:135]
    s_waitcnt lgkmcnt(0)
    v_mfma_f32_16x16x32_bf16 v[52:55], v[196:199], v[148:151], v[52:55]
    ds_read_b64_tr_b16 v[212:213], v43 offset:49152
    v_mfma_f32_16x16x32_bf16 v[56:59], v[200:203], v[148:151], v[56:59]
    ds_read_b64_tr_b16 v[214:215], v43 offset:50176
    v_mfma_f32_16x16x32_bf16 v[60:63], v[148:151], v[204:207], v[60:63]
    ds_read_b128 v[172:175], v40 offset:40960
    v_mfma_f32_16x16x32_bf16 v[64:67], v[208:211], v[148:151], v[64:67]
    ds_read_b64_tr_b16 v[216:217], v44 offset:49152
    v_mfma_f32_16x16x32_bf16 v[80:83], v[208:211], v[152:155], v[80:83]
    ds_read_b64_tr_b16 v[218:219], v44 offset:50176
    v_mfma_f32_16x16x32_bf16 v[76:79], v[152:155], v[204:207], v[76:79]
    ds_read_b128 v[176:179], v40 offset:43008
    v_mfma_f32_16x16x32_bf16 v[72:75], v[200:203], v[152:155], v[72:75]
    ds_read_b64_tr_b16 v[220:221], v45 offset:49152
    v_mfma_f32_16x16x32_bf16 v[68:71], v[196:199], v[152:155], v[68:71]
    ds_read_b64_tr_b16 v[222:223], v45 offset:50176
    v_mfma_f32_16x16x32_bf16 v[84:87], v[196:199], v[156:159], v[84:87]
    ds_read_b128 v[180:183], v40 offset:45056
    v_mfma_f32_16x16x32_bf16 v[88:91], v[200:203], v[156:159], v[88:91]
    ds_read_b64_tr_b16 v[224:225], v46 offset:49152
    v_mfma_f32_16x16x32_bf16 v[92:95], v[156:159], v[204:207], v[92:95]
    ds_read_b64_tr_b16 v[226:227], v46 offset:50176
    v_mfma_f32_16x16x32_bf16 v[96:99], v[208:211], v[156:159], v[96:99]
    ds_read_b128 v[184:187], v40 offset:47104
    v_mfma_f32_16x16x32_bf16 v[112:115], v[208:211], v[160:163], v[112:115]
    ds_read_b128 v[188:191], v40 offset:49152
    v_mfma_f32_16x16x32_bf16 v[108:111], v[160:163], v[204:207], v[108:111]
    ds_read_b128 v[192:195], v40 offset:51200
    v_mfma_f32_16x16x32_bf16 v[104:107], v[200:203], v[160:163], v[104:107]
    v_mfma_f32_16x16x32_bf16 v[100:103], v[196:199], v[160:163], v[100:103]
    v_mfma_f32_16x16x32_bf16 v[116:119], v[196:199], v[164:167], v[116:119]
    v_mfma_f32_16x16x32_bf16 v[120:123], v[200:203], v[164:167], v[120:123]
    v_mfma_f32_16x16x32_bf16 v[124:127], v[164:167], v[204:207], v[124:127]
    v_mfma_f32_16x16x32_bf16 v[128:131], v[208:211], v[164:167], v[128:131]
    v_mfma_f32_16x16x32_bf16 v[144:147], v[208:211], v[168:171], v[144:147]
    v_mfma_f32_16x16x32_bf16 v[140:143], v[168:171], v[204:207], v[140:143]
    v_mfma_f32_16x16x32_bf16 v[136:139], v[200:203], v[168:171], v[136:139]
    v_mfma_f32_16x16x32_bf16 v[132:135], v[196:199], v[168:171], v[132:135]
    s_waitcnt lgkmcnt(0)
    s_barrier
    v_mfma_f32_16x16x32_bf16 v[52:55], v[212:215], v[172:175], v[52:55]
    ds_read_b64_tr_b16 v[196:197], v47 offset:0
    v_mfma_f32_16x16x32_bf16 v[56:59], v[216:219], v[172:175], v[56:59]
    ds_read_b64_tr_b16 v[198:199], v47 offset:1024
    v_mfma_f32_16x16x32_bf16 v[60:63], v[172:175], v[220:223], v[60:63]
    ds_read_b128 v[148:151], v41 offset:0
    v_mfma_f32_16x16x32_bf16 v[64:67], v[224:227], v[172:175], v[64:67]
    ds_read_b64_tr_b16 v[200:201], v48 offset:0
    v_mfma_f32_16x16x32_bf16 v[80:83], v[224:227], v[176:179], v[80:83]
    ds_read_b64_tr_b16 v[202:203], v48 offset:1024
    v_mfma_f32_16x16x32_bf16 v[76:79], v[176:179], v[220:223], v[76:79]
    ds_read_b128 v[152:155], v41 offset:2048
    v_mfma_f32_16x16x32_bf16 v[72:75], v[216:219], v[176:179], v[72:75]
    ds_read_b64_tr_b16 v[204:205], v49 offset:0
    v_mfma_f32_16x16x32_bf16 v[68:71], v[212:215], v[176:179], v[68:71]
    ds_read_b64_tr_b16 v[206:207], v49 offset:1024
    v_mfma_f32_16x16x32_bf16 v[84:87], v[212:215], v[180:183], v[84:87]
    ds_read_b128 v[156:159], v41 offset:4096
    v_mfma_f32_16x16x32_bf16 v[88:91], v[216:219], v[180:183], v[88:91]
    ds_read_b64_tr_b16 v[208:209], v50 offset:0
    v_mfma_f32_16x16x32_bf16 v[92:95], v[180:183], v[220:223], v[92:95]
    ds_read_b64_tr_b16 v[210:211], v50 offset:1024
    v_mfma_f32_16x16x32_bf16 v[96:99], v[224:227], v[180:183], v[96:99]
    ds_read_b128 v[160:163], v41 offset:6144
    v_mfma_f32_16x16x32_bf16 v[112:115], v[224:227], v[184:187], v[112:115]
    ds_read_b128 v[164:167], v41 offset:8192
    v_mfma_f32_16x16x32_bf16 v[108:111], v[184:187], v[220:223], v[108:111]
    ds_read_b128 v[168:171], v41 offset:10240
    v_mfma_f32_16x16x32_bf16 v[104:107], v[216:219], v[184:187], v[104:107]
    v_mfma_f32_16x16x32_bf16 v[100:103], v[212:215], v[184:187], v[100:103]
    v_mfma_f32_16x16x32_bf16 v[116:119], v[212:215], v[188:191], v[116:119]
    v_mfma_f32_16x16x32_bf16 v[120:123], v[216:219], v[188:191], v[120:123]
    v_mfma_f32_16x16x32_bf16 v[124:127], v[188:191], v[220:223], v[124:127]
    v_mfma_f32_16x16x32_bf16 v[128:131], v[224:227], v[188:191], v[128:131]
    v_mfma_f32_16x16x32_bf16 v[144:147], v[224:227], v[192:195], v[144:147]
    v_mfma_f32_16x16x32_bf16 v[140:143], v[192:195], v[220:223], v[140:143]
    v_mfma_f32_16x16x32_bf16 v[136:139], v[216:219], v[192:195], v[136:139]
    v_mfma_f32_16x16x32_bf16 v[132:135], v[212:215], v[192:195], v[132:135]
    s_waitcnt lgkmcnt(0)
    v_mfma_f32_16x16x32_bf16 v[52:55], v[196:199], v[148:151], v[52:55]
    ds_read_b64_tr_b16 v[212:213], v47 offset:8192
    v_mfma_f32_16x16x32_bf16 v[56:59], v[200:203], v[148:151], v[56:59]
    ds_read_b64_tr_b16 v[214:215], v47 offset:9216
    v_mfma_f32_16x16x32_bf16 v[60:63], v[148:151], v[204:207], v[60:63]
    ds_read_b128 v[172:175], v42 offset:0
    v_mfma_f32_16x16x32_bf16 v[64:67], v[208:211], v[148:151], v[64:67]
    ds_read_b64_tr_b16 v[216:217], v48 offset:8192
    v_mfma_f32_16x16x32_bf16 v[80:83], v[208:211], v[152:155], v[80:83]
    ds_read_b64_tr_b16 v[218:219], v48 offset:9216
    v_mfma_f32_16x16x32_bf16 v[76:79], v[152:155], v[204:207], v[76:79]
    ds_read_b128 v[176:179], v42 offset:2048
    v_mfma_f32_16x16x32_bf16 v[72:75], v[200:203], v[152:155], v[72:75]
    ds_read_b64_tr_b16 v[220:221], v49 offset:8192
    v_mfma_f32_16x16x32_bf16 v[68:71], v[196:199], v[152:155], v[68:71]
    ds_read_b64_tr_b16 v[222:223], v49 offset:9216
    v_mfma_f32_16x16x32_bf16 v[84:87], v[196:199], v[156:159], v[84:87]
    ds_read_b128 v[180:183], v42 offset:4096
    v_mfma_f32_16x16x32_bf16 v[88:91], v[200:203], v[156:159], v[88:91]
    ds_read_b64_tr_b16 v[224:225], v50 offset:8192
    v_mfma_f32_16x16x32_bf16 v[92:95], v[156:159], v[204:207], v[92:95]
    ds_read_b64_tr_b16 v[226:227], v50 offset:9216
    v_mfma_f32_16x16x32_bf16 v[96:99], v[208:211], v[156:159], v[96:99]
    ds_read_b128 v[184:187], v42 offset:6144
    v_mfma_f32_16x16x32_bf16 v[112:115], v[208:211], v[160:163], v[112:115]
    ds_read_b128 v[188:191], v42 offset:8192
    v_mfma_f32_16x16x32_bf16 v[108:111], v[160:163], v[204:207], v[108:111]
    ds_read_b128 v[192:195], v42 offset:10240
    v_mfma_f32_16x16x32_bf16 v[104:107], v[200:203], v[160:163], v[104:107]
    v_mfma_f32_16x16x32_bf16 v[100:103], v[196:199], v[160:163], v[100:103]
    v_mfma_f32_16x16x32_bf16 v[116:119], v[196:199], v[164:167], v[116:119]
    v_mfma_f32_16x16x32_bf16 v[120:123], v[200:203], v[164:167], v[120:123]
    v_mfma_f32_16x16x32_bf16 v[124:127], v[164:167], v[204:207], v[124:127]
    v_mfma_f32_16x16x32_bf16 v[128:131], v[208:211], v[164:167], v[128:131]
    v_mfma_f32_16x16x32_bf16 v[144:147], v[208:211], v[168:171], v[144:147]
    v_mfma_f32_16x16x32_bf16 v[140:143], v[168:171], v[204:207], v[140:143]
    v_mfma_f32_16x16x32_bf16 v[136:139], v[200:203], v[168:171], v[136:139]
    v_mfma_f32_16x16x32_bf16 v[132:135], v[196:199], v[168:171], v[132:135]
    s_waitcnt lgkmcnt(0)
    s_barrier
    v_mfma_f32_16x16x32_bf16 v[52:55], v[212:215], v[172:175], v[52:55]
    ds_read_b64_tr_b16 v[196:197], v43 offset:0
    v_mfma_f32_16x16x32_bf16 v[56:59], v[216:219], v[172:175], v[56:59]
    ds_read_b64_tr_b16 v[198:199], v43 offset:1024
    v_mfma_f32_16x16x32_bf16 v[60:63], v[172:175], v[220:223], v[60:63]
    ds_read_b128 v[148:151], v39 offset:0
    v_mfma_f32_16x16x32_bf16 v[64:67], v[224:227], v[172:175], v[64:67]
    ds_read_b64_tr_b16 v[200:201], v44 offset:0
    v_mfma_f32_16x16x32_bf16 v[80:83], v[224:227], v[176:179], v[80:83]
    ds_read_b64_tr_b16 v[202:203], v44 offset:1024
    v_mfma_f32_16x16x32_bf16 v[76:79], v[176:179], v[220:223], v[76:79]
    ds_read_b128 v[152:155], v39 offset:2048
    v_mfma_f32_16x16x32_bf16 v[72:75], v[216:219], v[176:179], v[72:75]
    ds_read_b64_tr_b16 v[204:205], v45 offset:0
    v_mfma_f32_16x16x32_bf16 v[68:71], v[212:215], v[176:179], v[68:71]
    ds_read_b64_tr_b16 v[206:207], v45 offset:1024
    v_mfma_f32_16x16x32_bf16 v[84:87], v[212:215], v[180:183], v[84:87]
    ds_read_b128 v[156:159], v39 offset:4096
    v_mfma_f32_16x16x32_bf16 v[88:91], v[216:219], v[180:183], v[88:91]
    ds_read_b64_tr_b16 v[208:209], v46 offset:0
    v_mfma_f32_16x16x32_bf16 v[92:95], v[180:183], v[220:223], v[92:95]
    ds_read_b64_tr_b16 v[210:211], v46 offset:1024
    v_mfma_f32_16x16x32_bf16 v[96:99], v[224:227], v[180:183], v[96:99]
    ds_read_b128 v[160:163], v39 offset:6144
    v_mfma_f32_16x16x32_bf16 v[112:115], v[224:227], v[184:187], v[112:115]
    ds_read_b128 v[164:167], v39 offset:8192
    v_mfma_f32_16x16x32_bf16 v[108:111], v[184:187], v[220:223], v[108:111]
    ds_read_b128 v[168:171], v39 offset:10240
    v_mfma_f32_16x16x32_bf16 v[104:107], v[216:219], v[184:187], v[104:107]
    v_mfma_f32_16x16x32_bf16 v[100:103], v[212:215], v[184:187], v[100:103]
    v_mfma_f32_16x16x32_bf16 v[116:119], v[212:215], v[188:191], v[116:119]
    v_mfma_f32_16x16x32_bf16 v[120:123], v[216:219], v[188:191], v[120:123]
    v_mfma_f32_16x16x32_bf16 v[124:127], v[188:191], v[220:223], v[124:127]
    v_mfma_f32_16x16x32_bf16 v[128:131], v[224:227], v[188:191], v[128:131]
    v_mfma_f32_16x16x32_bf16 v[144:147], v[224:227], v[192:195], v[144:147]
    v_mfma_f32_16x16x32_bf16 v[140:143], v[192:195], v[220:223], v[140:143]
    v_mfma_f32_16x16x32_bf16 v[136:139], v[216:219], v[192:195], v[136:139]
    v_mfma_f32_16x16x32_bf16 v[132:135], v[212:215], v[192:195], v[132:135]
    s_waitcnt lgkmcnt(0)
    v_mfma_f32_16x16x32_bf16 v[52:55], v[196:199], v[148:151], v[52:55]
    ds_read_b64_tr_b16 v[212:213], v43 offset:8192
    v_mfma_f32_16x16x32_bf16 v[56:59], v[200:203], v[148:151], v[56:59]
    ds_read_b64_tr_b16 v[214:215], v43 offset:9216
    v_mfma_f32_16x16x32_bf16 v[60:63], v[148:151], v[204:207], v[60:63]
    ds_read_b128 v[172:175], v40 offset:0
    v_mfma_f32_16x16x32_bf16 v[64:67], v[208:211], v[148:151], v[64:67]
    ds_read_b64_tr_b16 v[216:217], v44 offset:8192
    v_mfma_f32_16x16x32_bf16 v[80:83], v[208:211], v[152:155], v[80:83]
    ds_read_b64_tr_b16 v[218:219], v44 offset:9216
    v_mfma_f32_16x16x32_bf16 v[76:79], v[152:155], v[204:207], v[76:79]
    ds_read_b128 v[176:179], v40 offset:2048
    v_mfma_f32_16x16x32_bf16 v[72:75], v[200:203], v[152:155], v[72:75]
    ds_read_b64_tr_b16 v[220:221], v45 offset:8192
    v_mfma_f32_16x16x32_bf16 v[68:71], v[196:199], v[152:155], v[68:71]
    ds_read_b64_tr_b16 v[222:223], v45 offset:9216
    v_mfma_f32_16x16x32_bf16 v[84:87], v[196:199], v[156:159], v[84:87]
    ds_read_b128 v[180:183], v40 offset:4096
    v_mfma_f32_16x16x32_bf16 v[88:91], v[200:203], v[156:159], v[88:91]
    ds_read_b64_tr_b16 v[224:225], v46 offset:8192
    v_mfma_f32_16x16x32_bf16 v[92:95], v[156:159], v[204:207], v[92:95]
    ds_read_b64_tr_b16 v[226:227], v46 offset:9216
    v_mfma_f32_16x16x32_bf16 v[96:99], v[208:211], v[156:159], v[96:99]
    ds_read_b128 v[184:187], v40 offset:6144
    v_mfma_f32_16x16x32_bf16 v[112:115], v[208:211], v[160:163], v[112:115]
    ds_read_b128 v[188:191], v40 offset:8192
    v_mfma_f32_16x16x32_bf16 v[108:111], v[160:163], v[204:207], v[108:111]
    ds_read_b128 v[192:195], v40 offset:10240
    v_mfma_f32_16x16x32_bf16 v[104:107], v[200:203], v[160:163], v[104:107]
    v_mfma_f32_16x16x32_bf16 v[100:103], v[196:199], v[160:163], v[100:103]
    v_mfma_f32_16x16x32_bf16 v[116:119], v[196:199], v[164:167], v[116:119]
    v_mfma_f32_16x16x32_bf16 v[120:123], v[200:203], v[164:167], v[120:123]
    v_mfma_f32_16x16x32_bf16 v[124:127], v[164:167], v[204:207], v[124:127]
    v_mfma_f32_16x16x32_bf16 v[128:131], v[208:211], v[164:167], v[128:131]
    v_mfma_f32_16x16x32_bf16 v[144:147], v[208:211], v[168:171], v[144:147]
    v_mfma_f32_16x16x32_bf16 v[140:143], v[168:171], v[204:207], v[140:143]
    v_mfma_f32_16x16x32_bf16 v[136:139], v[200:203], v[168:171], v[136:139]
    v_mfma_f32_16x16x32_bf16 v[132:135], v[196:199], v[168:171], v[132:135]
    s_waitcnt lgkmcnt(0)
    s_barrier
    v_mfma_f32_16x16x32_bf16 v[52:55], v[212:215], v[172:175], v[52:55]
    ds_read_b64_tr_b16 v[196:197], v43 offset:40960
    v_mfma_f32_16x16x32_bf16 v[56:59], v[216:219], v[172:175], v[56:59]
    ds_read_b64_tr_b16 v[198:199], v43 offset:41984
    v_mfma_f32_16x16x32_bf16 v[60:63], v[172:175], v[220:223], v[60:63]
    ds_read_b128 v[148:151], v39 offset:40960
    v_mfma_f32_16x16x32_bf16 v[64:67], v[224:227], v[172:175], v[64:67]
    ds_read_b64_tr_b16 v[200:201], v44 offset:40960
    v_mfma_f32_16x16x32_bf16 v[80:83], v[224:227], v[176:179], v[80:83]
    ds_read_b64_tr_b16 v[202:203], v44 offset:41984
    v_mfma_f32_16x16x32_bf16 v[76:79], v[176:179], v[220:223], v[76:79]
    ds_read_b128 v[152:155], v39 offset:43008
    v_mfma_f32_16x16x32_bf16 v[72:75], v[216:219], v[176:179], v[72:75]
    ds_read_b64_tr_b16 v[204:205], v45 offset:40960
    v_mfma_f32_16x16x32_bf16 v[68:71], v[212:215], v[176:179], v[68:71]
    ds_read_b64_tr_b16 v[206:207], v45 offset:41984
    v_mfma_f32_16x16x32_bf16 v[84:87], v[212:215], v[180:183], v[84:87]
    ds_read_b128 v[156:159], v39 offset:45056
    v_mfma_f32_16x16x32_bf16 v[88:91], v[216:219], v[180:183], v[88:91]
    ds_read_b64_tr_b16 v[208:209], v46 offset:40960
    v_mfma_f32_16x16x32_bf16 v[92:95], v[180:183], v[220:223], v[92:95]
    ds_read_b64_tr_b16 v[210:211], v46 offset:41984
    v_mfma_f32_16x16x32_bf16 v[96:99], v[224:227], v[180:183], v[96:99]
    ds_read_b128 v[160:163], v39 offset:47104
    v_mfma_f32_16x16x32_bf16 v[112:115], v[224:227], v[184:187], v[112:115]
    ds_read_b128 v[164:167], v39 offset:49152
    v_mfma_f32_16x16x32_bf16 v[108:111], v[184:187], v[220:223], v[108:111]
    ds_read_b128 v[168:171], v39 offset:51200
    v_mfma_f32_16x16x32_bf16 v[104:107], v[216:219], v[184:187], v[104:107]
    v_mfma_f32_16x16x32_bf16 v[100:103], v[212:215], v[184:187], v[100:103]
    s_branch K_PG2
.p2align 12
K_CHM2:
K_STM2:
    s_branch K_WRET_M
    s_nop 0
K_PG2:
    v_mfma_f32_16x16x32_bf16 v[116:119], v[212:215], v[188:191], v[116:119]
    v_mfma_f32_16x16x32_bf16 v[120:123], v[216:219], v[188:191], v[120:123]
    v_mfma_f32_16x16x32_bf16 v[124:127], v[188:191], v[220:223], v[124:127]
    v_mfma_f32_16x16x32_bf16 v[128:131], v[224:227], v[188:191], v[128:131]
    v_mfma_f32_16x16x32_bf16 v[144:147], v[224:227], v[192:195], v[144:147]
    v_mfma_f32_16x16x32_bf16 v[140:143], v[192:195], v[220:223], v[140:143]
    v_mfma_f32_16x16x32_bf16 v[136:139], v[216:219], v[192:195], v[136:139]
    v_mfma_f32_16x16x32_bf16 v[132:135], v[212:215], v[192:195], v[132:135]
    s_waitcnt lgkmcnt(0)
    v_mfma_f32_16x16x32_bf16 v[52:55], v[196:199], v[148:151], v[52:55]
    ds_read_b64_tr_b16 v[212:213], v43 offset:49152
    v_mfma_f32_16x16x32_bf16 v[56:59], v[200:203], v[148:151], v[56:59]
    ds_read_b64_tr_b16 v[214:215], v43 offset:50176
    v_mfma_f32_16x16x32_bf16 v[60:63], v[148:151], v[204:207], v[60:63]
    ds_read_b128 v[172:175], v40 offset:40960
    v_mfma_f32_16x16x32_bf16 v[64:67], v[208:211], v[148:151], v[64:67]
    ds_read_b64_tr_b16 v[216:217], v44 offset:49152
    v_mfma_f32_16x16x32_bf16 v[80:83], v[208:211], v[152:155], v[80:83]
    ds_read_b64_tr_b16 v[218:219], v44 offset:50176
    v_mfma_f32_16x16x32_bf16 v[76:79], v[152:155], v[204:207], v[76:79]
    ds_read_b128 v[176:179], v40 offset:43008
    v_mfma_f32_16x16x32_bf16 v[72:75], v[200:203], v[152:155], v[72:75]
    ds_read_b64_tr_b16 v[220:221], v45 offset:49152
    v_mfma_f32_16x16x32_bf16 v[68:71], v[196:199], v[152:155], v[68:71]
    ds_read_b64_tr_b16 v[222:223], v45 offset:50176
    v_mfma_f32_16x16x32_bf16 v[84:87], v[196:199], v[156:159], v[84:87]
    ds_read_b128 v[180:183], v40 offset:45056
    v_mfma_f32_16x16x32_bf16 v[88:91], v[200:203], v[156:159], v[88:91]
    ds_read_b64_tr_b16 v[224:225], v46 offset:49152
    v_mfma_f32_16x16x32_bf16 v[92:95], v[156:159], v[204:207], v[92:95]
    ds_read_b64_tr_b16 v[226:227], v46 offset:50176
    v_mfma_f32_16x16x32_bf16 v[96:99], v[208:211], v[156:159], v[96:99]
    ds_read_b128 v[184:187], v40 offset:47104
    v_mfma_f32_16x16x32_bf16 v[112:115], v[208:211], v[160:163], v[112:115]
    ds_read_b128 v[188:191], v40 offset:49152
    v_mfma_f32_16x16x32_bf16 v[108:111], v[160:163], v[204:207], v[108:111]
    ds_read_b128 v[192:195], v40 offset:51200
    v_mfma_f32_16x16x32_bf16 v[104:107], v[200:203], v[160:163], v[104:107]
    v_mfma_f32_16x16x32_bf16 v[100:103], v[196:199], v[160:163], v[100:103]
    v_mfma_f32_16x16x32_bf16 v[116:119], v[196:199], v[164:167], v[116:119]
    v_mfma_f32_16x16x32_bf16 v[120:123], v[200:203], v[164:167], v[120:123]
    v_mfma_f32_16x16x32_bf16 v[124:127], v[164:167], v[204:207], v[124:127]
    v_mfma_f32_16x16x32_bf16 v[128:131], v[208:211], v[164:167], v[128:131]
    v_mfma_f32_16x16x32_bf16 v[144:147], v[208:211], v[168:171], v[144:147]
    v_mfma_f32_16x16x32_bf16 v[140:143], v[168:171], v[204:207], v[140:143]
    v_mfma_f32_16x16x32_bf16 v[136:139], v[200:203], v[168:171], v[136:139]
    v_mfma_f32_16x16x32_bf16 v[132:135], v[196:199], v[168:171], v[132:135]
    s_waitcnt lgkmcnt(0)
    s_barrier
    v_mfma_f32_16x16x32_bf16 v[52:55], v[212:215], v[172:175], v[52:55]
    ds_read_b64_tr_b16 v[196:197], v47 offset:0
    v_mfma_f32_16x16x32_bf16 v[56:59], v[216:219], v[172:175], v[56:59]
    ds_read_b64_tr_b16 v[198:199], v47 offset:1024
    v_mfma_f32_16x16x32_bf16 v[60:63], v[172:175], v[220:223], v[60:63]
    ds_read_b128 v[148:151], v41 offset:0
    v_mfma_f32_16x16x32_bf16 v[64:67], v[224:227], v[172:175], v[64:67]
    ds_read_b64_tr_b16 v[200:201], v48 offset:0
    v_mfma_f32_16x16x32_bf16 v[80:83], v[224:227], v[176:179], v[80:83]
    ds_read_b64_tr_b16 v[202:203], v48 offset:1024
    v_mfma_f32_16x16x32_bf16 v[76:79], v[176:179], v[220:223], v[76:79]
    ds_read_b128 v[152:155], v41 offset:2048
    v_mfma_f32_16x16x32_bf16 v[72:75], v[216:219], v[176:179], v[72:75]
    ds_read_b64_tr_b16 v[204:205], v49 offset:0
    v_mfma_f32_16x16x32_bf16 v[68:71], v[212:215], v[176:179], v[68:71]
    ds_read_b64_tr_b16 v[206:207], v49 offset:1024
    v_mfma_f32_16x16x32_bf16 v[84:87], v[212:215], v[180:183], v[84:87]
    ds_read_b128 v[156:159], v41 offset:4096
    v_mfma_f32_16x16x32_bf16 v[88:91], v[216:219], v[180:183], v[88:91]
    ds_read_b64_tr_b16 v[208:209], v50 offset:0
    v_mfma_f32_16x16x32_bf16 v[92:95], v[180:183], v[220:223], v[92:95]
    ds_read_b64_tr_b16 v[210:211], v50 offset:1024
    v_mfma_f32_16x16x32_bf16 v[96:99], v[224:227], v[180:183], v[96:99]
    ds_read_b128 v[160:163], v41 offset:6144
    v_mfma_f32_16x16x32_bf16 v[112:115], v[224:227], v[184:187], v[112:115]
    ds_read_b128 v[164:167], v41 offset:8192
    v_mfma_f32_16x16x32_bf16 v[108:111], v[184:187], v[220:223], v[108:111]
    ds_read_b128 v[168:171], v41 offset:10240
    v_mfma_f32_16x16x32_bf16 v[104:107], v[216:219], v[184:187], v[104:107]
    v_mfma_f32_16x16x32_bf16 v[100:103], v[212:215], v[184:187], v[100:103]
    v_mfma_f32_16x16x32_bf16 v[116:119], v[212:215], v[188:191], v[116:119]
    v_mfma_f32_16x16x32_bf16 v[120:123], v[216:219], v[188:191], v[120:123]
    v_mfma_f32_16x16x32_bf16 v[124:127], v[188:191], v[220:223], v[124:127]
    v_mfma_f32_16x16x32_bf16 v[128:131], v[224:227], v[188:191], v[128:131]
    v_mfma_f32_16x16x32_bf16 v[144:147], v[224:227], v[192:195], v[144:147]
    v_mfma_f32_16x16x32_bf16 v[140:143], v[192:195], v[220:223], v[140:143]
    v_mfma_f32_16x16x32_bf16 v[136:139], v[216:219], v[192:195], v[136:139]
    v_mfma_f32_16x16x32_bf16 v[132:135], v[212:215], v[192:195], v[132:135]
    s_waitcnt lgkmcnt(0)
    v_mfma_f32_16x16x32_bf16 v[132:135], v[196:199], v[168:171], v[132:135]
    ds_read_b64_tr_b16 v[212:213], v47 offset:8192
    ds_read_b64_tr_b16 v[214:215], v47 offset:9216
    v_mfma_f32_16x16x32_bf16 v[136:139], v[200:203], v[168:171], v[136:139]
    ds_read_b128 v[192:195], v42 offset:10240
    ds_read_b64_tr_b16 v[216:217], v48 offset:8192
    v_mfma_f32_16x16x32_bf16 v[140:143], v[168:171], v[204:207], v[140:143]
    ds_read_b64_tr_b16 v[218:219], v48 offset:9216
    ds_read_b64_tr_b16 v[220:221], v49 offset:8192
    v_mfma_f32_16x16x32_bf16 v[144:147], v[208:211], v[168:171], v[144:147]
    ds_read_b64_tr_b16 v[222:223], v49 offset:9216
    ds_read_b64_tr_b16 v[224:225], v50 offset:8192
    v_mfma_f32_16x16x32_bf16 v[116:119], v[196:199], v[164:167], v[116:119]
    ds_read_b64_tr_b16 v[226:227], v50 offset:9216
    ds_read_b128 v[188:191], v42 offset:8192
    v_mfma_f32_16x16x32_bf16 v[120:123], v[200:203], v[164:167], v[120:123]
    ds_read_b128 v[184:187], v42 offset:6144
    ds_read_b128 v[180:183], v42 offset:4096
    v_mfma_f32_16x16x32_bf16 v[124:127], v[164:167], v[204:207], v[124:127]
    ds_read_b128 v[176:179], v42 offset:2048
    ds_read_b128 v[172:175], v42 offset:0
    v_mfma_f32_16x16x32_bf16 v[128:131], v[208:211], v[164:167], v[128:131]
    s_waitcnt lgkmcnt(11)
    v_mfma_f32_16x16x32_bf16 v[132:135], v[212:215], v[192:195], v[132:135]
    s_waitcnt lgkmcnt(9)
    v_mfma_f32_16x16x32_bf16 v[136:139], v[216:219], v[192:195], v[136:139]
    s_waitcnt lgkmcnt(7)
    v_mfma_f32_16x16x32_bf16 v[140:143], v[192:195], v[220:223], v[140:143]
    s_waitcnt lgkmcnt(5)
    v_mfma_f32_16x16x32_bf16 v[144:147], v[224:227], v[192:195], v[144:147]
    s_waitcnt lgkmcnt(4)
    v_mfma_f32_16x16x32_bf16 v[116:119], v[212:215], v[188:191], v[116:119]
    v_cvt_pk_bf16_f32 v132, v132, v133
    v_cvt_pk_bf16_f32 v133, v134, v135
    v_mfma_f32_16x16x32_bf16 v[120:123], v[216:219], v[188:191], v[120:123]
    v_cvt_pk_bf16_f32 v136, v136, v137
    v_cvt_pk_bf16_f32 v137, v138, v139
    v_mfma_f32_16x16x32_bf16 v[124:127], v[188:191], v[220:223], v[124:127]
    v_mov_b32 v138, 0
    v_mov_b32 v139, 0
    v_mfma_f32_16x16x32_bf16 v[128:131], v[224:227], v[188:191], v[128:131]
    v_cvt_pk_bf16_f32 v134, v144, v145
    v_cvt_pk_bf16_f32 v135, v146, v147
    v_mfma_f32_16x16x32_bf16 v[100:103], v[196:199], v[160:163], v[100:103]
    v_cvt_pk_bf16_f32 v254, v140, v141
    v_cvt_pk_bf16_f32 v255, v142, v143
    v_mfma_f32_16x16x32_bf16 v[104:107], v[200:203], v[160:163], v[104:107]
    v_permlane16_swap_b32 v134, v138
    v_permlane16_swap_b32 v135, v139
    ds_write_b64 v32, v[134:135] offset:768
    v_mfma_f32_16x16x32_bf16 v[108:111], v[160:163], v[204:207], v[108:111]
    ds_read_b64_tr_b16 v[240:241], v33 offset:768
    s_cmp_lg_u32 s54, 0
    s_cbranch_scc1 K_NOX
    ds_write_b64 v34, v[132:133]
    ds_write_b64 v34, v[134:135] offset:512
    ds_write_b64 v34, v[254:255] offset:1024
    v_lshl_add_u32 v2, s55, 2, v38
    ds_write_b16 v2, v38 offset:30
K_NOX:
    v_mfma_f32_16x16x32_bf16 v[112:115], v[208:211], v[160:163], v[112:115]
    v_cvt_pk_bf16_f32 v116, v116, v117
    v_cvt_pk_bf16_f32 v117, v118, v119
    v_mfma_f32_16x16x32_bf16 v[192:195], v[132:135], v[136:139], v[16:19]
    v_cvt_pk_bf16_f32 v120, v120, v121
    v_cvt_pk_bf16_f32 v121, v122, v123
    s_waitcnt lgkmcnt(5)
    v_mfma_f32_16x16x32_bf16 v[100:103], v[212:215], v[184:187], v[100:103]
    v_mov_b32 v122, 0
    v_mov_b32 v123, 0
    v_mfma_f32_16x16x32_bf16 v[104:107], v[216:219], v[184:187], v[104:107]
    v_cvt_pk_bf16_f32 v118, v128, v129
    v_cvt_pk_bf16_f32 v119, v130, v131
    v_mfma_f32_16x16x32_bf16 v[108:111], v[184:187], v[220:223], v[108:111]
    v_cvt_pk_bf16_f32 v252, v124, v125
    v_cvt_pk_bf16_f32 v253, v126, v127
    v_mfma_f32_16x16x32_bf16 v[112:115], v[224:227], v[184:187], v[112:115]
    v_permlane16_swap_b32 v118, v122
    v_permlane16_swap_b32 v119, v123
    ds_write_b64 v32, v[118:119] offset:640
    v_mfma_f32_16x16x32_bf16 v[84:87], v[196:199], v[156:159], v[84:87]
    ds_read_b64_tr_b16 v[238:239], v33 offset:640
    v_cvt_pk_bf16_f32 v100, v100, v101
    v_mfma_f32_16x16x32_bf16 v[88:91], v[200:203], v[156:159], v[88:91]
    v_cvt_pk_bf16_f32 v101, v102, v103
    v_cvt_pk_bf16_f32 v104, v104, v105
    v_mfma_f32_16x16x32_bf16 v[168:171], v[116:119], v[136:139], v[12:15]
    v_cvt_pk_bf16_f32 v105, v106, v107
    v_mov_b32 v106, 0
    v_mfma_f32_16x16x32_bf16 v[92:95], v[156:159], v[204:207], v[92:95]
    v_mov_b32 v107, 0
    v_cvt_pk_bf16_f32 v102, v112, v113
    v_mfma_f32_16x16x32_bf16 v[188:191], v[116:119], v[120:123], v[16:19]
    v_cvt_pk_bf16_f32 v103, v114, v115
    v_cvt_pk_bf16_f32 v250, v108, v109
    v_mfma_f32_16x16x32_bf16 v[96:99], v[208:211], v[156:159], v[96:99]
    v_cvt_pk_bf16_f32 v251, v110, v111
    v_permlane16_swap_b32 v102, v106
    s_waitcnt lgkmcnt(6)
    v_mfma_f32_16x16x32_bf16 v[84:87], v[212:215], v[180:183], v[84:87]
    v_permlane16_swap_b32 v103, v107
    ds_write_b64 v32, v[102:103] offset:512
    v_mfma_f32_16x16x32_bf16 v[88:91], v[216:219], v[180:183], v[88:91]
    ds_read_b64_tr_b16 v[236:237], v33 offset:512
    v_max3_f32 v168, v168, v169, v192
    v_mfma_f32_16x16x32_bf16 v[92:95], v[180:183], v[220:223], v[92:95]
    v_max3_f32 v170, v170, v171, v194
    v_max_f32 v168, v168, v193
    v_mfma_f32_16x16x32_bf16 v[164:167], v[100:103], v[120:123], v[12:15]
    v_max_f32 v169, v170, v195
    v_cvt_pk_bf16_f32 v168, v168, v169
    v_mfma_f32_16x16x32_bf16 v[96:99], v[224:227], v[180:183], v[96:99]
    v_cvt_pk_bf16_f32 v84, v84, v85
    v_cvt_pk_bf16_f32 v85, v86, v87
    v_mfma_f32_16x16x32_bf16 v[184:187], v[100:103], v[104:107], v[16:19]
    v_cvt_pk_bf16_f32 v88, v88, v89
    v_cvt_pk_bf16_f32 v89, v90, v91
    v_mfma_f32_16x16x32_bf16 v[68:71], v[196:199], v[152:155], v[68:71]
    v_mov_b32 v90, 0
    v_mov_b32 v91, 0
    v_mfma_f32_16x16x32_bf16 v[72:75], v[200:203], v[152:155], v[72:75]
    v_max3_f32 v164, v164, v165, v188
    v_max3_f32 v166, v166, v167, v190
    v_mfma_f32_16x16x32_bf16 v[76:79], v[152:155], v[204:207], v[76:79]
    v_max_f32 v164, v164, v189
    v_max_f32 v165, v166, v191
    v_mfma_f32_16x16x32_bf16 v[80:83], v[208:211], v[152:155], v[80:83]
    v_cvt_pk_bf16_f32 v164, v164, v165
    v_cvt_pk_bf16_f32 v86, v96, v97
    s_waitcnt lgkmcnt(7)
    v_mfma_f32_16x16x32_bf16 v[68:71], v[212:215], v[176:179], v[68:71]
    v_cvt_pk_bf16_f32 v87, v98, v99
    v_cvt_pk_bf16_f32 v248, v92, v93
    v_mfma_f32_16x16x32_bf16 v[72:75], v[216:219], v[176:179], v[72:75]
    v_cvt_pk_bf16_f32 v249, v94, v95
    v_permlane16_swap_b32 v86, v90
    v_mfma_f32_16x16x32_bf16 v[76:79], v[176:179], v[220:223], v[76:79]
    v_permlane16_swap_b32 v87, v91
    ds_write_b64 v32, v[86:87] offset:384
    v_mfma_f32_16x16x32_bf16 v[80:83], v[224:227], v[176:179], v[80:83]
    ds_read_b64_tr_b16 v[234:235], v33 offset:384
    v_lshl_add_u32 v2, s55, 2, v38
    v_mfma_f32_16x16x32_bf16 v[52:55], v[196:199], v[148:151], v[52:55]
    ds_read_b32 v3, v2 offset:28
    ds_read_b64 v[144:145], v34
    v_mfma_f32_16x16x32_bf16 v[160:163], v[84:87], v[104:107], v[12:15]
    ds_read_b64 v[146:147], v34 offset:512
    ds_read_b64 v[242:243], v34 offset:1024
    v_mfma_f32_16x16x32_bf16 v[56:59], v[200:203], v[148:151], v[56:59]
    ds_read_b64_tr_b16 v[228:229], v33
    v_cvt_pk_bf16_f32 v68, v68, v69
    v_mfma_f32_16x16x32_bf16 v[180:183], v[84:87], v[88:91], v[16:19]
    v_cvt_pk_bf16_f32 v69, v70, v71
    v_cvt_pk_bf16_f32 v72, v72, v73
    v_mfma_f32_16x16x32_bf16 v[60:63], v[148:151], v[204:207], v[60:63]
    v_cvt_pk_bf16_f32 v73, v74, v75
    v_mov_b32 v74, 0
    v_mfma_f32_16x16x32_bf16 v[64:67], v[208:211], v[148:151], v[64:67]
    v_mov_b32 v75, 0
    v_cvt_pk_bf16_f32 v70, v80, v81
    s_waitcnt lgkmcnt(13)
    v_mfma_f32_16x16x32_bf16 v[52:55], v[212:215], v[172:175], v[52:55]
    v_cvt_pk_bf16_f32 v71, v82, v83
    v_cvt_pk_bf16_f32 v246, v76, v77
    v_mfma_f32_16x16x32_bf16 v[56:59], v[216:219], v[172:175], v[56:59]
    v_cvt_pk_bf16_f32 v247, v78, v79
    v_permlane16_swap_b32 v70, v74
    v_mfma_f32_16x16x32_bf16 v[60:63], v[172:175], v[220:223], v[60:63]
    v_permlane16_swap_b32 v71, v75
    ds_write_b64 v32, v[70:71] offset:256
    v_mfma_f32_16x16x32_bf16 v[64:67], v[224:227], v[172:175], v[64:67]
    ds_read_b64_tr_b16 v[232:233], v33 offset:256
    v_max3_f32 v160, v160, v161, v184
    v_max3_f32 v162, v162, v163, v186
    v_max_f32 v160, v160, v185
    v_max_f32 v161, v162, v187
    v_mfma_f32_16x16x32_bf16 v[156:159], v[68:71], v[88:91], v[12:15]
    v_cvt_pk_bf16_f32 v160, v160, v161
    v_cvt_pk_bf16_f32 v52, v52, v53
    v_cvt_pk_bf16_f32 v53, v54, v55
    v_mfma_f32_16x16x32_bf16 v[176:179], v[68:71], v[72:75], v[16:19]
    v_cvt_pk_bf16_f32 v56, v56, v57
    v_cvt_pk_bf16_f32 v57, v58, v59
    v_mov_b32 v58, 0
    v_mov_b32 v59, 0
    v_cvt_pk_bf16_f32 v54, v64, v65
    v_cvt_pk_bf16_f32 v55, v66, v67
    v_cvt_pk_bf16_f32 v244, v60, v61
    v_cvt_pk_bf16_f32 v245, v62, v63
    v_permlane16_swap_b32 v54, v58
    v_permlane16_swap_b32 v55, v59
    ds_write_b64 v32, v[54:55] offset:128
    ds_read_b64_tr_b16 v[230:231], v33 offset:128
    v_max3_f32 v156, v156, v157, v180
    v_max3_f32 v158, v158, v159, v182
    v_max_f32 v156, v156, v181
    v_mfma_f32_16x16x32_bf16 v[152:155], v[52:55], v[72:75], v[20:23]
    v_max_f32 v157, v158, v183
    v_cvt_pk_bf16_f32 v156, v156, v157
    v_mfma_f32_16x16x32_bf16 v[172:175], v[52:55], v[56:59], v[16:19]
    s_waitcnt lgkmcnt(4)
    v_readfirstlane_b32 s33, v3
    s_cmp_lt_u32 s33, 1811939328
    s_cbranch_scc1 K_XW
K_XR:
    v_mfma_f32_16x16x32_bf16 v[148:151], v[144:147], v[56:59], v[12:15]
    v_max3_f32 v152, v152, v153, v176
    v_max3_f32 v154, v154, v155, v178
    v_max_f32 v152, v152, v177
    v_max_f32 v153, v154, v179
    v_cvt_pk_bf16_f32 v152, v152, v153
    v_permlane16_swap_b32 v164, v168
    v_permlane16_swap_b32 v156, v160
    s_nop 1
    v_max3_f32 v148, v148, v149, v172
    v_max3_f32 v150, v150, v151, v174
    v_max_f32 v148, v148, v173
    v_max_f32 v149, v150, v175
    v_cvt_pk_bf16_f32 v148, v148, v149
    v_permlane32_swap_b32 v156, v164
    v_permlane32_swap_b32 v160, v168
    v_lshlrev_b32 v220, 16, v156
    v_and_b32 v221, 0xffff0000, v156
    v_lshlrev_b32 v224, 16, v164
    v_and_b32 v225, 0xffff0000, v164
    v_lshlrev_b32 v222, 16, v160
    v_and_b32 v223, 0xffff0000, v160
    v_lshlrev_b32 v226, 16, v168
    v_and_b32 v227, 0xffff0000, v168
    v_permlane16_swap_b32 v148, v152
    v_lshlrev_b32 v216, 16, v148
    v_and_b32 v217, 0xffff0000, v148
    v_lshlrev_b32 v218, 16, v152
    v_and_b32 v219, 0xffff0000, v152
    v_pk_mul_f32 v[220:221], v[220:221], s[60:61]
    v_pk_mul_f32 v[224:225], v[224:225], s[60:61]
    v_pk_mul_f32 v[222:223], v[222:223], s[60:61]
    v_pk_mul_f32 v[226:227], v[226:227], s[60:61]
    v_pk_mul_f32 v[216:217], v[216:217], s[60:61]
    v_pk_mul_f32 v[218:219], v[218:219], s[60:61]
    v_cvt_pk_bf16_f32 v156, v220, v221
    v_cvt_pk_bf16_f32 v164, v224, v225
    v_cvt_pk_bf16_f32 v160, v222, v223
    v_cvt_pk_bf16_f32 v168, v226, v227
    v_cvt_pk_bf16_f32 v148, v216, v217
    v_cvt_pk_bf16_f32 v152, v218, v219
    v_lshlrev_b32 v218, 16, v152
    v_and_b32 v219, 0xffff0000, v152
    v_lshlrev_b32 v216, 16, v148
    v_and_b32 v217, 0xffff0000, v148
    v_lshlrev_b32 v226, 16, v168
    v_and_b32 v227, 0xffff0000, v168
    v_lshlrev_b32 v222, 16, v160
    v_and_b32 v223, 0xffff0000, v160
    v_lshlrev_b32 v224, 16, v164
    v_and_b32 v225, 0xffff0000, v164
    v_lshlrev_b32 v220, 16, v156
    v_and_b32 v221, 0xffff0000, v156
    ds_read_b32 v3, v2 offset:28
    v_max3_f32 v174, v216, v217, v218
    v_max3_f32 v172, v220, v221, v224
    v_max_f32 v174, v174, v219
    v_max3_f32 v172, v172, v225, v222
    v_mov_b32 v176, v174
    v_max3_f32 v172, v172, v223, v226
    v_max_f32 v172, v172, v227
    v_permlane32_swap_b32 v174, v176
    v_mul_f32 v172, s58, v172
    v_max_f32 v174, v174, v176
    v_mul_f32 v174, s58, v174
    v_pk_fma_f32 v[220:221], v[220:221], s[58:59], v[172:173] op_sel_hi:[1,1,0] neg_lo:[0,0,1] neg_hi:[0,0,1]
    v_pk_fma_f32 v[222:223], v[222:223], s[58:59], v[172:173] op_sel_hi:[1,1,0] neg_lo:[0,0,1] neg_hi:[0,0,1]
    v_pk_fma_f32 v[224:225], v[224:225], s[58:59], v[172:173] op_sel_hi:[1,1,0] neg_lo:[0,0,1] neg_hi:[0,0,1]
    v_pk_fma_f32 v[226:227], v[226:227], s[58:59], v[172:173] op_sel_hi:[1,1,0] neg_lo:[0,0,1] neg_hi:[0,0,1]
    v_pk_fma_f32 v[216:217], v[216:217], s[58:59], v[174:175] op_sel_hi:[1,1,0] neg_lo:[0,0,1] neg_hi:[0,0,1]
    v_pk_fma_f32 v[218:219], v[218:219], s[58:59], v[174:175] op_sel_hi:[1,1,0] neg_lo:[0,0,1] neg_hi:[0,0,1]
    v_exp_f32 v216, v216
    v_exp_f32 v217, v217
    v_exp_f32 v218, v218
    v_exp_f32 v219, v219
    v_exp_f32 v220, v220
    v_exp_f32 v221, v221
    v_exp_f32 v222, v222
    v_exp_f32 v223, v223
    v_exp_f32 v224, v224
    v_exp_f32 v225, v225
    v_exp_f32 v226, v226
    v_exp_f32 v227, v227
    v_pk_add_f32 v[174:175], v[216:217], v[218:219]
    v_pk_add_f32 v[172:173], v[220:221], v[222:223]
    v_add_f32 v174, v174, v175
    v_pk_add_f32 v[178:179], v[224:225], v[226:227]
    v_mov_b32 v176, v174
    v_pk_add_f32 v[172:173], v[172:173], v[178:179]
    v_add_f32 v172, v172, v173
    v_permlane32_swap_b32 v174, v176
    v_rcp_f32 v172, v172
    v_add_f32 v174, v174, v176
    v_rcp_f32 v174, v174
    v_pk_mul_f32 v[220:221], v[220:221], v[172:173] op_sel_hi:[1,0]
    v_pk_mul_f32 v[222:223], v[222:223], v[172:173] op_sel_hi:[1,0]
    v_pk_mul_f32 v[224:225], v[224:225], v[172:173] op_sel_hi:[1,0]
    v_pk_mul_f32 v[226:227], v[226:227], v[172:173] op_sel_hi:[1,0]
    v_pk_mul_f32 v[216:217], v[216:217], v[174:175] op_sel_hi:[1,0]
    v_pk_mul_f32 v[218:219], v[218:219], v[174:175] op_sel_hi:[1,0]
    s_waitcnt lgkmcnt(0)
    v_readfirstlane_b32 s33, v3
    s_cmp_lt_u32 s33, s62
    s_cbranch_scc1 K_PW
K_PR:
    v_cvt_pk_bf16_f32 v156, v220, v221
    v_cvt_pk_bf16_f32 v164, v224, v225
    v_cvt_pk_bf16_f32 v160, v222, v223
    v_cvt_pk_bf16_f32 v168, v226, v227
    v_cvt_pk_bf16_f32 v148, v216, v217
    v_cvt_pk_bf16_f32 v152, v218, v219
    v_permlane32_swap_b32 v156, v164
    v_permlane32_swap_b32 v160, v168
    v_permlane16_swap_b32 v148, v152
    s_waitcnt lgkmcnt(0)
    v_permlane16_swap_b32 v156, v160
    v_permlane16_swap_b32 v164, v168
    v_perm_b32 v56, v148, v148, v24
    v_perm_b32 v57, v148, v148, v25
    v_perm_b32 v58, v148, v148, v26
    v_perm_b32 v59, v148, v148, v27
    v_perm_b32 v72, v152, v152, v24
    v_perm_b32 v73, v152, v152, v25
    v_mfma_f32_16x16x32_bf16 v[64:67], v[228:231], v[56:59], 0
    v_perm_b32 v74, v152, v152, v26
    v_perm_b32 v75, v152, v152, v27
    v_mfma_f32_16x16x32_bf16 v[60:63], v[242:245], v[56:59], 0
    v_perm_b32 v88, v156, v156, v24
    v_perm_b32 v89, v156, v156, v25
    v_mfma_f32_16x16x32_bf16 v[80:83], v[230:233], v[72:75], 0
    v_perm_b32 v90, v156, v156, v26
    v_perm_b32 v91, v156, v156, v27
    v_mfma_f32_16x16x32_bf16 v[76:79], v[244:247], v[72:75], 0
    v_perm_b32 v104, v160, v160, v24
    v_perm_b32 v105, v160, v160, v25
    v_mfma_f32_16x16x32_bf16 v[96:99], v[232:235], v[88:91], 0
    v_perm_b32 v106, v160, v160, v26
    v_perm_b32 v107, v160, v160, v27
    v_mfma_f32_16x16x32_bf16 v[92:95], v[246:249], v[88:91], 0
    v_perm_b32 v120, v164, v164, v24
    v_perm_b32 v121, v164, v164, v25
    v_mfma_f32_16x16x32_bf16 v[112:115], v[234:237], v[104:107], 0
    v_perm_b32 v122, v164, v164, v26
    v_perm_b32 v123, v164, v164, v27
    v_mfma_f32_16x16x32_bf16 v[108:111], v[248:251], v[104:107], 0
    v_perm_b32 v136, v168, v168, v24
    v_perm_b32 v137, v168, v168, v25
    v_mfma_f32_16x16x32_bf16 v[128:131], v[236:239], v[120:123], 0
    v_perm_b32 v138, v168, v168, v26
    v_perm_b32 v139, v168, v168, v27
    v_mfma_f32_16x16x32_bf16 v[124:127], v[250:253], v[120:123], 0
    v_mov_b32 v3, 1
    v_mfma_f32_16x16x32_bf16 v[144:147], v[238:241], v[136:139], 0
    v_lshl_add_u32 v2, s54, 2, v38
    v_cvt_pk_bf16_f32 v68, v64, v65
    v_mfma_f32_16x16x32_bf16 v[140:143], v[252:255], v[136:139], 0
    v_cvt_pk_bf16_f32 v69, v66, v67
    s_mov_b32 exec_lo, 0xffff0000
    v_cvt_pk_bf16_f32 v68, v80, v81
    v_cvt_pk_bf16_f32 v69, v82, v83
    s_mov_b32 exec_lo, 0
    v_cvt_pk_bf16_f32 v68, v96, v97
    v_cvt_pk_bf16_f32 v69, v98, v99
    s_mov_b32 exec_hi, 0xffff0000
    v_cvt_pk_bf16_f32 v68, v112, v113
    v_cvt_pk_bf16_f32 v69, v114, v115
    s_mov_b64 exec, -1
    ds_write_b64 v35, v[68:69]
    v_cvt_pk_bf16_f32 v70, v128, v129
    v_cvt_pk_bf16_f32 v71, v130, v131
    s_mov_b32 exec_lo, 0xffff0000
    v_cvt_pk_bf16_f32 v70, v144, v145
    v_cvt_pk_bf16_f32 v71, v146, v147
    s_mov_b32 exec_lo, -1
    s_mov_b32 exec_hi, 0
    ds_write_b64 v35, v[70:71] offset:1024
    s_mov_b32 exec_lo, 1
    ds_add_u32 v2, v3 offset:48
    s_mov_b64 exec, -1
    v_cvt_pk_bf16_f32 v52, v60, v61
    v_cvt_pk_bf16_f32 v54, v76, v77
    v_cvt_pk_bf16_f32 v53, v62, v63
    v_cvt_pk_bf16_f32 v55, v78, v79
    v_cvt_pk_bf16_f32 v84, v92, v93
    v_permlane16_swap_b32 v52, v54
    v_permlane16_swap_b32 v53, v55
    v_min_u32 v52, -2, v52
    buffer_store_dwordx4 v[52:55], v28, s[20:23], 0 offen sc1
    v_cvt_pk_bf16_f32 v86, v108, v109
    v_cvt_pk_bf16_f32 v85, v94, v95
    v_cvt_pk_bf16_f32 v87, v110, v111
    v_cvt_pk_bf16_f32 v116, v124, v125
    v_permlane16_swap_b32 v84, v86
    v_permlane16_swap_b32 v85, v87
    v_min_u32 v84, -2, v84
    buffer_store_dwordx4 v[84:87], v29, s[20:23], 0 offen sc1
    v_cvt_pk_bf16_f32 v118, v140, v141
    v_cvt_pk_bf16_f32 v117, v126, v127
    v_cvt_pk_bf16_f32 v119, v142, v143
    ds_read_b32 v3, v2 offset:48
    ds_read_b128 v[196:199], v36
    v_permlane16_swap_b32 v116, v118
    v_permlane16_swap_b32 v117, v119
    v_min_u32 v116, -2, v116
    buffer_store_dwordx4 v[116:119], v30, s[20:23], 0 offen sc1
    s_waitcnt lgkmcnt(0)
    v_readfirstlane_b32 s33, v3
    s_cmp_lt_u32 s33, s63
    s_cbranch_scc1 K_TW
K_TR:
    v_min_u32 v196, -2, v196
    buffer_store_dwordx4 v[196:199], v31, s[20:23], 0 offen sc1
    s_cmp_eq_u32 s34, -1
    s_cbranch_scc1 K_END
    s_add_u32 s30, s30, 4
    s_branch K_P2_HELP
K_CHM3:
K_STM3:
    s_branch K_WRET_M
    s_nop 0
K_XW:
    s_mov_b32 s3, 1048576
K_CGX:
    ds_read_b32 v3, v2 offset:28
    s_sub_u32 s3, s3, 1
    s_waitcnt lgkmcnt(0)
    v_readfirstlane_b32 s33, v3
    s_cselect_b32 s33, 1811939328, s33
    s_cmp_lt_u32 s33, 1811939328
    s_cbranch_scc1 K_CGX
    ds_read_b64 v[144:145], v34
    ds_read_b64 v[146:147], v34 offset:512
    ds_read_b64 v[242:243], v34 offset:1024
    ds_read_b64_tr_b16 v[228:229], v33
    s_waitcnt lgkmcnt(0)
    s_branch K_XR
K_PW:
    s_cmp_ge_u32 s33, 1811939332
    s_cbranch_scc1 K_PW2
    s_mov_b32 s3, 1048576
K_CGP:
    ds_read_b32 v3, v2 offset:28
    s_sub_u32 s3, s3, 1
    s_waitcnt lgkmcnt(0)
    v_readfirstlane_b32 s33, v3
    s_cselect_b32 s33, 1811939332, s33
    s_cmp_lt_u32 s33, 1811939332
    s_cbranch_scc1 K_CGP
K_PW2:
    s_cmp_lg_u32 s62, -1
    s_cbranch_scc1 K_PR
    v_mov_b32 v4, s36
    s_mov_b32 exec_lo, s37
    s_mov_b32 exec_hi, 0
    global_atomic_add v37, v4, s[6:7] sc1
    s_mov_b64 exec, -1
    s_branch K_PR
K_TW:
    s_cmp_lg_u32 s63, -1
    s_cbranch_scc1 K_TW2
    v_mov_b32 v4, s36
    s_mov_b32 exec_lo, s37
    s_mov_b32 exec_hi, 0
    global_atomic_add v37, v4, s[6:7] sc1
    s_mov_b64 exec, -1
    s_cmp_ge_u32 s33, 2
    s_cbranch_scc1 K_TR
K_TW2:
    s_mov_b32 s3, 1048576
K_CGT:
    ds_read_b32 v3, v2 offset:48
    s_sub_u32 s3, s3, 1
    s_waitcnt lgkmcnt(0)
    v_readfirstlane_b32 s33, v3
    s_cselect_b32 s33, 2, s33
    s_cmp_lt_u32 s33, 2
    s_cbranch_scc1 K_CGT
    ds_read_b128 v[196:199], v36
    s_waitcnt lgkmcnt(0)
    s_branch K_TR
K_P2_EARLY:
    s_lshl_b32 s62, s40, 7
    v_lshrrev_b32 v8, 3, v1
    v_lshrrev_b32 v9, 4, v1
    v_mov_b32 v15, 158720
    s_lshl_b32 s61, s40, 3
    s_add_u32 s61, s61, s30
    s_mul_i32 s3, s61, 20480
    s_lshl_b32 s33, s41, 7
    s_add_u32 s3, s3, s33
    v_and_b32 v2, 7, v1
    v_lshlrev_b32 v2, 4, v2
    v_mul_u32_u24 v4, 1280, v8
    v_add3_u32 v10, v2, v4, s3
    s_lshl_b32 s3, s30, 7
    s_add_u32 s3, s3, 159744
    v_lshl_add_u32 v11, v8, 3, s3
    s_mov_b32 s63, 10240
    s_add_u32 s20, s6, 0x100000
    s_addc_u32 s21, s7, 0
    s_mov_b32 s22, 0x280000
    s_mov_b32 s23, 0x20000
    s_mov_b32 s56, s10
    s_mov_b32 s57, s11
    s_mov_b32 s58, 0x280000
    s_mov_b32 s59, 0x20000
    v_mul_u32_u24 v3, 144, v8
    v_add_u32 v3, v2, v3
    s_mul_i32 s3, s30, 2304
    s_add_u32 s3, s3, 140288
    v_add_u32 v14, s3, v3
    buffer_load_dwordx4 v[16:19], v10, s[12:15], 0 offen
    buffer_load_dwordx4 v[20:23], v10, s[12:15], s63 offen
    v_bfe_u32 v48, v1, 2, 2
    v_and_b32 v49, 3, v1
    s_add_u32 s3, s61, s30
    s_lshr_b32 s33, s3, 2
    s_mul_i32 s33, s33, 76
    s_add_u32 s3, s3, s33
    s_lshl_b32 s3, s3, 10
    v_and_b32 v2, 15, v1
    v_lshl_add_u32 v2, v2, 4, s3
    v_lshrrev_b32 v3, 5, v1
    v_lshl_add_u32 v2, v3, 8, v2
    v_and_b32 v4, 1, v9
    v_lshl_add_u32 v52, v4, 10, v2
    v_mov_b32 v53, 0x1f000
    v_lshl_add_u32 v2, v3, 3, v48
    v_lshlrev_b32 v2, 7, v2
    s_branch K_PG3
.p2align 12
K_CHA0:
K_STA4:
    s_branch K_STA8
K_CHB0:
K_STB4:
    s_branch K_STB8
K_PG3:
    v_lshl_add_u32 v2, v49, 3, v2
    v_lshl_add_u32 v2, v4, 5, v2
    v_lshrrev_b32 v4, 1, v48
    v_lshl_add_u32 v54, v4, 6, v2
    v_xor_b32 v55, 64, v54
    v_mov_b32 v56, v54
    v_mov_b32 v57, v54
    v_and_b32 v2, 31, v1
    v_mul_u32_u24 v2, 144, v2
    v_lshl_add_u32 v2, v3, 3, v2
    s_mul_i32 s3, s30, 4608
    s_add_u32 s3, s3, 140288
    v_add_u32 v50, s3, v2
    s_and_b32 s33, s40, 3
    s_lshl_b32 s33, s33, 2
    s_lshr_b32 s33, 0xf63f, s33
    s_and_b32 s33, s33, 15
    s_lshl1_add_u32 s3, s30, 1
    s_cmp_ge_u32 s3, s33
    s_cselect_b32 s60, 24, 16
    s_cmp_gt_u32 s3, s33
    s_cselect_b32 s60, 20, s60
    v_add_u32 v58, s60, v15
    s_mov_b32 s64, -1
    s_mov_b32 s65, -1
    s_mov_b32 s66, -1
    s_mov_b32 s67, -1
    s_mov_b32 s68, -1
    s_mov_b32 s69, -1
    s_mov_b32 s70, 0xfffff
    s_mov_b32 s71, 131072
    v_mov_b32 v108, 0
    v_mov_b32 v109, 0
    v_mov_b32 v110, 0
    v_mov_b32 v111, 0
    v_mov_b32 v112, 0
    v_mov_b32 v113, 0
    v_mov_b32 v114, 0
    v_mov_b32 v115, 0
    v_mov_b32 v116, 0
    v_mov_b32 v117, 0
    v_mov_b32 v118, 0
    v_mov_b32 v119, 0
    v_mov_b32 v120, 0
    v_mov_b32 v121, 0
    v_mov_b32 v122, 0
    v_mov_b32 v123, 0
    v_mov_b32 v124, 0
    v_mov_b32 v125, 0
    v_mov_b32 v126, 0
    v_mov_b32 v127, 0
    v_mov_b32 v128, 0
    v_mov_b32 v129, 0
    v_mov_b32 v130, 0
    v_mov_b32 v131, 0
    v_mov_b32 v132, 0
    v_mov_b32 v133, 0
    v_mov_b32 v134, 0
    v_mov_b32 v135, 0
    v_mov_b32 v136, 0
    v_mov_b32 v137, 0
    v_mov_b32 v138, 0
    v_mov_b32 v139, 0
    s_barrier
    s_branch K_P2_AUXW
K_P2_GM:
    s_lshl_b32 s62, s40, 7
    v_lshrrev_b32 v8, 3, v1
    v_lshrrev_b32 v9, 4, v1
    v_mov_b32 v15, 158720
    s_lshl_b32 s61, s40, 3
    s_add_u32 s61, s61, s30
    s_mul_i32 s3, s61, 20480
    s_lshl_b32 s33, s41, 7
    s_add_u32 s3, s3, s33
    v_and_b32 v2, 7, v1
    v_lshlrev_b32 v2, 4, v2
    v_mul_u32_u24 v4, 1280, v8
    v_add3_u32 v10, v2, v4, s3
    s_lshl_b32 s3, s30, 7
    s_add_u32 s3, s3, 159744
    v_lshl_add_u32 v11, v8, 3, s3
    s_mov_b32 s63, 10240
    s_add_u32 s20, s6, 0x100000
    s_addc_u32 s21, s7, 0
    s_mov_b32 s22, 0x280000
    s_mov_b32 s23, 0x20000
    s_mov_b32 s56, s10
    s_mov_b32 s57, s11
    s_mov_b32 s58, 0x280000
    s_mov_b32 s59, 0x20000
    v_mul_u32_u24 v3, 144, v8
    v_add_u32 v3, v2, v3
    s_mul_i32 s3, s30, 2304
    s_add_u32 s3, s3, 140288
    v_add_u32 v14, s3, v3
    v_bfe_u32 v48, v1, 2, 2
    v_and_b32 v49, 3, v1
    s_add_u32 s3, s61, s30
    s_lshr_b32 s33, s3, 2
    s_mul_i32 s33, s33, 76
    s_add_u32 s3, s3, s33
    s_lshl_b32 s3, s3, 10
    v_and_b32 v2, 15, v1
    v_lshl_add_u32 v2, v2, 4, s3
    v_lshrrev_b32 v3, 5, v1
    v_lshl_add_u32 v2, v3, 8, v2
    v_and_b32 v4, 1, v9
    v_lshl_add_u32 v52, v4, 10, v2
    v_mov_b32 v53, 0x1f000
    v_lshl_add_u32 v2, v3, 3, v48
    v_lshlrev_b32 v2, 7, v2
    v_lshl_add_u32 v2, v49, 3, v2
    v_lshl_add_u32 v2, v4, 5, v2
    v_lshrrev_b32 v4, 1, v48
    v_lshl_add_u32 v54, v4, 6, v2
    v_xor_b32 v55, 64, v54
    v_mov_b32 v56, v54
    v_mov_b32 v57, v54
    v_and_b32 v2, 31, v1
    v_mul_u32_u24 v2, 144, v2
    v_lshl_add_u32 v2, v3, 3, v2
    s_mul_i32 s3, s30, 4608
    s_add_u32 s3, s3, 140288
    v_add_u32 v50, s3, v2
    s_and_b32 s33, s40, 3
    s_lshl_b32 s33, s33, 2
    s_lshr_b32 s33, 0xf63f, s33
    s_and_b32 s33, s33, 15
    s_lshl1_add_u32 s3, s30, 1
    s_cmp_ge_u32 s3, s33
    s_cselect_b32 s60, 24, 16
    s_cmp_gt_u32 s3, s33
    s_cselect_b32 s60, 20, s60
    v_add_u32 v58, s60, v15
    s_mov_b32 s64, -1
    s_mov_b32 s65, -1
    s_mov_b32 s66, -1
    s_mov_b32 s67, -1
    s_mov_b32 s68, -1
    s_mov_b32 s69, -1
    s_mov_b32 s70, 0xfffff
    s_mov_b32 s71, 131072
    v_mov_b32 v108, 0
    v_mov_b32 v109, 0
    v_mov_b32 v110, 0
    v_mov_b32 v111, 0
    v_mov_b32 v112, 0
    v_mov_b32 v113, 0
    v_mov_b32 v114, 0
    v_mov_b32 v115, 0
    v_mov_b32 v116, 0
    v_mov_b32 v117, 0
    v_mov_b32 v118, 0
    v_mov_b32 v119, 0
    v_mov_b32 v120, 0
    v_mov_b32 v121, 0
    v_mov_b32 v122, 0
    v_mov_b32 v123, 0
    v_mov_b32 v124, 0
    v_mov_b32 v125, 0
    v_mov_b32 v126, 0
    v_mov_b32 v127, 0
    v_mov_b32 v128, 0
    v_mov_b32 v129, 0
    v_mov_b32 v130, 0
    v_mov_b32 v131, 0
    v_mov_b32 v132, 0
    v_mov_b32 v133, 0
    v_mov_b32 v134, 0
    v_mov_b32 v135, 0
    v_mov_b32 v136, 0
    v_mov_b32 v137, 0
    v_mov_b32 v138, 0
    v_mov_b32 v139, 0
    buffer_load_dwordx4 v[16:19], v10, s[12:15], 0 offen
    buffer_load_dwordx4 v[20:23], v10, s[12:15], s63 offen
    s_cmp_eq_u32 s30, 0
    s_cbranch_scc1 K_CHB0
    s_cmp_eq_u32 s30, 1
    s_cbranch_scc1 K_CHB1
    s_cmp_eq_u32 s30, 2
    s_cbranch_scc1 K_CHB2
    s_branch K_CHB3
K_WRET_B:
    v_mov_b32 v3, 1
    s_waitcnt vmcnt(2)
    s_mov_b64 exec, 1
    ds_add_u32 v15, v3 offset:44
    s_mov_b64 exec, -1
    s_mov_b32 s3, 1048576
K_P2_GWM:
    ds_read_b32 v2, v15 offset:44
    s_sleep 1
    s_sub_u32 s3, s3, 1
    s_waitcnt lgkmcnt(0)
    v_readfirstlane_b32 s33, v2
    s_nop 3
    s_cselect_b32 s33, 4, s33
    s_cmp_lt_u32 s33, 4
    s_cbranch_scc1 K_P2_GWM
    ds_write_b32 v15, v15 offset:56
K_P2_GEMM:
    s_setprio 1
    s_add_u32 s53, s40, 1
    s_and_b32 s53, s53, 2
    s_mov_b32 s46, 0x84210
    s_mov_b32 s47, s46
    s_waitcnt vmcnt(0)
    v_lshlrev_b32 v32, 16, v16
    v_and_b32 v33, 0xffff0000, v16
    v_lshlrev_b32 v34, 16, v17
    v_and_b32 v35, 0xffff0000, v17
    v_lshlrev_b32 v36, 16, v18
    v_and_b32 v37, 0xffff0000, v18
    v_lshlrev_b32 v38, 16, v19
    v_and_b32 v39, 0xffff0000, v19
    v_lshlrev_b32 v40, 16, v20
    v_and_b32 v41, 0xffff0000, v20
    v_lshlrev_b32 v42, 16, v21
    v_and_b32 v43, 0xffff0000, v21
    v_lshlrev_b32 v44, 16, v22
    v_and_b32 v45, 0xffff0000, v22
    v_lshlrev_b32 v46, 16, v23
    v_and_b32 v47, 0xffff0000, v23
    s_branch K_SPL
    s_nop 0
K_IT0:
    v_mfma_f32_32x32x16_bf16 v[108:123], v[156:159], v[68:71], v[108:123]
    ds_read_b64_tr_b16 v[140:141], v56 offset:0
    ds_read_b64_tr_b16 v[142:143], v56 offset:512
    s_and_b32 s33, s50, s70
    s_cbranch_scc0 K_RF0
K_RB0:
    s_ff1_i32_b32 s51, s33
    v_mfma_f32_32x32x16_bf16 v[124:139], v[164:167], v[68:71], v[124:139]
    s_bitset0_b32 s70, s51
    s_lshl_b32 s64, s51, 12
    buffer_load_dwordx4 v[60:63], v52, s[20:23], s64 offen offset:0 sc1
    ds_read_b64_tr_b16 v[144:145], v56 offset:2048
    ds_read_b64_tr_b16 v[146:147], v56 offset:2560
    v_mfma_f32_32x32x16_bf16 v[108:123], v[160:163], v[72:75], v[108:123]
    buffer_load_dwordx4 v[64:67], v52, s[20:23], s64 offen offset:512 sc1
    ds_read_b64_tr_b16 v[148:149], v57 offset:0
    ds_read_b64_tr_b16 v[150:151], v57 offset:512
    s_waitcnt vmcnt(8) lgkmcnt(6)
    v_cmp_u_f32 vcc, v76, v80
    v_mfma_f32_32x32x16_bf16 v[124:139], v[168:171], v[72:75], v[124:139]
    ds_read_b64_tr_b16 v[152:153], v57 offset:2048
    ds_read_b64_tr_b16 v[154:155], v57 offset:2560
    v_and_or_b32 v56, s68, v53, v54
    v_and_or_b32 v57, s68, v53, v55
    s_cbranch_vccnz K_FX1
K_IT1:
    v_mfma_f32_32x32x16_bf16 v[108:123], v[172:175], v[76:79], v[108:123]
    ds_read_b64_tr_b16 v[156:157], v56 offset:0
    ds_read_b64_tr_b16 v[158:159], v56 offset:512
    s_and_b32 s33, s50, s70
    s_cbranch_scc0 K_RF1
K_RB1:
    s_ff1_i32_b32 s51, s33
    v_mfma_f32_32x32x16_bf16 v[124:139], v[180:183], v[76:79], v[124:139]
    s_bitset0_b32 s70, s51
    s_lshl_b32 s65, s51, 12
    buffer_load_dwordx4 v[68:71], v52, s[20:23], s65 offen offset:0 sc1
    ds_read_b64_tr_b16 v[160:161], v56 offset:2048
    ds_read_b64_tr_b16 v[162:163], v56 offset:2560
    v_mfma_f32_32x32x16_bf16 v[108:123], v[176:179], v[80:83], v[108:123]
    buffer_load_dwordx4 v[72:75], v52, s[20:23], s65 offen offset:512 sc1
    ds_read_b64_tr_b16 v[164:165], v57 offset:0
    ds_read_b64_tr_b16 v[166:167], v57 offset:512
    s_waitcnt vmcnt(8) lgkmcnt(6)
    v_cmp_u_f32 vcc, v84, v88
    v_mfma_f32_32x32x16_bf16 v[124:139], v[184:187], v[80:83], v[124:139]
    ds_read_b64_tr_b16 v[168:169], v57 offset:2048
    ds_read_b64_tr_b16 v[170:171], v57 offset:2560
    v_and_or_b32 v56, s69, v53, v54
    v_and_or_b32 v57, s69, v53, v55
    s_cbranch_vccnz K_FX2
K_IT2:
    v_mfma_f32_32x32x16_bf16 v[108:123], v[140:143], v[84:87], v[108:123]
    ds_read_b64_tr_b16 v[172:173], v56 offset:0
    ds_read_b64_tr_b16 v[174:175], v56 offset:512
    s_and_b32 s33, s50, s70
    s_cbranch_scc0 K_RF2
K_RB2:
    s_ff1_i32_b32 s51, s33
    v_mfma_f32_32x32x16_bf16 v[124:139], v[148:151], v[84:87], v[124:139]
    s_bitset0_b32 s70, s51
    s_lshl_b32 s66, s51, 12
    buffer_load_dwordx4 v[76:79], v52, s[20:23], s66 offen offset:0 sc1
    ds_read_b64_tr_b16 v[176:177], v56 offset:2048
    ds_read_b64_tr_b16 v[178:179], v56 offset:2560
    v_mfma_f32_32x32x16_bf16 v[108:123], v[144:147], v[88:91], v[108:123]
    buffer_load_dwordx4 v[80:83], v52, s[20:23], s66 offen offset:512 sc1
    ds_read_b64_tr_b16 v[180:181], v57 offset:0
    ds_read_b64_tr_b16 v[182:183], v57 offset:512
    s_waitcnt vmcnt(8) lgkmcnt(6)
    v_cmp_u_f32 vcc, v92, v96
    v_mfma_f32_32x32x16_bf16 v[124:139], v[152:155], v[88:91], v[124:139]
    ds_read_b64_tr_b16 v[184:185], v57 offset:2048
    ds_read_b64_tr_b16 v[186:187], v57 offset:2560
    v_and_or_b32 v56, s64, v53, v54
    v_and_or_b32 v57, s64, v53, v55
    s_cbranch_vccnz K_FX3
K_IT3:
    v_mfma_f32_32x32x16_bf16 v[108:123], v[156:159], v[92:95], v[108:123]
    ds_read_b64_tr_b16 v[140:141], v56 offset:0
    ds_read_b64_tr_b16 v[142:143], v56 offset:512
    s_and_b32 s33, s50, s70
    s_cbranch_scc0 K_RF3
K_RB3:
    s_ff1_i32_b32 s51, s33
    v_mfma_f32_32x32x16_bf16 v[124:139], v[164:167], v[92:95], v[124:139]
    s_bitset0_b32 s70, s51
    s_lshl_b32 s67, s51, 12
    buffer_load_dwordx4 v[84:87], v52, s[20:23], s67 offen offset:0 sc1
    ds_read_b64_tr_b16 v[144:145], v56 offset:2048
    ds_read_b64_tr_b16 v[146:147], v56 offset:2560
    v_mfma_f32_32x32x16_bf16 v[108:123], v[160:163], v[96:99], v[108:123]
    buffer_load_dwordx4 v[88:91], v52, s[20:23], s67 offen offset:512 sc1
    ds_read_b64_tr_b16 v[148:149], v57 offset:0
    ds_read_b64_tr_b16 v[150:151], v57 offset:512
    s_waitcnt vmcnt(8) lgkmcnt(6)
    v_cmp_u_f32 vcc, v100, v104
    v_mfma_f32_32x32x16_bf16 v[124:139], v[168:171], v[96:99], v[124:139]
    ds_read_b64_tr_b16 v[152:153], v57 offset:2048
    ds_read_b64_tr_b16 v[154:155], v57 offset:2560
    v_and_or_b32 v56, s65, v53, v54
    v_and_or_b32 v57, s65, v53, v55
    s_cbranch_vccnz K_FX4
K_IT4:
    v_mfma_f32_32x32x16_bf16 v[108:123], v[172:175], v[100:103], v[108:123]
    ds_read_b64_tr_b16 v[156:157], v56 offset:0
    ds_read_b64_tr_b16 v[158:159], v56 offset:512
    s_and_b32 s33, s50, s70
    s_cbranch_scc0 K_RF4
K_RB4:
    s_ff1_i32_b32 s51, s33
    v_mfma_f32_32x32x16_bf16 v[124:139], v[180:183], v[100:103], v[124:139]
    s_bitset0_b32 s70, s51
    s_lshl_b32 s68, s51, 12
    buffer_load_dwordx4 v[92:95], v52, s[20:23], s68 offen offset:0 sc1
    ds_read_b64_tr_b16 v[160:161], v56 offset:2048
    ds_read_b64_tr_b16 v[162:163], v56 offset:2560
    v_mfma_f32_32x32x16_bf16 v[108:123], v[176:179], v[104:107], v[108:123]
    buffer_load_dwordx4 v[96:99], v52, s[20:23], s68 offen offset:512 sc1
    ds_read_b64_tr_b16 v[164:165], v57 offset:0
    ds_read_b64_tr_b16 v[166:167], v57 offset:512
    s_waitcnt vmcnt(8) lgkmcnt(6)
    v_cmp_u_f32 vcc, v60, v64
    v_mfma_f32_32x32x16_bf16 v[124:139], v[184:187], v[104:107], v[124:139]
    ds_read_b64_tr_b16 v[168:169], v57 offset:2048
    ds_read_b64_tr_b16 v[170:171], v57 offset:2560
    v_and_or_b32 v56, s66, v53, v54
    v_and_or_b32 v57, s66, v53, v55
    s_cbranch_vccnz K_FX5
K_IT5:
    v_mfma_f32_32x32x16_bf16 v[108:123], v[140:143], v[60:63], v[108:123]
    ds_read_b64_tr_b16 v[172:173], v56 offset:0
    ds_read_b64_tr_b16 v[174:175], v56 offset:512
    s_and_b32 s33, s50, s70
    s_cbranch_scc0 K_RF5
K_RB5:
    s_ff1_i32_b32 s51, s33
    v_mfma_f32_32x32x16_bf16 v[124:139], v[148:151], v[60:63], v[124:139]
    s_bitset0_b32 s70, s51
    s_lshl_b32 s69, s51, 12
    buffer_load_dwordx4 v[100:103], v52, s[20:23], s69 offen offset:0 sc1
    ds_read_b64_tr_b16 v[176:177], v56 offset:2048
    ds_read_b64_tr_b16 v[178:179], v56 offset:2560
    v_mfma_f32_32x32x16_bf16 v[108:123], v[144:147], v[64:67], v[108:123]
    buffer_load_dwordx4 v[104:107], v52, s[20:23], s69 offen offset:512 sc1
    ds_read_b64_tr_b16 v[180:181], v57 offset:0
    ds_read_b64_tr_b16 v[182:183], v57 offset:512
    s_waitcnt vmcnt(8) lgkmcnt(6)
    v_cmp_u_f32 vcc, v68, v72
    v_mfma_f32_32x32x16_bf16 v[124:139], v[152:155], v[64:67], v[124:139]
    ds_read_b64_tr_b16 v[184:185], v57 offset:2048
    ds_read_b64_tr_b16 v[186:187], v57 offset:2560
    v_and_or_b32 v56, s67, v53, v54
    v_and_or_b32 v57, s67, v53, v55
    s_cbranch_vccnz K_FX0
    s_branch K_IT0
    s_nop 0
K_DR0:
    v_mfma_f32_32x32x16_bf16 v[108:123], v[156:159], v[68:71], v[108:123]
    ds_read_b64_tr_b16 v[140:141], v56 offset:0
    ds_read_b64_tr_b16 v[142:143], v56 offset:512
K_DM0:
    s_mov_b32 s64, -1
    v_mov_b32 v60, -1
    v_mfma_f32_32x32x16_bf16 v[124:139], v[164:167], v[68:71], v[124:139]
    buffer_load_dword v3, v52, s[20:23], s64 offen
    ds_read_b64_tr_b16 v[144:145], v56 offset:2048
    ds_read_b64_tr_b16 v[146:147], v56 offset:2560
    v_mfma_f32_32x32x16_bf16 v[108:123], v[160:163], v[72:75], v[108:123]
    buffer_load_dword v3, v52, s[20:23], s64 offen
    ds_read_b64_tr_b16 v[148:149], v57 offset:0
    ds_read_b64_tr_b16 v[150:151], v57 offset:512
    s_waitcnt vmcnt(8) lgkmcnt(6)
    v_cmp_u_f32 vcc, v76, v80
    v_mfma_f32_32x32x16_bf16 v[124:139], v[168:171], v[72:75], v[124:139]
    ds_read_b64_tr_b16 v[152:153], v57 offset:2048
    ds_read_b64_tr_b16 v[154:155], v57 offset:2560
    v_and_or_b32 v56, s68, v53, v54
    v_and_or_b32 v57, s68, v53, v55
    s_cbranch_vccnz K_DX1
K_DR1:
    v_mfma_f32_32x32x16_bf16 v[108:123], v[172:175], v[76:79], v[108:123]
    ds_read_b64_tr_b16 v[156:157], v56 offset:0
    ds_read_b64_tr_b16 v[158:159], v56 offset:512
K_DM1:
    s_mov_b32 s65, -1
    v_mov_b32 v68, -1
    v_mfma_f32_32x32x16_bf16 v[124:139], v[180:183], v[76:79], v[124:139]
    buffer_load_dword v3, v52, s[20:23], s65 offen
    ds_read_b64_tr_b16 v[160:161], v56 offset:2048
    ds_read_b64_tr_b16 v[162:163], v56 offset:2560
    v_mfma_f32_32x32x16_bf16 v[108:123], v[176:179], v[80:83], v[108:123]
    buffer_load_dword v3, v52, s[20:23], s65 offen
    ds_read_b64_tr_b16 v[164:165], v57 offset:0
    ds_read_b64_tr_b16 v[166:167], v57 offset:512
    s_waitcnt vmcnt(8) lgkmcnt(6)
    v_cmp_u_f32 vcc, v84, v88
    v_mfma_f32_32x32x16_bf16 v[124:139], v[184:187], v[80:83], v[124:139]
    ds_read_b64_tr_b16 v[168:169], v57 offset:2048
    ds_read_b64_tr_b16 v[170:171], v57 offset:2560
    v_and_or_b32 v56, s69, v53, v54
    v_and_or_b32 v57, s69, v53, v55
    s_cbranch_vccnz K_DX2
K_DR2:
    v_mfma_f32_32x32x16_bf16 v[108:123], v[140:143], v[84:87], v[108:123]
    ds_read_b64_tr_b16 v[172:173], v56 offset:0
    ds_read_b64_tr_b16 v[174:175], v56 offset:512
K_DM2:
    s_mov_b32 s66, -1
    v_mov_b32 v76, -1
    v_mfma_f32_32x32x16_bf16 v[124:139], v[148:151], v[84:87], v[124:139]
    buffer_load_dword v3, v52, s[20:23], s66 offen
    ds_read_b64_tr_b16 v[176:177], v56 offset:2048
    ds_read_b64_tr_b16 v[178:179], v56 offset:2560
    v_mfma_f32_32x32x16_bf16 v[108:123], v[144:147], v[88:91], v[108:123]
    buffer_load_dword v3, v52, s[20:23], s66 offen
    ds_read_b64_tr_b16 v[180:181], v57 offset:0
    ds_read_b64_tr_b16 v[182:183], v57 offset:512
    s_waitcnt vmcnt(8) lgkmcnt(6)
    v_cmp_u_f32 vcc, v92, v96
    v_mfma_f32_32x32x16_bf16 v[124:139], v[152:155], v[88:91], v[124:139]
    ds_read_b64_tr_b16 v[184:185], v57 offset:2048
    ds_read_b64_tr_b16 v[186:187], v57 offset:2560
    v_and_or_b32 v56, s64, v53, v54
    v_and_or_b32 v57, s64, v53, v55
    s_cbranch_vccnz K_DX3
K_DR3:
    v_mfma_f32_32x32x16_bf16 v[108:123], v[156:159], v[92:95], v[108:123]
    ds_read_b64_tr_b16 v[140:141], v56 offset:0
    ds_read_b64_tr_b16 v[142:143], v56 offset:512
K_DM3:
    s_mov_b32 s67, -1
    v_mov_b32 v84, -1
    v_mfma_f32_32x32x16_bf16 v[124:139], v[164:167], v[92:95], v[124:139]
    buffer_load_dword v3, v52, s[20:23], s67 offen
    ds_read_b64_tr_b16 v[144:145], v56 offset:2048
    ds_read_b64_tr_b16 v[146:147], v56 offset:2560
    v_mfma_f32_32x32x16_bf16 v[108:123], v[160:163], v[96:99], v[108:123]
    buffer_load_dword v3, v52, s[20:23], s67 offen
    ds_read_b64_tr_b16 v[148:149], v57 offset:0
    ds_read_b64_tr_b16 v[150:151], v57 offset:512
    s_waitcnt vmcnt(8) lgkmcnt(6)
    v_cmp_u_f32 vcc, v100, v104
    v_mfma_f32_32x32x16_bf16 v[124:139], v[168:171], v[96:99], v[124:139]
    ds_read_b64_tr_b16 v[152:153], v57 offset:2048
    ds_read_b64_tr_b16 v[154:155], v57 offset:2560
    v_and_or_b32 v56, s65, v53, v54
    v_and_or_b32 v57, s65, v53, v55
    s_cbranch_vccnz K_DX4
K_DR4:
    v_mfma_f32_32x32x16_bf16 v[108:123], v[172:175], v[100:103], v[108:123]
    ds_read_b64_tr_b16 v[156:157], v56 offset:0
    ds_read_b64_tr_b16 v[158:159], v56 offset:512
K_DM4:
    s_mov_b32 s68, -1
    v_mov_b32 v92, -1
    v_mfma_f32_32x32x16_bf16 v[124:139], v[180:183], v[100:103], v[124:139]
    buffer_load_dword v3, v52, s[20:23], s68 offen
    ds_read_b64_tr_b16 v[160:161], v56 offset:2048
    ds_read_b64_tr_b16 v[162:163], v56 offset:2560
    v_mfma_f32_32x32x16_bf16 v[108:123], v[176:179], v[104:107], v[108:123]
    buffer_load_dword v3, v52, s[20:23], s68 offen
    ds_read_b64_tr_b16 v[164:165], v57 offset:0
    ds_read_b64_tr_b16 v[166:167], v57 offset:512
    s_waitcnt vmcnt(8) lgkmcnt(6)
    v_cmp_u_f32 vcc, v60, v64
    v_mfma_f32_32x32x16_bf16 v[124:139], v[184:187], v[104:107], v[124:139]
    ds_read_b64_tr_b16 v[168:169], v57 offset:2048
    ds_read_b64_tr_b16 v[170:171], v57 offset:2560
    v_and_or_b32 v56, s66, v53, v54
    v_and_or_b32 v57, s66, v53, v55
    s_cbranch_vccnz K_DX5
K_DR5:
    v_mfma_f32_32x32x16_bf16 v[108:123], v[140:143], v[60:63], v[108:123]
    ds_read_b64_tr_b16 v[172:173], v56 offset:0
    ds_read_b64_tr_b16 v[174:175], v56 offset:512
K_DM5:
    s_mov_b32 s69, -1
    v_mov_b32 v100, -1
    v_mfma_f32_32x32x16_bf16 v[124:139], v[148:151], v[60:63], v[124:139]
    buffer_load_dword v3, v52, s[20:23], s69 offen
    ds_read_b64_tr_b16 v[176:177], v56 offset:2048
    ds_read_b64_tr_b16 v[178:179], v56 offset:2560
    v_mfma_f32_32x32x16_bf16 v[108:123], v[144:147], v[64:67], v[108:123]
    buffer_load_dword v3, v52, s[20:23], s69 offen
    ds_read_b64_tr_b16 v[180:181], v57 offset:0
    ds_read_b64_tr_b16 v[182:183], v57 offset:512
    s_waitcnt vmcnt(8) lgkmcnt(6)
    v_cmp_u_f32 vcc, v68, v72
    v_mfma_f32_32x32x16_bf16 v[124:139], v[152:155], v[64:67], v[124:139]
    ds_read_b64_tr_b16 v[184:185], v57 offset:2048
    ds_read_b64_tr_b16 v[186:187], v57 offset:2560
    v_and_or_b32 v56, s67, v53, v54
    v_and_or_b32 v57, s67, v53, v55
    s_cbranch_vccnz K_DX0
    s_branch K_DR0
K_CHA1:
K_STA5:
    s_branch K_STA9
K_CHB1:
K_STB5:
    s_branch K_STB9
K_RF0:
    s_cmp_eq_u32 s70, 0
    s_cbranch_scc1 K_DM0
    ds_read_b32 v59, v58
    s_waitcnt lgkmcnt(0)
    v_readfirstlane_b32 s50, v59
    s_and_b32 s33, s50, s70
    s_cbranch_scc1 K_RB0
    v_mfma_f32_32x32x16_bf16 v[124:139], v[164:167], v[68:71], v[124:139]
    s_mov_b32 s64, -1
    v_mov_b32 v60, -1
    buffer_load_dword v3, v52, s[20:23], s64 offen
    ds_read_b64_tr_b16 v[144:145], v56 offset:2048
    ds_read_b64_tr_b16 v[146:147], v56 offset:2560
    v_mfma_f32_32x32x16_bf16 v[108:123], v[160:163], v[72:75], v[108:123]
    buffer_load_dword v3, v52, s[20:23], s64 offen
    ds_read_b64_tr_b16 v[148:149], v57 offset:0
    ds_read_b64_tr_b16 v[150:151], v57 offset:512
    s_waitcnt vmcnt(8) lgkmcnt(6)
    v_cmp_u_f32 vcc, v76, v80
    v_mfma_f32_32x32x16_bf16 v[124:139], v[168:171], v[72:75], v[124:139]
    ds_read_b64_tr_b16 v[152:153], v57 offset:2048
    ds_read_b64_tr_b16 v[154:155], v57 offset:2560
    v_and_or_b32 v56, s68, v53, v54
    v_and_or_b32 v57, s68, v53, v55
    s_cbranch_vccz K_IT1
    s_branch K_FX1
K_TL0:
    s_waitcnt vmcnt(8) lgkmcnt(8)
    v_cmp_u_f32 vcc, v76, v80
    v_and_or_b32 v56, s68, v53, v54
    v_and_or_b32 v57, s68, v53, v55
    s_cbranch_vccz K_IT1
    s_branch K_FX1
K_DX0:
    s_and_b32 s51, s65, s66
    s_and_b32 s51, s51, s67
    s_and_b32 s51, s51, s68
    s_cmp_lt_i32 s51, 0
    s_cbranch_scc1 K_P2_MM
K_FX0:
    s_cmp_lt_i32 s65, 0
    s_cbranch_scc1 K_SK0
    v_max_u32 v2, v68, v72
    v_cmp_eq_u32 vcc, -1, v2
    s_cbranch_vccz K_IT0
    s_sub_u32 s71, s71, 1
    s_cbranch_scc1 K_IT0
    s_lshr_b32 s51, s65, 12
    s_bitset1_b32 s70, s51
K_SK0:
    s_and_b32 s33, s50, s70
    s_cbranch_scc0 K_NUL0
K_BK0:
    s_ff1_i32_b32 s51, s33
    s_lshl_b32 s64, s51, 12
    buffer_load_dwordx4 v[60:63], v52, s[20:23], s64 offen offset:0 sc1
    buffer_load_dwordx4 v[64:67], v52, s[20:23], s64 offen offset:512 sc1
    s_bitset0_b32 s70, s51
K_RD0:
    ds_read_b64_tr_b16 v[140:141], v56 offset:0
    ds_read_b64_tr_b16 v[142:143], v56 offset:512
    ds_read_b64_tr_b16 v[144:145], v56 offset:2048
    ds_read_b64_tr_b16 v[146:147], v56 offset:2560
    ds_read_b64_tr_b16 v[148:149], v57 offset:0
    ds_read_b64_tr_b16 v[150:151], v57 offset:512
    ds_read_b64_tr_b16 v[152:153], v57 offset:2048
    ds_read_b64_tr_b16 v[154:155], v57 offset:2560
    s_cmp_lt_i32 s66, 0
    s_cbranch_scc0 K_TL0
    v_and_or_b32 v56, s68, v53, v54
    v_and_or_b32 v57, s68, v53, v55
    s_branch K_SK1
K_NUL0:
    s_and_b32 s51, s66, s67
    s_and_b32 s51, s51, s68
    s_and_b32 s51, s51, s69
    s_cmp_lt_i32 s51, 0
    s_cbranch_scc0 K_PC0
    s_cmp_eq_u32 s70, 0
    s_cbranch_scc1 K_P2_MM
    s_branch K_SPN
K_PC0:
    s_cmp_eq_u32 s70, 0
    s_cbranch_scc1 K_NI0
    ds_read_b32 v59, v58
    s_waitcnt lgkmcnt(0)
    v_readfirstlane_b32 s50, v59
    s_and_b32 s33, s50, s70
    s_cbranch_scc1 K_BK0
    ds_read_b32 v59, v58
    s_waitcnt lgkmcnt(0)
    v_readfirstlane_b32 s50, v59
    s_and_b32 s33, s50, s70
    s_cbranch_scc1 K_BK0
K_NI0:
    s_mov_b32 s64, -1
    v_mov_b32 v60, -1
    buffer_load_dword v3, v52, s[20:23], s64 offen
    buffer_load_dword v3, v52, s[20:23], s64 offen
    s_branch K_RD0
K_RF1:
    s_cmp_eq_u32 s70, 0
    s_cbranch_scc1 K_DM1
    ds_read_b32 v59, v58
    s_waitcnt lgkmcnt(0)
    v_readfirstlane_b32 s50, v59
    s_and_b32 s33, s50, s70
    s_cbranch_scc1 K_RB1
    v_mfma_f32_32x32x16_bf16 v[124:139], v[180:183], v[76:79], v[124:139]
    s_mov_b32 s65, -1
    v_mov_b32 v68, -1
    buffer_load_dword v3, v52, s[20:23], s65 offen
    ds_read_b64_tr_b16 v[160:161], v56 offset:2048
    ds_read_b64_tr_b16 v[162:163], v56 offset:2560
    v_mfma_f32_32x32x16_bf16 v[108:123], v[176:179], v[80:83], v[108:123]
    buffer_load_dword v3, v52, s[20:23], s65 offen
    ds_read_b64_tr_b16 v[164:165], v57 offset:0
    ds_read_b64_tr_b16 v[166:167], v57 offset:512
    s_waitcnt vmcnt(8) lgkmcnt(6)
    v_cmp_u_f32 vcc, v84, v88
    v_mfma_f32_32x32x16_bf16 v[124:139], v[184:187], v[80:83], v[124:139]
    ds_read_b64_tr_b16 v[168:169], v57 offset:2048
    ds_read_b64_tr_b16 v[170:171], v57 offset:2560
    v_and_or_b32 v56, s69, v53, v54
    v_and_or_b32 v57, s69, v53, v55
    s_cbranch_vccz K_IT2
    s_branch K_FX2
K_CHA2:
K_STA6:
    s_branch K_STA10
K_CHB2:
K_STB6:
    s_branch K_STB10
K_TL1:
    s_waitcnt vmcnt(8) lgkmcnt(8)
    v_cmp_u_f32 vcc, v84, v88
    v_and_or_b32 v56, s69, v53, v54
    v_and_or_b32 v57, s69, v53, v55
    s_cbranch_vccz K_IT2
    s_branch K_FX2
K_DX1:
    s_and_b32 s51, s66, s67
    s_and_b32 s51, s51, s68
    s_and_b32 s51, s51, s69
    s_cmp_lt_i32 s51, 0
    s_cbranch_scc1 K_P2_MM
K_FX1:
    s_cmp_lt_i32 s66, 0
    s_cbranch_scc1 K_SK1
    v_max_u32 v2, v76, v80
    v_cmp_eq_u32 vcc, -1, v2
    s_cbranch_vccz K_IT1
    s_sub_u32 s71, s71, 1
    s_cbranch_scc1 K_IT1
    s_lshr_b32 s51, s66, 12
    s_bitset1_b32 s70, s51
K_SK1:
    s_and_b32 s33, s50, s70
    s_cbranch_scc0 K_NUL1
K_BK1:
    s_ff1_i32_b32 s51, s33
    s_lshl_b32 s65, s51, 12
    buffer_load_dwordx4 v[68:71], v52, s[20:23], s65 offen offset:0 sc1
    buffer_load_dwordx4 v[72:75], v52, s[20:23], s65 offen offset:512 sc1
    s_bitset0_b32 s70, s51
K_RD1:
    ds_read_b64_tr_b16 v[156:157], v56 offset:0
    ds_read_b64_tr_b16 v[158:159], v56 offset:512
    ds_read_b64_tr_b16 v[160:161], v56 offset:2048
    ds_read_b64_tr_b16 v[162:163], v56 offset:2560
    ds_read_b64_tr_b16 v[164:165], v57 offset:0
    ds_read_b64_tr_b16 v[166:167], v57 offset:512
    ds_read_b64_tr_b16 v[168:169], v57 offset:2048
    ds_read_b64_tr_b16 v[170:171], v57 offset:2560
    s_cmp_lt_i32 s67, 0
    s_cbranch_scc0 K_TL1
    v_and_or_b32 v56, s69, v53, v54
    v_and_or_b32 v57, s69, v53, v55
    s_branch K_SK2
K_NUL1:
    s_and_b32 s51, s64, s67
    s_and_b32 s51, s51, s68
    s_and_b32 s51, s51, s69
    s_cmp_lt_i32 s51, 0
    s_cbranch_scc0 K_PC1
    s_cmp_eq_u32 s70, 0
    s_cbranch_scc1 K_P2_MM
    s_branch K_SPN
K_PC1:
    s_cmp_eq_u32 s70, 0
    s_cbranch_scc1 K_NI1
    ds_read_b32 v59, v58
    s_waitcnt lgkmcnt(0)
    v_readfirstlane_b32 s50, v59
    s_and_b32 s33, s50, s70
    s_cbranch_scc1 K_BK1
    ds_read_b32 v59, v58
    s_waitcnt lgkmcnt(0)
    v_readfirstlane_b32 s50, v59
    s_and_b32 s33, s50, s70
    s_cbranch_scc1 K_BK1
K_NI1:
    s_mov_b32 s65, -1
    v_mov_b32 v68, -1
    buffer_load_dword v3, v52, s[20:23], s65 offen
    buffer_load_dword v3, v52, s[20:23], s65 offen
    s_branch K_RD1
K_RF2:
    s_cmp_eq_u32 s70, 0
    s_cbranch_scc1 K_DM2
    ds_read_b32 v59, v58
    s_waitcnt lgkmcnt(0)
    v_readfirstlane_b32 s50, v59
    s_and_b32 s33, s50, s70
    s_cbranch_scc1 K_RB2
    v_mfma_f32_32x32x16_bf16 v[124:139], v[148:151], v[84:87], v[124:139]
    s_mov_b32 s66, -1
    v_mov_b32 v76, -1
    buffer_load_dword v3, v52, s[20:23], s66 offen
    ds_read_b64_tr_b16 v[176:177], v56 offset:2048
    ds_read_b64_tr_b16 v[178:179], v56 offset:2560
    v_mfma_f32_32x32x16_bf16 v[108:123], v[144:147], v[88:91], v[108:123]
    buffer_load_dword v3, v52, s[20:23], s66 offen
    ds_read_b64_tr_b16 v[180:181], v57 offset:0
    ds_read_b64_tr_b16 v[182:183], v57 offset:512
    s_branch K_PG4
.p2align 12
K_CHA3:
K_STA7:
    s_branch K_STA11
K_CHB3:
K_STB7:
    s_branch K_STB11
K_PG4:
    s_waitcnt vmcnt(8) lgkmcnt(6)
    v_cmp_u_f32 vcc, v92, v96
    v_mfma_f32_32x32x16_bf16 v[124:139], v[152:155], v[88:91], v[124:139]
    ds_read_b64_tr_b16 v[184:185], v57 offset:2048
    ds_read_b64_tr_b16 v[186:187], v57 offset:2560
    v_and_or_b32 v56, s64, v53, v54
    v_and_or_b32 v57, s64, v53, v55
    s_cbranch_vccz K_IT3
    s_branch K_FX3
K_TL2:
    s_waitcnt vmcnt(8) lgkmcnt(8)
    v_cmp_u_f32 vcc, v92, v96
    v_and_or_b32 v56, s64, v53, v54
    v_and_or_b32 v57, s64, v53, v55
    s_cbranch_vccz K_IT3
    s_branch K_FX3
K_DX2:
    s_and_b32 s51, s64, s67
    s_and_b32 s51, s51, s68
    s_and_b32 s51, s51, s69
    s_cmp_lt_i32 s51, 0
    s_cbranch_scc1 K_P2_MM
K_FX2:
    s_cmp_lt_i32 s67, 0
    s_cbranch_scc1 K_SK2
    v_max_u32 v2, v84, v88
    v_cmp_eq_u32 vcc, -1, v2
    s_cbranch_vccz K_IT2
    s_sub_u32 s71, s71, 1
    s_cbranch_scc1 K_IT2
    s_lshr_b32 s51, s67, 12
    s_bitset1_b32 s70, s51
K_SK2:
    s_and_b32 s33, s50, s70
    s_cbranch_scc0 K_NUL2
K_BK2:
    s_ff1_i32_b32 s51, s33
    s_lshl_b32 s66, s51, 12
    buffer_load_dwordx4 v[76:79], v52, s[20:23], s66 offen offset:0 sc1
    buffer_load_dwordx4 v[80:83], v52, s[20:23], s66 offen offset:512 sc1
    s_bitset0_b32 s70, s51
K_RD2:
    ds_read_b64_tr_b16 v[172:173], v56 offset:0
    ds_read_b64_tr_b16 v[174:175], v56 offset:512
    ds_read_b64_tr_b16 v[176:177], v56 offset:2048
    ds_read_b64_tr_b16 v[178:179], v56 offset:2560
    ds_read_b64_tr_b16 v[180:181], v57 offset:0
    ds_read_b64_tr_b16 v[182:183], v57 offset:512
    ds_read_b64_tr_b16 v[184:185], v57 offset:2048
    ds_read_b64_tr_b16 v[186:187], v57 offset:2560
    s_cmp_lt_i32 s68, 0
    s_cbranch_scc0 K_TL2
    v_and_or_b32 v56, s64, v53, v54
    v_and_or_b32 v57, s64, v53, v55
    s_branch K_SK3
K_NUL2:
    s_and_b32 s51, s64, s65
    s_and_b32 s51, s51, s68
    s_and_b32 s51, s51, s69
    s_cmp_lt_i32 s51, 0
    s_cbranch_scc0 K_PC2
    s_cmp_eq_u32 s70, 0
    s_cbranch_scc1 K_P2_MM
    s_branch K_SPN
K_PC2:
    s_cmp_eq_u32 s70, 0
    s_cbranch_scc1 K_NI2
    ds_read_b32 v59, v58
    s_waitcnt lgkmcnt(0)
    v_readfirstlane_b32 s50, v59
    s_and_b32 s33, s50, s70
    s_cbranch_scc1 K_BK2
    ds_read_b32 v59, v58
    s_waitcnt lgkmcnt(0)
    v_readfirstlane_b32 s50, v59
    s_and_b32 s33, s50, s70
    s_cbranch_scc1 K_BK2
K_NI2:
    s_mov_b32 s66, -1
    v_mov_b32 v76, -1
    buffer_load_dword v3, v52, s[20:23], s66 offen
    buffer_load_dword v3, v52, s[20:23], s66 offen
    s_branch K_RD2
K_RF3:
    s_cmp_eq_u32 s70, 0
    s_cbranch_scc1 K_DM3
    ds_read_b32 v59, v58
    s_waitcnt lgkmcnt(0)
    v_readfirstlane_b32 s50, v59
    s_and_b32 s33, s50, s70
    s_cbranch_scc1 K_RB3
    v_mfma_f32_32x32x16_bf16 v[124:139], v[164:167], v[92:95], v[124:139]
    s_mov_b32 s67, -1
    v_mov_b32 v84, -1
    buffer_load_dword v3, v52, s[20:23], s67 offen
    ds_read_b64_tr_b16 v[144:145], v56 offset:2048
    ds_read_b64_tr_b16 v[146:147], v56 offset:2560
    v_mfma_f32_32x32x16_bf16 v[108:123], v[160:163], v[96:99], v[108:123]
    buffer_load_dword v3, v52, s[20:23], s67 offen
    ds_read_b64_tr_b16 v[148:149], v57 offset:0
    ds_read_b64_tr_b16 v[150:151], v57 offset:512
    s_waitcnt vmcnt(8) lgkmcnt(6)
    v_cmp_u_f32 vcc, v100, v104
    v_mfma_f32_32x32x16_bf16 v[124:139], v[168:171], v[96:99], v[124:139]
    ds_read_b64_tr_b16 v[152:153], v57 offset:2048
    ds_read_b64_tr_b16 v[154:155], v57 offset:2560
    v_and_or_b32 v56, s65, v53, v54
    v_and_or_b32 v57, s65, v53, v55
    s_cbranch_vccz K_IT4
    s_branch K_FX4
K_STA8:
    s_branch K_STA12
K_STB8:
    s_branch K_STB12
K_TL3:
    s_waitcnt vmcnt(8) lgkmcnt(8)
    v_cmp_u_f32 vcc, v100, v104
    v_and_or_b32 v56, s65, v53, v54
    v_and_or_b32 v57, s65, v53, v55
    s_cbranch_vccz K_IT4
    s_branch K_FX4
K_DX3:
    s_and_b32 s51, s64, s65
    s_and_b32 s51, s51, s68
    s_and_b32 s51, s51, s69
    s_cmp_lt_i32 s51, 0
    s_cbranch_scc1 K_P2_MM
K_FX3:
    s_cmp_lt_i32 s68, 0
    s_cbranch_scc1 K_SK3
    v_max_u32 v2, v92, v96
    v_cmp_eq_u32 vcc, -1, v2
    s_cbranch_vccz K_IT3
    s_sub_u32 s71, s71, 1
    s_cbranch_scc1 K_IT3
    s_lshr_b32 s51, s68, 12
    s_bitset1_b32 s70, s51
K_SK3:
    s_and_b32 s33, s50, s70
    s_cbranch_scc0 K_NUL3
K_BK3:
    s_ff1_i32_b32 s51, s33
    s_lshl_b32 s67, s51, 12
    buffer_load_dwordx4 v[84:87], v52, s[20:23], s67 offen offset:0 sc1
    buffer_load_dwordx4 v[88:91], v52, s[20:23], s67 offen offset:512 sc1
    s_bitset0_b32 s70, s51
K_RD3:
    ds_read_b64_tr_b16 v[140:141], v56 offset:0
    ds_read_b64_tr_b16 v[142:143], v56 offset:512
    ds_read_b64_tr_b16 v[144:145], v56 offset:2048
    ds_read_b64_tr_b16 v[146:147], v56 offset:2560
    ds_read_b64_tr_b16 v[148:149], v57 offset:0
    ds_read_b64_tr_b16 v[150:151], v57 offset:512
    ds_read_b64_tr_b16 v[152:153], v57 offset:2048
    ds_read_b64_tr_b16 v[154:155], v57 offset:2560
    s_cmp_lt_i32 s69, 0
    s_cbranch_scc0 K_TL3
    v_and_or_b32 v56, s65, v53, v54
    v_and_or_b32 v57, s65, v53, v55
    s_branch K_SK4
K_NUL3:
    s_and_b32 s51, s64, s65
    s_and_b32 s51, s51, s66
    s_and_b32 s51, s51, s69
    s_cmp_lt_i32 s51, 0
    s_cbranch_scc0 K_PC3
    s_cmp_eq_u32 s70, 0
    s_cbranch_scc1 K_P2_MM
    s_branch K_SPN
K_PC3:
    s_cmp_eq_u32 s70, 0
    s_cbranch_scc1 K_NI3
    ds_read_b32 v59, v58
    s_waitcnt lgkmcnt(0)
    v_readfirstlane_b32 s50, v59
    s_and_b32 s33, s50, s70
    s_cbranch_scc1 K_BK3
    ds_read_b32 v59, v58
    s_waitcnt lgkmcnt(0)
    v_readfirstlane_b32 s50, v59
    s_and_b32 s33, s50, s70
    s_cbranch_scc1 K_BK3
K_NI3:
    s_mov_b32 s67, -1
    v_mov_b32 v84, -1
    buffer_load_dword v3, v52, s[20:23], s67 offen
    buffer_load_dword v3, v52, s[20:23], s67 offen
    s_branch K_RD3
K_RF4:
    s_cmp_eq_u32 s70, 0
    s_cbranch_scc1 K_DM4
    ds_read_b32 v59, v58
    s_waitcnt lgkmcnt(0)
    v_readfirstlane_b32 s50, v59
    s_and_b32 s33, s50, s70
    s_cbranch_scc1 K_RB4
    v_mfma_f32_32x32x16_bf16 v[124:139], v[180:183], v[100:103], v[124:139]
    s_mov_b32 s68, -1
    v_mov_b32 v92, -1
    buffer_load_dword v3, v52, s[20:23], s68 offen
    ds_read_b64_tr_b16 v[160:161], v56 offset:2048
    ds_read_b64_tr_b16 v[162:163], v56 offset:2560
    v_mfma_f32_32x32x16_bf16 v[108:123], v[176:179], v[104:107], v[108:123]
    buffer_load_dword v3, v52, s[20:23], s68 offen
    ds_read_b64_tr_b16 v[164:165], v57 offset:0
    ds_read_b64_tr_b16 v[166:167], v57 offset:512
    s_waitcnt vmcnt(8) lgkmcnt(6)
    v_cmp_u_f32 vcc, v60, v64
    v_mfma_f32_32x32x16_bf16 v[124:139], v[184:187], v[104:107], v[124:139]
    ds_read_b64_tr_b16 v[168:169], v57 offset:2048
    ds_read_b64_tr_b16 v[170:171], v57 offset:2560
    v_and_or_b32 v56, s66, v53, v54
    v_and_or_b32 v57, s66, v53, v55
    s_cbranch_vccz K_IT5
    s_branch K_FX5
K_TL4:
    s_waitcnt vmcnt(8) lgkmcnt(8)
    v_cmp_u_f32 vcc, v60, v64
    v_and_or_b32 v56, s66, v53, v54
    v_and_or_b32 v57, s66, v53, v55
    s_cbranch_vccz K_IT5
    s_branch K_FX5
K_STA9:
    s_branch K_STA13
K_STB9:
    s_branch K_STB13
K_DX4:
    s_and_b32 s51, s64, s65
    s_and_b32 s51, s51, s66
    s_and_b32 s51, s51, s69
    s_cmp_lt_i32 s51, 0
    s_cbranch_scc1 K_P2_MM
K_FX4:
    s_cmp_lt_i32 s69, 0
    s_cbranch_scc1 K_SK4
    v_max_u32 v2, v100, v104
    v_cmp_eq_u32 vcc, -1, v2
    s_cbranch_vccz K_IT4
    s_sub_u32 s71, s71, 1
    s_cbranch_scc1 K_IT4
    s_lshr_b32 s51, s69, 12
    s_bitset1_b32 s70, s51
K_SK4:
    s_and_b32 s33, s50, s70
    s_cbranch_scc0 K_NUL4
K_BK4:
    s_ff1_i32_b32 s51, s33
    s_lshl_b32 s68, s51, 12
    buffer_load_dwordx4 v[92:95], v52, s[20:23], s68 offen offset:0 sc1
    buffer_load_dwordx4 v[96:99], v52, s[20:23], s68 offen offset:512 sc1
    s_bitset0_b32 s70, s51
K_RD4:
    ds_read_b64_tr_b16 v[156:157], v56 offset:0
    ds_read_b64_tr_b16 v[158:159], v56 offset:512
    ds_read_b64_tr_b16 v[160:161], v56 offset:2048
    ds_read_b64_tr_b16 v[162:163], v56 offset:2560
    ds_read_b64_tr_b16 v[164:165], v57 offset:0
    ds_read_b64_tr_b16 v[166:167], v57 offset:512
    ds_read_b64_tr_b16 v[168:169], v57 offset:2048
    ds_read_b64_tr_b16 v[170:171], v57 offset:2560
    s_cmp_lt_i32 s64, 0
    s_cbranch_scc0 K_TL4
    v_and_or_b32 v56, s66, v53, v54
    v_and_or_b32 v57, s66, v53, v55
    s_branch K_SK5
K_NUL4:
    s_and_b32 s51, s64, s65
    s_and_b32 s51, s51, s66
    s_and_b32 s51, s51, s67
    s_cmp_lt_i32 s51, 0
    s_cbranch_scc0 K_PC4
    s_cmp_eq_u32 s70, 0
    s_cbranch_scc1 K_P2_MM
    s_branch K_SPN
K_PC4:
    s_cmp_eq_u32 s70, 0
    s_cbranch_scc1 K_NI4
    ds_read_b32 v59, v58
    s_waitcnt lgkmcnt(0)
    v_readfirstlane_b32 s50, v59
    s_and_b32 s33, s50, s70
    s_cbranch_scc1 K_BK4
    ds_read_b32 v59, v58
    s_waitcnt lgkmcnt(0)
    v_readfirstlane_b32 s50, v59
    s_and_b32 s33, s50, s70
    s_cbranch_scc1 K_BK4
K_NI4:
    s_mov_b32 s68, -1
    v_mov_b32 v92, -1
    buffer_load_dword v3, v52, s[20:23], s68 offen
    buffer_load_dword v3, v52, s[20:23], s68 offen
    s_branch K_RD4
K_RF5:
    s_cmp_eq_u32 s70, 0
    s_cbranch_scc1 K_DM5
    ds_read_b32 v59, v58
    s_waitcnt lgkmcnt(0)
    v_readfirstlane_b32 s50, v59
    s_and_b32 s33, s50, s70
    s_cbranch_scc1 K_RB5
    v_mfma_f32_32x32x16_bf16 v[124:139], v[148:151], v[60:63], v[124:139]
    s_mov_b32 s69, -1
    v_mov_b32 v100, -1
    buffer_load_dword v3, v52, s[20:23], s69 offen
    ds_read_b64_tr_b16 v[176:177], v56 offset:2048
    ds_read_b64_tr_b16 v[178:179], v56 offset:2560
    v_mfma_f32_32x32x16_bf16 v[108:123], v[144:147], v[64:67], v[108:123]
    buffer_load_dword v3, v52, s[20:23], s69 offen
    ds_read_b64_tr_b16 v[180:181], v57 offset:0
    ds_read_b64_tr_b16 v[182:183], v57 offset:512
    s_waitcnt vmcnt(8) lgkmcnt(6)
    v_cmp_u_f32 vcc, v68, v72
    v_mfma_f32_32x32x16_bf16 v[124:139], v[152:155], v[64:67], v[124:139]
    ds_read_b64_tr_b16 v[184:185], v57 offset:2048
    ds_read_b64_tr_b16 v[186:187], v57 offset:2560
    v_and_or_b32 v56, s67, v53, v54
    v_and_or_b32 v57, s67, v53, v55
    s_cbranch_vccz K_IT0
    s_branch K_FX0
K_TL5:
    s_waitcnt vmcnt(8) lgkmcnt(8)
    v_cmp_u_f32 vcc, v68, v72
    v_and_or_b32 v56, s67, v53, v54
    v_and_or_b32 v57, s67, v53, v55
    s_cbranch_vccz K_IT0
    s_branch K_FX0
K_DX5:
    s_and_b32 s51, s64, s65
    s_and_b32 s51, s51, s66
    s_and_b32 s51, s51, s67
    s_cmp_lt_i32 s51, 0
    s_cbranch_scc1 K_P2_MM
K_FX5:
    s_cmp_lt_i32 s64, 0
    s_cbranch_scc1 K_SK5
    v_max_u32 v2, v60, v64
    v_cmp_eq_u32 vcc, -1, v2
    s_cbranch_vccz K_IT5
    s_sub_u32 s71, s71, 1
    s_cbranch_scc1 K_IT5
    s_lshr_b32 s51, s64, 12
    s_bitset1_b32 s70, s51
K_SK5:
    s_and_b32 s33, s50, s70
    s_cbranch_scc0 K_NUL5
K_BK5:
    s_ff1_i32_b32 s51, s33
    s_lshl_b32 s69, s51, 12
    buffer_load_dwordx4 v[100:103], v52, s[20:23], s69 offen offset:0 sc1
    buffer_load_dwordx4 v[104:107], v52, s[20:23], s69 offen offset:512 sc1
    s_bitset0_b32 s70, s51
K_RD5:
    ds_read_b64_tr_b16 v[172:173], v56 offset:0
    ds_read_b64_tr_b16 v[174:175], v56 offset:512
    ds_read_b64_tr_b16 v[176:177], v56 offset:2048
    ds_read_b64_tr_b16 v[178:179], v56 offset:2560
    ds_read_b64_tr_b16 v[180:181], v57 offset:0
    ds_read_b64_tr_b16 v[182:183], v57 offset:512
    ds_read_b64_tr_b16 v[184:185], v57 offset:2048
    ds_read_b64_tr_b16 v[186:187], v57 offset:2560
    s_cmp_lt_i32 s65, 0
    s_cbranch_scc0 K_TL5
    v_and_or_b32 v56, s67, v53, v54
    v_and_or_b32 v57, s67, v53, v55
    s_branch K_SK0
K_STA10:
    s_branch K_STA14
K_STB10:
    s_branch K_STB14
K_NUL5:
    s_and_b32 s51, s65, s66
    s_and_b32 s51, s51, s67
    s_and_b32 s51, s51, s68
    s_cmp_lt_i32 s51, 0
    s_cbranch_scc0 K_PC5
    s_cmp_eq_u32 s70, 0
    s_cbranch_scc1 K_P2_MM
    s_branch K_SPN
K_PC5:
    s_cmp_eq_u32 s70, 0
    s_cbranch_scc1 K_NI5
    ds_read_b32 v59, v58
    s_waitcnt lgkmcnt(0)
    v_readfirstlane_b32 s50, v59
    s_and_b32 s33, s50, s70
    s_cbranch_scc1 K_BK5
    ds_read_b32 v59, v58
    s_waitcnt lgkmcnt(0)
    v_readfirstlane_b32 s50, v59
    s_and_b32 s33, s50, s70
    s_cbranch_scc1 K_BK5
K_NI5:
    s_mov_b32 s69, -1
    v_mov_b32 v100, -1
    buffer_load_dword v3, v52, s[20:23], s69 offen
    buffer_load_dword v3, v52, s[20:23], s69 offen
    s_branch K_RD5
K_P2_MM:
    v_cvt_pk_bf16_f32 v188, v108, v109
    v_cvt_pk_bf16_f32 v189, v110, v111
    ds_write_b64 v50, v[188:189] offset:0
    v_cvt_pk_bf16_f32 v190, v112, v113
    v_cvt_pk_bf16_f32 v191, v114, v115
    ds_write_b64 v50, v[190:191] offset:16
    v_cvt_pk_bf16_f32 v192, v116, v117
    v_cvt_pk_bf16_f32 v193, v118, v119
    ds_write_b64 v50, v[192:193] offset:32
    v_cvt_pk_bf16_f32 v194, v120, v121
    v_cvt_pk_bf16_f32 v195, v122, v123
    ds_write_b64 v50, v[194:195] offset:48
    v_cvt_pk_bf16_f32 v188, v124, v125
    v_cvt_pk_bf16_f32 v189, v126, v127
    ds_write_b64 v50, v[188:189] offset:64
    v_cvt_pk_bf16_f32 v190, v128, v129
    v_cvt_pk_bf16_f32 v191, v130, v131
    ds_write_b64 v50, v[190:191] offset:80
    v_cvt_pk_bf16_f32 v192, v132, v133
    v_cvt_pk_bf16_f32 v193, v134, v135
    ds_write_b64 v50, v[192:193] offset:96
    v_cvt_pk_bf16_f32 v194, v136, v137
    v_cvt_pk_bf16_f32 v195, v138, v139
    ds_write_b64 v50, v[194:195] offset:112
K_P2_E2:
    s_waitcnt vmcnt(0) lgkmcnt(0)
    s_lshl_b32 s72, s61, 4
    s_barrier
    ds_read_b64 v[28:29], v15
    ds_read_b64 v[24:25], v11
    ds_read_b128 v[48:51], v14
    ds_read_b64 v[26:27], v11 offset:64
    ds_read_b128 v[52:55], v14 offset:1152
    s_waitcnt lgkmcnt(4)
    v_readfirstlane_b32 s48, v28
    v_readfirstlane_b32 s49, v29
    s_sub_u32 s3, s48, s72
    s_cmp_lt_u32 s3, 16
    s_cbranch_scc1 K_YROW0
K_NOY0:
    s_sub_u32 s3, s49, s72
    s_cmp_lt_u32 s3, 16
    s_cbranch_scc1 K_YROW1
K_NOY1:
    s_waitcnt lgkmcnt(3)
    v_pk_mul_f32 v[32:33], v[32:33], v[24:25] op_sel:[0,1] op_sel_hi:[1,1]
    v_pk_mul_f32 v[34:35], v[34:35], v[24:25] op_sel:[0,1] op_sel_hi:[1,1]
    v_pk_mul_f32 v[36:37], v[36:37], v[24:25] op_sel:[0,1] op_sel_hi:[1,1]
    v_pk_mul_f32 v[38:39], v[38:39], v[24:25] op_sel:[0,1] op_sel_hi:[1,1]
    s_waitcnt lgkmcnt(2)
    v_lshlrev_b32 v68, 16, v48
    v_and_b32 v69, 0xffff0000, v48
    v_pk_fma_f32 v[68:69], v[68:69], v[24:25], v[32:33] op_sel_hi:[1,0,1]
    v_cvt_pk_bf16_f32 v48, v68, v69
    v_lshlrev_b32 v70, 16, v49
    v_and_b32 v71, 0xffff0000, v49
    v_pk_fma_f32 v[70:71], v[70:71], v[24:25], v[34:35] op_sel_hi:[1,0,1]
    v_cvt_pk_bf16_f32 v49, v70, v71
    v_lshlrev_b32 v68, 16, v50
    v_and_b32 v69, 0xffff0000, v50
    v_pk_fma_f32 v[68:69], v[68:69], v[24:25], v[36:37] op_sel_hi:[1,0,1]
    v_cvt_pk_bf16_f32 v50, v68, v69
    v_lshlrev_b32 v70, 16, v51
    v_and_b32 v71, 0xffff0000, v51
    v_pk_fma_f32 v[70:71], v[70:71], v[24:25], v[38:39] op_sel_hi:[1,0,1]
    v_cvt_pk_bf16_f32 v51, v70, v71
    buffer_store_dwordx4 v[48:51], v10, s[56:59], 0 offen sc1
    s_waitcnt lgkmcnt(1)
    v_pk_mul_f32 v[40:41], v[40:41], v[26:27] op_sel:[0,1] op_sel_hi:[1,1]
    v_pk_mul_f32 v[42:43], v[42:43], v[26:27] op_sel:[0,1] op_sel_hi:[1,1]
    v_pk_mul_f32 v[44:45], v[44:45], v[26:27] op_sel:[0,1] op_sel_hi:[1,1]
    v_pk_mul_f32 v[46:47], v[46:47], v[26:27] op_sel:[0,1] op_sel_hi:[1,1]
    s_waitcnt lgkmcnt(0)
    v_lshlrev_b32 v68, 16, v52
    v_and_b32 v69, 0xffff0000, v52
    v_pk_fma_f32 v[68:69], v[68:69], v[26:27], v[40:41] op_sel_hi:[1,0,1]
    v_cvt_pk_bf16_f32 v52, v68, v69
    v_lshlrev_b32 v70, 16, v53
    v_and_b32 v71, 0xffff0000, v53
    v_pk_fma_f32 v[70:71], v[70:71], v[26:27], v[42:43] op_sel_hi:[1,0,1]
    v_cvt_pk_bf16_f32 v53, v70, v71
    v_lshlrev_b32 v68, 16, v54
    v_and_b32 v69, 0xffff0000, v54
    v_pk_fma_f32 v[68:69], v[68:69], v[26:27], v[44:45] op_sel_hi:[1,0,1]
    v_cvt_pk_bf16_f32 v54, v68, v69
    v_lshlrev_b32 v70, 16, v55
    v_and_b32 v71, 0xffff0000, v55
    v_pk_fma_f32 v[70:71], v[70:71], v[26:27], v[46:47] op_sel_hi:[1,0,1]
    v_cvt_pk_bf16_f32 v55, v70, v71
    buffer_store_dwordx4 v[52:55], v10, s[56:59], s63 offen sc1
K_END:
K_EXIT:
    s_endpgm
K_YROW0:
    v_and_b32 v2, 7, v1
    v_lshlrev_b32 v2, 5, v2
    v_add_u32 v2, 158976, v2
    ds_read_b128 v[56:59], v2
    ds_read_b128 v[60:63], v2 offset:16
    s_and_b32 s33, s3, 7
    v_cmp_eq_u32 vcc, s33, v8
    s_cmp_ge_u32 s3, 8
    s_cbranch_scc1 K_YR1_0
    s_waitcnt lgkmcnt(0)
    v_add_f32 v64, v32, v56
    v_cvt_pk_bf16_f32 v64, v64, v64
    v_lshlrev_b32 v64, 16, v64
    v_cndmask_b32 v32, v32, v64, vcc
    v_add_f32 v65, v33, v57
    v_cvt_pk_bf16_f32 v65, v65, v65
    v_lshlrev_b32 v65, 16, v65
    v_cndmask_b32 v33, v33, v65, vcc
    v_add_f32 v66, v34, v58
    v_cvt_pk_bf16_f32 v66, v66, v66
    v_lshlrev_b32 v66, 16, v66
    v_cndmask_b32 v34, v34, v66, vcc
    v_add_f32 v67, v35, v59
    v_cvt_pk_bf16_f32 v67, v67, v67
    v_lshlrev_b32 v67, 16, v67
    v_cndmask_b32 v35, v35, v67, vcc
    v_add_f32 v64, v36, v60
    v_cvt_pk_bf16_f32 v64, v64, v64
    v_lshlrev_b32 v64, 16, v64
    v_cndmask_b32 v36, v36, v64, vcc
    v_add_f32 v65, v37, v61
    v_cvt_pk_bf16_f32 v65, v65, v65
    v_lshlrev_b32 v65, 16, v65
    v_cndmask_b32 v37, v37, v65, vcc
    v_add_f32 v66, v38, v62
    v_cvt_pk_bf16_f32 v66, v66, v66
    v_lshlrev_b32 v66, 16, v66
    v_cndmask_b32 v38, v38, v66, vcc
    v_add_f32 v67, v39, v63
    v_cvt_pk_bf16_f32 v67, v67, v67
    v_lshlrev_b32 v67, 16, v67
    v_cndmask_b32 v39, v39, v67, vcc
    s_branch K_NOY0
K_YR1_0:
    s_waitcnt lgkmcnt(0)
    v_add_f32 v64, v40, v56
    v_cvt_pk_bf16_f32 v64, v64, v64
    v_lshlrev_b32 v64, 16, v64
    v_cndmask_b32 v40, v40, v64, vcc
    v_add_f32 v65, v41, v57
    v_cvt_pk_bf16_f32 v65, v65, v65
    v_lshlrev_b32 v65, 16, v65
    v_cndmask_b32 v41, v41, v65, vcc
    v_add_f32 v66, v42, v58
    v_cvt_pk_bf16_f32 v66, v66, v66
    v_lshlrev_b32 v66, 16, v66
    v_cndmask_b32 v42, v42, v66, vcc
    v_add_f32 v67, v43, v59
    v_cvt_pk_bf16_f32 v67, v67, v67
    v_lshlrev_b32 v67, 16, v67
    v_cndmask_b32 v43, v43, v67, vcc
    v_add_f32 v64, v44, v60
    v_cvt_pk_bf16_f32 v64, v64, v64
    v_lshlrev_b32 v64, 16, v64
    v_cndmask_b32 v44, v44, v64, vcc
    v_add_f32 v65, v45, v61
    v_cvt_pk_bf16_f32 v65, v65, v65
    v_lshlrev_b32 v65, 16, v65
    v_cndmask_b32 v45, v45, v65, vcc
    v_add_f32 v66, v46, v62
    v_cvt_pk_bf16_f32 v66, v66, v66
    v_lshlrev_b32 v66, 16, v66
    v_cndmask_b32 v46, v46, v66, vcc
    v_add_f32 v67, v47, v63
    v_cvt_pk_bf16_f32 v67, v67, v67
    v_lshlrev_b32 v67, 16, v67
    v_cndmask_b32 v47, v47, v67, vcc
    s_branch K_NOY0
K_YROW1:
    v_and_b32 v2, 7, v1
    v_lshlrev_b32 v2, 5, v2
    v_add_u32 v2, 159232, v2
    ds_read_b128 v[56:59], v2
    ds_read_b128 v[60:63], v2 offset:16
    s_and_b32 s33, s3, 7
    v_cmp_eq_u32 vcc, s33, v8
    s_cmp_ge_u32 s3, 8
    s_cbranch_scc1 K_YR1_1
    s_waitcnt lgkmcnt(0)
    v_add_f32 v64, v32, v56
    v_cvt_pk_bf16_f32 v64, v64, v64
    v_lshlrev_b32 v64, 16, v64
    v_cndmask_b32 v32, v32, v64, vcc
    v_add_f32 v65, v33, v57
    v_cvt_pk_bf16_f32 v65, v65, v65
    v_lshlrev_b32 v65, 16, v65
    v_cndmask_b32 v33, v33, v65, vcc
    v_add_f32 v66, v34, v58
    v_cvt_pk_bf16_f32 v66, v66, v66
    v_lshlrev_b32 v66, 16, v66
    v_cndmask_b32 v34, v34, v66, vcc
    v_add_f32 v67, v35, v59
    v_cvt_pk_bf16_f32 v67, v67, v67
    v_lshlrev_b32 v67, 16, v67
    v_cndmask_b32 v35, v35, v67, vcc
    v_add_f32 v64, v36, v60
    v_cvt_pk_bf16_f32 v64, v64, v64
    v_lshlrev_b32 v64, 16, v64
    v_cndmask_b32 v36, v36, v64, vcc
    v_add_f32 v65, v37, v61
    v_cvt_pk_bf16_f32 v65, v65, v65
    v_lshlrev_b32 v65, 16, v65
    v_cndmask_b32 v37, v37, v65, vcc
    v_add_f32 v66, v38, v62
    v_cvt_pk_bf16_f32 v66, v66, v66
    v_lshlrev_b32 v66, 16, v66
    v_cndmask_b32 v38, v38, v66, vcc
    v_add_f32 v67, v39, v63
    v_cvt_pk_bf16_f32 v67, v67, v67
    v_lshlrev_b32 v67, 16, v67
    v_cndmask_b32 v39, v39, v67, vcc
    s_branch K_NOY1
K_YR1_1:
    s_waitcnt lgkmcnt(0)
    v_add_f32 v64, v40, v56
    v_cvt_pk_bf16_f32 v64, v64, v64
    v_lshlrev_b32 v64, 16, v64
    v_cndmask_b32 v40, v40, v64, vcc
    v_add_f32 v65, v41, v57
    v_cvt_pk_bf16_f32 v65, v65, v65
    v_lshlrev_b32 v65, 16, v65
    v_cndmask_b32 v41, v41, v65, vcc
    v_add_f32 v66, v42, v58
    v_cvt_pk_bf16_f32 v66, v66, v66
    v_lshlrev_b32 v66, 16, v66
    v_cndmask_b32 v42, v42, v66, vcc
    v_add_f32 v67, v43, v59
    v_cvt_pk_bf16_f32 v67, v67, v67
    v_lshlrev_b32 v67, 16, v67
    v_cndmask_b32 v43, v43, v67, vcc
    v_add_f32 v64, v44, v60
    v_cvt_pk_bf16_f32 v64, v64, v64
    v_lshlrev_b32 v64, 16, v64
    v_cndmask_b32 v44, v44, v64, vcc
    v_add_f32 v65, v45, v61
    v_cvt_pk_bf16_f32 v65, v65, v65
    v_lshlrev_b32 v65, 16, v65
    v_cndmask_b32 v45, v45, v65, vcc
    v_add_f32 v66, v46, v62
    v_cvt_pk_bf16_f32 v66, v66, v66
    v_lshlrev_b32 v66, 16, v66
    v_cndmask_b32 v46, v46, v66, vcc
    v_add_f32 v67, v47, v63
    v_cvt_pk_bf16_f32 v67, v67, v67
    v_lshlrev_b32 v67, 16, v67
    v_cndmask_b32 v47, v47, v67, vcc
    s_branch K_NOY1
K_STA11:
    s_branch K_STA15
K_STB11:
    s_branch K_STB15
K_P2:
    s_cmp_ge_u32 s30, 4
    s_cbranch_scc1 K_P2_HELP
    s_lshl_b32 s62, s40, 7
    v_lshrrev_b32 v8, 3, v1
    v_lshrrev_b32 v9, 4, v1
    v_mov_b32 v15, 158720
    s_lshl_b32 s61, s40, 3
    s_add_u32 s61, s61, s30
    s_mul_i32 s3, s61, 20480
    s_lshl_b32 s33, s41, 7
    s_add_u32 s3, s3, s33
    v_and_b32 v2, 7, v1
    v_lshlrev_b32 v2, 4, v2
    v_mul_u32_u24 v4, 1280, v8
    v_add3_u32 v10, v2, v4, s3
    s_lshl_b32 s3, s30, 7
    s_add_u32 s3, s3, 159744
    v_lshl_add_u32 v11, v8, 3, s3
    s_mov_b32 s63, 10240
    s_add_u32 s20, s6, 0x100000
    s_addc_u32 s21, s7, 0
    s_mov_b32 s22, 0x280000
    s_mov_b32 s23, 0x20000
    s_mov_b32 s56, s10
    s_mov_b32 s57, s11
    s_mov_b32 s58, 0x280000
    s_mov_b32 s59, 0x20000
    v_mul_u32_u24 v3, 144, v8
    v_add_u32 v3, v2, v3
    s_mul_i32 s3, s30, 2304
    s_add_u32 s3, s3, 140288
    v_add_u32 v14, s3, v3
    buffer_load_dwordx4 v[16:19], v10, s[12:15], 0 offen
    buffer_load_dwordx4 v[20:23], v10, s[12:15], s63 offen
    v_bfe_u32 v48, v1, 2, 2
    v_and_b32 v49, 3, v1
    s_add_u32 s3, s61, s30
    s_lshr_b32 s33, s3, 2
    s_mul_i32 s33, s33, 76
    s_add_u32 s3, s3, s33
    s_lshl_b32 s3, s3, 10
    v_and_b32 v2, 15, v1
    v_lshl_add_u32 v2, v2, 4, s3
    v_lshrrev_b32 v3, 5, v1
    v_lshl_add_u32 v2, v3, 8, v2
    v_and_b32 v4, 1, v9
    v_lshl_add_u32 v52, v4, 10, v2
    v_mov_b32 v53, 0x1f000
    v_lshl_add_u32 v2, v3, 3, v48
    v_lshlrev_b32 v2, 7, v2
    v_lshl_add_u32 v2, v49, 3, v2
    v_lshl_add_u32 v2, v4, 5, v2
    v_lshrrev_b32 v4, 1, v48
    v_lshl_add_u32 v54, v4, 6, v2
    v_xor_b32 v55, 64, v54
    v_mov_b32 v56, v54
    v_mov_b32 v57, v54
    v_and_b32 v2, 31, v1
    v_mul_u32_u24 v2, 144, v2
    v_lshl_add_u32 v2, v3, 3, v2
    s_mul_i32 s3, s30, 4608
    s_add_u32 s3, s3, 140288
    v_add_u32 v50, s3, v2
    s_and_b32 s33, s40, 3
    s_lshl_b32 s33, s33, 2
    s_lshr_b32 s33, 0xf63f, s33
    s_and_b32 s33, s33, 15
    s_lshl1_add_u32 s3, s30, 1
    s_cmp_ge_u32 s3, s33
    s_cselect_b32 s60, 24, 16
    s_cmp_gt_u32 s3, s33
    s_cselect_b32 s60, 20, s60
    v_add_u32 v58, s60, v15
    s_mov_b32 s64, -1
    s_mov_b32 s65, -1
    s_mov_b32 s66, -1
    s_mov_b32 s67, -1
    s_mov_b32 s68, -1
    s_mov_b32 s69, -1
    s_mov_b32 s70, 0xfffff
    s_mov_b32 s71, 131072
    v_mov_b32 v108, 0
    v_mov_b32 v109, 0
    v_mov_b32 v110, 0
    v_mov_b32 v111, 0
    v_mov_b32 v112, 0
    v_mov_b32 v113, 0
    v_mov_b32 v114, 0
    v_mov_b32 v115, 0
    v_mov_b32 v116, 0
    v_mov_b32 v117, 0
    v_mov_b32 v118, 0
    v_mov_b32 v119, 0
    v_mov_b32 v120, 0
    v_mov_b32 v121, 0
    v_mov_b32 v122, 0
    v_mov_b32 v123, 0
    v_mov_b32 v124, 0
    v_mov_b32 v125, 0
    v_mov_b32 v126, 0
    v_mov_b32 v127, 0
    v_mov_b32 v128, 0
    v_mov_b32 v129, 0
    v_mov_b32 v130, 0
    v_mov_b32 v131, 0
    v_mov_b32 v132, 0
    v_mov_b32 v133, 0
    v_mov_b32 v134, 0
    v_mov_b32 v135, 0
    v_mov_b32 v136, 0
    v_mov_b32 v137, 0
    v_mov_b32 v138, 0
    v_mov_b32 v139, 0
K_P2_AUXW:
    v_lshrrev_b32 v2, 3, v1
    v_mul_u32_u24 v2, 1280, v2
    v_lshrrev_b32 v3, 2, v1
    v_and_b32 v3, 4, v3
    v_and_b32 v4, 7, v1
    v_xor_b32 v3, v3, v4
    v_lshl_add_u32 v2, v3, 4, v2
    s_lshl_b32 s33, s41, 7
    v_add_u32 v51, s33, v2
    v_lshrrev_b32 v5, 5, v1
    v_mul_u32_u24 v5, 20480, v5
    v_add_u32 v5, v5, v51
    s_lshl_b32 s52, s30, 2
    s_lshr_b32 s52, 0x7520, s52
    s_and_b32 s52, s52, 7
    s_mul_i32 s52, s52, 51200
    s_lshl_b32 s53, s30, 12
    s_add_u32 s60, s52, 0
    s_add_u32 m0, s53, 0
    s_waitcnt vmcnt(5)
    buffer_load_dwordx4 v51, s[24:27], s60 offen lds
    s_add_u32 s60, s52, 10240
    s_add_u32 m0, s53, 1024
    s_waitcnt vmcnt(5)
    buffer_load_dwordx4 v51, s[24:27], s60 offen lds
    s_add_u32 s60, s52, 25600
    s_add_u32 m0, s53, 2048
    s_waitcnt vmcnt(5)
    buffer_load_dwordx4 v51, s[24:27], s60 offen lds
    s_add_u32 s60, s52, 35840
    s_add_u32 m0, s53, 3072
    s_waitcnt vmcnt(5)
    buffer_load_dwordx4 v51, s[24:27], s60 offen lds
    s_add_u32 s60, s52, 409600
    s_add_u32 m0, s53, 20480
    s_waitcnt vmcnt(5)
    buffer_load_dwordx4 v51, s[24:27], s60 offen lds
    s_add_u32 s60, s52, 419840
    s_branch K_PG5
.p2align 12
K_STA12:
    s_branch K_WRET_A
K_STB12:
    s_branch K_WRET_B
K_PG5:
    s_add_u32 m0, s53, 21504
    s_waitcnt vmcnt(5)
    buffer_load_dwordx4 v51, s[24:27], s60 offen lds
    v_mov_b32 v3, 1
    s_mov_b64 exec, 1
    ds_add_u32 v15, v3 offset:52
    s_mov_b64 exec, -1
    s_add_u32 s60, s52, 435200
    s_add_u32 m0, s53, 22528
    s_waitcnt vmcnt(5)
    buffer_load_dwordx4 v51, s[24:27], s60 offen lds
    s_add_u32 s60, s52, 445440
    s_add_u32 m0, s53, 23552
    s_waitcnt vmcnt(5)
    buffer_load_dwordx4 v51, s[24:27], s60 offen lds
    s_lshl_b32 s53, s30, 10
    s_add_u32 s60, s52, 20480
    s_add_u32 m0, s53, 16384
    s_waitcnt vmcnt(5)
    buffer_load_dwordx4 v5, s[24:27], s60 offen lds
    s_add_u32 s60, s52, 430080
    s_add_u32 m0, s53, 36864
    s_waitcnt vmcnt(5)
    buffer_load_dwordx4 v5, s[24:27], s60 offen lds
    s_cmp_eq_u32 s30, 0
    s_cbranch_scc1 K_CHA0
    s_cmp_eq_u32 s30, 1
    s_cbranch_scc1 K_CHA1
    s_cmp_eq_u32 s30, 2
    s_cbranch_scc1 K_CHA2
    s_branch K_CHA3
K_WRET_A:
    v_mov_b32 v3, 1
    s_waitcnt vmcnt(0)
    s_mov_b64 exec, 1
    ds_add_u32 v15, v3 offset:44
    s_mov_b64 exec, -1
    s_mov_b32 s3, 1048576
K_P2_GWA:
    ds_read_b32 v2, v15 offset:44
    s_sub_u32 s3, s3, 1
    s_waitcnt lgkmcnt(0)
    v_readfirstlane_b32 s33, v2
    s_nop 3
    s_cselect_b32 s33, 4, s33
    s_cmp_lt_u32 s33, 4
    s_cbranch_scc1 K_P2_GWA
    s_branch K_P2_GEMM
K_P2_HELP:
    s_setprio 3
    s_cmp_eq_u32 s30, 7
    s_cbranch_scc1 K_P2_W7
    s_cmp_eq_u32 s30, 4
    s_cbranch_scc1 K_P2_NL
    s_cmp_ge_u32 s29, 8
    s_cbranch_scc1 K_P2_NL
    s_mov_b32 s24, s8
    s_mov_b32 s25, s9
    s_mov_b32 s26, 0xc8000
    s_mov_b32 s27, 0x20000
    v_lshrrev_b32 v2, 3, v1
    v_mul_u32_u24 v2, 1280, v2
    v_lshrrev_b32 v3, 2, v1
    v_and_b32 v3, 4, v3
    v_and_b32 v4, 7, v1
    v_xor_b32 v3, v3, v4
    v_lshl_add_u32 v2, v3, 4, v2
    s_lshl_b32 s33, s41, 7
    v_add_u32 v12, s33, v2
    v_lshrrev_b32 v5, 5, v1
    v_mul_u32_u24 v5, 20480, v5
    v_add_u32 v5, v5, v12
    s_sub_u32 s61, s30, 5
    s_lshl_b32 s52, s61, 2
    s_lshr_b32 s52, 0x6431, s52
    s_and_b32 s52, s52, 7
    s_mul_i32 s52, s52, 51200
    s_lshl_b32 s53, s61, 12
    s_add_u32 s60, s52, 0
    s_add_u32 m0, s53, 40960
    s_nop 0
    buffer_load_dwordx4 v12, s[24:27], s60 offen lds
    s_add_u32 s60, s52, 10240
    s_add_u32 m0, s53, 41984
    s_nop 0
    buffer_load_dwordx4 v12, s[24:27], s60 offen lds
    s_add_u32 s60, s52, 25600
    s_add_u32 m0, s53, 43008
    s_nop 0
    buffer_load_dwordx4 v12, s[24:27], s60 offen lds
    s_add_u32 s60, s52, 35840
    s_add_u32 m0, s53, 44032
    s_nop 0
    buffer_load_dwordx4 v12, s[24:27], s60 offen lds
    s_add_u32 s60, s52, 409600
    s_add_u32 m0, s53, 61440
    s_nop 0
    buffer_load_dwordx4 v12, s[24:27], s60 offen lds
    s_add_u32 s60, s52, 419840
    s_add_u32 m0, s53, 62464
    s_nop 0
    buffer_load_dwordx4 v12, s[24:27], s60 offen lds
    s_add_u32 s60, s52, 435200
    s_add_u32 m0, s53, 63488
    s_nop 0
    buffer_load_dwordx4 v12, s[24:27], s60 offen lds
    s_add_u32 s60, s52, 445440
    s_add_u32 m0, s53, 64512
    s_nop 0
    buffer_load_dwordx4 v12, s[24:27], s60 offen lds
    s_lshl_b32 s53, s61, 10
    s_add_u32 s60, s52, 20480
    s_add_u32 m0, s53, 57344
    s_nop 0
    buffer_load_dwordx4 v5, s[24:27], s60 offen lds
    s_add_u32 s60, s52, 430080
    s_add_u32 m0, s53, 77824
    s_nop 0
    buffer_load_dwordx4 v5, s[24:27], s60 offen lds
    s_add_u32 s61, s61, 2
    s_lshl_b32 s52, s61, 2
    s_lshr_b32 s52, 0x6431, s52
    s_and_b32 s52, s52, 7
    s_mul_i32 s52, s52, 51200
    s_lshl_b32 s53, s61, 12
    s_add_u32 s60, s52, 0
    s_add_u32 m0, s53, 40960
    s_nop 0
    buffer_load_dwordx4 v12, s[24:27], s60 offen lds
    s_add_u32 s60, s52, 10240
    s_add_u32 m0, s53, 41984
    s_nop 0
    buffer_load_dwordx4 v12, s[24:27], s60 offen lds
    s_add_u32 s60, s52, 25600
    s_add_u32 m0, s53, 43008
    s_nop 0
    buffer_load_dwordx4 v12, s[24:27], s60 offen lds
    s_add_u32 s60, s52, 35840
    s_add_u32 m0, s53, 44032
    s_nop 0
    buffer_load_dwordx4 v12, s[24:27], s60 offen lds
    s_add_u32 s60, s52, 409600
    s_add_u32 m0, s53, 61440
    s_nop 0
    buffer_load_dwordx4 v12, s[24:27], s60 offen lds
    s_add_u32 s60, s52, 419840
    s_add_u32 m0, s53, 62464
    s_nop 0
    buffer_load_dwordx4 v12, s[24:27], s60 offen lds
    s_add_u32 s60, s52, 435200
    s_add_u32 m0, s53, 63488
    s_nop 0
    buffer_load_dwordx4 v12, s[24:27], s60 offen lds
    s_add_u32 s60, s52, 445440
    s_add_u32 m0, s53, 64512
    s_nop 0
    buffer_load_dwordx4 v12, s[24:27], s60 offen lds
    s_lshl_b32 s53, s61, 10
    s_add_u32 s60, s52, 20480
    s_add_u32 m0, s53, 57344
    s_nop 0
    buffer_load_dwordx4 v5, s[24:27], s60 offen lds
    s_add_u32 s60, s52, 430080
    s_add_u32 m0, s53, 77824
    s_nop 0
    buffer_load_dwordx4 v5, s[24:27], s60 offen lds
    v_mov_b32 v2, 158720
    v_mov_b32 v3, 1
    s_waitcnt vmcnt(0)
    s_mov_b64 exec, 1
    ds_add_u32 v2, v3 offset:56
    s_mov_b64 exec, -1
K_P2_NL:
    s_lshl_b32 s62, s40, 7
    v_lshrrev_b32 v8, 3, v1
    v_lshrrev_b32 v9, 4, v1
    v_mov_b32 v15, 158720
    s_lshl_b32 s61, s40, 3
    s_add_u32 s61, s61, s30
    s_mul_i32 s3, s61, 20480
    s_lshl_b32 s33, s41, 7
    s_add_u32 s3, s3, s33
    v_and_b32 v2, 7, v1
    v_lshlrev_b32 v2, 4, v2
    v_mul_u32_u24 v4, 1280, v8
    v_add3_u32 v10, v2, v4, s3
    s_lshl_b32 s3, s30, 7
    s_add_u32 s3, s3, 159744
    v_lshl_add_u32 v11, v8, 3, s3
    s_mov_b32 s63, 10240
    s_add_u32 s20, s6, 0x100000
    s_addc_u32 s21, s7, 0
    s_mov_b32 s22, 0x280000
    s_mov_b32 s23, 0x20000
    s_mov_b32 s56, s10
    s_mov_b32 s57, s11
    s_mov_b32 s58, 0x280000
    s_mov_b32 s59, 0x20000
    v_mul_u32_u24 v3, 144, v8
    v_add_u32 v3, v2, v3
    s_mul_i32 s3, s30, 2304
    s_add_u32 s3, s3, 140288
    v_add_u32 v14, s3, v3
    s_add_u32 s44, s6, 0x10000
    s_addc_u32 s45, s7, 0
    s_mov_b32 s46, 0x43800
    s_mov_b32 s47, 0x20000
    v_mov_b32 v108, 1
    buffer_load_dwordx4 v[16:19], v10, s[12:15], 0 offen
    buffer_load_dwordx4 v[20:23], v10, s[12:15], s63 offen
    s_cmp_lg_u32 s30, 6
    s_cbranch_scc1 K_P2_HW
    s_mov_b32 s3, 131072
    s_waitcnt vmcnt(2)
K_P2_DPOLL:
    v_min_u32 v2, v7, v6
    v_cmp_eq_u32 vcc, 0, v2
    s_cbranch_vccz K_P2_DOK
    s_cmp_eq_u32 s3, 131072
    s_cbranch_scc1 K_P2_DNS
    s_sleep 12
K_P2_DNS:
    v_lshl_add_u32 v13, v1, 2, s42
    global_load_dword v7, v13, s[6:7] offset:256 sc1
    v_and_b32 v13, 0xfffffe04, v13
    global_load_dword v6, v13, s[6:7] offset:128 sc1
    s_sub_u32 s3, s3, 1
    s_waitcnt vmcnt(0)
    s_cmp_lg_u32 s3, 0
    s_cbranch_scc1 K_P2_DPOLL
K_P2_DOK:
    v_readlane_b32 s52, v6, 0
    v_readlane_b32 s53, v6, 1
    s_nop 1
    s_and_b32 s3, s52, 0x7ff
    s_sub_u32 s3, 2047, s3
    v_mov_b32 v48, s3
    v_mov_b32 v4, s52
    v_and_b32 v4, 0xffff0000, v4
    v_ashrrev_i32 v5, 31, v4
    v_not_b32 v5, v5
    v_or_b32 v5, 0x80000000, v5
    v_xor_b32 v4, v4, v5
    v_and_b32 v4, 0xffff0000, v4
    v_mul_f32 v5, 0xbfb8aa3b, v4
    v_exp_f32 v5, v5
    s_nop 0
    v_add_f32 v5, 1.0, v5
    v_rcp_f32 v4, v5
    s_nop 0
    v_cvt_pk_bf16_f32 v50, v4, v4
    v_lshlrev_b32 v50, 16, v50
    s_and_b32 s3, s53, 0x7ff
    s_sub_u32 s3, 2047, s3
    v_mov_b32 v49, s3
    v_mov_b32 v4, s53
    v_and_b32 v4, 0xffff0000, v4
    v_ashrrev_i32 v5, 31, v4
    v_not_b32 v5, v5
    v_or_b32 v5, 0x80000000, v5
    v_xor_b32 v4, v4, v5
    v_and_b32 v4, 0xffff0000, v4
    v_mul_f32 v5, 0xbfb8aa3b, v4
    v_exp_f32 v5, v5
    s_nop 0
    v_add_f32 v5, 1.0, v5
    v_rcp_f32 v4, v5
    s_nop 0
    v_cvt_pk_bf16_f32 v51, v4, v4
    v_lshlrev_b32 v51, 16, v51
    ds_write_b128 v15, v[48:51]
    ds_write_b32 v15, v108 offset:40
    v_lshl_add_u32 v13, v1, 4, v15
    v_lshlrev_b32 v52, 16, v7
    v_and_b32 v52, 0x7fff0000, v52
    v_and_b32 v54, 0x7fff0000, v7
    v_sub_f32 v53, 1.0, v52
    v_cvt_pk_bf16_f32 v53, v53, v53
    v_lshlrev_b32 v53, 16, v53
    v_sub_f32 v55, 1.0, v54
    v_cvt_pk_bf16_f32 v55, v55, v55
    v_lshlrev_b32 v55, 16, v55
    ds_write_b128 v13, v[52:55] offset:1024
    s_branch K_P2_E
K_STA13:
    s_branch K_WRET_A
K_STB13:
    s_branch K_WRET_B
K_P2_HW:
    s_mov_b32 s3, 1048576
K_P2_GS2:
    ds_read_b32 v2, v15 offset:40
    s_sleep 1
    s_sub_u32 s3, s3, 1
    s_waitcnt lgkmcnt(0)
    v_readfirstlane_b32 s33, v2
    s_nop 3
    s_cselect_b32 s33, 1, s33
    s_cmp_lt_u32 s33, 1
    s_cbranch_scc1 K_P2_GS2
    ds_read_b128 v[28:31], v15
    s_waitcnt lgkmcnt(0)
    s_cmp_eq_u32 s30, 4
    s_cselect_b64 vcc, -1, 0
    s_nop 1
    v_cndmask_b32 v2, v29, v28, vcc
    v_cndmask_b32 v5, v31, v30, vcc
    s_nop 0
    v_readfirstlane_b32 s52, v2
    s_nop 3
    s_sub_u32 s3, s52, s62
    s_cmp_lt_u32 s3, 128
    s_cbranch_scc0 K_P2_E
    s_mov_b32 s3, 131072
K_P2_YPOLL:
    s_load_dword s33, s[6:7], s42 offset:136 glc
    s_waitcnt lgkmcnt(0)
    s_cmp_lg_u32 s33, 0
    s_cbranch_scc1 K_P2_YGO
    s_sleep 4
    s_sub_u32 s3, s3, 1
    s_cbranch_scc0 K_P2_YPOLL
K_P2_YGO:
    v_and_b32 v2, 15, v1
    v_lshlrev_b32 v2, 4, v2
    v_mul_u32_u24 v4, 5120, v9
    s_sub_u32 s53, s30, 4
    s_mul_i32 s33, s53, 2560
    s_lshl_b32 s3, s41, 8
    s_add_u32 s3, s3, s33
    v_add3_u32 v3, v2, v4, s3
    s_mov_b32 s60, 0
    buffer_load_dwordx4 v[52:55], v3, s[44:47], s60 offen sc1
    s_mov_b32 s60, 20480
    buffer_load_dwordx4 v[56:59], v3, s[44:47], s60 offen sc1
    s_mov_b32 s60, 40960
    buffer_load_dwordx4 v[60:63], v3, s[44:47], s60 offen sc1
    s_mov_b32 s60, 61440
    buffer_load_dwordx4 v[64:67], v3, s[44:47], s60 offen sc1
    s_mov_b32 s60, 81920
    buffer_load_dwordx4 v[68:71], v3, s[44:47], s60 offen sc1
    s_mov_b32 s60, 102400
    buffer_load_dwordx4 v[72:75], v3, s[44:47], s60 offen sc1
    s_mov_b32 s60, 122880
    buffer_load_dwordx4 v[76:79], v3, s[44:47], s60 offen sc1
    s_mov_b32 s60, 143360
    buffer_load_dwordx4 v[80:83], v3, s[44:47], s60 offen sc1
    s_mov_b32 s60, 163840
    buffer_load_dwordx4 v[84:87], v3, s[44:47], s60 offen sc1
    s_mov_b32 s60, 184320
    buffer_load_dwordx4 v[88:91], v3, s[44:47], s60 offen sc1
    s_mov_b32 s60, 204800
    buffer_load_dwordx4 v[92:95], v3, s[44:47], s60 offen sc1
    s_mov_b32 s60, 225280
    buffer_load_dwordx4 v[96:99], v3, s[44:47], s60 offen sc1
    s_mov_b32 s60, 245760
    buffer_load_dwordx4 v[100:103], v3, s[44:47], s60 offen sc1
    s_mov_b32 s60, 266240
    buffer_load_dwordx4 v[104:107], v3, s[44:47], s60 offen sc1
    s_waitcnt vmcnt(12)
    v_add_f32 v48, v52, v56
    v_add_f32 v49, v53, v57
    v_add_f32 v50, v54, v58
    v_add_f32 v51, v55, v59
    s_waitcnt vmcnt(11)
    v_add_f32 v48, v48, v60
    v_add_f32 v49, v49, v61
    v_add_f32 v50, v50, v62
    v_add_f32 v51, v51, v63
    s_waitcnt vmcnt(10)
    v_add_f32 v48, v48, v64
    v_add_f32 v49, v49, v65
    v_add_f32 v50, v50, v66
    v_add_f32 v51, v51, v67
    s_waitcnt vmcnt(9)
    v_add_f32 v48, v48, v68
    v_add_f32 v49, v49, v69
    v_add_f32 v50, v50, v70
    v_add_f32 v51, v51, v71
    s_waitcnt vmcnt(8)
    v_add_f32 v48, v48, v72
    v_add_f32 v49, v49, v73
    v_add_f32 v50, v50, v74
    v_add_f32 v51, v51, v75
    s_waitcnt vmcnt(7)
    v_add_f32 v48, v48, v76
    v_add_f32 v49, v49, v77
    v_add_f32 v50, v50, v78
    v_add_f32 v51, v51, v79
    s_waitcnt vmcnt(6)
    v_add_f32 v48, v48, v80
    v_add_f32 v49, v49, v81
    v_add_f32 v50, v50, v82
    v_add_f32 v51, v51, v83
    s_waitcnt vmcnt(5)
    v_add_f32 v48, v48, v84
    v_add_f32 v49, v49, v85
    v_add_f32 v50, v50, v86
    v_add_f32 v51, v51, v87
    s_waitcnt vmcnt(4)
    v_add_f32 v48, v48, v88
    v_add_f32 v49, v49, v89
    v_add_f32 v50, v50, v90
    v_add_f32 v51, v51, v91
    s_waitcnt vmcnt(3)
    v_add_f32 v48, v48, v92
    v_add_f32 v49, v49, v93
    v_add_f32 v50, v50, v94
    v_add_f32 v51, v51, v95
    s_waitcnt vmcnt(2)
    v_add_f32 v48, v48, v96
    v_add_f32 v49, v49, v97
    v_add_f32 v50, v50, v98
    v_add_f32 v51, v51, v99
    s_waitcnt vmcnt(1)
    v_add_f32 v48, v48, v100
    v_add_f32 v49, v49, v101
    v_add_f32 v50, v50, v102
    v_add_f32 v51, v51, v103
    s_waitcnt vmcnt(0)
    v_add_f32 v48, v48, v104
    v_add_f32 v49, v49, v105
    v_add_f32 v50, v50, v106
    v_add_f32 v51, v51, v107
    v_mov_b32 v52, v48
    v_mov_b32 v53, v49
    v_mov_b32 v54, v50
    v_mov_b32 v55, v51
    s_nop 0
    v_permlane16_swap_b32 v48, v52
    v_permlane16_swap_b32 v49, v53
    v_permlane16_swap_b32 v50, v54
    v_permlane16_swap_b32 v51, v55
    v_add_f32 v48, v48, v52
    v_add_f32 v49, v49, v53
    v_add_f32 v50, v50, v54
    v_add_f32 v51, v51, v55
    v_mov_b32 v52, v48
    v_mov_b32 v53, v49
    v_mov_b32 v54, v50
    v_mov_b32 v55, v51
    s_nop 0
    v_permlane32_swap_b32 v48, v52
    v_permlane32_swap_b32 v49, v53
    v_permlane32_swap_b32 v50, v54
    v_permlane32_swap_b32 v51, v55
    v_add_f32 v48, v48, v52
    v_add_f32 v49, v49, v53
    v_add_f32 v50, v50, v54
    v_add_f32 v51, v51, v55
    v_cvt_pk_bf16_f32 v48, v48, v48
    v_lshlrev_b32 v48, 16, v48
    v_mul_f32 v48, v5, v48
    v_cvt_pk_bf16_f32 v48, v48, v48
    v_lshlrev_b32 v48, 16, v48
    v_cvt_pk_bf16_f32 v49, v49, v49
    v_lshlrev_b32 v49, 16, v49
    v_mul_f32 v49, v5, v49
    v_cvt_pk_bf16_f32 v49, v49, v49
    v_lshlrev_b32 v49, 16, v49
    v_cvt_pk_bf16_f32 v50, v50, v50
    v_lshlrev_b32 v50, 16, v50
    v_mul_f32 v50, v5, v50
    v_cvt_pk_bf16_f32 v50, v50, v50
    v_lshlrev_b32 v50, 16, v50
    v_cvt_pk_bf16_f32 v51, v51, v51
    v_lshlrev_b32 v51, 16, v51
    v_mul_f32 v51, v5, v51
    v_cvt_pk_bf16_f32 v51, v51, v51
    v_lshlrev_b32 v51, 16, v51
    s_lshl_b32 s3, s53, 8
    s_add_u32 s3, s3, 158976
    v_add_u32 v2, s3, v2
    ds_write_b128 v2, v[48:51]
    s_branch K_P2_E
K_STA14:
    s_branch K_WRET_A
K_STB14:
    s_branch K_WRET_B
K_P2_W7:
    s_mov_b32 s37, s42
    s_waitcnt lgkmcnt(0)
    s_load_dwordx2 s[48:49], s[6:7], s37 glc
    s_add_u32 s53, s40, 1
    s_and_b32 s53, s53, 2
    s_mov_b32 s46, 0x84210
    s_mov_b32 s47, s46
    v_mov_b32 v15, 158720
    v_mov_b32 v5, 0
    v_mov_b32 v48, 0x80000000
    s_mov_b64 exec, 1
    ds_or_b32 v15, v48 offset:16
    ds_or_b32 v15, v48 offset:20
    ds_or_b32 v15, v48 offset:24
    s_waitcnt lgkmcnt(0)
    s_cmp_eq_u32 s53, 0
    s_cselect_b32 s49, s48, s49
    s_lshl_b64 s[50:51], s[48:49], 1
    s_and_b64 s[50:51], s[50:51], s[48:49]
    s_lshl_b64 vcc, s[50:51], 2
    s_and_b64 s[50:51], s[50:51], vcc
    s_lshl_b64 s[50:51], s[50:51], 1
    s_and_b64 s[50:51], s[50:51], s[46:47]
    s_or_b64 s[48:49], s[48:49], s[50:51]
    v_readfirstlane_b32 s52, v5
    s_cmp_ge_u32 s52, 2
    s_cselect_b32 s52, -1, 0x3ff
    s_and_b32 s48, s48, s52
    s_and_b32 s49, s49, s52
    s_and_b32 s52, s48, s49
    v_mov_b32 v48, s48
    v_mov_b32 v49, s49
    v_mov_b32 v50, s52
    s_mov_b64 exec, 1
    ds_or_b64 v15, v[48:49] offset:16
    ds_or_b32 v15, v50 offset:24
    s_mov_b64 exec, -1
    s_load_dwordx2 s[48:49], s[6:7], s37 glc
    s_lshl_b32 s62, s40, 7
    v_lshrrev_b32 v8, 3, v1
    v_lshrrev_b32 v9, 4, v1
    v_mov_b32 v15, 158720
    s_lshl_b32 s61, s40, 3
    s_add_u32 s61, s61, s30
    s_mul_i32 s3, s61, 20480
    s_lshl_b32 s33, s41, 7
    s_add_u32 s3, s3, s33
    v_and_b32 v2, 7, v1
    v_lshlrev_b32 v2, 4, v2
    v_mul_u32_u24 v4, 1280, v8
    v_add3_u32 v10, v2, v4, s3
    s_lshl_b32 s3, s30, 7
    s_add_u32 s3, s3, 159744
    v_lshl_add_u32 v11, v8, 3, s3
    s_mov_b32 s63, 10240
    s_add_u32 s20, s6, 0x100000
    s_addc_u32 s21, s7, 0
    s_mov_b32 s22, 0x280000
    s_mov_b32 s23, 0x20000
    s_mov_b32 s56, s10
    s_mov_b32 s57, s11
    s_mov_b32 s58, 0x280000
    s_mov_b32 s59, 0x20000
    v_mul_u32_u24 v3, 144, v8
    v_add_u32 v3, v2, v3
    s_mul_i32 s3, s30, 2304
    s_add_u32 s3, s3, 140288
    v_add_u32 v14, s3, v3
    buffer_load_dwordx4 v[16:19], v10, s[12:15], 0 offen
    buffer_load_dwordx4 v[20:23], v10, s[12:15], s63 offen
    s_mov_b32 s3, 131072
    s_waitcnt lgkmcnt(0)
K_P2_FP:
    s_load_dwordx2 s[44:45], s[6:7], s37 glc
    s_cmp_eq_u32 s53, 0
    s_cselect_b32 s49, s48, s49
    s_lshl_b64 s[50:51], s[48:49], 1
    s_and_b64 s[50:51], s[50:51], s[48:49]
    s_lshl_b64 vcc, s[50:51], 2
    s_and_b64 s[50:51], s[50:51], vcc
    s_lshl_b64 s[50:51], s[50:51], 1
    s_and_b64 s[50:51], s[50:51], s[46:47]
    s_or_b64 s[48:49], s[48:49], s[50:51]
    v_readfirstlane_b32 s52, v5
    s_cmp_ge_u32 s52, 2
    s_cselect_b32 s52, -1, 0x3ff
    s_and_b32 s48, s48, s52
    s_and_b32 s49, s49, s52
    s_and_b32 s52, s48, s49
    v_mov_b32 v48, s48
    v_mov_b32 v49, s49
    v_mov_b32 v50, s52
    s_mov_b64 exec, 1
    ds_or_b64 v15, v[48:49] offset:16
    ds_or_b32 v15, v50 offset:24
    s_mov_b64 exec, -1
    ds_read_b32 v5, v15 offset:56
    s_cmp_eq_u32 s52, 0xfffff
    s_cbranch_scc1 K_P2_FGO
    s_cmp_lg_u64 s[48:49], 0
    s_cbranch_scc1 K_P2_FS2
    s_sleep 8
K_P2_FS2:
    s_sub_u32 s3, s3, 1
    s_waitcnt lgkmcnt(0)
    s_mov_b64 s[48:49], s[44:45]
    s_cbranch_scc0 K_P2_FP
    s_mov_b32 s3, 0
K_P2_FCHK:
    s_cmp_eq_u32 s53, 0
    s_cselect_b32 s49, s48, s49
    s_lshl_b64 s[50:51], s[48:49], 1
    s_and_b64 s[50:51], s[50:51], s[48:49]
    s_lshl_b64 vcc, s[50:51], 2
    s_and_b64 s[50:51], s[50:51], vcc
    s_lshl_b64 s[50:51], s[50:51], 1
    s_and_b64 s[50:51], s[50:51], s[46:47]
    s_or_b64 s[48:49], s[48:49], s[50:51]
    v_readfirstlane_b32 s52, v5
    s_cmp_ge_u32 s52, 2
    s_cselect_b32 s52, -1, 0x3ff
    s_and_b32 s48, s48, s52
    s_and_b32 s49, s49, s52
    s_and_b32 s52, s48, s49
    v_mov_b32 v48, s48
    v_mov_b32 v49, s49
    v_mov_b32 v50, s52
    s_mov_b64 exec, 1
    ds_or_b64 v15, v[48:49] offset:16
    ds_or_b32 v15, v50 offset:24
    s_mov_b64 exec, -1
    s_cmp_eq_u32 s52, 0xfffff
    s_cbranch_scc1 K_P2_FGO
    s_cmp_lg_u64 s[48:49], 0
    s_cbranch_scc1 K_P2_FS
    s_sleep 8
K_P2_FS:
    s_sleep 2
    s_load_dwordx2 s[48:49], s[6:7], s37 glc
    ds_read_b32 v5, v15 offset:56
    s_sub_u32 s3, s3, 1
    s_waitcnt lgkmcnt(0)
    s_cbranch_scc0 K_P2_FCHK
    v_mov_b32 v48, -1
    v_mov_b32 v49, -1
    v_mov_b32 v50, -1
    ds_write_b96 v15, v[48:50] offset:16
K_P2_FGO:
K_P2_E:
    s_setprio 0
    s_waitcnt vmcnt(0)
    v_lshlrev_b32 v32, 16, v16
    v_and_b32 v33, 0xffff0000, v16
    v_lshlrev_b32 v34, 16, v17
    v_and_b32 v35, 0xffff0000, v17
    v_lshlrev_b32 v36, 16, v18
    v_and_b32 v37, 0xffff0000, v18
    v_lshlrev_b32 v38, 16, v19
    v_and_b32 v39, 0xffff0000, v19
    v_lshlrev_b32 v40, 16, v20
    v_and_b32 v41, 0xffff0000, v20
    v_lshlrev_b32 v42, 16, v21
    v_and_b32 v43, 0xffff0000, v21
    v_lshlrev_b32 v44, 16, v22
    v_and_b32 v45, 0xffff0000, v22
    v_lshlrev_b32 v46, 16, v23
    v_and_b32 v47, 0xffff0000, v23
    s_branch K_P2_E2
K_STA15:
    s_branch K_WRET_A
K_STB15:
    s_branch K_WRET_B
K_SPN:
    s_mov_b32 s64, -1
    s_mov_b32 s65, -1
    s_mov_b32 s66, -1
    s_mov_b32 s67, -1
    s_mov_b32 s68, -1
    s_mov_b32 s69, -1
K_SPL:
    ds_read_b32 v59, v58
    s_waitcnt lgkmcnt(0)
    v_readfirstlane_b32 s50, v59
    s_and_b32 s33, s50, s70
    s_cbranch_scc1 K_BK0
    s_cmp_lt_i32 s50, 0
    s_cbranch_scc0 K_SPG
    s_sleep 1
    s_branch K_SPL
K_SPG:
    s_load_dwordx2 s[48:49], s[6:7], s42 glc
    ds_read_b32 v5, v15 offset:56
    s_waitcnt lgkmcnt(0)
    s_cmp_eq_u32 s53, 0
    s_cselect_b32 s49, s48, s49
    s_lshl_b64 s[50:51], s[48:49], 1
    s_and_b64 s[50:51], s[50:51], s[48:49]
    s_lshl_b64 vcc, s[50:51], 2
    s_and_b64 s[50:51], s[50:51], vcc
    s_lshl_b64 s[50:51], s[50:51], 1
    s_and_b64 s[50:51], s[50:51], s[46:47]
    s_or_b64 s[48:49], s[48:49], s[50:51]
    v_readfirstlane_b32 s52, v5
    s_cmp_ge_u32 s52, 2
    s_cselect_b32 s52, -1, 0x3ff
    s_and_b32 s48, s48, s52
    s_and_b32 s49, s49, s52
    s_and_b32 s52, s48, s49
    v_mov_b32 v188, s48
    v_mov_b32 v189, s49
    v_mov_b32 v190, s52
    s_mov_b64 exec, 1
    ds_or_b64 v15, v[188:189] offset:16
    ds_or_b32 v15, v190 offset:24
    s_mov_b64 exec, -1
    ds_read_b32 v59, v58
    s_waitcnt lgkmcnt(0)
    v_readfirstlane_b32 s50, v59
    s_and_b32 s33, s50, s70
    s_cbranch_scc1 K_BK0
    s_sleep 2
    ds_read_b32 v59, v58
    s_waitcnt lgkmcnt(0)
    v_readfirstlane_b32 s50, v59
    s_and_b32 s33, s50, s70
    s_cbranch_scc1 K_BK0
    s_sleep 2
    ds_read_b32 v59, v58
    s_waitcnt lgkmcnt(0)
    v_readfirstlane_b32 s50, v59
    s_and_b32 s33, s50, s70
    s_cbranch_scc1 K_BK0
    s_sleep 2
    ds_read_b32 v59, v58
    s_waitcnt lgkmcnt(0)
    v_readfirstlane_b32 s50, v59
    s_and_b32 s33, s50, s70
    s_cbranch_scc1 K_BK0
    s_branch K_SPL
K_CHEND:
K_AUX:
    s_cmp_ge_u32 s30, 4
    s_cbranch_scc1 K_AUX_L
    s_and_b32 s3, s2, 7
    s_lshr_b32 s70, s2, 3
    s_lshl3_add_u32 s3, s3, s70
    s_lshl_b32 s3, s3, 5
    s_lshl3_add_u32 s3, s30, s3
    v_bfe_u32 v8, v0, 4, 2
    v_add_u32 v8, s3, v8
    v_and_b32 v10, 15, v0
    v_lshlrev_b32 v10, 4, v10
    v_mul_u32_u24 v9, 1280, v8
    v_add_u32 v9, v9, v10
    v_and_b32 v2, 63, v0
    v_lshlrev_b32 v2, 4, v2
    s_lshl_b32 s71, s30, 12
    s_add_u32 s71, s71, 126016
    s_mov_b32 s70, 5120
    s_mov_b32 m0, s71
    s_waitcnt lgkmcnt(0)
    s_mov_b32 s16, s44
    s_mov_b32 s17, s45
    s_mov_b32 s18, 0x500
    s_mov_b32 s19, 0x20000
    s_mov_b32 s20, s52
    s_mov_b32 s21, s53
    s_mov_b32 s22, 0x500
    s_mov_b32 s23, 0x20000
    buffer_load_dwordx4 v2, s[16:19], 0 offen lds
    buffer_load_dwordx4 v2, s[16:19], 0 offen offset:1024 lds
    s_add_u32 m0, s71, 2048
    v_add_u32 v10, s71, v10
    buffer_load_dwordx4 v2, s[20:23], 0 offen lds
    buffer_load_dwordx4 v2, s[20:23], 0 offen offset:1024 lds
    buffer_load_dwordx4 v[16:19], v9, s[12:15], 0 offen offset:0
    buffer_load_dwordx4 v[20:23], v9, s[12:15], s70 offen offset:0
    buffer_load_dwordx4 v[24:27], v9, s[12:15], 0 offen offset:256
    buffer_load_dwordx4 v[28:31], v9, s[12:15], s70 offen offset:256
    buffer_load_dwordx4 v[32:35], v9, s[12:15], 0 offen offset:512
    buffer_load_dwordx4 v[36:39], v9, s[12:15], s70 offen offset:512
    buffer_load_dwordx4 v[40:43], v9, s[12:15], 0 offen offset:768
    buffer_load_dwordx4 v[44:47], v9, s[12:15], s70 offen offset:768
    buffer_load_dwordx4 v[48:51], v9, s[12:15], 0 offen offset:1024
    buffer_load_dwordx4 v[52:55], v9, s[12:15], s70 offen offset:1024
    s_barrier
    v_and_b32 v1, 63, v0
    v_mov_b32 v7, 0
    s_and_b32 s28, s2, 7
    s_lshr_b32 s29, s2, 3
    s_xor_b32 s30, s30, 4
    s_lshr_b32 s34, s29, 3
    s_lshl_b32 s34, s34, 2
    s_and_b32 s3, s29, 3
    s_add_u32 s34, s34, s3
    s_add_u32 s34, s34, 4
    s_bitcmp1_b32 s29, 2
    s_cselect_b32 s34, -1, s34
    s_cmp_lt_u32 s29, 8
    s_cselect_b32 s34, s29, s34
    s_lshl_b32 s40, s28, 1
    s_cmp_ge_u32 s34, 10
    s_addc_u32 s40, s40, 0
    s_sub_u32 s41, s34, 10
    s_branch K_PG6
.p2align 12
K_PG6:
    s_cmp_ge_u32 s34, 10
    s_cselect_b32 s41, s41, s34
    s_mul_i32 s42, s28, 20
    s_add_u32 s42, s42, s34
    s_and_b32 s42, s42, 255
    s_lshl_b32 s42, s42, 9
    s_add_u32 s42, s42, 524288
    s_mul_i32 s43, s28, 7
    s_add_u32 s43, s43, s29
    s_sub_u32 s43, s43, 1
    s_cmp_lt_u32 s43, 54
    s_cselect_b32 s43, s43, 63
    s_cmp_eq_u32 s29, 0
    s_cselect_b32 s43, 63, s43
    s_mov_b32 s24, s8
    s_mov_b32 s25, s9
    s_mov_b32 s26, 0xc8000
    s_mov_b32 s27, 0x20000
    s_add_u32 s64, s6, 0x80000
    s_addc_u32 s65, s7, 0
    s_mov_b32 s66, 0x14400
    s_mov_b32 s67, 0x20000
    s_add_u32 s60, s6, 0x10000
    s_addc_u32 s61, s7, 0
    s_mov_b32 s62, 0x43800
    s_mov_b32 s63, 0x20000
    v_mov_b32 v96, 0
    v_mov_b32 v97, 0
    v_mov_b32 v98, 0
    v_mov_b32 v99, 0
    v_mov_b32 v13, 158720
    s_waitcnt vmcnt(10)
    ds_read_b128 v[56:59], v10 offset:0
    ds_read_b128 v[76:79], v10 offset:2048
    ds_read_b128 v[60:63], v10 offset:256
    ds_read_b128 v[80:83], v10 offset:2304
    ds_read_b128 v[64:67], v10 offset:512
    ds_read_b128 v[84:87], v10 offset:2560
    ds_read_b128 v[68:71], v10 offset:768
    ds_read_b128 v[88:91], v10 offset:2816
    ds_read_b128 v[72:75], v10 offset:1024
    ds_read_b128 v[92:95], v10 offset:3072
    s_waitcnt vmcnt(8) lgkmcnt(8)
    v_dot2c_f32_bf16 v96, v16, v56
    v_dot2c_f32_bf16 v98, v16, v76
    v_dot2c_f32_bf16 v97, v20, v56
    v_dot2c_f32_bf16 v99, v20, v76
    v_dot2c_f32_bf16 v96, v17, v57
    v_dot2c_f32_bf16 v98, v17, v77
    v_dot2c_f32_bf16 v97, v21, v57
    v_dot2c_f32_bf16 v99, v21, v77
    v_dot2c_f32_bf16 v96, v18, v58
    v_dot2c_f32_bf16 v98, v18, v78
    v_dot2c_f32_bf16 v97, v22, v58
    v_dot2c_f32_bf16 v99, v22, v78
    v_dot2c_f32_bf16 v96, v19, v59
    v_dot2c_f32_bf16 v98, v19, v79
    v_dot2c_f32_bf16 v97, v23, v59
    v_dot2c_f32_bf16 v99, v23, v79
    s_waitcnt vmcnt(6) lgkmcnt(6)
    v_dot2c_f32_bf16 v96, v24, v60
    v_dot2c_f32_bf16 v98, v24, v80
    v_dot2c_f32_bf16 v97, v28, v60
    v_dot2c_f32_bf16 v99, v28, v80
    v_dot2c_f32_bf16 v96, v25, v61
    v_dot2c_f32_bf16 v98, v25, v81
    v_dot2c_f32_bf16 v97, v29, v61
    v_dot2c_f32_bf16 v99, v29, v81
    v_dot2c_f32_bf16 v96, v26, v62
    v_dot2c_f32_bf16 v98, v26, v82
    v_dot2c_f32_bf16 v97, v30, v62
    v_dot2c_f32_bf16 v99, v30, v82
    v_dot2c_f32_bf16 v96, v27, v63
    v_dot2c_f32_bf16 v98, v27, v83
    v_dot2c_f32_bf16 v97, v31, v63
    v_dot2c_f32_bf16 v99, v31, v83
    s_waitcnt vmcnt(4) lgkmcnt(4)
    v_dot2c_f32_bf16 v96, v32, v64
    v_dot2c_f32_bf16 v98, v32, v84
    v_dot2c_f32_bf16 v97, v36, v64
    v_dot2c_f32_bf16 v99, v36, v84
    v_dot2c_f32_bf16 v96, v33, v65
    v_dot2c_f32_bf16 v98, v33, v85
    v_dot2c_f32_bf16 v97, v37, v65
    v_dot2c_f32_bf16 v99, v37, v85
    v_dot2c_f32_bf16 v96, v34, v66
    v_dot2c_f32_bf16 v98, v34, v86
    v_dot2c_f32_bf16 v97, v38, v66
    v_dot2c_f32_bf16 v99, v38, v86
    v_dot2c_f32_bf16 v96, v35, v67
    v_dot2c_f32_bf16 v98, v35, v87
    v_dot2c_f32_bf16 v97, v39, v67
    v_dot2c_f32_bf16 v99, v39, v87
    s_waitcnt vmcnt(2) lgkmcnt(2)
    v_dot2c_f32_bf16 v96, v40, v68
    v_dot2c_f32_bf16 v98, v40, v88
    v_dot2c_f32_bf16 v97, v44, v68
    v_dot2c_f32_bf16 v99, v44, v88
    v_dot2c_f32_bf16 v96, v41, v69
    v_dot2c_f32_bf16 v98, v41, v89
    v_dot2c_f32_bf16 v97, v45, v69
    v_dot2c_f32_bf16 v99, v45, v89
    v_dot2c_f32_bf16 v96, v42, v70
    v_dot2c_f32_bf16 v98, v42, v90
    v_dot2c_f32_bf16 v97, v46, v70
    v_dot2c_f32_bf16 v99, v46, v90
    v_dot2c_f32_bf16 v96, v43, v71
    v_dot2c_f32_bf16 v98, v43, v91
    v_dot2c_f32_bf16 v97, v47, v71
    v_dot2c_f32_bf16 v99, v47, v91
    s_waitcnt vmcnt(0) lgkmcnt(0)
    v_dot2c_f32_bf16 v96, v48, v72
    v_dot2c_f32_bf16 v98, v48, v92
    v_dot2c_f32_bf16 v97, v52, v72
    v_dot2c_f32_bf16 v99, v52, v92
    v_dot2c_f32_bf16 v96, v49, v73
    v_dot2c_f32_bf16 v98, v49, v93
    v_dot2c_f32_bf16 v97, v53, v73
    v_dot2c_f32_bf16 v99, v53, v93
    v_dot2c_f32_bf16 v96, v50, v74
    v_dot2c_f32_bf16 v98, v50, v94
    v_dot2c_f32_bf16 v97, v54, v74
    v_dot2c_f32_bf16 v99, v54, v94
    v_dot2c_f32_bf16 v96, v51, v75
    v_dot2c_f32_bf16 v98, v51, v95
    v_dot2c_f32_bf16 v97, v55, v75
    v_dot2c_f32_bf16 v99, v55, v95
    s_nop 2
    v_add_f32_dpp v96, v96, v96 quad_perm:[1,0,3,2] row_mask:0xf bank_mask:0xf
    v_add_f32_dpp v97, v97, v97 quad_perm:[1,0,3,2] row_mask:0xf bank_mask:0xf
    v_add_f32_dpp v98, v98, v98 quad_perm:[1,0,3,2] row_mask:0xf bank_mask:0xf
    v_add_f32_dpp v99, v99, v99 quad_perm:[1,0,3,2] row_mask:0xf bank_mask:0xf
    v_add_f32_dpp v96, v96, v96 quad_perm:[2,3,0,1] row_mask:0xf bank_mask:0xf
    v_add_f32_dpp v97, v97, v97 quad_perm:[2,3,0,1] row_mask:0xf bank_mask:0xf
    v_add_f32_dpp v98, v98, v98 quad_perm:[2,3,0,1] row_mask:0xf bank_mask:0xf
    v_add_f32_dpp v99, v99, v99 quad_perm:[2,3,0,1] row_mask:0xf bank_mask:0xf
    v_add_f32_dpp v96, v96, v96 row_half_mirror row_mask:0xf bank_mask:0xf
    v_add_f32_dpp v97, v97, v97 row_half_mirror row_mask:0xf bank_mask:0xf
    v_add_f32_dpp v98, v98, v98 row_half_mirror row_mask:0xf bank_mask:0xf
    v_add_f32_dpp v99, v99, v99 row_half_mirror row_mask:0xf bank_mask:0xf
    v_add_f32_dpp v96, v96, v96 row_mirror row_mask:0xf bank_mask:0xf
    v_add_f32_dpp v97, v97, v97 row_mirror row_mask:0xf bank_mask:0xf
    v_add_f32_dpp v98, v98, v98 row_mirror row_mask:0xf bank_mask:0xf
    v_add_f32_dpp v99, v99, v99 row_mirror row_mask:0xf bank_mask:0xf
    v_and_b32 v4, 31, v8
    v_lshlrev_b32 v11, 2, v4
    v_add_u32 v11, 122880, v11
    v_lshlrev_b32 v12, 1, v4
    v_add_u32 v12, 123008, v12
    v_cvt_pk_bf16_f32 v2, v96, v96
    v_lshlrev_b32 v2, 16, v2
    v_ashrrev_i32 v3, 31, v2
    v_or_b32 v3, 0x80000000, v3
    v_xor_b32 v2, v2, v3
    v_and_b32 v2, 0xffff0000, v2
    v_sub_u32 v3, 0x87ff, v8
    v_or_b32 v96, v2, v3
    ds_write_b32 v11, v96 offset:0
    v_cvt_pk_bf16_f32 v98, v98, v98
    v_lshlrev_b32 v98, 16, v98
    v_mul_f32 v5, 0xbfb8aa3b, v98
    v_exp_f32 v5, v5
    s_nop 0
    v_add_f32 v5, 1.0, v5
    v_rcp_f32 v98, v5
    s_nop 0
    v_cvt_pk_bf16_f32 v98, v98, v98
    v_or_b32 v98, 0x8000, v98
    ds_write_b16 v12, v98 offset:0
    v_cvt_pk_bf16_f32 v2, v97, v97
    v_lshlrev_b32 v2, 16, v2
    v_ashrrev_i32 v3, 31, v2
    v_or_b32 v3, 0x80000000, v3
    v_xor_b32 v2, v2, v3
    v_and_b32 v2, 0xffff0000, v2
    v_sub_u32 v3, 0x87fb, v8
    v_or_b32 v97, v2, v3
    ds_write_b32 v11, v97 offset:16
    v_cvt_pk_bf16_f32 v99, v99, v99
    v_lshlrev_b32 v99, 16, v99
    v_mul_f32 v5, 0xbfb8aa3b, v99
    v_exp_f32 v5, v5
    s_nop 0
    v_add_f32 v5, 1.0, v5
    v_rcp_f32 v99, v5
    s_nop 0
    v_cvt_pk_bf16_f32 v99, v99, v99
    v_or_b32 v99, 0x8000, v99
    ds_write_b16 v12, v99 offset:8
    v_mov_b32 v3, 1
    s_mov_b64 exec, 1
    ds_add_u32 v13, v3 offset:48
    s_mov_b64 exec, -1
    s_cmp_ge_u32 s30, 6
    s_cbranch_scc1 K_AUX_G1
    s_mov_b32 s3, 1048576
K_FGR:
    ds_read_b32 v2, v13 offset:48
    s_sleep 1
    s_sub_u32 s3, s3, 1
    s_waitcnt lgkmcnt(0)
    v_readfirstlane_b32 s33, v2
    s_nop 3
    s_cselect_b32 s33, 4, s33
    s_cmp_lt_u32 s33, 4
    s_cbranch_scc1 K_FGR
    s_cmp_lg_u32 s30, 4
    s_cbranch_scc1 K_AUX_G0
    v_and_b32 v3, 31, v1
    v_lshlrev_b32 v3, 2, v3
    v_add_u32 v3, 122880, v3
    ds_read_b32 v2, v3
    s_waitcnt lgkmcnt(0)
    s_nop 1
    v_max_u32_dpp v3, v2, v2 quad_perm:[1,0,3,2] row_mask:0xf bank_mask:0xf
    s_nop 1
    v_max_u32_dpp v3, v3, v3 quad_perm:[2,3,0,1] row_mask:0xf bank_mask:0xf
    s_nop 1
    v_max_u32_dpp v3, v3, v3 row_half_mirror row_mask:0xf bank_mask:0xf
    s_nop 1
    v_max_u32_dpp v3, v3, v3 row_mirror row_mask:0xf bank_mask:0xf
    s_nop 1
    v_readlane_b32 s68, v3, 0
    v_readlane_b32 s76, v3, 16
    v_readlane_b32 s77, v3, 32
    v_readlane_b32 s78, v3, 48
    s_nop 3
    s_max_u32 s68, s68, s76
    s_max_u32 s77, s77, s78
    s_max_u32 s68, s68, s77
    v_cmp_ne_u32 vcc, s68, v2
    s_nop 1
    v_cndmask_b32 v2, 0, v2, vcc
    s_nop 1
    v_max_u32_dpp v3, v2, v2 quad_perm:[1,0,3,2] row_mask:0xf bank_mask:0xf
    s_nop 1
    v_max_u32_dpp v3, v3, v3 quad_perm:[2,3,0,1] row_mask:0xf bank_mask:0xf
    s_nop 1
    v_max_u32_dpp v3, v3, v3 row_half_mirror row_mask:0xf bank_mask:0xf
    s_nop 1
    v_max_u32_dpp v3, v3, v3 row_mirror row_mask:0xf bank_mask:0xf
    s_nop 1
    v_readlane_b32 s69, v3, 0
    v_readlane_b32 s76, v3, 16
    v_readlane_b32 s77, v3, 32
    v_readlane_b32 s78, v3, 48
    s_nop 3
    s_max_u32 s69, s69, s76
    s_max_u32 s77, s77, s78
    s_max_u32 s69, s69, s77
    s_load_dword s33, s[4:5], 0
    s_waitcnt lgkmcnt(0)
    s_cmp_ge_u32 s33, 1
    s_cbranch_scc1 K_ZO3
    s_sleep 8
    s_load_dword s33, s[4:5], 64
    s_waitcnt lgkmcnt(0)
    s_cmp_ge_u32 s33, 1
    s_cbranch_scc1 K_ZO3
    s_sleep 8
    s_mov_b32 s3, 16384
K_ZB3:
    v_mov_b32 v4, 0
    global_load_dword v4, v4, s[4:5] sc1
    s_waitcnt vmcnt(0)
    v_readfirstlane_b32 s33, v4
    s_cmp_ge_u32 s33, 1
    s_cbranch_scc1 K_ZO3
    s_sleep 8
    s_sub_u32 s3, s3, 1
    s_cbranch_scc0 K_ZB3
K_ZO3:
    s_lshl_b32 s3, s2, 3
    s_add_u32 s3, s3, 606208
    s_atomic_add_x2 s[68:69], s[6:7], s3
    s_cmp_lg_u32 s2, 63
    s_cbranch_scc1 K_AUX_G1
    s_mov_b32 s70, 81920
    v_lshlrev_b32 v3, 3, v1
    s_mov_b32 s3, 131072
K_AUX_POLL:
    buffer_load_dwordx2 v[176:177], v3, s[64:67], s70 offen sc1
    s_waitcnt vmcnt(0)
    v_min_u32 v2, v176, v177
    v_cmp_eq_u32 vcc, 0, v2
    s_cbranch_vccz K_AUX_GOT
    s_sleep 2
    s_sub_u32 s3, s3, 1
    s_cmp_lg_u32 s3, 0
    s_cbranch_scc1 K_AUX_POLL
K_AUX_GOT:
    s_waitcnt lgkmcnt(0)
    s_nop 1
    v_max_u32_dpp v3, v176, v176 quad_perm:[1,0,3,2] row_mask:0xf bank_mask:0xf
    s_nop 1
    v_max_u32_dpp v3, v3, v3 quad_perm:[2,3,0,1] row_mask:0xf bank_mask:0xf
    s_nop 1
    v_max_u32_dpp v3, v3, v3 row_half_mirror row_mask:0xf bank_mask:0xf
    s_nop 1
    v_max_u32_dpp v3, v3, v3 row_mirror row_mask:0xf bank_mask:0xf
    s_nop 1
    v_readlane_b32 s68, v3, 0
    v_readlane_b32 s76, v3, 16
    v_readlane_b32 s77, v3, 32
    v_readlane_b32 s78, v3, 48
    s_nop 3
    s_max_u32 s68, s68, s76
    s_max_u32 s77, s77, s78
    s_max_u32 s68, s68, s77
    v_cmp_ne_u32 vcc, s68, v176
    s_nop 1
    v_cndmask_b32 v2, v177, v176, vcc
    s_nop 1
    v_max_u32_dpp v3, v2, v2 quad_perm:[1,0,3,2] row_mask:0xf bank_mask:0xf
    s_nop 1
    v_max_u32_dpp v3, v3, v3 quad_perm:[2,3,0,1] row_mask:0xf bank_mask:0xf
    s_nop 1
    v_max_u32_dpp v3, v3, v3 row_half_mirror row_mask:0xf bank_mask:0xf
    s_nop 1
    v_max_u32_dpp v3, v3, v3 row_mirror row_mask:0xf bank_mask:0xf
    s_nop 1
    v_readlane_b32 s69, v3, 0
    v_readlane_b32 s76, v3, 16
    v_readlane_b32 s77, v3, 32
    v_readlane_b32 s78, v3, 48
    s_nop 3
    s_max_u32 s69, s69, s76
    s_max_u32 s77, s77, s78
    s_max_u32 s69, s69, s77
    v_mov_b32 v176, s68
    v_mov_b32 v177, s69
    s_mov_b32 s3, 1048576
K_FGZ:
    ds_read_b32 v2, v13 offset:36
    s_sleep 1
    s_sub_u32 s3, s3, 1
    s_waitcnt lgkmcnt(0)
    v_readfirstlane_b32 s33, v2
    s_nop 3
    s_cselect_b32 s33, 1, s33
    s_cmp_lt_u32 s33, 1
    s_cbranch_scc1 K_FGZ
    v_lshlrev_b32 v3, 9, v1
    s_mov_b32 s66, 81920
    s_mov_b32 s70, 0
    buffer_store_dwordx2 v[176:177], v3, s[64:67], s70 offen offset:128 sc1
    s_mov_b32 s70, 32768
    buffer_store_dwordx2 v[176:177], v3, s[64:67], s70 offen offset:128 sc1
    s_mov_b32 s70, 65536
    buffer_store_dwordx2 v[176:177], v3, s[64:67], s70 offen offset:128 sc1
    v_mov_b32 v3, 16
    ds_write_b32 v13, v3 offset:48
    s_branch K_AUX_G1
K_AUX_G0:
    v_and_b32 v3, 3, v1
    v_lshlrev_b32 v3, 4, v3
    v_add_u32 v2, 123008, v3
    ds_read_b128 v[176:179], v2
    v_lshrrev_b32 v2, 2, v1
    v_lshl_add_u32 v3, v2, 9, v3
    s_sleep 12
    s_load_dword s33, s[4:5], 128
    s_waitcnt lgkmcnt(0)
    s_cmp_ge_u32 s33, 8
    s_cbranch_scc1 K_ZO4
    s_sleep 8
    s_mov_b32 s3, 16384
K_ZB4:
    v_mov_b32 v4, 128
    global_load_dword v4, v4, s[4:5] sc1
    s_waitcnt vmcnt(0)
    v_readfirstlane_b32 s33, v4
    s_cmp_ge_u32 s33, 8
    s_cbranch_scc1 K_ZO4
    s_sleep 8
    s_sub_u32 s3, s3, 1
    s_cbranch_scc0 K_ZB4
K_ZO4:
    v_mov_b32 v2, 1
    ds_write_b32 v13, v2 offset:36
    s_lshr_b32 s3, s29, 2
    s_lshl1_add_u32 s3, s28, s3
    s_mul_i32 s3, s3, 5120
    s_and_b32 s70, s29, 3
    s_lshl_b32 s70, s70, 6
    s_add_u32 s3, s3, s70
    s_mov_b32 exec_hi, 0xff
    s_waitcnt lgkmcnt(0)
    buffer_store_dwordx4 v[176:179], v3, s[64:67], s3 offen offset:256 sc1
    s_mov_b64 exec, -1
K_AUX_G1:
    s_cmp_lg_u32 s43, 63
    s_cbranch_scc1 K_FFN_C
    s_cmp_lg_u32 s29, 0
    s_cbranch_scc1 K_AUX_NT
    s_lshl2_add_u32 s3, s28, s30
    s_sub_u32 s3, s3, 4
    s_mul_i32 s3, s3, 25600
    v_lshlrev_b32 v2, 7, v1
    buffer_load_dword v5, v2, s[24:27], s3 offen
    s_add_u32 s3, s3, 8192
    buffer_load_dword v5, v2, s[24:27], s3 offen
    s_add_u32 s3, s3, 8192
    buffer_load_dword v5, v2, s[24:27], s3 offen
    s_add_u32 s3, s3, 8192
    s_mov_b64 exec, 0xff
    buffer_load_dword v5, v2, s[24:27], s3 offen
    s_add_u32 s3, s3, 8192
    s_mov_b64 exec, -1
K_AUX_NT:
    s_mov_b32 s3, 1048576
K_FGZ2:
    ds_read_b32 v2, v13 offset:36
    s_sleep 1
    s_sub_u32 s3, s3, 1
    s_waitcnt lgkmcnt(0)
    v_readfirstlane_b32 s33, v2
    s_nop 3
    s_cselect_b32 s33, 1, s33
    s_cmp_lt_u32 s33, 1
    s_cbranch_scc1 K_FGZ2
    s_waitcnt vmcnt(0)
    s_branch K_P2
K_AUX_L:
    v_and_b32 v1, 63, v0
    v_mov_b32 v7, 0
    s_and_b32 s28, s2, 7
    s_lshr_b32 s29, s2, 3
    s_xor_b32 s30, s30, 4
    s_lshr_b32 s34, s29, 3
    s_lshl_b32 s34, s34, 2
    s_and_b32 s3, s29, 3
    s_add_u32 s34, s34, s3
    s_add_u32 s34, s34, 4
    s_bitcmp1_b32 s29, 2
    s_cselect_b32 s34, -1, s34
    s_cmp_lt_u32 s29, 8
    s_cselect_b32 s34, s29, s34
    s_lshl_b32 s40, s28, 1
    s_cmp_ge_u32 s34, 10
    s_addc_u32 s40, s40, 0
    s_sub_u32 s41, s34, 10
    s_cmp_ge_u32 s34, 10
    s_cselect_b32 s41, s41, s34
    s_mul_i32 s42, s28, 20
    s_add_u32 s42, s42, s34
    s_and_b32 s42, s42, 255
    s_lshl_b32 s42, s42, 9
    s_add_u32 s42, s42, 524288
    s_mul_i32 s43, s28, 7
    s_add_u32 s43, s43, s29
    s_sub_u32 s43, s43, 1
    s_cmp_lt_u32 s43, 54
    s_cselect_b32 s43, s43, 63
    s_cmp_eq_u32 s29, 0
    s_cselect_b32 s43, 63, s43
    v_mov_b32 v3, 158736
    ds_write2_b32 v3, v7, v7 offset0:0 offset1:1
    ds_write2_b32 v3, v7, v7 offset0:2 offset1:3
    ds_write2_b32 v3, v7, v7 offset0:4 offset1:5
    ds_write2_b32 v3, v7, v7 offset0:6 offset1:7
    ds_write2_b32 v3, v7, v7 offset0:8 offset1:9
    ds_write2_b32 v3, v7, v7 offset0:10 offset1:11
    v_lshrrev_b32 v3, 2, v1
    v_mul_u32_u24 v11, 3456, v3
    v_lshrrev_b32 v3, 4, v1
    v_and_b32 v3, 2, v3
    v_xor_b32 v3, v3, v1
    v_and_b32 v3, 3, v3
    v_lshl_add_u32 v11, v3, 4, v11
    s_mul_i32 s3, s30, 552960
    s_lshl_b32 s70, s43, 6
    s_add_u32 s3, s3, s70
    v_add_u32 v11, s3, v11
    s_mul_i32 s68, s30, 10240
    s_add_u32 s72, s68, 40960
    s_bitcmp1_b32 s43, 0
    s_cselect_b32 s71, s72, s68
    s_cselect_b32 s72, s68, s72
    v_lshlrev_b32 v8, 4, v1
    s_waitcnt lgkmcnt(0)
    s_barrier
    s_mov_b32 s24, s8
    s_mov_b32 s25, s9
    s_mov_b32 s26, 0xc8000
    s_mov_b32 s27, 0x20000
    s_cmp_lg_u32 s43, 63
    s_cbranch_scc1 K_AUX_FFN1
    s_cmp_lg_u32 s30, 0
    s_cbranch_scc1 K_AUX_NR
    s_cmp_eq_u32 s2, 55
    s_cbranch_scc1 K_AUX_NR
    s_cmp_eq_u32 s2, 63
    s_cselect_b32 s70, 0, 128
    s_mov_b32 s3, 1
    s_waitcnt vmcnt(0)
    s_atomic_add s3, s[4:5], s70
    s_atomic_add s3, s[4:5], s70 offset:64
    s_waitcnt lgkmcnt(0)
K_AUX_NR:
    v_mov_b32 v13, 158720
    s_mov_b32 s3, 1048576
K_FGZ3:
    ds_read_b32 v2, v13 offset:36
    s_sleep 1
    s_sub_u32 s3, s3, 1
    s_waitcnt lgkmcnt(0)
    v_readfirstlane_b32 s33, v2
    s_nop 3
    s_cselect_b32 s33, 1, s33
    s_cmp_lt_u32 s33, 1
    s_cbranch_scc1 K_FGZ3
    s_cmp_lg_u32 s2, 63
    s_cbranch_scc1 K_AUX_NH
    s_mov_b32 s3, 1048576
K_FGH:
    ds_read_b32 v2, v13 offset:48
    s_sleep 1
    s_sub_u32 s3, s3, 1
    s_waitcnt lgkmcnt(0)
    v_readfirstlane_b32 s33, v2
    s_nop 3
    s_cselect_b32 s33, 16, s33
    s_cmp_lt_u32 s33, 16
    s_cbranch_scc1 K_FGH
K_AUX_NH:
    s_branch K_P2
K_AUX_FFN1:
    s_bitcmp1_b32 s43, 0
    s_cselect_b64 s[56:57], s[48:49], s[46:47]
    s_cselect_b64 s[60:61], s[46:47], s[48:49]
    s_mov_b32 s58, 2211840
    s_mov_b32 s59, 0x20000
    s_mov_b32 s62, 2211840
    s_mov_b32 s63, 0x20000
    s_add_u32 m0, s71, 0
    s_mov_b32 s70, 0
    buffer_load_dwordx4 v11, s[56:59], s70 offen  lds
    s_add_u32 m0, s71, 1024
    s_mov_b32 s70, 55296
    buffer_load_dwordx4 v11, s[56:59], s70 offen  lds
    s_add_u32 m0, s71, 2048
    s_mov_b32 s70, 110592
    buffer_load_dwordx4 v11, s[56:59], s70 offen  lds
    s_add_u32 m0, s71, 3072
    s_mov_b32 s70, 165888
    buffer_load_dwordx4 v11, s[56:59], s70 offen  lds
    s_add_u32 m0, s71, 4096
    s_mov_b32 s70, 221184
    buffer_load_dwordx4 v11, s[56:59], s70 offen  lds
    s_add_u32 m0, s71, 5120
    s_mov_b32 s70, 276480
    buffer_load_dwordx4 v11, s[56:59], s70 offen  lds
    s_add_u32 m0, s71, 6144
    s_mov_b32 s70, 331776
    buffer_load_dwordx4 v11, s[56:59], s70 offen  lds
    s_add_u32 m0, s71, 7168
    s_mov_b32 s70, 387072
    buffer_load_dwordx4 v11, s[56:59], s70 offen  lds
    s_add_u32 m0, s71, 8192
    s_mov_b32 s70, 442368
    buffer_load_dwordx4 v11, s[56:59], s70 offen  lds
    s_add_u32 m0, s71, 9216
    s_mov_b32 s70, 497664
    buffer_load_dwordx4 v11, s[56:59], s70 offen  lds
    s_add_u32 m0, s72, 0
    s_mov_b32 s70, 0
    buffer_load_dwordx4 v11, s[60:63], s70 offen  lds
    s_add_u32 m0, s72, 1024
    s_mov_b32 s70, 55296
    buffer_load_dwordx4 v11, s[60:63], s70 offen  lds
    s_add_u32 m0, s72, 2048
    s_mov_b32 s70, 110592
    buffer_load_dwordx4 v11, s[60:63], s70 offen  lds
    s_add_u32 m0, s72, 3072
    s_mov_b32 s70, 165888
    buffer_load_dwordx4 v11, s[60:63], s70 offen  lds
    s_add_u32 m0, s72, 4096
    s_mov_b32 s70, 221184
    buffer_load_dwordx4 v11, s[60:63], s70 offen  lds
    s_add_u32 m0, s72, 5120
    s_mov_b32 s70, 276480
    buffer_load_dwordx4 v11, s[60:63], s70 offen  lds
    s_add_u32 m0, s72, 6144
    s_mov_b32 s70, 331776
    buffer_load_dwordx4 v11, s[60:63], s70 offen  lds
    s_add_u32 m0, s72, 7168
    s_mov_b32 s70, 387072
    buffer_load_dwordx4 v11, s[60:63], s70 offen  lds
    s_add_u32 m0, s72, 8192
    s_mov_b32 s70, 442368
    buffer_load_dwordx4 v11, s[60:63], s70 offen  lds
    s_add_u32 m0, s72, 9216
    s_mov_b32 s70, 497664
    buffer_load_dwordx4 v11, s[60:63], s70 offen  lds
    s_mov_b32 s64, s50
    s_mov_b32 s65, s51
    s_mov_b32 s66, 0x21c000
    s_mov_b32 s67, 0x20000
    s_mul_i32 s3, s43, 40960
    s_add_u32 s3, s3, s68
    v_lshrrev_b32 v2, 3, v1
    v_and_b32 v3, 2, v2
    s_lshl_b32 s70, s30, 2
    v_xor_b32 v3, s70, v3
    v_xor_b32 v3, v3, v1
    v_and_b32 v3, 7, v3
    v_mul_u32_u24 v2, 1280, v2
    v_lshl_add_u32 v2, v3, 4, v2
    v_add_u32 v12, s3, v2
    s_add_u32 m0, s68, 81920
    s_mov_b32 s70, 0
    buffer_load_dwordx4 v12, s[64:67], s70 offen  lds
    s_add_u32 m0, s68, 82944
    s_mov_b32 s70, 128
    buffer_load_dwordx4 v12, s[64:67], s70 offen  lds
    s_add_u32 m0, s68, 83968
    s_mov_b32 s70, 256
    buffer_load_dwordx4 v12, s[64:67], s70 offen  lds
    s_add_u32 m0, s68, 84992
    s_mov_b32 s70, 384
    buffer_load_dwordx4 v12, s[64:67], s70 offen  lds
    s_add_u32 m0, s68, 86016
    s_mov_b32 s70, 512
    buffer_load_dwordx4 v12, s[64:67], s70 offen  lds
    s_add_u32 m0, s68, 87040
    s_mov_b32 s70, 640
    buffer_load_dwordx4 v12, s[64:67], s70 offen  lds
    s_add_u32 m0, s68, 88064
    s_mov_b32 s70, 768
    buffer_load_dwordx4 v12, s[64:67], s70 offen  lds
    s_add_u32 m0, s68, 89088
    s_mov_b32 s70, 896
    buffer_load_dwordx4 v12, s[64:67], s70 offen  lds
    s_add_u32 m0, s68, 90112
    s_mov_b32 s70, 1024
    buffer_load_dwordx4 v12, s[64:67], s70 offen  lds
    s_add_u32 m0, s68, 91136
    s_mov_b32 s70, 1152
    buffer_load_dwordx4 v12, s[64:67], s70 offen  lds
    s_waitcnt vmcnt(10)
    s_barrier
    s_branch K_P2_EARLY
K_FFN_C:
    v_lshrrev_b32 v180, 4, v1
    v_bfe_u32 v2, v1, 2, 2
    v_lshl_add_u32 v2, v180, 3, v2
    v_and_b32 v3, 3, v1
    v_lshlrev_b32 v3, 3, v3
    v_lshl_add_u32 v181, v2, 6, v3
    s_bfe_u32 s3, s30, 0x10001
    s_mul_i32 s3, s3, 40960
    v_xor_b32 v4, s30, v180
    v_and_b32 v4, 1, v4
    v_lshl_add_u32 v181, v4, 5, v181
    v_add_u32 v181, s3, v181
    v_bfe_u32 v4, v1, 3, 2
    v_xor_b32 v4, s30, v4
    v_and_b32 v4, 3, v4
    v_lshl_add_u32 v3, v4, 5, v3
    v_and_b32 v2, 3, v2
    v_lshl_add_u32 v3, v2, 7, v3
    v_mul_u32_u24 v182, 10240, v180
    s_mov_b32 s3, 81920
    v_add3_u32 v182, v182, v3, s3
    v_mov_b32 v183, 123904
    s_cmp_lg_u32 s30, 5
    s_cbranch_scc1 K_KW
    s_mov_b32 s3, 131072
K_KPOLL:
    s_load_dwordx2 s[68:69], s[6:7], s42 offset:128 glc
    s_waitcnt lgkmcnt(0)
    s_min_u32 s33, s68, s69
    s_cmp_lg_u32 s33, 0
    s_cbranch_scc1 K_KGOT
    s_sleep 2
    s_sub_u32 s3, s3, 1
    s_cbranch_scc0 K_KPOLL
K_KGOT:
    v_mov_b32 v176, s68
    v_mov_b32 v177, s69
    ds_write_b64 v183, v[176:177]
    v_lshlrev_b32 v2, 4, v1
    s_and_b32 s70, s68, 0x7ff
    s_sub_u32 s70, 2047, s70
    s_mul_i32 s70, s70, 1280
    s_mov_b32 m0, 134208
    s_mov_b64 exec, -1
    buffer_load_dwordx4 v2, s[12:15], s70 offen lds
    s_mov_b64 exec, 0xffff
    buffer_load_dwordx4 v2, s[12:15], s70 offen offset:1024 lds
    s_and_b32 s70, s69, 0x7ff
    s_sub_u32 s70, 2047, s70
    s_mul_i32 s70, s70, 1280
    s_mov_b32 m0, 135552
    s_mov_b64 exec, -1
    buffer_load_dwordx4 v2, s[12:15], s70 offen lds
    s_mov_b64 exec, 0xffff
    buffer_load_dwordx4 v2, s[12:15], s70 offen offset:1024 lds
    s_mov_b64 exec, -1
    v_mov_b32 v3, 16
    s_waitcnt vmcnt(0)
    ds_write_b32 v13, v3 offset:48
    s_branch K_KW2
K_KW:
    s_cmp_lt_u32 s30, 6
    s_cbranch_scc1 K_KW2
    s_cmp_eq_u32 s30, 6
    s_cbranch_scc1 K_CHF0
    s_branch K_CHF1
K_WRET_F:
K_KW2:
    s_branch K_J7f38
K_CHF0:
K_STF16:
    s_branch K_STF18
    s_nop 0
K_J7f38:
    v_and_b32 v2, 1, v1
    v_mul_u32_u24 v9, 1344, v2
    v_lshl_add_u32 v9, v180, 4, v9
    v_add_u32 v9, 134208, v9
    v_and_b32 v2, 1, v1
    v_lshlrev_b32 v192, 6, v2
    v_lshl_add_u32 v192, v180, 4, v192
    s_and_b32 s3, s30, 3
    s_lshl_b32 s3, s3, 7
    v_add3_u32 v193, v192, s3, v183
    v_add_u32 v192, 64, v193
    v_add_u32 v193, 1088, v193
    v_lshrrev_b32 v2, 5, v1
    v_bfe_u32 v3, v1, 4, 1
    v_lshl_add_u32 v3, v3, 1, v2
    v_lshlrev_b32 v3, 6, v3
    v_and_b32 v4, 15, v1
    v_lshl_add_u32 v3, v4, 2, v3
    v_add_u32 v194, 123968, v3
    v_lshlrev_b32 v4, 1, v1
    s_add_u32 s3, s3, 124992
    v_add_u32 v195, s3, v4
    v_and_b32 v2, 1, v1
    v_mul_u32_u24 v2, 2560, v2
    v_lshl_add_u32 v196, v180, 4, v2
    s_lshl_b32 s70, s30, 6
    s_add_u32 s70, s70, 125760
    v_add_u32 v196, s70, v196
    v_mov_b32 v3, 1
    s_mov_b32 s3, 1048576
K_FGK:
    s_branch K_PG7
.p2align 12
K_CHF1:
K_STF17:
    s_branch K_WRET_F
    s_nop 0
K_PG7:
    ds_read_b32 v2, v13 offset:48
    s_sleep 1
    s_sub_u32 s3, s3, 1
    s_waitcnt lgkmcnt(0)
    v_readfirstlane_b32 s33, v2
    s_nop 3
    s_cselect_b32 s33, 16, s33
    s_cmp_lt_u32 s33, 16
    s_cbranch_scc1 K_FGK
    ds_read_b128 v[96:99], v9 offset:0
    ds_read_b128 v[100:103], v9 offset:64
    ds_read_b128 v[104:107], v9 offset:128
    ds_read_b128 v[108:111], v9 offset:192
    ds_read_b128 v[112:115], v9 offset:256
    ds_read_b128 v[116:119], v9 offset:320
    ds_read_b128 v[120:123], v9 offset:384
    ds_read_b128 v[124:127], v9 offset:448
    ds_read_b128 v[128:131], v9 offset:512
    ds_read_b128 v[132:135], v9 offset:576
    ds_read_b128 v[136:139], v9 offset:640
    ds_read_b128 v[140:143], v9 offset:704
    ds_read_b128 v[144:147], v9 offset:768
    ds_read_b128 v[148:151], v9 offset:832
    ds_read_b128 v[152:155], v9 offset:896
    ds_read_b128 v[156:159], v9 offset:960
    ds_read_b128 v[160:163], v9 offset:1024
    ds_read_b128 v[164:167], v9 offset:1088
    ds_read_b128 v[168:171], v9 offset:1152
    ds_read_b128 v[172:175], v9 offset:1216
    s_setprio 3
    s_barrier
    ds_read_b64_tr_b16 v[16:17], v181 offset:0
    ds_read_b64_tr_b16 v[18:19], v181 offset:256
    ds_read_b64_tr_b16 v[20:21], v181 offset:2048
    ds_read_b64_tr_b16 v[22:23], v181 offset:2304
    ds_read_b64_tr_b16 v[24:25], v181 offset:4096
    ds_read_b64_tr_b16 v[26:27], v181 offset:4352
    ds_read_b64_tr_b16 v[28:29], v181 offset:6144
    ds_read_b64_tr_b16 v[30:31], v181 offset:6400
    ds_read_b64_tr_b16 v[32:33], v181 offset:8192
    ds_read_b64_tr_b16 v[34:35], v181 offset:8448
    ds_read_b64_tr_b16 v[36:37], v181 offset:10240
    ds_read_b64_tr_b16 v[38:39], v181 offset:10496
    ds_read_b64_tr_b16 v[40:41], v181 offset:12288
    ds_read_b64_tr_b16 v[42:43], v181 offset:12544
    ds_read_b64_tr_b16 v[44:45], v181 offset:14336
    ds_read_b64_tr_b16 v[46:47], v181 offset:14592
    ds_read_b64_tr_b16 v[48:49], v181 offset:16384
    ds_read_b64_tr_b16 v[50:51], v181 offset:16640
    ds_read_b64_tr_b16 v[52:53], v181 offset:18432
    ds_read_b64_tr_b16 v[54:55], v181 offset:18688
    ds_read_b64_tr_b16 v[56:57], v181 offset:20480
    ds_read_b64_tr_b16 v[58:59], v181 offset:20736
    ds_read_b64_tr_b16 v[60:61], v181 offset:22528
    ds_read_b64_tr_b16 v[62:63], v181 offset:22784
    ds_read_b64_tr_b16 v[64:65], v181 offset:24576
    ds_read_b64_tr_b16 v[66:67], v181 offset:24832
    ds_read_b64_tr_b16 v[68:69], v181 offset:26624
    ds_read_b64_tr_b16 v[70:71], v181 offset:26880
    ds_read_b64_tr_b16 v[72:73], v181 offset:28672
    ds_read_b64_tr_b16 v[74:75], v181 offset:28928
    ds_read_b64_tr_b16 v[76:77], v181 offset:30720
    ds_read_b64_tr_b16 v[78:79], v181 offset:30976
    ds_read_b64_tr_b16 v[80:81], v181 offset:32768
    ds_read_b64_tr_b16 v[82:83], v181 offset:33024
    ds_read_b64_tr_b16 v[84:85], v181 offset:34816
    ds_read_b64_tr_b16 v[86:87], v181 offset:35072
    ds_read_b64_tr_b16 v[88:89], v181 offset:36864
    ds_read_b64_tr_b16 v[90:91], v181 offset:37120
    ds_read_b64_tr_b16 v[92:93], v181 offset:38912
    ds_read_b64_tr_b16 v[94:95], v181 offset:39168
    s_waitcnt lgkmcnt(0)
    s_barrier
    v_mfma_f32_16x16x32_bf16 v[184:187], v[16:19], v[96:99], 0
    v_mfma_f32_16x16x32_bf16 v[188:191], v[20:23], v[100:103], 0
    v_mfma_f32_16x16x32_bf16 v[184:187], v[24:27], v[104:107], v[184:187]
    v_mfma_f32_16x16x32_bf16 v[188:191], v[28:31], v[108:111], v[188:191]
    v_mfma_f32_16x16x32_bf16 v[184:187], v[32:35], v[112:115], v[184:187]
    v_mfma_f32_16x16x32_bf16 v[188:191], v[36:39], v[116:119], v[188:191]
    v_mfma_f32_16x16x32_bf16 v[184:187], v[40:43], v[120:123], v[184:187]
    v_mfma_f32_16x16x32_bf16 v[188:191], v[44:47], v[124:127], v[188:191]
    v_mfma_f32_16x16x32_bf16 v[184:187], v[48:51], v[128:131], v[184:187]
    v_mfma_f32_16x16x32_bf16 v[188:191], v[52:55], v[132:135], v[188:191]
    v_mfma_f32_16x16x32_bf16 v[184:187], v[56:59], v[136:139], v[184:187]
    v_mfma_f32_16x16x32_bf16 v[188:191], v[60:63], v[140:143], v[188:191]
    v_mfma_f32_16x16x32_bf16 v[184:187], v[64:67], v[144:147], v[184:187]
    v_mfma_f32_16x16x32_bf16 v[188:191], v[68:71], v[148:151], v[188:191]
    v_mfma_f32_16x16x32_bf16 v[184:187], v[72:75], v[152:155], v[184:187]
    v_mfma_f32_16x16x32_bf16 v[188:191], v[76:79], v[156:159], v[188:191]
    v_mfma_f32_16x16x32_bf16 v[184:187], v[80:83], v[160:163], v[184:187]
    v_mfma_f32_16x16x32_bf16 v[188:191], v[84:87], v[164:167], v[188:191]
    v_mfma_f32_16x16x32_bf16 v[184:187], v[88:91], v[168:171], v[184:187]
    v_mfma_f32_16x16x32_bf16 v[188:191], v[92:95], v[172:175], v[188:191]
    s_nop 7
    v_add_f32 v184, v184, v188
    v_add_f32 v185, v185, v189
    v_add_f32 v186, v186, v190
    v_add_f32 v187, v187, v191
    s_mov_b32 exec_lo, 0x00030003
    s_mov_b32 exec_hi, 0x00030003
    ds_write_b128 v192, v[184:187]
    s_mov_b64 exec, 1
    ds_add_u32 v13, v3 offset:52
    s_mov_b64 exec, -1
    s_cmp_lg_u32 s30, 6
    s_cbranch_scc1 K_NOS6B
    v_lshl_add_u32 v4, v1, 2, s42
    global_load_dword v7, v4, s[6:7] offset:256 sc1
    v_and_b32 v4, 0xfffffe04, v4
    global_load_dword v6, v4, s[6:7] offset:128 sc1
K_NOS6B:
    s_mov_b32 s3, 1048576
K_FGP:
    ds_read_b32 v2, v13 offset:52
    s_sleep 1
    s_sub_u32 s3, s3, 1
    s_waitcnt lgkmcnt(0)
    v_readfirstlane_b32 s33, v2
    s_nop 3
    s_cselect_b32 s33, 8, s33
    s_cmp_lt_u32 s33, 8
    s_cbranch_scc1 K_FGP
    ds_read_b32 v200, v194
    ds_read_b32 v202, v194 offset:256
    ds_read_b64_tr_b16 v[16:17], v182 offset:0
    ds_read_b64_tr_b16 v[18:19], v182 offset:512
    ds_read_b64_tr_b16 v[20:21], v182 offset:1024
    ds_read_b64_tr_b16 v[22:23], v182 offset:1536
    ds_read_b64_tr_b16 v[24:25], v182 offset:2048
    ds_read_b64_tr_b16 v[26:27], v182 offset:2560
    ds_read_b64_tr_b16 v[28:29], v182 offset:3072
    ds_read_b64_tr_b16 v[30:31], v182 offset:3584
    ds_read_b64_tr_b16 v[32:33], v182 offset:4096
    ds_read_b64_tr_b16 v[34:35], v182 offset:4608
    ds_read_b64_tr_b16 v[36:37], v182 offset:5120
    ds_read_b64_tr_b16 v[38:39], v182 offset:5632
    ds_read_b64_tr_b16 v[40:41], v182 offset:6144
    s_branch K_J83cc
K_STF18:
    s_branch K_WRET_F
    s_nop 0
K_J83cc:
    ds_read_b64_tr_b16 v[42:43], v182 offset:6656
    s_waitcnt lgkmcnt(14)
    v_cvt_pk_bf16_f32 v200, v200, v200
    v_lshlrev_b32 v200, 16, v200
    v_cvt_pk_bf16_f32 v202, v202, v202
    v_lshlrev_b32 v202, 16, v202
    v_mul_f32 v201, 0xbfb8aa3b, v200
    v_exp_f32 v201, v201
    s_nop 0
    v_add_f32 v201, 1.0, v201
    v_rcp_f32 v201, v201
    s_nop 0
    v_mul_f32 v200, v200, v201
    v_cvt_pk_bf16_f32 v200, v200, v200
    v_lshlrev_b32 v200, 16, v200
    v_mul_f32 v200, v200, v202
    v_cvt_pk_bf16_f32 v200, v200, v200
    ds_write_b16 v195, v200
    s_waitcnt lgkmcnt(0)
    ds_read_b128 v[200:203], v193
    ds_read_b64_tr_b16 v[44:45], v182 offset:7168
    ds_read_b64_tr_b16 v[46:47], v182 offset:7680
    ds_read_b64_tr_b16 v[48:49], v182 offset:8192
    ds_read_b64_tr_b16 v[50:51], v182 offset:8704
    ds_read_b64_tr_b16 v[52:53], v182 offset:9216
    ds_read_b64_tr_b16 v[54:55], v182 offset:9728
    s_waitcnt lgkmcnt(6)
    v_mfma_f32_16x16x32_bf16 v[96:99], v[16:19], v[200:203], 0
    v_mfma_f32_16x16x32_bf16 v[100:103], v[20:23], v[200:203], 0
    v_mfma_f32_16x16x32_bf16 v[104:107], v[24:27], v[200:203], 0
    v_mfma_f32_16x16x32_bf16 v[108:111], v[28:31], v[200:203], 0
    v_mfma_f32_16x16x32_bf16 v[112:115], v[32:35], v[200:203], 0
    v_mfma_f32_16x16x32_bf16 v[116:119], v[36:39], v[200:203], 0
    v_mfma_f32_16x16x32_bf16 v[120:123], v[40:43], v[200:203], 0
    s_waitcnt lgkmcnt(4)
    v_mfma_f32_16x16x32_bf16 v[124:127], v[44:47], v[200:203], 0
    s_waitcnt lgkmcnt(2)
    v_mfma_f32_16x16x32_bf16 v[128:131], v[48:51], v[200:203], 0
    s_waitcnt lgkmcnt(0)
    v_mfma_f32_16x16x32_bf16 v[132:135], v[52:55], v[200:203], 0
    s_mov_b32 exec_lo, 0x00030003
    s_mov_b32 exec_hi, 0x00030003
    ds_write_b128 v196, v[96:99] offset:0
    ds_write_b128 v196, v[100:103] offset:256
    ds_write_b128 v196, v[104:107] offset:512
    ds_write_b128 v196, v[108:111] offset:768
    ds_write_b128 v196, v[112:115] offset:1024
    ds_write_b128 v196, v[116:119] offset:1280
    ds_write_b128 v196, v[120:123] offset:1536
    ds_write_b128 v196, v[124:127] offset:1792
    ds_write_b128 v196, v[128:131] offset:2048
    ds_write_b128 v196, v[132:135] offset:2304
    v_mov_b32 v3, 1
    s_mov_b64 exec, 1
    ds_add_u32 v13, v3 offset:52
    s_mov_b64 exec, -1
    s_cmp_lg_u32 s30, 4
    s_cbranch_scc1 K_P2
    v_lshlrev_b32 v3, 4, v1
    v_add_u32 v4, 126016, v3
    s_mul_i32 s70, s43, 5120
    s_add_u32 s71, s70, 4096
    s_mov_b32 s3, 1048576
K_FGQ:
    ds_read_b32 v2, v13 offset:52
    s_sleep 1
    s_sub_u32 s3, s3, 1
    s_waitcnt lgkmcnt(0)
    v_readfirstlane_b32 s33, v2
    s_nop 3
    s_cselect_b32 s33, 12, s33
    s_cmp_lt_u32 s33, 12
    s_cbranch_scc1 K_FGQ
    ds_read_b128 v[16:19], v4 offset:0
    ds_read_b128 v[20:23], v4 offset:1024
    ds_read_b128 v[24:27], v4 offset:2048
    ds_read_b128 v[28:31], v4 offset:3072
    ds_read_b128 v[32:35], v4 offset:4096
    s_waitcnt lgkmcnt(4)
    buffer_store_dwordx4 v[16:19], v3, s[60:63], s70 offen offset:0 sc1
    s_waitcnt lgkmcnt(3)
    buffer_store_dwordx4 v[20:23], v3, s[60:63], s70 offen offset:1024 sc1
    s_waitcnt lgkmcnt(2)
    buffer_store_dwordx4 v[24:27], v3, s[60:63], s70 offen offset:2048 sc1
    s_waitcnt lgkmcnt(1)
    buffer_store_dwordx4 v[28:31], v3, s[60:63], s70 offen offset:3072 sc1
    s_waitcnt lgkmcnt(0)
    buffer_store_dwordx4 v[32:35], v3, s[60:63], s71 offen offset:0 sc1
    s_mov_b32 s3, 1
    s_waitcnt vmcnt(0)
    s_atomic_add s3, s[6:7], 606720 glc
    ds_read_b64 v[176:177], v183
    s_waitcnt lgkmcnt(0)
    s_cmp_lg_u32 s3, 53
    s_cbranch_scc1 K_P2
    v_readfirstlane_b32 s70, v176
    s_and_b32 s70, s70, 0x7ff
    s_sub_u32 s70, 2047, s70
    s_lshr_b32 s70, s70, 7
    s_mul_i32 s70, s70, 5120
    s_atomic_add s3, s[6:7], s70 offset:524424
    s_atomic_add s3, s[6:7], s70 offset:524936
    s_atomic_add s3, s[6:7], s70 offset:525448
    s_atomic_add s3, s[6:7], s70 offset:525960
    s_atomic_add s3, s[6:7], s70 offset:526472
    s_atomic_add s3, s[6:7], s70 offset:526984
    s_atomic_add s3, s[6:7], s70 offset:527496
    s_atomic_add s3, s[6:7], s70 offset:528008
    s_atomic_add s3, s[6:7], s70 offset:528520
    s_atomic_add s3, s[6:7], s70 offset:529032
    v_readfirstlane_b32 s70, v177
    s_and_b32 s70, s70, 0x7ff
    s_sub_u32 s70, 2047, s70
    s_lshr_b32 s70, s70, 7
    s_mul_i32 s70, s70, 5120
    s_atomic_add s3, s[6:7], s70 offset:524424
    s_atomic_add s3, s[6:7], s70 offset:524936
    s_atomic_add s3, s[6:7], s70 offset:525448
    s_atomic_add s3, s[6:7], s70 offset:525960
    s_atomic_add s3, s[6:7], s70 offset:526472
    s_atomic_add s3, s[6:7], s70 offset:526984
    s_atomic_add s3, s[6:7], s70 offset:527496
    s_atomic_add s3, s[6:7], s70 offset:528008
    s_atomic_add s3, s[6:7], s70 offset:528520
    s_atomic_add s3, s[6:7], s70 offset:529032
    s_waitcnt lgkmcnt(0)
    s_branch K_P2
K_CODE_END:
.section .rodata,"a"
.p2align 6
.amdhsa_kernel gated_mix__sliding_local_dilated__moe_arch_mod__prompt_kernel
  .amdhsa_next_free_vgpr 256
  .amdhsa_next_free_sgpr 79
  .amdhsa_accum_offset 256
  .amdhsa_group_segment_fixed_size 0
  .amdhsa_kernarg_size 96
  .amdhsa_user_sgpr_count 2
  .amdhsa_user_sgpr_kernarg_segment_ptr 1
  .amdhsa_system_sgpr_workgroup_id_x 1
.end_amdhsa_kernel
```

```asm
; @launch grid=(256,1,1) block=(512,1,1) lds=163840
.amdgcn_target "amdgcn-amd-amdhsa--gfx950"
.text
K_CPL = 34
.p2align 12
.p2align 8
.globl gated_mix__sliding_local_dilated__moe_arch_mod__prompt_kernel
.type gated_mix__sliding_local_dilated__moe_arch_mod__prompt_kernel,@function
gated_mix__sliding_local_dilated__moe_arch_mod__prompt_kernel:
    s_cmp_ge_u32 s2, 256
    s_cbranch_scc1 K_EXIT
    s_load_dwordx2 s[12:13], s[0:1], 0
    s_load_dwordx2 s[16:17], s[0:1], 8
    s_load_dwordx4 s[4:7], s[0:1], 80
    s_load_dwordx2 s[8:9], s[0:1], 16
    s_load_dwordx2 s[10:11], s[0:1], 72
    v_readfirstlane_b32 s30, v0
    s_mov_b32 s14, 0x280000
    s_mov_b32 s15, 0x20000
    s_lshr_b32 s30, s30, 6
    s_cmp_ge_u32 s2, 64
    s_cbranch_scc1 K_MAIN
    s_load_dwordx8 s[44:51], s[0:1], 32
    s_load_dwordx2 s[52:53], s[0:1], 64
    s_getpc_b64 s[38:39]
K_PC:
    s_lshr_b32 s3, s2, 3
    s_mul_i32 s3, s3, K_CPL
    v_add_u32 v2, s3, v0
    v_lshlrev_b32 v2, 7, v2
    v_min_u32 v2, K_CODE_END-K_PC-4, v2
    v_cmp_gt_u32 vcc, K_CPL, v0
    s_and_saveexec_b64 s[20:21], vcc
    s_cbranch_execz K_NOPF
    global_load_dword v6, v2, s[38:39]
K_NOPF:
    s_mov_b64 exec, -1
    s_cmp_lg_u32 s30, 4
    s_cbranch_scc1 K_AUX
    s_min_u32 s3, s2, 8
    s_mul_i32 s3, s3, 10240
    s_add_u32 s33, s3, 10240
    s_cmp_lt_u32 s2, 8
    s_cbranch_scc1 K_ZS
    s_cmp_lg_u32 s2, 63
    s_cbranch_scc1 K_AUX
    s_mov_b32 s33, 0
K_ZS:
    v_lshlrev_b32 v2, 4, v0
    v_mov_b32 v8, 0
    v_mov_b32 v9, 0
    v_mov_b32 v10, 0
    v_mov_b32 v11, 0
    s_waitcnt lgkmcnt(0)
    s_add_u32 s20, s6, 0x7f000
    s_addc_u32 s21, s7, 0
    s_mov_b32 s22, 0x15400
    s_mov_b32 s23, 0x20000
K_ZL:
    buffer_store_dwordx4 v[8:11], v2, s[20:23], s3 offen sc1
    s_add_u32 s3, s3, 1024
    s_cmp_lt_u32 s3, s33
    s_cbranch_scc1 K_ZL
    s_branch K_AUX
K_MAIN:
    s_cmp_ge_u32 s30, 4
    s_cbranch_scc1 K_CONS
    s_bfe_u32 s3, s2, 0x20001
    s_mul_i32 s44, s3, 655360
    s_add_u32 s14, s44, 655360
    s_lshr_b32 s33, s2, 6
    s_mul_i32 s3, s33, 225280
    s_add_u32 s44, s44, s3
    s_mul_i32 s3, s30, 61440
    s_add_u32 s44, s44, s3
    s_sub_u32 s44, s44, 245760
    v_bfe_u32 v3, v0, 4, 2
    s_lshr_b32 s3, s2, 1
    s_and_b32 s3, s3, 28
    s_or_b32 s3, s3, 0x40000
    v_lshlrev_b32 v2, 1, v3
    v_sub_u32 v2, v0, v2
    s_and_b32 s50, s2, 0xc1
    s_mov_b32 s49, 0x225310
    s_cmpk_eq_u32 s50, 128
    s_cselect_b32 s49, 0x75275526, s49
    s_cmpk_eq_u32 s50, 192
    s_cselect_b32 s49, 0x37750756, s49
    s_cmpk_eq_u32 s50, 65
    s_cselect_b32 s49, 0x225510, s49
    s_cmpk_eq_u32 s50, 129
    s_cselect_b32 s49, 0x75275525, s49
    s_cmpk_eq_u32 s50, 193
    s_cselect_b32 s49, 0x37769756, s49
    s_bfe_u32 s49, s49, s3
    s_bfe_u32 s32, 0x64317520, s3
    v_and_b32 v2, 15, v2
    v_mul_u32_u24 v5, 3840, v3
    s_lshl_b32 s3, s2, 2
    s_lshr_b32 s3, 0x44032335, s3
    s_and_b32 s3, s3, 15
    s_add_u32 s49, s49, s3
    s_mov_b32 s33, 0x00a55a
    v_subrev_u32 v5, 160, v5
    s_sub_u32 s3, s49, 10
    s_cselect_b32 s49, s49, s3
    v_mul_u32_u24 v4, 52, v2
    v_lshrrev_b32 v4, 5, v4
    v_and_b32 v4, 24, v4
    v_bfe_u32 v4, s33, v4, 8
    v_add_u32 v4, v4, v2
    v_lshl_add_u32 v218, v4, 4, v5
    v_add_u32 v4, 1, v2
    v_lshrrev_b32 v4, 4, v4
    v_lshl_add_u32 v218, v4, 28, v218
    v_xor_b32 v2, 8, v2
    v_mul_u32_u24 v4, 52, v2
    v_lshrrev_b32 v4, 5, v4
    v_and_b32 v4, 24, v4
    v_bfe_u32 v4, s33, v4, 8
    v_add_u32 v4, v4, v2
    v_lshl_add_u32 v219, v4, 4, v5
    v_add_u32 v4, 1, v2
    v_lshrrev_b32 v4, 4, v4
    v_lshl_add_u32 v219, v4, 28, v219
    s_bitcmp1_b32 s2, 0
    s_cselect_b32 s3, 8, 0
    s_add_u32 s32, s32, s3
    s_mul_i32 s50, s32, 80
    s_mul_i32 s3, s30, 61440
    s_add_u32 s50, s50, s3
    s_lshl_b32 s46, s30, 12
    s_add_u32 s46, s46, 24576
    s_mul_i32 s45, s30, 6144
    s_mov_b32 s18, 0x258000
    s_mov_b32 s19, 0x20000
    v_xor_b32 v3, v3, v0
    v_and_b32 v3, 7, v3
    v_bfe_u32 v2, v0, 3, 3
    v_mul_u32_u24 v2, 1280, v2
    v_lshl_add_u32 v216, v3, 4, v2
    v_xor_b32 v217, 64, v216
    s_lshl_b32 s47, s49, 7
    s_mul_i32 s48, s49, 245760
    s_add_u32 s51, s44, s47
    s_add_u32 s48, s48, s50
    s_add_u32 s49, s49, 1
    s_cmp_eq_u32 s49, 10
    s_cselect_b32 s49, 0, s49
    s_waitcnt lgkmcnt(0)
    s_add_u32 m0, s46, 81920
    s_add_u32 s52, s48, 0
    buffer_load_dwordx4 v218, s[16:19], s52 offen lds
    s_add_u32 m0, s45, 81920
    s_max_i32 s52, s51, s47
    buffer_load_dwordx4 v216, s[12:15], s52 offen lds
    s_add_u32 m0, s46, 82944
    s_add_u32 s52, s48, 15360
    buffer_load_dwordx4 v218, s[16:19], s52 offen lds
    s_add_u32 m0, s45, 82944
    s_add_u32 s52, s51, 10240
    s_max_i32 s52, s52, s47
    buffer_load_dwordx4 v217, s[12:15], s52 offen lds
    s_add_u32 m0, s45, 83968
    s_add_u32 s52, s51, 20480
    buffer_load_dwordx4 v216, s[12:15], s52 offen lds
    s_add_u32 m0, s46, 83968
    s_add_u32 s52, s48, 30720
    buffer_load_dwordx4 v219, s[16:19], s52 offen lds
    s_add_u32 m0, s45, 84992
    s_add_u32 s52, s51, 30720
    buffer_load_dwordx4 v217, s[12:15], s52 offen lds
    s_add_u32 m0, s46, 84992
    s_add_u32 s52, s48, 46080
    buffer_load_dwordx4 v219, s[16:19], s52 offen lds
    s_add_u32 m0, s45, 86016
    s_add_u32 s52, s51, 40960
    buffer_load_dwordx4 v216, s[12:15], s52 offen lds
    s_add_u32 m0, s45, 87040
    s_add_u32 s52, s51, 51200
    buffer_load_dwordx4 v217, s[12:15], s52 offen lds
    s_lshl_b32 s47, s49, 7
    s_mul_i32 s48, s49, 245760
    s_add_u32 s51, s44, s47
    s_add_u32 s48, s48, s50
    s_add_u32 s49, s49, 1
    s_cmp_eq_u32 s49, 10
    s_cselect_b32 s49, 0, s49
    s_add_u32 m0, s46, 0
    s_add_u32 s52, s48, 0
    buffer_load_dwordx4 v218, s[16:19], s52 offen lds
    s_add_u32 m0, s45, 0
    s_max_i32 s52, s51, s47
    buffer_load_dwordx4 v216, s[12:15], s52 offen lds
    s_add_u32 m0, s46, 1024
    s_add_u32 s52, s48, 15360
    buffer_load_dwordx4 v218, s[16:19], s52 offen lds
    s_add_u32 m0, s45, 1024
    s_add_u32 s52, s51, 10240
    s_max_i32 s52, s52, s47
    buffer_load_dwordx4 v217, s[12:15], s52 offen lds
    s_add_u32 m0, s45, 2048
    s_add_u32 s52, s51, 20480
    buffer_load_dwordx4 v216, s[12:15], s52 offen lds
    s_add_u32 m0, s46, 2048
    s_add_u32 s52, s48, 30720
    buffer_load_dwordx4 v219, s[16:19], s52 offen lds
    s_mov_b32 s43, s30
    v_and_b32 v1, 63, v0
    v_mov_b32 v7, 0
    s_and_b32 s28, s2, 7
    s_lshr_b32 s29, s2, 3
    s_xor_b32 s30, s30, 4
    s_lshr_b32 s34, s29, 3
    s_lshl_b32 s34, s34, 2
    s_and_b32 s3, s29, 3
    s_add_u32 s34, s34, s3
    s_add_u32 s34, s34, 4
    s_bitcmp1_b32 s29, 2
    s_cselect_b32 s34, -1, s34
    s_cmp_lt_u32 s29, 8
    s_cselect_b32 s34, s29, s34
    s_lshl_b32 s40, s28, 1
    s_cmp_ge_u32 s34, 10
    s_addc_u32 s40, s40, 0
    s_sub_u32 s41, s34, 10
    s_cmp_ge_u32 s34, 10
    s_cselect_b32 s41, s41, s34
    s_mul_i32 s42, s28, 20
    s_add_u32 s42, s42, s34
    s_and_b32 s42, s42, 255
    s_lshl_b32 s42, s42, 9
    s_add_u32 s42, s42, 524288
    s_lshr_b32 s31, s28, 1
    s_lshl_b32 s31, s31, 5
    s_lshr_b32 s3, s29, 3
    s_mul_i32 s3, s3, 11
    s_add_u32 s31, s31, s3
    s_sub_u32 s31, s31, 11
    s_and_b32 s32, s28, 1
    s_lshl_b32 s32, s32, 3
    s_and_b32 s3, s29, 7
    s_lshl_b32 s3, s3, 2
    s_lshr_b32 s3, 0x64317520, s3
    s_and_b32 s3, s3, 7
    s_add_u32 s32, s32, s3
    s_and_b32 s35, s29, 3
    s_and_b32 s3, s29, 4
    s_lshl_b32 s3, s3, 1
    s_add_u32 s35, s35, s3
    s_and_b32 s3, s28, 1
    s_lshl_b32 s3, s3, 2
    s_add_u32 s35, s35, s3
K_LOADER:
    s_mov_b32 s24, s8
    s_mov_b32 s25, s9
    s_mov_b32 s26, 0xc8000
    s_mov_b32 s27, 0x20000
    v_and_b32 v8, 15, v1
    v_lshrrev_b32 v9, 4, v1
    v_bfe_u32 v10, v1, 2, 2
    v_and_b32 v11, 3, v1
    s_add_u32 s20, s6, 0x100000
    s_addc_u32 s21, s7, 0
    s_mov_b32 s22, 0x280000
    s_mov_b32 s23, 0x20000
    s_lshr_b32 s53, s35, 2
    s_add_u32 s3, s53, s35
    s_lshl_b32 s3, s3, 12
    s_mul_i32 s33, s53, 19456
    s_lshl_b32 s53, s35, 8
    s_add_u32 s33, s33, s53
    s_add_u32 s33, s33, 16384
    s_lshr_b32 s53, s31, 5
    s_add_u32 s53, s53, 1
    s_mul_i32 s22, s53, 655360
    s_mov_b32 s53, s31
    s_add_u32 s54, s53, s43
    v_mov_b32 v3, s54
    v_lshrrev_b32 v2, 2, v3
    v_mul_u32_u24 v2, 76, v2
    v_add_lshl_u32 v2, v2, v3, 10
    v_lshl_add_u32 v2, v8, 4, v2
    v_add_u32 v220, s3, v2
    v_lshl_add_u32 v220, v9, 8, v220
    s_lshl_b32 s3, s43, 2
    v_add_u32 v4, s3, v9
    v_add_u32 v3, s53, v4
    v_lshrrev_b32 v2, 2, v3
    v_mul_u32_u24 v2, 76, v2
    v_add_lshl_u32 v2, v2, v3, 10
    v_lshl_add_u32 v2, v8, 4, v2
    v_add_u32 v221, s33, v2
    v_mov_b32 v5, 0x10000000
    v_cmp_gt_u32 vcc, 11, v4
    v_mov_b32 v224, -1
    v_mov_b32 v225, -1
    v_mov_b32 v226, -1
    v_mov_b32 v227, -1
    v_cndmask_b32 v221, v5, v221, vcc
    v_lshrrev_b32 v2, 3, v1
    v_mul_u32_u24 v2, 1280, v2
    v_lshrrev_b32 v3, 2, v1
    v_and_b32 v3, 4, v3
    v_and_b32 v4, 7, v1
    v_xor_b32 v3, v3, v4
    v_lshl_add_u32 v2, v3, 4, v2
    s_lshl_b32 s33, s41, 7
    v_add_u32 v222, s33, v2
    v_lshrrev_b32 v5, 5, v1
    v_mul_u32_u24 v5, 20480, v5
    v_add_u32 v5, v5, v222
    s_mov_b32 s30, s43
    s_waitcnt vmcnt(6)
    s_barrier
    s_add_u32 m0, s45, 3072
    s_add_u32 s52, s51, 30720
    buffer_load_dwordx4 v217, s[12:15], s52 offen lds
    s_add_u32 m0, s46, 3072
    s_add_u32 s52, s48, 46080
    buffer_load_dwordx4 v219, s[16:19], s52 offen lds
    s_add_u32 m0, s45, 4096
    s_add_u32 s52, s51, 40960
    buffer_load_dwordx4 v216, s[12:15], s52 offen lds
    s_add_u32 m0, s45, 5120
    s_add_u32 s52, s51, 51200
    buffer_load_dwordx4 v217, s[12:15], s52 offen lds
    s_lshl_b32 s47, s49, 7
    s_mul_i32 s48, s49, 245760
    s_add_u32 s51, s44, s47
    s_add_u32 s48, s48, s50
    s_add_u32 s49, s49, 1
    s_cmp_eq_u32 s49, 10
    s_cselect_b32 s49, 0, s49
    s_add_u32 m0, s46, 40960
    s_add_u32 s52, s48, 0
    buffer_load_dwordx4 v218, s[16:19], s52 offen lds
    s_add_u32 m0, s45, 40960
    s_max_i32 s52, s51, s47
    buffer_load_dwordx4 v216, s[12:15], s52 offen lds
    s_add_u32 m0, s46, 41984
    s_add_u32 s52, s48, 15360
    buffer_load_dwordx4 v218, s[16:19], s52 offen lds
    s_add_u32 m0, s45, 41984
    s_add_u32 s52, s51, 10240
    s_max_i32 s52, s52, s47
    buffer_load_dwordx4 v217, s[12:15], s52 offen lds
    s_add_u32 m0, s45, 43008
    s_add_u32 s52, s51, 20480
    buffer_load_dwordx4 v216, s[12:15], s52 offen lds
    s_add_u32 m0, s46, 43008
    s_add_u32 s52, s48, 30720
    buffer_load_dwordx4 v219, s[16:19], s52 offen lds
    s_waitcnt vmcnt(6)
    s_barrier
    s_add_u32 m0, s45, 44032
    s_add_u32 s52, s51, 30720
    buffer_load_dwordx4 v217, s[12:15], s52 offen lds
    s_add_u32 m0, s46, 44032
    s_add_u32 s52, s48, 46080
    buffer_load_dwordx4 v219, s[16:19], s52 offen lds
    s_add_u32 m0, s45, 45056
    s_add_u32 s52, s51, 40960
    buffer_load_dwordx4 v216, s[12:15], s52 offen lds
    s_add_u32 m0, s45, 46080
    s_add_u32 s52, s51, 51200
    buffer_load_dwordx4 v217, s[12:15], s52 offen lds
    s_lshl_b32 s47, s49, 7
    s_mul_i32 s48, s49, 245760
    s_add_u32 s51, s44, s47
    s_add_u32 s48, s48, s50
    s_add_u32 s49, s49, 1
    s_cmp_eq_u32 s49, 10
    s_cselect_b32 s49, 0, s49
    s_add_u32 m0, s46, 81920
    s_add_u32 s52, s48, 0
    buffer_load_dwordx4 v218, s[16:19], s52 offen lds
    s_add_u32 m0, s45, 81920
    s_max_i32 s52, s51, s47
    buffer_load_dwordx4 v216, s[12:15], s52 offen lds
    s_add_u32 m0, s46, 82944
    s_add_u32 s52, s48, 15360
    buffer_load_dwordx4 v218, s[16:19], s52 offen lds
    s_add_u32 m0, s45, 82944
    s_add_u32 s52, s51, 10240
    s_max_i32 s52, s52, s47
    buffer_load_dwordx4 v217, s[12:15], s52 offen lds
    s_add_u32 m0, s45, 83968
    s_add_u32 s52, s51, 20480
    buffer_load_dwordx4 v216, s[12:15], s52 offen lds
    s_add_u32 m0, s46, 83968
    s_add_u32 s52, s48, 30720
    buffer_load_dwordx4 v219, s[16:19], s52 offen lds
    s_waitcnt vmcnt(6)
    s_barrier
    s_add_u32 m0, s45, 84992
    s_add_u32 s52, s51, 30720
    buffer_load_dwordx4 v217, s[12:15], s52 offen lds
    s_add_u32 m0, s46, 84992
    s_add_u32 s52, s48, 46080
    buffer_load_dwordx4 v219, s[16:19], s52 offen lds
    s_add_u32 m0, s45, 86016
    s_add_u32 s52, s51, 40960
    buffer_load_dwordx4 v216, s[12:15], s52 offen lds
    s_add_u32 m0, s45, 87040
    s_add_u32 s52, s51, 51200
    buffer_load_dwordx4 v217, s[12:15], s52 offen lds
    s_lshl_b32 s47, s49, 7
    s_mul_i32 s48, s49, 245760
    s_add_u32 s51, s44, s47
    s_add_u32 s48, s48, s50
    s_add_u32 s49, s49, 1
    s_cmp_eq_u32 s49, 10
    s_cselect_b32 s49, 0, s49
    s_add_u32 m0, s46, 0
    s_add_u32 s52, s48, 0
    buffer_load_dwordx4 v218, s[16:19], s52 offen lds
    s_add_u32 m0, s45, 0
    s_max_i32 s52, s51, s47
    buffer_load_dwordx4 v216, s[12:15], s52 offen lds
    s_add_u32 m0, s46, 1024
    s_add_u32 s52, s48, 15360
    buffer_load_dwordx4 v218, s[16:19], s52 offen lds
    s_add_u32 m0, s45, 1024
    s_add_u32 s52, s51, 10240
    s_max_i32 s52, s52, s47
    buffer_load_dwordx4 v217, s[12:15], s52 offen lds
    s_add_u32 m0, s45, 2048
    s_add_u32 s52, s51, 20480
    buffer_load_dwordx4 v216, s[12:15], s52 offen lds
    s_add_u32 m0, s46, 2048
    s_add_u32 s52, s48, 30720
    buffer_load_dwordx4 v219, s[16:19], s52 offen lds
    s_waitcnt vmcnt(6)
    s_barrier
    s_add_u32 m0, s45, 3072
    s_add_u32 s52, s51, 30720
    buffer_load_dwordx4 v217, s[12:15], s52 offen lds
    s_add_u32 m0, s46, 3072
    s_add_u32 s52, s48, 46080
    buffer_load_dwordx4 v219, s[16:19], s52 offen lds
    s_add_u32 m0, s45, 4096
    s_add_u32 s52, s51, 40960
    buffer_load_dwordx4 v216, s[12:15], s52 offen lds
    s_add_u32 m0, s45, 5120
    s_add_u32 s52, s51, 51200
    buffer_load_dwordx4 v217, s[12:15], s52 offen lds
    s_lshl_b32 s47, s49, 7
    s_mul_i32 s48, s49, 245760
    s_add_u32 s51, s44, s47
    s_add_u32 s48, s48, s50
    s_add_u32 s49, s49, 1
    s_cmp_eq_u32 s49, 10
    s_cselect_b32 s49, 0, s49
    s_add_u32 m0, s46, 40960
    s_add_u32 s52, s48, 0
    buffer_load_dwordx4 v218, s[16:19], s52 offen lds
    s_add_u32 m0, s45, 40960
    s_max_i32 s52, s51, s47
    buffer_load_dwordx4 v216, s[12:15], s52 offen lds
    s_add_u32 m0, s46, 41984
    s_add_u32 s52, s48, 15360
    buffer_load_dwordx4 v218, s[16:19], s52 offen lds
    s_add_u32 m0, s45, 41984
    s_add_u32 s52, s51, 10240
    s_max_i32 s52, s52, s47
    buffer_load_dwordx4 v217, s[12:15], s52 offen lds
    s_add_u32 m0, s45, 43008
    s_add_u32 s52, s51, 20480
    buffer_load_dwordx4 v216, s[12:15], s52 offen lds
    s_add_u32 m0, s46, 43008
    s_add_u32 s52, s48, 30720
    buffer_load_dwordx4 v219, s[16:19], s52 offen lds
    s_waitcnt vmcnt(6)
    s_barrier
    s_add_u32 m0, s45, 44032
    s_add_u32 s52, s51, 30720
    buffer_load_dwordx4 v217, s[12:15], s52 offen lds
    s_add_u32 m0, s46, 44032
    s_add_u32 s52, s48, 46080
    buffer_load_dwordx4 v219, s[16:19], s52 offen lds
    s_add_u32 m0, s45, 45056
    s_add_u32 s52, s51, 40960
    buffer_load_dwordx4 v216, s[12:15], s52 offen lds
    s_add_u32 m0, s45, 46080
    s_add_u32 s52, s51, 51200
    buffer_load_dwordx4 v217, s[12:15], s52 offen lds
    s_lshl_b32 s47, s49, 7
    s_mul_i32 s48, s49, 245760
    s_add_u32 s51, s44, s47
    s_add_u32 s48, s48, s50
    s_add_u32 s49, s49, 1
    s_cmp_eq_u32 s49, 10
    s_cselect_b32 s49, 0, s49
    s_add_u32 m0, s46, 81920
    s_add_u32 s52, s48, 0
    buffer_load_dwordx4 v218, s[16:19], s52 offen lds
    s_add_u32 m0, s45, 81920
    s_max_i32 s52, s51, s47
    buffer_load_dwordx4 v216, s[12:15], s52 offen lds
    s_add_u32 m0, s46, 82944
    s_add_u32 s52, s48, 15360
    buffer_load_dwordx4 v218, s[16:19], s52 offen lds
    s_add_u32 m0, s45, 82944
    s_add_u32 s52, s51, 10240
    s_max_i32 s52, s52, s47
    buffer_load_dwordx4 v217, s[12:15], s52 offen lds
    s_add_u32 m0, s45, 83968
    s_add_u32 s52, s51, 20480
    buffer_load_dwordx4 v216, s[12:15], s52 offen lds
    s_add_u32 m0, s46, 83968
    s_add_u32 s52, s48, 30720
    buffer_load_dwordx4 v219, s[16:19], s52 offen lds
    s_waitcnt vmcnt(6)
    s_barrier
    s_add_u32 m0, s45, 84992
    s_add_u32 s52, s51, 30720
    buffer_load_dwordx4 v217, s[12:15], s52 offen lds
    s_add_u32 m0, s46, 84992
    s_add_u32 s52, s48, 46080
    buffer_load_dwordx4 v219, s[16:19], s52 offen lds
    s_add_u32 m0, s45, 86016
    s_add_u32 s52, s51, 40960
    buffer_load_dwordx4 v216, s[12:15], s52 offen lds
    s_add_u32 m0, s45, 87040
    s_add_u32 s52, s51, 51200
    buffer_load_dwordx4 v217, s[12:15], s52 offen lds
    s_lshl_b32 s47, s49, 7
    s_mul_i32 s48, s49, 245760
    s_add_u32 s51, s44, s47
    s_add_u32 s48, s48, s50
    s_add_u32 s49, s49, 1
    s_cmp_eq_u32 s49, 10
    s_cselect_b32 s49, 0, s49
    s_add_u32 m0, s46, 0
    s_add_u32 s52, s48, 0
    buffer_load_dwordx4 v218, s[16:19], s52 offen lds
    s_add_u32 m0, s45, 0
    s_max_i32 s52, s51, s47
    buffer_load_dwordx4 v216, s[12:15], s52 offen lds
    s_add_u32 m0, s46, 1024
    s_add_u32 s52, s48, 15360
    buffer_load_dwordx4 v218, s[16:19], s52 offen lds
    s_add_u32 m0, s45, 1024
    s_add_u32 s52, s51, 10240
    s_max_i32 s52, s52, s47
    buffer_load_dwordx4 v217, s[12:15], s52 offen lds
    s_add_u32 m0, s45, 2048
    s_add_u32 s52, s51, 20480
    buffer_load_dwordx4 v216, s[12:15], s52 offen lds
    s_add_u32 m0, s46, 2048
    s_add_u32 s52, s48, 30720
    buffer_load_dwordx4 v219, s[16:19], s52 offen lds
    s_branch K_PG0
.p2align 12
K_CHM0:
K_STM0:
    s_branch K_WRET_M
    s_nop 0
K_PG0:
    s_waitcnt vmcnt(6)
    s_barrier
    s_add_u32 m0, s45, 3072
    s_add_u32 s52, s51, 30720
    buffer_load_dwordx4 v217, s[12:15], s52 offen lds
    s_add_u32 m0, s46, 3072
    s_add_u32 s52, s48, 46080
    buffer_load_dwordx4 v219, s[16:19], s52 offen lds
    s_add_u32 m0, s45, 4096
    s_add_u32 s52, s51, 40960
    buffer_load_dwordx4 v216, s[12:15], s52 offen lds
    s_add_u32 m0, s45, 5120
    s_add_u32 s52, s51, 51200
    buffer_load_dwordx4 v217, s[12:15], s52 offen lds
    s_lshl_b32 s47, s49, 7
    s_mul_i32 s48, s49, 245760
    s_add_u32 s51, s44, s47
    s_add_u32 s48, s48, s50
    s_add_u32 s49, s49, 1
    s_cmp_eq_u32 s49, 10
    s_cselect_b32 s49, 0, s49
    s_add_u32 m0, s46, 40960
    s_add_u32 s52, s48, 0
    buffer_load_dwordx4 v218, s[16:19], s52 offen lds
    s_add_u32 m0, s45, 40960
    s_max_i32 s52, s51, s47
    buffer_load_dwordx4 v216, s[12:15], s52 offen lds
    s_add_u32 m0, s46, 41984
    s_add_u32 s52, s48, 15360
    buffer_load_dwordx4 v218, s[16:19], s52 offen lds
    s_add_u32 m0, s45, 41984
    s_add_u32 s52, s51, 10240
    s_max_i32 s52, s52, s47
    buffer_load_dwordx4 v217, s[12:15], s52 offen lds
    s_add_u32 m0, s45, 43008
    s_add_u32 s52, s51, 20480
    buffer_load_dwordx4 v216, s[12:15], s52 offen lds
    s_add_u32 m0, s46, 43008
    s_add_u32 s52, s48, 30720
    buffer_load_dwordx4 v219, s[16:19], s52 offen lds
    s_waitcnt vmcnt(6)
    s_barrier
    s_add_u32 m0, s45, 44032
    s_add_u32 s52, s51, 30720
    buffer_load_dwordx4 v217, s[12:15], s52 offen lds
    s_add_u32 m0, s46, 44032
    s_add_u32 s52, s48, 46080
    buffer_load_dwordx4 v219, s[16:19], s52 offen lds
    s_add_u32 m0, s45, 45056
    s_add_u32 s52, s51, 40960
    buffer_load_dwordx4 v216, s[12:15], s52 offen lds
    s_add_u32 m0, s45, 46080
    s_add_u32 s52, s51, 51200
    buffer_load_dwordx4 v217, s[12:15], s52 offen lds
    s_lshl_b32 s47, s49, 7
    s_mul_i32 s48, s49, 245760
    s_add_u32 s51, s44, s47
    s_add_u32 s48, s48, s50
    s_add_u32 s49, s49, 1
    s_cmp_eq_u32 s49, 10
    s_cselect_b32 s49, 0, s49
    s_add_u32 m0, s46, 81920
    s_add_u32 s52, s48, 0
    buffer_load_dwordx4 v218, s[16:19], s52 offen lds
    s_add_u32 m0, s45, 81920
    s_max_i32 s52, s51, s47
    buffer_load_dwordx4 v216, s[12:15], s52 offen lds
    s_add_u32 m0, s46, 82944
    s_add_u32 s52, s48, 15360
    buffer_load_dwordx4 v218, s[16:19], s52 offen lds
    s_add_u32 m0, s45, 82944
    s_add_u32 s52, s51, 10240
    s_max_i32 s52, s52, s47
    buffer_load_dwordx4 v217, s[12:15], s52 offen lds
    s_add_u32 m0, s45, 83968
    s_add_u32 s52, s51, 20480
    buffer_load_dwordx4 v216, s[12:15], s52 offen lds
    s_add_u32 m0, s46, 83968
    s_add_u32 s52, s48, 30720
    buffer_load_dwordx4 v219, s[16:19], s52 offen lds
    s_waitcnt vmcnt(6)
    s_barrier
    s_load_dword s54, s[4:5], 192
    s_add_u32 m0, s45, 84992
    s_add_u32 s52, s51, 30720
    buffer_load_dwordx4 v217, s[12:15], s52 offen lds
    s_add_u32 m0, s46, 84992
    s_add_u32 s52, s48, 46080
    buffer_load_dwordx4 v219, s[16:19], s52 offen lds
    s_add_u32 m0, s45, 86016
    s_add_u32 s52, s51, 40960
    buffer_load_dwordx4 v216, s[12:15], s52 offen lds
    s_add_u32 m0, s45, 87040
    s_add_u32 s52, s51, 51200
    buffer_load_dwordx4 v217, s[12:15], s52 offen lds
    s_waitcnt lgkmcnt(0)
    s_cmp_ge_u32 s54, 8
    s_cbranch_scc1 K_ZO0
    s_mov_b32 s3, 16384
K_ZB0:
    v_mov_b32 v4, 192
    global_load_dword v4, v4, s[4:5] sc1
    s_waitcnt vmcnt(0)
    v_readfirstlane_b32 s33, v4
    s_cmp_ge_u32 s33, 8
    s_cbranch_scc1 K_ZO0
    s_sleep 8
    s_sub_u32 s3, s3, 1
    s_cbranch_scc0 K_ZB0
K_ZO0:
    s_cmp_eq_u32 s34, -1
    s_cbranch_scc1 K_NOLT
    s_lshl_b32 s47, s43, 2
    s_lshr_b32 s47, 0x7520, s47
    s_and_b32 s47, s47, 7
    s_mul_i32 s47, s47, 51200
    s_lshl_b32 s48, s43, 12
    s_add_u32 s3, s47, 0
    s_add_u32 m0, s48, 0
    s_nop 0
    buffer_load_dwordx4 v222, s[24:27], s3 offen lds
    s_add_u32 s3, s47, 10240
    s_add_u32 m0, s48, 1024
    s_nop 0
    buffer_load_dwordx4 v222, s[24:27], s3 offen lds
    s_add_u32 s3, s47, 25600
    s_add_u32 m0, s48, 2048
    s_nop 0
    buffer_load_dwordx4 v222, s[24:27], s3 offen lds
    s_add_u32 s3, s47, 35840
    s_add_u32 m0, s48, 3072
    s_nop 0
    buffer_load_dwordx4 v222, s[24:27], s3 offen lds
    s_add_u32 s3, s47, 409600
    s_add_u32 m0, s48, 20480
    s_nop 0
    buffer_load_dwordx4 v222, s[24:27], s3 offen lds
    s_add_u32 s3, s47, 419840
    s_add_u32 m0, s48, 21504
    s_nop 0
    buffer_load_dwordx4 v222, s[24:27], s3 offen lds
    s_add_u32 s3, s47, 435200
    s_add_u32 m0, s48, 22528
    s_nop 0
    buffer_load_dwordx4 v222, s[24:27], s3 offen lds
    s_add_u32 s3, s47, 445440
    s_add_u32 m0, s48, 23552
    s_nop 0
    buffer_load_dwordx4 v222, s[24:27], s3 offen lds
    s_lshl_b32 s48, s43, 10
    s_add_u32 s3, s47, 20480
    s_add_u32 m0, s48, 16384
    s_nop 0
    buffer_load_dwordx4 v5, s[24:27], s3 offen lds
    s_add_u32 s3, s47, 430080
    s_add_u32 m0, s48, 36864
    s_nop 0
    buffer_load_dwordx4 v5, s[24:27], s3 offen lds
    s_waitcnt vmcnt(10)
    s_barrier
    s_mov_b32 s33, 81920
    s_cmp_eq_u32 s43, 3
    s_cselect_b32 s3, 0, 163840
    buffer_store_dwordx4 v[224:227], v220, s[20:23], 0 offen sc1
    buffer_store_dwordx4 v[224:227], v220, s[20:23], s33 offen sc1
    buffer_store_dwordx4 v[224:227], v220, s[20:23], s3 offen sc1
    buffer_store_dwordx4 v[224:227], v221, s[20:23], 0 offen sc1
    v_mov_b32 v2, 158720
    v_mov_b32 v3, 1
    s_waitcnt vmcnt(0)
    s_mov_b64 exec, 1
    ds_add_u32 v2, v3 offset:28
    ds_add_u32 v2, v3 offset:32
    s_mov_b64 exec, -1
    s_lshl_b32 s47, s43, 2
    s_lshr_b32 s47, 0x6431, s47
    s_and_b32 s47, s47, 7
    s_mul_i32 s47, s47, 51200
    s_lshl_b32 s48, s43, 12
    s_add_u32 s3, s47, 0
    s_add_u32 m0, s48, 40960
    s_nop 0
    buffer_load_dwordx4 v222, s[24:27], s3 offen lds
    s_add_u32 s3, s47, 10240
    s_add_u32 m0, s48, 41984
    s_nop 0
    buffer_load_dwordx4 v222, s[24:27], s3 offen lds
    s_add_u32 s3, s47, 25600
    s_add_u32 m0, s48, 43008
    s_nop 0
    buffer_load_dwordx4 v222, s[24:27], s3 offen lds
    s_add_u32 s3, s47, 35840
    s_add_u32 m0, s48, 44032
    s_nop 0
    buffer_load_dwordx4 v222, s[24:27], s3 offen lds
    s_add_u32 s3, s47, 409600
    s_add_u32 m0, s48, 61440
    s_nop 0
    buffer_load_dwordx4 v222, s[24:27], s3 offen lds
    s_add_u32 s3, s47, 419840
    s_add_u32 m0, s48, 62464
    s_nop 0
    buffer_load_dwordx4 v222, s[24:27], s3 offen lds
    s_add_u32 s3, s47, 435200
    s_add_u32 m0, s48, 63488
    s_nop 0
    buffer_load_dwordx4 v222, s[24:27], s3 offen lds
    s_add_u32 s3, s47, 445440
    s_add_u32 m0, s48, 64512
    s_nop 0
    buffer_load_dwordx4 v222, s[24:27], s3 offen lds
    s_lshl_b32 s48, s43, 10
    s_add_u32 s3, s47, 20480
    s_add_u32 m0, s48, 57344
    s_nop 0
    buffer_load_dwordx4 v5, s[24:27], s3 offen lds
    s_add_u32 s3, s47, 430080
    s_add_u32 m0, s48, 77824
    s_nop 0
    buffer_load_dwordx4 v5, s[24:27], s3 offen lds
    s_branch K_P2_GM
K_NOLT:
    s_waitcnt vmcnt(0)
    s_barrier
    s_mov_b32 s33, 81920
    s_cmp_eq_u32 s43, 3
    s_cselect_b32 s3, 0, 163840
    buffer_store_dwordx4 v[224:227], v220, s[20:23], 0 offen sc1
    buffer_store_dwordx4 v[224:227], v220, s[20:23], s33 offen sc1
    buffer_store_dwordx4 v[224:227], v220, s[20:23], s3 offen sc1
    buffer_store_dwordx4 v[224:227], v221, s[20:23], 0 offen sc1
    v_mov_b32 v2, 158720
    v_mov_b32 v3, 1
    s_waitcnt vmcnt(0)
    s_mov_b64 exec, 1
    ds_add_u32 v2, v3 offset:28
    ds_add_u32 v2, v3 offset:32
    s_mov_b64 exec, -1
    s_branch K_END
K_CONS:
    v_and_b32 v1, 63, v0
    v_and_b32 v8, 15, v1
    v_lshrrev_b32 v9, 4, v1
    v_bfe_u32 v10, v1, 2, 2
    v_and_b32 v11, 3, v1
    s_bfe_u32 s54, s30, 0x10001
    s_and_b32 s55, s30, 1
    v_lshrrev_b32 v2, 1, v8
    v_xor_b32 v2, v2, v9
    v_lshlrev_b32 v2, 4, v2
    v_lshl_add_u32 v2, v8, 7, v2
    s_mul_i32 s3, s54, 12288
    v_add_u32 v39, s3, v2
    v_xor_b32 v40, 64, v39
    v_add_u32 v41, 81920, v39
    v_add_u32 v42, 81920, v40
    v_and_b32 v2, 1, v9
    v_lshl_or_b32 v2, v2, 2, v10
    s_mul_i32 s3, s55, 40
    v_lshl_add_u32 v2, v2, 5, s3
    v_lshl_add_u32 v3, v9, 3, v10
    v_lshlrev_b32 v3, 8, v3
    v_add_u32 v3, 24576, v3
    v_lshl_add_u32 v5, v11, 3, v2
    s_mul_i32 s33, s55, 805306368
    s_sub_u32 s33, 0xf870c020, s33
    v_add_u32 v4, 0, v5
    v_and_b32 v4, 255, v4
    v_add_u32 v43, v4, v3
    v_add_u32 v47, 81920, v43
    v_add_u32 v4, 160, v5
    v_and_b32 v4, 255, v4
    v_add_u32 v44, v4, v3
    v_add_u32 v48, 81920, v44
    v_add_u32 v4, 80, v5
    v_and_b32 v4, 255, v4
    v_add_u32 v45, v4, v3
    v_add_u32 v49, 81920, v45
    v_lshlrev_b32 v4, 3, v11
    v_bfe_u32 v4, s33, v4, 8
    v_add_u32 v4, v4, v2
    v_and_b32 v4, 255, v4
    v_add_u32 v46, v4, v3
    v_add_u32 v50, 81920, v46
    v_and_b32 v1, 63, v0
    v_mov_b32 v7, 0
    s_and_b32 s28, s2, 7
    s_lshr_b32 s29, s2, 3
    s_xor_b32 s30, s30, 4
    s_lshr_b32 s34, s29, 3
    s_lshl_b32 s34, s34, 2
    s_and_b32 s3, s29, 3
    s_add_u32 s34, s34, s3
    s_add_u32 s34, s34, 4
    s_bitcmp1_b32 s29, 2
    s_cselect_b32 s34, -1, s34
    s_cmp_lt_u32 s29, 8
    s_cselect_b32 s34, s29, s34
    s_lshl_b32 s40, s28, 1
    s_cmp_ge_u32 s34, 10
    s_addc_u32 s40, s40, 0
    s_sub_u32 s41, s34, 10
    s_cmp_ge_u32 s34, 10
    s_cselect_b32 s41, s41, s34
    s_mul_i32 s42, s28, 20
    s_add_u32 s42, s42, s34
    s_and_b32 s42, s42, 255
    s_lshl_b32 s42, s42, 9
    s_add_u32 s42, s42, 524288
    v_mov_b32 v3, 158736
    ds_write2_b32 v3, v7, v7 offset0:0 offset1:1
    ds_write2_b32 v3, v7, v7 offset0:2 offset1:3
    ds_write2_b32 v3, v7, v7 offset0:4 offset1:5
    ds_write2_b32 v3, v7, v7 offset0:6 offset1:7
    ds_write2_b32 v3, v7, v7 offset0:8 offset1:9
    ds_write2_b32 v3, v7, v7 offset0:10 offset1:11
    s_lshr_b32 s31, s28, 1
    s_lshl_b32 s31, s31, 5
    s_lshr_b32 s3, s29, 3
    s_mul_i32 s3, s3, 11
    s_add_u32 s31, s31, s3
    s_sub_u32 s31, s31, 11
    s_and_b32 s32, s28, 1
    s_lshl_b32 s32, s32, 3
    s_and_b32 s3, s29, 7
    s_lshl_b32 s3, s3, 2
    s_lshr_b32 s3, 0x64317520, s3
    s_and_b32 s3, s3, 7
    s_add_u32 s32, s32, s3
    s_and_b32 s35, s29, 3
    s_and_b32 s3, s29, 4
    s_lshl_b32 s3, s3, 1
    s_add_u32 s35, s35, s3
    s_and_b32 s3, s28, 1
    s_lshl_b32 s3, s3, 2
    s_add_u32 s35, s35, s3
    s_or_b32 s56, s31, s54
    v_mov_b32 v37, 0xf149f2ca
    v_lshlrev_b32 v2, 2, v9
    v_sub_u32 v2, v8, v2
    s_cmp_eq_u32 s56, 0
    s_cselect_b32 s3, 0xf149f2ca, 0
    v_subrev_u32 v3, 0, v2
    v_and_b32 v4, 0x80000001, v3
    v_cmp_eq_u32 vcc, 0, v4
    s_nop 1
    v_cndmask_b32 v16, v37, 0, vcc
    v_cmp_eq_u32 vcc, 0x80000000, v4
    s_nop 1
    v_cndmask_b32 v12, v37, 0, vcc
    v_add_f32 v20, s3, v12
    v_subrev_u32 v3, 1, v2
    v_and_b32 v4, 0x80000001, v3
    v_cmp_eq_u32 vcc, 0, v4
    s_nop 1
    v_cndmask_b32 v17, v37, 0, vcc
    v_cmp_eq_u32 vcc, 0x80000000, v4
    s_nop 1
    v_cndmask_b32 v13, v37, 0, vcc
    v_add_f32 v21, s3, v13
    v_subrev_u32 v3, 2, v2
    v_and_b32 v4, 0x80000001, v3
    v_cmp_eq_u32 vcc, 0, v4
    s_nop 1
    v_cndmask_b32 v18, v37, 0, vcc
    v_cmp_eq_u32 vcc, 0x80000000, v4
    s_nop 1
    v_cndmask_b32 v14, v37, 0, vcc
    v_add_f32 v22, s3, v14
    v_subrev_u32 v3, 3, v2
    v_and_b32 v4, 0x80000001, v3
    v_cmp_eq_u32 vcc, 0, v4
    s_nop 1
    v_cndmask_b32 v19, v37, 0, vcc
    v_cmp_eq_u32 vcc, 0x80000000, v4
    s_nop 1
    v_cndmask_b32 v15, v37, 0, vcc
    v_add_f32 v23, s3, v15
    v_mov_b32 v3, 0x0c0c0c0c
    v_mov_b32 v4, 0xc0c0100
    v_cmp_eq_u32 vcc, 0, v12
    v_mov_b32 v5, 0x1000c0c
    s_nop 0
    v_cndmask_b32 v3, v3, v4, vcc
    v_cmp_eq_u32 vcc, 0, v13
    s_nop 1
    v_cndmask_b32 v24, v3, v5, vcc
    v_mov_b32 v3, 0x0c0c0c0c
    v_mov_b32 v4, 0xc0c0302
    v_cmp_eq_u32 vcc, 0, v14
    v_mov_b32 v5, 0x3020c0c
    s_nop 0
    v_cndmask_b32 v3, v3, v4, vcc
    v_cmp_eq_u32 vcc, 0, v15
    s_nop 1
    v_cndmask_b32 v25, v3, v5, vcc
    v_mov_b32 v3, 0x0c0c0c0c
    v_mov_b32 v4, 0xc0c0100
    v_cmp_eq_u32 vcc, 0, v16
    v_mov_b32 v5, 0x1000c0c
    s_nop 0
    v_cndmask_b32 v3, v3, v4, vcc
    v_cmp_eq_u32 vcc, 0, v17
    s_nop 1
    v_cndmask_b32 v26, v3, v5, vcc
    v_mov_b32 v3, 0x0c0c0c0c
    v_mov_b32 v4, 0xc0c0302
    v_cmp_eq_u32 vcc, 0, v18
    v_mov_b32 v5, 0x3020c0c
    s_nop 0
    v_cndmask_b32 v3, v3, v4, vcc
    v_cmp_eq_u32 vcc, 0, v19
    s_nop 1
    v_cndmask_b32 v27, v3, v5, vcc
    s_mul_i32 s3, s55, 1664
    s_mul_i32 s33, s54, 768
    s_add_u32 s3, s3, s33
    s_add_u32 s3, s3, 125952
    v_lshl_add_u32 v2, v9, 2, v10
    v_lshl_add_u32 v33, v2, 3, s3
    v_lshl_add_u32 v2, v8, 3, s3
    v_lshlrev_b32 v3, 3, v1
    v_add_u32 v3, 129280, v3
    v_cmp_eq_u32 vcc, 2, v9
    s_mul_i32 s3, s55, 1536
    s_add_u32 s3, s3, 122880
    v_cndmask_b32 v32, v3, v2, vcc
    v_lshl_add_u32 v34, v1, 3, s3
    s_mul_i32 s3, s54, 1536
    s_add_u32 s3, s3, 131328
    s_lshl3_add_u32 s33, s55, s3
    v_lshl_add_u32 v35, v8, 4, s33
    v_lshl_add_u32 v35, v9, 8, v35
    s_mul_i32 s33, s55, 768
    s_add_u32 s3, s3, s33
    v_lshl_add_u32 v36, v1, 4, s3
    v_mov_b32 v38, 158720
    s_waitcnt lgkmcnt(0)
    s_add_u32 s20, s6, 0x100000
    s_addc_u32 s21, s7, 0
    s_mov_b32 s22, 0x280000
    s_mov_b32 s23, 0x20000
    s_lshr_b32 s53, s35, 2
    s_add_u32 s58, s53, s35
    s_lshl_b32 s58, s58, 12
    s_mul_i32 s59, s53, 19456
    s_lshl_b32 s53, s35, 8
    s_add_u32 s59, s59, s53
    s_add_u32 s59, s59, 16384
    s_lshr_b32 s53, s31, 5
    s_add_u32 s53, s53, 1
    s_mul_i32 s22, s53, 655360
    s_mov_b32 s53, s31
    s_mul_i32 s3, s54, 6
    s_add_u32 s53, s53, s3
    s_add_u32 s53, s53, 3
    s_lshl_b32 s3, s55, 9
    s_add_u32 s58, s58, s3
    v_and_b32 v4, 1, v9
    v_lshrrev_b32 v5, 1, v9
    v_add_u32 v3, s53, v4
    v_lshrrev_b32 v2, 2, v3
    v_mul_u32_u24 v2, 76, v2
    v_add_lshl_u32 v2, v2, v3, 10
    v_lshl_add_u32 v2, v8, 4, v2
    v_add_u32 v30, s58, v2
    v_lshl_add_u32 v30, v5, 8, v30
    v_subrev_u32 v3, 2, v3
    v_lshrrev_b32 v2, 2, v3
    v_mul_u32_u24 v2, 76, v2
    v_add_lshl_u32 v2, v2, v3, 10
    v_lshl_add_u32 v2, v8, 4, v2
    v_add_u32 v29, s58, v2
    v_lshl_add_u32 v29, v5, 8, v29
    v_or_b32 v4, s54, v4
    v_cmp_eq_u32 vcc, 0, v4
    v_mov_b32 v5, 0x10000000
    v_subrev_u32 v28, 81920, v30
    v_cndmask_b32 v28, v28, v5, vcc
    s_mul_i32 s3, s55, 3
    s_add_u32 s53, s53, s3
    v_add_u32 v3, s53, v9
    v_lshrrev_b32 v2, 2, v3
    v_mul_u32_u24 v2, 76, v2
    v_add_lshl_u32 v2, v2, v3, 10
    v_lshl_add_u32 v2, v8, 4, v2
    v_add_u32 v31, s59, v2
    v_subrev_u32 v31, 81920, v31
    v_or_b32 v4, s30, v9
    v_cmp_eq_u32 vcc, 0, v4
    s_nop 1
    v_cndmask_b32 v31, v31, v5, vcc
    v_cmp_eq_u32 vcc, 3, v9
    s_nop 1
    v_cndmask_b32 v31, v31, v5, vcc
    s_lshr_b32 s3, s31, 3
    s_mul_i32 s3, s3, 5120
    s_add_u32 s3, s3, 524288
    s_and_b32 s33, s31, 31
    s_cselect_b32 s33, 4, 0
    v_mov_b32 v2, s33
    v_cmp_gt_u32 vcc, 10, v1
    v_lshl_add_u32 v37, v1, 9, s3
    s_mov_b32 s37, 0xfffff
    v_cndmask_b32 v2, 0, v2, vcc
    v_add_u32 v37, v37, v2
    s_lshr_b32 s36, s35, 2
    s_add_u32 s36, s36, s35
    s_lshl_b32 s36, 1, s36
    s_cmp_eq_u32 s30, 0
    s_cselect_b32 s36, s36, 0
    s_mov_b32 s62, 1811939332
    s_cmp_ge_u32 s36, 0x400
    s_cselect_b32 s62, -1, s62
    s_and_b32 s3, s36, 0x3ff
    s_cselect_b32 s63, -1, 2
    s_mov_b32 s58, 0x3fb8aa3b
    s_mov_b32 s59, s58
    s_mov_b32 s60, 0x3e64f92e
    s_mov_b32 s61, s60
    s_cmp_eq_u32 s30, 0
    s_cbranch_scc1 K_CHM0
    s_cmp_eq_u32 s30, 1
    s_cbranch_scc1 K_CHM1
    s_cmp_eq_u32 s30, 2
    s_cbranch_scc1 K_CHM2
    s_branch K_CHM3
K_WRET_M:
    s_setprio 2
    s_barrier
K_L0:
    ds_read_b64_tr_b16 v[196:197], v47 offset:0
    ds_read_b64_tr_b16 v[198:199], v47 offset:1024
    ds_read_b128 v[148:151], v41 offset:0
    ds_read_b64_tr_b16 v[200:201], v48 offset:0
    ds_read_b64_tr_b16 v[202:203], v48 offset:1024
    ds_read_b128 v[152:155], v41 offset:2048
    ds_read_b64_tr_b16 v[204:205], v49 offset:0
    ds_read_b64_tr_b16 v[206:207], v49 offset:1024
    ds_read_b128 v[156:159], v41 offset:4096
    ds_read_b64_tr_b16 v[208:209], v50 offset:0
    ds_read_b64_tr_b16 v[210:211], v50 offset:1024
    ds_read_b128 v[160:163], v41 offset:6144
    ds_read_b128 v[164:167], v41 offset:8192
    ds_read_b128 v[168:171], v41 offset:10240
    s_waitcnt lgkmcnt(0)
    v_mfma_f32_16x16x32_bf16 v[52:55], v[196:199], v[148:151], 0
    ds_read_b64_tr_b16 v[212:213], v47 offset:8192
    v_mfma_f32_16x16x32_bf16 v[56:59], v[200:203], v[148:151], 0
    ds_read_b64_tr_b16 v[214:215], v47 offset:9216
    v_mfma_f32_16x16x32_bf16 v[60:63], v[148:151], v[204:207], 0
    ds_read_b128 v[172:175], v42 offset:0
    v_mfma_f32_16x16x32_bf16 v[64:67], v[208:211], v[148:151], 0
    ds_read_b64_tr_b16 v[216:217], v48 offset:8192
    v_mfma_f32_16x16x32_bf16 v[80:83], v[208:211], v[152:155], 0
    ds_read_b64_tr_b16 v[218:219], v48 offset:9216
    v_mfma_f32_16x16x32_bf16 v[76:79], v[152:155], v[204:207], 0
    ds_read_b128 v[176:179], v42 offset:2048
    v_mfma_f32_16x16x32_bf16 v[72:75], v[200:203], v[152:155], 0
    ds_read_b64_tr_b16 v[220:221], v49 offset:8192
    v_mfma_f32_16x16x32_bf16 v[68:71], v[196:199], v[152:155], 0
    ds_read_b64_tr_b16 v[222:223], v49 offset:9216
    v_mfma_f32_16x16x32_bf16 v[84:87], v[196:199], v[156:159], 0
    ds_read_b128 v[180:183], v42 offset:4096
    v_mfma_f32_16x16x32_bf16 v[88:91], v[200:203], v[156:159], 0
    ds_read_b64_tr_b16 v[224:225], v50 offset:8192
    v_mfma_f32_16x16x32_bf16 v[92:95], v[156:159], v[204:207], 0
    ds_read_b64_tr_b16 v[226:227], v50 offset:9216
    v_mfma_f32_16x16x32_bf16 v[96:99], v[208:211], v[156:159], 0
    ds_read_b128 v[184:187], v42 offset:6144
    v_mfma_f32_16x16x32_bf16 v[112:115], v[208:211], v[160:163], 0
    ds_read_b128 v[188:191], v42 offset:8192
    v_mfma_f32_16x16x32_bf16 v[108:111], v[160:163], v[204:207], 0
    ds_read_b128 v[192:195], v42 offset:10240
    v_mfma_f32_16x16x32_bf16 v[104:107], v[200:203], v[160:163], 0
    v_mfma_f32_16x16x32_bf16 v[100:103], v[196:199], v[160:163], 0
    v_mfma_f32_16x16x32_bf16 v[116:119], v[196:199], v[164:167], 0
    v_mfma_f32_16x16x32_bf16 v[120:123], v[200:203], v[164:167], 0
    v_mfma_f32_16x16x32_bf16 v[124:127], v[164:167], v[204:207], 0
    v_mfma_f32_16x16x32_bf16 v[128:131], v[208:211], v[164:167], 0
    v_mfma_f32_16x16x32_bf16 v[144:147], v[208:211], v[168:171], 0
    v_mfma_f32_16x16x32_bf16 v[140:143], v[168:171], v[204:207], 0
    v_mfma_f32_16x16x32_bf16 v[136:139], v[200:203], v[168:171], 0
    v_mfma_f32_16x16x32_bf16 v[132:135], v[196:199], v[168:171], 0
    s_waitcnt lgkmcnt(0)
    s_barrier
    v_mfma_f32_16x16x32_bf16 v[52:55], v[212:215], v[172:175], v[52:55]
    ds_read_b64_tr_b16 v[196:197], v43 offset:0
    v_mfma_f32_16x16x32_bf16 v[56:59], v[216:219], v[172:175], v[56:59]
    ds_read_b64_tr_b16 v[198:199], v43 offset:1024
    v_mfma_f32_16x16x32_bf16 v[60:63], v[172:175], v[220:223], v[60:63]
    ds_read_b128 v[148:151], v39 offset:0
    v_mfma_f32_16x16x32_bf16 v[64:67], v[224:227], v[172:175], v[64:67]
    ds_read_b64_tr_b16 v[200:201], v44 offset:0
    v_mfma_f32_16x16x32_bf16 v[80:83], v[224:227], v[176:179], v[80:83]
    ds_read_b64_tr_b16 v[202:203], v44 offset:1024
    v_mfma_f32_16x16x32_bf16 v[76:79], v[176:179], v[220:223], v[76:79]
    ds_read_b128 v[152:155], v39 offset:2048
    v_mfma_f32_16x16x32_bf16 v[72:75], v[216:219], v[176:179], v[72:75]
    ds_read_b64_tr_b16 v[204:205], v45 offset:0
    v_mfma_f32_16x16x32_bf16 v[68:71], v[212:215], v[176:179], v[68:71]
    ds_read_b64_tr_b16 v[206:207], v45 offset:1024
    v_mfma_f32_16x16x32_bf16 v[84:87], v[212:215], v[180:183], v[84:87]
    ds_read_b128 v[156:159], v39 offset:4096
    v_mfma_f32_16x16x32_bf16 v[88:91], v[216:219], v[180:183], v[88:91]
    ds_read_b64_tr_b16 v[208:209], v46 offset:0
    v_mfma_f32_16x16x32_bf16 v[92:95], v[180:183], v[220:223], v[92:95]
    ds_read_b64_tr_b16 v[210:211], v46 offset:1024
    v_mfma_f32_16x16x32_bf16 v[96:99], v[224:227], v[180:183], v[96:99]
    ds_read_b128 v[160:163], v39 offset:6144
    v_mfma_f32_16x16x32_bf16 v[112:115], v[224:227], v[184:187], v[112:115]
    ds_read_b128 v[164:167], v39 offset:8192
    v_mfma_f32_16x16x32_bf16 v[108:111], v[184:187], v[220:223], v[108:111]
    ds_read_b128 v[168:171], v39 offset:10240
    v_mfma_f32_16x16x32_bf16 v[104:107], v[216:219], v[184:187], v[104:107]
    v_mfma_f32_16x16x32_bf16 v[100:103], v[212:215], v[184:187], v[100:103]
    v_mfma_f32_16x16x32_bf16 v[116:119], v[212:215], v[188:191], v[116:119]
    v_mfma_f32_16x16x32_bf16 v[120:123], v[216:219], v[188:191], v[120:123]
    v_mfma_f32_16x16x32_bf16 v[124:127], v[188:191], v[220:223], v[124:127]
    v_mfma_f32_16x16x32_bf16 v[128:131], v[224:227], v[188:191], v[128:131]
    v_mfma_f32_16x16x32_bf16 v[144:147], v[224:227], v[192:195], v[144:147]
    v_mfma_f32_16x16x32_bf16 v[140:143], v[192:195], v[220:223], v[140:143]
    v_mfma_f32_16x16x32_bf16 v[136:139], v[216:219], v[192:195], v[136:139]
    v_mfma_f32_16x16x32_bf16 v[132:135], v[212:215], v[192:195], v[132:135]
    s_waitcnt lgkmcnt(0)
    v_mfma_f32_16x16x32_bf16 v[52:55], v[196:199], v[148:151], v[52:55]
    ds_read_b64_tr_b16 v[212:213], v43 offset:8192
    v_mfma_f32_16x16x32_bf16 v[56:59], v[200:203], v[148:151], v[56:59]
    ds_read_b64_tr_b16 v[214:215], v43 offset:9216
    v_mfma_f32_16x16x32_bf16 v[60:63], v[148:151], v[204:207], v[60:63]
    ds_read_b128 v[172:175], v40 offset:0
    v_mfma_f32_16x16x32_bf16 v[64:67], v[208:211], v[148:151], v[64:67]
    ds_read_b64_tr_b16 v[216:217], v44 offset:8192
    v_mfma_f32_16x16x32_bf16 v[80:83], v[208:211], v[152:155], v[80:83]
    ds_read_b64_tr_b16 v[218:219], v44 offset:9216
    v_mfma_f32_16x16x32_bf16 v[76:79], v[152:155], v[204:207], v[76:79]
    ds_read_b128 v[176:179], v40 offset:2048
    v_mfma_f32_16x16x32_bf16 v[72:75], v[200:203], v[152:155], v[72:75]
    ds_read_b64_tr_b16 v[220:221], v45 offset:8192
    v_mfma_f32_16x16x32_bf16 v[68:71], v[196:199], v[152:155], v[68:71]
    ds_read_b64_tr_b16 v[222:223], v45 offset:9216
    v_mfma_f32_16x16x32_bf16 v[84:87], v[196:199], v[156:159], v[84:87]
    ds_read_b128 v[180:183], v40 offset:4096
    v_mfma_f32_16x16x32_bf16 v[88:91], v[200:203], v[156:159], v[88:91]
    ds_read_b64_tr_b16 v[224:225], v46 offset:8192
    v_mfma_f32_16x16x32_bf16 v[92:95], v[156:159], v[204:207], v[92:95]
    ds_read_b64_tr_b16 v[226:227], v46 offset:9216
    v_mfma_f32_16x16x32_bf16 v[96:99], v[208:211], v[156:159], v[96:99]
    ds_read_b128 v[184:187], v40 offset:6144
    s_branch K_PG1
.p2align 12
K_CHM1:
K_STM1:
    s_branch K_WRET_M
    s_nop 0
K_PG1:
    v_mfma_f32_16x16x32_bf16 v[112:115], v[208:211], v[160:163], v[112:115]
    ds_read_b128 v[188:191], v40 offset:8192
    v_mfma_f32_16x16x32_bf16 v[108:111], v[160:163], v[204:207], v[108:111]
    ds_read_b128 v[192:195], v40 offset:10240
    v_mfma_f32_16x16x32_bf16 v[104:107], v[200:203], v[160:163], v[104:107]
    v_mfma_f32_16x16x32_bf16 v[100:103], v[196:199], v[160:163], v[100:103]
    v_mfma_f32_16x16x32_bf16 v[116:119], v[196:199], v[164:167], v[116:119]
    v_mfma_f32_16x16x32_bf16 v[120:123], v[200:203], v[164:167], v[120:123]
    v_mfma_f32_16x16x32_bf16 v[124:127], v[164:167], v[204:207], v[124:127]
    v_mfma_f32_16x16x32_bf16 v[128:131], v[208:211], v[164:167], v[128:131]
    v_mfma_f32_16x16x32_bf16 v[144:147], v[208:211], v[168:171], v[144:147]
    v_mfma_f32_16x16x32_bf16 v[140:143], v[168:171], v[204:207], v[140:143]
    v_mfma_f32_16x16x32_bf16 v[136:139], v[200:203], v[168:171], v[136:139]
    v_mfma_f32_16x16x32_bf16 v[132:135], v[196:199], v[168:171], v[132:135]
    s_waitcnt lgkmcnt(0)
    s_barrier
    v_mfma_f32_16x16x32_bf16 v[52:55], v[212:215], v[172:175], v[52:55]
    ds_read_b64_tr_b16 v[196:197], v43 offset:40960
    v_mfma_f32_16x16x32_bf16 v[56:59], v[216:219], v[172:175], v[56:59]
    ds_read_b64_tr_b16 v[198:199], v43 offset:41984
    v_mfma_f32_16x16x32_bf16 v[60:63], v[172:175], v[220:223], v[60:63]
    ds_read_b128 v[148:151], v39 offset:40960
    v_mfma_f32_16x16x32_bf16 v[64:67], v[224:227], v[172:175], v[64:67]
    ds_read_b64_tr_b16 v[200:201], v44 offset:40960
    v_mfma_f32_16x16x32_bf16 v[80:83], v[224:227], v[176:179], v[80:83]
    ds_read_b64_tr_b16 v[202:203], v44 offset:41984
    v_mfma_f32_16x16x32_bf16 v[76:79], v[176:179], v[220:223], v[76:79]
    ds_read_b128 v[152:155], v39 offset:43008
    v_mfma_f32_16x16x32_bf16 v[72:75], v[216:219], v[176:179], v[72:75]
    ds_read_b64_tr_b16 v[204:205], v45 offset:40960
    v_mfma_f32_16x16x32_bf16 v[68:71], v[212:215], v[176:179], v[68:71]
    ds_read_b64_tr_b16 v[206:207], v45 offset:41984
    v_mfma_f32_16x16x32_bf16 v[84:87], v[212:215], v[180:183], v[84:87]
    ds_read_b128 v[156:159], v39 offset:45056
    v_mfma_f32_16x16x32_bf16 v[88:91], v[216:219], v[180:183], v[88:91]
    ds_read_b64_tr_b16 v[208:209], v46 offset:40960
    v_mfma_f32_16x16x32_bf16 v[92:95], v[180:183], v[220:223], v[92:95]
    ds_read_b64_tr_b16 v[210:211], v46 offset:41984
    v_mfma_f32_16x16x32_bf16 v[96:99], v[224:227], v[180:183], v[96:99]
    ds_read_b128 v[160:163], v39 offset:47104
    v_mfma_f32_16x16x32_bf16 v[112:115], v[224:227], v[184:187], v[112:115]
    ds_read_b128 v[164:167], v39 offset:49152
    v_mfma_f32_16x16x32_bf16 v[108:111], v[184:187], v[220:223], v[108:111]
    ds_read_b128 v[168:171], v39 offset:51200
    v_mfma_f32_16x16x32_bf16 v[104:107], v[216:219], v[184:187], v[104:107]
    v_mfma_f32_16x16x32_bf16 v[100:103], v[212:215], v[184:187], v[100:103]
    v_mfma_f32_16x16x32_bf16 v[116:119], v[212:215], v[188:191], v[116:119]
    v_mfma_f32_16x16x32_bf16 v[120:123], v[216:219], v[188:191], v[120:123]
    v_mfma_f32_16x16x32_bf16 v[124:127], v[188:191], v[220:223], v[124:127]
    v_mfma_f32_16x16x32_bf16 v[128:131], v[224:227], v[188:191], v[128:131]
    v_mfma_f32_16x16x32_bf16 v[144:147], v[224:227], v[192:195], v[144:147]
    v_mfma_f32_16x16x32_bf16 v[140:143], v[192:195], v[220:223], v[140:143]
    v_mfma_f32_16x16x32_bf16 v[136:139], v[216:219], v[192:195], v[136:139]
    v_mfma_f32_16x16x32_bf16 v[132:135], v[212:215], v[192:195], v[132:135]
    s_waitcnt lgkmcnt(0)
    v_mfma_f32_16x16x32_bf16 v[52:55], v[196:199], v[148:151], v[52:55]
    ds_read_b64_tr_b16 v[212:213], v43 offset:49152
    v_mfma_f32_16x16x32_bf16 v[56:59], v[200:203], v[148:151], v[56:59]
    ds_read_b64_tr_b16 v[214:215], v43 offset:50176
    v_mfma_f32_16x16x32_bf16 v[60:63], v[148:151], v[204:207], v[60:63]
    ds_read_b128 v[172:175], v40 offset:40960
    v_mfma_f32_16x16x32_bf16 v[64:67], v[208:211], v[148:151], v[64:67]
    ds_read_b64_tr_b16 v[216:217], v44 offset:49152
    v_mfma_f32_16x16x32_bf16 v[80:83], v[208:211], v[152:155], v[80:83]
    ds_read_b64_tr_b16 v[218:219], v44 offset:50176
    v_mfma_f32_16x16x32_bf16 v[76:79], v[152:155], v[204:207], v[76:79]
    ds_read_b128 v[176:179], v40 offset:43008
    v_mfma_f32_16x16x32_bf16 v[72:75], v[200:203], v[152:155], v[72:75]
    ds_read_b64_tr_b16 v[220:221], v45 offset:49152
    v_mfma_f32_16x16x32_bf16 v[68:71], v[196:199], v[152:155], v[68:71]
    ds_read_b64_tr_b16 v[222:223], v45 offset:50176
    v_mfma_f32_16x16x32_bf16 v[84:87], v[196:199], v[156:159], v[84:87]
    ds_read_b128 v[180:183], v40 offset:45056
    v_mfma_f32_16x16x32_bf16 v[88:91], v[200:203], v[156:159], v[88:91]
    ds_read_b64_tr_b16 v[224:225], v46 offset:49152
    v_mfma_f32_16x16x32_bf16 v[92:95], v[156:159], v[204:207], v[92:95]
    ds_read_b64_tr_b16 v[226:227], v46 offset:50176
    v_mfma_f32_16x16x32_bf16 v[96:99], v[208:211], v[156:159], v[96:99]
    ds_read_b128 v[184:187], v40 offset:47104
    v_mfma_f32_16x16x32_bf16 v[112:115], v[208:211], v[160:163], v[112:115]
    ds_read_b128 v[188:191], v40 offset:49152
    v_mfma_f32_16x16x32_bf16 v[108:111], v[160:163], v[204:207], v[108:111]
    ds_read_b128 v[192:195], v40 offset:51200
    v_mfma_f32_16x16x32_bf16 v[104:107], v[200:203], v[160:163], v[104:107]
    v_mfma_f32_16x16x32_bf16 v[100:103], v[196:199], v[160:163], v[100:103]
    v_mfma_f32_16x16x32_bf16 v[116:119], v[196:199], v[164:167], v[116:119]
    v_mfma_f32_16x16x32_bf16 v[120:123], v[200:203], v[164:167], v[120:123]
    v_mfma_f32_16x16x32_bf16 v[124:127], v[164:167], v[204:207], v[124:127]
    v_mfma_f32_16x16x32_bf16 v[128:131], v[208:211], v[164:167], v[128:131]
    v_mfma_f32_16x16x32_bf16 v[144:147], v[208:211], v[168:171], v[144:147]
    v_mfma_f32_16x16x32_bf16 v[140:143], v[168:171], v[204:207], v[140:143]
    v_mfma_f32_16x16x32_bf16 v[136:139], v[200:203], v[168:171], v[136:139]
    v_mfma_f32_16x16x32_bf16 v[132:135], v[196:199], v[168:171], v[132:135]
    s_waitcnt lgkmcnt(0)
    s_barrier
    v_mfma_f32_16x16x32_bf16 v[52:55], v[212:215], v[172:175], v[52:55]
    ds_read_b64_tr_b16 v[196:197], v47 offset:0
    v_mfma_f32_16x16x32_bf16 v[56:59], v[216:219], v[172:175], v[56:59]
    ds_read_b64_tr_b16 v[198:199], v47 offset:1024
    v_mfma_f32_16x16x32_bf16 v[60:63], v[172:175], v[220:223], v[60:63]
    ds_read_b128 v[148:151], v41 offset:0
    v_mfma_f32_16x16x32_bf16 v[64:67], v[224:227], v[172:175], v[64:67]
    ds_read_b64_tr_b16 v[200:201], v48 offset:0
    v_mfma_f32_16x16x32_bf16 v[80:83], v[224:227], v[176:179], v[80:83]
    ds_read_b64_tr_b16 v[202:203], v48 offset:1024
    v_mfma_f32_16x16x32_bf16 v[76:79], v[176:179], v[220:223], v[76:79]
    ds_read_b128 v[152:155], v41 offset:2048
    v_mfma_f32_16x16x32_bf16 v[72:75], v[216:219], v[176:179], v[72:75]
    ds_read_b64_tr_b16 v[204:205], v49 offset:0
    v_mfma_f32_16x16x32_bf16 v[68:71], v[212:215], v[176:179], v[68:71]
    ds_read_b64_tr_b16 v[206:207], v49 offset:1024
    v_mfma_f32_16x16x32_bf16 v[84:87], v[212:215], v[180:183], v[84:87]
    ds_read_b128 v[156:159], v41 offset:4096
    v_mfma_f32_16x16x32_bf16 v[88:91], v[216:219], v[180:183], v[88:91]
    ds_read_b64_tr_b16 v[208:209], v50 offset:0
    v_mfma_f32_16x16x32_bf16 v[92:95], v[180:183], v[220:223], v[92:95]
    ds_read_b64_tr_b16 v[210:211], v50 offset:1024
    v_mfma_f32_16x16x32_bf16 v[96:99], v[224:227], v[180:183], v[96:99]
    ds_read_b128 v[160:163], v41 offset:6144
    v_mfma_f32_16x16x32_bf16 v[112:115], v[224:227], v[184:187], v[112:115]
    ds_read_b128 v[164:167], v41 offset:8192
    v_mfma_f32_16x16x32_bf16 v[108:111], v[184:187], v[220:223], v[108:111]
    ds_read_b128 v[168:171], v41 offset:10240
    v_mfma_f32_16x16x32_bf16 v[104:107], v[216:219], v[184:187], v[104:107]
    v_mfma_f32_16x16x32_bf16 v[100:103], v[212:215], v[184:187], v[100:103]
    v_mfma_f32_16x16x32_bf16 v[116:119], v[212:215], v[188:191], v[116:119]
    v_mfma_f32_16x16x32_bf16 v[120:123], v[216:219], v[188:191], v[120:123]
    v_mfma_f32_16x16x32_bf16 v[124:127], v[188:191], v[220:223], v[124:127]
    v_mfma_f32_16x16x32_bf16 v[128:131], v[224:227], v[188:191], v[128:131]
    v_mfma_f32_16x16x32_bf16 v[144:147], v[224:227], v[192:195], v[144:147]
    v_mfma_f32_16x16x32_bf16 v[140:143], v[192:195], v[220:223], v[140:143]
    v_mfma_f32_16x16x32_bf16 v[136:139], v[216:219], v[192:195], v[136:139]
    v_mfma_f32_16x16x32_bf16 v[132:135], v[212:215], v[192:195], v[132:135]
    s_waitcnt lgkmcnt(0)
    v_mfma_f32_16x16x32_bf16 v[52:55], v[196:199], v[148:151], v[52:55]
    ds_read_b64_tr_b16 v[212:213], v47 offset:8192
    v_mfma_f32_16x16x32_bf16 v[56:59], v[200:203], v[148:151], v[56:59]
    ds_read_b64_tr_b16 v[214:215], v47 offset:9216
    v_mfma_f32_16x16x32_bf16 v[60:63], v[148:151], v[204:207], v[60:63]
    ds_read_b128 v[172:175], v42 offset:0
    v_mfma_f32_16x16x32_bf16 v[64:67], v[208:211], v[148:151], v[64:67]
    ds_read_b64_tr_b16 v[216:217], v48 offset:8192
    v_mfma_f32_16x16x32_bf16 v[80:83], v[208:211], v[152:155], v[80:83]
    ds_read_b64_tr_b16 v[218:219], v48 offset:9216
    v_mfma_f32_16x16x32_bf16 v[76:79], v[152:155], v[204:207], v[76:79]
    ds_read_b128 v[176:179], v42 offset:2048
    v_mfma_f32_16x16x32_bf16 v[72:75], v[200:203], v[152:155], v[72:75]
    ds_read_b64_tr_b16 v[220:221], v49 offset:8192
    v_mfma_f32_16x16x32_bf16 v[68:71], v[196:199], v[152:155], v[68:71]
    ds_read_b64_tr_b16 v[222:223], v49 offset:9216
    v_mfma_f32_16x16x32_bf16 v[84:87], v[196:199], v[156:159], v[84:87]
    ds_read_b128 v[180:183], v42 offset:4096
    v_mfma_f32_16x16x32_bf16 v[88:91], v[200:203], v[156:159], v[88:91]
    ds_read_b64_tr_b16 v[224:225], v50 offset:8192
    v_mfma_f32_16x16x32_bf16 v[92:95], v[156:159], v[204:207], v[92:95]
    ds_read_b64_tr_b16 v[226:227], v50 offset:9216
    v_mfma_f32_16x16x32_bf16 v[96:99], v[208:211], v[156:159], v[96:99]
    ds_read_b128 v[184:187], v42 offset:6144
    v_mfma_f32_16x16x32_bf16 v[112:115], v[208:211], v[160:163], v[112:115]
    ds_read_b128 v[188:191], v42 offset:8192
    v_mfma_f32_16x16x32_bf16 v[108:111], v[160:163], v[204:207], v[108:111]
    ds_read_b128 v[192:195], v42 offset:10240
    v_mfma_f32_16x16x32_bf16 v[104:107], v[200:203], v[160:163], v[104:107]
    v_mfma_f32_16x16x32_bf16 v[100:103], v[196:199], v[160:163], v[100:103]
    v_mfma_f32_16x16x32_bf16 v[116:119], v[196:199], v[164:167], v[116:119]
    v_mfma_f32_16x16x32_bf16 v[120:123], v[200:203], v[164:167], v[120:123]
    v_mfma_f32_16x16x32_bf16 v[124:127], v[164:167], v[204:207], v[124:127]
    v_mfma_f32_16x16x32_bf16 v[128:131], v[208:211], v[164:167], v[128:131]
    v_mfma_f32_16x16x32_bf16 v[144:147], v[208:211], v[168:171], v[144:147]
    v_mfma_f32_16x16x32_bf16 v[140:143], v[168:171], v[204:207], v[140:143]
    v_mfma_f32_16x16x32_bf16 v[136:139], v[200:203], v[168:171], v[136:139]
    v_mfma_f32_16x16x32_bf16 v[132:135], v[196:199], v[168:171], v[132:135]
    s_waitcnt lgkmcnt(0)
    s_barrier
    v_mfma_f32_16x16x32_bf16 v[52:55], v[212:215], v[172:175], v[52:55]
    ds_read_b64_tr_b16 v[196:197], v43 offset:0
    v_mfma_f32_16x16x32_bf16 v[56:59], v[216:219], v[172:175], v[56:59]
    ds_read_b64_tr_b16 v[198:199], v43 offset:1024
    v_mfma_f32_16x16x32_bf16 v[60:63], v[172:175], v[220:223], v[60:63]
    ds_read_b128 v[148:151], v39 offset:0
    v_mfma_f32_16x16x32_bf16 v[64:67], v[224:227], v[172:175], v[64:67]
    ds_read_b64_tr_b16 v[200:201], v44 offset:0
    v_mfma_f32_16x16x32_bf16 v[80:83], v[224:227], v[176:179], v[80:83]
    ds_read_b64_tr_b16 v[202:203], v44 offset:1024
    v_mfma_f32_16x16x32_bf16 v[76:79], v[176:179], v[220:223], v[76:79]
    ds_read_b128 v[152:155], v39 offset:2048
    v_mfma_f32_16x16x32_bf16 v[72:75], v[216:219], v[176:179], v[72:75]
    ds_read_b64_tr_b16 v[204:205], v45 offset:0
    v_mfma_f32_16x16x32_bf16 v[68:71], v[212:215], v[176:179], v[68:71]
    ds_read_b64_tr_b16 v[206:207], v45 offset:1024
    v_mfma_f32_16x16x32_bf16 v[84:87], v[212:215], v[180:183], v[84:87]
    ds_read_b128 v[156:159], v39 offset:4096
    v_mfma_f32_16x16x32_bf16 v[88:91], v[216:219], v[180:183], v[88:91]
    ds_read_b64_tr_b16 v[208:209], v46 offset:0
    v_mfma_f32_16x16x32_bf16 v[92:95], v[180:183], v[220:223], v[92:95]
    ds_read_b64_tr_b16 v[210:211], v46 offset:1024
    v_mfma_f32_16x16x32_bf16 v[96:99], v[224:227], v[180:183], v[96:99]
    ds_read_b128 v[160:163], v39 offset:6144
    v_mfma_f32_16x16x32_bf16 v[112:115], v[224:227], v[184:187], v[112:115]
    ds_read_b128 v[164:167], v39 offset:8192
    v_mfma_f32_16x16x32_bf16 v[108:111], v[184:187], v[220:223], v[108:111]
    ds_read_b128 v[168:171], v39 offset:10240
    v_mfma_f32_16x16x32_bf16 v[104:107], v[216:219], v[184:187], v[104:107]
    v_mfma_f32_16x16x32_bf16 v[100:103], v[212:215], v[184:187], v[100:103]
    v_mfma_f32_16x16x32_bf16 v[116:119], v[212:215], v[188:191], v[116:119]
    v_mfma_f32_16x16x32_bf16 v[120:123], v[216:219], v[188:191], v[120:123]
    v_mfma_f32_16x16x32_bf16 v[124:127], v[188:191], v[220:223], v[124:127]
    v_mfma_f32_16x16x32_bf16 v[128:131], v[224:227], v[188:191], v[128:131]
    v_mfma_f32_16x16x32_bf16 v[144:147], v[224:227], v[192:195], v[144:147]
    v_mfma_f32_16x16x32_bf16 v[140:143], v[192:195], v[220:223], v[140:143]
    v_mfma_f32_16x16x32_bf16 v[136:139], v[216:219], v[192:195], v[136:139]
    v_mfma_f32_16x16x32_bf16 v[132:135], v[212:215], v[192:195], v[132:135]
    s_waitcnt lgkmcnt(0)
    v_mfma_f32_16x16x32_bf16 v[52:55], v[196:199], v[148:151], v[52:55]
    ds_read_b64_tr_b16 v[212:213], v43 offset:8192
    v_mfma_f32_16x16x32_bf16 v[56:59], v[200:203], v[148:151], v[56:59]
    ds_read_b64_tr_b16 v[214:215], v43 offset:9216
    v_mfma_f32_16x16x32_bf16 v[60:63], v[148:151], v[204:207], v[60:63]
    ds_read_b128 v[172:175], v40 offset:0
    v_mfma_f32_16x16x32_bf16 v[64:67], v[208:211], v[148:151], v[64:67]
    ds_read_b64_tr_b16 v[216:217], v44 offset:8192
    v_mfma_f32_16x16x32_bf16 v[80:83], v[208:211], v[152:155], v[80:83]
    ds_read_b64_tr_b16 v[218:219], v44 offset:9216
    v_mfma_f32_16x16x32_bf16 v[76:79], v[152:155], v[204:207], v[76:79]
    ds_read_b128 v[176:179], v40 offset:2048
    v_mfma_f32_16x16x32_bf16 v[72:75], v[200:203], v[152:155], v[72:75]
    ds_read_b64_tr_b16 v[220:221], v45 offset:8192
    v_mfma_f32_16x16x32_bf16 v[68:71], v[196:199], v[152:155], v[68:71]
    ds_read_b64_tr_b16 v[222:223], v45 offset:9216
    v_mfma_f32_16x16x32_bf16 v[84:87], v[196:199], v[156:159], v[84:87]
    ds_read_b128 v[180:183], v40 offset:4096
    v_mfma_f32_16x16x32_bf16 v[88:91], v[200:203], v[156:159], v[88:91]
    ds_read_b64_tr_b16 v[224:225], v46 offset:8192
    v_mfma_f32_16x16x32_bf16 v[92:95], v[156:159], v[204:207], v[92:95]
    ds_read_b64_tr_b16 v[226:227], v46 offset:9216
    v_mfma_f32_16x16x32_bf16 v[96:99], v[208:211], v[156:159], v[96:99]
    ds_read_b128 v[184:187], v40 offset:6144
    v_mfma_f32_16x16x32_bf16 v[112:115], v[208:211], v[160:163], v[112:115]
    ds_read_b128 v[188:191], v40 offset:8192
    v_mfma_f32_16x16x32_bf16 v[108:111], v[160:163], v[204:207], v[108:111]
    ds_read_b128 v[192:195], v40 offset:10240
    v_mfma_f32_16x16x32_bf16 v[104:107], v[200:203], v[160:163], v[104:107]
    v_mfma_f32_16x16x32_bf16 v[100:103], v[196:199], v[160:163], v[100:103]
    v_mfma_f32_16x16x32_bf16 v[116:119], v[196:199], v[164:167], v[116:119]
    v_mfma_f32_16x16x32_bf16 v[120:123], v[200:203], v[164:167], v[120:123]
    v_mfma_f32_16x16x32_bf16 v[124:127], v[164:167], v[204:207], v[124:127]
    v_mfma_f32_16x16x32_bf16 v[128:131], v[208:211], v[164:167], v[128:131]
    v_mfma_f32_16x16x32_bf16 v[144:147], v[208:211], v[168:171], v[144:147]
    v_mfma_f32_16x16x32_bf16 v[140:143], v[168:171], v[204:207], v[140:143]
    v_mfma_f32_16x16x32_bf16 v[136:139], v[200:203], v[168:171], v[136:139]
    v_mfma_f32_16x16x32_bf16 v[132:135], v[196:199], v[168:171], v[132:135]
    s_waitcnt lgkmcnt(0)
    s_barrier
    v_mfma_f32_16x16x32_bf16 v[52:55], v[212:215], v[172:175], v[52:55]
    ds_read_b64_tr_b16 v[196:197], v43 offset:40960
    v_mfma_f32_16x16x32_bf16 v[56:59], v[216:219], v[172:175], v[56:59]
    ds_read_b64_tr_b16 v[198:199], v43 offset:41984
    v_mfma_f32_16x16x32_bf16 v[60:63], v[172:175], v[220:223], v[60:63]
    ds_read_b128 v[148:151], v39 offset:40960
    v_mfma_f32_16x16x32_bf16 v[64:67], v[224:227], v[172:175], v[64:67]
    ds_read_b64_tr_b16 v[200:201], v44 offset:40960
    v_mfma_f32_16x16x32_bf16 v[80:83], v[224:227], v[176:179], v[80:83]
    ds_read_b64_tr_b16 v[202:203], v44 offset:41984
    v_mfma_f32_16x16x32_bf16 v[76:79], v[176:179], v[220:223], v[76:79]
    ds_read_b128 v[152:155], v39 offset:43008
    v_mfma_f32_16x16x32_bf16 v[72:75], v[216:219], v[176:179], v[72:75]
    ds_read_b64_tr_b16 v[204:205], v45 offset:40960
    v_mfma_f32_16x16x32_bf16 v[68:71], v[212:215], v[176:179], v[68:71]
    ds_read_b64_tr_b16 v[206:207], v45 offset:41984
    v_mfma_f32_16x16x32_bf16 v[84:87], v[212:215], v[180:183], v[84:87]
    ds_read_b128 v[156:159], v39 offset:45056
    v_mfma_f32_16x16x32_bf16 v[88:91], v[216:219], v[180:183], v[88:91]
    ds_read_b64_tr_b16 v[208:209], v46 offset:40960
    v_mfma_f32_16x16x32_bf16 v[92:95], v[180:183], v[220:223], v[92:95]
    ds_read_b64_tr_b16 v[210:211], v46 offset:41984
    v_mfma_f32_16x16x32_bf16 v[96:99], v[224:227], v[180:183], v[96:99]
    ds_read_b128 v[160:163], v39 offset:47104
    v_mfma_f32_16x16x32_bf16 v[112:115], v[224:227], v[184:187], v[112:115]
    ds_read_b128 v[164:167], v39 offset:49152
    v_mfma_f32_16x16x32_bf16 v[108:111], v[184:187], v[220:223], v[108:111]
    ds_read_b128 v[168:171], v39 offset:51200
    v_mfma_f32_16x16x32_bf16 v[104:107], v[216:219], v[184:187], v[104:107]
    v_mfma_f32_16x16x32_bf16 v[100:103], v[212:215], v[184:187], v[100:103]
    v_mfma_f32_16x16x32_bf16 v[116:119], v[212:215], v[188:191], v[116:119]
    v_mfma_f32_16x16x32_bf16 v[120:123], v[216:219], v[188:191], v[120:123]
    v_mfma_f32_16x16x32_bf16 v[124:127], v[188:191], v[220:223], v[124:127]
    v_mfma_f32_16x16x32_bf16 v[128:131], v[224:227], v[188:191], v[128:131]
    v_mfma_f32_16x16x32_bf16 v[144:147], v[224:227], v[192:195], v[144:147]
    v_mfma_f32_16x16x32_bf16 v[140:143], v[192:195], v[220:223], v[140:143]
    v_mfma_f32_16x16x32_bf16 v[136:139], v[216:219], v[192:195], v[136:139]
    v_mfma_f32_16x16x32_bf16 v[132:135], v[212:215], v[192:195], v[132:135]
    s_waitcnt lgkmcnt(0)
    v_mfma_f32_16x16x32_bf16 v[52:55], v[196:199], v[148:151], v[52:55]
    ds_read_b64_tr_b16 v[212:213], v43 offset:49152
    v_mfma_f32_16x16x32_bf16 v[56:59], v[200:203], v[148:151], v[56:59]
    ds_read_b64_tr_b16 v[214:215], v43 offset:50176
    v_mfma_f32_16x16x32_bf16 v[60:63], v[148:151], v[204:207], v[60:63]
    ds_read_b128 v[172:175], v40 offset:40960
    v_mfma_f32_16x16x32_bf16 v[64:67], v[208:211], v[148:151], v[64:67]
    ds_read_b64_tr_b16 v[216:217], v44 offset:49152
    v_mfma_f32_16x16x32_bf16 v[80:83], v[208:211], v[152:155], v[80:83]
    ds_read_b64_tr_b16 v[218:219], v44 offset:50176
    v_mfma_f32_16x16x32_bf16 v[76:79], v[152:155], v[204:207], v[76:79]
    ds_read_b128 v[176:179], v40 offset:43008
    v_mfma_f32_16x16x32_bf16 v[72:75], v[200:203], v[152:155], v[72:75]
    ds_read_b64_tr_b16 v[220:221], v45 offset:49152
    v_mfma_f32_16x16x32_bf16 v[68:71], v[196:199], v[152:155], v[68:71]
    ds_read_b64_tr_b16 v[222:223], v45 offset:50176
    v_mfma_f32_16x16x32_bf16 v[84:87], v[196:199], v[156:159], v[84:87]
    ds_read_b128 v[180:183], v40 offset:45056
    v_mfma_f32_16x16x32_bf16 v[88:91], v[200:203], v[156:159], v[88:91]
    ds_read_b64_tr_b16 v[224:225], v46 offset:49152
    v_mfma_f32_16x16x32_bf16 v[92:95], v[156:159], v[204:207], v[92:95]
    ds_read_b64_tr_b16 v[226:227], v46 offset:50176
    v_mfma_f32_16x16x32_bf16 v[96:99], v[208:211], v[156:159], v[96:99]
    ds_read_b128 v[184:187], v40 offset:47104
    v_mfma_f32_16x16x32_bf16 v[112:115], v[208:211], v[160:163], v[112:115]
    ds_read_b128 v[188:191], v40 offset:49152
    v_mfma_f32_16x16x32_bf16 v[108:111], v[160:163], v[204:207], v[108:111]
    ds_read_b128 v[192:195], v40 offset:51200
    v_mfma_f32_16x16x32_bf16 v[104:107], v[200:203], v[160:163], v[104:107]
    v_mfma_f32_16x16x32_bf16 v[100:103], v[196:199], v[160:163], v[100:103]
    v_mfma_f32_16x16x32_bf16 v[116:119], v[196:199], v[164:167], v[116:119]
    v_mfma_f32_16x16x32_bf16 v[120:123], v[200:203], v[164:167], v[120:123]
    v_mfma_f32_16x16x32_bf16 v[124:127], v[164:167], v[204:207], v[124:127]
    v_mfma_f32_16x16x32_bf16 v[128:131], v[208:211], v[164:167], v[128:131]
    v_mfma_f32_16x16x32_bf16 v[144:147], v[208:211], v[168:171], v[144:147]
    v_mfma_f32_16x16x32_bf16 v[140:143], v[168:171], v[204:207], v[140:143]
    v_mfma_f32_16x16x32_bf16 v[136:139], v[200:203], v[168:171], v[136:139]
    v_mfma_f32_16x16x32_bf16 v[132:135], v[196:199], v[168:171], v[132:135]
    s_waitcnt lgkmcnt(0)
    s_barrier
    v_mfma_f32_16x16x32_bf16 v[52:55], v[212:215], v[172:175], v[52:55]
    ds_read_b64_tr_b16 v[196:197], v47 offset:0
    v_mfma_f32_16x16x32_bf16 v[56:59], v[216:219], v[172:175], v[56:59]
    ds_read_b64_tr_b16 v[198:199], v47 offset:1024
    v_mfma_f32_16x16x32_bf16 v[60:63], v[172:175], v[220:223], v[60:63]
    ds_read_b128 v[148:151], v41 offset:0
    v_mfma_f32_16x16x32_bf16 v[64:67], v[224:227], v[172:175], v[64:67]
    ds_read_b64_tr_b16 v[200:201], v48 offset:0
    v_mfma_f32_16x16x32_bf16 v[80:83], v[224:227], v[176:179], v[80:83]
    ds_read_b64_tr_b16 v[202:203], v48 offset:1024
    v_mfma_f32_16x16x32_bf16 v[76:79], v[176:179], v[220:223], v[76:79]
    ds_read_b128 v[152:155], v41 offset:2048
    v_mfma_f32_16x16x32_bf16 v[72:75], v[216:219], v[176:179], v[72:75]
    ds_read_b64_tr_b16 v[204:205], v49 offset:0
    v_mfma_f32_16x16x32_bf16 v[68:71], v[212:215], v[176:179], v[68:71]
    ds_read_b64_tr_b16 v[206:207], v49 offset:1024
    v_mfma_f32_16x16x32_bf16 v[84:87], v[212:215], v[180:183], v[84:87]
    ds_read_b128 v[156:159], v41 offset:4096
    v_mfma_f32_16x16x32_bf16 v[88:91], v[216:219], v[180:183], v[88:91]
    ds_read_b64_tr_b16 v[208:209], v50 offset:0
    v_mfma_f32_16x16x32_bf16 v[92:95], v[180:183], v[220:223], v[92:95]
    ds_read_b64_tr_b16 v[210:211], v50 offset:1024
    v_mfma_f32_16x16x32_bf16 v[96:99], v[224:227], v[180:183], v[96:99]
    ds_read_b128 v[160:163], v41 offset:6144
    v_mfma_f32_16x16x32_bf16 v[112:115], v[224:227], v[184:187], v[112:115]
    ds_read_b128 v[164:167], v41 offset:8192
    v_mfma_f32_16x16x32_bf16 v[108:111], v[184:187], v[220:223], v[108:111]
    ds_read_b128 v[168:171], v41 offset:10240
    v_mfma_f32_16x16x32_bf16 v[104:107], v[216:219], v[184:187], v[104:107]
    v_mfma_f32_16x16x32_bf16 v[100:103], v[212:215], v[184:187], v[100:103]
    v_mfma_f32_16x16x32_bf16 v[116:119], v[212:215], v[188:191], v[116:119]
    v_mfma_f32_16x16x32_bf16 v[120:123], v[216:219], v[188:191], v[120:123]
    v_mfma_f32_16x16x32_bf16 v[124:127], v[188:191], v[220:223], v[124:127]
    v_mfma_f32_16x16x32_bf16 v[128:131], v[224:227], v[188:191], v[128:131]
    v_mfma_f32_16x16x32_bf16 v[144:147], v[224:227], v[192:195], v[144:147]
    v_mfma_f32_16x16x32_bf16 v[140:143], v[192:195], v[220:223], v[140:143]
    v_mfma_f32_16x16x32_bf16 v[136:139], v[216:219], v[192:195], v[136:139]
    v_mfma_f32_16x16x32_bf16 v[132:135], v[212:215], v[192:195], v[132:135]
    s_waitcnt lgkmcnt(0)
    v_mfma_f32_16x16x32_bf16 v[52:55], v[196:199], v[148:151], v[52:55]
    ds_read_b64_tr_b16 v[212:213], v47 offset:8192
    v_mfma_f32_16x16x32_bf16 v[56:59], v[200:203], v[148:151], v[56:59]
    ds_read_b64_tr_b16 v[214:215], v47 offset:9216
    v_mfma_f32_16x16x32_bf16 v[60:63], v[148:151], v[204:207], v[60:63]
    ds_read_b128 v[172:175], v42 offset:0
    v_mfma_f32_16x16x32_bf16 v[64:67], v[208:211], v[148:151], v[64:67]
    ds_read_b64_tr_b16 v[216:217], v48 offset:8192
    v_mfma_f32_16x16x32_bf16 v[80:83], v[208:211], v[152:155], v[80:83]
    ds_read_b64_tr_b16 v[218:219], v48 offset:9216
    v_mfma_f32_16x16x32_bf16 v[76:79], v[152:155], v[204:207], v[76:79]
    ds_read_b128 v[176:179], v42 offset:2048
    v_mfma_f32_16x16x32_bf16 v[72:75], v[200:203], v[152:155], v[72:75]
    ds_read_b64_tr_b16 v[220:221], v49 offset:8192
    v_mfma_f32_16x16x32_bf16 v[68:71], v[196:199], v[152:155], v[68:71]
    ds_read_b64_tr_b16 v[222:223], v49 offset:9216
    v_mfma_f32_16x16x32_bf16 v[84:87], v[196:199], v[156:159], v[84:87]
    ds_read_b128 v[180:183], v42 offset:4096
    v_mfma_f32_16x16x32_bf16 v[88:91], v[200:203], v[156:159], v[88:91]
    ds_read_b64_tr_b16 v[224:225], v50 offset:8192
    v_mfma_f32_16x16x32_bf16 v[92:95], v[156:159], v[204:207], v[92:95]
    ds_read_b64_tr_b16 v[226:227], v50 offset:9216
    v_mfma_f32_16x16x32_bf16 v[96:99], v[208:211], v[156:159], v[96:99]
    ds_read_b128 v[184:187], v42 offset:6144
    v_mfma_f32_16x16x32_bf16 v[112:115], v[208:211], v[160:163], v[112:115]
    ds_read_b128 v[188:191], v42 offset:8192
    v_mfma_f32_16x16x32_bf16 v[108:111], v[160:163], v[204:207], v[108:111]
    ds_read_b128 v[192:195], v42 offset:10240
    v_mfma_f32_16x16x32_bf16 v[104:107], v[200:203], v[160:163], v[104:107]
    v_mfma_f32_16x16x32_bf16 v[100:103], v[196:199], v[160:163], v[100:103]
    v_mfma_f32_16x16x32_bf16 v[116:119], v[196:199], v[164:167], v[116:119]
    v_mfma_f32_16x16x32_bf16 v[120:123], v[200:203], v[164:167], v[120:123]
    v_mfma_f32_16x16x32_bf16 v[124:127], v[164:167], v[204:207], v[124:127]
    v_mfma_f32_16x16x32_bf16 v[128:131], v[208:211], v[164:167], v[128:131]
    v_mfma_f32_16x16x32_bf16 v[144:147], v[208:211], v[168:171], v[144:147]
    v_mfma_f32_16x16x32_bf16 v[140:143], v[168:171], v[204:207], v[140:143]
    v_mfma_f32_16x16x32_bf16 v[136:139], v[200:203], v[168:171], v[136:139]
    v_mfma_f32_16x16x32_bf16 v[132:135], v[196:199], v[168:171], v[132:135]
    s_waitcnt lgkmcnt(0)
    s_barrier
    v_mfma_f32_16x16x32_bf16 v[52:55], v[212:215], v[172:175], v[52:55]
    ds_read_b64_tr_b16 v[196:197], v43 offset:0
    v_mfma_f32_16x16x32_bf16 v[56:59], v[216:219], v[172:175], v[56:59]
    ds_read_b64_tr_b16 v[198:199], v43 offset:1024
    v_mfma_f32_16x16x32_bf16 v[60:63], v[172:175], v[220:223], v[60:63]
    ds_read_b128 v[148:151], v39 offset:0
    v_mfma_f32_16x16x32_bf16 v[64:67], v[224:227], v[172:175], v[64:67]
    ds_read_b64_tr_b16 v[200:201], v44 offset:0
    v_mfma_f32_16x16x32_bf16 v[80:83], v[224:227], v[176:179], v[80:83]
    ds_read_b64_tr_b16 v[202:203], v44 offset:1024
    v_mfma_f32_16x16x32_bf16 v[76:79], v[176:179], v[220:223], v[76:79]
    ds_read_b128 v[152:155], v39 offset:2048
    v_mfma_f32_16x16x32_bf16 v[72:75], v[216:219], v[176:179], v[72:75]
    ds_read_b64_tr_b16 v[204:205], v45 offset:0
    v_mfma_f32_16x16x32_bf16 v[68:71], v[212:215], v[176:179], v[68:71]
    ds_read_b64_tr_b16 v[206:207], v45 offset:1024
    v_mfma_f32_16x16x32_bf16 v[84:87], v[212:215], v[180:183], v[84:87]
    ds_read_b128 v[156:159], v39 offset:4096
    v_mfma_f32_16x16x32_bf16 v[88:91], v[216:219], v[180:183], v[88:91]
    ds_read_b64_tr_b16 v[208:209], v46 offset:0
    v_mfma_f32_16x16x32_bf16 v[92:95], v[180:183], v[220:223], v[92:95]
    ds_read_b64_tr_b16 v[210:211], v46 offset:1024
    v_mfma_f32_16x16x32_bf16 v[96:99], v[224:227], v[180:183], v[96:99]
    ds_read_b128 v[160:163], v39 offset:6144
    v_mfma_f32_16x16x32_bf16 v[112:115], v[224:227], v[184:187], v[112:115]
    ds_read_b128 v[164:167], v39 offset:8192
    v_mfma_f32_16x16x32_bf16 v[108:111], v[184:187], v[220:223], v[108:111]
    ds_read_b128 v[168:171], v39 offset:10240
    v_mfma_f32_16x16x32_bf16 v[104:107], v[216:219], v[184:187], v[104:107]
    v_mfma_f32_16x16x32_bf16 v[100:103], v[212:215], v[184:187], v[100:103]
    v_mfma_f32_16x16x32_bf16 v[116:119], v[212:215], v[188:191], v[116:119]
    v_mfma_f32_16x16x32_bf16 v[120:123], v[216:219], v[188:191], v[120:123]
    v_mfma_f32_16x16x32_bf16 v[124:127], v[188:191], v[220:223], v[124:127]
    v_mfma_f32_16x16x32_bf16 v[128:131], v[224:227], v[188:191], v[128:131]
    v_mfma_f32_16x16x32_bf16 v[144:147], v[224:227], v[192:195], v[144:147]
    v_mfma_f32_16x16x32_bf16 v[140:143], v[192:195], v[220:223], v[140:143]
    v_mfma_f32_16x16x32_bf16 v[136:139], v[216:219], v[192:195], v[136:139]
    v_mfma_f32_16x16x32_bf16 v[132:135], v[212:215], v[192:195], v[132:135]
    s_waitcnt lgkmcnt(0)
    v_mfma_f32_16x16x32_bf16 v[52:55], v[196:199], v[148:151], v[52:55]
    ds_read_b64_tr_b16 v[212:213], v43 offset:8192
    v_mfma_f32_16x16x32_bf16 v[56:59], v[200:203], v[148:151], v[56:59]
    ds_read_b64_tr_b16 v[214:215], v43 offset:9216
    v_mfma_f32_16x16x32_bf16 v[60:63], v[148:151], v[204:207], v[60:63]
    ds_read_b128 v[172:175], v40 offset:0
    v_mfma_f32_16x16x32_bf16 v[64:67], v[208:211], v[148:151], v[64:67]
    ds_read_b64_tr_b16 v[216:217], v44 offset:8192
    v_mfma_f32_16x16x32_bf16 v[80:83], v[208:211], v[152:155], v[80:83]
    ds_read_b64_tr_b16 v[218:219], v44 offset:9216
    v_mfma_f32_16x16x32_bf16 v[76:79], v[152:155], v[204:207], v[76:79]
    ds_read_b128 v[176:179], v40 offset:2048
    v_mfma_f32_16x16x32_bf16 v[72:75], v[200:203], v[152:155], v[72:75]
    ds_read_b64_tr_b16 v[220:221], v45 offset:8192
    v_mfma_f32_16x16x32_bf16 v[68:71], v[196:199], v[152:155], v[68:71]
    ds_read_b64_tr_b16 v[222:223], v45 offset:9216
    v_mfma_f32_16x16x32_bf16 v[84:87], v[196:199], v[156:159], v[84:87]
    ds_read_b128 v[180:183], v40 offset:4096
    v_mfma_f32_16x16x32_bf16 v[88:91], v[200:203], v[156:159], v[88:91]
    ds_read_b64_tr_b16 v[224:225], v46 offset:8192
    v_mfma_f32_16x16x32_bf16 v[92:95], v[156:159], v[204:207], v[92:95]
    ds_read_b64_tr_b16 v[226:227], v46 offset:9216
    v_mfma_f32_16x16x32_bf16 v[96:99], v[208:211], v[156:159], v[96:99]
    ds_read_b128 v[184:187], v40 offset:6144
    v_mfma_f32_16x16x32_bf16 v[112:115], v[208:211], v[160:163], v[112:115]
    ds_read_b128 v[188:191], v40 offset:8192
    v_mfma_f32_16x16x32_bf16 v[108:111], v[160:163], v[204:207], v[108:111]
    ds_read_b128 v[192:195], v40 offset:10240
    v_mfma_f32_16x16x32_bf16 v[104:107], v[200:203], v[160:163], v[104:107]
    v_mfma_f32_16x16x32_bf16 v[100:103], v[196:199], v[160:163], v[100:103]
    v_mfma_f32_16x16x32_bf16 v[116:119], v[196:199], v[164:167], v[116:119]
    v_mfma_f32_16x16x32_bf16 v[120:123], v[200:203], v[164:167], v[120:123]
    v_mfma_f32_16x16x32_bf16 v[124:127], v[164:167], v[204:207], v[124:127]
    v_mfma_f32_16x16x32_bf16 v[128:131], v[208:211], v[164:167], v[128:131]
    v_mfma_f32_16x16x32_bf16 v[144:147], v[208:211], v[168:171], v[144:147]
    v_mfma_f32_16x16x32_bf16 v[140:143], v[168:171], v[204:207], v[140:143]
    v_mfma_f32_16x16x32_bf16 v[136:139], v[200:203], v[168:171], v[136:139]
    v_mfma_f32_16x16x32_bf16 v[132:135], v[196:199], v[168:171], v[132:135]
    s_waitcnt lgkmcnt(0)
    s_barrier
    v_mfma_f32_16x16x32_bf16 v[52:55], v[212:215], v[172:175], v[52:55]
    ds_read_b64_tr_b16 v[196:197], v43 offset:40960
    v_mfma_f32_16x16x32_bf16 v[56:59], v[216:219], v[172:175], v[56:59]
    ds_read_b64_tr_b16 v[198:199], v43 offset:41984
    v_mfma_f32_16x16x32_bf16 v[60:63], v[172:175], v[220:223], v[60:63]
    ds_read_b128 v[148:151], v39 offset:40960
    v_mfma_f32_16x16x32_bf16 v[64:67], v[224:227], v[172:175], v[64:67]
    ds_read_b64_tr_b16 v[200:201], v44 offset:40960
    v_mfma_f32_16x16x32_bf16 v[80:83], v[224:227], v[176:179], v[80:83]
    ds_read_b64_tr_b16 v[202:203], v44 offset:41984
    v_mfma_f32_16x16x32_bf16 v[76:79], v[176:179], v[220:223], v[76:79]
    ds_read_b128 v[152:155], v39 offset:43008
    v_mfma_f32_16x16x32_bf16 v[72:75], v[216:219], v[176:179], v[72:75]
    ds_read_b64_tr_b16 v[204:205], v45 offset:40960
    v_mfma_f32_16x16x32_bf16 v[68:71], v[212:215], v[176:179], v[68:71]
    ds_read_b64_tr_b16 v[206:207], v45 offset:41984
    v_mfma_f32_16x16x32_bf16 v[84:87], v[212:215], v[180:183], v[84:87]
    ds_read_b128 v[156:159], v39 offset:45056
    v_mfma_f32_16x16x32_bf16 v[88:91], v[216:219], v[180:183], v[88:91]
    ds_read_b64_tr_b16 v[208:209], v46 offset:40960
    v_mfma_f32_16x16x32_bf16 v[92:95], v[180:183], v[220:223], v[92:95]
    ds_read_b64_tr_b16 v[210:211], v46 offset:41984
    v_mfma_f32_16x16x32_bf16 v[96:99], v[224:227], v[180:183], v[96:99]
    ds_read_b128 v[160:163], v39 offset:47104
    v_mfma_f32_16x16x32_bf16 v[112:115], v[224:227], v[184:187], v[112:115]
    ds_read_b128 v[164:167], v39 offset:49152
    v_mfma_f32_16x16x32_bf16 v[108:111], v[184:187], v[220:223], v[108:111]
    ds_read_b128 v[168:171], v39 offset:51200
    v_mfma_f32_16x16x32_bf16 v[104:107], v[216:219], v[184:187], v[104:107]
    v_mfma_f32_16x16x32_bf16 v[100:103], v[212:215], v[184:187], v[100:103]
    s_branch K_PG2
.p2align 12
K_CHM2:
K_STM2:
    s_branch K_WRET_M
    s_nop 0
K_PG2:
    v_mfma_f32_16x16x32_bf16 v[116:119], v[212:215], v[188:191], v[116:119]
    v_mfma_f32_16x16x32_bf16 v[120:123], v[216:219], v[188:191], v[120:123]
    v_mfma_f32_16x16x32_bf16 v[124:127], v[188:191], v[220:223], v[124:127]
    v_mfma_f32_16x16x32_bf16 v[128:131], v[224:227], v[188:191], v[128:131]
    v_mfma_f32_16x16x32_bf16 v[144:147], v[224:227], v[192:195], v[144:147]
    v_mfma_f32_16x16x32_bf16 v[140:143], v[192:195], v[220:223], v[140:143]
    v_mfma_f32_16x16x32_bf16 v[136:139], v[216:219], v[192:195], v[136:139]
    v_mfma_f32_16x16x32_bf16 v[132:135], v[212:215], v[192:195], v[132:135]
    s_waitcnt lgkmcnt(0)
    v_mfma_f32_16x16x32_bf16 v[52:55], v[196:199], v[148:151], v[52:55]
    ds_read_b64_tr_b16 v[212:213], v43 offset:49152
    v_mfma_f32_16x16x32_bf16 v[56:59], v[200:203], v[148:151], v[56:59]
    ds_read_b64_tr_b16 v[214:215], v43 offset:50176
    v_mfma_f32_16x16x32_bf16 v[60:63], v[148:151], v[204:207], v[60:63]
    ds_read_b128 v[172:175], v40 offset:40960
    v_mfma_f32_16x16x32_bf16 v[64:67], v[208:211], v[148:151], v[64:67]
    ds_read_b64_tr_b16 v[216:217], v44 offset:49152
    v_mfma_f32_16x16x32_bf16 v[80:83], v[208:211], v[152:155], v[80:83]
    ds_read_b64_tr_b16 v[218:219], v44 offset:50176
    v_mfma_f32_16x16x32_bf16 v[76:79], v[152:155], v[204:207], v[76:79]
    ds_read_b128 v[176:179], v40 offset:43008
    v_mfma_f32_16x16x32_bf16 v[72:75], v[200:203], v[152:155], v[72:75]
    ds_read_b64_tr_b16 v[220:221], v45 offset:49152
    v_mfma_f32_16x16x32_bf16 v[68:71], v[196:199], v[152:155], v[68:71]
    ds_read_b64_tr_b16 v[222:223], v45 offset:50176
    v_mfma_f32_16x16x32_bf16 v[84:87], v[196:199], v[156:159], v[84:87]
    ds_read_b128 v[180:183], v40 offset:45056
    v_mfma_f32_16x16x32_bf16 v[88:91], v[200:203], v[156:159], v[88:91]
    ds_read_b64_tr_b16 v[224:225], v46 offset:49152
    v_mfma_f32_16x16x32_bf16 v[92:95], v[156:159], v[204:207], v[92:95]
    ds_read_b64_tr_b16 v[226:227], v46 offset:50176
    v_mfma_f32_16x16x32_bf16 v[96:99], v[208:211], v[156:159], v[96:99]
    ds_read_b128 v[184:187], v40 offset:47104
    v_mfma_f32_16x16x32_bf16 v[112:115], v[208:211], v[160:163], v[112:115]
    ds_read_b128 v[188:191], v40 offset:49152
    v_mfma_f32_16x16x32_bf16 v[108:111], v[160:163], v[204:207], v[108:111]
    ds_read_b128 v[192:195], v40 offset:51200
    v_mfma_f32_16x16x32_bf16 v[104:107], v[200:203], v[160:163], v[104:107]
    v_mfma_f32_16x16x32_bf16 v[100:103], v[196:199], v[160:163], v[100:103]
    v_mfma_f32_16x16x32_bf16 v[116:119], v[196:199], v[164:167], v[116:119]
    v_mfma_f32_16x16x32_bf16 v[120:123], v[200:203], v[164:167], v[120:123]
    v_mfma_f32_16x16x32_bf16 v[124:127], v[164:167], v[204:207], v[124:127]
    v_mfma_f32_16x16x32_bf16 v[128:131], v[208:211], v[164:167], v[128:131]
    v_mfma_f32_16x16x32_bf16 v[144:147], v[208:211], v[168:171], v[144:147]
    v_mfma_f32_16x16x32_bf16 v[140:143], v[168:171], v[204:207], v[140:143]
    v_mfma_f32_16x16x32_bf16 v[136:139], v[200:203], v[168:171], v[136:139]
    v_mfma_f32_16x16x32_bf16 v[132:135], v[196:199], v[168:171], v[132:135]
    s_waitcnt lgkmcnt(0)
    s_barrier
    v_mfma_f32_16x16x32_bf16 v[52:55], v[212:215], v[172:175], v[52:55]
    ds_read_b64_tr_b16 v[196:197], v47 offset:0
    v_mfma_f32_16x16x32_bf16 v[56:59], v[216:219], v[172:175], v[56:59]
    ds_read_b64_tr_b16 v[198:199], v47 offset:1024
    v_mfma_f32_16x16x32_bf16 v[60:63], v[172:175], v[220:223], v[60:63]
    ds_read_b128 v[148:151], v41 offset:0
    v_mfma_f32_16x16x32_bf16 v[64:67], v[224:227], v[172:175], v[64:67]
    ds_read_b64_tr_b16 v[200:201], v48 offset:0
    v_mfma_f32_16x16x32_bf16 v[80:83], v[224:227], v[176:179], v[80:83]
    ds_read_b64_tr_b16 v[202:203], v48 offset:1024
    v_mfma_f32_16x16x32_bf16 v[76:79], v[176:179], v[220:223], v[76:79]
    ds_read_b128 v[152:155], v41 offset:2048
    v_mfma_f32_16x16x32_bf16 v[72:75], v[216:219], v[176:179], v[72:75]
    ds_read_b64_tr_b16 v[204:205], v49 offset:0
    v_mfma_f32_16x16x32_bf16 v[68:71], v[212:215], v[176:179], v[68:71]
    ds_read_b64_tr_b16 v[206:207], v49 offset:1024
    v_mfma_f32_16x16x32_bf16 v[84:87], v[212:215], v[180:183], v[84:87]
    ds_read_b128 v[156:159], v41 offset:4096
    v_mfma_f32_16x16x32_bf16 v[88:91], v[216:219], v[180:183], v[88:91]
    ds_read_b64_tr_b16 v[208:209], v50 offset:0
    v_mfma_f32_16x16x32_bf16 v[92:95], v[180:183], v[220:223], v[92:95]
    ds_read_b64_tr_b16 v[210:211], v50 offset:1024
    v_mfma_f32_16x16x32_bf16 v[96:99], v[224:227], v[180:183], v[96:99]
    ds_read_b128 v[160:163], v41 offset:6144
    v_mfma_f32_16x16x32_bf16 v[112:115], v[224:227], v[184:187], v[112:115]
    ds_read_b128 v[164:167], v41 offset:8192
    v_mfma_f32_16x16x32_bf16 v[108:111], v[184:187], v[220:223], v[108:111]
    ds_read_b128 v[168:171], v41 offset:10240
    v_mfma_f32_16x16x32_bf16 v[104:107], v[216:219], v[184:187], v[104:107]
    v_mfma_f32_16x16x32_bf16 v[100:103], v[212:215], v[184:187], v[100:103]
    v_mfma_f32_16x16x32_bf16 v[116:119], v[212:215], v[188:191], v[116:119]
    v_mfma_f32_16x16x32_bf16 v[120:123], v[216:219], v[188:191], v[120:123]
    v_mfma_f32_16x16x32_bf16 v[124:127], v[188:191], v[220:223], v[124:127]
    v_mfma_f32_16x16x32_bf16 v[128:131], v[224:227], v[188:191], v[128:131]
    v_mfma_f32_16x16x32_bf16 v[144:147], v[224:227], v[192:195], v[144:147]
    v_mfma_f32_16x16x32_bf16 v[140:143], v[192:195], v[220:223], v[140:143]
    v_mfma_f32_16x16x32_bf16 v[136:139], v[216:219], v[192:195], v[136:139]
    v_mfma_f32_16x16x32_bf16 v[132:135], v[212:215], v[192:195], v[132:135]
    s_waitcnt lgkmcnt(0)
    v_mfma_f32_16x16x32_bf16 v[132:135], v[196:199], v[168:171], v[132:135]
    ds_read_b64_tr_b16 v[212:213], v47 offset:8192
    ds_read_b64_tr_b16 v[214:215], v47 offset:9216
    v_mfma_f32_16x16x32_bf16 v[136:139], v[200:203], v[168:171], v[136:139]
    ds_read_b128 v[192:195], v42 offset:10240
    ds_read_b64_tr_b16 v[216:217], v48 offset:8192
    v_mfma_f32_16x16x32_bf16 v[140:143], v[168:171], v[204:207], v[140:143]
    ds_read_b64_tr_b16 v[218:219], v48 offset:9216
    ds_read_b64_tr_b16 v[220:221], v49 offset:8192
    v_mfma_f32_16x16x32_bf16 v[144:147], v[208:211], v[168:171], v[144:147]
    ds_read_b64_tr_b16 v[222:223], v49 offset:9216
    ds_read_b64_tr_b16 v[224:225], v50 offset:8192
    v_mfma_f32_16x16x32_bf16 v[116:119], v[196:199], v[164:167], v[116:119]
    ds_read_b64_tr_b16 v[226:227], v50 offset:9216
    ds_read_b128 v[188:191], v42 offset:8192
    v_mfma_f32_16x16x32_bf16 v[120:123], v[200:203], v[164:167], v[120:123]
    ds_read_b128 v[184:187], v42 offset:6144
    ds_read_b128 v[180:183], v42 offset:4096
    v_mfma_f32_16x16x32_bf16 v[124:127], v[164:167], v[204:207], v[124:127]
    ds_read_b128 v[176:179], v42 offset:2048
    ds_read_b128 v[172:175], v42 offset:0
    v_mfma_f32_16x16x32_bf16 v[128:131], v[208:211], v[164:167], v[128:131]
    s_waitcnt lgkmcnt(11)
    v_mfma_f32_16x16x32_bf16 v[132:135], v[212:215], v[192:195], v[132:135]
    s_waitcnt lgkmcnt(9)
    v_mfma_f32_16x16x32_bf16 v[136:139], v[216:219], v[192:195], v[136:139]
    s_waitcnt lgkmcnt(7)
    v_mfma_f32_16x16x32_bf16 v[140:143], v[192:195], v[220:223], v[140:143]
    s_waitcnt lgkmcnt(5)
    v_mfma_f32_16x16x32_bf16 v[144:147], v[224:227], v[192:195], v[144:147]
    s_waitcnt lgkmcnt(4)
    v_mfma_f32_16x16x32_bf16 v[116:119], v[212:215], v[188:191], v[116:119]
    v_cvt_pk_bf16_f32 v132, v132, v133
    v_cvt_pk_bf16_f32 v133, v134, v135
    v_mfma_f32_16x16x32_bf16 v[120:123], v[216:219], v[188:191], v[120:123]
    v_cvt_pk_bf16_f32 v136, v136, v137
    v_cvt_pk_bf16_f32 v137, v138, v139
    v_mfma_f32_16x16x32_bf16 v[124:127], v[188:191], v[220:223], v[124:127]
    v_mov_b32 v138, 0
    v_mov_b32 v139, 0
    v_mfma_f32_16x16x32_bf16 v[128:131], v[224:227], v[188:191], v[128:131]
    v_cvt_pk_bf16_f32 v134, v144, v145
    v_cvt_pk_bf16_f32 v135, v146, v147
    v_mfma_f32_16x16x32_bf16 v[100:103], v[196:199], v[160:163], v[100:103]
    v_cvt_pk_bf16_f32 v254, v140, v141
    v_cvt_pk_bf16_f32 v255, v142, v143
    v_mfma_f32_16x16x32_bf16 v[104:107], v[200:203], v[160:163], v[104:107]
    v_permlane16_swap_b32 v134, v138
    v_permlane16_swap_b32 v135, v139
    ds_write_b64 v32, v[134:135] offset:768
    v_mfma_f32_16x16x32_bf16 v[108:111], v[160:163], v[204:207], v[108:111]
    ds_read_b64_tr_b16 v[240:241], v33 offset:768
    s_cmp_lg_u32 s54, 0
    s_cbranch_scc1 K_NOX
    ds_write_b64 v34, v[132:133]
    ds_write_b64 v34, v[134:135] offset:512
    ds_write_b64 v34, v[254:255] offset:1024
    v_lshl_add_u32 v2, s55, 2, v38
    ds_write_b16 v2, v38 offset:30
K_NOX:
    v_mfma_f32_16x16x32_bf16 v[112:115], v[208:211], v[160:163], v[112:115]
    v_cvt_pk_bf16_f32 v116, v116, v117
    v_cvt_pk_bf16_f32 v117, v118, v119
    v_mfma_f32_16x16x32_bf16 v[192:195], v[132:135], v[136:139], v[16:19]
    v_cvt_pk_bf16_f32 v120, v120, v121
    v_cvt_pk_bf16_f32 v121, v122, v123
    s_waitcnt lgkmcnt(5)
    v_mfma_f32_16x16x32_bf16 v[100:103], v[212:215], v[184:187], v[100:103]
    v_mov_b32 v122, 0
    v_mov_b32 v123, 0
    v_mfma_f32_16x16x32_bf16 v[104:107], v[216:219], v[184:187], v[104:107]
    v_cvt_pk_bf16_f32 v118, v128, v129
    v_cvt_pk_bf16_f32 v119, v130, v131
    v_mfma_f32_16x16x32_bf16 v[108:111], v[184:187], v[220:223], v[108:111]
    v_cvt_pk_bf16_f32 v252, v124, v125
    v_cvt_pk_bf16_f32 v253, v126, v127
    v_mfma_f32_16x16x32_bf16 v[112:115], v[224:227], v[184:187], v[112:115]
    v_permlane16_swap_b32 v118, v122
    v_permlane16_swap_b32 v119, v123
    ds_write_b64 v32, v[118:119] offset:640
    v_mfma_f32_16x16x32_bf16 v[84:87], v[196:199], v[156:159], v[84:87]
    ds_read_b64_tr_b16 v[238:239], v33 offset:640
    v_cvt_pk_bf16_f32 v100, v100, v101
    v_mfma_f32_16x16x32_bf16 v[88:91], v[200:203], v[156:159], v[88:91]
    v_cvt_pk_bf16_f32 v101, v102, v103
    v_cvt_pk_bf16_f32 v104, v104, v105
    v_mfma_f32_16x16x32_bf16 v[168:171], v[116:119], v[136:139], v[12:15]
    v_cvt_pk_bf16_f32 v105, v106, v107
    v_mov_b32 v106, 0
    v_mfma_f32_16x16x32_bf16 v[92:95], v[156:159], v[204:207], v[92:95]
    v_mov_b32 v107, 0
    v_cvt_pk_bf16_f32 v102, v112, v113
    v_mfma_f32_16x16x32_bf16 v[188:191], v[116:119], v[120:123], v[16:19]
    v_cvt_pk_bf16_f32 v103, v114, v115
    v_cvt_pk_bf16_f32 v250, v108, v109
    v_mfma_f32_16x16x32_bf16 v[96:99], v[208:211], v[156:159], v[96:99]
    v_cvt_pk_bf16_f32 v251, v110, v111
    v_permlane16_swap_b32 v102, v106
    s_waitcnt lgkmcnt(6)
    v_mfma_f32_16x16x32_bf16 v[84:87], v[212:215], v[180:183], v[84:87]
    v_permlane16_swap_b32 v103, v107
    ds_write_b64 v32, v[102:103] offset:512
    v_mfma_f32_16x16x32_bf16 v[88:91], v[216:219], v[180:183], v[88:91]
    ds_read_b64_tr_b16 v[236:237], v33 offset:512
    v_max3_f32 v168, v168, v169, v192
    v_mfma_f32_16x16x32_bf16 v[92:95], v[180:183], v[220:223], v[92:95]
    v_max3_f32 v170, v170, v171, v194
    v_max_f32 v168, v168, v193
    v_mfma_f32_16x16x32_bf16 v[164:167], v[100:103], v[120:123], v[12:15]
    v_max_f32 v169, v170, v195
    v_cvt_pk_bf16_f32 v168, v168, v169
    v_mfma_f32_16x16x32_bf16 v[96:99], v[224:227], v[180:183], v[96:99]
    v_cvt_pk_bf16_f32 v84, v84, v85
    v_cvt_pk_bf16_f32 v85, v86, v87
    v_mfma_f32_16x16x32_bf16 v[184:187], v[100:103], v[104:107], v[16:19]
    v_cvt_pk_bf16_f32 v88, v88, v89
    v_cvt_pk_bf16_f32 v89, v90, v91
    v_mfma_f32_16x16x32_bf16 v[68:71], v[196:199], v[152:155], v[68:71]
    v_mov_b32 v90, 0
    v_mov_b32 v91, 0
    v_mfma_f32_16x16x32_bf16 v[72:75], v[200:203], v[152:155], v[72:75]
    v_max3_f32 v164, v164, v165, v188
    v_max3_f32 v166, v166, v167, v190
    v_mfma_f32_16x16x32_bf16 v[76:79], v[152:155], v[204:207], v[76:79]
    v_max_f32 v164, v164, v189
    v_max_f32 v165, v166, v191
    v_mfma_f32_16x16x32_bf16 v[80:83], v[208:211], v[152:155], v[80:83]
    v_cvt_pk_bf16_f32 v164, v164, v165
    v_cvt_pk_bf16_f32 v86, v96, v97
    s_waitcnt lgkmcnt(7)
    v_mfma_f32_16x16x32_bf16 v[68:71], v[212:215], v[176:179], v[68:71]
    v_cvt_pk_bf16_f32 v87, v98, v99
    v_cvt_pk_bf16_f32 v248, v92, v93
    v_mfma_f32_16x16x32_bf16 v[72:75], v[216:219], v[176:179], v[72:75]
    v_cvt_pk_bf16_f32 v249, v94, v95
    v_permlane16_swap_b32 v86, v90
    v_mfma_f32_16x16x32_bf16 v[76:79], v[176:179], v[220:223], v[76:79]
    v_permlane16_swap_b32 v87, v91
    ds_write_b64 v32, v[86:87] offset:384
    v_mfma_f32_16x16x32_bf16 v[80:83], v[224:227], v[176:179], v[80:83]
    ds_read_b64_tr_b16 v[234:235], v33 offset:384
    v_lshl_add_u32 v2, s55, 2, v38
    v_mfma_f32_16x16x32_bf16 v[52:55], v[196:199], v[148:151], v[52:55]
    ds_read_b32 v3, v2 offset:28
    ds_read_b64 v[144:145], v34
    v_mfma_f32_16x16x32_bf16 v[160:163], v[84:87], v[104:107], v[12:15]
    ds_read_b64 v[146:147], v34 offset:512
    ds_read_b64 v[242:243], v34 offset:1024
    v_mfma_f32_16x16x32_bf16 v[56:59], v[200:203], v[148:151], v[56:59]
    ds_read_b64_tr_b16 v[228:229], v33
    v_cvt_pk_bf16_f32 v68, v68, v69
    v_mfma_f32_16x16x32_bf16 v[180:183], v[84:87], v[88:91], v[16:19]
    v_cvt_pk_bf16_f32 v69, v70, v71
    v_cvt_pk_bf16_f32 v72, v72, v73
    v_mfma_f32_16x16x32_bf16 v[60:63], v[148:151], v[204:207], v[60:63]
    v_cvt_pk_bf16_f32 v73, v74, v75
    v_mov_b32 v74, 0
    v_mfma_f32_16x16x32_bf16 v[64:67], v[208:211], v[148:151], v[64:67]
    v_mov_b32 v75, 0
    v_cvt_pk_bf16_f32 v70, v80, v81
    s_waitcnt lgkmcnt(13)
    v_mfma_f32_16x16x32_bf16 v[52:55], v[212:215], v[172:175], v[52:55]
    v_cvt_pk_bf16_f32 v71, v82, v83
    v_cvt_pk_bf16_f32 v246, v76, v77
    v_mfma_f32_16x16x32_bf16 v[56:59], v[216:219], v[172:175], v[56:59]
    v_cvt_pk_bf16_f32 v247, v78, v79
    v_permlane16_swap_b32 v70, v74
    v_mfma_f32_16x16x32_bf16 v[60:63], v[172:175], v[220:223], v[60:63]
    v_permlane16_swap_b32 v71, v75
    ds_write_b64 v32, v[70:71] offset:256
    v_mfma_f32_16x16x32_bf16 v[64:67], v[224:227], v[172:175], v[64:67]
    ds_read_b64_tr_b16 v[232:233], v33 offset:256
    v_max3_f32 v160, v160, v161, v184
    v_max3_f32 v162, v162, v163, v186
    v_max_f32 v160, v160, v185
    v_max_f32 v161, v162, v187
    v_mfma_f32_16x16x32_bf16 v[156:159], v[68:71], v[88:91], v[12:15]
    v_cvt_pk_bf16_f32 v160, v160, v161
    v_cvt_pk_bf16_f32 v52, v52, v53
    v_cvt_pk_bf16_f32 v53, v54, v55
    v_mfma_f32_16x16x32_bf16 v[176:179], v[68:71], v[72:75], v[16:19]
    v_cvt_pk_bf16_f32 v56, v56, v57
    v_cvt_pk_bf16_f32 v57, v58, v59
    v_mov_b32 v58, 0
    v_mov_b32 v59, 0
    v_cvt_pk_bf16_f32 v54, v64, v65
    v_cvt_pk_bf16_f32 v55, v66, v67
    v_cvt_pk_bf16_f32 v244, v60, v61
    v_cvt_pk_bf16_f32 v245, v62, v63
    v_permlane16_swap_b32 v54, v58
    v_permlane16_swap_b32 v55, v59
    ds_write_b64 v32, v[54:55] offset:128
    ds_read_b64_tr_b16 v[230:231], v33 offset:128
    v_max3_f32 v156, v156, v157, v180
    v_max3_f32 v158, v158, v159, v182
    v_max_f32 v156, v156, v181
    v_mfma_f32_16x16x32_bf16 v[152:155], v[52:55], v[72:75], v[20:23]
    v_max_f32 v157, v158, v183
    v_cvt_pk_bf16_f32 v156, v156, v157
    v_mfma_f32_16x16x32_bf16 v[172:175], v[52:55], v[56:59], v[16:19]
    s_waitcnt lgkmcnt(4)
    v_readfirstlane_b32 s33, v3
    s_cmp_lt_u32 s33, 1811939328
    s_cbranch_scc1 K_XW
K_XR:
    v_mfma_f32_16x16x32_bf16 v[148:151], v[144:147], v[56:59], v[12:15]
    v_max3_f32 v152, v152, v153, v176
    v_max3_f32 v154, v154, v155, v178
    v_max_f32 v152, v152, v177
    v_max_f32 v153, v154, v179
    v_cvt_pk_bf16_f32 v152, v152, v153
    v_permlane16_swap_b32 v164, v168
    v_permlane16_swap_b32 v156, v160
    s_nop 1
    v_max3_f32 v148, v148, v149, v172
    v_max3_f32 v150, v150, v151, v174
    v_max_f32 v148, v148, v173
    v_max_f32 v149, v150, v175
    v_cvt_pk_bf16_f32 v148, v148, v149
    v_permlane32_swap_b32 v156, v164
    v_permlane32_swap_b32 v160, v168
    v_lshlrev_b32 v220, 16, v156
    v_and_b32 v221, 0xffff0000, v156
    v_lshlrev_b32 v224, 16, v164
    v_and_b32 v225, 0xffff0000, v164
    v_lshlrev_b32 v222, 16, v160
    v_and_b32 v223, 0xffff0000, v160
    v_lshlrev_b32 v226, 16, v168
    v_and_b32 v227, 0xffff0000, v168
    v_permlane16_swap_b32 v148, v152
    v_lshlrev_b32 v216, 16, v148
    v_and_b32 v217, 0xffff0000, v148
    v_lshlrev_b32 v218, 16, v152
    v_and_b32 v219, 0xffff0000, v152
    v_pk_mul_f32 v[220:221], v[220:221], s[60:61]
    v_pk_mul_f32 v[224:225], v[224:225], s[60:61]
    v_pk_mul_f32 v[222:223], v[222:223], s[60:61]
    v_pk_mul_f32 v[226:227], v[226:227], s[60:61]
    v_pk_mul_f32 v[216:217], v[216:217], s[60:61]
    v_pk_mul_f32 v[218:219], v[218:219], s[60:61]
    v_cvt_pk_bf16_f32 v156, v220, v221
    v_cvt_pk_bf16_f32 v164, v224, v225
    v_cvt_pk_bf16_f32 v160, v222, v223
    v_cvt_pk_bf16_f32 v168, v226, v227
    v_cvt_pk_bf16_f32 v148, v216, v217
    v_cvt_pk_bf16_f32 v152, v218, v219
    v_lshlrev_b32 v218, 16, v152
    v_and_b32 v219, 0xffff0000, v152
    v_lshlrev_b32 v216, 16, v148
    v_and_b32 v217, 0xffff0000, v148
    v_lshlrev_b32 v226, 16, v168
    v_and_b32 v227, 0xffff0000, v168
    v_lshlrev_b32 v222, 16, v160
    v_and_b32 v223, 0xffff0000, v160
    v_lshlrev_b32 v224, 16, v164
    v_and_b32 v225, 0xffff0000, v164
    v_lshlrev_b32 v220, 16, v156
    v_and_b32 v221, 0xffff0000, v156
    ds_read_b32 v3, v2 offset:28
    v_max3_f32 v174, v216, v217, v218
    v_max3_f32 v172, v220, v221, v224
    v_max_f32 v174, v174, v219
    v_max3_f32 v172, v172, v225, v222
    v_mov_b32 v176, v174
    v_max3_f32 v172, v172, v223, v226
    v_max_f32 v172, v172, v227
    v_permlane32_swap_b32 v174, v176
    v_mul_f32 v172, s58, v172
    v_max_f32 v174, v174, v176
    v_mul_f32 v174, s58, v174
    v_pk_fma_f32 v[220:221], v[220:221], s[58:59], v[172:173] op_sel_hi:[1,1,0] neg_lo:[0,0,1] neg_hi:[0,0,1]
    v_pk_fma_f32 v[222:223], v[222:223], s[58:59], v[172:173] op_sel_hi:[1,1,0] neg_lo:[0,0,1] neg_hi:[0,0,1]
    v_pk_fma_f32 v[224:225], v[224:225], s[58:59], v[172:173] op_sel_hi:[1,1,0] neg_lo:[0,0,1] neg_hi:[0,0,1]
    v_pk_fma_f32 v[226:227], v[226:227], s[58:59], v[172:173] op_sel_hi:[1,1,0] neg_lo:[0,0,1] neg_hi:[0,0,1]
    v_pk_fma_f32 v[216:217], v[216:217], s[58:59], v[174:175] op_sel_hi:[1,1,0] neg_lo:[0,0,1] neg_hi:[0,0,1]
    v_pk_fma_f32 v[218:219], v[218:219], s[58:59], v[174:175] op_sel_hi:[1,1,0] neg_lo:[0,0,1] neg_hi:[0,0,1]
    v_exp_f32 v216, v216
    v_exp_f32 v217, v217
    v_exp_f32 v218, v218
    v_exp_f32 v219, v219
    v_exp_f32 v220, v220
    v_exp_f32 v221, v221
    v_exp_f32 v222, v222
    v_exp_f32 v223, v223
    v_exp_f32 v224, v224
    v_exp_f32 v225, v225
    v_exp_f32 v226, v226
    v_exp_f32 v227, v227
    v_pk_add_f32 v[174:175], v[216:217], v[218:219]
    v_pk_add_f32 v[172:173], v[220:221], v[222:223]
    v_add_f32 v174, v174, v175
    v_pk_add_f32 v[178:179], v[224:225], v[226:227]
    v_mov_b32 v176, v174
    v_pk_add_f32 v[172:173], v[172:173], v[178:179]
    v_add_f32 v172, v172, v173
    v_permlane32_swap_b32 v174, v176
    v_rcp_f32 v172, v172
    v_add_f32 v174, v174, v176
    v_rcp_f32 v174, v174
    v_pk_mul_f32 v[220:221], v[220:221], v[172:173] op_sel_hi:[1,0]
    v_pk_mul_f32 v[222:223], v[222:223], v[172:173] op_sel_hi:[1,0]
    v_pk_mul_f32 v[224:225], v[224:225], v[172:173] op_sel_hi:[1,0]
    v_pk_mul_f32 v[226:227], v[226:227], v[172:173] op_sel_hi:[1,0]
    v_pk_mul_f32 v[216:217], v[216:217], v[174:175] op_sel_hi:[1,0]
    v_pk_mul_f32 v[218:219], v[218:219], v[174:175] op_sel_hi:[1,0]
    s_waitcnt lgkmcnt(0)
    v_readfirstlane_b32 s33, v3
    s_cmp_lt_u32 s33, s62
    s_cbranch_scc1 K_PW
K_PR:
    v_cvt_pk_bf16_f32 v156, v220, v221
    v_cvt_pk_bf16_f32 v164, v224, v225
    v_cvt_pk_bf16_f32 v160, v222, v223
    v_cvt_pk_bf16_f32 v168, v226, v227
    v_cvt_pk_bf16_f32 v148, v216, v217
    v_cvt_pk_bf16_f32 v152, v218, v219
    v_permlane32_swap_b32 v156, v164
    v_permlane32_swap_b32 v160, v168
    v_permlane16_swap_b32 v148, v152
    s_waitcnt lgkmcnt(0)
    v_permlane16_swap_b32 v156, v160
    v_permlane16_swap_b32 v164, v168
    v_perm_b32 v56, v148, v148, v24
    v_perm_b32 v57, v148, v148, v25
    v_perm_b32 v58, v148, v148, v26
    v_perm_b32 v59, v148, v148, v27
    v_perm_b32 v72, v152, v152, v24
    v_perm_b32 v73, v152, v152, v25
    v_mfma_f32_16x16x32_bf16 v[64:67], v[228:231], v[56:59], 0
    v_perm_b32 v74, v152, v152, v26
    v_perm_b32 v75, v152, v152, v27
    v_mfma_f32_16x16x32_bf16 v[60:63], v[242:245], v[56:59], 0
    v_perm_b32 v88, v156, v156, v24
    v_perm_b32 v89, v156, v156, v25
    v_mfma_f32_16x16x32_bf16 v[80:83], v[230:233], v[72:75], 0
    v_perm_b32 v90, v156, v156, v26
    v_perm_b32 v91, v156, v156, v27
    v_mfma_f32_16x16x32_bf16 v[76:79], v[244:247], v[72:75], 0
    v_perm_b32 v104, v160, v160, v24
    v_perm_b32 v105, v160, v160, v25
    v_mfma_f32_16x16x32_bf16 v[96:99], v[232:235], v[88:91], 0
    v_perm_b32 v106, v160, v160, v26
    v_perm_b32 v107, v160, v160, v27
    v_mfma_f32_16x16x32_bf16 v[92:95], v[246:249], v[88:91], 0
    v_perm_b32 v120, v164, v164, v24
    v_perm_b32 v121, v164, v164, v25
    v_mfma_f32_16x16x32_bf16 v[112:115], v[234:237], v[104:107], 0
    v_perm_b32 v122, v164, v164, v26
    v_perm_b32 v123, v164, v164, v27
    v_mfma_f32_16x16x32_bf16 v[108:111], v[248:251], v[104:107], 0
    v_perm_b32 v136, v168, v168, v24
    v_perm_b32 v137, v168, v168, v25
    v_mfma_f32_16x16x32_bf16 v[128:131], v[236:239], v[120:123], 0
    v_perm_b32 v138, v168, v168, v26
    v_perm_b32 v139, v168, v168, v27
    v_mfma_f32_16x16x32_bf16 v[124:127], v[250:253], v[120:123], 0
    v_mov_b32 v3, 1
    v_mfma_f32_16x16x32_bf16 v[144:147], v[238:241], v[136:139], 0
    v_lshl_add_u32 v2, s54, 2, v38
    v_cvt_pk_bf16_f32 v68, v64, v65
    v_mfma_f32_16x16x32_bf16 v[140:143], v[252:255], v[136:139], 0
    v_cvt_pk_bf16_f32 v69, v66, v67
    s_mov_b32 exec_lo, 0xffff0000
    v_cvt_pk_bf16_f32 v68, v80, v81
    v_cvt_pk_bf16_f32 v69, v82, v83
    s_mov_b32 exec_lo, 0
    v_cvt_pk_bf16_f32 v68, v96, v97
    v_cvt_pk_bf16_f32 v69, v98, v99
    s_mov_b32 exec_hi, 0xffff0000
    v_cvt_pk_bf16_f32 v68, v112, v113
    v_cvt_pk_bf16_f32 v69, v114, v115
    s_mov_b64 exec, -1
    ds_write_b64 v35, v[68:69]
    v_cvt_pk_bf16_f32 v70, v128, v129
    v_cvt_pk_bf16_f32 v71, v130, v131
    s_mov_b32 exec_lo, 0xffff0000
    v_cvt_pk_bf16_f32 v70, v144, v145
    v_cvt_pk_bf16_f32 v71, v146, v147
    s_mov_b32 exec_lo, -1
    s_mov_b32 exec_hi, 0
    ds_write_b64 v35, v[70:71] offset:1024
    s_mov_b32 exec_lo, 1
    ds_add_u32 v2, v3 offset:48
    s_mov_b64 exec, -1
    v_cvt_pk_bf16_f32 v52, v60, v61
    v_cvt_pk_bf16_f32 v54, v76, v77
    v_cvt_pk_bf16_f32 v53, v62, v63
    v_cvt_pk_bf16_f32 v55, v78, v79
    v_cvt_pk_bf16_f32 v84, v92, v93
    v_permlane16_swap_b32 v52, v54
    v_permlane16_swap_b32 v53, v55
    v_min_u32 v52, -2, v52
    buffer_store_dwordx4 v[52:55], v28, s[20:23], 0 offen sc1
    v_cvt_pk_bf16_f32 v86, v108, v109
    v_cvt_pk_bf16_f32 v85, v94, v95
    v_cvt_pk_bf16_f32 v87, v110, v111
    v_cvt_pk_bf16_f32 v116, v124, v125
    v_permlane16_swap_b32 v84, v86
    v_permlane16_swap_b32 v85, v87
    v_min_u32 v84, -2, v84
    buffer_store_dwordx4 v[84:87], v29, s[20:23], 0 offen sc1
    v_cvt_pk_bf16_f32 v118, v140, v141
    v_cvt_pk_bf16_f32 v117, v126, v127
    v_cvt_pk_bf16_f32 v119, v142, v143
    ds_read_b32 v3, v2 offset:48
    ds_read_b128 v[196:199], v36
    v_permlane16_swap_b32 v116, v118
    v_permlane16_swap_b32 v117, v119
    v_min_u32 v116, -2, v116
    buffer_store_dwordx4 v[116:119], v30, s[20:23], 0 offen sc1
    s_waitcnt lgkmcnt(0)
    v_readfirstlane_b32 s33, v3
    s_cmp_lt_u32 s33, s63
    s_cbranch_scc1 K_TW
K_TR:
    v_min_u32 v196, -2, v196
    buffer_store_dwordx4 v[196:199], v31, s[20:23], 0 offen sc1
    s_cmp_eq_u32 s34, -1
    s_cbranch_scc1 K_END
    s_add_u32 s30, s30, 4
    s_branch K_P2_HELP
K_CHM3:
K_STM3:
    s_branch K_WRET_M
    s_nop 0
K_XW:
    s_mov_b32 s3, 1048576
K_CGX:
    ds_read_b32 v3, v2 offset:28
    s_sub_u32 s3, s3, 1
    s_waitcnt lgkmcnt(0)
    v_readfirstlane_b32 s33, v3
    s_cselect_b32 s33, 1811939328, s33
    s_cmp_lt_u32 s33, 1811939328
    s_cbranch_scc1 K_CGX
    ds_read_b64 v[144:145], v34
    ds_read_b64 v[146:147], v34 offset:512
    ds_read_b64 v[242:243], v34 offset:1024
    ds_read_b64_tr_b16 v[228:229], v33
    s_waitcnt lgkmcnt(0)
    s_branch K_XR
K_PW:
    s_cmp_ge_u32 s33, 1811939332
    s_cbranch_scc1 K_PW2
    s_mov_b32 s3, 1048576
K_CGP:
    ds_read_b32 v3, v2 offset:28
    s_sub_u32 s3, s3, 1
    s_waitcnt lgkmcnt(0)
    v_readfirstlane_b32 s33, v3
    s_cselect_b32 s33, 1811939332, s33
    s_cmp_lt_u32 s33, 1811939332
    s_cbranch_scc1 K_CGP
K_PW2:
    s_cmp_lg_u32 s62, -1
    s_cbranch_scc1 K_PR
    v_mov_b32 v4, s36
    s_mov_b32 exec_lo, s37
    s_mov_b32 exec_hi, 0
    global_atomic_add v37, v4, s[6:7] sc1
    s_mov_b64 exec, -1
    s_branch K_PR
K_TW:
    s_cmp_lg_u32 s63, -1
    s_cbranch_scc1 K_TW2
    v_mov_b32 v4, s36
    s_mov_b32 exec_lo, s37
    s_mov_b32 exec_hi, 0
    global_atomic_add v37, v4, s[6:7] sc1
    s_mov_b64 exec, -1
    s_cmp_ge_u32 s33, 2
    s_cbranch_scc1 K_TR
K_TW2:
    s_mov_b32 s3, 1048576
K_CGT:
    ds_read_b32 v3, v2 offset:48
    s_sub_u32 s3, s3, 1
    s_waitcnt lgkmcnt(0)
    v_readfirstlane_b32 s33, v3
    s_cselect_b32 s33, 2, s33
    s_cmp_lt_u32 s33, 2
    s_cbranch_scc1 K_CGT
    ds_read_b128 v[196:199], v36
    s_waitcnt lgkmcnt(0)
    s_branch K_TR
K_P2_EARLY:
    s_lshl_b32 s62, s40, 7
    v_lshrrev_b32 v8, 3, v1
    v_lshrrev_b32 v9, 4, v1
    v_mov_b32 v15, 158720
    s_lshl_b32 s61, s40, 3
    s_add_u32 s61, s61, s30
    s_mul_i32 s3, s61, 20480
    s_lshl_b32 s33, s41, 7
    s_add_u32 s3, s3, s33
    v_and_b32 v2, 7, v1
    v_lshlrev_b32 v2, 4, v2
    v_mul_u32_u24 v4, 1280, v8
    v_add3_u32 v10, v2, v4, s3
    s_lshl_b32 s3, s30, 7
    s_add_u32 s3, s3, 159744
    v_lshl_add_u32 v11, v8, 3, s3
    s_mov_b32 s63, 10240
    s_add_u32 s20, s6, 0x100000
    s_addc_u32 s21, s7, 0
    s_mov_b32 s22, 0x280000
    s_mov_b32 s23, 0x20000
    s_mov_b32 s56, s10
    s_mov_b32 s57, s11
    s_mov_b32 s58, 0x280000
    s_mov_b32 s59, 0x20000
    v_mul_u32_u24 v3, 144, v8
    v_add_u32 v3, v2, v3
    s_mul_i32 s3, s30, 2304
    s_add_u32 s3, s3, 140288
    v_add_u32 v14, s3, v3
    buffer_load_dwordx4 v[16:19], v10, s[12:15], 0 offen
    buffer_load_dwordx4 v[20:23], v10, s[12:15], s63 offen
    v_bfe_u32 v48, v1, 2, 2
    v_and_b32 v49, 3, v1
    s_add_u32 s3, s61, s30
    s_lshr_b32 s33, s3, 2
    s_mul_i32 s33, s33, 76
    s_add_u32 s3, s3, s33
    s_lshl_b32 s3, s3, 10
    v_and_b32 v2, 15, v1
    v_lshl_add_u32 v2, v2, 4, s3
    v_lshrrev_b32 v3, 5, v1
    v_lshl_add_u32 v2, v3, 8, v2
    v_and_b32 v4, 1, v9
    v_lshl_add_u32 v52, v4, 10, v2
    v_mov_b32 v53, 0x1f000
    v_lshl_add_u32 v2, v3, 3, v48
    v_lshlrev_b32 v2, 7, v2
    s_branch K_PG3
.p2align 12
K_CHA0:
K_STA4:
    s_branch K_STA8
K_CHB0:
K_STB4:
    s_branch K_STB8
K_PG3:
    v_lshl_add_u32 v2, v49, 3, v2
    v_lshl_add_u32 v2, v4, 5, v2
    v_lshrrev_b32 v4, 1, v48
    v_lshl_add_u32 v54, v4, 6, v2
    v_xor_b32 v55, 64, v54
    v_mov_b32 v56, v54
    v_mov_b32 v57, v54
    v_and_b32 v2, 31, v1
    v_mul_u32_u24 v2, 144, v2
    v_lshl_add_u32 v2, v3, 3, v2
    s_mul_i32 s3, s30, 4608
    s_add_u32 s3, s3, 140288
    v_add_u32 v50, s3, v2
    s_and_b32 s33, s40, 3
    s_lshl_b32 s33, s33, 2
    s_lshr_b32 s33, 0xf63f, s33
    s_and_b32 s33, s33, 15
    s_lshl1_add_u32 s3, s30, 1
    s_cmp_ge_u32 s3, s33
    s_cselect_b32 s60, 24, 16
    s_cmp_gt_u32 s3, s33
    s_cselect_b32 s60, 20, s60
    v_add_u32 v58, s60, v15
    s_mov_b32 s64, -1
    s_mov_b32 s65, -1
    s_mov_b32 s66, -1
    s_mov_b32 s67, -1
    s_mov_b32 s68, -1
    s_mov_b32 s69, -1
    s_mov_b32 s70, 0xfffff
    s_mov_b32 s71, 131072
    v_mov_b32 v108, 0
    v_mov_b32 v109, 0
    v_mov_b32 v110, 0
    v_mov_b32 v111, 0
    v_mov_b32 v112, 0
    v_mov_b32 v113, 0
    v_mov_b32 v114, 0
    v_mov_b32 v115, 0
    v_mov_b32 v116, 0
    v_mov_b32 v117, 0
    v_mov_b32 v118, 0
    v_mov_b32 v119, 0
    v_mov_b32 v120, 0
    v_mov_b32 v121, 0
    v_mov_b32 v122, 0
    v_mov_b32 v123, 0
    v_mov_b32 v124, 0
    v_mov_b32 v125, 0
    v_mov_b32 v126, 0
    v_mov_b32 v127, 0
    v_mov_b32 v128, 0
    v_mov_b32 v129, 0
    v_mov_b32 v130, 0
    v_mov_b32 v131, 0
    v_mov_b32 v132, 0
    v_mov_b32 v133, 0
    v_mov_b32 v134, 0
    v_mov_b32 v135, 0
    v_mov_b32 v136, 0
    v_mov_b32 v137, 0
    v_mov_b32 v138, 0
    v_mov_b32 v139, 0
    s_barrier
    s_branch K_P2_AUXW
K_P2_GM:
    s_lshl_b32 s62, s40, 7
    v_lshrrev_b32 v8, 3, v1
    v_lshrrev_b32 v9, 4, v1
    v_mov_b32 v15, 158720
    s_lshl_b32 s61, s40, 3
    s_add_u32 s61, s61, s30
    s_mul_i32 s3, s61, 20480
    s_lshl_b32 s33, s41, 7
    s_add_u32 s3, s3, s33
    v_and_b32 v2, 7, v1
    v_lshlrev_b32 v2, 4, v2
    v_mul_u32_u24 v4, 1280, v8
    v_add3_u32 v10, v2, v4, s3
    s_lshl_b32 s3, s30, 7
    s_add_u32 s3, s3, 159744
    v_lshl_add_u32 v11, v8, 3, s3
    s_mov_b32 s63, 10240
    s_add_u32 s20, s6, 0x100000
    s_addc_u32 s21, s7, 0
    s_mov_b32 s22, 0x280000
    s_mov_b32 s23, 0x20000
    s_mov_b32 s56, s10
    s_mov_b32 s57, s11
    s_mov_b32 s58, 0x280000
    s_mov_b32 s59, 0x20000
    v_mul_u32_u24 v3, 144, v8
    v_add_u32 v3, v2, v3
    s_mul_i32 s3, s30, 2304
    s_add_u32 s3, s3, 140288
    v_add_u32 v14, s3, v3
    v_bfe_u32 v48, v1, 2, 2
    v_and_b32 v49, 3, v1
    s_add_u32 s3, s61, s30
    s_lshr_b32 s33, s3, 2
    s_mul_i32 s33, s33, 76
    s_add_u32 s3, s3, s33
    s_lshl_b32 s3, s3, 10
    v_and_b32 v2, 15, v1
    v_lshl_add_u32 v2, v2, 4, s3
    v_lshrrev_b32 v3, 5, v1
    v_lshl_add_u32 v2, v3, 8, v2
    v_and_b32 v4, 1, v9
    v_lshl_add_u32 v52, v4, 10, v2
    v_mov_b32 v53, 0x1f000
    v_lshl_add_u32 v2, v3, 3, v48
    v_lshlrev_b32 v2, 7, v2
    v_lshl_add_u32 v2, v49, 3, v2
    v_lshl_add_u32 v2, v4, 5, v2
    v_lshrrev_b32 v4, 1, v48
    v_lshl_add_u32 v54, v4, 6, v2
    v_xor_b32 v55, 64, v54
    v_mov_b32 v56, v54
    v_mov_b32 v57, v54
    v_and_b32 v2, 31, v1
    v_mul_u32_u24 v2, 144, v2
    v_lshl_add_u32 v2, v3, 3, v2
    s_mul_i32 s3, s30, 4608
    s_add_u32 s3, s3, 140288
    v_add_u32 v50, s3, v2
    s_and_b32 s33, s40, 3
    s_lshl_b32 s33, s33, 2
    s_lshr_b32 s33, 0xf63f, s33
    s_and_b32 s33, s33, 15
    s_lshl1_add_u32 s3, s30, 1
    s_cmp_ge_u32 s3, s33
    s_cselect_b32 s60, 24, 16
    s_cmp_gt_u32 s3, s33
    s_cselect_b32 s60, 20, s60
    v_add_u32 v58, s60, v15
    s_mov_b32 s64, -1
    s_mov_b32 s65, -1
    s_mov_b32 s66, -1
    s_mov_b32 s67, -1
    s_mov_b32 s68, -1
    s_mov_b32 s69, -1
    s_mov_b32 s70, 0xfffff
    s_mov_b32 s71, 131072
    v_mov_b32 v108, 0
    v_mov_b32 v109, 0
    v_mov_b32 v110, 0
    v_mov_b32 v111, 0
    v_mov_b32 v112, 0
    v_mov_b32 v113, 0
    v_mov_b32 v114, 0
    v_mov_b32 v115, 0
    v_mov_b32 v116, 0
    v_mov_b32 v117, 0
    v_mov_b32 v118, 0
    v_mov_b32 v119, 0
    v_mov_b32 v120, 0
    v_mov_b32 v121, 0
    v_mov_b32 v122, 0
    v_mov_b32 v123, 0
    v_mov_b32 v124, 0
    v_mov_b32 v125, 0
    v_mov_b32 v126, 0
    v_mov_b32 v127, 0
    v_mov_b32 v128, 0
    v_mov_b32 v129, 0
    v_mov_b32 v130, 0
    v_mov_b32 v131, 0
    v_mov_b32 v132, 0
    v_mov_b32 v133, 0
    v_mov_b32 v134, 0
    v_mov_b32 v135, 0
    v_mov_b32 v136, 0
    v_mov_b32 v137, 0
    v_mov_b32 v138, 0
    v_mov_b32 v139, 0
    buffer_load_dwordx4 v[16:19], v10, s[12:15], 0 offen
    buffer_load_dwordx4 v[20:23], v10, s[12:15], s63 offen
    s_cmp_eq_u32 s30, 0
    s_cbranch_scc1 K_CHB0
    s_cmp_eq_u32 s30, 1
    s_cbranch_scc1 K_CHB1
    s_cmp_eq_u32 s30, 2
    s_cbranch_scc1 K_CHB2
    s_branch K_CHB3
K_WRET_B:
    v_mov_b32 v3, 1
    s_waitcnt vmcnt(2)
    s_mov_b64 exec, 1
    ds_add_u32 v15, v3 offset:44
    s_mov_b64 exec, -1
    s_mov_b32 s3, 1048576
K_P2_GWM:
    ds_read_b32 v2, v15 offset:44
    s_sleep 1
    s_sub_u32 s3, s3, 1
    s_waitcnt lgkmcnt(0)
    v_readfirstlane_b32 s33, v2
    s_nop 3
    s_cselect_b32 s33, 4, s33
    s_cmp_lt_u32 s33, 4
    s_cbranch_scc1 K_P2_GWM
    ds_write_b32 v15, v15 offset:56
K_P2_GEMM:
    s_setprio 1
    s_add_u32 s53, s40, 1
    s_and_b32 s53, s53, 2
    s_mov_b32 s46, 0x84210
    s_mov_b32 s47, s46
    s_waitcnt vmcnt(0)
    v_lshlrev_b32 v32, 16, v16
    v_and_b32 v33, 0xffff0000, v16
    v_lshlrev_b32 v34, 16, v17
    v_and_b32 v35, 0xffff0000, v17
    v_lshlrev_b32 v36, 16, v18
    v_and_b32 v37, 0xffff0000, v18
    v_lshlrev_b32 v38, 16, v19
    v_and_b32 v39, 0xffff0000, v19
    v_lshlrev_b32 v40, 16, v20
    v_and_b32 v41, 0xffff0000, v20
    v_lshlrev_b32 v42, 16, v21
    v_and_b32 v43, 0xffff0000, v21
    v_lshlrev_b32 v44, 16, v22
    v_and_b32 v45, 0xffff0000, v22
    v_lshlrev_b32 v46, 16, v23
    v_and_b32 v47, 0xffff0000, v23
    s_branch K_SPL
    s_nop 0
K_IT0:
    v_mfma_f32_32x32x16_bf16 v[108:123], v[156:159], v[68:71], v[108:123]
    ds_read_b64_tr_b16 v[140:141], v56 offset:0
    ds_read_b64_tr_b16 v[142:143], v56 offset:512
    s_and_b32 s33, s50, s70
    s_cbranch_scc0 K_RF0
K_RB0:
    s_ff1_i32_b32 s51, s33
    v_mfma_f32_32x32x16_bf16 v[124:139], v[164:167], v[68:71], v[124:139]
    s_bitset0_b32 s70, s51
    s_lshl_b32 s64, s51, 12
    buffer_load_dwordx4 v[60:63], v52, s[20:23], s64 offen offset:0 sc1
    ds_read_b64_tr_b16 v[144:145], v56 offset:2048
    ds_read_b64_tr_b16 v[146:147], v56 offset:2560
    v_mfma_f32_32x32x16_bf16 v[108:123], v[160:163], v[72:75], v[108:123]
    buffer_load_dwordx4 v[64:67], v52, s[20:23], s64 offen offset:512 sc1
    ds_read_b64_tr_b16 v[148:149], v57 offset:0
    ds_read_b64_tr_b16 v[150:151], v57 offset:512
    s_waitcnt vmcnt(8) lgkmcnt(6)
    v_cmp_u_f32 vcc, v76, v80
    v_mfma_f32_32x32x16_bf16 v[124:139], v[168:171], v[72:75], v[124:139]
    ds_read_b64_tr_b16 v[152:153], v57 offset:2048
    ds_read_b64_tr_b16 v[154:155], v57 offset:2560
    v_and_or_b32 v56, s68, v53, v54
    v_and_or_b32 v57, s68, v53, v55
    s_cbranch_vccnz K_FX1
K_IT1:
    v_mfma_f32_32x32x16_bf16 v[108:123], v[172:175], v[76:79], v[108:123]
    ds_read_b64_tr_b16 v[156:157], v56 offset:0
    ds_read_b64_tr_b16 v[158:159], v56 offset:512
    s_and_b32 s33, s50, s70
    s_cbranch_scc0 K_RF1
K_RB1:
    s_ff1_i32_b32 s51, s33
    v_mfma_f32_32x32x16_bf16 v[124:139], v[180:183], v[76:79], v[124:139]
    s_bitset0_b32 s70, s51
    s_lshl_b32 s65, s51, 12
    buffer_load_dwordx4 v[68:71], v52, s[20:23], s65 offen offset:0 sc1
    ds_read_b64_tr_b16 v[160:161], v56 offset:2048
    ds_read_b64_tr_b16 v[162:163], v56 offset:2560
    v_mfma_f32_32x32x16_bf16 v[108:123], v[176:179], v[80:83], v[108:123]
    buffer_load_dwordx4 v[72:75], v52, s[20:23], s65 offen offset:512 sc1
    ds_read_b64_tr_b16 v[164:165], v57 offset:0
    ds_read_b64_tr_b16 v[166:167], v57 offset:512
    s_waitcnt vmcnt(8) lgkmcnt(6)
    v_cmp_u_f32 vcc, v84, v88
    v_mfma_f32_32x32x16_bf16 v[124:139], v[184:187], v[80:83], v[124:139]
    ds_read_b64_tr_b16 v[168:169], v57 offset:2048
    ds_read_b64_tr_b16 v[170:171], v57 offset:2560
    v_and_or_b32 v56, s69, v53, v54
    v_and_or_b32 v57, s69, v53, v55
    s_cbranch_vccnz K_FX2
K_IT2:
    v_mfma_f32_32x32x16_bf16 v[108:123], v[140:143], v[84:87], v[108:123]
    ds_read_b64_tr_b16 v[172:173], v56 offset:0
    ds_read_b64_tr_b16 v[174:175], v56 offset:512
    s_and_b32 s33, s50, s70
    s_cbranch_scc0 K_RF2
K_RB2:
    s_ff1_i32_b32 s51, s33
    v_mfma_f32_32x32x16_bf16 v[124:139], v[148:151], v[84:87], v[124:139]
    s_bitset0_b32 s70, s51
    s_lshl_b32 s66, s51, 12
    buffer_load_dwordx4 v[76:79], v52, s[20:23], s66 offen offset:0 sc1
    ds_read_b64_tr_b16 v[176:177], v56 offset:2048
    ds_read_b64_tr_b16 v[178:179], v56 offset:2560
    v_mfma_f32_32x32x16_bf16 v[108:123], v[144:147], v[88:91], v[108:123]
    buffer_load_dwordx4 v[80:83], v52, s[20:23], s66 offen offset:512 sc1
    ds_read_b64_tr_b16 v[180:181], v57 offset:0
    ds_read_b64_tr_b16 v[182:183], v57 offset:512
    s_waitcnt vmcnt(8) lgkmcnt(6)
    v_cmp_u_f32 vcc, v92, v96
    v_mfma_f32_32x32x16_bf16 v[124:139], v[152:155], v[88:91], v[124:139]
    ds_read_b64_tr_b16 v[184:185], v57 offset:2048
    ds_read_b64_tr_b16 v[186:187], v57 offset:2560
    v_and_or_b32 v56, s64, v53, v54
    v_and_or_b32 v57, s64, v53, v55
    s_cbranch_vccnz K_FX3
K_IT3:
    v_mfma_f32_32x32x16_bf16 v[108:123], v[156:159], v[92:95], v[108:123]
    ds_read_b64_tr_b16 v[140:141], v56 offset:0
    ds_read_b64_tr_b16 v[142:143], v56 offset:512
    s_and_b32 s33, s50, s70
    s_cbranch_scc0 K_RF3
K_RB3:
    s_ff1_i32_b32 s51, s33
    v_mfma_f32_32x32x16_bf16 v[124:139], v[164:167], v[92:95], v[124:139]
    s_bitset0_b32 s70, s51
    s_lshl_b32 s67, s51, 12
    buffer_load_dwordx4 v[84:87], v52, s[20:23], s67 offen offset:0 sc1
    ds_read_b64_tr_b16 v[144:145], v56 offset:2048
    ds_read_b64_tr_b16 v[146:147], v56 offset:2560
    v_mfma_f32_32x32x16_bf16 v[108:123], v[160:163], v[96:99], v[108:123]
    buffer_load_dwordx4 v[88:91], v52, s[20:23], s67 offen offset:512 sc1
    ds_read_b64_tr_b16 v[148:149], v57 offset:0
    ds_read_b64_tr_b16 v[150:151], v57 offset:512
    s_waitcnt vmcnt(8) lgkmcnt(6)
    v_cmp_u_f32 vcc, v100, v104
    v_mfma_f32_32x32x16_bf16 v[124:139], v[168:171], v[96:99], v[124:139]
    ds_read_b64_tr_b16 v[152:153], v57 offset:2048
    ds_read_b64_tr_b16 v[154:155], v57 offset:2560
    v_and_or_b32 v56, s65, v53, v54
    v_and_or_b32 v57, s65, v53, v55
    s_cbranch_vccnz K_FX4
K_IT4:
    v_mfma_f32_32x32x16_bf16 v[108:123], v[172:175], v[100:103], v[108:123]
    ds_read_b64_tr_b16 v[156:157], v56 offset:0
    ds_read_b64_tr_b16 v[158:159], v56 offset:512
    s_and_b32 s33, s50, s70
    s_cbranch_scc0 K_RF4
K_RB4:
    s_ff1_i32_b32 s51, s33
    v_mfma_f32_32x32x16_bf16 v[124:139], v[180:183], v[100:103], v[124:139]
    s_bitset0_b32 s70, s51
    s_lshl_b32 s68, s51, 12
    buffer_load_dwordx4 v[92:95], v52, s[20:23], s68 offen offset:0 sc1
    ds_read_b64_tr_b16 v[160:161], v56 offset:2048
    ds_read_b64_tr_b16 v[162:163], v56 offset:2560
    v_mfma_f32_32x32x16_bf16 v[108:123], v[176:179], v[104:107], v[108:123]
    buffer_load_dwordx4 v[96:99], v52, s[20:23], s68 offen offset:512 sc1
    ds_read_b64_tr_b16 v[164:165], v57 offset:0
    ds_read_b64_tr_b16 v[166:167], v57 offset:512
    s_waitcnt vmcnt(8) lgkmcnt(6)
    v_cmp_u_f32 vcc, v60, v64
    v_mfma_f32_32x32x16_bf16 v[124:139], v[184:187], v[104:107], v[124:139]
    ds_read_b64_tr_b16 v[168:169], v57 offset:2048
    ds_read_b64_tr_b16 v[170:171], v57 offset:2560
    v_and_or_b32 v56, s66, v53, v54
    v_and_or_b32 v57, s66, v53, v55
    s_cbranch_vccnz K_FX5
K_IT5:
    v_mfma_f32_32x32x16_bf16 v[108:123], v[140:143], v[60:63], v[108:123]
    ds_read_b64_tr_b16 v[172:173], v56 offset:0
    ds_read_b64_tr_b16 v[174:175], v56 offset:512
    s_and_b32 s33, s50, s70
    s_cbranch_scc0 K_RF5
K_RB5:
    s_ff1_i32_b32 s51, s33
    v_mfma_f32_32x32x16_bf16 v[124:139], v[148:151], v[60:63], v[124:139]
    s_bitset0_b32 s70, s51
    s_lshl_b32 s69, s51, 12
    buffer_load_dwordx4 v[100:103], v52, s[20:23], s69 offen offset:0 sc1
    ds_read_b64_tr_b16 v[176:177], v56 offset:2048
    ds_read_b64_tr_b16 v[178:179], v56 offset:2560
    v_mfma_f32_32x32x16_bf16 v[108:123], v[144:147], v[64:67], v[108:123]
    buffer_load_dwordx4 v[104:107], v52, s[20:23], s69 offen offset:512 sc1
    ds_read_b64_tr_b16 v[180:181], v57 offset:0
    ds_read_b64_tr_b16 v[182:183], v57 offset:512
    s_waitcnt vmcnt(8) lgkmcnt(6)
    v_cmp_u_f32 vcc, v68, v72
    v_mfma_f32_32x32x16_bf16 v[124:139], v[152:155], v[64:67], v[124:139]
    ds_read_b64_tr_b16 v[184:185], v57 offset:2048
    ds_read_b64_tr_b16 v[186:187], v57 offset:2560
    v_and_or_b32 v56, s67, v53, v54
    v_and_or_b32 v57, s67, v53, v55
    s_cbranch_vccnz K_FX0
    s_branch K_IT0
    s_nop 0
K_DR0:
    v_mfma_f32_32x32x16_bf16 v[108:123], v[156:159], v[68:71], v[108:123]
    ds_read_b64_tr_b16 v[140:141], v56 offset:0
    ds_read_b64_tr_b16 v[142:143], v56 offset:512
K_DM0:
    s_mov_b32 s64, -1
    v_mov_b32 v60, -1
    v_mfma_f32_32x32x16_bf16 v[124:139], v[164:167], v[68:71], v[124:139]
    buffer_load_dword v3, v52, s[20:23], s64 offen
    ds_read_b64_tr_b16 v[144:145], v56 offset:2048
    ds_read_b64_tr_b16 v[146:147], v56 offset:2560
    v_mfma_f32_32x32x16_bf16 v[108:123], v[160:163], v[72:75], v[108:123]
    buffer_load_dword v3, v52, s[20:23], s64 offen
    ds_read_b64_tr_b16 v[148:149], v57 offset:0
    ds_read_b64_tr_b16 v[150:151], v57 offset:512
    s_waitcnt vmcnt(8) lgkmcnt(6)
    v_cmp_u_f32 vcc, v76, v80
    v_mfma_f32_32x32x16_bf16 v[124:139], v[168:171], v[72:75], v[124:139]
    ds_read_b64_tr_b16 v[152:153], v57 offset:2048
    ds_read_b64_tr_b16 v[154:155], v57 offset:2560
    v_and_or_b32 v56, s68, v53, v54
    v_and_or_b32 v57, s68, v53, v55
    s_cbranch_vccnz K_DX1
K_DR1:
    v_mfma_f32_32x32x16_bf16 v[108:123], v[172:175], v[76:79], v[108:123]
    ds_read_b64_tr_b16 v[156:157], v56 offset:0
    ds_read_b64_tr_b16 v[158:159], v56 offset:512
K_DM1:
    s_mov_b32 s65, -1
    v_mov_b32 v68, -1
    v_mfma_f32_32x32x16_bf16 v[124:139], v[180:183], v[76:79], v[124:139]
    buffer_load_dword v3, v52, s[20:23], s65 offen
    ds_read_b64_tr_b16 v[160:161], v56 offset:2048
    ds_read_b64_tr_b16 v[162:163], v56 offset:2560
    v_mfma_f32_32x32x16_bf16 v[108:123], v[176:179], v[80:83], v[108:123]
    buffer_load_dword v3, v52, s[20:23], s65 offen
    ds_read_b64_tr_b16 v[164:165], v57 offset:0
    ds_read_b64_tr_b16 v[166:167], v57 offset:512
    s_waitcnt vmcnt(8) lgkmcnt(6)
    v_cmp_u_f32 vcc, v84, v88
    v_mfma_f32_32x32x16_bf16 v[124:139], v[184:187], v[80:83], v[124:139]
    ds_read_b64_tr_b16 v[168:169], v57 offset:2048
    ds_read_b64_tr_b16 v[170:171], v57 offset:2560
    v_and_or_b32 v56, s69, v53, v54
    v_and_or_b32 v57, s69, v53, v55
    s_cbranch_vccnz K_DX2
K_DR2:
    v_mfma_f32_32x32x16_bf16 v[108:123], v[140:143], v[84:87], v[108:123]
    ds_read_b64_tr_b16 v[172:173], v56 offset:0
    ds_read_b64_tr_b16 v[174:175], v56 offset:512
K_DM2:
    s_mov_b32 s66, -1
    v_mov_b32 v76, -1
    v_mfma_f32_32x32x16_bf16 v[124:139], v[148:151], v[84:87], v[124:139]
    buffer_load_dword v3, v52, s[20:23], s66 offen
    ds_read_b64_tr_b16 v[176:177], v56 offset:2048
    ds_read_b64_tr_b16 v[178:179], v56 offset:2560
    v_mfma_f32_32x32x16_bf16 v[108:123], v[144:147], v[88:91], v[108:123]
    buffer_load_dword v3, v52, s[20:23], s66 offen
    ds_read_b64_tr_b16 v[180:181], v57 offset:0
    ds_read_b64_tr_b16 v[182:183], v57 offset:512
    s_waitcnt vmcnt(8) lgkmcnt(6)
    v_cmp_u_f32 vcc, v92, v96
    v_mfma_f32_32x32x16_bf16 v[124:139], v[152:155], v[88:91], v[124:139]
    ds_read_b64_tr_b16 v[184:185], v57 offset:2048
    ds_read_b64_tr_b16 v[186:187], v57 offset:2560
    v_and_or_b32 v56, s64, v53, v54
    v_and_or_b32 v57, s64, v53, v55
    s_cbranch_vccnz K_DX3
K_DR3:
    v_mfma_f32_32x32x16_bf16 v[108:123], v[156:159], v[92:95], v[108:123]
    ds_read_b64_tr_b16 v[140:141], v56 offset:0
    ds_read_b64_tr_b16 v[142:143], v56 offset:512
K_DM3:
    s_mov_b32 s67, -1
    v_mov_b32 v84, -1
    v_mfma_f32_32x32x16_bf16 v[124:139], v[164:167], v[92:95], v[124:139]
    buffer_load_dword v3, v52, s[20:23], s67 offen
    ds_read_b64_tr_b16 v[144:145], v56 offset:2048
    ds_read_b64_tr_b16 v[146:147], v56 offset:2560
    v_mfma_f32_32x32x16_bf16 v[108:123], v[160:163], v[96:99], v[108:123]
    buffer_load_dword v3, v52, s[20:23], s67 offen
    ds_read_b64_tr_b16 v[148:149], v57 offset:0
    ds_read_b64_tr_b16 v[150:151], v57 offset:512
    s_waitcnt vmcnt(8) lgkmcnt(6)
    v_cmp_u_f32 vcc, v100, v104
    v_mfma_f32_32x32x16_bf16 v[124:139], v[168:171], v[96:99], v[124:139]
    ds_read_b64_tr_b16 v[152:153], v57 offset:2048
    ds_read_b64_tr_b16 v[154:155], v57 offset:2560
    v_and_or_b32 v56, s65, v53, v54
    v_and_or_b32 v57, s65, v53, v55
    s_cbranch_vccnz K_DX4
K_DR4:
    v_mfma_f32_32x32x16_bf16 v[108:123], v[172:175], v[100:103], v[108:123]
    ds_read_b64_tr_b16 v[156:157], v56 offset:0
    ds_read_b64_tr_b16 v[158:159], v56 offset:512
K_DM4:
    s_mov_b32 s68, -1
    v_mov_b32 v92, -1
    v_mfma_f32_32x32x16_bf16 v[124:139], v[180:183], v[100:103], v[124:139]
    buffer_load_dword v3, v52, s[20:23], s68 offen
    ds_read_b64_tr_b16 v[160:161], v56 offset:2048
    ds_read_b64_tr_b16 v[162:163], v56 offset:2560
    v_mfma_f32_32x32x16_bf16 v[108:123], v[176:179], v[104:107], v[108:123]
    buffer_load_dword v3, v52, s[20:23], s68 offen
    ds_read_b64_tr_b16 v[164:165], v57 offset:0
    ds_read_b64_tr_b16 v[166:167], v57 offset:512
    s_waitcnt vmcnt(8) lgkmcnt(6)
    v_cmp_u_f32 vcc, v60, v64
    v_mfma_f32_32x32x16_bf16 v[124:139], v[184:187], v[104:107], v[124:139]
    ds_read_b64_tr_b16 v[168:169], v57 offset:2048
    ds_read_b64_tr_b16 v[170:171], v57 offset:2560
    v_and_or_b32 v56, s66, v53, v54
    v_and_or_b32 v57, s66, v53, v55
    s_cbranch_vccnz K_DX5
K_DR5:
    v_mfma_f32_32x32x16_bf16 v[108:123], v[140:143], v[60:63], v[108:123]
    ds_read_b64_tr_b16 v[172:173], v56 offset:0
    ds_read_b64_tr_b16 v[174:175], v56 offset:512
K_DM5:
    s_mov_b32 s69, -1
    v_mov_b32 v100, -1
    v_mfma_f32_32x32x16_bf16 v[124:139], v[148:151], v[60:63], v[124:139]
    buffer_load_dword v3, v52, s[20:23], s69 offen
    ds_read_b64_tr_b16 v[176:177], v56 offset:2048
    ds_read_b64_tr_b16 v[178:179], v56 offset:2560
    v_mfma_f32_32x32x16_bf16 v[108:123], v[144:147], v[64:67], v[108:123]
    buffer_load_dword v3, v52, s[20:23], s69 offen
    ds_read_b64_tr_b16 v[180:181], v57 offset:0
    ds_read_b64_tr_b16 v[182:183], v57 offset:512
    s_waitcnt vmcnt(8) lgkmcnt(6)
    v_cmp_u_f32 vcc, v68, v72
    v_mfma_f32_32x32x16_bf16 v[124:139], v[152:155], v[64:67], v[124:139]
    ds_read_b64_tr_b16 v[184:185], v57 offset:2048
    ds_read_b64_tr_b16 v[186:187], v57 offset:2560
    v_and_or_b32 v56, s67, v53, v54
    v_and_or_b32 v57, s67, v53, v55
    s_cbranch_vccnz K_DX0
    s_branch K_DR0
K_CHA1:
K_STA5:
    s_branch K_STA9
K_CHB1:
K_STB5:
    s_branch K_STB9
K_RF0:
    s_cmp_eq_u32 s70, 0
    s_cbranch_scc1 K_DM0
    ds_read_b32 v59, v58
    s_waitcnt lgkmcnt(0)
    v_readfirstlane_b32 s50, v59
    s_and_b32 s33, s50, s70
    s_cbranch_scc1 K_RB0
    v_mfma_f32_32x32x16_bf16 v[124:139], v[164:167], v[68:71], v[124:139]
    s_mov_b32 s64, -1
    v_mov_b32 v60, -1
    buffer_load_dword v3, v52, s[20:23], s64 offen
    ds_read_b64_tr_b16 v[144:145], v56 offset:2048
    ds_read_b64_tr_b16 v[146:147], v56 offset:2560
    v_mfma_f32_32x32x16_bf16 v[108:123], v[160:163], v[72:75], v[108:123]
    buffer_load_dword v3, v52, s[20:23], s64 offen
    ds_read_b64_tr_b16 v[148:149], v57 offset:0
    ds_read_b64_tr_b16 v[150:151], v57 offset:512
    s_waitcnt vmcnt(8) lgkmcnt(6)
    v_cmp_u_f32 vcc, v76, v80
    v_mfma_f32_32x32x16_bf16 v[124:139], v[168:171], v[72:75], v[124:139]
    ds_read_b64_tr_b16 v[152:153], v57 offset:2048
    ds_read_b64_tr_b16 v[154:155], v57 offset:2560
    v_and_or_b32 v56, s68, v53, v54
    v_and_or_b32 v57, s68, v53, v55
    s_cbranch_vccz K_IT1
    s_branch K_FX1
K_TL0:
    s_waitcnt vmcnt(8) lgkmcnt(8)
    v_cmp_u_f32 vcc, v76, v80
    v_and_or_b32 v56, s68, v53, v54
    v_and_or_b32 v57, s68, v53, v55
    s_cbranch_vccz K_IT1
    s_branch K_FX1
K_DX0:
    s_and_b32 s51, s65, s66
    s_and_b32 s51, s51, s67
    s_and_b32 s51, s51, s68
    s_cmp_lt_i32 s51, 0
    s_cbranch_scc1 K_P2_MM
K_FX0:
    s_cmp_lt_i32 s65, 0
    s_cbranch_scc1 K_SK0
    v_max_u32 v2, v68, v72
    v_cmp_eq_u32 vcc, -1, v2
    s_cbranch_vccz K_IT0
    s_sub_u32 s71, s71, 1
    s_cbranch_scc1 K_IT0
    s_lshr_b32 s51, s65, 12
    s_bitset1_b32 s70, s51
K_SK0:
    s_and_b32 s33, s50, s70
    s_cbranch_scc0 K_NUL0
K_BK0:
    s_ff1_i32_b32 s51, s33
    s_lshl_b32 s64, s51, 12
    buffer_load_dwordx4 v[60:63], v52, s[20:23], s64 offen offset:0 sc1
    buffer_load_dwordx4 v[64:67], v52, s[20:23], s64 offen offset:512 sc1
    s_bitset0_b32 s70, s51
K_RD0:
    ds_read_b64_tr_b16 v[140:141], v56 offset:0
    ds_read_b64_tr_b16 v[142:143], v56 offset:512
    ds_read_b64_tr_b16 v[144:145], v56 offset:2048
    ds_read_b64_tr_b16 v[146:147], v56 offset:2560
    ds_read_b64_tr_b16 v[148:149], v57 offset:0
    ds_read_b64_tr_b16 v[150:151], v57 offset:512
    ds_read_b64_tr_b16 v[152:153], v57 offset:2048
    ds_read_b64_tr_b16 v[154:155], v57 offset:2560
    s_cmp_lt_i32 s66, 0
    s_cbranch_scc0 K_TL0
    v_and_or_b32 v56, s68, v53, v54
    v_and_or_b32 v57, s68, v53, v55
    s_branch K_SK1
K_NUL0:
    s_and_b32 s51, s66, s67
    s_and_b32 s51, s51, s68
    s_and_b32 s51, s51, s69
    s_cmp_lt_i32 s51, 0
    s_cbranch_scc0 K_PC0
    s_cmp_eq_u32 s70, 0
    s_cbranch_scc1 K_P2_MM
    s_branch K_SPN
K_PC0:
    s_cmp_eq_u32 s70, 0
    s_cbranch_scc1 K_NI0
    ds_read_b32 v59, v58
    s_waitcnt lgkmcnt(0)
    v_readfirstlane_b32 s50, v59
    s_and_b32 s33, s50, s70
    s_cbranch_scc1 K_BK0
    ds_read_b32 v59, v58
    s_waitcnt lgkmcnt(0)
    v_readfirstlane_b32 s50, v59
    s_and_b32 s33, s50, s70
    s_cbranch_scc1 K_BK0
K_NI0:
    s_mov_b32 s64, -1
    v_mov_b32 v60, -1
    buffer_load_dword v3, v52, s[20:23], s64 offen
    buffer_load_dword v3, v52, s[20:23], s64 offen
    s_branch K_RD0
K_RF1:
    s_cmp_eq_u32 s70, 0
    s_cbranch_scc1 K_DM1
    ds_read_b32 v59, v58
    s_waitcnt lgkmcnt(0)
    v_readfirstlane_b32 s50, v59
    s_and_b32 s33, s50, s70
    s_cbranch_scc1 K_RB1
    v_mfma_f32_32x32x16_bf16 v[124:139], v[180:183], v[76:79], v[124:139]
    s_mov_b32 s65, -1
    v_mov_b32 v68, -1
    buffer_load_dword v3, v52, s[20:23], s65 offen
    ds_read_b64_tr_b16 v[160:161], v56 offset:2048
    ds_read_b64_tr_b16 v[162:163], v56 offset:2560
    v_mfma_f32_32x32x16_bf16 v[108:123], v[176:179], v[80:83], v[108:123]
    buffer_load_dword v3, v52, s[20:23], s65 offen
    ds_read_b64_tr_b16 v[164:165], v57 offset:0
    ds_read_b64_tr_b16 v[166:167], v57 offset:512
    s_waitcnt vmcnt(8) lgkmcnt(6)
    v_cmp_u_f32 vcc, v84, v88
    v_mfma_f32_32x32x16_bf16 v[124:139], v[184:187], v[80:83], v[124:139]
    ds_read_b64_tr_b16 v[168:169], v57 offset:2048
    ds_read_b64_tr_b16 v[170:171], v57 offset:2560
    v_and_or_b32 v56, s69, v53, v54
    v_and_or_b32 v57, s69, v53, v55
    s_cbranch_vccz K_IT2
    s_branch K_FX2
K_CHA2:
K_STA6:
    s_branch K_STA10
K_CHB2:
K_STB6:
    s_branch K_STB10
K_TL1:
    s_waitcnt vmcnt(8) lgkmcnt(8)
    v_cmp_u_f32 vcc, v84, v88
    v_and_or_b32 v56, s69, v53, v54
    v_and_or_b32 v57, s69, v53, v55
    s_cbranch_vccz K_IT2
    s_branch K_FX2
K_DX1:
    s_and_b32 s51, s66, s67
    s_and_b32 s51, s51, s68
    s_and_b32 s51, s51, s69
    s_cmp_lt_i32 s51, 0
    s_cbranch_scc1 K_P2_MM
K_FX1:
    s_cmp_lt_i32 s66, 0
    s_cbranch_scc1 K_SK1
    v_max_u32 v2, v76, v80
    v_cmp_eq_u32 vcc, -1, v2
    s_cbranch_vccz K_IT1
    s_sub_u32 s71, s71, 1
    s_cbranch_scc1 K_IT1
    s_lshr_b32 s51, s66, 12
    s_bitset1_b32 s70, s51
K_SK1:
    s_and_b32 s33, s50, s70
    s_cbranch_scc0 K_NUL1
K_BK1:
    s_ff1_i32_b32 s51, s33
    s_lshl_b32 s65, s51, 12
    buffer_load_dwordx4 v[68:71], v52, s[20:23], s65 offen offset:0 sc1
    buffer_load_dwordx4 v[72:75], v52, s[20:23], s65 offen offset:512 sc1
    s_bitset0_b32 s70, s51
K_RD1:
    ds_read_b64_tr_b16 v[156:157], v56 offset:0
    ds_read_b64_tr_b16 v[158:159], v56 offset:512
    ds_read_b64_tr_b16 v[160:161], v56 offset:2048
    ds_read_b64_tr_b16 v[162:163], v56 offset:2560
    ds_read_b64_tr_b16 v[164:165], v57 offset:0
    ds_read_b64_tr_b16 v[166:167], v57 offset:512
    ds_read_b64_tr_b16 v[168:169], v57 offset:2048
    ds_read_b64_tr_b16 v[170:171], v57 offset:2560
    s_cmp_lt_i32 s67, 0
    s_cbranch_scc0 K_TL1
    v_and_or_b32 v56, s69, v53, v54
    v_and_or_b32 v57, s69, v53, v55
    s_branch K_SK2
K_NUL1:
    s_and_b32 s51, s64, s67
    s_and_b32 s51, s51, s68
    s_and_b32 s51, s51, s69
    s_cmp_lt_i32 s51, 0
    s_cbranch_scc0 K_PC1
    s_cmp_eq_u32 s70, 0
    s_cbranch_scc1 K_P2_MM
    s_branch K_SPN
K_PC1:
    s_cmp_eq_u32 s70, 0
    s_cbranch_scc1 K_NI1
    ds_read_b32 v59, v58
    s_waitcnt lgkmcnt(0)
    v_readfirstlane_b32 s50, v59
    s_and_b32 s33, s50, s70
    s_cbranch_scc1 K_BK1
    ds_read_b32 v59, v58
    s_waitcnt lgkmcnt(0)
    v_readfirstlane_b32 s50, v59
    s_and_b32 s33, s50, s70
    s_cbranch_scc1 K_BK1
K_NI1:
    s_mov_b32 s65, -1
    v_mov_b32 v68, -1
    buffer_load_dword v3, v52, s[20:23], s65 offen
    buffer_load_dword v3, v52, s[20:23], s65 offen
    s_branch K_RD1
K_RF2:
    s_cmp_eq_u32 s70, 0
    s_cbranch_scc1 K_DM2
    ds_read_b32 v59, v58
    s_waitcnt lgkmcnt(0)
    v_readfirstlane_b32 s50, v59
    s_and_b32 s33, s50, s70
    s_cbranch_scc1 K_RB2
    v_mfma_f32_32x32x16_bf16 v[124:139], v[148:151], v[84:87], v[124:139]
    s_mov_b32 s66, -1
    v_mov_b32 v76, -1
    buffer_load_dword v3, v52, s[20:23], s66 offen
    ds_read_b64_tr_b16 v[176:177], v56 offset:2048
    ds_read_b64_tr_b16 v[178:179], v56 offset:2560
    v_mfma_f32_32x32x16_bf16 v[108:123], v[144:147], v[88:91], v[108:123]
    buffer_load_dword v3, v52, s[20:23], s66 offen
    ds_read_b64_tr_b16 v[180:181], v57 offset:0
    ds_read_b64_tr_b16 v[182:183], v57 offset:512
    s_branch K_PG4
.p2align 12
K_CHA3:
K_STA7:
    s_branch K_STA11
K_CHB3:
K_STB7:
    s_branch K_STB11
K_PG4:
    s_waitcnt vmcnt(8) lgkmcnt(6)
    v_cmp_u_f32 vcc, v92, v96
    v_mfma_f32_32x32x16_bf16 v[124:139], v[152:155], v[88:91], v[124:139]
    ds_read_b64_tr_b16 v[184:185], v57 offset:2048
    ds_read_b64_tr_b16 v[186:187], v57 offset:2560
    v_and_or_b32 v56, s64, v53, v54
    v_and_or_b32 v57, s64, v53, v55
    s_cbranch_vccz K_IT3
    s_branch K_FX3
K_TL2:
    s_waitcnt vmcnt(8) lgkmcnt(8)
    v_cmp_u_f32 vcc, v92, v96
    v_and_or_b32 v56, s64, v53, v54
    v_and_or_b32 v57, s64, v53, v55
    s_cbranch_vccz K_IT3
    s_branch K_FX3
K_DX2:
    s_and_b32 s51, s64, s67
    s_and_b32 s51, s51, s68
    s_and_b32 s51, s51, s69
    s_cmp_lt_i32 s51, 0
    s_cbranch_scc1 K_P2_MM
K_FX2:
    s_cmp_lt_i32 s67, 0
    s_cbranch_scc1 K_SK2
    v_max_u32 v2, v84, v88
    v_cmp_eq_u32 vcc, -1, v2
    s_cbranch_vccz K_IT2
    s_sub_u32 s71, s71, 1
    s_cbranch_scc1 K_IT2
    s_lshr_b32 s51, s67, 12
    s_bitset1_b32 s70, s51
K_SK2:
    s_and_b32 s33, s50, s70
    s_cbranch_scc0 K_NUL2
K_BK2:
    s_ff1_i32_b32 s51, s33
    s_lshl_b32 s66, s51, 12
    buffer_load_dwordx4 v[76:79], v52, s[20:23], s66 offen offset:0 sc1
    buffer_load_dwordx4 v[80:83], v52, s[20:23], s66 offen offset:512 sc1
    s_bitset0_b32 s70, s51
K_RD2:
    ds_read_b64_tr_b16 v[172:173], v56 offset:0
    ds_read_b64_tr_b16 v[174:175], v56 offset:512
    ds_read_b64_tr_b16 v[176:177], v56 offset:2048
    ds_read_b64_tr_b16 v[178:179], v56 offset:2560
    ds_read_b64_tr_b16 v[180:181], v57 offset:0
    ds_read_b64_tr_b16 v[182:183], v57 offset:512
    ds_read_b64_tr_b16 v[184:185], v57 offset:2048
    ds_read_b64_tr_b16 v[186:187], v57 offset:2560
    s_cmp_lt_i32 s68, 0
    s_cbranch_scc0 K_TL2
    v_and_or_b32 v56, s64, v53, v54
    v_and_or_b32 v57, s64, v53, v55
    s_branch K_SK3
K_NUL2:
    s_and_b32 s51, s64, s65
    s_and_b32 s51, s51, s68
    s_and_b32 s51, s51, s69
    s_cmp_lt_i32 s51, 0
    s_cbranch_scc0 K_PC2
    s_cmp_eq_u32 s70, 0
    s_cbranch_scc1 K_P2_MM
    s_branch K_SPN
K_PC2:
    s_cmp_eq_u32 s70, 0
    s_cbranch_scc1 K_NI2
    ds_read_b32 v59, v58
    s_waitcnt lgkmcnt(0)
    v_readfirstlane_b32 s50, v59
    s_and_b32 s33, s50, s70
    s_cbranch_scc1 K_BK2
    ds_read_b32 v59, v58
    s_waitcnt lgkmcnt(0)
    v_readfirstlane_b32 s50, v59
    s_and_b32 s33, s50, s70
    s_cbranch_scc1 K_BK2
K_NI2:
    s_mov_b32 s66, -1
    v_mov_b32 v76, -1
    buffer_load_dword v3, v52, s[20:23], s66 offen
    buffer_load_dword v3, v52, s[20:23], s66 offen
    s_branch K_RD2
K_RF3:
    s_cmp_eq_u32 s70, 0
    s_cbranch_scc1 K_DM3
    ds_read_b32 v59, v58
    s_waitcnt lgkmcnt(0)
    v_readfirstlane_b32 s50, v59
    s_and_b32 s33, s50, s70
    s_cbranch_scc1 K_RB3
    v_mfma_f32_32x32x16_bf16 v[124:139], v[164:167], v[92:95], v[124:139]
    s_mov_b32 s67, -1
    v_mov_b32 v84, -1
    buffer_load_dword v3, v52, s[20:23], s67 offen
    ds_read_b64_tr_b16 v[144:145], v56 offset:2048
    ds_read_b64_tr_b16 v[146:147], v56 offset:2560
    v_mfma_f32_32x32x16_bf16 v[108:123], v[160:163], v[96:99], v[108:123]
    buffer_load_dword v3, v52, s[20:23], s67 offen
    ds_read_b64_tr_b16 v[148:149], v57 offset:0
    ds_read_b64_tr_b16 v[150:151], v57 offset:512
    s_waitcnt vmcnt(8) lgkmcnt(6)
    v_cmp_u_f32 vcc, v100, v104
    v_mfma_f32_32x32x16_bf16 v[124:139], v[168:171], v[96:99], v[124:139]
    ds_read_b64_tr_b16 v[152:153], v57 offset:2048
    ds_read_b64_tr_b16 v[154:155], v57 offset:2560
    v_and_or_b32 v56, s65, v53, v54
    v_and_or_b32 v57, s65, v53, v55
    s_cbranch_vccz K_IT4
    s_branch K_FX4
K_STA8:
    s_branch K_STA12
K_STB8:
    s_branch K_STB12
K_TL3:
    s_waitcnt vmcnt(8) lgkmcnt(8)
    v_cmp_u_f32 vcc, v100, v104
    v_and_or_b32 v56, s65, v53, v54
    v_and_or_b32 v57, s65, v53, v55
    s_cbranch_vccz K_IT4
    s_branch K_FX4
K_DX3:
    s_and_b32 s51, s64, s65
    s_and_b32 s51, s51, s68
    s_and_b32 s51, s51, s69
    s_cmp_lt_i32 s51, 0
    s_cbranch_scc1 K_P2_MM
K_FX3:
    s_cmp_lt_i32 s68, 0
    s_cbranch_scc1 K_SK3
    v_max_u32 v2, v92, v96
    v_cmp_eq_u32 vcc, -1, v2
    s_cbranch_vccz K_IT3
    s_sub_u32 s71, s71, 1
    s_cbranch_scc1 K_IT3
    s_lshr_b32 s51, s68, 12
    s_bitset1_b32 s70, s51
K_SK3:
    s_and_b32 s33, s50, s70
    s_cbranch_scc0 K_NUL3
K_BK3:
    s_ff1_i32_b32 s51, s33
    s_lshl_b32 s67, s51, 12
    buffer_load_dwordx4 v[84:87], v52, s[20:23], s67 offen offset:0 sc1
    buffer_load_dwordx4 v[88:91], v52, s[20:23], s67 offen offset:512 sc1
    s_bitset0_b32 s70, s51
K_RD3:
    ds_read_b64_tr_b16 v[140:141], v56 offset:0
    ds_read_b64_tr_b16 v[142:143], v56 offset:512
    ds_read_b64_tr_b16 v[144:145], v56 offset:2048
    ds_read_b64_tr_b16 v[146:147], v56 offset:2560
    ds_read_b64_tr_b16 v[148:149], v57 offset:0
    ds_read_b64_tr_b16 v[150:151], v57 offset:512
    ds_read_b64_tr_b16 v[152:153], v57 offset:2048
    ds_read_b64_tr_b16 v[154:155], v57 offset:2560
    s_cmp_lt_i32 s69, 0
    s_cbranch_scc0 K_TL3
    v_and_or_b32 v56, s65, v53, v54
    v_and_or_b32 v57, s65, v53, v55
    s_branch K_SK4
K_NUL3:
    s_and_b32 s51, s64, s65
    s_and_b32 s51, s51, s66
    s_and_b32 s51, s51, s69
    s_cmp_lt_i32 s51, 0
    s_cbranch_scc0 K_PC3
    s_cmp_eq_u32 s70, 0
    s_cbranch_scc1 K_P2_MM
    s_branch K_SPN
K_PC3:
    s_cmp_eq_u32 s70, 0
    s_cbranch_scc1 K_NI3
    ds_read_b32 v59, v58
    s_waitcnt lgkmcnt(0)
    v_readfirstlane_b32 s50, v59
    s_and_b32 s33, s50, s70
    s_cbranch_scc1 K_BK3
    ds_read_b32 v59, v58
    s_waitcnt lgkmcnt(0)
    v_readfirstlane_b32 s50, v59
    s_and_b32 s33, s50, s70
    s_cbranch_scc1 K_BK3
K_NI3:
    s_mov_b32 s67, -1
    v_mov_b32 v84, -1
    buffer_load_dword v3, v52, s[20:23], s67 offen
    buffer_load_dword v3, v52, s[20:23], s67 offen
    s_branch K_RD3
K_RF4:
    s_cmp_eq_u32 s70, 0
    s_cbranch_scc1 K_DM4
    ds_read_b32 v59, v58
    s_waitcnt lgkmcnt(0)
    v_readfirstlane_b32 s50, v59
    s_and_b32 s33, s50, s70
    s_cbranch_scc1 K_RB4
    v_mfma_f32_32x32x16_bf16 v[124:139], v[180:183], v[100:103], v[124:139]
    s_mov_b32 s68, -1
    v_mov_b32 v92, -1
    buffer_load_dword v3, v52, s[20:23], s68 offen
    ds_read_b64_tr_b16 v[160:161], v56 offset:2048
    ds_read_b64_tr_b16 v[162:163], v56 offset:2560
    v_mfma_f32_32x32x16_bf16 v[108:123], v[176:179], v[104:107], v[108:123]
    buffer_load_dword v3, v52, s[20:23], s68 offen
    ds_read_b64_tr_b16 v[164:165], v57 offset:0
    ds_read_b64_tr_b16 v[166:167], v57 offset:512
    s_waitcnt vmcnt(8) lgkmcnt(6)
    v_cmp_u_f32 vcc, v60, v64
    v_mfma_f32_32x32x16_bf16 v[124:139], v[184:187], v[104:107], v[124:139]
    ds_read_b64_tr_b16 v[168:169], v57 offset:2048
    ds_read_b64_tr_b16 v[170:171], v57 offset:2560
    v_and_or_b32 v56, s66, v53, v54
    v_and_or_b32 v57, s66, v53, v55
    s_cbranch_vccz K_IT5
    s_branch K_FX5
K_TL4:
    s_waitcnt vmcnt(8) lgkmcnt(8)
    v_cmp_u_f32 vcc, v60, v64
    v_and_or_b32 v56, s66, v53, v54
    v_and_or_b32 v57, s66, v53, v55
    s_cbranch_vccz K_IT5
    s_branch K_FX5
K_STA9:
    s_branch K_STA13
K_STB9:
    s_branch K_STB13
K_DX4:
    s_and_b32 s51, s64, s65
    s_and_b32 s51, s51, s66
    s_and_b32 s51, s51, s69
    s_cmp_lt_i32 s51, 0
    s_cbranch_scc1 K_P2_MM
K_FX4:
    s_cmp_lt_i32 s69, 0
    s_cbranch_scc1 K_SK4
    v_max_u32 v2, v100, v104
    v_cmp_eq_u32 vcc, -1, v2
    s_cbranch_vccz K_IT4
    s_sub_u32 s71, s71, 1
    s_cbranch_scc1 K_IT4
    s_lshr_b32 s51, s69, 12
    s_bitset1_b32 s70, s51
K_SK4:
    s_and_b32 s33, s50, s70
    s_cbranch_scc0 K_NUL4
K_BK4:
    s_ff1_i32_b32 s51, s33
    s_lshl_b32 s68, s51, 12
    buffer_load_dwordx4 v[92:95], v52, s[20:23], s68 offen offset:0 sc1
    buffer_load_dwordx4 v[96:99], v52, s[20:23], s68 offen offset:512 sc1
    s_bitset0_b32 s70, s51
K_RD4:
    ds_read_b64_tr_b16 v[156:157], v56 offset:0
    ds_read_b64_tr_b16 v[158:159], v56 offset:512
    ds_read_b64_tr_b16 v[160:161], v56 offset:2048
    ds_read_b64_tr_b16 v[162:163], v56 offset:2560
    ds_read_b64_tr_b16 v[164:165], v57 offset:0
    ds_read_b64_tr_b16 v[166:167], v57 offset:512
    ds_read_b64_tr_b16 v[168:169], v57 offset:2048
    ds_read_b64_tr_b16 v[170:171], v57 offset:2560
    s_cmp_lt_i32 s64, 0
    s_cbranch_scc0 K_TL4
    v_and_or_b32 v56, s66, v53, v54
    v_and_or_b32 v57, s66, v53, v55
    s_branch K_SK5
K_NUL4:
    s_and_b32 s51, s64, s65
    s_and_b32 s51, s51, s66
    s_and_b32 s51, s51, s67
    s_cmp_lt_i32 s51, 0
    s_cbranch_scc0 K_PC4
    s_cmp_eq_u32 s70, 0
    s_cbranch_scc1 K_P2_MM
    s_branch K_SPN
K_PC4:
    s_cmp_eq_u32 s70, 0
    s_cbranch_scc1 K_NI4
    ds_read_b32 v59, v58
    s_waitcnt lgkmcnt(0)
    v_readfirstlane_b32 s50, v59
    s_and_b32 s33, s50, s70
    s_cbranch_scc1 K_BK4
    ds_read_b32 v59, v58
    s_waitcnt lgkmcnt(0)
    v_readfirstlane_b32 s50, v59
    s_and_b32 s33, s50, s70
    s_cbranch_scc1 K_BK4
K_NI4:
    s_mov_b32 s68, -1
    v_mov_b32 v92, -1
    buffer_load_dword v3, v52, s[20:23], s68 offen
    buffer_load_dword v3, v52, s[20:23], s68 offen
    s_branch K_RD4
K_RF5:
    s_cmp_eq_u32 s70, 0
    s_cbranch_scc1 K_DM5
    ds_read_b32 v59, v58
    s_waitcnt lgkmcnt(0)
    v_readfirstlane_b32 s50, v59
    s_and_b32 s33, s50, s70
    s_cbranch_scc1 K_RB5
    v_mfma_f32_32x32x16_bf16 v[124:139], v[148:151], v[60:63], v[124:139]
    s_mov_b32 s69, -1
    v_mov_b32 v100, -1
    buffer_load_dword v3, v52, s[20:23], s69 offen
    ds_read_b64_tr_b16 v[176:177], v56 offset:2048
    ds_read_b64_tr_b16 v[178:179], v56 offset:2560
    v_mfma_f32_32x32x16_bf16 v[108:123], v[144:147], v[64:67], v[108:123]
    buffer_load_dword v3, v52, s[20:23], s69 offen
    ds_read_b64_tr_b16 v[180:181], v57 offset:0
    ds_read_b64_tr_b16 v[182:183], v57 offset:512
    s_waitcnt vmcnt(8) lgkmcnt(6)
    v_cmp_u_f32 vcc, v68, v72
    v_mfma_f32_32x32x16_bf16 v[124:139], v[152:155], v[64:67], v[124:139]
    ds_read_b64_tr_b16 v[184:185], v57 offset:2048
    ds_read_b64_tr_b16 v[186:187], v57 offset:2560
    v_and_or_b32 v56, s67, v53, v54
    v_and_or_b32 v57, s67, v53, v55
    s_cbranch_vccz K_IT0
    s_branch K_FX0
K_TL5:
    s_waitcnt vmcnt(8) lgkmcnt(8)
    v_cmp_u_f32 vcc, v68, v72
    v_and_or_b32 v56, s67, v53, v54
    v_and_or_b32 v57, s67, v53, v55
    s_cbranch_vccz K_IT0
    s_branch K_FX0
K_DX5:
    s_and_b32 s51, s64, s65
    s_and_b32 s51, s51, s66
    s_and_b32 s51, s51, s67
    s_cmp_lt_i32 s51, 0
    s_cbranch_scc1 K_P2_MM
K_FX5:
    s_cmp_lt_i32 s64, 0
    s_cbranch_scc1 K_SK5
    v_max_u32 v2, v60, v64
    v_cmp_eq_u32 vcc, -1, v2
    s_cbranch_vccz K_IT5
    s_sub_u32 s71, s71, 1
    s_cbranch_scc1 K_IT5
    s_lshr_b32 s51, s64, 12
    s_bitset1_b32 s70, s51
K_SK5:
    s_and_b32 s33, s50, s70
    s_cbranch_scc0 K_NUL5
K_BK5:
    s_ff1_i32_b32 s51, s33
    s_lshl_b32 s69, s51, 12
    buffer_load_dwordx4 v[100:103], v52, s[20:23], s69 offen offset:0 sc1
    buffer_load_dwordx4 v[104:107], v52, s[20:23], s69 offen offset:512 sc1
    s_bitset0_b32 s70, s51
K_RD5:
    ds_read_b64_tr_b16 v[172:173], v56 offset:0
    ds_read_b64_tr_b16 v[174:175], v56 offset:512
    ds_read_b64_tr_b16 v[176:177], v56 offset:2048
    ds_read_b64_tr_b16 v[178:179], v56 offset:2560
    ds_read_b64_tr_b16 v[180:181], v57 offset:0
    ds_read_b64_tr_b16 v[182:183], v57 offset:512
    ds_read_b64_tr_b16 v[184:185], v57 offset:2048
    ds_read_b64_tr_b16 v[186:187], v57 offset:2560
    s_cmp_lt_i32 s65, 0
    s_cbranch_scc0 K_TL5
    v_and_or_b32 v56, s67, v53, v54
    v_and_or_b32 v57, s67, v53, v55
    s_branch K_SK0
K_STA10:
    s_branch K_STA14
K_STB10:
    s_branch K_STB14
K_NUL5:
    s_and_b32 s51, s65, s66
    s_and_b32 s51, s51, s67
    s_and_b32 s51, s51, s68
    s_cmp_lt_i32 s51, 0
    s_cbranch_scc0 K_PC5
    s_cmp_eq_u32 s70, 0
    s_cbranch_scc1 K_P2_MM
    s_branch K_SPN
K_PC5:
    s_cmp_eq_u32 s70, 0
    s_cbranch_scc1 K_NI5
    ds_read_b32 v59, v58
    s_waitcnt lgkmcnt(0)
    v_readfirstlane_b32 s50, v59
    s_and_b32 s33, s50, s70
    s_cbranch_scc1 K_BK5
    ds_read_b32 v59, v58
    s_waitcnt lgkmcnt(0)
    v_readfirstlane_b32 s50, v59
    s_and_b32 s33, s50, s70
    s_cbranch_scc1 K_BK5
K_NI5:
    s_mov_b32 s69, -1
    v_mov_b32 v100, -1
    buffer_load_dword v3, v52, s[20:23], s69 offen
    buffer_load_dword v3, v52, s[20:23], s69 offen
    s_branch K_RD5
K_P2_MM:
    v_cvt_pk_bf16_f32 v188, v108, v109
    v_cvt_pk_bf16_f32 v189, v110, v111
    ds_write_b64 v50, v[188:189] offset:0
    v_cvt_pk_bf16_f32 v190, v112, v113
    v_cvt_pk_bf16_f32 v191, v114, v115
    ds_write_b64 v50, v[190:191] offset:16
    v_cvt_pk_bf16_f32 v192, v116, v117
    v_cvt_pk_bf16_f32 v193, v118, v119
    ds_write_b64 v50, v[192:193] offset:32
    v_cvt_pk_bf16_f32 v194, v120, v121
    v_cvt_pk_bf16_f32 v195, v122, v123
    ds_write_b64 v50, v[194:195] offset:48
    v_cvt_pk_bf16_f32 v188, v124, v125
    v_cvt_pk_bf16_f32 v189, v126, v127
    ds_write_b64 v50, v[188:189] offset:64
    v_cvt_pk_bf16_f32 v190, v128, v129
    v_cvt_pk_bf16_f32 v191, v130, v131
    ds_write_b64 v50, v[190:191] offset:80
    v_cvt_pk_bf16_f32 v192, v132, v133
    v_cvt_pk_bf16_f32 v193, v134, v135
    ds_write_b64 v50, v[192:193] offset:96
    v_cvt_pk_bf16_f32 v194, v136, v137
    v_cvt_pk_bf16_f32 v195, v138, v139
    ds_write_b64 v50, v[194:195] offset:112
K_P2_E2:
    s_waitcnt vmcnt(0) lgkmcnt(0)
    s_lshl_b32 s72, s61, 4
    s_barrier
    ds_read_b64 v[28:29], v15
    ds_read_b64 v[24:25], v11
    ds_read_b128 v[48:51], v14
    ds_read_b64 v[26:27], v11 offset:64
    ds_read_b128 v[52:55], v14 offset:1152
    s_waitcnt lgkmcnt(4)
    v_readfirstlane_b32 s48, v28
    v_readfirstlane_b32 s49, v29
    s_sub_u32 s3, s48, s72
    s_cmp_lt_u32 s3, 16
    s_cbranch_scc1 K_YROW0
K_NOY0:
    s_sub_u32 s3, s49, s72
    s_cmp_lt_u32 s3, 16
    s_cbranch_scc1 K_YROW1
K_NOY1:
    s_waitcnt lgkmcnt(3)
    v_pk_mul_f32 v[32:33], v[32:33], v[24:25] op_sel:[0,1] op_sel_hi:[1,1]
    v_pk_mul_f32 v[34:35], v[34:35], v[24:25] op_sel:[0,1] op_sel_hi:[1,1]
    v_pk_mul_f32 v[36:37], v[36:37], v[24:25] op_sel:[0,1] op_sel_hi:[1,1]
    v_pk_mul_f32 v[38:39], v[38:39], v[24:25] op_sel:[0,1] op_sel_hi:[1,1]
    s_waitcnt lgkmcnt(2)
    v_lshlrev_b32 v68, 16, v48
    v_and_b32 v69, 0xffff0000, v48
    v_pk_fma_f32 v[68:69], v[68:69], v[24:25], v[32:33] op_sel_hi:[1,0,1]
    v_cvt_pk_bf16_f32 v48, v68, v69
    v_lshlrev_b32 v70, 16, v49
    v_and_b32 v71, 0xffff0000, v49
    v_pk_fma_f32 v[70:71], v[70:71], v[24:25], v[34:35] op_sel_hi:[1,0,1]
    v_cvt_pk_bf16_f32 v49, v70, v71
    v_lshlrev_b32 v68, 16, v50
    v_and_b32 v69, 0xffff0000, v50
    v_pk_fma_f32 v[68:69], v[68:69], v[24:25], v[36:37] op_sel_hi:[1,0,1]
    v_cvt_pk_bf16_f32 v50, v68, v69
    v_lshlrev_b32 v70, 16, v51
    v_and_b32 v71, 0xffff0000, v51
    v_pk_fma_f32 v[70:71], v[70:71], v[24:25], v[38:39] op_sel_hi:[1,0,1]
    v_cvt_pk_bf16_f32 v51, v70, v71
    buffer_store_dwordx4 v[48:51], v10, s[56:59], 0 offen sc1
    s_waitcnt lgkmcnt(1)
    v_pk_mul_f32 v[40:41], v[40:41], v[26:27] op_sel:[0,1] op_sel_hi:[1,1]
    v_pk_mul_f32 v[42:43], v[42:43], v[26:27] op_sel:[0,1] op_sel_hi:[1,1]
    v_pk_mul_f32 v[44:45], v[44:45], v[26:27] op_sel:[0,1] op_sel_hi:[1,1]
    v_pk_mul_f32 v[46:47], v[46:47], v[26:27] op_sel:[0,1] op_sel_hi:[1,1]
    s_waitcnt lgkmcnt(0)
    v_lshlrev_b32 v68, 16, v52
    v_and_b32 v69, 0xffff0000, v52
    v_pk_fma_f32 v[68:69], v[68:69], v[26:27], v[40:41] op_sel_hi:[1,0,1]
    v_cvt_pk_bf16_f32 v52, v68, v69
    v_lshlrev_b32 v70, 16, v53
    v_and_b32 v71, 0xffff0000, v53
    v_pk_fma_f32 v[70:71], v[70:71], v[26:27], v[42:43] op_sel_hi:[1,0,1]
    v_cvt_pk_bf16_f32 v53, v70, v71
    v_lshlrev_b32 v68, 16, v54
    v_and_b32 v69, 0xffff0000, v54
    v_pk_fma_f32 v[68:69], v[68:69], v[26:27], v[44:45] op_sel_hi:[1,0,1]
    v_cvt_pk_bf16_f32 v54, v68, v69
    v_lshlrev_b32 v70, 16, v55
    v_and_b32 v71, 0xffff0000, v55
    v_pk_fma_f32 v[70:71], v[70:71], v[26:27], v[46:47] op_sel_hi:[1,0,1]
    v_cvt_pk_bf16_f32 v55, v70, v71
    buffer_store_dwordx4 v[52:55], v10, s[56:59], s63 offen sc1
K_END:
K_EXIT:
    s_endpgm
K_YROW0:
    v_and_b32 v2, 7, v1
    v_lshlrev_b32 v2, 5, v2
    v_add_u32 v2, 158976, v2
    ds_read_b128 v[56:59], v2
    ds_read_b128 v[60:63], v2 offset:16
    s_and_b32 s33, s3, 7
    v_cmp_eq_u32 vcc, s33, v8
    s_cmp_ge_u32 s3, 8
    s_cbranch_scc1 K_YR1_0
    s_waitcnt lgkmcnt(0)
    v_add_f32 v64, v32, v56
    v_cvt_pk_bf16_f32 v64, v64, v64
    v_lshlrev_b32 v64, 16, v64
    v_cndmask_b32 v32, v32, v64, vcc
    v_add_f32 v65, v33, v57
    v_cvt_pk_bf16_f32 v65, v65, v65
    v_lshlrev_b32 v65, 16, v65
    v_cndmask_b32 v33, v33, v65, vcc
    v_add_f32 v66, v34, v58
    v_cvt_pk_bf16_f32 v66, v66, v66
    v_lshlrev_b32 v66, 16, v66
    v_cndmask_b32 v34, v34, v66, vcc
    v_add_f32 v67, v35, v59
    v_cvt_pk_bf16_f32 v67, v67, v67
    v_lshlrev_b32 v67, 16, v67
    v_cndmask_b32 v35, v35, v67, vcc
    v_add_f32 v64, v36, v60
    v_cvt_pk_bf16_f32 v64, v64, v64
    v_lshlrev_b32 v64, 16, v64
    v_cndmask_b32 v36, v36, v64, vcc
    v_add_f32 v65, v37, v61
    v_cvt_pk_bf16_f32 v65, v65, v65
    v_lshlrev_b32 v65, 16, v65
    v_cndmask_b32 v37, v37, v65, vcc
    v_add_f32 v66, v38, v62
    v_cvt_pk_bf16_f32 v66, v66, v66
    v_lshlrev_b32 v66, 16, v66
    v_cndmask_b32 v38, v38, v66, vcc
    v_add_f32 v67, v39, v63
    v_cvt_pk_bf16_f32 v67, v67, v67
    v_lshlrev_b32 v67, 16, v67
    v_cndmask_b32 v39, v39, v67, vcc
    s_branch K_NOY0
K_YR1_0:
    s_waitcnt lgkmcnt(0)
    v_add_f32 v64, v40, v56
    v_cvt_pk_bf16_f32 v64, v64, v64
    v_lshlrev_b32 v64, 16, v64
    v_cndmask_b32 v40, v40, v64, vcc
    v_add_f32 v65, v41, v57
    v_cvt_pk_bf16_f32 v65, v65, v65
    v_lshlrev_b32 v65, 16, v65
    v_cndmask_b32 v41, v41, v65, vcc
    v_add_f32 v66, v42, v58
    v_cvt_pk_bf16_f32 v66, v66, v66
    v_lshlrev_b32 v66, 16, v66
    v_cndmask_b32 v42, v42, v66, vcc
    v_add_f32 v67, v43, v59
    v_cvt_pk_bf16_f32 v67, v67, v67
    v_lshlrev_b32 v67, 16, v67
    v_cndmask_b32 v43, v43, v67, vcc
    v_add_f32 v64, v44, v60
    v_cvt_pk_bf16_f32 v64, v64, v64
    v_lshlrev_b32 v64, 16, v64
    v_cndmask_b32 v44, v44, v64, vcc
    v_add_f32 v65, v45, v61
    v_cvt_pk_bf16_f32 v65, v65, v65
    v_lshlrev_b32 v65, 16, v65
    v_cndmask_b32 v45, v45, v65, vcc
    v_add_f32 v66, v46, v62
    v_cvt_pk_bf16_f32 v66, v66, v66
    v_lshlrev_b32 v66, 16, v66
    v_cndmask_b32 v46, v46, v66, vcc
    v_add_f32 v67, v47, v63
    v_cvt_pk_bf16_f32 v67, v67, v67
    v_lshlrev_b32 v67, 16, v67
    v_cndmask_b32 v47, v47, v67, vcc
    s_branch K_NOY0
K_YROW1:
    v_and_b32 v2, 7, v1
    v_lshlrev_b32 v2, 5, v2
    v_add_u32 v2, 159232, v2
    ds_read_b128 v[56:59], v2
    ds_read_b128 v[60:63], v2 offset:16
    s_and_b32 s33, s3, 7
    v_cmp_eq_u32 vcc, s33, v8
    s_cmp_ge_u32 s3, 8
    s_cbranch_scc1 K_YR1_1
    s_waitcnt lgkmcnt(0)
    v_add_f32 v64, v32, v56
    v_cvt_pk_bf16_f32 v64, v64, v64
    v_lshlrev_b32 v64, 16, v64
    v_cndmask_b32 v32, v32, v64, vcc
    v_add_f32 v65, v33, v57
    v_cvt_pk_bf16_f32 v65, v65, v65
    v_lshlrev_b32 v65, 16, v65
    v_cndmask_b32 v33, v33, v65, vcc
    v_add_f32 v66, v34, v58
    v_cvt_pk_bf16_f32 v66, v66, v66
    v_lshlrev_b32 v66, 16, v66
    v_cndmask_b32 v34, v34, v66, vcc
    v_add_f32 v67, v35, v59
    v_cvt_pk_bf16_f32 v67, v67, v67
    v_lshlrev_b32 v67, 16, v67
    v_cndmask_b32 v35, v35, v67, vcc
    v_add_f32 v64, v36, v60
    v_cvt_pk_bf16_f32 v64, v64, v64
    v_lshlrev_b32 v64, 16, v64
    v_cndmask_b32 v36, v36, v64, vcc
    v_add_f32 v65, v37, v61
    v_cvt_pk_bf16_f32 v65, v65, v65
    v_lshlrev_b32 v65, 16, v65
    v_cndmask_b32 v37, v37, v65, vcc
    v_add_f32 v66, v38, v62
    v_cvt_pk_bf16_f32 v66, v66, v66
    v_lshlrev_b32 v66, 16, v66
    v_cndmask_b32 v38, v38, v66, vcc
    v_add_f32 v67, v39, v63
    v_cvt_pk_bf16_f32 v67, v67, v67
    v_lshlrev_b32 v67, 16, v67
    v_cndmask_b32 v39, v39, v67, vcc
    s_branch K_NOY1
K_YR1_1:
    s_waitcnt lgkmcnt(0)
    v_add_f32 v64, v40, v56
    v_cvt_pk_bf16_f32 v64, v64, v64
    v_lshlrev_b32 v64, 16, v64
    v_cndmask_b32 v40, v40, v64, vcc
    v_add_f32 v65, v41, v57
    v_cvt_pk_bf16_f32 v65, v65, v65
    v_lshlrev_b32 v65, 16, v65
    v_cndmask_b32 v41, v41, v65, vcc
    v_add_f32 v66, v42, v58
    v_cvt_pk_bf16_f32 v66, v66, v66
    v_lshlrev_b32 v66, 16, v66
    v_cndmask_b32 v42, v42, v66, vcc
    v_add_f32 v67, v43, v59
    v_cvt_pk_bf16_f32 v67, v67, v67
    v_lshlrev_b32 v67, 16, v67
    v_cndmask_b32 v43, v43, v67, vcc
    v_add_f32 v64, v44, v60
    v_cvt_pk_bf16_f32 v64, v64, v64
    v_lshlrev_b32 v64, 16, v64
    v_cndmask_b32 v44, v44, v64, vcc
    v_add_f32 v65, v45, v61
    v_cvt_pk_bf16_f32 v65, v65, v65
    v_lshlrev_b32 v65, 16, v65
    v_cndmask_b32 v45, v45, v65, vcc
    v_add_f32 v66, v46, v62
    v_cvt_pk_bf16_f32 v66, v66, v66
    v_lshlrev_b32 v66, 16, v66
    v_cndmask_b32 v46, v46, v66, vcc
    v_add_f32 v67, v47, v63
    v_cvt_pk_bf16_f32 v67, v67, v67
    v_lshlrev_b32 v67, 16, v67
    v_cndmask_b32 v47, v47, v67, vcc
    s_branch K_NOY1
K_STA11:
    s_branch K_STA15
K_STB11:
    s_branch K_STB15
K_P2:
    s_cmp_ge_u32 s30, 4
    s_cbranch_scc1 K_P2_HELP
    s_lshl_b32 s62, s40, 7
    v_lshrrev_b32 v8, 3, v1
    v_lshrrev_b32 v9, 4, v1
    v_mov_b32 v15, 158720
    s_lshl_b32 s61, s40, 3
    s_add_u32 s61, s61, s30
    s_mul_i32 s3, s61, 20480
    s_lshl_b32 s33, s41, 7
    s_add_u32 s3, s3, s33
    v_and_b32 v2, 7, v1
    v_lshlrev_b32 v2, 4, v2
    v_mul_u32_u24 v4, 1280, v8
    v_add3_u32 v10, v2, v4, s3
    s_lshl_b32 s3, s30, 7
    s_add_u32 s3, s3, 159744
    v_lshl_add_u32 v11, v8, 3, s3
    s_mov_b32 s63, 10240
    s_add_u32 s20, s6, 0x100000
    s_addc_u32 s21, s7, 0
    s_mov_b32 s22, 0x280000
    s_mov_b32 s23, 0x20000
    s_mov_b32 s56, s10
    s_mov_b32 s57, s11
    s_mov_b32 s58, 0x280000
    s_mov_b32 s59, 0x20000
    v_mul_u32_u24 v3, 144, v8
    v_add_u32 v3, v2, v3
    s_mul_i32 s3, s30, 2304
    s_add_u32 s3, s3, 140288
    v_add_u32 v14, s3, v3
    buffer_load_dwordx4 v[16:19], v10, s[12:15], 0 offen
    buffer_load_dwordx4 v[20:23], v10, s[12:15], s63 offen
    v_bfe_u32 v48, v1, 2, 2
    v_and_b32 v49, 3, v1
    s_add_u32 s3, s61, s30
    s_lshr_b32 s33, s3, 2
    s_mul_i32 s33, s33, 76
    s_add_u32 s3, s3, s33
    s_lshl_b32 s3, s3, 10
    v_and_b32 v2, 15, v1
    v_lshl_add_u32 v2, v2, 4, s3
    v_lshrrev_b32 v3, 5, v1
    v_lshl_add_u32 v2, v3, 8, v2
    v_and_b32 v4, 1, v9
    v_lshl_add_u32 v52, v4, 10, v2
    v_mov_b32 v53, 0x1f000
    v_lshl_add_u32 v2, v3, 3, v48
    v_lshlrev_b32 v2, 7, v2
    v_lshl_add_u32 v2, v49, 3, v2
    v_lshl_add_u32 v2, v4, 5, v2
    v_lshrrev_b32 v4, 1, v48
    v_lshl_add_u32 v54, v4, 6, v2
    v_xor_b32 v55, 64, v54
    v_mov_b32 v56, v54
    v_mov_b32 v57, v54
    v_and_b32 v2, 31, v1
    v_mul_u32_u24 v2, 144, v2
    v_lshl_add_u32 v2, v3, 3, v2
    s_mul_i32 s3, s30, 4608
    s_add_u32 s3, s3, 140288
    v_add_u32 v50, s3, v2
    s_and_b32 s33, s40, 3
    s_lshl_b32 s33, s33, 2
    s_lshr_b32 s33, 0xf63f, s33
    s_and_b32 s33, s33, 15
    s_lshl1_add_u32 s3, s30, 1
    s_cmp_ge_u32 s3, s33
    s_cselect_b32 s60, 24, 16
    s_cmp_gt_u32 s3, s33
    s_cselect_b32 s60, 20, s60
    v_add_u32 v58, s60, v15
    s_mov_b32 s64, -1
    s_mov_b32 s65, -1
    s_mov_b32 s66, -1
    s_mov_b32 s67, -1
    s_mov_b32 s68, -1
    s_mov_b32 s69, -1
    s_mov_b32 s70, 0xfffff
    s_mov_b32 s71, 131072
    v_mov_b32 v108, 0
    v_mov_b32 v109, 0
    v_mov_b32 v110, 0
    v_mov_b32 v111, 0
    v_mov_b32 v112, 0
    v_mov_b32 v113, 0
    v_mov_b32 v114, 0
    v_mov_b32 v115, 0
    v_mov_b32 v116, 0
    v_mov_b32 v117, 0
    v_mov_b32 v118, 0
    v_mov_b32 v119, 0
    v_mov_b32 v120, 0
    v_mov_b32 v121, 0
    v_mov_b32 v122, 0
    v_mov_b32 v123, 0
    v_mov_b32 v124, 0
    v_mov_b32 v125, 0
    v_mov_b32 v126, 0
    v_mov_b32 v127, 0
    v_mov_b32 v128, 0
    v_mov_b32 v129, 0
    v_mov_b32 v130, 0
    v_mov_b32 v131, 0
    v_mov_b32 v132, 0
    v_mov_b32 v133, 0
    v_mov_b32 v134, 0
    v_mov_b32 v135, 0
    v_mov_b32 v136, 0
    v_mov_b32 v137, 0
    v_mov_b32 v138, 0
    v_mov_b32 v139, 0
K_P2_AUXW:
    v_lshrrev_b32 v2, 3, v1
    v_mul_u32_u24 v2, 1280, v2
    v_lshrrev_b32 v3, 2, v1
    v_and_b32 v3, 4, v3
    v_and_b32 v4, 7, v1
    v_xor_b32 v3, v3, v4
    v_lshl_add_u32 v2, v3, 4, v2
    s_lshl_b32 s33, s41, 7
    v_add_u32 v51, s33, v2
    v_lshrrev_b32 v5, 5, v1
    v_mul_u32_u24 v5, 20480, v5
    v_add_u32 v5, v5, v51
    s_lshl_b32 s52, s30, 2
    s_lshr_b32 s52, 0x7520, s52
    s_and_b32 s52, s52, 7
    s_mul_i32 s52, s52, 51200
    s_lshl_b32 s53, s30, 12
    s_add_u32 s60, s52, 0
    s_add_u32 m0, s53, 0
    s_waitcnt vmcnt(5)
    buffer_load_dwordx4 v51, s[24:27], s60 offen lds
    s_add_u32 s60, s52, 10240
    s_add_u32 m0, s53, 1024
    s_waitcnt vmcnt(5)
    buffer_load_dwordx4 v51, s[24:27], s60 offen lds
    s_add_u32 s60, s52, 25600
    s_add_u32 m0, s53, 2048
    s_waitcnt vmcnt(5)
    buffer_load_dwordx4 v51, s[24:27], s60 offen lds
    s_add_u32 s60, s52, 35840
    s_add_u32 m0, s53, 3072
    s_waitcnt vmcnt(5)
    buffer_load_dwordx4 v51, s[24:27], s60 offen lds
    s_add_u32 s60, s52, 409600
    s_add_u32 m0, s53, 20480
    s_waitcnt vmcnt(5)
    buffer_load_dwordx4 v51, s[24:27], s60 offen lds
    s_add_u32 s60, s52, 419840
    s_branch K_PG5
.p2align 12
K_STA12:
    s_branch K_WRET_A
K_STB12:
    s_branch K_WRET_B
K_PG5:
    s_add_u32 m0, s53, 21504
    s_waitcnt vmcnt(5)
    buffer_load_dwordx4 v51, s[24:27], s60 offen lds
    v_mov_b32 v3, 1
    s_mov_b64 exec, 1
    ds_add_u32 v15, v3 offset:52
    s_mov_b64 exec, -1
    s_add_u32 s60, s52, 435200
    s_add_u32 m0, s53, 22528
    s_waitcnt vmcnt(5)
    buffer_load_dwordx4 v51, s[24:27], s60 offen lds
    s_add_u32 s60, s52, 445440
    s_add_u32 m0, s53, 23552
    s_waitcnt vmcnt(5)
    buffer_load_dwordx4 v51, s[24:27], s60 offen lds
    s_lshl_b32 s53, s30, 10
    s_add_u32 s60, s52, 20480
    s_add_u32 m0, s53, 16384
    s_waitcnt vmcnt(5)
    buffer_load_dwordx4 v5, s[24:27], s60 offen lds
    s_add_u32 s60, s52, 430080
    s_add_u32 m0, s53, 36864
    s_waitcnt vmcnt(5)
    buffer_load_dwordx4 v5, s[24:27], s60 offen lds
    s_cmp_eq_u32 s30, 0
    s_cbranch_scc1 K_CHA0
    s_cmp_eq_u32 s30, 1
    s_cbranch_scc1 K_CHA1
    s_cmp_eq_u32 s30, 2
    s_cbranch_scc1 K_CHA2
    s_branch K_CHA3
K_WRET_A:
    v_mov_b32 v3, 1
    s_waitcnt vmcnt(0)
    s_mov_b64 exec, 1
    ds_add_u32 v15, v3 offset:44
    s_mov_b64 exec, -1
    s_mov_b32 s3, 1048576
K_P2_GWA:
    ds_read_b32 v2, v15 offset:44
    s_sub_u32 s3, s3, 1
    s_waitcnt lgkmcnt(0)
    v_readfirstlane_b32 s33, v2
    s_nop 3
    s_cselect_b32 s33, 4, s33
    s_cmp_lt_u32 s33, 4
    s_cbranch_scc1 K_P2_GWA
    s_branch K_P2_GEMM
K_P2_HELP:
    s_setprio 3
    s_cmp_eq_u32 s30, 7
    s_cbranch_scc1 K_P2_W7
    s_cmp_eq_u32 s30, 4
    s_cbranch_scc1 K_P2_NL
    s_cmp_ge_u32 s29, 8
    s_cbranch_scc1 K_P2_NL
    s_mov_b32 s24, s8
    s_mov_b32 s25, s9
    s_mov_b32 s26, 0xc8000
    s_mov_b32 s27, 0x20000
    v_lshrrev_b32 v2, 3, v1
    v_mul_u32_u24 v2, 1280, v2
    v_lshrrev_b32 v3, 2, v1
    v_and_b32 v3, 4, v3
    v_and_b32 v4, 7, v1
    v_xor_b32 v3, v3, v4
    v_lshl_add_u32 v2, v3, 4, v2
    s_lshl_b32 s33, s41, 7
    v_add_u32 v12, s33, v2
    v_lshrrev_b32 v5, 5, v1
    v_mul_u32_u24 v5, 20480, v5
    v_add_u32 v5, v5, v12
    s_sub_u32 s61, s30, 5
    s_lshl_b32 s52, s61, 2
    s_lshr_b32 s52, 0x6431, s52
    s_and_b32 s52, s52, 7
    s_mul_i32 s52, s52, 51200
    s_lshl_b32 s53, s61, 12
    s_add_u32 s60, s52, 0
    s_add_u32 m0, s53, 40960
    s_nop 0
    buffer_load_dwordx4 v12, s[24:27], s60 offen lds
    s_add_u32 s60, s52, 10240
    s_add_u32 m0, s53, 41984
    s_nop 0
    buffer_load_dwordx4 v12, s[24:27], s60 offen lds
    s_add_u32 s60, s52, 25600
    s_add_u32 m0, s53, 43008
    s_nop 0
    buffer_load_dwordx4 v12, s[24:27], s60 offen lds
    s_add_u32 s60, s52, 35840
    s_add_u32 m0, s53, 44032
    s_nop 0
    buffer_load_dwordx4 v12, s[24:27], s60 offen lds
    s_add_u32 s60, s52, 409600
    s_add_u32 m0, s53, 61440
    s_nop 0
    buffer_load_dwordx4 v12, s[24:27], s60 offen lds
    s_add_u32 s60, s52, 419840
    s_add_u32 m0, s53, 62464
    s_nop 0
    buffer_load_dwordx4 v12, s[24:27], s60 offen lds
    s_add_u32 s60, s52, 435200
    s_add_u32 m0, s53, 63488
    s_nop 0
    buffer_load_dwordx4 v12, s[24:27], s60 offen lds
    s_add_u32 s60, s52, 445440
    s_add_u32 m0, s53, 64512
    s_nop 0
    buffer_load_dwordx4 v12, s[24:27], s60 offen lds
    s_lshl_b32 s53, s61, 10
    s_add_u32 s60, s52, 20480
    s_add_u32 m0, s53, 57344
    s_nop 0
    buffer_load_dwordx4 v5, s[24:27], s60 offen lds
    s_add_u32 s60, s52, 430080
    s_add_u32 m0, s53, 77824
    s_nop 0
    buffer_load_dwordx4 v5, s[24:27], s60 offen lds
    s_add_u32 s61, s61, 2
    s_lshl_b32 s52, s61, 2
    s_lshr_b32 s52, 0x6431, s52
    s_and_b32 s52, s52, 7
    s_mul_i32 s52, s52, 51200
    s_lshl_b32 s53, s61, 12
    s_add_u32 s60, s52, 0
    s_add_u32 m0, s53, 40960
    s_nop 0
    buffer_load_dwordx4 v12, s[24:27], s60 offen lds
    s_add_u32 s60, s52, 10240
    s_add_u32 m0, s53, 41984
    s_nop 0
    buffer_load_dwordx4 v12, s[24:27], s60 offen lds
    s_add_u32 s60, s52, 25600
    s_add_u32 m0, s53, 43008
    s_nop 0
    buffer_load_dwordx4 v12, s[24:27], s60 offen lds
    s_add_u32 s60, s52, 35840
    s_add_u32 m0, s53, 44032
    s_nop 0
    buffer_load_dwordx4 v12, s[24:27], s60 offen lds
    s_add_u32 s60, s52, 409600
    s_add_u32 m0, s53, 61440
    s_nop 0
    buffer_load_dwordx4 v12, s[24:27], s60 offen lds
    s_add_u32 s60, s52, 419840
    s_add_u32 m0, s53, 62464
    s_nop 0
    buffer_load_dwordx4 v12, s[24:27], s60 offen lds
    s_add_u32 s60, s52, 435200
    s_add_u32 m0, s53, 63488
    s_nop 0
    buffer_load_dwordx4 v12, s[24:27], s60 offen lds
    s_add_u32 s60, s52, 445440
    s_add_u32 m0, s53, 64512
    s_nop 0
    buffer_load_dwordx4 v12, s[24:27], s60 offen lds
    s_lshl_b32 s53, s61, 10
    s_add_u32 s60, s52, 20480
    s_add_u32 m0, s53, 57344
    s_nop 0
    buffer_load_dwordx4 v5, s[24:27], s60 offen lds
    s_add_u32 s60, s52, 430080
    s_add_u32 m0, s53, 77824
    s_nop 0
    buffer_load_dwordx4 v5, s[24:27], s60 offen lds
    v_mov_b32 v2, 158720
    v_mov_b32 v3, 1
    s_waitcnt vmcnt(0)
    s_mov_b64 exec, 1
    ds_add_u32 v2, v3 offset:56
    s_mov_b64 exec, -1
K_P2_NL:
    s_lshl_b32 s62, s40, 7
    v_lshrrev_b32 v8, 3, v1
    v_lshrrev_b32 v9, 4, v1
    v_mov_b32 v15, 158720
    s_lshl_b32 s61, s40, 3
    s_add_u32 s61, s61, s30
    s_mul_i32 s3, s61, 20480
    s_lshl_b32 s33, s41, 7
    s_add_u32 s3, s3, s33
    v_and_b32 v2, 7, v1
    v_lshlrev_b32 v2, 4, v2
    v_mul_u32_u24 v4, 1280, v8
    v_add3_u32 v10, v2, v4, s3
    s_lshl_b32 s3, s30, 7
    s_add_u32 s3, s3, 159744
    v_lshl_add_u32 v11, v8, 3, s3
    s_mov_b32 s63, 10240
    s_add_u32 s20, s6, 0x100000
    s_addc_u32 s21, s7, 0
    s_mov_b32 s22, 0x280000
    s_mov_b32 s23, 0x20000
    s_mov_b32 s56, s10
    s_mov_b32 s57, s11
    s_mov_b32 s58, 0x280000
    s_mov_b32 s59, 0x20000
    v_mul_u32_u24 v3, 144, v8
    v_add_u32 v3, v2, v3
    s_mul_i32 s3, s30, 2304
    s_add_u32 s3, s3, 140288
    v_add_u32 v14, s3, v3
    s_add_u32 s44, s6, 0x10000
    s_addc_u32 s45, s7, 0
    s_mov_b32 s46, 0x43800
    s_mov_b32 s47, 0x20000
    v_mov_b32 v108, 1
    buffer_load_dwordx4 v[16:19], v10, s[12:15], 0 offen
    buffer_load_dwordx4 v[20:23], v10, s[12:15], s63 offen
    s_cmp_lg_u32 s30, 6
    s_cbranch_scc1 K_P2_HW
    s_mov_b32 s3, 131072
    s_waitcnt vmcnt(2)
K_P2_DPOLL:
    v_min_u32 v2, v7, v6
    v_cmp_eq_u32 vcc, 0, v2
    s_cbranch_vccz K_P2_DOK
    s_cmp_eq_u32 s3, 131072
    s_cbranch_scc1 K_P2_DNS
    s_sleep 12
K_P2_DNS:
    v_lshl_add_u32 v13, v1, 2, s42
    global_load_dword v7, v13, s[6:7] offset:256 sc1
    v_and_b32 v13, 0xfffffe04, v13
    global_load_dword v6, v13, s[6:7] offset:128 sc1
    s_sub_u32 s3, s3, 1
    s_waitcnt vmcnt(0)
    s_cmp_lg_u32 s3, 0
    s_cbranch_scc1 K_P2_DPOLL
K_P2_DOK:
    v_readlane_b32 s52, v6, 0
    v_readlane_b32 s53, v6, 1
    s_nop 1
    s_and_b32 s3, s52, 0x7ff
    s_sub_u32 s3, 2047, s3
    v_mov_b32 v48, s3
    v_mov_b32 v4, s52
    v_and_b32 v4, 0xffff0000, v4
    v_ashrrev_i32 v5, 31, v4
    v_not_b32 v5, v5
    v_or_b32 v5, 0x80000000, v5
    v_xor_b32 v4, v4, v5
    v_and_b32 v4, 0xffff0000, v4
    v_mul_f32 v5, 0xbfb8aa3b, v4
    v_exp_f32 v5, v5
    s_nop 0
    v_add_f32 v5, 1.0, v5
    v_rcp_f32 v4, v5
    s_nop 0
    v_cvt_pk_bf16_f32 v50, v4, v4
    v_lshlrev_b32 v50, 16, v50
    s_and_b32 s3, s53, 0x7ff
    s_sub_u32 s3, 2047, s3
    v_mov_b32 v49, s3
    v_mov_b32 v4, s53
    v_and_b32 v4, 0xffff0000, v4
    v_ashrrev_i32 v5, 31, v4
    v_not_b32 v5, v5
    v_or_b32 v5, 0x80000000, v5
    v_xor_b32 v4, v4, v5
    v_and_b32 v4, 0xffff0000, v4
    v_mul_f32 v5, 0xbfb8aa3b, v4
    v_exp_f32 v5, v5
    s_nop 0
    v_add_f32 v5, 1.0, v5
    v_rcp_f32 v4, v5
    s_nop 0
    v_cvt_pk_bf16_f32 v51, v4, v4
    v_lshlrev_b32 v51, 16, v51
    ds_write_b128 v15, v[48:51]
    ds_write_b32 v15, v108 offset:40
    v_lshl_add_u32 v13, v1, 4, v15
    v_lshlrev_b32 v52, 16, v7
    v_and_b32 v52, 0x7fff0000, v52
    v_and_b32 v54, 0x7fff0000, v7
    v_sub_f32 v53, 1.0, v52
    v_cvt_pk_bf16_f32 v53, v53, v53
    v_lshlrev_b32 v53, 16, v53
    v_sub_f32 v55, 1.0, v54
    v_cvt_pk_bf16_f32 v55, v55, v55
    v_lshlrev_b32 v55, 16, v55
    ds_write_b128 v13, v[52:55] offset:1024
    s_branch K_P2_E
K_STA13:
    s_branch K_WRET_A
K_STB13:
    s_branch K_WRET_B
K_P2_HW:
    s_mov_b32 s3, 1048576
K_P2_GS2:
    ds_read_b32 v2, v15 offset:40
    s_sleep 1
    s_sub_u32 s3, s3, 1
    s_waitcnt lgkmcnt(0)
    v_readfirstlane_b32 s33, v2
    s_nop 3
    s_cselect_b32 s33, 1, s33
    s_cmp_lt_u32 s33, 1
    s_cbranch_scc1 K_P2_GS2
    ds_read_b128 v[28:31], v15
    s_waitcnt lgkmcnt(0)
    s_cmp_eq_u32 s30, 4
    s_cselect_b64 vcc, -1, 0
    s_nop 1
    v_cndmask_b32 v2, v29, v28, vcc
    v_cndmask_b32 v5, v31, v30, vcc
    s_nop 0
    v_readfirstlane_b32 s52, v2
    s_nop 3
    s_sub_u32 s3, s52, s62
    s_cmp_lt_u32 s3, 128
    s_cbranch_scc0 K_P2_E
    s_mov_b32 s3, 131072
K_P2_YPOLL:
    s_load_dword s33, s[6:7], s42 offset:136 glc
    s_waitcnt lgkmcnt(0)
    s_cmp_lg_u32 s33, 0
    s_cbranch_scc1 K_P2_YGO
    s_sleep 4
    s_sub_u32 s3, s3, 1
    s_cbranch_scc0 K_P2_YPOLL
K_P2_YGO:
    v_and_b32 v2, 15, v1
    v_lshlrev_b32 v2, 4, v2
    v_mul_u32_u24 v4, 5120, v9
    s_sub_u32 s53, s30, 4
    s_mul_i32 s33, s53, 2560
    s_lshl_b32 s3, s41, 8
    s_add_u32 s3, s3, s33
    v_add3_u32 v3, v2, v4, s3
    s_mov_b32 s60, 0
    buffer_load_dwordx4 v[52:55], v3, s[44:47], s60 offen sc1
    s_mov_b32 s60, 20480
    buffer_load_dwordx4 v[56:59], v3, s[44:47], s60 offen sc1
    s_mov_b32 s60, 40960
    buffer_load_dwordx4 v[60:63], v3, s[44:47], s60 offen sc1
    s_mov_b32 s60, 61440
    buffer_load_dwordx4 v[64:67], v3, s[44:47], s60 offen sc1
    s_mov_b32 s60, 81920
    buffer_load_dwordx4 v[68:71], v3, s[44:47], s60 offen sc1
    s_mov_b32 s60, 102400
    buffer_load_dwordx4 v[72:75], v3, s[44:47], s60 offen sc1
    s_mov_b32 s60, 122880
    buffer_load_dwordx4 v[76:79], v3, s[44:47], s60 offen sc1
    s_mov_b32 s60, 143360
    buffer_load_dwordx4 v[80:83], v3, s[44:47], s60 offen sc1
    s_mov_b32 s60, 163840
    buffer_load_dwordx4 v[84:87], v3, s[44:47], s60 offen sc1
    s_mov_b32 s60, 184320
    buffer_load_dwordx4 v[88:91], v3, s[44:47], s60 offen sc1
    s_mov_b32 s60, 204800
    buffer_load_dwordx4 v[92:95], v3, s[44:47], s60 offen sc1
    s_mov_b32 s60, 225280
    buffer_load_dwordx4 v[96:99], v3, s[44:47], s60 offen sc1
    s_mov_b32 s60, 245760
    buffer_load_dwordx4 v[100:103], v3, s[44:47], s60 offen sc1
    s_mov_b32 s60, 266240
    buffer_load_dwordx4 v[104:107], v3, s[44:47], s60 offen sc1
    s_waitcnt vmcnt(12)
    v_add_f32 v48, v52, v56
    v_add_f32 v49, v53, v57
    v_add_f32 v50, v54, v58
    v_add_f32 v51, v55, v59
    s_waitcnt vmcnt(11)
    v_add_f32 v48, v48, v60
    v_add_f32 v49, v49, v61
    v_add_f32 v50, v50, v62
    v_add_f32 v51, v51, v63
    s_waitcnt vmcnt(10)
    v_add_f32 v48, v48, v64
    v_add_f32 v49, v49, v65
    v_add_f32 v50, v50, v66
    v_add_f32 v51, v51, v67
    s_waitcnt vmcnt(9)
    v_add_f32 v48, v48, v68
    v_add_f32 v49, v49, v69
    v_add_f32 v50, v50, v70
    v_add_f32 v51, v51, v71
    s_waitcnt vmcnt(8)
    v_add_f32 v48, v48, v72
    v_add_f32 v49, v49, v73
    v_add_f32 v50, v50, v74
    v_add_f32 v51, v51, v75
    s_waitcnt vmcnt(7)
    v_add_f32 v48, v48, v76
    v_add_f32 v49, v49, v77
    v_add_f32 v50, v50, v78
    v_add_f32 v51, v51, v79
    s_waitcnt vmcnt(6)
    v_add_f32 v48, v48, v80
    v_add_f32 v49, v49, v81
    v_add_f32 v50, v50, v82
    v_add_f32 v51, v51, v83
    s_waitcnt vmcnt(5)
    v_add_f32 v48, v48, v84
    v_add_f32 v49, v49, v85
    v_add_f32 v50, v50, v86
    v_add_f32 v51, v51, v87
    s_waitcnt vmcnt(4)
    v_add_f32 v48, v48, v88
    v_add_f32 v49, v49, v89
    v_add_f32 v50, v50, v90
    v_add_f32 v51, v51, v91
    s_waitcnt vmcnt(3)
    v_add_f32 v48, v48, v92
    v_add_f32 v49, v49, v93
    v_add_f32 v50, v50, v94
    v_add_f32 v51, v51, v95
    s_waitcnt vmcnt(2)
    v_add_f32 v48, v48, v96
    v_add_f32 v49, v49, v97
    v_add_f32 v50, v50, v98
    v_add_f32 v51, v51, v99
    s_waitcnt vmcnt(1)
    v_add_f32 v48, v48, v100
    v_add_f32 v49, v49, v101
    v_add_f32 v50, v50, v102
    v_add_f32 v51, v51, v103
    s_waitcnt vmcnt(0)
    v_add_f32 v48, v48, v104
    v_add_f32 v49, v49, v105
    v_add_f32 v50, v50, v106
    v_add_f32 v51, v51, v107
    v_mov_b32 v52, v48
    v_mov_b32 v53, v49
    v_mov_b32 v54, v50
    v_mov_b32 v55, v51
    s_nop 0
    v_permlane16_swap_b32 v48, v52
    v_permlane16_swap_b32 v49, v53
    v_permlane16_swap_b32 v50, v54
    v_permlane16_swap_b32 v51, v55
    v_add_f32 v48, v48, v52
    v_add_f32 v49, v49, v53
    v_add_f32 v50, v50, v54
    v_add_f32 v51, v51, v55
    v_mov_b32 v52, v48
    v_mov_b32 v53, v49
    v_mov_b32 v54, v50
    v_mov_b32 v55, v51
    s_nop 0
    v_permlane32_swap_b32 v48, v52
    v_permlane32_swap_b32 v49, v53
    v_permlane32_swap_b32 v50, v54
    v_permlane32_swap_b32 v51, v55
    v_add_f32 v48, v48, v52
    v_add_f32 v49, v49, v53
    v_add_f32 v50, v50, v54
    v_add_f32 v51, v51, v55
    v_cvt_pk_bf16_f32 v48, v48, v48
    v_lshlrev_b32 v48, 16, v48
    v_mul_f32 v48, v5, v48
    v_cvt_pk_bf16_f32 v48, v48, v48
    v_lshlrev_b32 v48, 16, v48
    v_cvt_pk_bf16_f32 v49, v49, v49
    v_lshlrev_b32 v49, 16, v49
    v_mul_f32 v49, v5, v49
    v_cvt_pk_bf16_f32 v49, v49, v49
    v_lshlrev_b32 v49, 16, v49
    v_cvt_pk_bf16_f32 v50, v50, v50
    v_lshlrev_b32 v50, 16, v50
    v_mul_f32 v50, v5, v50
    v_cvt_pk_bf16_f32 v50, v50, v50
    v_lshlrev_b32 v50, 16, v50
    v_cvt_pk_bf16_f32 v51, v51, v51
    v_lshlrev_b32 v51, 16, v51
    v_mul_f32 v51, v5, v51
    v_cvt_pk_bf16_f32 v51, v51, v51
    v_lshlrev_b32 v51, 16, v51
    s_lshl_b32 s3, s53, 8
    s_add_u32 s3, s3, 158976
    v_add_u32 v2, s3, v2
    ds_write_b128 v2, v[48:51]
    s_branch K_P2_E
K_STA14:
    s_branch K_WRET_A
K_STB14:
    s_branch K_WRET_B
K_P2_W7:
    s_mov_b32 s37, s42
    s_waitcnt lgkmcnt(0)
    s_load_dwordx2 s[48:49], s[6:7], s37 glc
    s_add_u32 s53, s40, 1
    s_and_b32 s53, s53, 2
    s_mov_b32 s46, 0x84210
    s_mov_b32 s47, s46
    v_mov_b32 v15, 158720
    v_mov_b32 v5, 0
    v_mov_b32 v48, 0x80000000
    s_mov_b64 exec, 1
    ds_or_b32 v15, v48 offset:16
    ds_or_b32 v15, v48 offset:20
    ds_or_b32 v15, v48 offset:24
    s_waitcnt lgkmcnt(0)
    s_cmp_eq_u32 s53, 0
    s_cselect_b32 s49, s48, s49
    s_lshl_b64 s[50:51], s[48:49], 1
    s_and_b64 s[50:51], s[50:51], s[48:49]
    s_lshl_b64 vcc, s[50:51], 2
    s_and_b64 s[50:51], s[50:51], vcc
    s_lshl_b64 s[50:51], s[50:51], 1
    s_and_b64 s[50:51], s[50:51], s[46:47]
    s_or_b64 s[48:49], s[48:49], s[50:51]
    v_readfirstlane_b32 s52, v5
    s_cmp_ge_u32 s52, 2
    s_cselect_b32 s52, -1, 0x3ff
    s_and_b32 s48, s48, s52
    s_and_b32 s49, s49, s52
    s_and_b32 s52, s48, s49
    v_mov_b32 v48, s48
    v_mov_b32 v49, s49
    v_mov_b32 v50, s52
    s_mov_b64 exec, 1
    ds_or_b64 v15, v[48:49] offset:16
    ds_or_b32 v15, v50 offset:24
    s_mov_b64 exec, -1
    s_load_dwordx2 s[48:49], s[6:7], s37 glc
    s_lshl_b32 s62, s40, 7
    v_lshrrev_b32 v8, 3, v1
    v_lshrrev_b32 v9, 4, v1
    v_mov_b32 v15, 158720
    s_lshl_b32 s61, s40, 3
    s_add_u32 s61, s61, s30
    s_mul_i32 s3, s61, 20480
    s_lshl_b32 s33, s41, 7
    s_add_u32 s3, s3, s33
    v_and_b32 v2, 7, v1
    v_lshlrev_b32 v2, 4, v2
    v_mul_u32_u24 v4, 1280, v8
    v_add3_u32 v10, v2, v4, s3
    s_lshl_b32 s3, s30, 7
    s_add_u32 s3, s3, 159744
    v_lshl_add_u32 v11, v8, 3, s3
    s_mov_b32 s63, 10240
    s_add_u32 s20, s6, 0x100000
    s_addc_u32 s21, s7, 0
    s_mov_b32 s22, 0x280000
    s_mov_b32 s23, 0x20000
    s_mov_b32 s56, s10
    s_mov_b32 s57, s11
    s_mov_b32 s58, 0x280000
    s_mov_b32 s59, 0x20000
    v_mul_u32_u24 v3, 144, v8
    v_add_u32 v3, v2, v3
    s_mul_i32 s3, s30, 2304
    s_add_u32 s3, s3, 140288
    v_add_u32 v14, s3, v3
    buffer_load_dwordx4 v[16:19], v10, s[12:15], 0 offen
    buffer_load_dwordx4 v[20:23], v10, s[12:15], s63 offen
    s_mov_b32 s3, 131072
    s_waitcnt lgkmcnt(0)
K_P2_FP:
    s_load_dwordx2 s[44:45], s[6:7], s37 glc
    s_cmp_eq_u32 s53, 0
    s_cselect_b32 s49, s48, s49
    s_lshl_b64 s[50:51], s[48:49], 1
    s_and_b64 s[50:51], s[50:51], s[48:49]
    s_lshl_b64 vcc, s[50:51], 2
    s_and_b64 s[50:51], s[50:51], vcc
    s_lshl_b64 s[50:51], s[50:51], 1
    s_and_b64 s[50:51], s[50:51], s[46:47]
    s_or_b64 s[48:49], s[48:49], s[50:51]
    v_readfirstlane_b32 s52, v5
    s_cmp_ge_u32 s52, 2
    s_cselect_b32 s52, -1, 0x3ff
    s_and_b32 s48, s48, s52
    s_and_b32 s49, s49, s52
    s_and_b32 s52, s48, s49
    v_mov_b32 v48, s48
    v_mov_b32 v49, s49
    v_mov_b32 v50, s52
    s_mov_b64 exec, 1
    ds_or_b64 v15, v[48:49] offset:16
    ds_or_b32 v15, v50 offset:24
    s_mov_b64 exec, -1
    ds_read_b32 v5, v15 offset:56
    s_cmp_eq_u32 s52, 0xfffff
    s_cbranch_scc1 K_P2_FGO
    s_cmp_lg_u64 s[48:49], 0
    s_cbranch_scc1 K_P2_FS2
    s_sleep 8
K_P2_FS2:
    s_sub_u32 s3, s3, 1
    s_waitcnt lgkmcnt(0)
    s_mov_b64 s[48:49], s[44:45]
    s_cbranch_scc0 K_P2_FP
    s_mov_b32 s3, 0
K_P2_FCHK:
    s_cmp_eq_u32 s53, 0
    s_cselect_b32 s49, s48, s49
    s_lshl_b64 s[50:51], s[48:49], 1
    s_and_b64 s[50:51], s[50:51], s[48:49]
    s_lshl_b64 vcc, s[50:51], 2
    s_and_b64 s[50:51], s[50:51], vcc
    s_lshl_b64 s[50:51], s[50:51], 1
    s_and_b64 s[50:51], s[50:51], s[46:47]
    s_or_b64 s[48:49], s[48:49], s[50:51]
    v_readfirstlane_b32 s52, v5
    s_cmp_ge_u32 s52, 2
    s_cselect_b32 s52, -1, 0x3ff
    s_and_b32 s48, s48, s52
    s_and_b32 s49, s49, s52
    s_and_b32 s52, s48, s49
    v_mov_b32 v48, s48
    v_mov_b32 v49, s49
    v_mov_b32 v50, s52
    s_mov_b64 exec, 1
    ds_or_b64 v15, v[48:49] offset:16
    ds_or_b32 v15, v50 offset:24
    s_mov_b64 exec, -1
    s_cmp_eq_u32 s52, 0xfffff
    s_cbranch_scc1 K_P2_FGO
    s_cmp_lg_u64 s[48:49], 0
    s_cbranch_scc1 K_P2_FS
    s_sleep 8
K_P2_FS:
    s_sleep 2
    s_load_dwordx2 s[48:49], s[6:7], s37 glc
    ds_read_b32 v5, v15 offset:56
    s_sub_u32 s3, s3, 1
    s_waitcnt lgkmcnt(0)
    s_cbranch_scc0 K_P2_FCHK
    v_mov_b32 v48, -1
    v_mov_b32 v49, -1
    v_mov_b32 v50, -1
    ds_write_b96 v15, v[48:50] offset:16
K_P2_FGO:
K_P2_E:
    s_setprio 0
    s_waitcnt vmcnt(0)
    v_lshlrev_b32 v32, 16, v16
    v_and_b32 v33, 0xffff0000, v16
    v_lshlrev_b32 v34, 16, v17
    v_and_b32 v35, 0xffff0000, v17
    v_lshlrev_b32 v36, 16, v18
    v_and_b32 v37, 0xffff0000, v18
    v_lshlrev_b32 v38, 16, v19
    v_and_b32 v39, 0xffff0000, v19
    v_lshlrev_b32 v40, 16, v20
    v_and_b32 v41, 0xffff0000, v20
    v_lshlrev_b32 v42, 16, v21
    v_and_b32 v43, 0xffff0000, v21
    v_lshlrev_b32 v44, 16, v22
    v_and_b32 v45, 0xffff0000, v22
    v_lshlrev_b32 v46, 16, v23
    v_and_b32 v47, 0xffff0000, v23
    s_branch K_P2_E2
K_STA15:
    s_branch K_WRET_A
K_STB15:
    s_branch K_WRET_B
K_SPN:
    s_mov_b32 s64, -1
    s_mov_b32 s65, -1
    s_mov_b32 s66, -1
    s_mov_b32 s67, -1
    s_mov_b32 s68, -1
    s_mov_b32 s69, -1
K_SPL:
    ds_read_b32 v59, v58
    s_waitcnt lgkmcnt(0)
    v_readfirstlane_b32 s50, v59
    s_and_b32 s33, s50, s70
    s_cbranch_scc1 K_BK0
    s_cmp_lt_i32 s50, 0
    s_cbranch_scc0 K_SPG
    s_sleep 1
    s_branch K_SPL
K_SPG:
    s_load_dwordx2 s[48:49], s[6:7], s42 glc
    ds_read_b32 v5, v15 offset:56
    s_waitcnt lgkmcnt(0)
    s_cmp_eq_u32 s53, 0
    s_cselect_b32 s49, s48, s49
    s_lshl_b64 s[50:51], s[48:49], 1
    s_and_b64 s[50:51], s[50:51], s[48:49]
    s_lshl_b64 vcc, s[50:51], 2
    s_and_b64 s[50:51], s[50:51], vcc
    s_lshl_b64 s[50:51], s[50:51], 1
    s_and_b64 s[50:51], s[50:51], s[46:47]
    s_or_b64 s[48:49], s[48:49], s[50:51]
    v_readfirstlane_b32 s52, v5
    s_cmp_ge_u32 s52, 2
    s_cselect_b32 s52, -1, 0x3ff
    s_and_b32 s48, s48, s52
    s_and_b32 s49, s49, s52
    s_and_b32 s52, s48, s49
    v_mov_b32 v188, s48
    v_mov_b32 v189, s49
    v_mov_b32 v190, s52
    s_mov_b64 exec, 1
    ds_or_b64 v15, v[188:189] offset:16
    ds_or_b32 v15, v190 offset:24
    s_mov_b64 exec, -1
    ds_read_b32 v59, v58
    s_waitcnt lgkmcnt(0)
    v_readfirstlane_b32 s50, v59
    s_and_b32 s33, s50, s70
    s_cbranch_scc1 K_BK0
    s_sleep 2
    ds_read_b32 v59, v58
    s_waitcnt lgkmcnt(0)
    v_readfirstlane_b32 s50, v59
    s_and_b32 s33, s50, s70
    s_cbranch_scc1 K_BK0
    s_sleep 2
    ds_read_b32 v59, v58
    s_waitcnt lgkmcnt(0)
    v_readfirstlane_b32 s50, v59
    s_and_b32 s33, s50, s70
    s_cbranch_scc1 K_BK0
    s_sleep 2
    ds_read_b32 v59, v58
    s_waitcnt lgkmcnt(0)
    v_readfirstlane_b32 s50, v59
    s_and_b32 s33, s50, s70
    s_cbranch_scc1 K_BK0
    s_branch K_SPL
K_CHEND:
K_AUX:
    s_cmp_ge_u32 s30, 4
    s_cbranch_scc1 K_AUX_L
    s_and_b32 s3, s2, 7
    s_lshr_b32 s70, s2, 3
    s_lshl3_add_u32 s3, s3, s70
    s_lshl_b32 s3, s3, 5
    s_lshl3_add_u32 s3, s30, s3
    v_bfe_u32 v8, v0, 4, 2
    v_add_u32 v8, s3, v8
    v_and_b32 v10, 15, v0
    v_lshlrev_b32 v10, 4, v10
    v_mul_u32_u24 v9, 1280, v8
    v_add_u32 v9, v9, v10
    v_and_b32 v2, 63, v0
    v_lshlrev_b32 v2, 4, v2
    s_lshl_b32 s71, s30, 12
    s_add_u32 s71, s71, 126016
    s_mov_b32 s70, 5120
    s_mov_b32 m0, s71
    s_waitcnt lgkmcnt(0)
    s_mov_b32 s16, s44
    s_mov_b32 s17, s45
    s_mov_b32 s18, 0x500
    s_mov_b32 s19, 0x20000
    s_mov_b32 s20, s52
    s_mov_b32 s21, s53
    s_mov_b32 s22, 0x500
    s_mov_b32 s23, 0x20000
    buffer_load_dwordx4 v2, s[16:19], 0 offen lds
    buffer_load_dwordx4 v2, s[16:19], 0 offen offset:1024 lds
    s_add_u32 m0, s71, 2048
    v_add_u32 v10, s71, v10
    buffer_load_dwordx4 v2, s[20:23], 0 offen lds
    buffer_load_dwordx4 v2, s[20:23], 0 offen offset:1024 lds
    buffer_load_dwordx4 v[16:19], v9, s[12:15], 0 offen offset:0
    buffer_load_dwordx4 v[20:23], v9, s[12:15], s70 offen offset:0
    buffer_load_dwordx4 v[24:27], v9, s[12:15], 0 offen offset:256
    buffer_load_dwordx4 v[28:31], v9, s[12:15], s70 offen offset:256
    buffer_load_dwordx4 v[32:35], v9, s[12:15], 0 offen offset:512
    buffer_load_dwordx4 v[36:39], v9, s[12:15], s70 offen offset:512
    buffer_load_dwordx4 v[40:43], v9, s[12:15], 0 offen offset:768
    buffer_load_dwordx4 v[44:47], v9, s[12:15], s70 offen offset:768
    buffer_load_dwordx4 v[48:51], v9, s[12:15], 0 offen offset:1024
    buffer_load_dwordx4 v[52:55], v9, s[12:15], s70 offen offset:1024
    s_barrier
    v_and_b32 v1, 63, v0
    v_mov_b32 v7, 0
    s_and_b32 s28, s2, 7
    s_lshr_b32 s29, s2, 3
    s_xor_b32 s30, s30, 4
    s_lshr_b32 s34, s29, 3
    s_lshl_b32 s34, s34, 2
    s_and_b32 s3, s29, 3
    s_add_u32 s34, s34, s3
    s_add_u32 s34, s34, 4
    s_bitcmp1_b32 s29, 2
    s_cselect_b32 s34, -1, s34
    s_cmp_lt_u32 s29, 8
    s_cselect_b32 s34, s29, s34
    s_lshl_b32 s40, s28, 1
    s_cmp_ge_u32 s34, 10
    s_addc_u32 s40, s40, 0
    s_sub_u32 s41, s34, 10
    s_branch K_PG6
.p2align 12
K_PG6:
    s_cmp_ge_u32 s34, 10
    s_cselect_b32 s41, s41, s34
    s_mul_i32 s42, s28, 20
    s_add_u32 s42, s42, s34
    s_and_b32 s42, s42, 255
    s_lshl_b32 s42, s42, 9
    s_add_u32 s42, s42, 524288
    s_mul_i32 s43, s28, 7
    s_add_u32 s43, s43, s29
    s_sub_u32 s43, s43, 1
    s_cmp_lt_u32 s43, 54
    s_cselect_b32 s43, s43, 63
    s_cmp_eq_u32 s29, 0
    s_cselect_b32 s43, 63, s43
    s_mov_b32 s24, s8
    s_mov_b32 s25, s9
    s_mov_b32 s26, 0xc8000
    s_mov_b32 s27, 0x20000
    s_add_u32 s64, s6, 0x80000
    s_addc_u32 s65, s7, 0
    s_mov_b32 s66, 0x14400
    s_mov_b32 s67, 0x20000
    s_add_u32 s60, s6, 0x10000
    s_addc_u32 s61, s7, 0
    s_mov_b32 s62, 0x43800
    s_mov_b32 s63, 0x20000
    v_mov_b32 v96, 0
    v_mov_b32 v97, 0
    v_mov_b32 v98, 0
    v_mov_b32 v99, 0
    v_mov_b32 v13, 158720
    s_waitcnt vmcnt(10)
    ds_read_b128 v[56:59], v10 offset:0
    ds_read_b128 v[76:79], v10 offset:2048
    ds_read_b128 v[60:63], v10 offset:256
    ds_read_b128 v[80:83], v10 offset:2304
    ds_read_b128 v[64:67], v10 offset:512
    ds_read_b128 v[84:87], v10 offset:2560
    ds_read_b128 v[68:71], v10 offset:768
    ds_read_b128 v[88:91], v10 offset:2816
    ds_read_b128 v[72:75], v10 offset:1024
    ds_read_b128 v[92:95], v10 offset:3072
    s_waitcnt vmcnt(8) lgkmcnt(8)
    v_dot2c_f32_bf16 v96, v16, v56
    v_dot2c_f32_bf16 v98, v16, v76
    v_dot2c_f32_bf16 v97, v20, v56
    v_dot2c_f32_bf16 v99, v20, v76
    v_dot2c_f32_bf16 v96, v17, v57
    v_dot2c_f32_bf16 v98, v17, v77
    v_dot2c_f32_bf16 v97, v21, v57
    v_dot2c_f32_bf16 v99, v21, v77
    v_dot2c_f32_bf16 v96, v18, v58
    v_dot2c_f32_bf16 v98, v18, v78
    v_dot2c_f32_bf16 v97, v22, v58
    v_dot2c_f32_bf16 v99, v22, v78
    v_dot2c_f32_bf16 v96, v19, v59
    v_dot2c_f32_bf16 v98, v19, v79
    v_dot2c_f32_bf16 v97, v23, v59
    v_dot2c_f32_bf16 v99, v23, v79
    s_waitcnt vmcnt(6) lgkmcnt(6)
    v_dot2c_f32_bf16 v96, v24, v60
    v_dot2c_f32_bf16 v98, v24, v80
    v_dot2c_f32_bf16 v97, v28, v60
    v_dot2c_f32_bf16 v99, v28, v80
    v_dot2c_f32_bf16 v96, v25, v61
    v_dot2c_f32_bf16 v98, v25, v81
    v_dot2c_f32_bf16 v97, v29, v61
    v_dot2c_f32_bf16 v99, v29, v81
    v_dot2c_f32_bf16 v96, v26, v62
    v_dot2c_f32_bf16 v98, v26, v82
    v_dot2c_f32_bf16 v97, v30, v62
    v_dot2c_f32_bf16 v99, v30, v82
    v_dot2c_f32_bf16 v96, v27, v63
    v_dot2c_f32_bf16 v98, v27, v83
    v_dot2c_f32_bf16 v97, v31, v63
    v_dot2c_f32_bf16 v99, v31, v83
    s_waitcnt vmcnt(4) lgkmcnt(4)
    v_dot2c_f32_bf16 v96, v32, v64
    v_dot2c_f32_bf16 v98, v32, v84
    v_dot2c_f32_bf16 v97, v36, v64
    v_dot2c_f32_bf16 v99, v36, v84
    v_dot2c_f32_bf16 v96, v33, v65
    v_dot2c_f32_bf16 v98, v33, v85
    v_dot2c_f32_bf16 v97, v37, v65
    v_dot2c_f32_bf16 v99, v37, v85
    v_dot2c_f32_bf16 v96, v34, v66
    v_dot2c_f32_bf16 v98, v34, v86
    v_dot2c_f32_bf16 v97, v38, v66
    v_dot2c_f32_bf16 v99, v38, v86
    v_dot2c_f32_bf16 v96, v35, v67
    v_dot2c_f32_bf16 v98, v35, v87
    v_dot2c_f32_bf16 v97, v39, v67
    v_dot2c_f32_bf16 v99, v39, v87
    s_waitcnt vmcnt(2) lgkmcnt(2)
    v_dot2c_f32_bf16 v96, v40, v68
    v_dot2c_f32_bf16 v98, v40, v88
    v_dot2c_f32_bf16 v97, v44, v68
    v_dot2c_f32_bf16 v99, v44, v88
    v_dot2c_f32_bf16 v96, v41, v69
    v_dot2c_f32_bf16 v98, v41, v89
    v_dot2c_f32_bf16 v97, v45, v69
    v_dot2c_f32_bf16 v99, v45, v89
    v_dot2c_f32_bf16 v96, v42, v70
    v_dot2c_f32_bf16 v98, v42, v90
    v_dot2c_f32_bf16 v97, v46, v70
    v_dot2c_f32_bf16 v99, v46, v90
    v_dot2c_f32_bf16 v96, v43, v71
    v_dot2c_f32_bf16 v98, v43, v91
    v_dot2c_f32_bf16 v97, v47, v71
    v_dot2c_f32_bf16 v99, v47, v91
    s_waitcnt vmcnt(0) lgkmcnt(0)
    v_dot2c_f32_bf16 v96, v48, v72
    v_dot2c_f32_bf16 v98, v48, v92
    v_dot2c_f32_bf16 v97, v52, v72
    v_dot2c_f32_bf16 v99, v52, v92
    v_dot2c_f32_bf16 v96, v49, v73
    v_dot2c_f32_bf16 v98, v49, v93
    v_dot2c_f32_bf16 v97, v53, v73
    v_dot2c_f32_bf16 v99, v53, v93
    v_dot2c_f32_bf16 v96, v50, v74
    v_dot2c_f32_bf16 v98, v50, v94
    v_dot2c_f32_bf16 v97, v54, v74
    v_dot2c_f32_bf16 v99, v54, v94
    v_dot2c_f32_bf16 v96, v51, v75
    v_dot2c_f32_bf16 v98, v51, v95
    v_dot2c_f32_bf16 v97, v55, v75
    v_dot2c_f32_bf16 v99, v55, v95
    s_nop 2
    v_add_f32_dpp v96, v96, v96 quad_perm:[1,0,3,2] row_mask:0xf bank_mask:0xf
    v_add_f32_dpp v97, v97, v97 quad_perm:[1,0,3,2] row_mask:0xf bank_mask:0xf
    v_add_f32_dpp v98, v98, v98 quad_perm:[1,0,3,2] row_mask:0xf bank_mask:0xf
    v_add_f32_dpp v99, v99, v99 quad_perm:[1,0,3,2] row_mask:0xf bank_mask:0xf
    v_add_f32_dpp v96, v96, v96 quad_perm:[2,3,0,1] row_mask:0xf bank_mask:0xf
    v_add_f32_dpp v97, v97, v97 quad_perm:[2,3,0,1] row_mask:0xf bank_mask:0xf
    v_add_f32_dpp v98, v98, v98 quad_perm:[2,3,0,1] row_mask:0xf bank_mask:0xf
    v_add_f32_dpp v99, v99, v99 quad_perm:[2,3,0,1] row_mask:0xf bank_mask:0xf
    v_add_f32_dpp v96, v96, v96 row_half_mirror row_mask:0xf bank_mask:0xf
    v_add_f32_dpp v97, v97, v97 row_half_mirror row_mask:0xf bank_mask:0xf
    v_add_f32_dpp v98, v98, v98 row_half_mirror row_mask:0xf bank_mask:0xf
    v_add_f32_dpp v99, v99, v99 row_half_mirror row_mask:0xf bank_mask:0xf
    v_add_f32_dpp v96, v96, v96 row_mirror row_mask:0xf bank_mask:0xf
    v_add_f32_dpp v97, v97, v97 row_mirror row_mask:0xf bank_mask:0xf
    v_add_f32_dpp v98, v98, v98 row_mirror row_mask:0xf bank_mask:0xf
    v_add_f32_dpp v99, v99, v99 row_mirror row_mask:0xf bank_mask:0xf
    v_and_b32 v4, 31, v8
    v_lshlrev_b32 v11, 2, v4
    v_add_u32 v11, 122880, v11
    v_lshlrev_b32 v12, 1, v4
    v_add_u32 v12, 123008, v12
    v_cvt_pk_bf16_f32 v2, v96, v96
    v_lshlrev_b32 v2, 16, v2
    v_ashrrev_i32 v3, 31, v2
    v_or_b32 v3, 0x80000000, v3
    v_xor_b32 v2, v2, v3
    v_and_b32 v2, 0xffff0000, v2
    v_sub_u32 v3, 0x87ff, v8
    v_or_b32 v96, v2, v3
    ds_write_b32 v11, v96 offset:0
    v_cvt_pk_bf16_f32 v98, v98, v98
    v_lshlrev_b32 v98, 16, v98
    v_mul_f32 v5, 0xbfb8aa3b, v98
    v_exp_f32 v5, v5
    s_nop 0
    v_add_f32 v5, 1.0, v5
    v_rcp_f32 v98, v5
    s_nop 0
    v_cvt_pk_bf16_f32 v98, v98, v98
    v_or_b32 v98, 0x8000, v98
    ds_write_b16 v12, v98 offset:0
    v_cvt_pk_bf16_f32 v2, v97, v97
    v_lshlrev_b32 v2, 16, v2
    v_ashrrev_i32 v3, 31, v2
    v_or_b32 v3, 0x80000000, v3
    v_xor_b32 v2, v2, v3
    v_and_b32 v2, 0xffff0000, v2
    v_sub_u32 v3, 0x87fb, v8
    v_or_b32 v97, v2, v3
    ds_write_b32 v11, v97 offset:16
    v_cvt_pk_bf16_f32 v99, v99, v99
    v_lshlrev_b32 v99, 16, v99
    v_mul_f32 v5, 0xbfb8aa3b, v99
    v_exp_f32 v5, v5
    s_nop 0
    v_add_f32 v5, 1.0, v5
    v_rcp_f32 v99, v5
    s_nop 0
    v_cvt_pk_bf16_f32 v99, v99, v99
    v_or_b32 v99, 0x8000, v99
    ds_write_b16 v12, v99 offset:8
    v_mov_b32 v3, 1
    s_mov_b64 exec, 1
    ds_add_u32 v13, v3 offset:48
    s_mov_b64 exec, -1
    s_cmp_ge_u32 s30, 6
    s_cbranch_scc1 K_AUX_G1
    s_mov_b32 s3, 1048576
K_FGR:
    ds_read_b32 v2, v13 offset:48
    s_sleep 1
    s_sub_u32 s3, s3, 1
    s_waitcnt lgkmcnt(0)
    v_readfirstlane_b32 s33, v2
    s_nop 3
    s_cselect_b32 s33, 4, s33
    s_cmp_lt_u32 s33, 4
    s_cbranch_scc1 K_FGR
    s_cmp_lg_u32 s30, 4
    s_cbranch_scc1 K_AUX_G0
    v_and_b32 v3, 31, v1
    v_lshlrev_b32 v3, 2, v3
    v_add_u32 v3, 122880, v3
    ds_read_b32 v2, v3
    s_waitcnt lgkmcnt(0)
    s_nop 1
    v_max_u32_dpp v3, v2, v2 quad_perm:[1,0,3,2] row_mask:0xf bank_mask:0xf
    s_nop 1
    v_max_u32_dpp v3, v3, v3 quad_perm:[2,3,0,1] row_mask:0xf bank_mask:0xf
    s_nop 1
    v_max_u32_dpp v3, v3, v3 row_half_mirror row_mask:0xf bank_mask:0xf
    s_nop 1
    v_max_u32_dpp v3, v3, v3 row_mirror row_mask:0xf bank_mask:0xf
    s_nop 1
    v_readlane_b32 s68, v3, 0
    v_readlane_b32 s76, v3, 16
    v_readlane_b32 s77, v3, 32
    v_readlane_b32 s78, v3, 48
    s_nop 3
    s_max_u32 s68, s68, s76
    s_max_u32 s77, s77, s78
    s_max_u32 s68, s68, s77
    v_cmp_ne_u32 vcc, s68, v2
    s_nop 1
    v_cndmask_b32 v2, 0, v2, vcc
    s_nop 1
    v_max_u32_dpp v3, v2, v2 quad_perm:[1,0,3,2] row_mask:0xf bank_mask:0xf
    s_nop 1
    v_max_u32_dpp v3, v3, v3 quad_perm:[2,3,0,1] row_mask:0xf bank_mask:0xf
    s_nop 1
    v_max_u32_dpp v3, v3, v3 row_half_mirror row_mask:0xf bank_mask:0xf
    s_nop 1
    v_max_u32_dpp v3, v3, v3 row_mirror row_mask:0xf bank_mask:0xf
    s_nop 1
    v_readlane_b32 s69, v3, 0
    v_readlane_b32 s76, v3, 16
    v_readlane_b32 s77, v3, 32
    v_readlane_b32 s78, v3, 48
    s_nop 3
    s_max_u32 s69, s69, s76
    s_max_u32 s77, s77, s78
    s_max_u32 s69, s69, s77
    s_load_dword s33, s[4:5], 0
    s_waitcnt lgkmcnt(0)
    s_cmp_ge_u32 s33, 1
    s_cbranch_scc1 K_ZO3
    s_sleep 8
    s_load_dword s33, s[4:5], 64
    s_waitcnt lgkmcnt(0)
    s_cmp_ge_u32 s33, 1
    s_cbranch_scc1 K_ZO3
    s_sleep 8
    s_mov_b32 s3, 16384
K_ZB3:
    v_mov_b32 v4, 0
    global_load_dword v4, v4, s[4:5] sc1
    s_waitcnt vmcnt(0)
    v_readfirstlane_b32 s33, v4
    s_cmp_ge_u32 s33, 1
    s_cbranch_scc1 K_ZO3
    s_sleep 8
    s_sub_u32 s3, s3, 1
    s_cbranch_scc0 K_ZB3
K_ZO3:
    s_lshl_b32 s3, s2, 3
    s_add_u32 s3, s3, 606208
    s_atomic_add_x2 s[68:69], s[6:7], s3
    s_cmp_lg_u32 s2, 63
    s_cbranch_scc1 K_AUX_G1
    s_mov_b32 s70, 81920
    v_lshlrev_b32 v3, 3, v1
    s_mov_b32 s3, 131072
K_AUX_POLL:
    buffer_load_dwordx2 v[176:177], v3, s[64:67], s70 offen sc1
    s_waitcnt vmcnt(0)
    v_min_u32 v2, v176, v177
    v_cmp_eq_u32 vcc, 0, v2
    s_cbranch_vccz K_AUX_GOT
    s_sleep 2
    s_sub_u32 s3, s3, 1
    s_cmp_lg_u32 s3, 0
    s_cbranch_scc1 K_AUX_POLL
K_AUX_GOT:
    s_waitcnt lgkmcnt(0)
    s_nop 1
    v_max_u32_dpp v3, v176, v176 quad_perm:[1,0,3,2] row_mask:0xf bank_mask:0xf
    s_nop 1
    v_max_u32_dpp v3, v3, v3 quad_perm:[2,3,0,1] row_mask:0xf bank_mask:0xf
    s_nop 1
    v_max_u32_dpp v3, v3, v3 row_half_mirror row_mask:0xf bank_mask:0xf
    s_nop 1
    v_max_u32_dpp v3, v3, v3 row_mirror row_mask:0xf bank_mask:0xf
    s_nop 1
    v_readlane_b32 s68, v3, 0
    v_readlane_b32 s76, v3, 16
    v_readlane_b32 s77, v3, 32
    v_readlane_b32 s78, v3, 48
    s_nop 3
    s_max_u32 s68, s68, s76
    s_max_u32 s77, s77, s78
    s_max_u32 s68, s68, s77
    v_cmp_ne_u32 vcc, s68, v176
    s_nop 1
    v_cndmask_b32 v2, v177, v176, vcc
    s_nop 1
    v_max_u32_dpp v3, v2, v2 quad_perm:[1,0,3,2] row_mask:0xf bank_mask:0xf
    s_nop 1
    v_max_u32_dpp v3, v3, v3 quad_perm:[2,3,0,1] row_mask:0xf bank_mask:0xf
    s_nop 1
    v_max_u32_dpp v3, v3, v3 row_half_mirror row_mask:0xf bank_mask:0xf
    s_nop 1
    v_max_u32_dpp v3, v3, v3 row_mirror row_mask:0xf bank_mask:0xf
    s_nop 1
    v_readlane_b32 s69, v3, 0
    v_readlane_b32 s76, v3, 16
    v_readlane_b32 s77, v3, 32
    v_readlane_b32 s78, v3, 48
    s_nop 3
    s_max_u32 s69, s69, s76
    s_max_u32 s77, s77, s78
    s_max_u32 s69, s69, s77
    v_mov_b32 v176, s68
    v_mov_b32 v177, s69
    s_mov_b32 s3, 1048576
K_FGZ:
    ds_read_b32 v2, v13 offset:36
    s_sleep 1
    s_sub_u32 s3, s3, 1
    s_waitcnt lgkmcnt(0)
    v_readfirstlane_b32 s33, v2
    s_nop 3
    s_cselect_b32 s33, 1, s33
    s_cmp_lt_u32 s33, 1
    s_cbranch_scc1 K_FGZ
    v_lshlrev_b32 v3, 9, v1
    s_mov_b32 s66, 81920
    s_mov_b32 s70, 0
    buffer_store_dwordx2 v[176:177], v3, s[64:67], s70 offen offset:128 sc1
    s_mov_b32 s70, 32768
    buffer_store_dwordx2 v[176:177], v3, s[64:67], s70 offen offset:128 sc1
    s_mov_b32 s70, 65536
    buffer_store_dwordx2 v[176:177], v3, s[64:67], s70 offen offset:128 sc1
    v_mov_b32 v3, 16
    ds_write_b32 v13, v3 offset:48
    s_branch K_AUX_G1
K_AUX_G0:
    v_and_b32 v3, 3, v1
    v_lshlrev_b32 v3, 4, v3
    v_add_u32 v2, 123008, v3
    ds_read_b128 v[176:179], v2
    v_lshrrev_b32 v2, 2, v1
    v_lshl_add_u32 v3, v2, 9, v3
    s_sleep 12
    s_load_dword s33, s[4:5], 128
    s_waitcnt lgkmcnt(0)
    s_cmp_ge_u32 s33, 8
    s_cbranch_scc1 K_ZO4
    s_sleep 8
    s_mov_b32 s3, 16384
K_ZB4:
    v_mov_b32 v4, 128
    global_load_dword v4, v4, s[4:5] sc1
    s_waitcnt vmcnt(0)
    v_readfirstlane_b32 s33, v4
    s_cmp_ge_u32 s33, 8
    s_cbranch_scc1 K_ZO4
    s_sleep 8
    s_sub_u32 s3, s3, 1
    s_cbranch_scc0 K_ZB4
K_ZO4:
    v_mov_b32 v2, 1
    ds_write_b32 v13, v2 offset:36
    s_lshr_b32 s3, s29, 2
    s_lshl1_add_u32 s3, s28, s3
    s_mul_i32 s3, s3, 5120
    s_and_b32 s70, s29, 3
    s_lshl_b32 s70, s70, 6
    s_add_u32 s3, s3, s70
    s_mov_b32 exec_hi, 0xff
    s_waitcnt lgkmcnt(0)
    buffer_store_dwordx4 v[176:179], v3, s[64:67], s3 offen offset:256 sc1
    s_mov_b64 exec, -1
K_AUX_G1:
    s_cmp_lg_u32 s43, 63
    s_cbranch_scc1 K_FFN_C
    s_cmp_lg_u32 s29, 0
    s_cbranch_scc1 K_AUX_NT
    s_lshl2_add_u32 s3, s28, s30
    s_sub_u32 s3, s3, 4
    s_mul_i32 s3, s3, 25600
    v_lshlrev_b32 v2, 7, v1
    buffer_load_dword v5, v2, s[24:27], s3 offen
    s_add_u32 s3, s3, 8192
    buffer_load_dword v5, v2, s[24:27], s3 offen
    s_add_u32 s3, s3, 8192
    buffer_load_dword v5, v2, s[24:27], s3 offen
    s_add_u32 s3, s3, 8192
    s_mov_b64 exec, 0xff
    buffer_load_dword v5, v2, s[24:27], s3 offen
    s_add_u32 s3, s3, 8192
    s_mov_b64 exec, -1
K_AUX_NT:
    s_mov_b32 s3, 1048576
K_FGZ2:
    ds_read_b32 v2, v13 offset:36
    s_sleep 1
    s_sub_u32 s3, s3, 1
    s_waitcnt lgkmcnt(0)
    v_readfirstlane_b32 s33, v2
    s_nop 3
    s_cselect_b32 s33, 1, s33
    s_cmp_lt_u32 s33, 1
    s_cbranch_scc1 K_FGZ2
    s_waitcnt vmcnt(0)
    s_branch K_P2
K_AUX_L:
    v_and_b32 v1, 63, v0
    v_mov_b32 v7, 0
    s_and_b32 s28, s2, 7
    s_lshr_b32 s29, s2, 3
    s_xor_b32 s30, s30, 4
    s_lshr_b32 s34, s29, 3
    s_lshl_b32 s34, s34, 2
    s_and_b32 s3, s29, 3
    s_add_u32 s34, s34, s3
    s_add_u32 s34, s34, 4
    s_bitcmp1_b32 s29, 2
    s_cselect_b32 s34, -1, s34
    s_cmp_lt_u32 s29, 8
    s_cselect_b32 s34, s29, s34
    s_lshl_b32 s40, s28, 1
    s_cmp_ge_u32 s34, 10
    s_addc_u32 s40, s40, 0
    s_sub_u32 s41, s34, 10
    s_cmp_ge_u32 s34, 10
    s_cselect_b32 s41, s41, s34
    s_mul_i32 s42, s28, 20
    s_add_u32 s42, s42, s34
    s_and_b32 s42, s42, 255
    s_lshl_b32 s42, s42, 9
    s_add_u32 s42, s42, 524288
    s_mul_i32 s43, s28, 7
    s_add_u32 s43, s43, s29
    s_sub_u32 s43, s43, 1
    s_cmp_lt_u32 s43, 54
    s_cselect_b32 s43, s43, 63
    s_cmp_eq_u32 s29, 0
    s_cselect_b32 s43, 63, s43
    v_mov_b32 v3, 158736
    ds_write2_b32 v3, v7, v7 offset0:0 offset1:1
    ds_write2_b32 v3, v7, v7 offset0:2 offset1:3
    ds_write2_b32 v3, v7, v7 offset0:4 offset1:5
    ds_write2_b32 v3, v7, v7 offset0:6 offset1:7
    ds_write2_b32 v3, v7, v7 offset0:8 offset1:9
    ds_write2_b32 v3, v7, v7 offset0:10 offset1:11
    v_lshrrev_b32 v3, 2, v1
    v_mul_u32_u24 v11, 3456, v3
    v_lshrrev_b32 v3, 4, v1
    v_and_b32 v3, 2, v3
    v_xor_b32 v3, v3, v1
    v_and_b32 v3, 3, v3
    v_lshl_add_u32 v11, v3, 4, v11
    s_mul_i32 s3, s30, 552960
    s_lshl_b32 s70, s43, 6
    s_add_u32 s3, s3, s70
    v_add_u32 v11, s3, v11
    s_mul_i32 s68, s30, 10240
    s_add_u32 s72, s68, 40960
    s_bitcmp1_b32 s43, 0
    s_cselect_b32 s71, s72, s68
    s_cselect_b32 s72, s68, s72
    v_lshlrev_b32 v8, 4, v1
    s_waitcnt lgkmcnt(0)
    s_barrier
    s_mov_b32 s24, s8
    s_mov_b32 s25, s9
    s_mov_b32 s26, 0xc8000
    s_mov_b32 s27, 0x20000
    s_cmp_lg_u32 s43, 63
    s_cbranch_scc1 K_AUX_FFN1
    s_cmp_lg_u32 s30, 0
    s_cbranch_scc1 K_AUX_NR
    s_cmp_eq_u32 s2, 55
    s_cbranch_scc1 K_AUX_NR
    s_cmp_eq_u32 s2, 63
    s_cselect_b32 s70, 0, 128
    s_mov_b32 s3, 1
    s_waitcnt vmcnt(0)
    s_atomic_add s3, s[4:5], s70
    s_atomic_add s3, s[4:5], s70 offset:64
    s_waitcnt lgkmcnt(0)
K_AUX_NR:
    v_mov_b32 v13, 158720
    s_mov_b32 s3, 1048576
K_FGZ3:
    ds_read_b32 v2, v13 offset:36
    s_sleep 1
    s_sub_u32 s3, s3, 1
    s_waitcnt lgkmcnt(0)
    v_readfirstlane_b32 s33, v2
    s_nop 3
    s_cselect_b32 s33, 1, s33
    s_cmp_lt_u32 s33, 1
    s_cbranch_scc1 K_FGZ3
    s_cmp_lg_u32 s2, 63
    s_cbranch_scc1 K_AUX_NH
    s_mov_b32 s3, 1048576
K_FGH:
    ds_read_b32 v2, v13 offset:48
    s_sleep 1
    s_sub_u32 s3, s3, 1
    s_waitcnt lgkmcnt(0)
    v_readfirstlane_b32 s33, v2
    s_nop 3
    s_cselect_b32 s33, 16, s33
    s_cmp_lt_u32 s33, 16
    s_cbranch_scc1 K_FGH
K_AUX_NH:
    s_branch K_P2
K_AUX_FFN1:
    s_bitcmp1_b32 s43, 0
    s_cselect_b64 s[56:57], s[48:49], s[46:47]
    s_cselect_b64 s[60:61], s[46:47], s[48:49]
    s_mov_b32 s58, 2211840
    s_mov_b32 s59, 0x20000
    s_mov_b32 s62, 2211840
    s_mov_b32 s63, 0x20000
    s_add_u32 m0, s71, 0
    s_mov_b32 s70, 0
    buffer_load_dwordx4 v11, s[56:59], s70 offen  lds
    s_add_u32 m0, s71, 1024
    s_mov_b32 s70, 55296
    buffer_load_dwordx4 v11, s[56:59], s70 offen  lds
    s_add_u32 m0, s71, 2048
    s_mov_b32 s70, 110592
    buffer_load_dwordx4 v11, s[56:59], s70 offen  lds
    s_add_u32 m0, s71, 3072
    s_mov_b32 s70, 165888
    buffer_load_dwordx4 v11, s[56:59], s70 offen  lds
    s_add_u32 m0, s71, 4096
    s_mov_b32 s70, 221184
    buffer_load_dwordx4 v11, s[56:59], s70 offen  lds
    s_add_u32 m0, s71, 5120
    s_mov_b32 s70, 276480
    buffer_load_dwordx4 v11, s[56:59], s70 offen  lds
    s_add_u32 m0, s71, 6144
    s_mov_b32 s70, 331776
    buffer_load_dwordx4 v11, s[56:59], s70 offen  lds
    s_add_u32 m0, s71, 7168
    s_mov_b32 s70, 387072
    buffer_load_dwordx4 v11, s[56:59], s70 offen  lds
    s_add_u32 m0, s71, 8192
    s_mov_b32 s70, 442368
    buffer_load_dwordx4 v11, s[56:59], s70 offen  lds
    s_add_u32 m0, s71, 9216
    s_mov_b32 s70, 497664
    buffer_load_dwordx4 v11, s[56:59], s70 offen  lds
    s_add_u32 m0, s72, 0
    s_mov_b32 s70, 0
    buffer_load_dwordx4 v11, s[60:63], s70 offen  lds
    s_add_u32 m0, s72, 1024
    s_mov_b32 s70, 55296
    buffer_load_dwordx4 v11, s[60:63], s70 offen  lds
    s_add_u32 m0, s72, 2048
    s_mov_b32 s70, 110592
    buffer_load_dwordx4 v11, s[60:63], s70 offen  lds
    s_add_u32 m0, s72, 3072
    s_mov_b32 s70, 165888
    buffer_load_dwordx4 v11, s[60:63], s70 offen  lds
    s_add_u32 m0, s72, 4096
    s_mov_b32 s70, 221184
    buffer_load_dwordx4 v11, s[60:63], s70 offen  lds
    s_add_u32 m0, s72, 5120
    s_mov_b32 s70, 276480
    buffer_load_dwordx4 v11, s[60:63], s70 offen  lds
    s_add_u32 m0, s72, 6144
    s_mov_b32 s70, 331776
    buffer_load_dwordx4 v11, s[60:63], s70 offen  lds
    s_add_u32 m0, s72, 7168
    s_mov_b32 s70, 387072
    buffer_load_dwordx4 v11, s[60:63], s70 offen  lds
    s_add_u32 m0, s72, 8192
    s_mov_b32 s70, 442368
    buffer_load_dwordx4 v11, s[60:63], s70 offen  lds
    s_add_u32 m0, s72, 9216
    s_mov_b32 s70, 497664
    buffer_load_dwordx4 v11, s[60:63], s70 offen  lds
    s_mov_b32 s64, s50
    s_mov_b32 s65, s51
    s_mov_b32 s66, 0x21c000
    s_mov_b32 s67, 0x20000
    s_mul_i32 s3, s43, 40960
    s_add_u32 s3, s3, s68
    v_lshrrev_b32 v2, 3, v1
    v_and_b32 v3, 2, v2
    s_lshl_b32 s70, s30, 2
    v_xor_b32 v3, s70, v3
    v_xor_b32 v3, v3, v1
    v_and_b32 v3, 7, v3
    v_mul_u32_u24 v2, 1280, v2
    v_lshl_add_u32 v2, v3, 4, v2
    v_add_u32 v12, s3, v2
    s_add_u32 m0, s68, 81920
    s_mov_b32 s70, 0
    buffer_load_dwordx4 v12, s[64:67], s70 offen nt lds
    s_add_u32 m0, s68, 82944
    s_mov_b32 s70, 128
    buffer_load_dwordx4 v12, s[64:67], s70 offen nt lds
    s_add_u32 m0, s68, 83968
    s_mov_b32 s70, 256
    buffer_load_dwordx4 v12, s[64:67], s70 offen nt lds
    s_add_u32 m0, s68, 84992
    s_mov_b32 s70, 384
    buffer_load_dwordx4 v12, s[64:67], s70 offen nt lds
    s_add_u32 m0, s68, 86016
    s_mov_b32 s70, 512
    buffer_load_dwordx4 v12, s[64:67], s70 offen nt lds
    s_add_u32 m0, s68, 87040
    s_mov_b32 s70, 640
    buffer_load_dwordx4 v12, s[64:67], s70 offen nt lds
    s_add_u32 m0, s68, 88064
    s_mov_b32 s70, 768
    buffer_load_dwordx4 v12, s[64:67], s70 offen nt lds
    s_add_u32 m0, s68, 89088
    s_mov_b32 s70, 896
    buffer_load_dwordx4 v12, s[64:67], s70 offen nt lds
    s_add_u32 m0, s68, 90112
    s_mov_b32 s70, 1024
    buffer_load_dwordx4 v12, s[64:67], s70 offen nt lds
    s_add_u32 m0, s68, 91136
    s_mov_b32 s70, 1152
    buffer_load_dwordx4 v12, s[64:67], s70 offen nt lds
    s_waitcnt vmcnt(10)
    s_barrier
    s_branch K_P2_EARLY
K_FFN_C:
    v_lshrrev_b32 v180, 4, v1
    v_bfe_u32 v2, v1, 2, 2
    v_lshl_add_u32 v2, v180, 3, v2
    v_and_b32 v3, 3, v1
    v_lshlrev_b32 v3, 3, v3
    v_lshl_add_u32 v181, v2, 6, v3
    s_bfe_u32 s3, s30, 0x10001
    s_mul_i32 s3, s3, 40960
    v_xor_b32 v4, s30, v180
    v_and_b32 v4, 1, v4
    v_lshl_add_u32 v181, v4, 5, v181
    v_add_u32 v181, s3, v181
    v_bfe_u32 v4, v1, 3, 2
    v_xor_b32 v4, s30, v4
    v_and_b32 v4, 3, v4
    v_lshl_add_u32 v3, v4, 5, v3
    v_and_b32 v2, 3, v2
    v_lshl_add_u32 v3, v2, 7, v3
    v_mul_u32_u24 v182, 10240, v180
    s_mov_b32 s3, 81920
    v_add3_u32 v182, v182, v3, s3
    v_mov_b32 v183, 123904
    s_cmp_lg_u32 s30, 5
    s_cbranch_scc1 K_KW
    s_mov_b32 s3, 131072
K_KPOLL:
    s_load_dwordx2 s[68:69], s[6:7], s42 offset:128 glc
    s_waitcnt lgkmcnt(0)
    s_min_u32 s33, s68, s69
    s_cmp_lg_u32 s33, 0
    s_cbranch_scc1 K_KGOT
    s_sleep 2
    s_sub_u32 s3, s3, 1
    s_cbranch_scc0 K_KPOLL
K_KGOT:
    v_mov_b32 v176, s68
    v_mov_b32 v177, s69
    ds_write_b64 v183, v[176:177]
    v_lshlrev_b32 v2, 4, v1
    s_and_b32 s70, s68, 0x7ff
    s_sub_u32 s70, 2047, s70
    s_mul_i32 s70, s70, 1280
    s_mov_b32 m0, 134208
    s_mov_b64 exec, -1
    buffer_load_dwordx4 v2, s[12:15], s70 offen lds
    s_mov_b64 exec, 0xffff
    buffer_load_dwordx4 v2, s[12:15], s70 offen offset:1024 lds
    s_and_b32 s70, s69, 0x7ff
    s_sub_u32 s70, 2047, s70
    s_mul_i32 s70, s70, 1280
    s_mov_b32 m0, 135552
    s_mov_b64 exec, -1
    buffer_load_dwordx4 v2, s[12:15], s70 offen lds
    s_mov_b64 exec, 0xffff
    buffer_load_dwordx4 v2, s[12:15], s70 offen offset:1024 lds
    s_mov_b64 exec, -1
    v_mov_b32 v3, 16
    s_waitcnt vmcnt(0)
    ds_write_b32 v13, v3 offset:48
    s_branch K_KW2
K_KW:
    s_cmp_lt_u32 s30, 6
    s_cbranch_scc1 K_KW2
    s_cmp_eq_u32 s30, 6
    s_cbranch_scc1 K_CHF0
    s_branch K_CHF1
K_WRET_F:
K_KW2:
    s_branch K_J7f38
K_CHF0:
K_STF16:
    s_branch K_STF18
    s_nop 0
K_J7f38:
    v_and_b32 v2, 1, v1
    v_mul_u32_u24 v9, 1344, v2
    v_lshl_add_u32 v9, v180, 4, v9
    v_add_u32 v9, 134208, v9
    v_and_b32 v2, 1, v1
    v_lshlrev_b32 v192, 6, v2
    v_lshl_add_u32 v192, v180, 4, v192
    s_and_b32 s3, s30, 3
    s_lshl_b32 s3, s3, 7
    v_add3_u32 v193, v192, s3, v183
    v_add_u32 v192, 64, v193
    v_add_u32 v193, 1088, v193
    v_lshrrev_b32 v2, 5, v1
    v_bfe_u32 v3, v1, 4, 1
    v_lshl_add_u32 v3, v3, 1, v2
    v_lshlrev_b32 v3, 6, v3
    v_and_b32 v4, 15, v1
    v_lshl_add_u32 v3, v4, 2, v3
    v_add_u32 v194, 123968, v3
    v_lshlrev_b32 v4, 1, v1
    s_add_u32 s3, s3, 124992
    v_add_u32 v195, s3, v4
    v_and_b32 v2, 1, v1
    v_mul_u32_u24 v2, 2560, v2
    v_lshl_add_u32 v196, v180, 4, v2
    s_lshl_b32 s70, s30, 6
    s_add_u32 s70, s70, 125760
    v_add_u32 v196, s70, v196
    v_mov_b32 v3, 1
    s_mov_b32 s3, 1048576
K_FGK:
    s_branch K_PG7
.p2align 12
K_CHF1:
K_STF17:
    s_branch K_WRET_F
    s_nop 0
K_PG7:
    ds_read_b32 v2, v13 offset:48
    s_sleep 1
    s_sub_u32 s3, s3, 1
    s_waitcnt lgkmcnt(0)
    v_readfirstlane_b32 s33, v2
    s_nop 3
    s_cselect_b32 s33, 16, s33
    s_cmp_lt_u32 s33, 16
    s_cbranch_scc1 K_FGK
    ds_read_b128 v[96:99], v9 offset:0
    ds_read_b128 v[100:103], v9 offset:64
    ds_read_b128 v[104:107], v9 offset:128
    ds_read_b128 v[108:111], v9 offset:192
    ds_read_b128 v[112:115], v9 offset:256
    ds_read_b128 v[116:119], v9 offset:320
    ds_read_b128 v[120:123], v9 offset:384
    ds_read_b128 v[124:127], v9 offset:448
    ds_read_b128 v[128:131], v9 offset:512
    ds_read_b128 v[132:135], v9 offset:576
    ds_read_b128 v[136:139], v9 offset:640
    ds_read_b128 v[140:143], v9 offset:704
    ds_read_b128 v[144:147], v9 offset:768
    ds_read_b128 v[148:151], v9 offset:832
    ds_read_b128 v[152:155], v9 offset:896
    ds_read_b128 v[156:159], v9 offset:960
    ds_read_b128 v[160:163], v9 offset:1024
    ds_read_b128 v[164:167], v9 offset:1088
    ds_read_b128 v[168:171], v9 offset:1152
    ds_read_b128 v[172:175], v9 offset:1216
    s_setprio 3
    s_barrier
    ds_read_b64_tr_b16 v[16:17], v181 offset:0
    ds_read_b64_tr_b16 v[18:19], v181 offset:256
    ds_read_b64_tr_b16 v[20:21], v181 offset:2048
    ds_read_b64_tr_b16 v[22:23], v181 offset:2304
    ds_read_b64_tr_b16 v[24:25], v181 offset:4096
    ds_read_b64_tr_b16 v[26:27], v181 offset:4352
    ds_read_b64_tr_b16 v[28:29], v181 offset:6144
    ds_read_b64_tr_b16 v[30:31], v181 offset:6400
    ds_read_b64_tr_b16 v[32:33], v181 offset:8192
    ds_read_b64_tr_b16 v[34:35], v181 offset:8448
    ds_read_b64_tr_b16 v[36:37], v181 offset:10240
    ds_read_b64_tr_b16 v[38:39], v181 offset:10496
    ds_read_b64_tr_b16 v[40:41], v181 offset:12288
    ds_read_b64_tr_b16 v[42:43], v181 offset:12544
    ds_read_b64_tr_b16 v[44:45], v181 offset:14336
    ds_read_b64_tr_b16 v[46:47], v181 offset:14592
    ds_read_b64_tr_b16 v[48:49], v181 offset:16384
    ds_read_b64_tr_b16 v[50:51], v181 offset:16640
    ds_read_b64_tr_b16 v[52:53], v181 offset:18432
    ds_read_b64_tr_b16 v[54:55], v181 offset:18688
    ds_read_b64_tr_b16 v[56:57], v181 offset:20480
    ds_read_b64_tr_b16 v[58:59], v181 offset:20736
    ds_read_b64_tr_b16 v[60:61], v181 offset:22528
    ds_read_b64_tr_b16 v[62:63], v181 offset:22784
    ds_read_b64_tr_b16 v[64:65], v181 offset:24576
    ds_read_b64_tr_b16 v[66:67], v181 offset:24832
    ds_read_b64_tr_b16 v[68:69], v181 offset:26624
    ds_read_b64_tr_b16 v[70:71], v181 offset:26880
    ds_read_b64_tr_b16 v[72:73], v181 offset:28672
    ds_read_b64_tr_b16 v[74:75], v181 offset:28928
    ds_read_b64_tr_b16 v[76:77], v181 offset:30720
    ds_read_b64_tr_b16 v[78:79], v181 offset:30976
    ds_read_b64_tr_b16 v[80:81], v181 offset:32768
    ds_read_b64_tr_b16 v[82:83], v181 offset:33024
    ds_read_b64_tr_b16 v[84:85], v181 offset:34816
    ds_read_b64_tr_b16 v[86:87], v181 offset:35072
    ds_read_b64_tr_b16 v[88:89], v181 offset:36864
    ds_read_b64_tr_b16 v[90:91], v181 offset:37120
    ds_read_b64_tr_b16 v[92:93], v181 offset:38912
    ds_read_b64_tr_b16 v[94:95], v181 offset:39168
    s_waitcnt lgkmcnt(0)
    s_barrier
    v_mfma_f32_16x16x32_bf16 v[184:187], v[16:19], v[96:99], 0
    v_mfma_f32_16x16x32_bf16 v[188:191], v[20:23], v[100:103], 0
    v_mfma_f32_16x16x32_bf16 v[184:187], v[24:27], v[104:107], v[184:187]
    v_mfma_f32_16x16x32_bf16 v[188:191], v[28:31], v[108:111], v[188:191]
    v_mfma_f32_16x16x32_bf16 v[184:187], v[32:35], v[112:115], v[184:187]
    v_mfma_f32_16x16x32_bf16 v[188:191], v[36:39], v[116:119], v[188:191]
    v_mfma_f32_16x16x32_bf16 v[184:187], v[40:43], v[120:123], v[184:187]
    v_mfma_f32_16x16x32_bf16 v[188:191], v[44:47], v[124:127], v[188:191]
    v_mfma_f32_16x16x32_bf16 v[184:187], v[48:51], v[128:131], v[184:187]
    v_mfma_f32_16x16x32_bf16 v[188:191], v[52:55], v[132:135], v[188:191]
    v_mfma_f32_16x16x32_bf16 v[184:187], v[56:59], v[136:139], v[184:187]
    v_mfma_f32_16x16x32_bf16 v[188:191], v[60:63], v[140:143], v[188:191]
    v_mfma_f32_16x16x32_bf16 v[184:187], v[64:67], v[144:147], v[184:187]
    v_mfma_f32_16x16x32_bf16 v[188:191], v[68:71], v[148:151], v[188:191]
    v_mfma_f32_16x16x32_bf16 v[184:187], v[72:75], v[152:155], v[184:187]
    v_mfma_f32_16x16x32_bf16 v[188:191], v[76:79], v[156:159], v[188:191]
    v_mfma_f32_16x16x32_bf16 v[184:187], v[80:83], v[160:163], v[184:187]
    v_mfma_f32_16x16x32_bf16 v[188:191], v[84:87], v[164:167], v[188:191]
    v_mfma_f32_16x16x32_bf16 v[184:187], v[88:91], v[168:171], v[184:187]
    v_mfma_f32_16x16x32_bf16 v[188:191], v[92:95], v[172:175], v[188:191]
    s_nop 7
    v_add_f32 v184, v184, v188
    v_add_f32 v185, v185, v189
    v_add_f32 v186, v186, v190
    v_add_f32 v187, v187, v191
    s_mov_b32 exec_lo, 0x00030003
    s_mov_b32 exec_hi, 0x00030003
    ds_write_b128 v192, v[184:187]
    s_mov_b64 exec, 1
    ds_add_u32 v13, v3 offset:52
    s_mov_b64 exec, -1
    s_cmp_lg_u32 s30, 6
    s_cbranch_scc1 K_NOS6B
    v_lshl_add_u32 v4, v1, 2, s42
    global_load_dword v7, v4, s[6:7] offset:256 sc1
    v_and_b32 v4, 0xfffffe04, v4
    global_load_dword v6, v4, s[6:7] offset:128 sc1
K_NOS6B:
    s_mov_b32 s3, 1048576
K_FGP:
    ds_read_b32 v2, v13 offset:52
    s_sleep 1
    s_sub_u32 s3, s3, 1
    s_waitcnt lgkmcnt(0)
    v_readfirstlane_b32 s33, v2
    s_nop 3
    s_cselect_b32 s33, 8, s33
    s_cmp_lt_u32 s33, 8
    s_cbranch_scc1 K_FGP
    ds_read_b32 v200, v194
    ds_read_b32 v202, v194 offset:256
    ds_read_b64_tr_b16 v[16:17], v182 offset:0
    ds_read_b64_tr_b16 v[18:19], v182 offset:512
    ds_read_b64_tr_b16 v[20:21], v182 offset:1024
    ds_read_b64_tr_b16 v[22:23], v182 offset:1536
    ds_read_b64_tr_b16 v[24:25], v182 offset:2048
    ds_read_b64_tr_b16 v[26:27], v182 offset:2560
    ds_read_b64_tr_b16 v[28:29], v182 offset:3072
    ds_read_b64_tr_b16 v[30:31], v182 offset:3584
    ds_read_b64_tr_b16 v[32:33], v182 offset:4096
    ds_read_b64_tr_b16 v[34:35], v182 offset:4608
    ds_read_b64_tr_b16 v[36:37], v182 offset:5120
    ds_read_b64_tr_b16 v[38:39], v182 offset:5632
    ds_read_b64_tr_b16 v[40:41], v182 offset:6144
    s_branch K_J83cc
K_STF18:
    s_branch K_WRET_F
    s_nop 0
K_J83cc:
    ds_read_b64_tr_b16 v[42:43], v182 offset:6656
    s_waitcnt lgkmcnt(14)
    v_cvt_pk_bf16_f32 v200, v200, v200
    v_lshlrev_b32 v200, 16, v200
    v_cvt_pk_bf16_f32 v202, v202, v202
    v_lshlrev_b32 v202, 16, v202
    v_mul_f32 v201, 0xbfb8aa3b, v200
    v_exp_f32 v201, v201
    s_nop 0
    v_add_f32 v201, 1.0, v201
    v_rcp_f32 v201, v201
    s_nop 0
    v_mul_f32 v200, v200, v201
    v_cvt_pk_bf16_f32 v200, v200, v200
    v_lshlrev_b32 v200, 16, v200
    v_mul_f32 v200, v200, v202
    v_cvt_pk_bf16_f32 v200, v200, v200
    ds_write_b16 v195, v200
    s_waitcnt lgkmcnt(0)
    ds_read_b128 v[200:203], v193
    ds_read_b64_tr_b16 v[44:45], v182 offset:7168
    ds_read_b64_tr_b16 v[46:47], v182 offset:7680
    ds_read_b64_tr_b16 v[48:49], v182 offset:8192
    ds_read_b64_tr_b16 v[50:51], v182 offset:8704
    ds_read_b64_tr_b16 v[52:53], v182 offset:9216
    ds_read_b64_tr_b16 v[54:55], v182 offset:9728
    s_waitcnt lgkmcnt(6)
    v_mfma_f32_16x16x32_bf16 v[96:99], v[16:19], v[200:203], 0
    v_mfma_f32_16x16x32_bf16 v[100:103], v[20:23], v[200:203], 0
    v_mfma_f32_16x16x32_bf16 v[104:107], v[24:27], v[200:203], 0
    v_mfma_f32_16x16x32_bf16 v[108:111], v[28:31], v[200:203], 0
    v_mfma_f32_16x16x32_bf16 v[112:115], v[32:35], v[200:203], 0
    v_mfma_f32_16x16x32_bf16 v[116:119], v[36:39], v[200:203], 0
    v_mfma_f32_16x16x32_bf16 v[120:123], v[40:43], v[200:203], 0
    s_waitcnt lgkmcnt(4)
    v_mfma_f32_16x16x32_bf16 v[124:127], v[44:47], v[200:203], 0
    s_waitcnt lgkmcnt(2)
    v_mfma_f32_16x16x32_bf16 v[128:131], v[48:51], v[200:203], 0
    s_waitcnt lgkmcnt(0)
    v_mfma_f32_16x16x32_bf16 v[132:135], v[52:55], v[200:203], 0
    s_mov_b32 exec_lo, 0x00030003
    s_mov_b32 exec_hi, 0x00030003
    ds_write_b128 v196, v[96:99] offset:0
    ds_write_b128 v196, v[100:103] offset:256
    ds_write_b128 v196, v[104:107] offset:512
    ds_write_b128 v196, v[108:111] offset:768
    ds_write_b128 v196, v[112:115] offset:1024
    ds_write_b128 v196, v[116:119] offset:1280
    ds_write_b128 v196, v[120:123] offset:1536
    ds_write_b128 v196, v[124:127] offset:1792
    ds_write_b128 v196, v[128:131] offset:2048
    ds_write_b128 v196, v[132:135] offset:2304
    v_mov_b32 v3, 1
    s_mov_b64 exec, 1
    ds_add_u32 v13, v3 offset:52
    s_mov_b64 exec, -1
    s_cmp_lg_u32 s30, 4
    s_cbranch_scc1 K_P2
    v_lshlrev_b32 v3, 4, v1
    v_add_u32 v4, 126016, v3
    s_mul_i32 s70, s43, 5120
    s_add_u32 s71, s70, 4096
    s_mov_b32 s3, 1048576
K_FGQ:
    ds_read_b32 v2, v13 offset:52
    s_sleep 1
    s_sub_u32 s3, s3, 1
    s_waitcnt lgkmcnt(0)
    v_readfirstlane_b32 s33, v2
    s_nop 3
    s_cselect_b32 s33, 12, s33
    s_cmp_lt_u32 s33, 12
    s_cbranch_scc1 K_FGQ
    ds_read_b128 v[16:19], v4 offset:0
    ds_read_b128 v[20:23], v4 offset:1024
    ds_read_b128 v[24:27], v4 offset:2048
    ds_read_b128 v[28:31], v4 offset:3072
    ds_read_b128 v[32:35], v4 offset:4096
    s_waitcnt lgkmcnt(4)
    buffer_store_dwordx4 v[16:19], v3, s[60:63], s70 offen offset:0 sc1
    s_waitcnt lgkmcnt(3)
    buffer_store_dwordx4 v[20:23], v3, s[60:63], s70 offen offset:1024 sc1
    s_waitcnt lgkmcnt(2)
    buffer_store_dwordx4 v[24:27], v3, s[60:63], s70 offen offset:2048 sc1
    s_waitcnt lgkmcnt(1)
    buffer_store_dwordx4 v[28:31], v3, s[60:63], s70 offen offset:3072 sc1
    s_waitcnt lgkmcnt(0)
    buffer_store_dwordx4 v[32:35], v3, s[60:63], s71 offen offset:0 sc1
    s_mov_b32 s3, 1
    s_waitcnt vmcnt(0)
    s_atomic_add s3, s[6:7], 606720 glc
    ds_read_b64 v[176:177], v183
    s_waitcnt lgkmcnt(0)
    s_cmp_lg_u32 s3, 53
    s_cbranch_scc1 K_P2
    v_readfirstlane_b32 s70, v176
    s_and_b32 s70, s70, 0x7ff
    s_sub_u32 s70, 2047, s70
    s_lshr_b32 s70, s70, 7
    s_mul_i32 s70, s70, 5120
    s_atomic_add s3, s[6:7], s70 offset:524424
    s_atomic_add s3, s[6:7], s70 offset:524936
    s_atomic_add s3, s[6:7], s70 offset:525448
    s_atomic_add s3, s[6:7], s70 offset:525960
    s_atomic_add s3, s[6:7], s70 offset:526472
    s_atomic_add s3, s[6:7], s70 offset:526984
    s_atomic_add s3, s[6:7], s70 offset:527496
    s_atomic_add s3, s[6:7], s70 offset:528008
    s_atomic_add s3, s[6:7], s70 offset:528520
    s_atomic_add s3, s[6:7], s70 offset:529032
    v_readfirstlane_b32 s70, v177
    s_and_b32 s70, s70, 0x7ff
    s_sub_u32 s70, 2047, s70
    s_lshr_b32 s70, s70, 7
    s_mul_i32 s70, s70, 5120
    s_atomic_add s3, s[6:7], s70 offset:524424
    s_atomic_add s3, s[6:7], s70 offset:524936
    s_atomic_add s3, s[6:7], s70 offset:525448
    s_atomic_add s3, s[6:7], s70 offset:525960
    s_atomic_add s3, s[6:7], s70 offset:526472
    s_atomic_add s3, s[6:7], s70 offset:526984
    s_atomic_add s3, s[6:7], s70 offset:527496
    s_atomic_add s3, s[6:7], s70 offset:528008
    s_atomic_add s3, s[6:7], s70 offset:528520
    s_atomic_add s3, s[6:7], s70 offset:529032
    s_waitcnt lgkmcnt(0)
    s_branch K_P2
K_CODE_END:
.section .rodata,"a"
.p2align 6
.amdhsa_kernel gated_mix__sliding_local_dilated__moe_arch_mod__prompt_kernel
  .amdhsa_next_free_vgpr 256
  .amdhsa_next_free_sgpr 79
  .amdhsa_accum_offset 256
  .amdhsa_group_segment_fixed_size 0
  .amdhsa_kernarg_size 96
  .amdhsa_user_sgpr_count 2
  .amdhsa_user_sgpr_kernarg_segment_ptr 1
  .amdhsa_system_sgpr_workgroup_id_x 1
.end_amdhsa_kernel
```
